```python
import torch

def _softmax(x, axis=-1):
    return torch.softmax(x, dim=axis)
def _gelu(x):
    return torch.nn.functional.gelu(x, approximate="tanh")
def _silu(x):
    return torch.nn.functional.silu(x)
def _sigmoid(x):
    return torch.sigmoid(x)
def _layernorm(x, axis=-1, eps=1e-5):
    m = x.mean(dim=axis, keepdim=True)
    v = x.var(dim=axis, keepdim=True, unbiased=False)
    return (x - m) / torch.sqrt(v + eps)
def _scatter_add(tgt, idx, src, axis=0):
    return tgt.clone().index_add_(axis, idx, src)
def _segment_sum(src, seg, n):
    out = torch.zeros((n,) + src.shape[1:], dtype=src.dtype)
    return out.index_add_(0, seg, src)
def _pad(x, pw):
    flat = tuple(v for pair in reversed(pw) for v in pair)
    return torch.nn.functional.pad(x, flat)

kernel_name = 'interleave_layers__sliding_local_dilated__glu_gated_swiglu__prompt'

def setup_inputs():

    _w = (lambda a: (lambda t: t.to(torch.bfloat16) if t.is_floating_point() else t)(torch.as_tensor(a)))
    def _A_setup():
        B, S, D = 1, 2048, 1024
        return {
            "x": _w((lambda *s: torch.randn(*s, dtype=torch.bfloat16) * 0.05)(B, S, D)),
            "wqkv": _w((lambda *s: torch.randn(*s, dtype=torch.bfloat16) * 0.05)(D, 3 * D)),
            "wo": _w((lambda *s: torch.randn(*s, dtype=torch.bfloat16) * 0.05)(D, D)),
        }
    _A_in = _A_setup()

    def _B_setup():
        B, S, D, F = 1, 2048, 1024, 3584
        return {
            "x": _w((lambda *s: torch.randn(*s, dtype=torch.bfloat16) * 0.05)(B, S, D)),
            "w1": _w((lambda *s: torch.randn(*s, dtype=torch.bfloat16) * 0.8)(D, F) * (2.0 / D) ** 0.5),
            "w3": _w((lambda *s: torch.randn(*s, dtype=torch.bfloat16) * 0.8)(D, F) * (2.0 / D) ** 0.5),
            "w2": _w((lambda *s: torch.randn(*s, dtype=torch.bfloat16) * 0.8)(F, D) * (2.0 / F) ** 0.5),
        }
    _B_in = _B_setup()

    return {
        "A_x": _A_in["x"],
        "A_wqkv": _A_in["wqkv"],
        "A_wo": _A_in["wo"],
        "B_x": _B_in["x"],
        "B_w1": _B_in["w1"],
        "B_w3": _B_in["w3"],
        "B_w2": _B_in["w2"],
    }

def reference(A_x, A_wqkv, A_wo, B_x, B_w1, B_w3, B_w2):
    def _A_ref(x, wqkv, wo):
        B, S, D = x.shape
        H = 32; Dh = D // H
        W, dil = 8, 2
        qkv = (lambda x, *d: x.permute(*d))((x @ wqkv).reshape(B, S, 3, H, Dh), 2, 0, 3, 1, 4)
        q, k, v = qkv[0], qkv[1], qkv[2]
        scale = Dh ** -0.5
        pos = torch.arange(S)
        off = torch.arange(W) * dil
        idx = pos[:, None] - off[None, :]
        mask = idx >= 0
        idx_c = torch.where(mask, idx, 0).reshape(-1)
        kg = k[:, :, idx_c, :].reshape(B, H, S, W, Dh)
        vg = v[:, :, idx_c, :].reshape(B, H, S, W, Dh)
        logits = torch.einsum("bhsd,bhswd->bhsw", q, kg) * scale
        logits = torch.where(mask[None, None, :, :], logits, -1e9)
        attn = _softmax(logits, axis=-1)
        o = torch.einsum("bhsw,bhswd->bhsd", attn, vg)
        return (lambda x, *d: x.permute(*d))(o, 0, 2, 1, 3).reshape(B, S, D) @ wo

    def _B_ref(x, w1, w3, w2):
        gate = torch.einsum("bsd,df->bsf", x, w1)
        up = torch.einsum("bsd,df->bsf", x, w3)
        h = _silu(gate) * up
        out = torch.einsum("bsf,fd->bsd", h, w2)
        return out

    x = A_x
    x = x + _A_ref(_layernorm(x, axis=-1), A_wqkv, A_wo)
    x = x + _B_ref(_layernorm(x, axis=-1), B_w1, B_w3, B_w2)
    x = x + _A_ref(_layernorm(x, axis=-1), A_wqkv, A_wo)
    x = x + _B_ref(_layernorm(x, axis=-1), B_w1, B_w3, B_w2)
    return x
```

```asm
; @launch grid=(256,1,1) block=(512,1,1) lds=163840
.amdgcn_target "amdgcn-amd-amdhsa--gfx950"
.text
.globl interleave_layers__sliding_local_dilated__glu_gated_swiglu__prompt_kernel
.p2align 8
.type interleave_layers__sliding_local_dilated__glu_gated_swiglu__prompt_kernel,@function
interleave_layers__sliding_local_dilated__glu_gated_swiglu__prompt_kernel:
    s_cmp_ge_u32 s2, 256
    s_cbranch_scc0 K_go
    s_endpgm
K_go:
    s_load_dwordx4 s[72:75], s[0:1], 0
    s_load_dwordx2 s[76:77], s[0:1], 16
    s_load_dwordx8 s[80:87], s[0:1], 32
    s_load_dwordx4 s[88:91], s[0:1], 64
    v_lshrrev_b32 v1, 6, v0
    v_and_b32 v254, 63, v0
    v_readfirstlane_b32 s3, v1
    v_lshlrev_b32 v254, 4, v254
    v_mov_b32 v255, 0
    s_and_b32 s55, s2, 6
    s_lshl_b32 s55, s55, 1
    s_lshr_b32 s56, s2, 3
    s_and_b32 s56, s56, 3
    s_add_u32 s40, s55, s56
    s_and_b32 s55, s2, 1
    s_lshr_b32 s56, s2, 5
    s_lshl_b32 s41, s55, 3
    s_add_u32 s41, s41, s56
    s_lshl_b32 s51, s56, 1
    s_add_u32 s51, s51, s55
    s_and_b32 s42, s3, 3
    s_and_b32 s43, s3, 1
    s_lshr_b32 s44, s42, 1
    s_mov_b32 s45, 1
    s_mov_b32 s46, 0
    s_lshl_b32 s47, s40, 18
    s_add_u32 s49, s47, 8388608
    s_add_u32 s48, s47, 12582912
    s_mul_i32 s50, s40, 917504
    s_add_u32 s50, s50, 20971520
    s_lshl_b32 s52, s40, 15
    s_add_u32 s52, s52, 67108864
    s_add_u32 s53, s52, 524288
    s_lshl_b32 s54, s40, 7
    s_add_u32 s54, s54, 71303168
    s_waitcnt lgkmcnt(0)
    s_mov_b32 s4, s90
    s_mov_b32 s5, s91
    s_mov_b32 s6, 268435456
    s_mov_b32 s7, 0x00020000
    s_mov_b32 s8, s74
    s_mov_b32 s9, s75
    s_mov_b32 s10, 6291456
    s_mov_b32 s11, 0x00020000
    s_mov_b32 s24, s72
    s_mov_b32 s25, s73
    s_mov_b32 s26, 4194304
    s_mov_b32 s27, 0x00020000
    s_mov_b32 s12, s76
    s_mov_b32 s13, s77
    s_mov_b32 s14, 2097152
    s_mov_b32 s15, 0x00020000
    s_cmp_eq_u32 s43, 0
    s_cselect_b32 s16, s80, s82
    s_cselect_b32 s17, s81, s83
    s_mov_b32 s18, 7340032
    s_mov_b32 s19, 0x00020000
    s_mov_b32 s20, s84
    s_mov_b32 s21, s85
    s_mov_b32 s22, 7340032
    s_mov_b32 s23, 0x00020000
    s_mov_b32 s28, s86
    s_mov_b32 s29, s87
    s_mov_b32 s30, 4194304
    s_mov_b32 s31, 0x00020000
    s_mov_b32 s32, s88
    s_mov_b32 s33, s89
    s_mov_b32 s34, 256
    s_mov_b32 s35, 0x00020000
    s_mov_b32 s36, s72
    s_mov_b32 s37, s73
    s_mov_b32 s38, 4194304
    s_mov_b32 s39, 0x00020000
    s_cmp_ge_u32 s3, 4
    s_cbranch_scc1 Y_start
    s_getpc_b64 s[72:73]
K_pc:
    s_mov_b32 s74, K_end-K_pc
    s_mov_b32 s75, 0x00020000
    s_lshr_b32 s55, s2, 3
    s_lshl_b32 s55, s55, 2
    s_add_u32 s55, s55, s42
    s_lshl_b32 s55, s55, 10
    v_lshlrev_b32 v100, 3, v254
    s_mov_b64 exec, 0xff
    buffer_load_dword v101, v100, s[72:75], s55 offen
    s_mov_b64 exec, -1
    v_lshrrev_b32 v100, 7, v254
    v_and_b32 v102, 0x70, v254
    s_cmp_eq_u32 s42, 3
    s_cbranch_scc1 xp_1
    v_mul_u32_u24 v100, 6144, v100
    v_add_u32 v100, v100, v102
    s_mul_i32 s56, s2, 3
    s_add_u32 s56, s56, s42
    s_and_b32 s55, s56, 15
    s_mul_i32 s55, s55, 393216
    s_lshr_b32 s57, s56, 4
    s_lshl_b32 s57, s57, 7
    s_add_u32 s55, s55, s57
    buffer_load_dwordx4 v[0:3], v100, s[8:11], s55 offen
    s_add_u32 s55, s55, 49152
    buffer_load_dwordx4 v[4:7], v100, s[8:11], s55 offen
    s_add_u32 s55, s55, 49152
    buffer_load_dwordx4 v[8:11], v100, s[8:11], s55 offen
    s_add_u32 s55, s55, 49152
    buffer_load_dwordx4 v[12:15], v100, s[8:11], s55 offen
    s_add_u32 s55, s55, 49152
    buffer_load_dwordx4 v[16:19], v100, s[8:11], s55 offen
    s_add_u32 s55, s55, 49152
    buffer_load_dwordx4 v[20:23], v100, s[8:11], s55 offen
    s_add_u32 s55, s55, 49152
    buffer_load_dwordx4 v[24:27], v100, s[8:11], s55 offen
    s_add_u32 s55, s55, 49152
    buffer_load_dwordx4 v[28:31], v100, s[8:11], s55 offen
    s_add_u32 s55, s55, 49152
    v_mov_b32 v64, 0
    v_mov_b32 v65, 0
    v_mov_b32 v66, 0
    v_mov_b32 v67, 0
    v_mov_b32 v68, 0
    v_mov_b32 v69, 0
    v_mov_b32 v70, 0
    v_mov_b32 v71, 0
    v_mov_b32 v102, 0x00003f80
    v_mov_b32 v103, 0x3f800000
    s_waitcnt vmcnt(7)
    v_dot2_f32_bf16 v64, v0, v102, v64
    v_dot2_f32_bf16 v65, v0, v103, v65
    v_dot2_f32_bf16 v66, v1, v102, v66
    v_dot2_f32_bf16 v67, v1, v103, v67
    v_dot2_f32_bf16 v68, v2, v102, v68
    v_dot2_f32_bf16 v69, v2, v103, v69
    v_dot2_f32_bf16 v70, v3, v102, v70
    v_dot2_f32_bf16 v71, v3, v103, v71
    s_waitcnt vmcnt(6)
    v_dot2_f32_bf16 v64, v4, v102, v64
    v_dot2_f32_bf16 v65, v4, v103, v65
    v_dot2_f32_bf16 v66, v5, v102, v66
    v_dot2_f32_bf16 v67, v5, v103, v67
    v_dot2_f32_bf16 v68, v6, v102, v68
    v_dot2_f32_bf16 v69, v6, v103, v69
    v_dot2_f32_bf16 v70, v7, v102, v70
    v_dot2_f32_bf16 v71, v7, v103, v71
    s_waitcnt vmcnt(5)
    v_dot2_f32_bf16 v64, v8, v102, v64
    v_dot2_f32_bf16 v65, v8, v103, v65
    v_dot2_f32_bf16 v66, v9, v102, v66
    v_dot2_f32_bf16 v67, v9, v103, v67
    v_dot2_f32_bf16 v68, v10, v102, v68
    v_dot2_f32_bf16 v69, v10, v103, v69
    v_dot2_f32_bf16 v70, v11, v102, v70
    v_dot2_f32_bf16 v71, v11, v103, v71
    s_waitcnt vmcnt(4)
    v_dot2_f32_bf16 v64, v12, v102, v64
    v_dot2_f32_bf16 v65, v12, v103, v65
    v_dot2_f32_bf16 v66, v13, v102, v66
    v_dot2_f32_bf16 v67, v13, v103, v67
    v_dot2_f32_bf16 v68, v14, v102, v68
    v_dot2_f32_bf16 v69, v14, v103, v69
    v_dot2_f32_bf16 v70, v15, v102, v70
    v_dot2_f32_bf16 v71, v15, v103, v71
    s_waitcnt vmcnt(3)
    v_dot2_f32_bf16 v64, v16, v102, v64
    v_dot2_f32_bf16 v65, v16, v103, v65
    v_dot2_f32_bf16 v66, v17, v102, v66
    v_dot2_f32_bf16 v67, v17, v103, v67
    v_dot2_f32_bf16 v68, v18, v102, v68
    v_dot2_f32_bf16 v69, v18, v103, v69
    v_dot2_f32_bf16 v70, v19, v102, v70
    v_dot2_f32_bf16 v71, v19, v103, v71
    s_waitcnt vmcnt(2)
    v_dot2_f32_bf16 v64, v20, v102, v64
    v_dot2_f32_bf16 v65, v20, v103, v65
    v_dot2_f32_bf16 v66, v21, v102, v66
    v_dot2_f32_bf16 v67, v21, v103, v67
    v_dot2_f32_bf16 v68, v22, v102, v68
    v_dot2_f32_bf16 v69, v22, v103, v69
    v_dot2_f32_bf16 v70, v23, v102, v70
    v_dot2_f32_bf16 v71, v23, v103, v71
    s_waitcnt vmcnt(1)
    v_dot2_f32_bf16 v64, v24, v102, v64
    v_dot2_f32_bf16 v65, v24, v103, v65
    v_dot2_f32_bf16 v66, v25, v102, v66
    v_dot2_f32_bf16 v67, v25, v103, v67
    v_dot2_f32_bf16 v68, v26, v102, v68
    v_dot2_f32_bf16 v69, v26, v103, v69
    v_dot2_f32_bf16 v70, v27, v102, v70
    v_dot2_f32_bf16 v71, v27, v103, v71
    s_waitcnt vmcnt(0)
    v_dot2_f32_bf16 v64, v28, v102, v64
    v_dot2_f32_bf16 v65, v28, v103, v65
    v_dot2_f32_bf16 v66, v29, v102, v66
    v_dot2_f32_bf16 v67, v29, v103, v67
    v_dot2_f32_bf16 v68, v30, v102, v68
    v_dot2_f32_bf16 v69, v30, v103, v69
    v_dot2_f32_bf16 v70, v31, v102, v70
    v_dot2_f32_bf16 v71, v31, v103, v71
    s_nop 3
    v_add_f32_dpp v64, v64, v64 row_ror:8 row_mask:0xf bank_mask:0xf
    v_add_f32_dpp v65, v65, v65 row_ror:8 row_mask:0xf bank_mask:0xf
    v_add_f32_dpp v66, v66, v66 row_ror:8 row_mask:0xf bank_mask:0xf
    v_add_f32_dpp v67, v67, v67 row_ror:8 row_mask:0xf bank_mask:0xf
    v_add_f32_dpp v68, v68, v68 row_ror:8 row_mask:0xf bank_mask:0xf
    v_add_f32_dpp v69, v69, v69 row_ror:8 row_mask:0xf bank_mask:0xf
    v_add_f32_dpp v70, v70, v70 row_ror:8 row_mask:0xf bank_mask:0xf
    v_add_f32_dpp v71, v71, v71 row_ror:8 row_mask:0xf bank_mask:0xf
    v_mov_b32 v80, v64
    v_mov_b32 v81, v65
    v_mov_b32 v82, v66
    v_mov_b32 v83, v67
    v_mov_b32 v84, v68
    v_mov_b32 v85, v69
    v_mov_b32 v86, v70
    v_mov_b32 v87, v71
    s_nop 1
    v_permlane16_swap_b32 v64, v80
    v_permlane16_swap_b32 v65, v81
    v_permlane16_swap_b32 v66, v82
    v_permlane16_swap_b32 v67, v83
    v_permlane16_swap_b32 v68, v84
    v_permlane16_swap_b32 v69, v85
    v_permlane16_swap_b32 v70, v86
    v_permlane16_swap_b32 v71, v87
    v_add_f32 v64, v64, v80
    v_add_f32 v65, v65, v81
    v_add_f32 v66, v66, v82
    v_add_f32 v67, v67, v83
    v_add_f32 v68, v68, v84
    v_add_f32 v69, v69, v85
    v_add_f32 v70, v70, v86
    v_add_f32 v71, v71, v87
    v_mov_b32 v80, v64
    v_mov_b32 v81, v65
    v_mov_b32 v82, v66
    v_mov_b32 v83, v67
    v_mov_b32 v84, v68
    v_mov_b32 v85, v69
    v_mov_b32 v86, v70
    v_mov_b32 v87, v71
    s_nop 1
    v_permlane32_swap_b32 v64, v80
    v_permlane32_swap_b32 v65, v81
    v_permlane32_swap_b32 v66, v82
    v_permlane32_swap_b32 v67, v83
    v_permlane32_swap_b32 v68, v84
    v_permlane32_swap_b32 v69, v85
    v_permlane32_swap_b32 v70, v86
    v_permlane32_swap_b32 v71, v87
    v_add_f32 v64, v64, v80
    v_add_f32 v65, v65, v81
    v_add_f32 v66, v66, v82
    v_add_f32 v67, v67, v83
    v_add_f32 v68, v68, v84
    v_add_f32 v69, v69, v85
    v_add_f32 v70, v70, v86
    v_add_f32 v71, v71, v87
    s_and_b32 s55, s56, 15
    s_mul_i32 s55, s55, 12288
    s_lshl_b32 s57, s57, 1
    s_add_u32 s55, s55, s57
    s_add_u32 s55, s55, 70516736
    v_lshlrev_b32 v100, 1, v254
    s_mov_b64 exec, 0xff
    buffer_store_dwordx4 v[64:67], v100, s[4:7], s55 offen sc0 sc1
    buffer_store_dwordx4 v[68:71], v100, s[4:7], s55 offen offset:16 sc0 sc1
    s_mov_b64 exec, -1
    s_branch xp_2
xp_1:
    v_lshl_add_u32 v100, v100, 11, v102
    s_lshl_b32 s55, s2, 14
    buffer_load_dwordx4 v[0:3], v100, s[24:27], s55 offen offset:0
    buffer_load_dwordx4 v[4:7], v100, s[24:27], s55 offen offset:128
    buffer_load_dwordx4 v[8:11], v100, s[24:27], s55 offen offset:256
    buffer_load_dwordx4 v[12:15], v100, s[24:27], s55 offen offset:384
    buffer_load_dwordx4 v[16:19], v100, s[24:27], s55 offen offset:512
    buffer_load_dwordx4 v[20:23], v100, s[24:27], s55 offen offset:640
    buffer_load_dwordx4 v[24:27], v100, s[24:27], s55 offen offset:768
    buffer_load_dwordx4 v[28:31], v100, s[24:27], s55 offen offset:896
    buffer_load_dwordx4 v[32:35], v100, s[24:27], s55 offen offset:1024
    buffer_load_dwordx4 v[36:39], v100, s[24:27], s55 offen offset:1152
    buffer_load_dwordx4 v[40:43], v100, s[24:27], s55 offen offset:1280
    buffer_load_dwordx4 v[44:47], v100, s[24:27], s55 offen offset:1408
    buffer_load_dwordx4 v[48:51], v100, s[24:27], s55 offen offset:1536
    buffer_load_dwordx4 v[52:55], v100, s[24:27], s55 offen offset:1664
    buffer_load_dwordx4 v[56:59], v100, s[24:27], s55 offen offset:1792
    buffer_load_dwordx4 v[60:63], v100, s[24:27], s55 offen offset:1920
    v_mov_b32 v64, 0
    v_mov_b32 v65, 0
    v_mov_b32 v66, 0
    v_mov_b32 v67, 0
    v_mov_b32 v102, 0x3f803f80
    s_waitcnt vmcnt(15)
    v_dot2_f32_bf16 v64, v0, v102, v64
    v_dot2_f32_bf16 v65, v0, v0, v65
    v_dot2_f32_bf16 v66, v1, v102, v66
    v_dot2_f32_bf16 v67, v1, v1, v67
    v_dot2_f32_bf16 v64, v2, v102, v64
    v_dot2_f32_bf16 v65, v2, v2, v65
    v_dot2_f32_bf16 v66, v3, v102, v66
    v_dot2_f32_bf16 v67, v3, v3, v67
    s_waitcnt vmcnt(14)
    v_dot2_f32_bf16 v64, v4, v102, v64
    v_dot2_f32_bf16 v65, v4, v4, v65
    v_dot2_f32_bf16 v66, v5, v102, v66
    v_dot2_f32_bf16 v67, v5, v5, v67
    v_dot2_f32_bf16 v64, v6, v102, v64
    v_dot2_f32_bf16 v65, v6, v6, v65
    v_dot2_f32_bf16 v66, v7, v102, v66
    v_dot2_f32_bf16 v67, v7, v7, v67
    s_waitcnt vmcnt(13)
    v_dot2_f32_bf16 v64, v8, v102, v64
    v_dot2_f32_bf16 v65, v8, v8, v65
    v_dot2_f32_bf16 v66, v9, v102, v66
    v_dot2_f32_bf16 v67, v9, v9, v67
    v_dot2_f32_bf16 v64, v10, v102, v64
    v_dot2_f32_bf16 v65, v10, v10, v65
    v_dot2_f32_bf16 v66, v11, v102, v66
    v_dot2_f32_bf16 v67, v11, v11, v67
    s_waitcnt vmcnt(12)
    v_dot2_f32_bf16 v64, v12, v102, v64
    v_dot2_f32_bf16 v65, v12, v12, v65
    v_dot2_f32_bf16 v66, v13, v102, v66
    v_dot2_f32_bf16 v67, v13, v13, v67
    v_dot2_f32_bf16 v64, v14, v102, v64
    v_dot2_f32_bf16 v65, v14, v14, v65
    v_dot2_f32_bf16 v66, v15, v102, v66
    v_dot2_f32_bf16 v67, v15, v15, v67
    s_waitcnt vmcnt(11)
    v_dot2_f32_bf16 v64, v16, v102, v64
    v_dot2_f32_bf16 v65, v16, v16, v65
    v_dot2_f32_bf16 v66, v17, v102, v66
    v_dot2_f32_bf16 v67, v17, v17, v67
    v_dot2_f32_bf16 v64, v18, v102, v64
    v_dot2_f32_bf16 v65, v18, v18, v65
    v_dot2_f32_bf16 v66, v19, v102, v66
    v_dot2_f32_bf16 v67, v19, v19, v67
    s_waitcnt vmcnt(10)
    v_dot2_f32_bf16 v64, v20, v102, v64
    v_dot2_f32_bf16 v65, v20, v20, v65
    v_dot2_f32_bf16 v66, v21, v102, v66
    v_dot2_f32_bf16 v67, v21, v21, v67
    v_dot2_f32_bf16 v64, v22, v102, v64
    v_dot2_f32_bf16 v65, v22, v22, v65
    v_dot2_f32_bf16 v66, v23, v102, v66
    v_dot2_f32_bf16 v67, v23, v23, v67
    s_waitcnt vmcnt(9)
    v_dot2_f32_bf16 v64, v24, v102, v64
    v_dot2_f32_bf16 v65, v24, v24, v65
    v_dot2_f32_bf16 v66, v25, v102, v66
    v_dot2_f32_bf16 v67, v25, v25, v67
    v_dot2_f32_bf16 v64, v26, v102, v64
    v_dot2_f32_bf16 v65, v26, v26, v65
    v_dot2_f32_bf16 v66, v27, v102, v66
    v_dot2_f32_bf16 v67, v27, v27, v67
    s_waitcnt vmcnt(8)
    v_dot2_f32_bf16 v64, v28, v102, v64
    v_dot2_f32_bf16 v65, v28, v28, v65
    v_dot2_f32_bf16 v66, v29, v102, v66
    v_dot2_f32_bf16 v67, v29, v29, v67
    v_dot2_f32_bf16 v64, v30, v102, v64
    v_dot2_f32_bf16 v65, v30, v30, v65
    v_dot2_f32_bf16 v66, v31, v102, v66
    v_dot2_f32_bf16 v67, v31, v31, v67
    s_waitcnt vmcnt(7)
    v_dot2_f32_bf16 v64, v32, v102, v64
    v_dot2_f32_bf16 v65, v32, v32, v65
    v_dot2_f32_bf16 v66, v33, v102, v66
    v_dot2_f32_bf16 v67, v33, v33, v67
    v_dot2_f32_bf16 v64, v34, v102, v64
    v_dot2_f32_bf16 v65, v34, v34, v65
    v_dot2_f32_bf16 v66, v35, v102, v66
    v_dot2_f32_bf16 v67, v35, v35, v67
    s_waitcnt vmcnt(6)
    v_dot2_f32_bf16 v64, v36, v102, v64
    v_dot2_f32_bf16 v65, v36, v36, v65
    v_dot2_f32_bf16 v66, v37, v102, v66
    v_dot2_f32_bf16 v67, v37, v37, v67
    v_dot2_f32_bf16 v64, v38, v102, v64
    v_dot2_f32_bf16 v65, v38, v38, v65
    v_dot2_f32_bf16 v66, v39, v102, v66
    v_dot2_f32_bf16 v67, v39, v39, v67
    s_waitcnt vmcnt(5)
    v_dot2_f32_bf16 v64, v40, v102, v64
    v_dot2_f32_bf16 v65, v40, v40, v65
    v_dot2_f32_bf16 v66, v41, v102, v66
    v_dot2_f32_bf16 v67, v41, v41, v67
    v_dot2_f32_bf16 v64, v42, v102, v64
    v_dot2_f32_bf16 v65, v42, v42, v65
    v_dot2_f32_bf16 v66, v43, v102, v66
    v_dot2_f32_bf16 v67, v43, v43, v67
    s_waitcnt vmcnt(4)
    v_dot2_f32_bf16 v64, v44, v102, v64
    v_dot2_f32_bf16 v65, v44, v44, v65
    v_dot2_f32_bf16 v66, v45, v102, v66
    v_dot2_f32_bf16 v67, v45, v45, v67
    v_dot2_f32_bf16 v64, v46, v102, v64
    v_dot2_f32_bf16 v65, v46, v46, v65
    v_dot2_f32_bf16 v66, v47, v102, v66
    v_dot2_f32_bf16 v67, v47, v47, v67
    s_waitcnt vmcnt(3)
    v_dot2_f32_bf16 v64, v48, v102, v64
    v_dot2_f32_bf16 v65, v48, v48, v65
    v_dot2_f32_bf16 v66, v49, v102, v66
    v_dot2_f32_bf16 v67, v49, v49, v67
    v_dot2_f32_bf16 v64, v50, v102, v64
    v_dot2_f32_bf16 v65, v50, v50, v65
    v_dot2_f32_bf16 v66, v51, v102, v66
    v_dot2_f32_bf16 v67, v51, v51, v67
    s_waitcnt vmcnt(2)
    v_dot2_f32_bf16 v64, v52, v102, v64
    v_dot2_f32_bf16 v65, v52, v52, v65
    v_dot2_f32_bf16 v66, v53, v102, v66
    v_dot2_f32_bf16 v67, v53, v53, v67
    v_dot2_f32_bf16 v64, v54, v102, v64
    v_dot2_f32_bf16 v65, v54, v54, v65
    v_dot2_f32_bf16 v66, v55, v102, v66
    v_dot2_f32_bf16 v67, v55, v55, v67
    s_waitcnt vmcnt(1)
    v_dot2_f32_bf16 v64, v56, v102, v64
    v_dot2_f32_bf16 v65, v56, v56, v65
    v_dot2_f32_bf16 v66, v57, v102, v66
    v_dot2_f32_bf16 v67, v57, v57, v67
    v_dot2_f32_bf16 v64, v58, v102, v64
    v_dot2_f32_bf16 v65, v58, v58, v65
    v_dot2_f32_bf16 v66, v59, v102, v66
    v_dot2_f32_bf16 v67, v59, v59, v67
    s_waitcnt vmcnt(0)
    v_dot2_f32_bf16 v64, v60, v102, v64
    v_dot2_f32_bf16 v65, v60, v60, v65
    v_dot2_f32_bf16 v66, v61, v102, v66
    v_dot2_f32_bf16 v67, v61, v61, v67
    v_dot2_f32_bf16 v64, v62, v102, v64
    v_dot2_f32_bf16 v65, v62, v62, v65
    v_dot2_f32_bf16 v66, v63, v102, v66
    v_dot2_f32_bf16 v67, v63, v63, v67
    s_nop 3
    v_add_f32 v64, v64, v66
    v_add_f32 v65, v65, v67
    s_nop 1
    v_add_f32_dpp v64, v64, v64 quad_perm:[1,0,3,2] row_mask:0xf bank_mask:0xf
    v_add_f32_dpp v65, v65, v65 quad_perm:[1,0,3,2] row_mask:0xf bank_mask:0xf
    s_nop 1
    v_add_f32_dpp v64, v64, v64 quad_perm:[2,3,0,1] row_mask:0xf bank_mask:0xf
    v_add_f32_dpp v65, v65, v65 quad_perm:[2,3,0,1] row_mask:0xf bank_mask:0xf
    s_nop 1
    v_add_f32_dpp v64, v64, v64 row_half_mirror row_mask:0xf bank_mask:0xf
    v_add_f32_dpp v65, v65, v65 row_half_mirror row_mask:0xf bank_mask:0xf
    v_lshrrev_b32 v100, 4, v254
    s_lshl_b32 s55, s2, 6
    s_add_u32 s55, s55, 70254592
    s_mov_b32 s70, 0x01010101
    s_mov_b32 s71, 0x01010101
    s_mov_b64 exec, s[70:71]
    buffer_store_dwordx2 v[64:65], v100, s[4:7], s55 offen sc0 sc1
    s_mov_b64 exec, -1
xp_2:
X_layer:
    v_lshrrev_b32 v206, 4, v254
    v_lshrrev_b32 v207, 8, v254
    v_and_b32 v208, 15, v206
    s_lshl_b32 s55, s44, 13
    s_add_u32 s55, s55, 98304
    s_cmp_lg_u32 s46, 0
    s_cbranch_scc1 g1_3
    v_and_b32 v210, 6, v208
    v_xor_b32 v210, v210, v207
    v_lshlrev_b32 v210, 4, v210
    v_lshl_add_u32 v200, v208, 7, v210
    v_xor_b32 v201, 64, v200
    s_branch g1_4
g1_3:
    v_mov_b32 v200, v254
    v_add_u32 v201, 1024, v254
g1_4:
    v_add_u32 v200, s55, v200
    v_add_u32 v201, s55, v201
    v_lshrrev_b32 v209, 6, v254
    v_lshrrev_b32 v210, 1, v209
    v_and_b32 v210, 3, v210
    s_lshl_b32 s55, s43, 1
    v_xor_b32 v210, s55, v210
    v_lshlrev_b32 v209, 7, v209
    v_lshl_add_u32 v209, v210, 5, v209
    v_and_b32 v210, 0x30, v254
    v_lshrrev_b32 v210, 1, v210
    v_add_u32 v202, v209, v210
    v_xor_b32 v203, 32, v202
    v_add_u32 v204, 49152, v202
    v_add_u32 v205, 49152, v203
    v_mov_b32 v0, 0
    v_mov_b32 v1, 0
    v_mov_b32 v2, 0
    v_mov_b32 v3, 0
    v_mov_b32 v4, 0
    v_mov_b32 v5, 0
    v_mov_b32 v6, 0
    v_mov_b32 v7, 0
    v_mov_b32 v8, 0
    v_mov_b32 v9, 0
    v_mov_b32 v10, 0
    v_mov_b32 v11, 0
    v_mov_b32 v12, 0
    v_mov_b32 v13, 0
    v_mov_b32 v14, 0
    v_mov_b32 v15, 0
    v_mov_b32 v16, 0
    v_mov_b32 v17, 0
    v_mov_b32 v18, 0
    v_mov_b32 v19, 0
    v_mov_b32 v20, 0
    v_mov_b32 v21, 0
    v_mov_b32 v22, 0
    v_mov_b32 v23, 0
    v_mov_b32 v24, 0
    v_mov_b32 v25, 0
    v_mov_b32 v26, 0
    v_mov_b32 v27, 0
    v_mov_b32 v28, 0
    v_mov_b32 v29, 0
    v_mov_b32 v30, 0
    v_mov_b32 v31, 0
    v_mov_b32 v32, 0
    v_mov_b32 v33, 0
    v_mov_b32 v34, 0
    v_mov_b32 v35, 0
    v_mov_b32 v36, 0
    v_mov_b32 v37, 0
    v_mov_b32 v38, 0
    v_mov_b32 v39, 0
    v_mov_b32 v40, 0
    v_mov_b32 v41, 0
    v_mov_b32 v42, 0
    v_mov_b32 v43, 0
    v_mov_b32 v44, 0
    v_mov_b32 v45, 0
    v_mov_b32 v46, 0
    v_mov_b32 v47, 0
    v_mov_b32 v48, 0
    v_mov_b32 v49, 0
    v_mov_b32 v50, 0
    v_mov_b32 v51, 0
    v_mov_b32 v52, 0
    v_mov_b32 v53, 0
    v_mov_b32 v54, 0
    v_mov_b32 v55, 0
    v_mov_b32 v56, 0
    v_mov_b32 v57, 0
    v_mov_b32 v58, 0
    v_mov_b32 v59, 0
    v_mov_b32 v60, 0
    v_mov_b32 v61, 0
    v_mov_b32 v62, 0
    v_mov_b32 v63, 0
    v_mov_b32 v64, 0
    v_mov_b32 v65, 0
    v_mov_b32 v66, 0
    v_mov_b32 v67, 0
    v_mov_b32 v68, 0
    v_mov_b32 v69, 0
    v_mov_b32 v70, 0
    v_mov_b32 v71, 0
    v_mov_b32 v72, 0
    v_mov_b32 v73, 0
    v_mov_b32 v74, 0
    v_mov_b32 v75, 0
    v_mov_b32 v76, 0
    v_mov_b32 v77, 0
    v_mov_b32 v78, 0
    v_mov_b32 v79, 0
    v_mov_b32 v80, 0
    v_mov_b32 v81, 0
    v_mov_b32 v82, 0
    v_mov_b32 v83, 0
    v_mov_b32 v84, 0
    v_mov_b32 v85, 0
    v_mov_b32 v86, 0
    v_mov_b32 v87, 0
    v_mov_b32 v88, 0
    v_mov_b32 v89, 0
    v_mov_b32 v90, 0
    v_mov_b32 v91, 0
    v_mov_b32 v92, 0
    v_mov_b32 v93, 0
    v_mov_b32 v94, 0
    v_mov_b32 v95, 0
    v_mov_b32 v96, 0
    v_mov_b32 v97, 0
    v_mov_b32 v98, 0
    v_mov_b32 v99, 0
    v_mov_b32 v100, 0
    v_mov_b32 v101, 0
    v_mov_b32 v102, 0
    v_mov_b32 v103, 0
    v_mov_b32 v104, 0
    v_mov_b32 v105, 0
    v_mov_b32 v106, 0
    v_mov_b32 v107, 0
    v_mov_b32 v108, 0
    v_mov_b32 v109, 0
    v_mov_b32 v110, 0
    v_mov_b32 v111, 0
    s_lshl_b32 s55, s51, 14
    s_lshl_b32 s56, s44, 13
    s_add_u32 s55, s55, s56
    s_lshl_b32 s56, s43, 10
    s_add_u32 s55, s55, s56
    s_add_u32 s62, s55, s47
    v_lshrrev_b32 v209, 3, v206
    v_and_b32 v209, 3, v209
    v_lshlrev_b32 v209, 11, v209
    v_and_b32 v210, 7, v206
    v_lshl_add_u32 v213, v210, 7, v209
    s_barrier
    ds_read_b64_tr_b16 v[152:153], v202 offset:0
    ds_read_b64_tr_b16 v[154:155], v202 offset:2048
    ds_read_b128 v[116:119], v200 offset:2048
    ds_read_b128 v[120:123], v200 offset:4096
    ds_read_b128 v[124:127], v200 offset:6144
    ds_read_b128 v[128:131], v200 offset:8192
    ds_read_b64_tr_b16 v[156:157], v203 offset:0
    ds_read_b64_tr_b16 v[158:159], v203 offset:2048
    ds_read_b64_tr_b16 v[160:161], v202 offset:4096
    ds_read_b64_tr_b16 v[162:163], v202 offset:6144
    ds_read_b128 v[112:115], v200 offset:0
    ds_read_b64_tr_b16 v[164:165], v203 offset:4096
    ds_read_b64_tr_b16 v[166:167], v203 offset:6144
    ds_read_b64_tr_b16 v[168:169], v202 offset:8192
    ds_read_b64_tr_b16 v[170:171], v202 offset:10240
    ds_read_b64_tr_b16 v[172:173], v203 offset:8192
    ds_read_b64_tr_b16 v[174:175], v203 offset:10240
    s_mov_b32 s58, 5
    .p2align 3
loop_5:
    s_waitcnt lgkmcnt(0)
    s_barrier
    .p2align 3
    v_mfma_f32_16x16x32_bf16 v[0:3], v[152:155], v[116:119], v[0:3]
    ds_read_b64_tr_b16 v[176:177], v202 offset:16384
    v_mfma_f32_16x16x32_bf16 v[8:11], v[152:155], v[120:123], v[8:11]
    ds_read_b64_tr_b16 v[178:179], v202 offset:18432
    v_mfma_f32_16x16x32_bf16 v[16:19], v[152:155], v[124:127], v[16:19]
    ds_read_b128 v[136:139], v201 offset:2048
    v_mfma_f32_16x16x32_bf16 v[24:27], v[152:155], v[128:131], v[24:27]
    ds_read_b128 v[140:143], v201 offset:4096
    v_mfma_f32_16x16x32_bf16 v[4:7], v[156:159], v[116:119], v[4:7]
    ds_read_b128 v[144:147], v201 offset:6144
    v_mfma_f32_16x16x32_bf16 v[12:15], v[156:159], v[120:123], v[12:15]
    v_mfma_f32_16x16x32_bf16 v[20:23], v[156:159], v[124:127], v[20:23]
    ds_read_b128 v[148:151], v201 offset:8192
    v_mfma_f32_16x16x32_bf16 v[28:31], v[156:159], v[128:131], v[28:31]
    ds_read_b64_tr_b16 v[180:181], v203 offset:16384
    v_mfma_f32_16x16x32_bf16 v[32:35], v[160:163], v[112:115], v[32:35]
    ds_read_b64_tr_b16 v[182:183], v203 offset:18432
    v_mfma_f32_16x16x32_bf16 v[40:43], v[160:163], v[116:119], v[40:43]
    ds_read_b64_tr_b16 v[184:185], v202 offset:20480
    v_mfma_f32_16x16x32_bf16 v[48:51], v[160:163], v[120:123], v[48:51]
    v_mfma_f32_16x16x32_bf16 v[56:59], v[160:163], v[124:127], v[56:59]
    ds_read_b64_tr_b16 v[186:187], v202 offset:22528
    v_mfma_f32_16x16x32_bf16 v[64:67], v[160:163], v[128:131], v[64:67]
    ds_read_b128 v[132:135], v201 offset:0
    v_mfma_f32_16x16x32_bf16 v[36:39], v[164:167], v[112:115], v[36:39]
    ds_read_b64_tr_b16 v[188:189], v203 offset:20480
    v_mfma_f32_16x16x32_bf16 v[44:47], v[164:167], v[116:119], v[44:47]
    ds_read_b64_tr_b16 v[190:191], v203 offset:22528
    v_mfma_f32_16x16x32_bf16 v[52:55], v[164:167], v[120:123], v[52:55]
    v_mfma_f32_16x16x32_bf16 v[60:63], v[164:167], v[124:127], v[60:63]
    ds_read_b64_tr_b16 v[192:193], v202 offset:24576
    v_mfma_f32_16x16x32_bf16 v[68:71], v[164:167], v[128:131], v[68:71]
    ds_read_b64_tr_b16 v[194:195], v202 offset:26624
    v_mfma_f32_16x16x32_bf16 v[72:75], v[112:115], v[168:171], v[72:75]
    ds_read_b64_tr_b16 v[196:197], v203 offset:24576
    v_mfma_f32_16x16x32_bf16 v[80:83], v[116:119], v[168:171], v[80:83]
    ds_read_b64_tr_b16 v[198:199], v203 offset:26624
    v_mfma_f32_16x16x32_bf16 v[88:91], v[120:123], v[168:171], v[88:91]
    v_mfma_f32_16x16x32_bf16 v[96:99], v[124:127], v[168:171], v[96:99]
    v_mfma_f32_16x16x32_bf16 v[104:107], v[128:131], v[168:171], v[104:107]
    v_mfma_f32_16x16x32_bf16 v[76:79], v[112:115], v[172:175], v[76:79]
    v_mfma_f32_16x16x32_bf16 v[84:87], v[116:119], v[172:175], v[84:87]
    v_mfma_f32_16x16x32_bf16 v[92:95], v[120:123], v[172:175], v[92:95]
    v_mfma_f32_16x16x32_bf16 v[100:103], v[124:127], v[172:175], v[100:103]
    v_mfma_f32_16x16x32_bf16 v[108:111], v[128:131], v[172:175], v[108:111]
    s_waitcnt lgkmcnt(0)
    s_barrier
    .p2align 3
    v_mfma_f32_16x16x32_bf16 v[0:3], v[176:179], v[136:139], v[0:3]
    ds_read_b64_tr_b16 v[152:153], v202 offset:32768
    v_mfma_f32_16x16x32_bf16 v[8:11], v[176:179], v[140:143], v[8:11]
    ds_read_b64_tr_b16 v[154:155], v202 offset:34816
    v_mfma_f32_16x16x32_bf16 v[16:19], v[176:179], v[144:147], v[16:19]
    ds_read_b128 v[116:119], v200 offset:20480
    v_mfma_f32_16x16x32_bf16 v[24:27], v[176:179], v[148:151], v[24:27]
    ds_read_b128 v[120:123], v200 offset:22528
    v_mfma_f32_16x16x32_bf16 v[4:7], v[180:183], v[136:139], v[4:7]
    ds_read_b128 v[124:127], v200 offset:24576
    v_mfma_f32_16x16x32_bf16 v[12:15], v[180:183], v[140:143], v[12:15]
    v_mfma_f32_16x16x32_bf16 v[20:23], v[180:183], v[144:147], v[20:23]
    ds_read_b128 v[128:131], v200 offset:26624
    v_mfma_f32_16x16x32_bf16 v[28:31], v[180:183], v[148:151], v[28:31]
    ds_read_b64_tr_b16 v[156:157], v203 offset:32768
    v_mfma_f32_16x16x32_bf16 v[32:35], v[184:187], v[132:135], v[32:35]
    ds_read_b64_tr_b16 v[158:159], v203 offset:34816
    v_mfma_f32_16x16x32_bf16 v[40:43], v[184:187], v[136:139], v[40:43]
    ds_read_b64_tr_b16 v[160:161], v202 offset:36864
    v_mfma_f32_16x16x32_bf16 v[48:51], v[184:187], v[140:143], v[48:51]
    v_mfma_f32_16x16x32_bf16 v[56:59], v[184:187], v[144:147], v[56:59]
    ds_read_b64_tr_b16 v[162:163], v202 offset:38912
    v_mfma_f32_16x16x32_bf16 v[64:67], v[184:187], v[148:151], v[64:67]
    ds_read_b128 v[112:115], v200 offset:18432
    v_mfma_f32_16x16x32_bf16 v[36:39], v[188:191], v[132:135], v[36:39]
    ds_read_b64_tr_b16 v[164:165], v203 offset:36864
    v_mfma_f32_16x16x32_bf16 v[44:47], v[188:191], v[136:139], v[44:47]
    ds_read_b64_tr_b16 v[166:167], v203 offset:38912
    v_mfma_f32_16x16x32_bf16 v[52:55], v[188:191], v[140:143], v[52:55]
    v_mfma_f32_16x16x32_bf16 v[60:63], v[188:191], v[144:147], v[60:63]
    ds_read_b64_tr_b16 v[168:169], v202 offset:40960
    v_mfma_f32_16x16x32_bf16 v[68:71], v[188:191], v[148:151], v[68:71]
    ds_read_b64_tr_b16 v[170:171], v202 offset:43008
    v_mfma_f32_16x16x32_bf16 v[72:75], v[132:135], v[192:195], v[72:75]
    ds_read_b64_tr_b16 v[172:173], v203 offset:40960
    v_mfma_f32_16x16x32_bf16 v[80:83], v[136:139], v[192:195], v[80:83]
    ds_read_b64_tr_b16 v[174:175], v203 offset:43008
    v_mfma_f32_16x16x32_bf16 v[88:91], v[140:143], v[192:195], v[88:91]
    v_mfma_f32_16x16x32_bf16 v[96:99], v[144:147], v[192:195], v[96:99]
    v_mfma_f32_16x16x32_bf16 v[104:107], v[148:151], v[192:195], v[104:107]
    v_mfma_f32_16x16x32_bf16 v[76:79], v[132:135], v[196:199], v[76:79]
    v_mfma_f32_16x16x32_bf16 v[84:87], v[136:139], v[196:199], v[84:87]
    v_mfma_f32_16x16x32_bf16 v[92:95], v[140:143], v[196:199], v[92:95]
    v_mfma_f32_16x16x32_bf16 v[100:103], v[144:147], v[196:199], v[100:103]
    v_mfma_f32_16x16x32_bf16 v[108:111], v[148:151], v[196:199], v[108:111]
    s_waitcnt vmcnt(0) lgkmcnt(0)
    s_barrier
    .p2align 3
    v_mfma_f32_16x16x32_bf16 v[0:3], v[152:155], v[116:119], v[0:3]
    ds_read_b64_tr_b16 v[176:177], v204 offset:0
    v_mfma_f32_16x16x32_bf16 v[8:11], v[152:155], v[120:123], v[8:11]
    ds_read_b64_tr_b16 v[178:179], v204 offset:2048
    v_mfma_f32_16x16x32_bf16 v[16:19], v[152:155], v[124:127], v[16:19]
    ds_read_b128 v[136:139], v201 offset:20480
    v_mfma_f32_16x16x32_bf16 v[24:27], v[152:155], v[128:131], v[24:27]
    ds_read_b128 v[140:143], v201 offset:22528
    v_mfma_f32_16x16x32_bf16 v[4:7], v[156:159], v[116:119], v[4:7]
    ds_read_b128 v[144:147], v201 offset:24576
    v_mfma_f32_16x16x32_bf16 v[12:15], v[156:159], v[120:123], v[12:15]
    v_mfma_f32_16x16x32_bf16 v[20:23], v[156:159], v[124:127], v[20:23]
    ds_read_b128 v[148:151], v201 offset:26624
    v_mfma_f32_16x16x32_bf16 v[28:31], v[156:159], v[128:131], v[28:31]
    ds_read_b64_tr_b16 v[180:181], v205 offset:0
    v_mfma_f32_16x16x32_bf16 v[32:35], v[160:163], v[112:115], v[32:35]
    ds_read_b64_tr_b16 v[182:183], v205 offset:2048
    v_mfma_f32_16x16x32_bf16 v[40:43], v[160:163], v[116:119], v[40:43]
    ds_read_b64_tr_b16 v[184:185], v204 offset:4096
    v_mfma_f32_16x16x32_bf16 v[48:51], v[160:163], v[120:123], v[48:51]
    v_mfma_f32_16x16x32_bf16 v[56:59], v[160:163], v[124:127], v[56:59]
    ds_read_b64_tr_b16 v[186:187], v204 offset:6144
    v_mfma_f32_16x16x32_bf16 v[64:67], v[160:163], v[128:131], v[64:67]
    ds_read_b128 v[132:135], v201 offset:18432
    v_mfma_f32_16x16x32_bf16 v[36:39], v[164:167], v[112:115], v[36:39]
    ds_read_b64_tr_b16 v[188:189], v205 offset:4096
    v_mfma_f32_16x16x32_bf16 v[44:47], v[164:167], v[116:119], v[44:47]
    ds_read_b64_tr_b16 v[190:191], v205 offset:6144
    v_mfma_f32_16x16x32_bf16 v[52:55], v[164:167], v[120:123], v[52:55]
    v_mfma_f32_16x16x32_bf16 v[60:63], v[164:167], v[124:127], v[60:63]
    ds_read_b64_tr_b16 v[192:193], v204 offset:8192
    v_mfma_f32_16x16x32_bf16 v[68:71], v[164:167], v[128:131], v[68:71]
    ds_read_b64_tr_b16 v[194:195], v204 offset:10240
    v_mfma_f32_16x16x32_bf16 v[72:75], v[112:115], v[168:171], v[72:75]
    ds_read_b64_tr_b16 v[196:197], v205 offset:8192
    v_mfma_f32_16x16x32_bf16 v[80:83], v[116:119], v[168:171], v[80:83]
    ds_read_b64_tr_b16 v[198:199], v205 offset:10240
    v_mfma_f32_16x16x32_bf16 v[88:91], v[120:123], v[168:171], v[88:91]
    v_mfma_f32_16x16x32_bf16 v[96:99], v[124:127], v[168:171], v[96:99]
    v_mfma_f32_16x16x32_bf16 v[104:107], v[128:131], v[168:171], v[104:107]
    v_mfma_f32_16x16x32_bf16 v[76:79], v[112:115], v[172:175], v[76:79]
    v_mfma_f32_16x16x32_bf16 v[84:87], v[116:119], v[172:175], v[84:87]
    v_mfma_f32_16x16x32_bf16 v[92:95], v[120:123], v[172:175], v[92:95]
    v_mfma_f32_16x16x32_bf16 v[100:103], v[124:127], v[172:175], v[100:103]
    v_mfma_f32_16x16x32_bf16 v[108:111], v[128:131], v[172:175], v[108:111]
    s_waitcnt lgkmcnt(0)
    s_barrier
    .p2align 3
    v_mfma_f32_16x16x32_bf16 v[0:3], v[176:179], v[136:139], v[0:3]
    ds_read_b64_tr_b16 v[152:153], v204 offset:16384
    v_mfma_f32_16x16x32_bf16 v[8:11], v[176:179], v[140:143], v[8:11]
    ds_read_b64_tr_b16 v[154:155], v204 offset:18432
    v_mfma_f32_16x16x32_bf16 v[16:19], v[176:179], v[144:147], v[16:19]
    ds_read_b128 v[116:119], v200 offset:38912
    v_mfma_f32_16x16x32_bf16 v[24:27], v[176:179], v[148:151], v[24:27]
    ds_read_b128 v[120:123], v200 offset:40960
    v_mfma_f32_16x16x32_bf16 v[4:7], v[180:183], v[136:139], v[4:7]
    ds_read_b128 v[124:127], v200 offset:43008
    v_mfma_f32_16x16x32_bf16 v[12:15], v[180:183], v[140:143], v[12:15]
    v_mfma_f32_16x16x32_bf16 v[20:23], v[180:183], v[144:147], v[20:23]
    ds_read_b128 v[128:131], v200 offset:45056
    v_mfma_f32_16x16x32_bf16 v[28:31], v[180:183], v[148:151], v[28:31]
    ds_read_b64_tr_b16 v[156:157], v205 offset:16384
    v_mfma_f32_16x16x32_bf16 v[32:35], v[184:187], v[132:135], v[32:35]
    ds_read_b64_tr_b16 v[158:159], v205 offset:18432
    v_mfma_f32_16x16x32_bf16 v[40:43], v[184:187], v[136:139], v[40:43]
    ds_read_b64_tr_b16 v[160:161], v204 offset:20480
    v_mfma_f32_16x16x32_bf16 v[48:51], v[184:187], v[140:143], v[48:51]
    v_mfma_f32_16x16x32_bf16 v[56:59], v[184:187], v[144:147], v[56:59]
    ds_read_b64_tr_b16 v[162:163], v204 offset:22528
    v_mfma_f32_16x16x32_bf16 v[64:67], v[184:187], v[148:151], v[64:67]
    ds_read_b128 v[112:115], v200 offset:36864
    v_mfma_f32_16x16x32_bf16 v[36:39], v[188:191], v[132:135], v[36:39]
    ds_read_b64_tr_b16 v[164:165], v205 offset:20480
    v_mfma_f32_16x16x32_bf16 v[44:47], v[188:191], v[136:139], v[44:47]
    ds_read_b64_tr_b16 v[166:167], v205 offset:22528
    v_mfma_f32_16x16x32_bf16 v[52:55], v[188:191], v[140:143], v[52:55]
    v_mfma_f32_16x16x32_bf16 v[60:63], v[188:191], v[144:147], v[60:63]
    ds_read_b64_tr_b16 v[168:169], v204 offset:24576
    v_mfma_f32_16x16x32_bf16 v[68:71], v[188:191], v[148:151], v[68:71]
    ds_read_b64_tr_b16 v[170:171], v204 offset:26624
    v_mfma_f32_16x16x32_bf16 v[72:75], v[132:135], v[192:195], v[72:75]
    ds_read_b64_tr_b16 v[172:173], v205 offset:24576
    v_mfma_f32_16x16x32_bf16 v[80:83], v[136:139], v[192:195], v[80:83]
    ds_read_b64_tr_b16 v[174:175], v205 offset:26624
    v_mfma_f32_16x16x32_bf16 v[88:91], v[140:143], v[192:195], v[88:91]
    v_mfma_f32_16x16x32_bf16 v[96:99], v[144:147], v[192:195], v[96:99]
    v_mfma_f32_16x16x32_bf16 v[104:107], v[148:151], v[192:195], v[104:107]
    v_mfma_f32_16x16x32_bf16 v[76:79], v[132:135], v[196:199], v[76:79]
    v_mfma_f32_16x16x32_bf16 v[84:87], v[136:139], v[196:199], v[84:87]
    v_mfma_f32_16x16x32_bf16 v[92:95], v[140:143], v[196:199], v[92:95]
    v_mfma_f32_16x16x32_bf16 v[100:103], v[144:147], v[196:199], v[100:103]
    v_mfma_f32_16x16x32_bf16 v[108:111], v[148:151], v[196:199], v[108:111]
    s_waitcnt lgkmcnt(0)
    s_barrier
    .p2align 3
    v_mfma_f32_16x16x32_bf16 v[0:3], v[152:155], v[116:119], v[0:3]
    ds_read_b64_tr_b16 v[176:177], v204 offset:32768
    v_mfma_f32_16x16x32_bf16 v[8:11], v[152:155], v[120:123], v[8:11]
    ds_read_b64_tr_b16 v[178:179], v204 offset:34816
    v_mfma_f32_16x16x32_bf16 v[16:19], v[152:155], v[124:127], v[16:19]
    ds_read_b128 v[136:139], v201 offset:38912
    v_mfma_f32_16x16x32_bf16 v[24:27], v[152:155], v[128:131], v[24:27]
    ds_read_b128 v[140:143], v201 offset:40960
    v_mfma_f32_16x16x32_bf16 v[4:7], v[156:159], v[116:119], v[4:7]
    ds_read_b128 v[144:147], v201 offset:43008
    v_mfma_f32_16x16x32_bf16 v[12:15], v[156:159], v[120:123], v[12:15]
    v_mfma_f32_16x16x32_bf16 v[20:23], v[156:159], v[124:127], v[20:23]
    ds_read_b128 v[148:151], v201 offset:45056
    v_mfma_f32_16x16x32_bf16 v[28:31], v[156:159], v[128:131], v[28:31]
    ds_read_b64_tr_b16 v[180:181], v205 offset:32768
    v_mfma_f32_16x16x32_bf16 v[32:35], v[160:163], v[112:115], v[32:35]
    ds_read_b64_tr_b16 v[182:183], v205 offset:34816
    v_mfma_f32_16x16x32_bf16 v[40:43], v[160:163], v[116:119], v[40:43]
    ds_read_b64_tr_b16 v[184:185], v204 offset:36864
    v_mfma_f32_16x16x32_bf16 v[48:51], v[160:163], v[120:123], v[48:51]
    v_mfma_f32_16x16x32_bf16 v[56:59], v[160:163], v[124:127], v[56:59]
    ds_read_b64_tr_b16 v[186:187], v204 offset:38912
    v_mfma_f32_16x16x32_bf16 v[64:67], v[160:163], v[128:131], v[64:67]
    ds_read_b128 v[132:135], v201 offset:36864
    v_mfma_f32_16x16x32_bf16 v[36:39], v[164:167], v[112:115], v[36:39]
    ds_read_b64_tr_b16 v[188:189], v205 offset:36864
    v_mfma_f32_16x16x32_bf16 v[44:47], v[164:167], v[116:119], v[44:47]
    ds_read_b64_tr_b16 v[190:191], v205 offset:38912
    v_mfma_f32_16x16x32_bf16 v[52:55], v[164:167], v[120:123], v[52:55]
    v_mfma_f32_16x16x32_bf16 v[60:63], v[164:167], v[124:127], v[60:63]
    ds_read_b64_tr_b16 v[192:193], v204 offset:40960
    v_mfma_f32_16x16x32_bf16 v[68:71], v[164:167], v[128:131], v[68:71]
    ds_read_b64_tr_b16 v[194:195], v204 offset:43008
    v_mfma_f32_16x16x32_bf16 v[72:75], v[112:115], v[168:171], v[72:75]
    ds_read_b64_tr_b16 v[196:197], v205 offset:40960
    v_mfma_f32_16x16x32_bf16 v[80:83], v[116:119], v[168:171], v[80:83]
    ds_read_b64_tr_b16 v[198:199], v205 offset:43008
    v_mfma_f32_16x16x32_bf16 v[88:91], v[120:123], v[168:171], v[88:91]
    v_mfma_f32_16x16x32_bf16 v[96:99], v[124:127], v[168:171], v[96:99]
    v_mfma_f32_16x16x32_bf16 v[104:107], v[128:131], v[168:171], v[104:107]
    v_mfma_f32_16x16x32_bf16 v[76:79], v[112:115], v[172:175], v[76:79]
    v_mfma_f32_16x16x32_bf16 v[84:87], v[116:119], v[172:175], v[84:87]
    v_mfma_f32_16x16x32_bf16 v[92:95], v[120:123], v[172:175], v[92:95]
    v_mfma_f32_16x16x32_bf16 v[100:103], v[124:127], v[172:175], v[100:103]
    v_mfma_f32_16x16x32_bf16 v[108:111], v[128:131], v[172:175], v[108:111]
    s_waitcnt lgkmcnt(0)
    s_barrier
    .p2align 3
    v_mfma_f32_16x16x32_bf16 v[0:3], v[176:179], v[136:139], v[0:3]
    ds_read_b64_tr_b16 v[152:153], v202 offset:0
    v_mfma_f32_16x16x32_bf16 v[8:11], v[176:179], v[140:143], v[8:11]
    ds_read_b64_tr_b16 v[154:155], v202 offset:2048
    v_mfma_f32_16x16x32_bf16 v[16:19], v[176:179], v[144:147], v[16:19]
    ds_read_b128 v[116:119], v200 offset:2048
    v_mfma_f32_16x16x32_bf16 v[24:27], v[176:179], v[148:151], v[24:27]
    ds_read_b128 v[120:123], v200 offset:4096
    v_mfma_f32_16x16x32_bf16 v[4:7], v[180:183], v[136:139], v[4:7]
    ds_read_b128 v[124:127], v200 offset:6144
    v_mfma_f32_16x16x32_bf16 v[12:15], v[180:183], v[140:143], v[12:15]
    v_mfma_f32_16x16x32_bf16 v[20:23], v[180:183], v[144:147], v[20:23]
    ds_read_b128 v[128:131], v200 offset:8192
    v_mfma_f32_16x16x32_bf16 v[28:31], v[180:183], v[148:151], v[28:31]
    ds_read_b64_tr_b16 v[156:157], v203 offset:0
    v_mfma_f32_16x16x32_bf16 v[32:35], v[184:187], v[132:135], v[32:35]
    ds_read_b64_tr_b16 v[158:159], v203 offset:2048
    v_mfma_f32_16x16x32_bf16 v[40:43], v[184:187], v[136:139], v[40:43]
    ds_read_b64_tr_b16 v[160:161], v202 offset:4096
    v_mfma_f32_16x16x32_bf16 v[48:51], v[184:187], v[140:143], v[48:51]
    v_mfma_f32_16x16x32_bf16 v[56:59], v[184:187], v[144:147], v[56:59]
    ds_read_b64_tr_b16 v[162:163], v202 offset:6144
    v_mfma_f32_16x16x32_bf16 v[64:67], v[184:187], v[148:151], v[64:67]
    ds_read_b128 v[112:115], v200 offset:0
    v_mfma_f32_16x16x32_bf16 v[36:39], v[188:191], v[132:135], v[36:39]
    ds_read_b64_tr_b16 v[164:165], v203 offset:4096
    v_mfma_f32_16x16x32_bf16 v[44:47], v[188:191], v[136:139], v[44:47]
    ds_read_b64_tr_b16 v[166:167], v203 offset:6144
    v_mfma_f32_16x16x32_bf16 v[52:55], v[188:191], v[140:143], v[52:55]
    v_mfma_f32_16x16x32_bf16 v[60:63], v[188:191], v[144:147], v[60:63]
    ds_read_b64_tr_b16 v[168:169], v202 offset:8192
    v_mfma_f32_16x16x32_bf16 v[68:71], v[188:191], v[148:151], v[68:71]
    ds_read_b64_tr_b16 v[170:171], v202 offset:10240
    v_mfma_f32_16x16x32_bf16 v[72:75], v[132:135], v[192:195], v[72:75]
    ds_read_b64_tr_b16 v[172:173], v203 offset:8192
    v_mfma_f32_16x16x32_bf16 v[80:83], v[136:139], v[192:195], v[80:83]
    ds_read_b64_tr_b16 v[174:175], v203 offset:10240
    v_mfma_f32_16x16x32_bf16 v[88:91], v[140:143], v[192:195], v[88:91]
    v_mfma_f32_16x16x32_bf16 v[96:99], v[144:147], v[192:195], v[96:99]
    v_mfma_f32_16x16x32_bf16 v[104:107], v[148:151], v[192:195], v[104:107]
    v_mfma_f32_16x16x32_bf16 v[76:79], v[132:135], v[196:199], v[76:79]
    v_mfma_f32_16x16x32_bf16 v[84:87], v[136:139], v[196:199], v[84:87]
    s_sub_u32 s58, s58, 1
    s_cmp_lg_u32 s58, 0
    .p2align 3
    v_mfma_f32_16x16x32_bf16 v[92:95], v[140:143], v[196:199], v[92:95]
    v_mfma_f32_16x16x32_bf16 v[100:103], v[144:147], v[196:199], v[100:103]
    v_mfma_f32_16x16x32_bf16 v[108:111], v[148:151], v[196:199], v[108:111]
    s_cbranch_scc1 loop_5
    s_waitcnt lgkmcnt(0)
    s_barrier
    .p2align 3
    v_mfma_f32_16x16x32_bf16 v[0:3], v[152:155], v[116:119], v[0:3]
    ds_read_b64_tr_b16 v[176:177], v202 offset:16384
    v_mfma_f32_16x16x32_bf16 v[8:11], v[152:155], v[120:123], v[8:11]
    ds_read_b64_tr_b16 v[178:179], v202 offset:18432
    v_mfma_f32_16x16x32_bf16 v[16:19], v[152:155], v[124:127], v[16:19]
    ds_read_b128 v[136:139], v201 offset:2048
    v_mfma_f32_16x16x32_bf16 v[24:27], v[152:155], v[128:131], v[24:27]
    ds_read_b128 v[140:143], v201 offset:4096
    v_mfma_f32_16x16x32_bf16 v[4:7], v[156:159], v[116:119], v[4:7]
    ds_read_b128 v[144:147], v201 offset:6144
    v_mfma_f32_16x16x32_bf16 v[12:15], v[156:159], v[120:123], v[12:15]
    v_mfma_f32_16x16x32_bf16 v[20:23], v[156:159], v[124:127], v[20:23]
    ds_read_b128 v[148:151], v201 offset:8192
    v_mfma_f32_16x16x32_bf16 v[28:31], v[156:159], v[128:131], v[28:31]
    ds_read_b64_tr_b16 v[180:181], v203 offset:16384
    v_mfma_f32_16x16x32_bf16 v[32:35], v[160:163], v[112:115], v[32:35]
    ds_read_b64_tr_b16 v[182:183], v203 offset:18432
    v_mfma_f32_16x16x32_bf16 v[40:43], v[160:163], v[116:119], v[40:43]
    ds_read_b64_tr_b16 v[184:185], v202 offset:20480
    v_mfma_f32_16x16x32_bf16 v[48:51], v[160:163], v[120:123], v[48:51]
    v_mfma_f32_16x16x32_bf16 v[56:59], v[160:163], v[124:127], v[56:59]
    ds_read_b64_tr_b16 v[186:187], v202 offset:22528
    v_mfma_f32_16x16x32_bf16 v[64:67], v[160:163], v[128:131], v[64:67]
    ds_read_b128 v[132:135], v201 offset:0
    v_mfma_f32_16x16x32_bf16 v[36:39], v[164:167], v[112:115], v[36:39]
    ds_read_b64_tr_b16 v[188:189], v203 offset:20480
    v_mfma_f32_16x16x32_bf16 v[44:47], v[164:167], v[116:119], v[44:47]
    ds_read_b64_tr_b16 v[190:191], v203 offset:22528
    v_mfma_f32_16x16x32_bf16 v[52:55], v[164:167], v[120:123], v[52:55]
    v_mfma_f32_16x16x32_bf16 v[60:63], v[164:167], v[124:127], v[60:63]
    ds_read_b64_tr_b16 v[192:193], v202 offset:24576
    v_mfma_f32_16x16x32_bf16 v[68:71], v[164:167], v[128:131], v[68:71]
    ds_read_b64_tr_b16 v[194:195], v202 offset:26624
    v_mfma_f32_16x16x32_bf16 v[72:75], v[112:115], v[168:171], v[72:75]
    ds_read_b64_tr_b16 v[196:197], v203 offset:24576
    v_mfma_f32_16x16x32_bf16 v[80:83], v[116:119], v[168:171], v[80:83]
    ds_read_b64_tr_b16 v[198:199], v203 offset:26624
    v_mfma_f32_16x16x32_bf16 v[88:91], v[120:123], v[168:171], v[88:91]
    v_mfma_f32_16x16x32_bf16 v[96:99], v[124:127], v[168:171], v[96:99]
    v_mfma_f32_16x16x32_bf16 v[104:107], v[128:131], v[168:171], v[104:107]
    v_mfma_f32_16x16x32_bf16 v[76:79], v[112:115], v[172:175], v[76:79]
    v_mfma_f32_16x16x32_bf16 v[84:87], v[116:119], v[172:175], v[84:87]
    v_mfma_f32_16x16x32_bf16 v[92:95], v[120:123], v[172:175], v[92:95]
    v_mfma_f32_16x16x32_bf16 v[100:103], v[124:127], v[172:175], v[100:103]
    v_mfma_f32_16x16x32_bf16 v[108:111], v[128:131], v[172:175], v[108:111]
    s_waitcnt lgkmcnt(0)
    s_barrier
    .p2align 3
    v_mfma_f32_16x16x32_bf16 v[0:3], v[176:179], v[136:139], v[0:3]
    v_mfma_f32_16x16x32_bf16 v[8:11], v[176:179], v[140:143], v[8:11]
    v_mfma_f32_16x16x32_bf16 v[16:19], v[176:179], v[144:147], v[16:19]
    v_mfma_f32_16x16x32_bf16 v[24:27], v[176:179], v[148:151], v[24:27]
    v_mfma_f32_16x16x32_bf16 v[4:7], v[180:183], v[136:139], v[4:7]
    v_mfma_f32_16x16x32_bf16 v[12:15], v[180:183], v[140:143], v[12:15]
    v_mfma_f32_16x16x32_bf16 v[20:23], v[180:183], v[144:147], v[20:23]
    v_mfma_f32_16x16x32_bf16 v[28:31], v[180:183], v[148:151], v[28:31]
    v_mfma_f32_16x16x32_bf16 v[32:35], v[184:187], v[132:135], v[32:35]
    v_mfma_f32_16x16x32_bf16 v[40:43], v[184:187], v[136:139], v[40:43]
    v_mfma_f32_16x16x32_bf16 v[48:51], v[184:187], v[140:143], v[48:51]
    v_mfma_f32_16x16x32_bf16 v[56:59], v[184:187], v[144:147], v[56:59]
    v_mfma_f32_16x16x32_bf16 v[64:67], v[184:187], v[148:151], v[64:67]
    v_mfma_f32_16x16x32_bf16 v[36:39], v[188:191], v[132:135], v[36:39]
    v_mfma_f32_16x16x32_bf16 v[44:47], v[188:191], v[136:139], v[44:47]
    v_mfma_f32_16x16x32_bf16 v[52:55], v[188:191], v[140:143], v[52:55]
    v_mfma_f32_16x16x32_bf16 v[60:63], v[188:191], v[144:147], v[60:63]
    v_mfma_f32_16x16x32_bf16 v[68:71], v[188:191], v[148:151], v[68:71]
    v_mfma_f32_16x16x32_bf16 v[72:75], v[132:135], v[192:195], v[72:75]
    v_mfma_f32_16x16x32_bf16 v[80:83], v[136:139], v[192:195], v[80:83]
    v_mfma_f32_16x16x32_bf16 v[88:91], v[140:143], v[192:195], v[88:91]
    v_mfma_f32_16x16x32_bf16 v[96:99], v[144:147], v[192:195], v[96:99]
    v_mfma_f32_16x16x32_bf16 v[104:107], v[148:151], v[192:195], v[104:107]
    v_mfma_f32_16x16x32_bf16 v[76:79], v[132:135], v[196:199], v[76:79]
    v_mfma_f32_16x16x32_bf16 v[84:87], v[136:139], v[196:199], v[84:87]
    v_mfma_f32_16x16x32_bf16 v[92:95], v[140:143], v[196:199], v[92:95]
    v_mfma_f32_16x16x32_bf16 v[100:103], v[144:147], v[196:199], v[100:103]
    v_mfma_f32_16x16x32_bf16 v[108:111], v[148:151], v[196:199], v[108:111]
    v_mov_b32 v211, 157568
    ds_read_b32 v211, v211
    s_lshl_b32 s55, s43, 7
    s_add_u32 s55, s55, 154752
    v_lshlrev_b32 v209, 4, v207
    v_add_u32 v209, s55, v209
    v_lshlrev_b32 v210, 2, v208
    v_add_u32 v210, s55, v210
    ds_read_b128 v[152:155], v209 offset:0
    ds_read_b128 v[156:159], v209 offset:64
    ds_read_b128 v[160:163], v209 offset:256
    ds_read_b128 v[164:167], v209 offset:320
    ds_read_b32 v168, v210 offset:512
    ds_read_b32 v169, v210 offset:576
    s_waitcnt lgkmcnt(6)
    v_readfirstlane_b32 s45, v211
    s_lshl_b32 s55, s44, 9
    s_add_u32 s55, s55, 153600
    v_lshlrev_b32 v211, 3, v208
    v_add_u32 v211, s55, v211
    ds_read_b64 v[112:113], v211 offset:0
    ds_read_b64 v[114:115], v211 offset:128
    ds_read_b64 v[116:117], v211 offset:256
    ds_read_b64 v[118:119], v211 offset:384
    ds_read_b64 v[120:121], v211 offset:512
    v_lshlrev_b32 v212, 5, v207
    v_add_u32 v212, s55, v212
    s_waitcnt lgkmcnt(0)
    v_sub_f32 v244, 0, v112
    v_fmac_f32 v32, v244, v160
    v_fmac_f32 v33, v244, v161
    v_fmac_f32 v34, v244, v162
    v_fmac_f32 v35, v244, v163
    v_mul_f32 v32, v113, v32
    v_mul_f32 v33, v113, v33
    v_mul_f32 v34, v113, v34
    v_mul_f32 v35, v113, v35
    v_cvt_pk_bf16_f32 v132, v32, v33
    v_cvt_pk_bf16_f32 v133, v34, v35
    v_fmac_f32 v36, v244, v164
    v_fmac_f32 v37, v244, v165
    v_fmac_f32 v38, v244, v166
    v_fmac_f32 v39, v244, v167
    v_mul_f32 v36, v113, v36
    v_mul_f32 v37, v113, v37
    v_mul_f32 v38, v113, v38
    v_mul_f32 v39, v113, v39
    v_cvt_pk_bf16_f32 v134, v36, v37
    v_cvt_pk_bf16_f32 v135, v38, v39
    v_sub_f32 v244, 0, v114
    v_fmac_f32 v0, v244, v152
    v_fmac_f32 v1, v244, v153
    v_fmac_f32 v2, v244, v154
    v_fmac_f32 v3, v244, v155
    v_mul_f32 v0, v115, v0
    v_mul_f32 v1, v115, v1
    v_mul_f32 v2, v115, v2
    v_mul_f32 v3, v115, v3
    v_cvt_pk_bf16_f32 v220, v0, v1
    v_cvt_pk_bf16_f32 v221, v2, v3
    v_fmac_f32 v4, v244, v156
    v_fmac_f32 v5, v244, v157
    v_fmac_f32 v6, v244, v158
    v_fmac_f32 v7, v244, v159
    v_mul_f32 v4, v115, v4
    v_mul_f32 v5, v115, v5
    v_mul_f32 v6, v115, v6
    v_mul_f32 v7, v115, v7
    v_cvt_pk_bf16_f32 v222, v4, v5
    v_cvt_pk_bf16_f32 v223, v6, v7
    v_fmac_f32 v40, v244, v160
    v_fmac_f32 v41, v244, v161
    v_fmac_f32 v42, v244, v162
    v_fmac_f32 v43, v244, v163
    v_mul_f32 v40, v115, v40
    v_mul_f32 v41, v115, v41
    v_mul_f32 v42, v115, v42
    v_mul_f32 v43, v115, v43
    v_cvt_pk_bf16_f32 v136, v40, v41
    v_cvt_pk_bf16_f32 v137, v42, v43
    v_fmac_f32 v44, v244, v164
    v_fmac_f32 v45, v244, v165
    v_fmac_f32 v46, v244, v166
    v_fmac_f32 v47, v244, v167
    v_mul_f32 v44, v115, v44
    v_mul_f32 v45, v115, v45
    v_mul_f32 v46, v115, v46
    v_mul_f32 v47, v115, v47
    v_cvt_pk_bf16_f32 v138, v44, v45
    v_cvt_pk_bf16_f32 v139, v46, v47
    v_sub_f32 v244, 0, v116
    v_fmac_f32 v8, v244, v152
    v_fmac_f32 v9, v244, v153
    v_fmac_f32 v10, v244, v154
    v_fmac_f32 v11, v244, v155
    v_mul_f32 v8, v117, v8
    v_mul_f32 v9, v117, v9
    v_mul_f32 v10, v117, v10
    v_mul_f32 v11, v117, v11
    v_cvt_pk_bf16_f32 v224, v8, v9
    v_cvt_pk_bf16_f32 v225, v10, v11
    v_fmac_f32 v12, v244, v156
    v_fmac_f32 v13, v244, v157
    v_fmac_f32 v14, v244, v158
    v_fmac_f32 v15, v244, v159
    v_mul_f32 v12, v117, v12
    v_mul_f32 v13, v117, v13
    v_mul_f32 v14, v117, v14
    v_mul_f32 v15, v117, v15
    v_cvt_pk_bf16_f32 v226, v12, v13
    v_cvt_pk_bf16_f32 v227, v14, v15
    v_fmac_f32 v48, v244, v160
    v_fmac_f32 v49, v244, v161
    v_fmac_f32 v50, v244, v162
    v_fmac_f32 v51, v244, v163
    v_mul_f32 v48, v117, v48
    v_mul_f32 v49, v117, v49
    v_mul_f32 v50, v117, v50
    v_mul_f32 v51, v117, v51
    v_cvt_pk_bf16_f32 v140, v48, v49
    v_cvt_pk_bf16_f32 v141, v50, v51
    v_fmac_f32 v52, v244, v164
    v_fmac_f32 v53, v244, v165
    v_fmac_f32 v54, v244, v166
    v_fmac_f32 v55, v244, v167
    v_mul_f32 v52, v117, v52
    v_mul_f32 v53, v117, v53
    v_mul_f32 v54, v117, v54
    v_mul_f32 v55, v117, v55
    v_cvt_pk_bf16_f32 v142, v52, v53
    v_cvt_pk_bf16_f32 v143, v54, v55
    v_sub_f32 v244, 0, v118
    v_fmac_f32 v16, v244, v152
    v_fmac_f32 v17, v244, v153
    v_fmac_f32 v18, v244, v154
    v_fmac_f32 v19, v244, v155
    v_mul_f32 v16, v119, v16
    v_mul_f32 v17, v119, v17
    v_mul_f32 v18, v119, v18
    v_mul_f32 v19, v119, v19
    v_cvt_pk_bf16_f32 v228, v16, v17
    v_cvt_pk_bf16_f32 v229, v18, v19
    v_fmac_f32 v20, v244, v156
    v_fmac_f32 v21, v244, v157
    v_fmac_f32 v22, v244, v158
    v_fmac_f32 v23, v244, v159
    v_mul_f32 v20, v119, v20
    v_mul_f32 v21, v119, v21
    v_mul_f32 v22, v119, v22
    v_mul_f32 v23, v119, v23
    v_cvt_pk_bf16_f32 v230, v20, v21
    v_cvt_pk_bf16_f32 v231, v22, v23
    v_fmac_f32 v56, v244, v160
    v_fmac_f32 v57, v244, v161
    v_fmac_f32 v58, v244, v162
    v_fmac_f32 v59, v244, v163
    v_mul_f32 v56, v119, v56
    v_mul_f32 v57, v119, v57
    v_mul_f32 v58, v119, v58
    v_mul_f32 v59, v119, v59
    v_cvt_pk_bf16_f32 v144, v56, v57
    v_cvt_pk_bf16_f32 v145, v58, v59
    v_fmac_f32 v60, v244, v164
    v_fmac_f32 v61, v244, v165
    v_fmac_f32 v62, v244, v166
    v_fmac_f32 v63, v244, v167
    v_mul_f32 v60, v119, v60
    v_mul_f32 v61, v119, v61
    v_mul_f32 v62, v119, v62
    v_mul_f32 v63, v119, v63
    v_cvt_pk_bf16_f32 v146, v60, v61
    v_cvt_pk_bf16_f32 v147, v62, v63
    v_sub_f32 v244, 0, v120
    v_fmac_f32 v24, v244, v152
    v_fmac_f32 v25, v244, v153
    v_fmac_f32 v26, v244, v154
    v_fmac_f32 v27, v244, v155
    v_mul_f32 v24, v121, v24
    v_mul_f32 v25, v121, v25
    v_mul_f32 v26, v121, v26
    v_mul_f32 v27, v121, v27
    v_cvt_pk_bf16_f32 v232, v24, v25
    v_cvt_pk_bf16_f32 v233, v26, v27
    v_fmac_f32 v28, v244, v156
    v_fmac_f32 v29, v244, v157
    v_fmac_f32 v30, v244, v158
    v_fmac_f32 v31, v244, v159
    v_mul_f32 v28, v121, v28
    v_mul_f32 v29, v121, v29
    v_mul_f32 v30, v121, v30
    v_mul_f32 v31, v121, v31
    v_cvt_pk_bf16_f32 v234, v28, v29
    v_cvt_pk_bf16_f32 v235, v30, v31
    v_fmac_f32 v64, v244, v160
    v_fmac_f32 v65, v244, v161
    v_fmac_f32 v66, v244, v162
    v_fmac_f32 v67, v244, v163
    v_mul_f32 v64, v121, v64
    v_mul_f32 v65, v121, v65
    v_mul_f32 v66, v121, v66
    v_mul_f32 v67, v121, v67
    v_cvt_pk_bf16_f32 v148, v64, v65
    v_cvt_pk_bf16_f32 v149, v66, v67
    v_fmac_f32 v68, v244, v164
    v_fmac_f32 v69, v244, v165
    v_fmac_f32 v70, v244, v166
    v_fmac_f32 v71, v244, v167
    v_mul_f32 v68, v121, v68
    v_mul_f32 v69, v121, v69
    v_mul_f32 v70, v121, v70
    v_mul_f32 v71, v121, v71
    v_cvt_pk_bf16_f32 v150, v68, v69
    v_cvt_pk_bf16_f32 v151, v70, v71
    ds_read_b128 v[236:239], v212 offset:0
    ds_read_b128 v[240:243], v212 offset:16
    s_waitcnt lgkmcnt(0)
    v_fma_f32 v72, -v236, v168, v72
    v_fma_f32 v73, -v238, v168, v73
    v_fma_f32 v74, -v240, v168, v74
    v_fma_f32 v75, -v242, v168, v75
    v_mul_f32 v72, v237, v72
    v_mul_f32 v73, v239, v73
    v_mul_f32 v74, v241, v74
    v_mul_f32 v75, v243, v75
    v_cvt_pk_bf16_f32 v176, v72, v73
    v_cvt_pk_bf16_f32 v177, v74, v75
    v_fma_f32 v76, -v236, v169, v76
    v_fma_f32 v77, -v238, v169, v77
    v_fma_f32 v78, -v240, v169, v78
    v_fma_f32 v79, -v242, v169, v79
    v_mul_f32 v76, v237, v76
    v_mul_f32 v77, v239, v77
    v_mul_f32 v78, v241, v78
    v_mul_f32 v79, v243, v79
    v_cvt_pk_bf16_f32 v186, v76, v77
    v_cvt_pk_bf16_f32 v187, v78, v79
    ds_read_b128 v[236:239], v212 offset:128
    ds_read_b128 v[240:243], v212 offset:144
    s_waitcnt lgkmcnt(0)
    v_fma_f32 v80, -v236, v168, v80
    v_fma_f32 v81, -v238, v168, v81
    v_fma_f32 v82, -v240, v168, v82
    v_fma_f32 v83, -v242, v168, v83
    v_mul_f32 v80, v237, v80
    v_mul_f32 v81, v239, v81
    v_mul_f32 v82, v241, v82
    v_mul_f32 v83, v243, v83
    v_cvt_pk_bf16_f32 v178, v80, v81
    v_cvt_pk_bf16_f32 v179, v82, v83
    v_fma_f32 v84, -v236, v169, v84
    v_fma_f32 v85, -v238, v169, v85
    v_fma_f32 v86, -v240, v169, v86
    v_fma_f32 v87, -v242, v169, v87
    v_mul_f32 v84, v237, v84
    v_mul_f32 v85, v239, v85
    v_mul_f32 v86, v241, v86
    v_mul_f32 v87, v243, v87
    v_cvt_pk_bf16_f32 v188, v84, v85
    v_cvt_pk_bf16_f32 v189, v86, v87
    ds_read_b128 v[236:239], v212 offset:256
    ds_read_b128 v[240:243], v212 offset:272
    s_waitcnt lgkmcnt(0)
    v_fma_f32 v88, -v236, v168, v88
    v_fma_f32 v89, -v238, v168, v89
    v_fma_f32 v90, -v240, v168, v90
    v_fma_f32 v91, -v242, v168, v91
    v_mul_f32 v88, v237, v88
    v_mul_f32 v89, v239, v89
    v_mul_f32 v90, v241, v90
    v_mul_f32 v91, v243, v91
    v_cvt_pk_bf16_f32 v180, v88, v89
    v_cvt_pk_bf16_f32 v181, v90, v91
    v_fma_f32 v92, -v236, v169, v92
    v_fma_f32 v93, -v238, v169, v93
    v_fma_f32 v94, -v240, v169, v94
    v_fma_f32 v95, -v242, v169, v95
    v_mul_f32 v92, v237, v92
    v_mul_f32 v93, v239, v93
    v_mul_f32 v94, v241, v94
    v_mul_f32 v95, v243, v95
    v_cvt_pk_bf16_f32 v190, v92, v93
    v_cvt_pk_bf16_f32 v191, v94, v95
    ds_read_b128 v[236:239], v212 offset:384
    ds_read_b128 v[240:243], v212 offset:400
    s_waitcnt lgkmcnt(0)
    v_fma_f32 v96, -v236, v168, v96
    v_fma_f32 v97, -v238, v168, v97
    v_fma_f32 v98, -v240, v168, v98
    v_fma_f32 v99, -v242, v168, v99
    v_mul_f32 v96, v237, v96
    v_mul_f32 v97, v239, v97
    v_mul_f32 v98, v241, v98
    v_mul_f32 v99, v243, v99
    v_cvt_pk_bf16_f32 v182, v96, v97
    v_cvt_pk_bf16_f32 v183, v98, v99
    v_fma_f32 v100, -v236, v169, v100
    v_fma_f32 v101, -v238, v169, v101
    v_fma_f32 v102, -v240, v169, v102
    v_fma_f32 v103, -v242, v169, v103
    v_mul_f32 v100, v237, v100
    v_mul_f32 v101, v239, v101
    v_mul_f32 v102, v241, v102
    v_mul_f32 v103, v243, v103
    v_cvt_pk_bf16_f32 v192, v100, v101
    v_cvt_pk_bf16_f32 v193, v102, v103
    ds_read_b128 v[236:239], v212 offset:512
    ds_read_b128 v[240:243], v212 offset:528
    s_waitcnt lgkmcnt(0)
    v_fma_f32 v104, -v236, v168, v104
    v_fma_f32 v105, -v238, v168, v105
    v_fma_f32 v106, -v240, v168, v106
    v_fma_f32 v107, -v242, v168, v107
    v_mul_f32 v104, v237, v104
    v_mul_f32 v105, v239, v105
    v_mul_f32 v106, v241, v106
    v_mul_f32 v107, v243, v107
    v_cvt_pk_bf16_f32 v184, v104, v105
    v_cvt_pk_bf16_f32 v185, v106, v107
    v_fma_f32 v108, -v236, v169, v108
    v_fma_f32 v109, -v238, v169, v109
    v_fma_f32 v110, -v240, v169, v110
    v_fma_f32 v111, -v242, v169, v111
    v_mul_f32 v108, v237, v108
    v_mul_f32 v109, v239, v109
    v_mul_f32 v110, v241, v110
    v_mul_f32 v111, v243, v111
    v_cvt_pk_bf16_f32 v194, v108, v109
    v_cvt_pk_bf16_f32 v195, v110, v111
    v_lshlrev_b32 v209, 2, v207
    v_sub_u32 v209, v208, v209
    v_subrev_u32 v210, 0, v209
    v_and_b32 v211, 1, v210
    v_cmp_eq_u32 s[70:71], 0, v211
    v_cmp_le_i32 vcc, 0, v210
    s_and_b64 s[72:73], s[70:71], vcc
    v_cmp_ge_i32 vcc, -2, v210
    s_and_b64 s[80:81], s[70:71], vcc
    v_subrev_u32 v210, 1, v209
    v_and_b32 v211, 1, v210
    v_cmp_eq_u32 s[70:71], 0, v211
    v_cmp_le_i32 vcc, 0, v210
    s_and_b64 s[74:75], s[70:71], vcc
    v_cmp_ge_i32 vcc, -2, v210
    s_and_b64 s[82:83], s[70:71], vcc
    v_subrev_u32 v210, 2, v209
    v_and_b32 v211, 1, v210
    v_cmp_eq_u32 s[70:71], 0, v211
    v_cmp_le_i32 vcc, 0, v210
    s_and_b64 s[76:77], s[70:71], vcc
    v_cmp_ge_i32 vcc, -2, v210
    s_and_b64 s[84:85], s[70:71], vcc
    v_subrev_u32 v210, 3, v209
    v_and_b32 v211, 1, v210
    v_cmp_eq_u32 s[70:71], 0, v211
    v_cmp_le_i32 vcc, 0, v210
    s_and_b64 s[78:79], s[70:71], vcc
    v_cmp_ge_i32 vcc, -2, v210
    s_and_b64 s[86:87], s[70:71], vcc
    s_or_b32 s59, s40, s44
    s_mov_b32 s63, 0x3e8293ee
    s_mov_b32 s64, 0xf149f2ca
    s_nop 1
    v_mfma_f32_16x16x32_bf16 v[0:3], v[136:139], v[220:223], 0
    v_mfma_f32_16x16x32_bf16 v[4:7], v[132:135], v[220:223], 0
    s_cmp_eq_u32 s59, 0
    s_cselect_b64 s[88:89], 0, s[80:81]
    s_cselect_b64 s[90:91], 0, s[82:83]
    s_cselect_b64 s[92:93], 0, s[84:85]
    s_cselect_b64 s[94:95], 0, s[86:87]
    s_nop 7
    v_mov_b32 v24, s64
    v_mul_f32 v0, s63, v0
    v_mul_f32 v4, s63, v4
    v_mul_f32 v1, s63, v1
    v_mul_f32 v5, s63, v5
    v_mul_f32 v2, s63, v2
    v_mul_f32 v6, s63, v6
    v_mul_f32 v3, s63, v3
    v_mul_f32 v7, s63, v7
    v_cndmask_b32 v0, v24, v0, s[72:73]
    v_cndmask_b32 v4, v24, v4, s[88:89]
    v_cndmask_b32 v1, v24, v1, s[74:75]
    v_cndmask_b32 v5, v24, v5, s[90:91]
    v_cndmask_b32 v2, v24, v2, s[76:77]
    v_cndmask_b32 v6, v24, v6, s[92:93]
    v_cndmask_b32 v3, v24, v3, s[78:79]
    v_cndmask_b32 v7, v24, v7, s[94:95]
    v_max3_f32 v25, v0, v1, v2
    v_max3_f32 v26, v3, v4, v5
    v_max3_f32 v25, v25, v6, v7
    v_max_f32 v25, v25, v26
    v_mov_b32 v26, v25
    s_nop 1
    v_permlane16_swap_b32 v25, v26
    v_max_f32 v25, v25, v26
    v_mov_b32 v26, v25
    s_nop 1
    v_permlane32_swap_b32 v25, v26
    v_max_f32 v25, v25, v26
    v_sub_f32 v0, v0, v25
    v_sub_f32 v1, v1, v25
    v_sub_f32 v2, v2, v25
    v_sub_f32 v3, v3, v25
    v_sub_f32 v4, v4, v25
    v_sub_f32 v5, v5, v25
    v_sub_f32 v6, v6, v25
    v_sub_f32 v7, v7, v25
    v_exp_f32 v0, v0
    v_exp_f32 v1, v1
    v_exp_f32 v2, v2
    v_exp_f32 v3, v3
    v_exp_f32 v4, v4
    v_exp_f32 v5, v5
    v_exp_f32 v6, v6
    v_exp_f32 v7, v7
    v_add_f32 v25, v0, v1
    v_add_f32 v25, v25, v2
    v_add_f32 v25, v25, v3
    v_add_f32 v25, v25, v4
    v_add_f32 v25, v25, v5
    v_add_f32 v25, v25, v6
    v_add_f32 v25, v25, v7
    v_mov_b32 v26, v25
    s_nop 1
    v_permlane16_swap_b32 v25, v26
    v_add_f32 v25, v25, v26
    v_mov_b32 v26, v25
    s_nop 1
    v_permlane32_swap_b32 v25, v26
    v_add_f32 v25, v25, v26
    v_rcp_f32 v25, v25
    s_nop 0
    v_mul_f32 v0, v0, v25
    v_mul_f32 v1, v1, v25
    v_mul_f32 v2, v2, v25
    v_mul_f32 v3, v3, v25
    v_mul_f32 v4, v4, v25
    v_mul_f32 v5, v5, v25
    v_mul_f32 v6, v6, v25
    v_mul_f32 v7, v7, v25
    v_cvt_pk_bf16_f32 v8, v4, v5
    v_cvt_pk_bf16_f32 v9, v6, v7
    v_cvt_pk_bf16_f32 v10, v0, v1
    v_cvt_pk_bf16_f32 v11, v2, v3
    s_nop 1
    v_mfma_f32_16x16x32_bf16 v[12:15], v[176:179], v[8:11], 0
    v_mfma_f32_16x16x32_bf16 v[16:19], v[186:189], v[8:11], 0
    s_nop 7
    v_cvt_pk_bf16_f32 v20, v12, v13
    v_cvt_pk_bf16_f32 v21, v14, v15
    v_cvt_pk_bf16_f32 v22, v16, v17
    v_cvt_pk_bf16_f32 v23, v18, v19
    s_add_u32 s55, s62, 0
    buffer_store_dwordx4 v[20:23], v254, s[4:7], s55 offen sc0 sc1
    s_nop 1
    s_nop 1
    v_mfma_f32_16x16x32_bf16 v[0:3], v[140:143], v[224:227], 0
    v_mfma_f32_16x16x32_bf16 v[4:7], v[136:139], v[224:227], 0
    s_nop 7
    v_mov_b32 v24, s64
    v_mul_f32 v0, s63, v0
    v_mul_f32 v4, s63, v4
    v_mul_f32 v1, s63, v1
    v_mul_f32 v5, s63, v5
    v_mul_f32 v2, s63, v2
    v_mul_f32 v6, s63, v6
    v_mul_f32 v3, s63, v3
    v_mul_f32 v7, s63, v7
    v_cndmask_b32 v0, v24, v0, s[72:73]
    v_cndmask_b32 v4, v24, v4, s[80:81]
    v_cndmask_b32 v1, v24, v1, s[74:75]
    v_cndmask_b32 v5, v24, v5, s[82:83]
    v_cndmask_b32 v2, v24, v2, s[76:77]
    v_cndmask_b32 v6, v24, v6, s[84:85]
    v_cndmask_b32 v3, v24, v3, s[78:79]
    v_cndmask_b32 v7, v24, v7, s[86:87]
    v_max3_f32 v25, v0, v1, v2
    v_max3_f32 v26, v3, v4, v5
    v_max3_f32 v25, v25, v6, v7
    v_max_f32 v25, v25, v26
    v_mov_b32 v26, v25
    s_nop 1
    v_permlane16_swap_b32 v25, v26
    v_max_f32 v25, v25, v26
    v_mov_b32 v26, v25
    s_nop 1
    v_permlane32_swap_b32 v25, v26
    v_max_f32 v25, v25, v26
    v_sub_f32 v0, v0, v25
    v_sub_f32 v1, v1, v25
    v_sub_f32 v2, v2, v25
    v_sub_f32 v3, v3, v25
    v_sub_f32 v4, v4, v25
    v_sub_f32 v5, v5, v25
    v_sub_f32 v6, v6, v25
    v_sub_f32 v7, v7, v25
    v_exp_f32 v0, v0
    v_exp_f32 v1, v1
    v_exp_f32 v2, v2
    v_exp_f32 v3, v3
    v_exp_f32 v4, v4
    v_exp_f32 v5, v5
    v_exp_f32 v6, v6
    v_exp_f32 v7, v7
    v_add_f32 v25, v0, v1
    v_add_f32 v25, v25, v2
    v_add_f32 v25, v25, v3
    v_add_f32 v25, v25, v4
    v_add_f32 v25, v25, v5
    v_add_f32 v25, v25, v6
    v_add_f32 v25, v25, v7
    v_mov_b32 v26, v25
    s_nop 1
    v_permlane16_swap_b32 v25, v26
    v_add_f32 v25, v25, v26
    v_mov_b32 v26, v25
    s_nop 1
    v_permlane32_swap_b32 v25, v26
    v_add_f32 v25, v25, v26
    v_rcp_f32 v25, v25
    s_nop 0
    v_mul_f32 v0, v0, v25
    v_mul_f32 v1, v1, v25
    v_mul_f32 v2, v2, v25
    v_mul_f32 v3, v3, v25
    v_mul_f32 v4, v4, v25
    v_mul_f32 v5, v5, v25
    v_mul_f32 v6, v6, v25
    v_mul_f32 v7, v7, v25
    v_cvt_pk_bf16_f32 v8, v4, v5
    v_cvt_pk_bf16_f32 v9, v6, v7
    v_cvt_pk_bf16_f32 v10, v0, v1
    v_cvt_pk_bf16_f32 v11, v2, v3
    s_nop 1
    v_mfma_f32_16x16x32_bf16 v[12:15], v[178:181], v[8:11], 0
    v_mfma_f32_16x16x32_bf16 v[16:19], v[188:191], v[8:11], 0
    s_nop 7
    v_cvt_pk_bf16_f32 v20, v12, v13
    v_cvt_pk_bf16_f32 v21, v14, v15
    v_cvt_pk_bf16_f32 v22, v16, v17
    v_cvt_pk_bf16_f32 v23, v18, v19
    s_add_u32 s55, s62, 2048
    buffer_store_dwordx4 v[20:23], v254, s[4:7], s55 offen sc0 sc1
    s_nop 1
    s_nop 1
    v_mfma_f32_16x16x32_bf16 v[0:3], v[144:147], v[228:231], 0
    v_mfma_f32_16x16x32_bf16 v[4:7], v[140:143], v[228:231], 0
    s_nop 7
    v_mov_b32 v24, s64
    v_mul_f32 v0, s63, v0
    v_mul_f32 v4, s63, v4
    v_mul_f32 v1, s63, v1
    v_mul_f32 v5, s63, v5
    v_mul_f32 v2, s63, v2
    v_mul_f32 v6, s63, v6
    v_mul_f32 v3, s63, v3
    v_mul_f32 v7, s63, v7
    v_cndmask_b32 v0, v24, v0, s[72:73]
    v_cndmask_b32 v4, v24, v4, s[80:81]
    v_cndmask_b32 v1, v24, v1, s[74:75]
    v_cndmask_b32 v5, v24, v5, s[82:83]
    v_cndmask_b32 v2, v24, v2, s[76:77]
    v_cndmask_b32 v6, v24, v6, s[84:85]
    v_cndmask_b32 v3, v24, v3, s[78:79]
    v_cndmask_b32 v7, v24, v7, s[86:87]
    v_max3_f32 v25, v0, v1, v2
    v_max3_f32 v26, v3, v4, v5
    v_max3_f32 v25, v25, v6, v7
    v_max_f32 v25, v25, v26
    v_mov_b32 v26, v25
    s_nop 1
    v_permlane16_swap_b32 v25, v26
    v_max_f32 v25, v25, v26
    v_mov_b32 v26, v25
    s_nop 1
    v_permlane32_swap_b32 v25, v26
    v_max_f32 v25, v25, v26
    v_sub_f32 v0, v0, v25
    v_sub_f32 v1, v1, v25
    v_sub_f32 v2, v2, v25
    v_sub_f32 v3, v3, v25
    v_sub_f32 v4, v4, v25
    v_sub_f32 v5, v5, v25
    v_sub_f32 v6, v6, v25
    v_sub_f32 v7, v7, v25
    v_exp_f32 v0, v0
    v_exp_f32 v1, v1
    v_exp_f32 v2, v2
    v_exp_f32 v3, v3
    v_exp_f32 v4, v4
    v_exp_f32 v5, v5
    v_exp_f32 v6, v6
    v_exp_f32 v7, v7
    v_add_f32 v25, v0, v1
    v_add_f32 v25, v25, v2
    v_add_f32 v25, v25, v3
    v_add_f32 v25, v25, v4
    v_add_f32 v25, v25, v5
    v_add_f32 v25, v25, v6
    v_add_f32 v25, v25, v7
    v_mov_b32 v26, v25
    s_nop 1
    v_permlane16_swap_b32 v25, v26
    v_add_f32 v25, v25, v26
    v_mov_b32 v26, v25
    s_nop 1
    v_permlane32_swap_b32 v25, v26
    v_add_f32 v25, v25, v26
    v_rcp_f32 v25, v25
    s_nop 0
    v_mul_f32 v0, v0, v25
    v_mul_f32 v1, v1, v25
    v_mul_f32 v2, v2, v25
    v_mul_f32 v3, v3, v25
    v_mul_f32 v4, v4, v25
    v_mul_f32 v5, v5, v25
    v_mul_f32 v6, v6, v25
    v_mul_f32 v7, v7, v25
    v_cvt_pk_bf16_f32 v8, v4, v5
    v_cvt_pk_bf16_f32 v9, v6, v7
    v_cvt_pk_bf16_f32 v10, v0, v1
    v_cvt_pk_bf16_f32 v11, v2, v3
    s_nop 1
    v_mfma_f32_16x16x32_bf16 v[12:15], v[180:183], v[8:11], 0
    v_mfma_f32_16x16x32_bf16 v[16:19], v[190:193], v[8:11], 0
    s_nop 7
    v_cvt_pk_bf16_f32 v20, v12, v13
    v_cvt_pk_bf16_f32 v21, v14, v15
    v_cvt_pk_bf16_f32 v22, v16, v17
    v_cvt_pk_bf16_f32 v23, v18, v19
    s_add_u32 s55, s62, 4096
    buffer_store_dwordx4 v[20:23], v254, s[4:7], s55 offen sc0 sc1
    s_nop 1
    s_nop 1
    v_mfma_f32_16x16x32_bf16 v[0:3], v[148:151], v[232:235], 0
    v_mfma_f32_16x16x32_bf16 v[4:7], v[144:147], v[232:235], 0
    s_nop 7
    v_mov_b32 v24, s64
    v_mul_f32 v0, s63, v0
    v_mul_f32 v4, s63, v4
    v_mul_f32 v1, s63, v1
    v_mul_f32 v5, s63, v5
    v_mul_f32 v2, s63, v2
    v_mul_f32 v6, s63, v6
    v_mul_f32 v3, s63, v3
    v_mul_f32 v7, s63, v7
    v_cndmask_b32 v0, v24, v0, s[72:73]
    v_cndmask_b32 v4, v24, v4, s[80:81]
    v_cndmask_b32 v1, v24, v1, s[74:75]
    v_cndmask_b32 v5, v24, v5, s[82:83]
    v_cndmask_b32 v2, v24, v2, s[76:77]
    v_cndmask_b32 v6, v24, v6, s[84:85]
    v_cndmask_b32 v3, v24, v3, s[78:79]
    v_cndmask_b32 v7, v24, v7, s[86:87]
    v_max3_f32 v25, v0, v1, v2
    v_max3_f32 v26, v3, v4, v5
    v_max3_f32 v25, v25, v6, v7
    v_max_f32 v25, v25, v26
    v_mov_b32 v26, v25
    s_nop 1
    v_permlane16_swap_b32 v25, v26
    v_max_f32 v25, v25, v26
    v_mov_b32 v26, v25
    s_nop 1
    v_permlane32_swap_b32 v25, v26
    v_max_f32 v25, v25, v26
    v_sub_f32 v0, v0, v25
    v_sub_f32 v1, v1, v25
    v_sub_f32 v2, v2, v25
    v_sub_f32 v3, v3, v25
    v_sub_f32 v4, v4, v25
    v_sub_f32 v5, v5, v25
    v_sub_f32 v6, v6, v25
    v_sub_f32 v7, v7, v25
    v_exp_f32 v0, v0
    v_exp_f32 v1, v1
    v_exp_f32 v2, v2
    v_exp_f32 v3, v3
    v_exp_f32 v4, v4
    v_exp_f32 v5, v5
    v_exp_f32 v6, v6
    v_exp_f32 v7, v7
    v_add_f32 v25, v0, v1
    v_add_f32 v25, v25, v2
    v_add_f32 v25, v25, v3
    v_add_f32 v25, v25, v4
    v_add_f32 v25, v25, v5
    v_add_f32 v25, v25, v6
    v_add_f32 v25, v25, v7
    v_mov_b32 v26, v25
    s_nop 1
    v_permlane16_swap_b32 v25, v26
    v_add_f32 v25, v25, v26
    v_mov_b32 v26, v25
    s_nop 1
    v_permlane32_swap_b32 v25, v26
    v_add_f32 v25, v25, v26
    v_rcp_f32 v25, v25
    s_nop 0
    v_mul_f32 v0, v0, v25
    v_mul_f32 v1, v1, v25
    v_mul_f32 v2, v2, v25
    v_mul_f32 v3, v3, v25
    v_mul_f32 v4, v4, v25
    v_mul_f32 v5, v5, v25
    v_mul_f32 v6, v6, v25
    v_mul_f32 v7, v7, v25
    v_cvt_pk_bf16_f32 v8, v4, v5
    v_cvt_pk_bf16_f32 v9, v6, v7
    v_cvt_pk_bf16_f32 v10, v0, v1
    v_cvt_pk_bf16_f32 v11, v2, v3
    s_nop 1
    v_mfma_f32_16x16x32_bf16 v[12:15], v[182:185], v[8:11], 0
    v_mfma_f32_16x16x32_bf16 v[16:19], v[192:195], v[8:11], 0
    s_nop 7
    v_cvt_pk_bf16_f32 v20, v12, v13
    v_cvt_pk_bf16_f32 v21, v14, v15
    v_cvt_pk_bf16_f32 v22, v16, v17
    v_cvt_pk_bf16_f32 v23, v18, v19
    s_add_u32 s55, s62, 6144
    buffer_store_dwordx4 v[20:23], v254, s[4:7], s55 offen sc0 sc1
    s_nop 1
    s_waitcnt vmcnt(0)
    s_barrier
    s_cmp_lg_u32 s46, 0
    s_cbranch_scc1 g2_6
    v_and_b32 v152, 0xf0, v254
    v_lshlrev_b32 v152, 7, v152
    v_lshrrev_b32 v153, 8, v254
    v_lshl_add_u32 v152, v153, 3, v152
    s_lshl_b32 s55, s40, 18
    s_lshl_b32 s56, s43, 17
    s_add_u32 s55, s55, s56
    s_lshl_b32 s56, s51, 7
    s_add_u32 s55, s55, s56
    s_lshl_b32 s56, s44, 6
    s_add_u32 s55, s55, s56
    buffer_load_dwordx2 v[136:137], v152, s[24:27], s55 offen offset:0
    buffer_load_dwordx2 v[138:139], v152, s[24:27], s55 offen offset:32
    s_add_u32 s55, s55, 32768
    buffer_load_dwordx2 v[140:141], v152, s[24:27], s55 offen offset:0
    buffer_load_dwordx2 v[142:143], v152, s[24:27], s55 offen offset:32
    s_add_u32 s55, s55, 32768
    buffer_load_dwordx2 v[144:145], v152, s[24:27], s55 offen offset:0
    buffer_load_dwordx2 v[146:147], v152, s[24:27], s55 offen offset:32
    s_add_u32 s55, s55, 32768
    buffer_load_dwordx2 v[148:149], v152, s[24:27], s55 offen offset:0
    buffer_load_dwordx2 v[150:151], v152, s[24:27], s55 offen offset:32
    s_add_u32 s55, s55, 32768
    s_branch g2_7
g2_6:
    s_lshl_b32 s55, s51, 14
    s_lshl_b32 s56, s43, 13
    s_add_u32 s55, s55, s56
    s_lshl_b32 s56, s44, 10
    s_add_u32 s55, s55, s56
    s_add_u32 s55, s55, s48
    buffer_load_dwordx4 v[136:139], v254, s[4:7], s55 offen
    s_add_u32 s55, s55, 2048
    buffer_load_dwordx4 v[140:143], v254, s[4:7], s55 offen
    s_add_u32 s55, s55, 2048
    buffer_load_dwordx4 v[144:147], v254, s[4:7], s55 offen
    s_add_u32 s55, s55, 2048
    buffer_load_dwordx4 v[148:151], v254, s[4:7], s55 offen
    s_add_u32 s55, s55, 2048
g2_7:
    v_mov_b32 v156, -1
    v_mov_b32 v157, -1
    v_mov_b32 v158, -1
    v_mov_b32 v159, -1
    s_lshl_b32 s55, s51, 14
    s_lshl_b32 s56, s42, 12
    s_add_u32 s55, s55, s56
    s_add_u32 s55, s55, s47
    s_add_u32 s55, s55, 50331648
    buffer_store_dwordx4 v[156:159], v254, s[4:7], s55 offen offset:0 sc0 sc1
    buffer_store_dwordx4 v[156:159], v254, s[4:7], s55 offen offset:1024 sc0 sc1
    buffer_store_dwordx4 v[156:159], v254, s[4:7], s55 offen offset:2048 sc0 sc1
    buffer_store_dwordx4 v[156:159], v254, s[4:7], s55 offen offset:3072 sc0 sc1
    s_lshl_b32 s55, s43, 13
    s_add_u32 s55, s55, 98304
    v_add_u32 v128, s55, v254
    v_lshrrev_b32 v152, 6, v254
    v_lshrrev_b32 v153, 1, v152
    v_and_b32 v153, 3, v153
    s_lshl_b32 s55, s44, 1
    v_xor_b32 v153, s55, v153
    v_lshlrev_b32 v152, 7, v152
    v_lshl_add_u32 v152, v153, 5, v152
    v_and_b32 v153, 0x30, v254
    v_lshrrev_b32 v153, 1, v153
    v_add_u32 v129, v152, v153
    v_xor_b32 v130, 32, v129
    v_add_u32 v131, 49152, v129
    v_add_u32 v132, 49152, v130
    s_waitcnt vmcnt(4)
    v_lshlrev_b32 v0, 16, v136
    v_and_b32 v1, 0xffff0000, v136
    v_lshlrev_b32 v2, 16, v137
    v_and_b32 v3, 0xffff0000, v137
    v_lshlrev_b32 v16, 16, v138
    v_and_b32 v17, 0xffff0000, v138
    v_lshlrev_b32 v18, 16, v139
    v_and_b32 v19, 0xffff0000, v139
    v_lshlrev_b32 v4, 16, v140
    v_and_b32 v5, 0xffff0000, v140
    v_lshlrev_b32 v6, 16, v141
    v_and_b32 v7, 0xffff0000, v141
    v_lshlrev_b32 v20, 16, v142
    v_and_b32 v21, 0xffff0000, v142
    v_lshlrev_b32 v22, 16, v143
    v_and_b32 v23, 0xffff0000, v143
    v_lshlrev_b32 v8, 16, v144
    v_and_b32 v9, 0xffff0000, v144
    v_lshlrev_b32 v10, 16, v145
    v_and_b32 v11, 0xffff0000, v145
    v_lshlrev_b32 v24, 16, v146
    v_and_b32 v25, 0xffff0000, v146
    v_lshlrev_b32 v26, 16, v147
    v_and_b32 v27, 0xffff0000, v147
    v_lshlrev_b32 v12, 16, v148
    v_and_b32 v13, 0xffff0000, v148
    v_lshlrev_b32 v14, 16, v149
    v_and_b32 v15, 0xffff0000, v149
    v_lshlrev_b32 v28, 16, v150
    v_and_b32 v29, 0xffff0000, v150
    v_lshlrev_b32 v30, 16, v151
    v_and_b32 v31, 0xffff0000, v151
    s_barrier
    ds_read_b64_tr_b16 v[96:97], v129 offset:32768
    ds_read_b64_tr_b16 v[98:99], v129 offset:34816
    ds_read_b128 v[32:35], v128 offset:0
    ds_read_b128 v[36:39], v128 offset:2048
    ds_read_b128 v[40:43], v128 offset:4096
    ds_read_b128 v[44:47], v128 offset:6144
    ds_read_b64_tr_b16 v[100:101], v130 offset:32768
    ds_read_b64_tr_b16 v[102:103], v130 offset:34816
    ds_read_b64_tr_b16 v[104:105], v129 offset:36864
    ds_read_b64_tr_b16 v[106:107], v129 offset:38912
    ds_read_b128 v[48:51], v128 offset:1024
    ds_read_b128 v[52:55], v128 offset:3072
    ds_read_b128 v[56:59], v128 offset:5120
    ds_read_b128 v[60:63], v128 offset:7168
    ds_read_b64_tr_b16 v[108:109], v130 offset:36864
    ds_read_b64_tr_b16 v[110:111], v130 offset:38912
    s_waitcnt lgkmcnt(0)
    s_barrier
    .p2align 3
    v_mfma_f32_16x16x32_bf16 v[0:3], v[96:99], v[32:35], v[0:3]
    ds_read_b64_tr_b16 v[112:113], v129 offset:40960
    ds_read_b64_tr_b16 v[114:115], v129 offset:43008
    v_mfma_f32_16x16x32_bf16 v[4:7], v[96:99], v[36:39], v[4:7]
    ds_read_b128 v[64:67], v128 offset:16384
    v_mfma_f32_16x16x32_bf16 v[8:11], v[96:99], v[40:43], v[8:11]
    ds_read_b128 v[68:71], v128 offset:18432
    v_mfma_f32_16x16x32_bf16 v[12:15], v[96:99], v[44:47], v[12:15]
    ds_read_b128 v[72:75], v128 offset:20480
    ds_read_b128 v[76:79], v128 offset:22528
    v_mfma_f32_16x16x32_bf16 v[16:19], v[100:103], v[32:35], v[16:19]
    ds_read_b64_tr_b16 v[116:117], v130 offset:40960
    v_mfma_f32_16x16x32_bf16 v[20:23], v[100:103], v[36:39], v[20:23]
    ds_read_b64_tr_b16 v[118:119], v130 offset:43008
    v_mfma_f32_16x16x32_bf16 v[24:27], v[100:103], v[40:43], v[24:27]
    ds_read_b64_tr_b16 v[120:121], v129 offset:45056
    ds_read_b64_tr_b16 v[122:123], v129 offset:47104
    v_mfma_f32_16x16x32_bf16 v[28:31], v[100:103], v[44:47], v[28:31]
    ds_read_b128 v[80:83], v128 offset:17408
    v_mfma_f32_16x16x32_bf16 v[0:3], v[104:107], v[48:51], v[0:3]
    ds_read_b128 v[84:87], v128 offset:19456
    v_mfma_f32_16x16x32_bf16 v[4:7], v[104:107], v[52:55], v[4:7]
    ds_read_b128 v[88:91], v128 offset:21504
    ds_read_b128 v[92:95], v128 offset:23552
    v_mfma_f32_16x16x32_bf16 v[8:11], v[104:107], v[56:59], v[8:11]
    ds_read_b64_tr_b16 v[124:125], v130 offset:45056
    v_mfma_f32_16x16x32_bf16 v[12:15], v[104:107], v[60:63], v[12:15]
    ds_read_b64_tr_b16 v[126:127], v130 offset:47104
    v_mfma_f32_16x16x32_bf16 v[16:19], v[108:111], v[48:51], v[16:19]
    v_mfma_f32_16x16x32_bf16 v[20:23], v[108:111], v[52:55], v[20:23]
    v_mfma_f32_16x16x32_bf16 v[24:27], v[108:111], v[56:59], v[24:27]
    v_mfma_f32_16x16x32_bf16 v[28:31], v[108:111], v[60:63], v[28:31]
    s_waitcnt lgkmcnt(0)
    s_barrier
    .p2align 3
    v_mfma_f32_16x16x32_bf16 v[0:3], v[112:115], v[64:67], v[0:3]
    ds_read_b64_tr_b16 v[96:97], v131 offset:0
    ds_read_b64_tr_b16 v[98:99], v131 offset:2048
    v_mfma_f32_16x16x32_bf16 v[4:7], v[112:115], v[68:71], v[4:7]
    ds_read_b128 v[32:35], v128 offset:32768
    v_mfma_f32_16x16x32_bf16 v[8:11], v[112:115], v[72:75], v[8:11]
    ds_read_b128 v[36:39], v128 offset:34816
    v_mfma_f32_16x16x32_bf16 v[12:15], v[112:115], v[76:79], v[12:15]
    ds_read_b128 v[40:43], v128 offset:36864
    ds_read_b128 v[44:47], v128 offset:38912
    v_mfma_f32_16x16x32_bf16 v[16:19], v[116:119], v[64:67], v[16:19]
    ds_read_b64_tr_b16 v[100:101], v132 offset:0
    v_mfma_f32_16x16x32_bf16 v[20:23], v[116:119], v[68:71], v[20:23]
    ds_read_b64_tr_b16 v[102:103], v132 offset:2048
    v_mfma_f32_16x16x32_bf16 v[24:27], v[116:119], v[72:75], v[24:27]
    ds_read_b64_tr_b16 v[104:105], v131 offset:4096
    ds_read_b64_tr_b16 v[106:107], v131 offset:6144
    v_mfma_f32_16x16x32_bf16 v[28:31], v[116:119], v[76:79], v[28:31]
    ds_read_b128 v[48:51], v128 offset:33792
    v_mfma_f32_16x16x32_bf16 v[0:3], v[120:123], v[80:83], v[0:3]
    ds_read_b128 v[52:55], v128 offset:35840
    v_mfma_f32_16x16x32_bf16 v[4:7], v[120:123], v[84:87], v[4:7]
    ds_read_b128 v[56:59], v128 offset:37888
    ds_read_b128 v[60:63], v128 offset:39936
    v_mfma_f32_16x16x32_bf16 v[8:11], v[120:123], v[88:91], v[8:11]
    ds_read_b64_tr_b16 v[108:109], v132 offset:4096
    v_mfma_f32_16x16x32_bf16 v[12:15], v[120:123], v[92:95], v[12:15]
    ds_read_b64_tr_b16 v[110:111], v132 offset:6144
    v_mfma_f32_16x16x32_bf16 v[16:19], v[124:127], v[80:83], v[16:19]
    v_mfma_f32_16x16x32_bf16 v[20:23], v[124:127], v[84:87], v[20:23]
    v_mfma_f32_16x16x32_bf16 v[24:27], v[124:127], v[88:91], v[24:27]
    v_mfma_f32_16x16x32_bf16 v[28:31], v[124:127], v[92:95], v[28:31]
    s_waitcnt lgkmcnt(0)
    s_barrier
    .p2align 3
    v_mfma_f32_16x16x32_bf16 v[0:3], v[96:99], v[32:35], v[0:3]
    ds_read_b64_tr_b16 v[112:113], v131 offset:8192
    ds_read_b64_tr_b16 v[114:115], v131 offset:10240
    v_mfma_f32_16x16x32_bf16 v[4:7], v[96:99], v[36:39], v[4:7]
    ds_read_b128 v[64:67], v128 offset:0
    v_mfma_f32_16x16x32_bf16 v[8:11], v[96:99], v[40:43], v[8:11]
    ds_read_b128 v[68:71], v128 offset:2048
    v_mfma_f32_16x16x32_bf16 v[12:15], v[96:99], v[44:47], v[12:15]
    ds_read_b128 v[72:75], v128 offset:4096
    ds_read_b128 v[76:79], v128 offset:6144
    v_mfma_f32_16x16x32_bf16 v[16:19], v[100:103], v[32:35], v[16:19]
    ds_read_b64_tr_b16 v[116:117], v132 offset:8192
    v_mfma_f32_16x16x32_bf16 v[20:23], v[100:103], v[36:39], v[20:23]
    ds_read_b64_tr_b16 v[118:119], v132 offset:10240
    v_mfma_f32_16x16x32_bf16 v[24:27], v[100:103], v[40:43], v[24:27]
    ds_read_b64_tr_b16 v[120:121], v131 offset:12288
    ds_read_b64_tr_b16 v[122:123], v131 offset:14336
    v_mfma_f32_16x16x32_bf16 v[28:31], v[100:103], v[44:47], v[28:31]
    ds_read_b128 v[80:83], v128 offset:1024
    v_mfma_f32_16x16x32_bf16 v[0:3], v[104:107], v[48:51], v[0:3]
    ds_read_b128 v[84:87], v128 offset:3072
    v_mfma_f32_16x16x32_bf16 v[4:7], v[104:107], v[52:55], v[4:7]
    ds_read_b128 v[88:91], v128 offset:5120
    ds_read_b128 v[92:95], v128 offset:7168
    v_mfma_f32_16x16x32_bf16 v[8:11], v[104:107], v[56:59], v[8:11]
    ds_read_b64_tr_b16 v[124:125], v132 offset:12288
    v_mfma_f32_16x16x32_bf16 v[12:15], v[104:107], v[60:63], v[12:15]
    ds_read_b64_tr_b16 v[126:127], v132 offset:14336
    v_mfma_f32_16x16x32_bf16 v[16:19], v[108:111], v[48:51], v[16:19]
    v_mfma_f32_16x16x32_bf16 v[20:23], v[108:111], v[52:55], v[20:23]
    v_mfma_f32_16x16x32_bf16 v[24:27], v[108:111], v[56:59], v[24:27]
    v_mfma_f32_16x16x32_bf16 v[28:31], v[108:111], v[60:63], v[28:31]
    s_waitcnt lgkmcnt(0)
    s_barrier
    .p2align 3
    v_mfma_f32_16x16x32_bf16 v[0:3], v[112:115], v[64:67], v[0:3]
    ds_read_b64_tr_b16 v[96:97], v131 offset:16384
    ds_read_b64_tr_b16 v[98:99], v131 offset:18432
    v_mfma_f32_16x16x32_bf16 v[4:7], v[112:115], v[68:71], v[4:7]
    ds_read_b128 v[32:35], v128 offset:16384
    v_mfma_f32_16x16x32_bf16 v[8:11], v[112:115], v[72:75], v[8:11]
    ds_read_b128 v[36:39], v128 offset:18432
    v_mfma_f32_16x16x32_bf16 v[12:15], v[112:115], v[76:79], v[12:15]
    ds_read_b128 v[40:43], v128 offset:20480
    ds_read_b128 v[44:47], v128 offset:22528
    v_mfma_f32_16x16x32_bf16 v[16:19], v[116:119], v[64:67], v[16:19]
    ds_read_b64_tr_b16 v[100:101], v132 offset:16384
    v_mfma_f32_16x16x32_bf16 v[20:23], v[116:119], v[68:71], v[20:23]
    ds_read_b64_tr_b16 v[102:103], v132 offset:18432
    v_mfma_f32_16x16x32_bf16 v[24:27], v[116:119], v[72:75], v[24:27]
    ds_read_b64_tr_b16 v[104:105], v131 offset:20480
    ds_read_b64_tr_b16 v[106:107], v131 offset:22528
    v_mfma_f32_16x16x32_bf16 v[28:31], v[116:119], v[76:79], v[28:31]
    ds_read_b128 v[48:51], v128 offset:17408
    v_mfma_f32_16x16x32_bf16 v[0:3], v[120:123], v[80:83], v[0:3]
    ds_read_b128 v[52:55], v128 offset:19456
    v_mfma_f32_16x16x32_bf16 v[4:7], v[120:123], v[84:87], v[4:7]
    ds_read_b128 v[56:59], v128 offset:21504
    ds_read_b128 v[60:63], v128 offset:23552
    v_mfma_f32_16x16x32_bf16 v[8:11], v[120:123], v[88:91], v[8:11]
    ds_read_b64_tr_b16 v[108:109], v132 offset:20480
    v_mfma_f32_16x16x32_bf16 v[12:15], v[120:123], v[92:95], v[12:15]
    ds_read_b64_tr_b16 v[110:111], v132 offset:22528
    v_mfma_f32_16x16x32_bf16 v[16:19], v[124:127], v[80:83], v[16:19]
    v_mfma_f32_16x16x32_bf16 v[20:23], v[124:127], v[84:87], v[20:23]
    v_mfma_f32_16x16x32_bf16 v[24:27], v[124:127], v[88:91], v[24:27]
    v_mfma_f32_16x16x32_bf16 v[28:31], v[124:127], v[92:95], v[28:31]
    s_waitcnt lgkmcnt(0)
    s_barrier
    .p2align 3
    v_mfma_f32_16x16x32_bf16 v[0:3], v[96:99], v[32:35], v[0:3]
    ds_read_b64_tr_b16 v[112:113], v131 offset:24576
    ds_read_b64_tr_b16 v[114:115], v131 offset:26624
    v_mfma_f32_16x16x32_bf16 v[4:7], v[96:99], v[36:39], v[4:7]
    ds_read_b128 v[64:67], v128 offset:32768
    v_mfma_f32_16x16x32_bf16 v[8:11], v[96:99], v[40:43], v[8:11]
    ds_read_b128 v[68:71], v128 offset:34816
    v_mfma_f32_16x16x32_bf16 v[12:15], v[96:99], v[44:47], v[12:15]
    ds_read_b128 v[72:75], v128 offset:36864
    ds_read_b128 v[76:79], v128 offset:38912
    v_mfma_f32_16x16x32_bf16 v[16:19], v[100:103], v[32:35], v[16:19]
    ds_read_b64_tr_b16 v[116:117], v132 offset:24576
    v_mfma_f32_16x16x32_bf16 v[20:23], v[100:103], v[36:39], v[20:23]
    ds_read_b64_tr_b16 v[118:119], v132 offset:26624
    v_mfma_f32_16x16x32_bf16 v[24:27], v[100:103], v[40:43], v[24:27]
    ds_read_b64_tr_b16 v[120:121], v131 offset:28672
    ds_read_b64_tr_b16 v[122:123], v131 offset:30720
    v_mfma_f32_16x16x32_bf16 v[28:31], v[100:103], v[44:47], v[28:31]
    ds_read_b128 v[80:83], v128 offset:33792
    v_mfma_f32_16x16x32_bf16 v[0:3], v[104:107], v[48:51], v[0:3]
    ds_read_b128 v[84:87], v128 offset:35840
    v_mfma_f32_16x16x32_bf16 v[4:7], v[104:107], v[52:55], v[4:7]
    ds_read_b128 v[88:91], v128 offset:37888
    ds_read_b128 v[92:95], v128 offset:39936
    v_mfma_f32_16x16x32_bf16 v[8:11], v[104:107], v[56:59], v[8:11]
    ds_read_b64_tr_b16 v[124:125], v132 offset:28672
    v_mfma_f32_16x16x32_bf16 v[12:15], v[104:107], v[60:63], v[12:15]
    ds_read_b64_tr_b16 v[126:127], v132 offset:30720
    v_mfma_f32_16x16x32_bf16 v[16:19], v[108:111], v[48:51], v[16:19]
    v_mfma_f32_16x16x32_bf16 v[20:23], v[108:111], v[52:55], v[20:23]
    v_mfma_f32_16x16x32_bf16 v[24:27], v[108:111], v[56:59], v[24:27]
    v_mfma_f32_16x16x32_bf16 v[28:31], v[108:111], v[60:63], v[28:31]
    s_waitcnt lgkmcnt(0)
    s_barrier
    .p2align 3
    v_mfma_f32_16x16x32_bf16 v[0:3], v[112:115], v[64:67], v[0:3]
    ds_read_b64_tr_b16 v[96:97], v131 offset:32768
    ds_read_b64_tr_b16 v[98:99], v131 offset:34816
    v_mfma_f32_16x16x32_bf16 v[4:7], v[112:115], v[68:71], v[4:7]
    ds_read_b128 v[32:35], v128 offset:0
    v_mfma_f32_16x16x32_bf16 v[8:11], v[112:115], v[72:75], v[8:11]
    ds_read_b128 v[36:39], v128 offset:2048
    v_mfma_f32_16x16x32_bf16 v[12:15], v[112:115], v[76:79], v[12:15]
    ds_read_b128 v[40:43], v128 offset:4096
    ds_read_b128 v[44:47], v128 offset:6144
    v_mfma_f32_16x16x32_bf16 v[16:19], v[116:119], v[64:67], v[16:19]
    ds_read_b64_tr_b16 v[100:101], v132 offset:32768
    v_mfma_f32_16x16x32_bf16 v[20:23], v[116:119], v[68:71], v[20:23]
    ds_read_b64_tr_b16 v[102:103], v132 offset:34816
    v_mfma_f32_16x16x32_bf16 v[24:27], v[116:119], v[72:75], v[24:27]
    ds_read_b64_tr_b16 v[104:105], v131 offset:36864
    ds_read_b64_tr_b16 v[106:107], v131 offset:38912
    v_mfma_f32_16x16x32_bf16 v[28:31], v[116:119], v[76:79], v[28:31]
    ds_read_b128 v[48:51], v128 offset:1024
    v_mfma_f32_16x16x32_bf16 v[0:3], v[120:123], v[80:83], v[0:3]
    ds_read_b128 v[52:55], v128 offset:3072
    v_mfma_f32_16x16x32_bf16 v[4:7], v[120:123], v[84:87], v[4:7]
    ds_read_b128 v[56:59], v128 offset:5120
    ds_read_b128 v[60:63], v128 offset:7168
    v_mfma_f32_16x16x32_bf16 v[8:11], v[120:123], v[88:91], v[8:11]
    ds_read_b64_tr_b16 v[108:109], v132 offset:36864
    v_mfma_f32_16x16x32_bf16 v[12:15], v[120:123], v[92:95], v[12:15]
    ds_read_b64_tr_b16 v[110:111], v132 offset:38912
    v_mfma_f32_16x16x32_bf16 v[16:19], v[124:127], v[80:83], v[16:19]
    v_mfma_f32_16x16x32_bf16 v[20:23], v[124:127], v[84:87], v[20:23]
    v_mfma_f32_16x16x32_bf16 v[24:27], v[124:127], v[88:91], v[24:27]
    v_mfma_f32_16x16x32_bf16 v[28:31], v[124:127], v[92:95], v[28:31]
    s_waitcnt lgkmcnt(0)
    s_barrier
    .p2align 3
    v_mfma_f32_16x16x32_bf16 v[0:3], v[96:99], v[32:35], v[0:3]
    ds_read_b64_tr_b16 v[112:113], v131 offset:40960
    ds_read_b64_tr_b16 v[114:115], v131 offset:43008
    v_mfma_f32_16x16x32_bf16 v[4:7], v[96:99], v[36:39], v[4:7]
    ds_read_b128 v[64:67], v128 offset:16384
    v_mfma_f32_16x16x32_bf16 v[8:11], v[96:99], v[40:43], v[8:11]
    ds_read_b128 v[68:71], v128 offset:18432
    v_mfma_f32_16x16x32_bf16 v[12:15], v[96:99], v[44:47], v[12:15]
    ds_read_b128 v[72:75], v128 offset:20480
    ds_read_b128 v[76:79], v128 offset:22528
    v_mfma_f32_16x16x32_bf16 v[16:19], v[100:103], v[32:35], v[16:19]
    ds_read_b64_tr_b16 v[116:117], v132 offset:40960
    v_mfma_f32_16x16x32_bf16 v[20:23], v[100:103], v[36:39], v[20:23]
    ds_read_b64_tr_b16 v[118:119], v132 offset:43008
    v_mfma_f32_16x16x32_bf16 v[24:27], v[100:103], v[40:43], v[24:27]
    ds_read_b64_tr_b16 v[120:121], v131 offset:45056
    ds_read_b64_tr_b16 v[122:123], v131 offset:47104
    v_mfma_f32_16x16x32_bf16 v[28:31], v[100:103], v[44:47], v[28:31]
    ds_read_b128 v[80:83], v128 offset:17408
    v_mfma_f32_16x16x32_bf16 v[0:3], v[104:107], v[48:51], v[0:3]
    ds_read_b128 v[84:87], v128 offset:19456
    v_mfma_f32_16x16x32_bf16 v[4:7], v[104:107], v[52:55], v[4:7]
    ds_read_b128 v[88:91], v128 offset:21504
    ds_read_b128 v[92:95], v128 offset:23552
    v_mfma_f32_16x16x32_bf16 v[8:11], v[104:107], v[56:59], v[8:11]
    ds_read_b64_tr_b16 v[124:125], v132 offset:45056
    v_mfma_f32_16x16x32_bf16 v[12:15], v[104:107], v[60:63], v[12:15]
    ds_read_b64_tr_b16 v[126:127], v132 offset:47104
    v_mfma_f32_16x16x32_bf16 v[16:19], v[108:111], v[48:51], v[16:19]
    v_mfma_f32_16x16x32_bf16 v[20:23], v[108:111], v[52:55], v[20:23]
    v_mfma_f32_16x16x32_bf16 v[24:27], v[108:111], v[56:59], v[24:27]
    v_mfma_f32_16x16x32_bf16 v[28:31], v[108:111], v[60:63], v[28:31]
    s_waitcnt lgkmcnt(0)
    s_barrier
    .p2align 3
    v_mfma_f32_16x16x32_bf16 v[0:3], v[112:115], v[64:67], v[0:3]
    ds_read_b64_tr_b16 v[96:97], v129 offset:0
    ds_read_b64_tr_b16 v[98:99], v129 offset:2048
    v_mfma_f32_16x16x32_bf16 v[4:7], v[112:115], v[68:71], v[4:7]
    ds_read_b128 v[32:35], v128 offset:32768
    v_mfma_f32_16x16x32_bf16 v[8:11], v[112:115], v[72:75], v[8:11]
    ds_read_b128 v[36:39], v128 offset:34816
    v_mfma_f32_16x16x32_bf16 v[12:15], v[112:115], v[76:79], v[12:15]
    ds_read_b128 v[40:43], v128 offset:36864
    ds_read_b128 v[44:47], v128 offset:38912
    v_mfma_f32_16x16x32_bf16 v[16:19], v[116:119], v[64:67], v[16:19]
    ds_read_b64_tr_b16 v[100:101], v130 offset:0
    v_mfma_f32_16x16x32_bf16 v[20:23], v[116:119], v[68:71], v[20:23]
    ds_read_b64_tr_b16 v[102:103], v130 offset:2048
    v_mfma_f32_16x16x32_bf16 v[24:27], v[116:119], v[72:75], v[24:27]
    ds_read_b64_tr_b16 v[104:105], v129 offset:4096
    ds_read_b64_tr_b16 v[106:107], v129 offset:6144
    v_mfma_f32_16x16x32_bf16 v[28:31], v[116:119], v[76:79], v[28:31]
    ds_read_b128 v[48:51], v128 offset:33792
    v_mfma_f32_16x16x32_bf16 v[0:3], v[120:123], v[80:83], v[0:3]
    ds_read_b128 v[52:55], v128 offset:35840
    v_mfma_f32_16x16x32_bf16 v[4:7], v[120:123], v[84:87], v[4:7]
    ds_read_b128 v[56:59], v128 offset:37888
    ds_read_b128 v[60:63], v128 offset:39936
    v_mfma_f32_16x16x32_bf16 v[8:11], v[120:123], v[88:91], v[8:11]
    ds_read_b64_tr_b16 v[108:109], v130 offset:4096
    v_mfma_f32_16x16x32_bf16 v[12:15], v[120:123], v[92:95], v[12:15]
    ds_read_b64_tr_b16 v[110:111], v130 offset:6144
    v_mfma_f32_16x16x32_bf16 v[16:19], v[124:127], v[80:83], v[16:19]
    v_mfma_f32_16x16x32_bf16 v[20:23], v[124:127], v[84:87], v[20:23]
    v_mfma_f32_16x16x32_bf16 v[24:27], v[124:127], v[88:91], v[24:27]
    v_mfma_f32_16x16x32_bf16 v[28:31], v[124:127], v[92:95], v[28:31]
    s_waitcnt lgkmcnt(0)
    s_barrier
    .p2align 3
    v_mfma_f32_16x16x32_bf16 v[0:3], v[96:99], v[32:35], v[0:3]
    ds_read_b64_tr_b16 v[112:113], v129 offset:8192
    ds_read_b64_tr_b16 v[114:115], v129 offset:10240
    v_mfma_f32_16x16x32_bf16 v[4:7], v[96:99], v[36:39], v[4:7]
    ds_read_b128 v[64:67], v128 offset:0
    v_mfma_f32_16x16x32_bf16 v[8:11], v[96:99], v[40:43], v[8:11]
    ds_read_b128 v[68:71], v128 offset:2048
    v_mfma_f32_16x16x32_bf16 v[12:15], v[96:99], v[44:47], v[12:15]
    ds_read_b128 v[72:75], v128 offset:4096
    ds_read_b128 v[76:79], v128 offset:6144
    v_mfma_f32_16x16x32_bf16 v[16:19], v[100:103], v[32:35], v[16:19]
    ds_read_b64_tr_b16 v[116:117], v130 offset:8192
    v_mfma_f32_16x16x32_bf16 v[20:23], v[100:103], v[36:39], v[20:23]
    ds_read_b64_tr_b16 v[118:119], v130 offset:10240
    v_mfma_f32_16x16x32_bf16 v[24:27], v[100:103], v[40:43], v[24:27]
    ds_read_b64_tr_b16 v[120:121], v129 offset:12288
    ds_read_b64_tr_b16 v[122:123], v129 offset:14336
    v_mfma_f32_16x16x32_bf16 v[28:31], v[100:103], v[44:47], v[28:31]
    ds_read_b128 v[80:83], v128 offset:1024
    v_mfma_f32_16x16x32_bf16 v[0:3], v[104:107], v[48:51], v[0:3]
    ds_read_b128 v[84:87], v128 offset:3072
    v_mfma_f32_16x16x32_bf16 v[4:7], v[104:107], v[52:55], v[4:7]
    ds_read_b128 v[88:91], v128 offset:5120
    ds_read_b128 v[92:95], v128 offset:7168
    v_mfma_f32_16x16x32_bf16 v[8:11], v[104:107], v[56:59], v[8:11]
    ds_read_b64_tr_b16 v[124:125], v130 offset:12288
    v_mfma_f32_16x16x32_bf16 v[12:15], v[104:107], v[60:63], v[12:15]
    ds_read_b64_tr_b16 v[126:127], v130 offset:14336
    v_mfma_f32_16x16x32_bf16 v[16:19], v[108:111], v[48:51], v[16:19]
    v_mfma_f32_16x16x32_bf16 v[20:23], v[108:111], v[52:55], v[20:23]
    v_mfma_f32_16x16x32_bf16 v[24:27], v[108:111], v[56:59], v[24:27]
    v_mfma_f32_16x16x32_bf16 v[28:31], v[108:111], v[60:63], v[28:31]
    s_waitcnt lgkmcnt(0)
    s_barrier
    .p2align 3
    v_mfma_f32_16x16x32_bf16 v[0:3], v[112:115], v[64:67], v[0:3]
    ds_read_b64_tr_b16 v[96:97], v129 offset:16384
    ds_read_b64_tr_b16 v[98:99], v129 offset:18432
    v_mfma_f32_16x16x32_bf16 v[4:7], v[112:115], v[68:71], v[4:7]
    ds_read_b128 v[32:35], v128 offset:16384
    v_mfma_f32_16x16x32_bf16 v[8:11], v[112:115], v[72:75], v[8:11]
    ds_read_b128 v[36:39], v128 offset:18432
    v_mfma_f32_16x16x32_bf16 v[12:15], v[112:115], v[76:79], v[12:15]
    ds_read_b128 v[40:43], v128 offset:20480
    ds_read_b128 v[44:47], v128 offset:22528
    v_mfma_f32_16x16x32_bf16 v[16:19], v[116:119], v[64:67], v[16:19]
    ds_read_b64_tr_b16 v[100:101], v130 offset:16384
    v_mfma_f32_16x16x32_bf16 v[20:23], v[116:119], v[68:71], v[20:23]
    ds_read_b64_tr_b16 v[102:103], v130 offset:18432
    v_mfma_f32_16x16x32_bf16 v[24:27], v[116:119], v[72:75], v[24:27]
    ds_read_b64_tr_b16 v[104:105], v129 offset:20480
    ds_read_b64_tr_b16 v[106:107], v129 offset:22528
    v_mfma_f32_16x16x32_bf16 v[28:31], v[116:119], v[76:79], v[28:31]
    ds_read_b128 v[48:51], v128 offset:17408
    v_mfma_f32_16x16x32_bf16 v[0:3], v[120:123], v[80:83], v[0:3]
    ds_read_b128 v[52:55], v128 offset:19456
    v_mfma_f32_16x16x32_bf16 v[4:7], v[120:123], v[84:87], v[4:7]
    ds_read_b128 v[56:59], v128 offset:21504
    ds_read_b128 v[60:63], v128 offset:23552
    v_mfma_f32_16x16x32_bf16 v[8:11], v[120:123], v[88:91], v[8:11]
    ds_read_b64_tr_b16 v[108:109], v130 offset:20480
    v_mfma_f32_16x16x32_bf16 v[12:15], v[120:123], v[92:95], v[12:15]
    ds_read_b64_tr_b16 v[110:111], v130 offset:22528
    v_mfma_f32_16x16x32_bf16 v[16:19], v[124:127], v[80:83], v[16:19]
    v_mfma_f32_16x16x32_bf16 v[20:23], v[124:127], v[84:87], v[20:23]
    v_mfma_f32_16x16x32_bf16 v[24:27], v[124:127], v[88:91], v[24:27]
    v_mfma_f32_16x16x32_bf16 v[28:31], v[124:127], v[92:95], v[28:31]
    s_waitcnt lgkmcnt(0)
    s_barrier
    .p2align 3
    v_mfma_f32_16x16x32_bf16 v[0:3], v[96:99], v[32:35], v[0:3]
    ds_read_b64_tr_b16 v[112:113], v129 offset:24576
    ds_read_b64_tr_b16 v[114:115], v129 offset:26624
    v_mfma_f32_16x16x32_bf16 v[4:7], v[96:99], v[36:39], v[4:7]
    ds_read_b128 v[64:67], v128 offset:32768
    v_mfma_f32_16x16x32_bf16 v[8:11], v[96:99], v[40:43], v[8:11]
    ds_read_b128 v[68:71], v128 offset:34816
    v_mfma_f32_16x16x32_bf16 v[12:15], v[96:99], v[44:47], v[12:15]
    ds_read_b128 v[72:75], v128 offset:36864
    ds_read_b128 v[76:79], v128 offset:38912
    v_mfma_f32_16x16x32_bf16 v[16:19], v[100:103], v[32:35], v[16:19]
    ds_read_b64_tr_b16 v[116:117], v130 offset:24576
    v_mfma_f32_16x16x32_bf16 v[20:23], v[100:103], v[36:39], v[20:23]
    ds_read_b64_tr_b16 v[118:119], v130 offset:26624
    v_mfma_f32_16x16x32_bf16 v[24:27], v[100:103], v[40:43], v[24:27]
    ds_read_b64_tr_b16 v[120:121], v129 offset:28672
    ds_read_b64_tr_b16 v[122:123], v129 offset:30720
    v_mfma_f32_16x16x32_bf16 v[28:31], v[100:103], v[44:47], v[28:31]
    ds_read_b128 v[80:83], v128 offset:33792
    v_mfma_f32_16x16x32_bf16 v[0:3], v[104:107], v[48:51], v[0:3]
    ds_read_b128 v[84:87], v128 offset:35840
    v_mfma_f32_16x16x32_bf16 v[4:7], v[104:107], v[52:55], v[4:7]
    ds_read_b128 v[88:91], v128 offset:37888
    ds_read_b128 v[92:95], v128 offset:39936
    v_mfma_f32_16x16x32_bf16 v[8:11], v[104:107], v[56:59], v[8:11]
    ds_read_b64_tr_b16 v[124:125], v130 offset:28672
    v_mfma_f32_16x16x32_bf16 v[12:15], v[104:107], v[60:63], v[12:15]
    ds_read_b64_tr_b16 v[126:127], v130 offset:30720
    v_mfma_f32_16x16x32_bf16 v[16:19], v[108:111], v[48:51], v[16:19]
    v_mfma_f32_16x16x32_bf16 v[20:23], v[108:111], v[52:55], v[20:23]
    v_mfma_f32_16x16x32_bf16 v[24:27], v[108:111], v[56:59], v[24:27]
    v_mfma_f32_16x16x32_bf16 v[28:31], v[108:111], v[60:63], v[28:31]
    s_waitcnt lgkmcnt(0)
    s_barrier
    .p2align 3
    v_mfma_f32_16x16x32_bf16 v[0:3], v[112:115], v[64:67], v[0:3]
    ds_read_b64_tr_b16 v[96:97], v129 offset:32768
    ds_read_b64_tr_b16 v[98:99], v129 offset:34816
    v_mfma_f32_16x16x32_bf16 v[4:7], v[112:115], v[68:71], v[4:7]
    ds_read_b128 v[32:35], v128 offset:0
    v_mfma_f32_16x16x32_bf16 v[8:11], v[112:115], v[72:75], v[8:11]
    ds_read_b128 v[36:39], v128 offset:2048
    v_mfma_f32_16x16x32_bf16 v[12:15], v[112:115], v[76:79], v[12:15]
    ds_read_b128 v[40:43], v128 offset:4096
    ds_read_b128 v[44:47], v128 offset:6144
    v_mfma_f32_16x16x32_bf16 v[16:19], v[116:119], v[64:67], v[16:19]
    ds_read_b64_tr_b16 v[100:101], v130 offset:32768
    v_mfma_f32_16x16x32_bf16 v[20:23], v[116:119], v[68:71], v[20:23]
    ds_read_b64_tr_b16 v[102:103], v130 offset:34816
    v_mfma_f32_16x16x32_bf16 v[24:27], v[116:119], v[72:75], v[24:27]
    ds_read_b64_tr_b16 v[104:105], v129 offset:36864
    ds_read_b64_tr_b16 v[106:107], v129 offset:38912
    v_mfma_f32_16x16x32_bf16 v[28:31], v[116:119], v[76:79], v[28:31]
    ds_read_b128 v[48:51], v128 offset:1024
    v_mfma_f32_16x16x32_bf16 v[0:3], v[120:123], v[80:83], v[0:3]
    ds_read_b128 v[52:55], v128 offset:3072
    v_mfma_f32_16x16x32_bf16 v[4:7], v[120:123], v[84:87], v[4:7]
    ds_read_b128 v[56:59], v128 offset:5120
    ds_read_b128 v[60:63], v128 offset:7168
    v_mfma_f32_16x16x32_bf16 v[8:11], v[120:123], v[88:91], v[8:11]
    ds_read_b64_tr_b16 v[108:109], v130 offset:36864
    v_mfma_f32_16x16x32_bf16 v[12:15], v[120:123], v[92:95], v[12:15]
    ds_read_b64_tr_b16 v[110:111], v130 offset:38912
    v_mfma_f32_16x16x32_bf16 v[16:19], v[124:127], v[80:83], v[16:19]
    v_mfma_f32_16x16x32_bf16 v[20:23], v[124:127], v[84:87], v[20:23]
    v_mfma_f32_16x16x32_bf16 v[24:27], v[124:127], v[88:91], v[24:27]
    v_mfma_f32_16x16x32_bf16 v[28:31], v[124:127], v[92:95], v[28:31]
    s_waitcnt lgkmcnt(0)
    s_barrier
    .p2align 3
    v_mfma_f32_16x16x32_bf16 v[0:3], v[96:99], v[32:35], v[0:3]
    ds_read_b64_tr_b16 v[112:113], v129 offset:40960
    ds_read_b64_tr_b16 v[114:115], v129 offset:43008
    v_mfma_f32_16x16x32_bf16 v[4:7], v[96:99], v[36:39], v[4:7]
    ds_read_b128 v[64:67], v128 offset:16384
    v_mfma_f32_16x16x32_bf16 v[8:11], v[96:99], v[40:43], v[8:11]
    ds_read_b128 v[68:71], v128 offset:18432
    v_mfma_f32_16x16x32_bf16 v[12:15], v[96:99], v[44:47], v[12:15]
    ds_read_b128 v[72:75], v128 offset:20480
    ds_read_b128 v[76:79], v128 offset:22528
    v_mfma_f32_16x16x32_bf16 v[16:19], v[100:103], v[32:35], v[16:19]
    ds_read_b64_tr_b16 v[116:117], v130 offset:40960
    v_mfma_f32_16x16x32_bf16 v[20:23], v[100:103], v[36:39], v[20:23]
    ds_read_b64_tr_b16 v[118:119], v130 offset:43008
    v_mfma_f32_16x16x32_bf16 v[24:27], v[100:103], v[40:43], v[24:27]
    ds_read_b64_tr_b16 v[120:121], v129 offset:45056
    ds_read_b64_tr_b16 v[122:123], v129 offset:47104
    v_mfma_f32_16x16x32_bf16 v[28:31], v[100:103], v[44:47], v[28:31]
    ds_read_b128 v[80:83], v128 offset:17408
    v_mfma_f32_16x16x32_bf16 v[0:3], v[104:107], v[48:51], v[0:3]
    ds_read_b128 v[84:87], v128 offset:19456
    v_mfma_f32_16x16x32_bf16 v[4:7], v[104:107], v[52:55], v[4:7]
    ds_read_b128 v[88:91], v128 offset:21504
    ds_read_b128 v[92:95], v128 offset:23552
    v_mfma_f32_16x16x32_bf16 v[8:11], v[104:107], v[56:59], v[8:11]
    ds_read_b64_tr_b16 v[124:125], v130 offset:45056
    v_mfma_f32_16x16x32_bf16 v[12:15], v[104:107], v[60:63], v[12:15]
    ds_read_b64_tr_b16 v[126:127], v130 offset:47104
    v_mfma_f32_16x16x32_bf16 v[16:19], v[108:111], v[48:51], v[16:19]
    v_mfma_f32_16x16x32_bf16 v[20:23], v[108:111], v[52:55], v[20:23]
    v_mfma_f32_16x16x32_bf16 v[24:27], v[108:111], v[56:59], v[24:27]
    v_mfma_f32_16x16x32_bf16 v[28:31], v[108:111], v[60:63], v[28:31]
    s_waitcnt lgkmcnt(0)
    s_barrier
    .p2align 3
    v_mfma_f32_16x16x32_bf16 v[0:3], v[112:115], v[64:67], v[0:3]
    ds_read_b64_tr_b16 v[96:97], v131 offset:0
    ds_read_b64_tr_b16 v[98:99], v131 offset:2048
    v_mfma_f32_16x16x32_bf16 v[4:7], v[112:115], v[68:71], v[4:7]
    ds_read_b128 v[32:35], v128 offset:32768
    v_mfma_f32_16x16x32_bf16 v[8:11], v[112:115], v[72:75], v[8:11]
    ds_read_b128 v[36:39], v128 offset:34816
    v_mfma_f32_16x16x32_bf16 v[12:15], v[112:115], v[76:79], v[12:15]
    ds_read_b128 v[40:43], v128 offset:36864
    ds_read_b128 v[44:47], v128 offset:38912
    v_mfma_f32_16x16x32_bf16 v[16:19], v[116:119], v[64:67], v[16:19]
    ds_read_b64_tr_b16 v[100:101], v132 offset:0
    v_mfma_f32_16x16x32_bf16 v[20:23], v[116:119], v[68:71], v[20:23]
    ds_read_b64_tr_b16 v[102:103], v132 offset:2048
    v_mfma_f32_16x16x32_bf16 v[24:27], v[116:119], v[72:75], v[24:27]
    ds_read_b64_tr_b16 v[104:105], v131 offset:4096
    ds_read_b64_tr_b16 v[106:107], v131 offset:6144
    v_mfma_f32_16x16x32_bf16 v[28:31], v[116:119], v[76:79], v[28:31]
    ds_read_b128 v[48:51], v128 offset:33792
    v_mfma_f32_16x16x32_bf16 v[0:3], v[120:123], v[80:83], v[0:3]
    ds_read_b128 v[52:55], v128 offset:35840
    v_mfma_f32_16x16x32_bf16 v[4:7], v[120:123], v[84:87], v[4:7]
    ds_read_b128 v[56:59], v128 offset:37888
    ds_read_b128 v[60:63], v128 offset:39936
    v_mfma_f32_16x16x32_bf16 v[8:11], v[120:123], v[88:91], v[8:11]
    ds_read_b64_tr_b16 v[108:109], v132 offset:4096
    v_mfma_f32_16x16x32_bf16 v[12:15], v[120:123], v[92:95], v[12:15]
    ds_read_b64_tr_b16 v[110:111], v132 offset:6144
    v_mfma_f32_16x16x32_bf16 v[16:19], v[124:127], v[80:83], v[16:19]
    v_mfma_f32_16x16x32_bf16 v[20:23], v[124:127], v[84:87], v[20:23]
    v_mfma_f32_16x16x32_bf16 v[24:27], v[124:127], v[88:91], v[24:27]
    v_mfma_f32_16x16x32_bf16 v[28:31], v[124:127], v[92:95], v[28:31]
    s_waitcnt lgkmcnt(0)
    s_barrier
    .p2align 3
    v_mfma_f32_16x16x32_bf16 v[0:3], v[96:99], v[32:35], v[0:3]
    ds_read_b64_tr_b16 v[112:113], v131 offset:8192
    ds_read_b64_tr_b16 v[114:115], v131 offset:10240
    v_mfma_f32_16x16x32_bf16 v[4:7], v[96:99], v[36:39], v[4:7]
    ds_read_b128 v[64:67], v128 offset:0
    v_mfma_f32_16x16x32_bf16 v[8:11], v[96:99], v[40:43], v[8:11]
    ds_read_b128 v[68:71], v128 offset:2048
    v_mfma_f32_16x16x32_bf16 v[12:15], v[96:99], v[44:47], v[12:15]
    ds_read_b128 v[72:75], v128 offset:4096
    ds_read_b128 v[76:79], v128 offset:6144
    v_mfma_f32_16x16x32_bf16 v[16:19], v[100:103], v[32:35], v[16:19]
    ds_read_b64_tr_b16 v[116:117], v132 offset:8192
    v_mfma_f32_16x16x32_bf16 v[20:23], v[100:103], v[36:39], v[20:23]
    ds_read_b64_tr_b16 v[118:119], v132 offset:10240
    v_mfma_f32_16x16x32_bf16 v[24:27], v[100:103], v[40:43], v[24:27]
    ds_read_b64_tr_b16 v[120:121], v131 offset:12288
    ds_read_b64_tr_b16 v[122:123], v131 offset:14336
    v_mfma_f32_16x16x32_bf16 v[28:31], v[100:103], v[44:47], v[28:31]
    ds_read_b128 v[80:83], v128 offset:1024
    v_mfma_f32_16x16x32_bf16 v[0:3], v[104:107], v[48:51], v[0:3]
    ds_read_b128 v[84:87], v128 offset:3072
    v_mfma_f32_16x16x32_bf16 v[4:7], v[104:107], v[52:55], v[4:7]
    ds_read_b128 v[88:91], v128 offset:5120
    ds_read_b128 v[92:95], v128 offset:7168
    v_mfma_f32_16x16x32_bf16 v[8:11], v[104:107], v[56:59], v[8:11]
    ds_read_b64_tr_b16 v[124:125], v132 offset:12288
    v_mfma_f32_16x16x32_bf16 v[12:15], v[104:107], v[60:63], v[12:15]
    ds_read_b64_tr_b16 v[126:127], v132 offset:14336
    v_mfma_f32_16x16x32_bf16 v[16:19], v[108:111], v[48:51], v[16:19]
    v_mfma_f32_16x16x32_bf16 v[20:23], v[108:111], v[52:55], v[20:23]
    v_mfma_f32_16x16x32_bf16 v[24:27], v[108:111], v[56:59], v[24:27]
    v_mfma_f32_16x16x32_bf16 v[28:31], v[108:111], v[60:63], v[28:31]
    s_waitcnt lgkmcnt(0)
    s_barrier
    .p2align 3
    v_mfma_f32_16x16x32_bf16 v[0:3], v[112:115], v[64:67], v[0:3]
    v_mfma_f32_16x16x32_bf16 v[4:7], v[112:115], v[68:71], v[4:7]
    v_mfma_f32_16x16x32_bf16 v[8:11], v[112:115], v[72:75], v[8:11]
    v_mfma_f32_16x16x32_bf16 v[12:15], v[112:115], v[76:79], v[12:15]
    v_mfma_f32_16x16x32_bf16 v[16:19], v[116:119], v[64:67], v[16:19]
    v_mfma_f32_16x16x32_bf16 v[20:23], v[116:119], v[68:71], v[20:23]
    v_mfma_f32_16x16x32_bf16 v[24:27], v[116:119], v[72:75], v[24:27]
    v_mfma_f32_16x16x32_bf16 v[28:31], v[116:119], v[76:79], v[28:31]
    v_mfma_f32_16x16x32_bf16 v[0:3], v[120:123], v[80:83], v[0:3]
    v_mfma_f32_16x16x32_bf16 v[4:7], v[120:123], v[84:87], v[4:7]
    v_mfma_f32_16x16x32_bf16 v[8:11], v[120:123], v[88:91], v[8:11]
    v_mfma_f32_16x16x32_bf16 v[12:15], v[120:123], v[92:95], v[12:15]
    v_mfma_f32_16x16x32_bf16 v[16:19], v[124:127], v[80:83], v[16:19]
    v_mfma_f32_16x16x32_bf16 v[20:23], v[124:127], v[84:87], v[20:23]
    v_mfma_f32_16x16x32_bf16 v[24:27], v[124:127], v[88:91], v[24:27]
    v_mfma_f32_16x16x32_bf16 v[28:31], v[124:127], v[92:95], v[28:31]
    s_nop 7
    s_lshl_b32 s55, s51, 14
    s_lshl_b32 s56, s43, 13
    s_add_u32 s55, s55, s56
    s_lshl_b32 s56, s44, 10
    s_add_u32 s55, s55, s56
    s_add_u32 s59, s55, s49
    s_add_u32 s60, s59, 4096
    v_cvt_pk_bf16_f32 v136, v0, v1
    v_cvt_pk_bf16_f32 v137, v2, v3
    v_cvt_pk_bf16_f32 v138, v16, v17
    v_cvt_pk_bf16_f32 v139, v18, v19
    buffer_store_dwordx4 v[136:139], v254, s[4:7], s59 offen offset:0 sc0 sc1
    v_cvt_pk_bf16_f32 v140, v4, v5
    v_cvt_pk_bf16_f32 v141, v6, v7
    v_cvt_pk_bf16_f32 v142, v20, v21
    v_cvt_pk_bf16_f32 v143, v22, v23
    buffer_store_dwordx4 v[140:143], v254, s[4:7], s59 offen offset:2048 sc0 sc1
    v_cvt_pk_bf16_f32 v144, v8, v9
    v_cvt_pk_bf16_f32 v145, v10, v11
    v_cvt_pk_bf16_f32 v146, v24, v25
    v_cvt_pk_bf16_f32 v147, v26, v27
    buffer_store_dwordx4 v[144:147], v254, s[4:7], s60 offen offset:0 sc0 sc1
    v_cvt_pk_bf16_f32 v148, v12, v13
    v_cvt_pk_bf16_f32 v149, v14, v15
    v_cvt_pk_bf16_f32 v150, v28, v29
    v_cvt_pk_bf16_f32 v151, v30, v31
    buffer_store_dwordx4 v[148:151], v254, s[4:7], s60 offen offset:2048 sc0 sc1
    v_mov_b32 v168, 0x3f803f80
    v_mov_b32 v160, 0
    v_mov_b32 v164, 0
    v_mov_b32 v161, 0
    v_mov_b32 v165, 0
    v_mov_b32 v162, 0
    v_mov_b32 v166, 0
    v_mov_b32 v163, 0
    v_mov_b32 v167, 0
    v_dot2_f32_bf16 v160, v136, v168, v160
    v_dot2_f32_bf16 v164, v136, v136, v164
    v_dot2_f32_bf16 v161, v140, v168, v161
    v_dot2_f32_bf16 v165, v140, v140, v165
    v_dot2_f32_bf16 v162, v144, v168, v162
    v_dot2_f32_bf16 v166, v144, v144, v166
    v_dot2_f32_bf16 v163, v148, v168, v163
    v_dot2_f32_bf16 v167, v148, v148, v167
    v_dot2_f32_bf16 v160, v137, v168, v160
    v_dot2_f32_bf16 v164, v137, v137, v164
    v_dot2_f32_bf16 v161, v141, v168, v161
    v_dot2_f32_bf16 v165, v141, v141, v165
    v_dot2_f32_bf16 v162, v145, v168, v162
    v_dot2_f32_bf16 v166, v145, v145, v166
    v_dot2_f32_bf16 v163, v149, v168, v163
    v_dot2_f32_bf16 v167, v149, v149, v167
    v_dot2_f32_bf16 v160, v138, v168, v160
    v_dot2_f32_bf16 v164, v138, v138, v164
    v_dot2_f32_bf16 v161, v142, v168, v161
    v_dot2_f32_bf16 v165, v142, v142, v165
    v_dot2_f32_bf16 v162, v146, v168, v162
    v_dot2_f32_bf16 v166, v146, v146, v166
    v_dot2_f32_bf16 v163, v150, v168, v163
    v_dot2_f32_bf16 v167, v150, v150, v167
    v_dot2_f32_bf16 v160, v139, v168, v160
    v_dot2_f32_bf16 v164, v139, v139, v164
    v_dot2_f32_bf16 v161, v143, v168, v161
    v_dot2_f32_bf16 v165, v143, v143, v165
    v_dot2_f32_bf16 v162, v147, v168, v162
    v_dot2_f32_bf16 v166, v147, v147, v166
    v_dot2_f32_bf16 v163, v151, v168, v163
    v_dot2_f32_bf16 v167, v151, v151, v167
    s_nop 3
    v_permlane32_swap_b32 v160, v162
    v_permlane32_swap_b32 v161, v163
    v_permlane32_swap_b32 v164, v166
    v_permlane32_swap_b32 v165, v167
    v_add_f32 v160, v160, v162
    v_add_f32 v161, v161, v163
    v_add_f32 v164, v164, v166
    v_add_f32 v165, v165, v167
    s_nop 1
    v_permlane16_swap_b32 v160, v161
    v_permlane16_swap_b32 v164, v165
    v_add_f32 v160, v160, v161
    v_add_f32 v161, v164, v165
    s_lshl_b32 s55, s51, 11
    s_lshl_b32 s56, s44, 10
    s_add_u32 s55, s55, s56
    s_lshl_b32 s56, s43, 9
    s_add_u32 s55, s55, s56
    s_add_u32 s59, s55, s52
    v_lshrrev_b32 v164, 1, v254
    s_waitcnt vmcnt(0)
    s_barrier
    buffer_store_dwordx2 v[160:161], v164, s[4:7], s59 offen sc0 sc1
    s_lshl_b32 s55, s43, 13
    s_add_u32 s55, s55, 98304
    v_add_u32 v224, s55, v254
    s_lshl_b32 s56, s44, 2
    v_lshrrev_b32 v233, 6, v254
    v_and_b32 v234, 7, v233
    v_xor_b32 v234, s56, v234
    v_lshlrev_b32 v233, 8, v233
    v_lshl_add_u32 v233, v234, 5, v233
    v_and_b32 v234, 0x30, v254
    v_lshrrev_b32 v234, 1, v234
    v_add_u32 v233, v233, v234
    v_xor_b32 v225, 0, v233
    v_xor_b32 v226, 32, v233
    v_xor_b32 v227, 64, v233
    v_xor_b32 v228, 96, v233
    v_add_u32 v229, 49152, v225
    v_add_u32 v230, 49152, v226
    v_add_u32 v231, 49152, v227
    v_add_u32 v232, 49152, v228
    s_cmp_ge_u32 s42, 2
    s_cbranch_scc1 x3_8
    s_lshl_b32 s61, s43, 13
    s_add_u32 s62, s49, s61
    s_and_b32 s55, s51, 1
    s_mul_i32 s55, s55, 458752
    s_add_u32 s63, s50, s55
    s_add_u32 s63, s63, s61
    s_branch x3_9
x3_8:
    s_mov_b32 s55, 5462
    v_lshrrev_b32 v233, 4, v254
    v_mul_lo_u32 v234, v233, s55
    v_lshrrev_b32 v234, 16, v234
    v_mul_u32_u24 v235, 12, v234
    v_sub_u32 v233, v233, v235
    v_lshrrev_b32 v235, 1, v234
    v_and_b32 v235, 2, v235
    v_xor_b32 v233, v233, v235
    v_mul_u32_u24 v234, 7168, v234
    v_lshl_add_u32 v236, v233, 4, v234
    v_lshrrev_b32 v233, 4, v254
    v_add_u32 v233, 64, v233
    v_mul_lo_u32 v234, v233, s55
    v_lshrrev_b32 v234, 16, v234
    v_mul_u32_u24 v235, 12, v234
    v_sub_u32 v233, v233, v235
    v_lshrrev_b32 v235, 1, v234
    v_and_b32 v235, 2, v235
    v_xor_b32 v233, v233, v235
    v_mul_u32_u24 v234, 7168, v234
    v_lshl_add_u32 v237, v233, 4, v234
    v_subrev_u32 v237, 1024, v237
    v_lshrrev_b32 v233, 4, v254
    v_add_u32 v233, 128, v233
    v_mul_lo_u32 v234, v233, s55
    v_lshrrev_b32 v234, 16, v234
    v_mul_u32_u24 v235, 12, v234
    v_sub_u32 v233, v233, v235
    v_lshrrev_b32 v235, 1, v234
    v_and_b32 v235, 2, v235
    v_xor_b32 v233, v233, v235
    v_mul_u32_u24 v234, 7168, v234
    v_lshl_add_u32 v238, v233, 4, v234
    v_subrev_u32 v238, 2048, v238
    s_mul_i32 s61, s43, 6144
    s_mul_i32 s63, s41, 448
    s_and_b32 s55, s41, 1
    s_xor_b32 s55, s55, 1
    s_lshl_b32 s55, s55, 8
    s_add_u32 s63, s63, s55
    v_and_b32 v234, 0xf0, v254
    v_lshrrev_b32 v233, 8, v254
    v_and_b32 v235, 7, v233
    v_lshlrev_b32 v235, 5, v235
    v_xor_b32 v235, v234, v235
    v_mul_u32_u24 v233, 2048, v233
    v_add_u32 v239, v233, v235
    v_lshrrev_b32 v233, 8, v254
    v_add_u32 v233, 4, v233
    v_and_b32 v235, 7, v233
    v_lshlrev_b32 v235, 5, v235
    v_xor_b32 v235, v234, v235
    v_mul_u32_u24 v233, 2048, v233
    v_add_u32 v240, v233, v235
    v_subrev_u32 v240, 1024, v240
    v_lshrrev_b32 v233, 8, v254
    v_add_u32 v233, 8, v233
    v_and_b32 v235, 7, v233
    v_lshlrev_b32 v235, 5, v235
    v_xor_b32 v235, v234, v235
    v_mul_u32_u24 v233, 2048, v233
    v_add_u32 v241, v233, v235
    v_subrev_u32 v241, 2048, v241
    v_lshrrev_b32 v233, 8, v254
    v_add_u32 v233, 12, v233
    v_and_b32 v235, 7, v233
    v_lshlrev_b32 v235, 5, v235
    v_xor_b32 v235, v234, v235
    v_mul_u32_u24 v233, 2048, v233
    v_add_u32 v242, v233, v235
    v_subrev_u32 v242, 3072, v242
    s_lshl_b32 s67, s43, 13
    s_and_b32 s55, s51, 1
    s_mul_i32 s68, s55, 3670016
    s_lshr_b32 s55, s51, 1
    s_lshl_b32 s55, s55, 8
    s_add_u32 s68, s68, s55
    s_mul_i32 s55, s43, 196608
    s_add_u32 s69, s68, s55
    s_lshl_b32 s55, s43, 17
    s_add_u32 s68, s68, s55
x3_9:
    v_mov_b32 v243, v224
    s_and_b32 s56, s51, 1
    s_lshl_b32 s56, s56, 2
    s_lshl_b32 s55, s44, 1
    s_add_u32 s56, s56, s55
    v_lshrrev_b32 v233, 6, v254
    v_and_b32 v234, 7, v233
    v_xor_b32 v234, s56, v234
    v_lshlrev_b32 v233, 8, v233
    v_lshl_add_u32 v233, v234, 5, v233
    v_and_b32 v234, 0x30, v254
    v_lshrrev_b32 v234, 1, v234
    v_add_u32 v233, v233, v234
    v_xor_b32 v244, 0, v233
    v_xor_b32 v245, 32, v233
    v_xor_b32 v246, 128, v233
    v_xor_b32 v247, 160, v233
    v_add_u32 v248, 49152, v244
    v_add_u32 v249, 49152, v245
    v_add_u32 v250, 49152, v246
    v_add_u32 v251, 49152, v247
    v_mov_b32 v0, 0
    v_mov_b32 v1, 0
    v_mov_b32 v2, 0
    v_mov_b32 v3, 0
    v_mov_b32 v4, 0
    v_mov_b32 v5, 0
    v_mov_b32 v6, 0
    v_mov_b32 v7, 0
    v_mov_b32 v8, 0
    v_mov_b32 v9, 0
    v_mov_b32 v10, 0
    v_mov_b32 v11, 0
    v_mov_b32 v12, 0
    v_mov_b32 v13, 0
    v_mov_b32 v14, 0
    v_mov_b32 v15, 0
    v_mov_b32 v16, 0
    v_mov_b32 v17, 0
    v_mov_b32 v18, 0
    v_mov_b32 v19, 0
    v_mov_b32 v20, 0
    v_mov_b32 v21, 0
    v_mov_b32 v22, 0
    v_mov_b32 v23, 0
    v_mov_b32 v24, 0
    v_mov_b32 v25, 0
    v_mov_b32 v26, 0
    v_mov_b32 v27, 0
    v_mov_b32 v28, 0
    v_mov_b32 v29, 0
    v_mov_b32 v30, 0
    v_mov_b32 v31, 0
    v_mov_b32 v32, 0
    v_mov_b32 v33, 0
    v_mov_b32 v34, 0
    v_mov_b32 v35, 0
    v_mov_b32 v36, 0
    v_mov_b32 v37, 0
    v_mov_b32 v38, 0
    v_mov_b32 v39, 0
    v_mov_b32 v40, 0
    v_mov_b32 v41, 0
    v_mov_b32 v42, 0
    v_mov_b32 v43, 0
    v_mov_b32 v44, 0
    v_mov_b32 v45, 0
    v_mov_b32 v46, 0
    v_mov_b32 v47, 0
    v_mov_b32 v48, 0
    v_mov_b32 v49, 0
    v_mov_b32 v50, 0
    v_mov_b32 v51, 0
    v_mov_b32 v52, 0
    v_mov_b32 v53, 0
    v_mov_b32 v54, 0
    v_mov_b32 v55, 0
    v_mov_b32 v56, 0
    v_mov_b32 v57, 0
    v_mov_b32 v58, 0
    v_mov_b32 v59, 0
    v_mov_b32 v60, 0
    v_mov_b32 v61, 0
    v_mov_b32 v62, 0
    v_mov_b32 v63, 0
    v_mov_b32 v64, 0
    v_mov_b32 v65, 0
    v_mov_b32 v66, 0
    v_mov_b32 v67, 0
    v_mov_b32 v68, 0
    v_mov_b32 v69, 0
    v_mov_b32 v70, 0
    v_mov_b32 v71, 0
    v_mov_b32 v72, 0
    v_mov_b32 v73, 0
    v_mov_b32 v74, 0
    v_mov_b32 v75, 0
    v_mov_b32 v76, 0
    v_mov_b32 v77, 0
    v_mov_b32 v78, 0
    v_mov_b32 v79, 0
    v_mov_b32 v80, 0
    v_mov_b32 v81, 0
    v_mov_b32 v82, 0
    v_mov_b32 v83, 0
    v_mov_b32 v84, 0
    v_mov_b32 v85, 0
    v_mov_b32 v86, 0
    v_mov_b32 v87, 0
    v_mov_b32 v88, 0
    v_mov_b32 v89, 0
    v_mov_b32 v90, 0
    v_mov_b32 v91, 0
    v_mov_b32 v92, 0
    v_mov_b32 v93, 0
    v_mov_b32 v94, 0
    v_mov_b32 v95, 0
    v_mov_b32 v96, 0
    v_mov_b32 v97, 0
    v_mov_b32 v98, 0
    v_mov_b32 v99, 0
    v_mov_b32 v100, 0
    v_mov_b32 v101, 0
    v_mov_b32 v102, 0
    v_mov_b32 v103, 0
    v_mov_b32 v104, 0
    v_mov_b32 v105, 0
    v_mov_b32 v106, 0
    v_mov_b32 v107, 0
    v_mov_b32 v108, 0
    v_mov_b32 v109, 0
    v_mov_b32 v110, 0
    v_mov_b32 v111, 0
    v_mov_b32 v112, 0
    v_mov_b32 v113, 0
    v_mov_b32 v114, 0
    v_mov_b32 v115, 0
    v_mov_b32 v116, 0
    v_mov_b32 v117, 0
    v_mov_b32 v118, 0
    v_mov_b32 v119, 0
    v_mov_b32 v120, 0
    v_mov_b32 v121, 0
    v_mov_b32 v122, 0
    v_mov_b32 v123, 0
    v_mov_b32 v124, 0
    v_mov_b32 v125, 0
    v_mov_b32 v126, 0
    v_mov_b32 v127, 0
    s_lshr_b32 s55, s41, 3
    s_mul_i32 s55, s55, 28
    s_and_b32 s56, s41, 7
    s_add_u32 s55, s55, s56
    s_lshl_b32 s55, s55, 14
    s_lshl_b32 s56, s43, 13
    s_add_u32 s55, s55, s56
    s_lshl_b32 s56, s44, 10
    s_add_u32 s55, s55, s56
    s_add_u32 s64, s55, s50
    s_barrier
    ds_read_b64_tr_b16 v[160:161], v229 offset:16384
    ds_read_b64_tr_b16 v[162:163], v229 offset:20480
    ds_read_b128 v[128:131], v224 offset:0
    ds_read_b128 v[132:135], v224 offset:2048
    ds_read_b128 v[136:139], v224 offset:4096
    ds_read_b128 v[140:143], v224 offset:6144
    ds_read_b64_tr_b16 v[176:177], v229 offset:24576
    ds_read_b64_tr_b16 v[178:179], v229 offset:28672
    ds_read_b64_tr_b16 v[164:165], v230 offset:16384
    ds_read_b64_tr_b16 v[166:167], v230 offset:20480
    ds_read_b64_tr_b16 v[180:181], v230 offset:24576
    ds_read_b64_tr_b16 v[182:183], v230 offset:28672
    ds_read_b64_tr_b16 v[168:169], v231 offset:16384
    ds_read_b64_tr_b16 v[170:171], v231 offset:20480
    ds_read_b64_tr_b16 v[184:185], v231 offset:24576
    ds_read_b64_tr_b16 v[186:187], v231 offset:28672
    ds_read_b64_tr_b16 v[172:173], v232 offset:16384
    ds_read_b64_tr_b16 v[174:175], v232 offset:20480
    ds_read_b64_tr_b16 v[188:189], v232 offset:24576
    ds_read_b64_tr_b16 v[190:191], v232 offset:28672
    s_mov_b32 s58, 5
    .p2align 3
loop_10:
    s_waitcnt lgkmcnt(0)
    s_barrier
    .p2align 3
    v_mfma_f32_16x16x32_bf16 v[0:3], v[160:163], v[128:131], v[0:3]
    ds_read_b64_tr_b16 v[192:193], v229 offset:32768
    v_mfma_f32_16x16x32_bf16 v[4:7], v[160:163], v[132:135], v[4:7]
    ds_read_b64_tr_b16 v[194:195], v229 offset:36864
    v_mfma_f32_16x16x32_bf16 v[8:11], v[160:163], v[136:139], v[8:11]
    ds_read_b128 v[144:147], v224 offset:1024
    v_mfma_f32_16x16x32_bf16 v[12:15], v[160:163], v[140:143], v[12:15]
    ds_read_b128 v[148:151], v224 offset:3072
    v_mfma_f32_16x16x32_bf16 v[64:67], v[176:179], v[128:131], v[64:67]
    ds_read_b128 v[152:155], v224 offset:5120
    v_mfma_f32_16x16x32_bf16 v[68:71], v[176:179], v[132:135], v[68:71]
    v_mfma_f32_16x16x32_bf16 v[72:75], v[176:179], v[136:139], v[72:75]
    ds_read_b128 v[156:159], v224 offset:7168
    v_mfma_f32_16x16x32_bf16 v[76:79], v[176:179], v[140:143], v[76:79]
    ds_read_b64_tr_b16 v[208:209], v229 offset:40960
    v_mfma_f32_16x16x32_bf16 v[16:19], v[164:167], v[128:131], v[16:19]
    ds_read_b64_tr_b16 v[210:211], v229 offset:45056
    v_mfma_f32_16x16x32_bf16 v[20:23], v[164:167], v[132:135], v[20:23]
    ds_read_b64_tr_b16 v[196:197], v230 offset:32768
    v_mfma_f32_16x16x32_bf16 v[24:27], v[164:167], v[136:139], v[24:27]
    ds_read_b64_tr_b16 v[198:199], v230 offset:36864
    v_mfma_f32_16x16x32_bf16 v[28:31], v[164:167], v[140:143], v[28:31]
    v_mfma_f32_16x16x32_bf16 v[80:83], v[180:183], v[128:131], v[80:83]
    ds_read_b64_tr_b16 v[212:213], v230 offset:40960
    v_mfma_f32_16x16x32_bf16 v[84:87], v[180:183], v[132:135], v[84:87]
    ds_read_b64_tr_b16 v[214:215], v230 offset:45056
    v_mfma_f32_16x16x32_bf16 v[88:91], v[180:183], v[136:139], v[88:91]
    ds_read_b64_tr_b16 v[200:201], v231 offset:32768
    v_mfma_f32_16x16x32_bf16 v[92:95], v[180:183], v[140:143], v[92:95]
    ds_read_b64_tr_b16 v[202:203], v231 offset:36864
    v_mfma_f32_16x16x32_bf16 v[32:35], v[168:171], v[128:131], v[32:35]
    ds_read_b64_tr_b16 v[216:217], v231 offset:40960
    v_mfma_f32_16x16x32_bf16 v[36:39], v[168:171], v[132:135], v[36:39]
    v_mfma_f32_16x16x32_bf16 v[40:43], v[168:171], v[136:139], v[40:43]
    ds_read_b64_tr_b16 v[218:219], v231 offset:45056
    v_mfma_f32_16x16x32_bf16 v[44:47], v[168:171], v[140:143], v[44:47]
    ds_read_b64_tr_b16 v[204:205], v232 offset:32768
    v_mfma_f32_16x16x32_bf16 v[96:99], v[184:187], v[128:131], v[96:99]
    ds_read_b64_tr_b16 v[206:207], v232 offset:36864
    v_mfma_f32_16x16x32_bf16 v[100:103], v[184:187], v[132:135], v[100:103]
    ds_read_b64_tr_b16 v[220:221], v232 offset:40960
    v_mfma_f32_16x16x32_bf16 v[104:107], v[184:187], v[136:139], v[104:107]
    ds_read_b64_tr_b16 v[222:223], v232 offset:45056
    v_mfma_f32_16x16x32_bf16 v[108:111], v[184:187], v[140:143], v[108:111]
    v_mfma_f32_16x16x32_bf16 v[48:51], v[172:175], v[128:131], v[48:51]
    v_mfma_f32_16x16x32_bf16 v[52:55], v[172:175], v[132:135], v[52:55]
    v_mfma_f32_16x16x32_bf16 v[56:59], v[172:175], v[136:139], v[56:59]
    v_mfma_f32_16x16x32_bf16 v[60:63], v[172:175], v[140:143], v[60:63]
    v_mfma_f32_16x16x32_bf16 v[112:115], v[188:191], v[128:131], v[112:115]
    v_mfma_f32_16x16x32_bf16 v[116:119], v[188:191], v[132:135], v[116:119]
    v_mfma_f32_16x16x32_bf16 v[120:123], v[188:191], v[136:139], v[120:123]
    v_mfma_f32_16x16x32_bf16 v[124:127], v[188:191], v[140:143], v[124:127]
    s_waitcnt lgkmcnt(0)
    s_barrier
    .p2align 3
    v_mfma_f32_16x16x32_bf16 v[0:3], v[192:195], v[144:147], v[0:3]
    ds_read_b64_tr_b16 v[160:161], v225 offset:0
    v_mfma_f32_16x16x32_bf16 v[4:7], v[192:195], v[148:151], v[4:7]
    ds_read_b64_tr_b16 v[162:163], v225 offset:4096
    v_mfma_f32_16x16x32_bf16 v[8:11], v[192:195], v[152:155], v[8:11]
    ds_read_b128 v[128:131], v224 offset:16384
    v_mfma_f32_16x16x32_bf16 v[12:15], v[192:195], v[156:159], v[12:15]
    ds_read_b128 v[132:135], v224 offset:18432
    v_mfma_f32_16x16x32_bf16 v[64:67], v[208:211], v[144:147], v[64:67]
    ds_read_b128 v[136:139], v224 offset:20480
    v_mfma_f32_16x16x32_bf16 v[68:71], v[208:211], v[148:151], v[68:71]
    v_mfma_f32_16x16x32_bf16 v[72:75], v[208:211], v[152:155], v[72:75]
    ds_read_b128 v[140:143], v224 offset:22528
    v_mfma_f32_16x16x32_bf16 v[76:79], v[208:211], v[156:159], v[76:79]
    ds_read_b64_tr_b16 v[176:177], v225 offset:8192
    v_mfma_f32_16x16x32_bf16 v[16:19], v[196:199], v[144:147], v[16:19]
    ds_read_b64_tr_b16 v[178:179], v225 offset:12288
    v_mfma_f32_16x16x32_bf16 v[20:23], v[196:199], v[148:151], v[20:23]
    ds_read_b64_tr_b16 v[164:165], v226 offset:0
    v_mfma_f32_16x16x32_bf16 v[24:27], v[196:199], v[152:155], v[24:27]
    ds_read_b64_tr_b16 v[166:167], v226 offset:4096
    v_mfma_f32_16x16x32_bf16 v[28:31], v[196:199], v[156:159], v[28:31]
    v_mfma_f32_16x16x32_bf16 v[80:83], v[212:215], v[144:147], v[80:83]
    ds_read_b64_tr_b16 v[180:181], v226 offset:8192
    v_mfma_f32_16x16x32_bf16 v[84:87], v[212:215], v[148:151], v[84:87]
    ds_read_b64_tr_b16 v[182:183], v226 offset:12288
    v_mfma_f32_16x16x32_bf16 v[88:91], v[212:215], v[152:155], v[88:91]
    ds_read_b64_tr_b16 v[168:169], v227 offset:0
    v_mfma_f32_16x16x32_bf16 v[92:95], v[212:215], v[156:159], v[92:95]
    ds_read_b64_tr_b16 v[170:171], v227 offset:4096
    v_mfma_f32_16x16x32_bf16 v[32:35], v[200:203], v[144:147], v[32:35]
    ds_read_b64_tr_b16 v[184:185], v227 offset:8192
    v_mfma_f32_16x16x32_bf16 v[36:39], v[200:203], v[148:151], v[36:39]
    v_mfma_f32_16x16x32_bf16 v[40:43], v[200:203], v[152:155], v[40:43]
    ds_read_b64_tr_b16 v[186:187], v227 offset:12288
    v_mfma_f32_16x16x32_bf16 v[44:47], v[200:203], v[156:159], v[44:47]
    ds_read_b64_tr_b16 v[172:173], v228 offset:0
    v_mfma_f32_16x16x32_bf16 v[96:99], v[216:219], v[144:147], v[96:99]
    ds_read_b64_tr_b16 v[174:175], v228 offset:4096
    v_mfma_f32_16x16x32_bf16 v[100:103], v[216:219], v[148:151], v[100:103]
    ds_read_b64_tr_b16 v[188:189], v228 offset:8192
    v_mfma_f32_16x16x32_bf16 v[104:107], v[216:219], v[152:155], v[104:107]
    ds_read_b64_tr_b16 v[190:191], v228 offset:12288
    v_mfma_f32_16x16x32_bf16 v[108:111], v[216:219], v[156:159], v[108:111]
    v_mfma_f32_16x16x32_bf16 v[48:51], v[204:207], v[144:147], v[48:51]
    v_mfma_f32_16x16x32_bf16 v[52:55], v[204:207], v[148:151], v[52:55]
    v_mfma_f32_16x16x32_bf16 v[56:59], v[204:207], v[152:155], v[56:59]
    v_mfma_f32_16x16x32_bf16 v[60:63], v[204:207], v[156:159], v[60:63]
    v_mfma_f32_16x16x32_bf16 v[112:115], v[220:223], v[144:147], v[112:115]
    v_mfma_f32_16x16x32_bf16 v[116:119], v[220:223], v[148:151], v[116:119]
    v_mfma_f32_16x16x32_bf16 v[120:123], v[220:223], v[152:155], v[120:123]
    v_mfma_f32_16x16x32_bf16 v[124:127], v[220:223], v[156:159], v[124:127]
    s_waitcnt vmcnt(0) lgkmcnt(0)
    s_barrier
    .p2align 3
    v_mfma_f32_16x16x32_bf16 v[0:3], v[160:163], v[128:131], v[0:3]
    ds_read_b64_tr_b16 v[192:193], v225 offset:16384
    v_mfma_f32_16x16x32_bf16 v[4:7], v[160:163], v[132:135], v[4:7]
    ds_read_b64_tr_b16 v[194:195], v225 offset:20480
    v_mfma_f32_16x16x32_bf16 v[8:11], v[160:163], v[136:139], v[8:11]
    ds_read_b128 v[144:147], v224 offset:17408
    v_mfma_f32_16x16x32_bf16 v[12:15], v[160:163], v[140:143], v[12:15]
    ds_read_b128 v[148:151], v224 offset:19456
    v_mfma_f32_16x16x32_bf16 v[64:67], v[176:179], v[128:131], v[64:67]
    ds_read_b128 v[152:155], v224 offset:21504
    v_mfma_f32_16x16x32_bf16 v[68:71], v[176:179], v[132:135], v[68:71]
    v_mfma_f32_16x16x32_bf16 v[72:75], v[176:179], v[136:139], v[72:75]
    ds_read_b128 v[156:159], v224 offset:23552
    v_mfma_f32_16x16x32_bf16 v[76:79], v[176:179], v[140:143], v[76:79]
    ds_read_b64_tr_b16 v[208:209], v225 offset:24576
    v_mfma_f32_16x16x32_bf16 v[16:19], v[164:167], v[128:131], v[16:19]
    ds_read_b64_tr_b16 v[210:211], v225 offset:28672
    v_mfma_f32_16x16x32_bf16 v[20:23], v[164:167], v[132:135], v[20:23]
    ds_read_b64_tr_b16 v[196:197], v226 offset:16384
    v_mfma_f32_16x16x32_bf16 v[24:27], v[164:167], v[136:139], v[24:27]
    ds_read_b64_tr_b16 v[198:199], v226 offset:20480
    v_mfma_f32_16x16x32_bf16 v[28:31], v[164:167], v[140:143], v[28:31]
    v_mfma_f32_16x16x32_bf16 v[80:83], v[180:183], v[128:131], v[80:83]
    ds_read_b64_tr_b16 v[212:213], v226 offset:24576
    v_mfma_f32_16x16x32_bf16 v[84:87], v[180:183], v[132:135], v[84:87]
    ds_read_b64_tr_b16 v[214:215], v226 offset:28672
    v_mfma_f32_16x16x32_bf16 v[88:91], v[180:183], v[136:139], v[88:91]
    ds_read_b64_tr_b16 v[200:201], v227 offset:16384
    v_mfma_f32_16x16x32_bf16 v[92:95], v[180:183], v[140:143], v[92:95]
    ds_read_b64_tr_b16 v[202:203], v227 offset:20480
    v_mfma_f32_16x16x32_bf16 v[32:35], v[168:171], v[128:131], v[32:35]
    ds_read_b64_tr_b16 v[216:217], v227 offset:24576
    v_mfma_f32_16x16x32_bf16 v[36:39], v[168:171], v[132:135], v[36:39]
    v_mfma_f32_16x16x32_bf16 v[40:43], v[168:171], v[136:139], v[40:43]
    ds_read_b64_tr_b16 v[218:219], v227 offset:28672
    v_mfma_f32_16x16x32_bf16 v[44:47], v[168:171], v[140:143], v[44:47]
    ds_read_b64_tr_b16 v[204:205], v228 offset:16384
    v_mfma_f32_16x16x32_bf16 v[96:99], v[184:187], v[128:131], v[96:99]
    ds_read_b64_tr_b16 v[206:207], v228 offset:20480
    v_mfma_f32_16x16x32_bf16 v[100:103], v[184:187], v[132:135], v[100:103]
    ds_read_b64_tr_b16 v[220:221], v228 offset:24576
    v_mfma_f32_16x16x32_bf16 v[104:107], v[184:187], v[136:139], v[104:107]
    ds_read_b64_tr_b16 v[222:223], v228 offset:28672
    v_mfma_f32_16x16x32_bf16 v[108:111], v[184:187], v[140:143], v[108:111]
    v_mfma_f32_16x16x32_bf16 v[48:51], v[172:175], v[128:131], v[48:51]
    v_mfma_f32_16x16x32_bf16 v[52:55], v[172:175], v[132:135], v[52:55]
    v_mfma_f32_16x16x32_bf16 v[56:59], v[172:175], v[136:139], v[56:59]
    v_mfma_f32_16x16x32_bf16 v[60:63], v[172:175], v[140:143], v[60:63]
    v_mfma_f32_16x16x32_bf16 v[112:115], v[188:191], v[128:131], v[112:115]
    v_mfma_f32_16x16x32_bf16 v[116:119], v[188:191], v[132:135], v[116:119]
    v_mfma_f32_16x16x32_bf16 v[120:123], v[188:191], v[136:139], v[120:123]
    v_mfma_f32_16x16x32_bf16 v[124:127], v[188:191], v[140:143], v[124:127]
    s_waitcnt lgkmcnt(0)
    s_barrier
    .p2align 3
    v_mfma_f32_16x16x32_bf16 v[0:3], v[192:195], v[144:147], v[0:3]
    ds_read_b64_tr_b16 v[160:161], v225 offset:32768
    v_mfma_f32_16x16x32_bf16 v[4:7], v[192:195], v[148:151], v[4:7]
    ds_read_b64_tr_b16 v[162:163], v225 offset:36864
    v_mfma_f32_16x16x32_bf16 v[8:11], v[192:195], v[152:155], v[8:11]
    ds_read_b128 v[128:131], v224 offset:32768
    v_mfma_f32_16x16x32_bf16 v[12:15], v[192:195], v[156:159], v[12:15]
    ds_read_b128 v[132:135], v224 offset:34816
    v_mfma_f32_16x16x32_bf16 v[64:67], v[208:211], v[144:147], v[64:67]
    ds_read_b128 v[136:139], v224 offset:36864
    v_mfma_f32_16x16x32_bf16 v[68:71], v[208:211], v[148:151], v[68:71]
    v_mfma_f32_16x16x32_bf16 v[72:75], v[208:211], v[152:155], v[72:75]
    ds_read_b128 v[140:143], v224 offset:38912
    v_mfma_f32_16x16x32_bf16 v[76:79], v[208:211], v[156:159], v[76:79]
    ds_read_b64_tr_b16 v[176:177], v225 offset:40960
    v_mfma_f32_16x16x32_bf16 v[16:19], v[196:199], v[144:147], v[16:19]
    ds_read_b64_tr_b16 v[178:179], v225 offset:45056
    v_mfma_f32_16x16x32_bf16 v[20:23], v[196:199], v[148:151], v[20:23]
    ds_read_b64_tr_b16 v[164:165], v226 offset:32768
    v_mfma_f32_16x16x32_bf16 v[24:27], v[196:199], v[152:155], v[24:27]
    ds_read_b64_tr_b16 v[166:167], v226 offset:36864
    v_mfma_f32_16x16x32_bf16 v[28:31], v[196:199], v[156:159], v[28:31]
    v_mfma_f32_16x16x32_bf16 v[80:83], v[212:215], v[144:147], v[80:83]
    ds_read_b64_tr_b16 v[180:181], v226 offset:40960
    v_mfma_f32_16x16x32_bf16 v[84:87], v[212:215], v[148:151], v[84:87]
    ds_read_b64_tr_b16 v[182:183], v226 offset:45056
    v_mfma_f32_16x16x32_bf16 v[88:91], v[212:215], v[152:155], v[88:91]
    ds_read_b64_tr_b16 v[168:169], v227 offset:32768
    v_mfma_f32_16x16x32_bf16 v[92:95], v[212:215], v[156:159], v[92:95]
    ds_read_b64_tr_b16 v[170:171], v227 offset:36864
    v_mfma_f32_16x16x32_bf16 v[32:35], v[200:203], v[144:147], v[32:35]
    ds_read_b64_tr_b16 v[184:185], v227 offset:40960
    v_mfma_f32_16x16x32_bf16 v[36:39], v[200:203], v[148:151], v[36:39]
    v_mfma_f32_16x16x32_bf16 v[40:43], v[200:203], v[152:155], v[40:43]
    ds_read_b64_tr_b16 v[186:187], v227 offset:45056
    v_mfma_f32_16x16x32_bf16 v[44:47], v[200:203], v[156:159], v[44:47]
    ds_read_b64_tr_b16 v[172:173], v228 offset:32768
    v_mfma_f32_16x16x32_bf16 v[96:99], v[216:219], v[144:147], v[96:99]
    ds_read_b64_tr_b16 v[174:175], v228 offset:36864
    v_mfma_f32_16x16x32_bf16 v[100:103], v[216:219], v[148:151], v[100:103]
    ds_read_b64_tr_b16 v[188:189], v228 offset:40960
    v_mfma_f32_16x16x32_bf16 v[104:107], v[216:219], v[152:155], v[104:107]
    ds_read_b64_tr_b16 v[190:191], v228 offset:45056
    v_mfma_f32_16x16x32_bf16 v[108:111], v[216:219], v[156:159], v[108:111]
    v_mfma_f32_16x16x32_bf16 v[48:51], v[204:207], v[144:147], v[48:51]
    v_mfma_f32_16x16x32_bf16 v[52:55], v[204:207], v[148:151], v[52:55]
    v_mfma_f32_16x16x32_bf16 v[56:59], v[204:207], v[152:155], v[56:59]
    v_mfma_f32_16x16x32_bf16 v[60:63], v[204:207], v[156:159], v[60:63]
    v_mfma_f32_16x16x32_bf16 v[112:115], v[220:223], v[144:147], v[112:115]
    v_mfma_f32_16x16x32_bf16 v[116:119], v[220:223], v[148:151], v[116:119]
    v_mfma_f32_16x16x32_bf16 v[120:123], v[220:223], v[152:155], v[120:123]
    v_mfma_f32_16x16x32_bf16 v[124:127], v[220:223], v[156:159], v[124:127]
    s_waitcnt lgkmcnt(0)
    s_barrier
    .p2align 3
    v_mfma_f32_16x16x32_bf16 v[0:3], v[160:163], v[128:131], v[0:3]
    ds_read_b64_tr_b16 v[192:193], v229 offset:0
    v_mfma_f32_16x16x32_bf16 v[4:7], v[160:163], v[132:135], v[4:7]
    ds_read_b64_tr_b16 v[194:195], v229 offset:4096
    v_mfma_f32_16x16x32_bf16 v[8:11], v[160:163], v[136:139], v[8:11]
    ds_read_b128 v[144:147], v224 offset:33792
    v_mfma_f32_16x16x32_bf16 v[12:15], v[160:163], v[140:143], v[12:15]
    ds_read_b128 v[148:151], v224 offset:35840
    v_mfma_f32_16x16x32_bf16 v[64:67], v[176:179], v[128:131], v[64:67]
    ds_read_b128 v[152:155], v224 offset:37888
    v_mfma_f32_16x16x32_bf16 v[68:71], v[176:179], v[132:135], v[68:71]
    v_mfma_f32_16x16x32_bf16 v[72:75], v[176:179], v[136:139], v[72:75]
    ds_read_b128 v[156:159], v224 offset:39936
    v_mfma_f32_16x16x32_bf16 v[76:79], v[176:179], v[140:143], v[76:79]
    ds_read_b64_tr_b16 v[208:209], v229 offset:8192
    v_mfma_f32_16x16x32_bf16 v[16:19], v[164:167], v[128:131], v[16:19]
    ds_read_b64_tr_b16 v[210:211], v229 offset:12288
    v_mfma_f32_16x16x32_bf16 v[20:23], v[164:167], v[132:135], v[20:23]
    ds_read_b64_tr_b16 v[196:197], v230 offset:0
    v_mfma_f32_16x16x32_bf16 v[24:27], v[164:167], v[136:139], v[24:27]
    ds_read_b64_tr_b16 v[198:199], v230 offset:4096
    v_mfma_f32_16x16x32_bf16 v[28:31], v[164:167], v[140:143], v[28:31]
    v_mfma_f32_16x16x32_bf16 v[80:83], v[180:183], v[128:131], v[80:83]
    ds_read_b64_tr_b16 v[212:213], v230 offset:8192
    v_mfma_f32_16x16x32_bf16 v[84:87], v[180:183], v[132:135], v[84:87]
    ds_read_b64_tr_b16 v[214:215], v230 offset:12288
    v_mfma_f32_16x16x32_bf16 v[88:91], v[180:183], v[136:139], v[88:91]
    ds_read_b64_tr_b16 v[200:201], v231 offset:0
    v_mfma_f32_16x16x32_bf16 v[92:95], v[180:183], v[140:143], v[92:95]
    ds_read_b64_tr_b16 v[202:203], v231 offset:4096
    v_mfma_f32_16x16x32_bf16 v[32:35], v[168:171], v[128:131], v[32:35]
    ds_read_b64_tr_b16 v[216:217], v231 offset:8192
    v_mfma_f32_16x16x32_bf16 v[36:39], v[168:171], v[132:135], v[36:39]
    v_mfma_f32_16x16x32_bf16 v[40:43], v[168:171], v[136:139], v[40:43]
    ds_read_b64_tr_b16 v[218:219], v231 offset:12288
    v_mfma_f32_16x16x32_bf16 v[44:47], v[168:171], v[140:143], v[44:47]
    ds_read_b64_tr_b16 v[204:205], v232 offset:0
    v_mfma_f32_16x16x32_bf16 v[96:99], v[184:187], v[128:131], v[96:99]
    ds_read_b64_tr_b16 v[206:207], v232 offset:4096
    v_mfma_f32_16x16x32_bf16 v[100:103], v[184:187], v[132:135], v[100:103]
    ds_read_b64_tr_b16 v[220:221], v232 offset:8192
    v_mfma_f32_16x16x32_bf16 v[104:107], v[184:187], v[136:139], v[104:107]
    ds_read_b64_tr_b16 v[222:223], v232 offset:12288
    v_mfma_f32_16x16x32_bf16 v[108:111], v[184:187], v[140:143], v[108:111]
    v_mfma_f32_16x16x32_bf16 v[48:51], v[172:175], v[128:131], v[48:51]
    v_mfma_f32_16x16x32_bf16 v[52:55], v[172:175], v[132:135], v[52:55]
    v_mfma_f32_16x16x32_bf16 v[56:59], v[172:175], v[136:139], v[56:59]
    v_mfma_f32_16x16x32_bf16 v[60:63], v[172:175], v[140:143], v[60:63]
    v_mfma_f32_16x16x32_bf16 v[112:115], v[188:191], v[128:131], v[112:115]
    v_mfma_f32_16x16x32_bf16 v[116:119], v[188:191], v[132:135], v[116:119]
    v_mfma_f32_16x16x32_bf16 v[120:123], v[188:191], v[136:139], v[120:123]
    v_mfma_f32_16x16x32_bf16 v[124:127], v[188:191], v[140:143], v[124:127]
    s_waitcnt lgkmcnt(0)
    s_barrier
    .p2align 3
    v_mfma_f32_16x16x32_bf16 v[0:3], v[192:195], v[144:147], v[0:3]
    ds_read_b64_tr_b16 v[160:161], v229 offset:16384
    v_mfma_f32_16x16x32_bf16 v[4:7], v[192:195], v[148:151], v[4:7]
    ds_read_b64_tr_b16 v[162:163], v229 offset:20480
    v_mfma_f32_16x16x32_bf16 v[8:11], v[192:195], v[152:155], v[8:11]
    ds_read_b128 v[128:131], v224 offset:0
    v_mfma_f32_16x16x32_bf16 v[12:15], v[192:195], v[156:159], v[12:15]
    ds_read_b128 v[132:135], v224 offset:2048
    v_mfma_f32_16x16x32_bf16 v[64:67], v[208:211], v[144:147], v[64:67]
    ds_read_b128 v[136:139], v224 offset:4096
    v_mfma_f32_16x16x32_bf16 v[68:71], v[208:211], v[148:151], v[68:71]
    v_mfma_f32_16x16x32_bf16 v[72:75], v[208:211], v[152:155], v[72:75]
    ds_read_b128 v[140:143], v224 offset:6144
    v_mfma_f32_16x16x32_bf16 v[76:79], v[208:211], v[156:159], v[76:79]
    ds_read_b64_tr_b16 v[176:177], v229 offset:24576
    v_mfma_f32_16x16x32_bf16 v[16:19], v[196:199], v[144:147], v[16:19]
    ds_read_b64_tr_b16 v[178:179], v229 offset:28672
    v_mfma_f32_16x16x32_bf16 v[20:23], v[196:199], v[148:151], v[20:23]
    ds_read_b64_tr_b16 v[164:165], v230 offset:16384
    v_mfma_f32_16x16x32_bf16 v[24:27], v[196:199], v[152:155], v[24:27]
    ds_read_b64_tr_b16 v[166:167], v230 offset:20480
    v_mfma_f32_16x16x32_bf16 v[28:31], v[196:199], v[156:159], v[28:31]
    v_mfma_f32_16x16x32_bf16 v[80:83], v[212:215], v[144:147], v[80:83]
    ds_read_b64_tr_b16 v[180:181], v230 offset:24576
    v_mfma_f32_16x16x32_bf16 v[84:87], v[212:215], v[148:151], v[84:87]
    ds_read_b64_tr_b16 v[182:183], v230 offset:28672
    v_mfma_f32_16x16x32_bf16 v[88:91], v[212:215], v[152:155], v[88:91]
    ds_read_b64_tr_b16 v[168:169], v231 offset:16384
    v_mfma_f32_16x16x32_bf16 v[92:95], v[212:215], v[156:159], v[92:95]
    ds_read_b64_tr_b16 v[170:171], v231 offset:20480
    v_mfma_f32_16x16x32_bf16 v[32:35], v[200:203], v[144:147], v[32:35]
    ds_read_b64_tr_b16 v[184:185], v231 offset:24576
    v_mfma_f32_16x16x32_bf16 v[36:39], v[200:203], v[148:151], v[36:39]
    v_mfma_f32_16x16x32_bf16 v[40:43], v[200:203], v[152:155], v[40:43]
    ds_read_b64_tr_b16 v[186:187], v231 offset:28672
    v_mfma_f32_16x16x32_bf16 v[44:47], v[200:203], v[156:159], v[44:47]
    ds_read_b64_tr_b16 v[172:173], v232 offset:16384
    v_mfma_f32_16x16x32_bf16 v[96:99], v[216:219], v[144:147], v[96:99]
    ds_read_b64_tr_b16 v[174:175], v232 offset:20480
    v_mfma_f32_16x16x32_bf16 v[100:103], v[216:219], v[148:151], v[100:103]
    ds_read_b64_tr_b16 v[188:189], v232 offset:24576
    v_mfma_f32_16x16x32_bf16 v[104:107], v[216:219], v[152:155], v[104:107]
    ds_read_b64_tr_b16 v[190:191], v232 offset:28672
    v_mfma_f32_16x16x32_bf16 v[108:111], v[216:219], v[156:159], v[108:111]
    v_mfma_f32_16x16x32_bf16 v[48:51], v[204:207], v[144:147], v[48:51]
    v_mfma_f32_16x16x32_bf16 v[52:55], v[204:207], v[148:151], v[52:55]
    v_mfma_f32_16x16x32_bf16 v[56:59], v[204:207], v[152:155], v[56:59]
    v_mfma_f32_16x16x32_bf16 v[60:63], v[204:207], v[156:159], v[60:63]
    v_mfma_f32_16x16x32_bf16 v[112:115], v[220:223], v[144:147], v[112:115]
    s_sub_u32 s58, s58, 1
    s_cmp_lg_u32 s58, 0
    .p2align 3
    v_mfma_f32_16x16x32_bf16 v[116:119], v[220:223], v[148:151], v[116:119]
    v_mfma_f32_16x16x32_bf16 v[120:123], v[220:223], v[152:155], v[120:123]
    v_mfma_f32_16x16x32_bf16 v[124:127], v[220:223], v[156:159], v[124:127]
    s_cbranch_scc1 loop_10
    s_waitcnt lgkmcnt(0)
    s_barrier
    .p2align 3
    v_mfma_f32_16x16x32_bf16 v[0:3], v[160:163], v[128:131], v[0:3]
    ds_read_b64_tr_b16 v[192:193], v229 offset:32768
    v_mfma_f32_16x16x32_bf16 v[4:7], v[160:163], v[132:135], v[4:7]
    ds_read_b64_tr_b16 v[194:195], v229 offset:36864
    v_mfma_f32_16x16x32_bf16 v[8:11], v[160:163], v[136:139], v[8:11]
    ds_read_b128 v[144:147], v224 offset:1024
    v_mfma_f32_16x16x32_bf16 v[12:15], v[160:163], v[140:143], v[12:15]
    ds_read_b128 v[148:151], v224 offset:3072
    v_mfma_f32_16x16x32_bf16 v[64:67], v[176:179], v[128:131], v[64:67]
    ds_read_b128 v[152:155], v224 offset:5120
    v_mfma_f32_16x16x32_bf16 v[68:71], v[176:179], v[132:135], v[68:71]
    v_mfma_f32_16x16x32_bf16 v[72:75], v[176:179], v[136:139], v[72:75]
    ds_read_b128 v[156:159], v224 offset:7168
    v_mfma_f32_16x16x32_bf16 v[76:79], v[176:179], v[140:143], v[76:79]
    ds_read_b64_tr_b16 v[208:209], v229 offset:40960
    v_mfma_f32_16x16x32_bf16 v[16:19], v[164:167], v[128:131], v[16:19]
    ds_read_b64_tr_b16 v[210:211], v229 offset:45056
    v_mfma_f32_16x16x32_bf16 v[20:23], v[164:167], v[132:135], v[20:23]
    ds_read_b64_tr_b16 v[196:197], v230 offset:32768
    v_mfma_f32_16x16x32_bf16 v[24:27], v[164:167], v[136:139], v[24:27]
    ds_read_b64_tr_b16 v[198:199], v230 offset:36864
    v_mfma_f32_16x16x32_bf16 v[28:31], v[164:167], v[140:143], v[28:31]
    v_mfma_f32_16x16x32_bf16 v[80:83], v[180:183], v[128:131], v[80:83]
    ds_read_b64_tr_b16 v[212:213], v230 offset:40960
    v_mfma_f32_16x16x32_bf16 v[84:87], v[180:183], v[132:135], v[84:87]
    ds_read_b64_tr_b16 v[214:215], v230 offset:45056
    v_mfma_f32_16x16x32_bf16 v[88:91], v[180:183], v[136:139], v[88:91]
    ds_read_b64_tr_b16 v[200:201], v231 offset:32768
    v_mfma_f32_16x16x32_bf16 v[92:95], v[180:183], v[140:143], v[92:95]
    ds_read_b64_tr_b16 v[202:203], v231 offset:36864
    v_mfma_f32_16x16x32_bf16 v[32:35], v[168:171], v[128:131], v[32:35]
    ds_read_b64_tr_b16 v[216:217], v231 offset:40960
    v_mfma_f32_16x16x32_bf16 v[36:39], v[168:171], v[132:135], v[36:39]
    v_mfma_f32_16x16x32_bf16 v[40:43], v[168:171], v[136:139], v[40:43]
    ds_read_b64_tr_b16 v[218:219], v231 offset:45056
    v_mfma_f32_16x16x32_bf16 v[44:47], v[168:171], v[140:143], v[44:47]
    ds_read_b64_tr_b16 v[204:205], v232 offset:32768
    v_mfma_f32_16x16x32_bf16 v[96:99], v[184:187], v[128:131], v[96:99]
    ds_read_b64_tr_b16 v[206:207], v232 offset:36864
    v_mfma_f32_16x16x32_bf16 v[100:103], v[184:187], v[132:135], v[100:103]
    ds_read_b64_tr_b16 v[220:221], v232 offset:40960
    v_mfma_f32_16x16x32_bf16 v[104:107], v[184:187], v[136:139], v[104:107]
    ds_read_b64_tr_b16 v[222:223], v232 offset:45056
    v_mfma_f32_16x16x32_bf16 v[108:111], v[184:187], v[140:143], v[108:111]
    v_mfma_f32_16x16x32_bf16 v[48:51], v[172:175], v[128:131], v[48:51]
    v_mfma_f32_16x16x32_bf16 v[52:55], v[172:175], v[132:135], v[52:55]
    v_mfma_f32_16x16x32_bf16 v[56:59], v[172:175], v[136:139], v[56:59]
    v_mfma_f32_16x16x32_bf16 v[60:63], v[172:175], v[140:143], v[60:63]
    v_mfma_f32_16x16x32_bf16 v[112:115], v[188:191], v[128:131], v[112:115]
    v_mfma_f32_16x16x32_bf16 v[116:119], v[188:191], v[132:135], v[116:119]
    v_mfma_f32_16x16x32_bf16 v[120:123], v[188:191], v[136:139], v[120:123]
    v_mfma_f32_16x16x32_bf16 v[124:127], v[188:191], v[140:143], v[124:127]
    s_waitcnt lgkmcnt(0)
    s_barrier
    .p2align 3
    v_mfma_f32_16x16x32_bf16 v[0:3], v[192:195], v[144:147], v[0:3]
    v_mfma_f32_16x16x32_bf16 v[4:7], v[192:195], v[148:151], v[4:7]
    v_mfma_f32_16x16x32_bf16 v[8:11], v[192:195], v[152:155], v[8:11]
    v_mfma_f32_16x16x32_bf16 v[12:15], v[192:195], v[156:159], v[12:15]
    v_mfma_f32_16x16x32_bf16 v[64:67], v[208:211], v[144:147], v[64:67]
    v_mfma_f32_16x16x32_bf16 v[68:71], v[208:211], v[148:151], v[68:71]
    v_mfma_f32_16x16x32_bf16 v[72:75], v[208:211], v[152:155], v[72:75]
    v_mfma_f32_16x16x32_bf16 v[76:79], v[208:211], v[156:159], v[76:79]
    v_mfma_f32_16x16x32_bf16 v[16:19], v[196:199], v[144:147], v[16:19]
    v_mfma_f32_16x16x32_bf16 v[20:23], v[196:199], v[148:151], v[20:23]
    v_mfma_f32_16x16x32_bf16 v[24:27], v[196:199], v[152:155], v[24:27]
    v_mfma_f32_16x16x32_bf16 v[28:31], v[196:199], v[156:159], v[28:31]
    v_mfma_f32_16x16x32_bf16 v[80:83], v[212:215], v[144:147], v[80:83]
    v_mfma_f32_16x16x32_bf16 v[84:87], v[212:215], v[148:151], v[84:87]
    v_mfma_f32_16x16x32_bf16 v[88:91], v[212:215], v[152:155], v[88:91]
    v_mfma_f32_16x16x32_bf16 v[92:95], v[212:215], v[156:159], v[92:95]
    v_mfma_f32_16x16x32_bf16 v[32:35], v[200:203], v[144:147], v[32:35]
    v_mfma_f32_16x16x32_bf16 v[36:39], v[200:203], v[148:151], v[36:39]
    v_mfma_f32_16x16x32_bf16 v[40:43], v[200:203], v[152:155], v[40:43]
    v_mfma_f32_16x16x32_bf16 v[44:47], v[200:203], v[156:159], v[44:47]
    v_mfma_f32_16x16x32_bf16 v[96:99], v[216:219], v[144:147], v[96:99]
    v_mfma_f32_16x16x32_bf16 v[100:103], v[216:219], v[148:151], v[100:103]
    v_mfma_f32_16x16x32_bf16 v[104:107], v[216:219], v[152:155], v[104:107]
    v_mfma_f32_16x16x32_bf16 v[108:111], v[216:219], v[156:159], v[108:111]
    v_mfma_f32_16x16x32_bf16 v[48:51], v[204:207], v[144:147], v[48:51]
    v_mfma_f32_16x16x32_bf16 v[52:55], v[204:207], v[148:151], v[52:55]
    v_mfma_f32_16x16x32_bf16 v[56:59], v[204:207], v[152:155], v[56:59]
    v_mfma_f32_16x16x32_bf16 v[60:63], v[204:207], v[156:159], v[60:63]
    v_mfma_f32_16x16x32_bf16 v[112:115], v[220:223], v[144:147], v[112:115]
    v_mfma_f32_16x16x32_bf16 v[116:119], v[220:223], v[148:151], v[116:119]
    v_mfma_f32_16x16x32_bf16 v[120:123], v[220:223], v[152:155], v[120:123]
    v_mfma_f32_16x16x32_bf16 v[124:127], v[220:223], v[156:159], v[124:127]
    s_cmp_ge_u32 s42, 2
    s_cbranch_scc1 X_w
    s_setprio 1
    s_waitcnt lgkmcnt(0)
    s_barrier
    s_nop 7
    s_add_u32 m0, s61, 98304
    s_add_u32 s59, s62, 32768
    buffer_load_dwordx4 v254, s[4:7], s59 offen lds
    s_lshl_b32 s55, s51, 14
    s_lshl_b32 s56, s43, 13
    s_add_u32 s55, s55, s56
    s_lshl_b32 s56, s44, 10
    s_add_u32 s55, s55, s56
    s_add_u32 s55, s55, s49
    buffer_load_dwordx4 v[160:163], v254, s[4:7], s55 offen offset:0
    buffer_load_dwordx4 v[164:167], v254, s[4:7], s55 offen offset:2048
    s_add_u32 s55, s55, 4096
    buffer_load_dwordx4 v[168:171], v254, s[4:7], s55 offen offset:0
    buffer_load_dwordx4 v[172:175], v254, s[4:7], s55 offen offset:2048
    s_lshl_b32 s55, s43, 9
    s_add_u32 s55, s55, 153600
    v_and_b32 v232, 0xf0, v254
    v_lshrrev_b32 v232, 1, v232
    v_add_u32 v232, s55, v232
    buffer_load_dwordx4 v254, s[4:7], s59 offen offset:1024 lds
    ds_read_b64 v[220:221], v232 offset:0
    ds_read_b64 v[222:223], v232 offset:128
    ds_read_b64 v[224:225], v232 offset:256
    buffer_load_dwordx4 v254, s[4:7], s59 offen offset:2048 lds
    ds_read_b64 v[226:227], v232 offset:384
    s_waitcnt lgkmcnt(0)
    v_sub_f32 v192, 0, v220
    buffer_load_dwordx4 v254, s[4:7], s59 offen offset:3072 lds
    v_mul_f32 v196, 0xbfb8aa3b, v221
    v_mul_f32 v200, v221, v221
    v_sub_f32 v193, 0, v222
    s_add_u32 m0, s61, 102400
    s_add_u32 s60, s62, 36864
    buffer_load_dwordx4 v254, s[4:7], s60 offen lds
    v_mul_f32 v197, 0xbfb8aa3b, v223
    v_mul_f32 v201, v223, v223
    buffer_load_dwordx4 v254, s[4:7], s60 offen offset:1024 lds
    v_sub_f32 v194, 0, v224
    v_mul_f32 v198, 0xbfb8aa3b, v225
    v_mul_f32 v202, v225, v225
    buffer_load_dwordx4 v254, s[4:7], s60 offen offset:2048 lds
    v_sub_f32 v195, 0, v226
    v_mul_f32 v199, 0xbfb8aa3b, v227
    v_mul_f32 v203, v227, v227
    buffer_load_dwordx4 v254, s[4:7], s60 offen offset:3072 lds
    v_rcp_f32 v200, v200
    v_rcp_f32 v201, v201
    v_rcp_f32 v202, v202
    s_waitcnt lgkmcnt(0)
    s_barrier
    s_add_u32 m0, s61, 114688
    s_add_u32 s59, s62, 49152
    buffer_load_dwordx4 v254, s[4:7], s59 offen lds
    v_rcp_f32 v203, v203
    s_nop 0
    s_lshl_b32 s55, s44, 8
    s_add_u32 s55, s55, 155520
    v_lshrrev_b32 v235, 8, v254
    v_lshlrev_b32 v235, 4, v235
    v_add_u32 v235, s55, v235
    ds_read_b128 v[204:207], v235 offset:0
    ds_read_b128 v[208:211], v235 offset:512
    ds_read_b128 v[212:215], v235 offset:64
    buffer_load_dwordx4 v254, s[4:7], s59 offen offset:1024 lds
    ds_read_b128 v[216:219], v235 offset:576
    s_waitcnt lgkmcnt(0)
    v_fmac_f32 v0, v192, v204
    v_fmac_f32 v1, v192, v205
    v_fmac_f32 v2, v192, v206
    v_fmac_f32 v3, v192, v207
    buffer_load_dwordx4 v254, s[4:7], s59 offen offset:2048 lds
    v_mul_f32 v220, v196, v0
    v_mul_f32 v221, v196, v1
    v_mul_f32 v222, v196, v2
    v_mul_f32 v223, v196, v3
    v_fmac_f32 v64, v192, v208
    v_fmac_f32 v65, v192, v209
    buffer_load_dwordx4 v254, s[4:7], s59 offen offset:3072 lds
    v_fmac_f32 v66, v192, v210
    v_fmac_f32 v67, v192, v211
    v_exp_f32 v220, v220
    v_exp_f32 v221, v221
    v_exp_f32 v222, v222
    v_exp_f32 v223, v223
    v_mul_f32 v0, v0, v64
    s_waitcnt lgkmcnt(0)
    s_barrier
    s_add_u32 m0, s61, 118784
    s_add_u32 s60, s62, 53248
    buffer_load_dwordx4 v254, s[4:7], s60 offen lds
    v_mul_f32 v1, v1, v65
    v_mul_f32 v2, v2, v66
    v_mul_f32 v3, v3, v67
    v_fma_f32 v220, v220, v200, v200
    v_fma_f32 v221, v221, v200, v200
    v_fma_f32 v222, v222, v200, v200
    buffer_load_dwordx4 v254, s[4:7], s60 offen offset:1024 lds
    v_fma_f32 v223, v223, v200, v200
    v_rcp_f32 v220, v220
    v_rcp_f32 v221, v221
    v_rcp_f32 v222, v222
    v_rcp_f32 v223, v223
    v_mul_f32 v0, v0, v220
    v_mul_f32 v1, v1, v221
    buffer_load_dwordx4 v254, s[4:7], s60 offen offset:2048 lds
    v_mul_f32 v2, v2, v222
    v_mul_f32 v3, v3, v223
    v_cvt_pk_bf16_f32 v224, v0, v1
    v_cvt_pk_bf16_f32 v225, v2, v3
    v_fmac_f32 v16, v192, v212
    v_fmac_f32 v17, v192, v213
    buffer_load_dwordx4 v254, s[4:7], s60 offen offset:3072 lds
    v_fmac_f32 v18, v192, v214
    v_fmac_f32 v19, v192, v215
    v_mul_f32 v220, v196, v16
    v_mul_f32 v221, v196, v17
    v_mul_f32 v222, v196, v18
    v_mul_f32 v223, v196, v19
    v_fmac_f32 v80, v192, v216
    s_waitcnt vmcnt(8) lgkmcnt(0)
    s_barrier
    s_add_u32 m0, s61, 131072
    s_add_u32 s59, s62, 65536
    buffer_load_dwordx4 v254, s[4:7], s59 offen lds
    v_fmac_f32 v81, v192, v217
    v_fmac_f32 v82, v192, v218
    v_fmac_f32 v83, v192, v219
    v_exp_f32 v220, v220
    v_exp_f32 v221, v221
    buffer_load_dwordx4 v254, s[4:7], s59 offen offset:1024 lds
    v_exp_f32 v222, v222
    v_exp_f32 v223, v223
    v_mul_f32 v16, v16, v80
    v_mul_f32 v17, v17, v81
    v_mul_f32 v18, v18, v82
    v_mul_f32 v19, v19, v83
    buffer_load_dwordx4 v254, s[4:7], s59 offen offset:2048 lds
    v_fma_f32 v220, v220, v200, v200
    v_fma_f32 v221, v221, v200, v200
    v_fma_f32 v222, v222, v200, v200
    v_fma_f32 v223, v223, v200, v200
    v_rcp_f32 v220, v220
    buffer_load_dwordx4 v254, s[4:7], s59 offen offset:3072 lds
    v_rcp_f32 v221, v221
    v_rcp_f32 v222, v222
    v_rcp_f32 v223, v223
    v_mul_f32 v16, v16, v220
    v_mul_f32 v17, v17, v221
    v_mul_f32 v18, v18, v222
    s_waitcnt lgkmcnt(0)
    s_barrier
    s_add_u32 m0, s61, 135168
    s_add_u32 s60, s62, 69632
    buffer_load_dwordx4 v254, s[4:7], s60 offen lds
    v_mul_f32 v19, v19, v223
    v_cvt_pk_bf16_f32 v226, v16, v17
    v_cvt_pk_bf16_f32 v227, v18, v19
    s_add_u32 s55, s64, 0
    buffer_store_dwordx4 v[224:227], v254, s[4:7], s55 offen sc0 sc1
    v_fmac_f32 v4, v193, v204
    buffer_load_dwordx4 v254, s[4:7], s60 offen offset:1024 lds
    v_fmac_f32 v5, v193, v205
    v_fmac_f32 v6, v193, v206
    v_fmac_f32 v7, v193, v207
    v_mul_f32 v220, v197, v4
    v_mul_f32 v221, v197, v5
    v_mul_f32 v222, v197, v6
    buffer_load_dwordx4 v254, s[4:7], s60 offen offset:2048 lds
    v_mul_f32 v223, v197, v7
    v_fmac_f32 v68, v193, v208
    v_fmac_f32 v69, v193, v209
    v_fmac_f32 v70, v193, v210
    v_fmac_f32 v71, v193, v211
    v_exp_f32 v220, v220
    buffer_load_dwordx4 v254, s[4:7], s60 offen offset:3072 lds
    v_exp_f32 v221, v221
    v_exp_f32 v222, v222
    v_exp_f32 v223, v223
    v_mul_f32 v4, v4, v68
    v_mul_f32 v5, v5, v69
    v_mul_f32 v6, v6, v70
    s_waitcnt vmcnt(9) lgkmcnt(0)
    s_barrier
    s_add_u32 m0, s61, 98304
    s_add_u32 s59, s62, 81920
    buffer_load_dwordx4 v254, s[4:7], s59 offen lds
    v_mul_f32 v7, v7, v71
    v_fma_f32 v220, v220, v201, v201
    v_fma_f32 v221, v221, v201, v201
    v_fma_f32 v222, v222, v201, v201
    v_fma_f32 v223, v223, v201, v201
    v_rcp_f32 v220, v220
    buffer_load_dwordx4 v254, s[4:7], s59 offen offset:1024 lds
    v_rcp_f32 v221, v221
    v_rcp_f32 v222, v222
    v_rcp_f32 v223, v223
    v_mul_f32 v4, v4, v220
    v_mul_f32 v5, v5, v221
    v_mul_f32 v6, v6, v222
    v_mul_f32 v7, v7, v223
    buffer_load_dwordx4 v254, s[4:7], s59 offen offset:2048 lds
    v_cvt_pk_bf16_f32 v228, v4, v5
    v_cvt_pk_bf16_f32 v229, v6, v7
    v_fmac_f32 v20, v193, v212
    v_fmac_f32 v21, v193, v213
    v_fmac_f32 v22, v193, v214
    v_fmac_f32 v23, v193, v215
    buffer_load_dwordx4 v254, s[4:7], s59 offen offset:3072 lds
    v_mul_f32 v220, v197, v20
    v_mul_f32 v221, v197, v21
    v_mul_f32 v222, v197, v22
    v_mul_f32 v223, v197, v23
    v_fmac_f32 v84, v193, v216
    v_fmac_f32 v85, v193, v217
    v_fmac_f32 v86, v193, v218
    s_waitcnt lgkmcnt(0)
    s_barrier
    s_add_u32 m0, s61, 102400
    s_add_u32 s60, s62, 86016
    buffer_load_dwordx4 v254, s[4:7], s60 offen lds
    v_fmac_f32 v87, v193, v219
    v_exp_f32 v220, v220
    v_exp_f32 v221, v221
    v_exp_f32 v222, v222
    v_exp_f32 v223, v223
    buffer_load_dwordx4 v254, s[4:7], s60 offen offset:1024 lds
    v_mul_f32 v20, v20, v84
    v_mul_f32 v21, v21, v85
    v_mul_f32 v22, v22, v86
    v_mul_f32 v23, v23, v87
    v_fma_f32 v220, v220, v201, v201
    v_fma_f32 v221, v221, v201, v201
    buffer_load_dwordx4 v254, s[4:7], s60 offen offset:2048 lds
    v_fma_f32 v222, v222, v201, v201
    v_fma_f32 v223, v223, v201, v201
    v_rcp_f32 v220, v220
    v_rcp_f32 v221, v221
    v_rcp_f32 v222, v222
    buffer_load_dwordx4 v254, s[4:7], s60 offen offset:3072 lds
    v_rcp_f32 v223, v223
    v_mul_f32 v20, v20, v220
    v_mul_f32 v21, v21, v221
    v_mul_f32 v22, v22, v222
    v_mul_f32 v23, v23, v223
    v_cvt_pk_bf16_f32 v230, v20, v21
    s_waitcnt vmcnt(8) lgkmcnt(0)
    s_barrier
    s_add_u32 m0, s61, 114688
    s_add_u32 s59, s62, 98304
    buffer_load_dwordx4 v254, s[4:7], s59 offen lds
    v_cvt_pk_bf16_f32 v231, v22, v23
    s_add_u32 s55, s64, 2048
    buffer_store_dwordx4 v[228:231], v254, s[4:7], s55 offen sc0 sc1
    v_fmac_f32 v8, v194, v204
    v_fmac_f32 v9, v194, v205
    v_fmac_f32 v10, v194, v206
    buffer_load_dwordx4 v254, s[4:7], s59 offen offset:1024 lds
    v_fmac_f32 v11, v194, v207
    v_mul_f32 v220, v198, v8
    v_mul_f32 v221, v198, v9
    v_mul_f32 v222, v198, v10
    v_mul_f32 v223, v198, v11
    v_fmac_f32 v72, v194, v208
    buffer_load_dwordx4 v254, s[4:7], s59 offen offset:2048 lds
    v_fmac_f32 v73, v194, v209
    v_fmac_f32 v74, v194, v210
    v_fmac_f32 v75, v194, v211
    v_exp_f32 v220, v220
    v_exp_f32 v221, v221
    v_exp_f32 v222, v222
    buffer_load_dwordx4 v254, s[4:7], s59 offen offset:3072 lds
    v_exp_f32 v223, v223
    v_mul_f32 v8, v8, v72
    v_mul_f32 v9, v9, v73
    v_mul_f32 v10, v10, v74
    v_mul_f32 v11, v11, v75
    v_fma_f32 v220, v220, v202, v202
    s_waitcnt lgkmcnt(0)
    s_barrier
    s_add_u32 m0, s61, 118784
    s_add_u32 s60, s62, 102400
    buffer_load_dwordx4 v254, s[4:7], s60 offen lds
    v_fma_f32 v221, v221, v202, v202
    v_fma_f32 v222, v222, v202, v202
    v_fma_f32 v223, v223, v202, v202
    v_rcp_f32 v220, v220
    v_rcp_f32 v221, v221
    v_rcp_f32 v222, v222
    buffer_load_dwordx4 v254, s[4:7], s60 offen offset:1024 lds
    v_rcp_f32 v223, v223
    v_mul_f32 v8, v8, v220
    v_mul_f32 v9, v9, v221
    v_mul_f32 v10, v10, v222
    v_mul_f32 v11, v11, v223
    v_cvt_pk_bf16_f32 v224, v8, v9
    buffer_load_dwordx4 v254, s[4:7], s60 offen offset:2048 lds
    v_cvt_pk_bf16_f32 v225, v10, v11
    v_fmac_f32 v24, v194, v212
    v_fmac_f32 v25, v194, v213
    v_fmac_f32 v26, v194, v214
    v_fmac_f32 v27, v194, v215
    v_mul_f32 v220, v198, v24
    buffer_load_dwordx4 v254, s[4:7], s60 offen offset:3072 lds
    v_mul_f32 v221, v198, v25
    v_mul_f32 v222, v198, v26
    v_mul_f32 v223, v198, v27
    v_fmac_f32 v88, v194, v216
    v_fmac_f32 v89, v194, v217
    v_fmac_f32 v90, v194, v218
    v_fmac_f32 v91, v194, v219
    s_waitcnt vmcnt(9) lgkmcnt(0)
    s_barrier
    s_add_u32 m0, s61, 131072
    s_add_u32 s59, s62, 114688
    buffer_load_dwordx4 v254, s[4:7], s59 offen lds
    v_exp_f32 v220, v220
    v_exp_f32 v221, v221
    v_exp_f32 v222, v222
    v_exp_f32 v223, v223
    v_mul_f32 v24, v24, v88
    buffer_load_dwordx4 v254, s[4:7], s59 offen offset:1024 lds
    v_mul_f32 v25, v25, v89
    v_mul_f32 v26, v26, v90
    v_mul_f32 v27, v27, v91
    v_fma_f32 v220, v220, v202, v202
    v_fma_f32 v221, v221, v202, v202
    v_fma_f32 v222, v222, v202, v202
    buffer_load_dwordx4 v254, s[4:7], s59 offen offset:2048 lds
    v_fma_f32 v223, v223, v202, v202
    v_rcp_f32 v220, v220
    v_rcp_f32 v221, v221
    v_rcp_f32 v222, v222
    v_rcp_f32 v223, v223
    buffer_load_dwordx4 v254, s[4:7], s59 offen offset:3072 lds
    v_mul_f32 v24, v24, v220
    v_mul_f32 v25, v25, v221
    v_mul_f32 v26, v26, v222
    v_mul_f32 v27, v27, v223
    v_cvt_pk_bf16_f32 v226, v24, v25
    v_cvt_pk_bf16_f32 v227, v26, v27
    s_waitcnt lgkmcnt(0)
    s_barrier
    s_add_u32 m0, s61, 135168
    s_add_u32 s60, s62, 118784
    buffer_load_dwordx4 v254, s[4:7], s60 offen lds
    s_add_u32 s55, s64, 4096
    buffer_store_dwordx4 v[224:227], v254, s[4:7], s55 offen sc0 sc1
    v_fmac_f32 v12, v195, v204
    v_fmac_f32 v13, v195, v205
    v_fmac_f32 v14, v195, v206
    v_fmac_f32 v15, v195, v207
    buffer_load_dwordx4 v254, s[4:7], s60 offen offset:1024 lds
    v_mul_f32 v220, v199, v12
    v_mul_f32 v221, v199, v13
    v_mul_f32 v222, v199, v14
    v_mul_f32 v223, v199, v15
    v_fmac_f32 v76, v195, v208
    v_fmac_f32 v77, v195, v209
    buffer_load_dwordx4 v254, s[4:7], s60 offen offset:2048 lds
    v_fmac_f32 v78, v195, v210
    v_fmac_f32 v79, v195, v211
    v_exp_f32 v220, v220
    v_exp_f32 v221, v221
    v_exp_f32 v222, v222
    v_exp_f32 v223, v223
    buffer_load_dwordx4 v254, s[4:7], s60 offen offset:3072 lds
    v_mul_f32 v12, v12, v76
    v_mul_f32 v13, v13, v77
    v_mul_f32 v14, v14, v78
    v_mul_f32 v15, v15, v79
    v_fma_f32 v220, v220, v203, v203
    v_fma_f32 v221, v221, v203, v203
    s_waitcnt vmcnt(9) lgkmcnt(0)
    s_barrier
    s_add_u32 m0, s61, 98304
    s_add_u32 s59, s62, 131072
    buffer_load_dwordx4 v254, s[4:7], s59 offen lds
    v_fma_f32 v222, v222, v203, v203
    v_fma_f32 v223, v223, v203, v203
    v_rcp_f32 v220, v220
    v_rcp_f32 v221, v221
    v_rcp_f32 v222, v222
    v_rcp_f32 v223, v223
    buffer_load_dwordx4 v254, s[4:7], s59 offen offset:1024 lds
    v_mul_f32 v12, v12, v220
    v_mul_f32 v13, v13, v221
    v_mul_f32 v14, v14, v222
    v_mul_f32 v15, v15, v223
    v_cvt_pk_bf16_f32 v228, v12, v13
    v_cvt_pk_bf16_f32 v229, v14, v15
    buffer_load_dwordx4 v254, s[4:7], s59 offen offset:2048 lds
    v_fmac_f32 v28, v195, v212
    v_fmac_f32 v29, v195, v213
    v_fmac_f32 v30, v195, v214
    v_fmac_f32 v31, v195, v215
    v_mul_f32 v220, v199, v28
    v_mul_f32 v221, v199, v29
    buffer_load_dwordx4 v254, s[4:7], s59 offen offset:3072 lds
    v_mul_f32 v222, v199, v30
    v_mul_f32 v223, v199, v31
    v_fmac_f32 v92, v195, v216
    v_fmac_f32 v93, v195, v217
    v_fmac_f32 v94, v195, v218
    v_fmac_f32 v95, v195, v219
    v_exp_f32 v220, v220
    s_waitcnt lgkmcnt(0)
    s_barrier
    s_add_u32 m0, s61, 102400
    s_add_u32 s60, s62, 135168
    buffer_load_dwordx4 v254, s[4:7], s60 offen lds
    v_exp_f32 v221, v221
    v_exp_f32 v222, v222
    v_exp_f32 v223, v223
    v_mul_f32 v28, v28, v92
    v_mul_f32 v29, v29, v93
    buffer_load_dwordx4 v254, s[4:7], s60 offen offset:1024 lds
    v_mul_f32 v30, v30, v94
    v_mul_f32 v31, v31, v95
    v_fma_f32 v220, v220, v203, v203
    v_fma_f32 v221, v221, v203, v203
    v_fma_f32 v222, v222, v203, v203
    buffer_load_dwordx4 v254, s[4:7], s60 offen offset:2048 lds
    v_fma_f32 v223, v223, v203, v203
    v_rcp_f32 v220, v220
    v_rcp_f32 v221, v221
    v_rcp_f32 v222, v222
    v_rcp_f32 v223, v223
    buffer_load_dwordx4 v254, s[4:7], s60 offen offset:3072 lds
    v_mul_f32 v28, v28, v220
    v_mul_f32 v29, v29, v221
    v_mul_f32 v30, v30, v222
    v_mul_f32 v31, v31, v223
    v_cvt_pk_bf16_f32 v230, v28, v29
    v_cvt_pk_bf16_f32 v231, v30, v31
    s_waitcnt vmcnt(8) lgkmcnt(0)
    s_barrier
    s_add_u32 m0, s61, 114688
    s_add_u32 s59, s62, 147456
    buffer_load_dwordx4 v254, s[4:7], s59 offen lds
    s_add_u32 s55, s64, 6144
    buffer_store_dwordx4 v[228:231], v254, s[4:7], s55 offen sc0 sc1
    ds_read_b128 v[204:207], v235 offset:128
    ds_read_b128 v[208:211], v235 offset:640
    ds_read_b128 v[212:215], v235 offset:192
    ds_read_b128 v[216:219], v235 offset:704
    buffer_load_dwordx4 v254, s[4:7], s59 offen offset:1024 lds
    s_waitcnt lgkmcnt(0)
    v_fmac_f32 v32, v192, v204
    v_fmac_f32 v33, v192, v205
    v_fmac_f32 v34, v192, v206
    v_fmac_f32 v35, v192, v207
    buffer_load_dwordx4 v254, s[4:7], s59 offen offset:2048 lds
    v_mul_f32 v220, v196, v32
    v_mul_f32 v221, v196, v33
    v_mul_f32 v222, v196, v34
    v_mul_f32 v223, v196, v35
    v_fmac_f32 v96, v192, v208
    buffer_load_dwordx4 v254, s[4:7], s59 offen offset:3072 lds
    v_fmac_f32 v97, v192, v209
    v_fmac_f32 v98, v192, v210
    v_fmac_f32 v99, v192, v211
    v_exp_f32 v220, v220
    v_exp_f32 v221, v221
    v_exp_f32 v222, v222
    s_waitcnt lgkmcnt(0)
    s_barrier
    s_add_u32 m0, s61, 118784
    s_add_u32 s60, s62, 151552
    buffer_load_dwordx4 v254, s[4:7], s60 offen lds
    v_exp_f32 v223, v223
    v_mul_f32 v32, v32, v96
    v_mul_f32 v33, v33, v97
    v_mul_f32 v34, v34, v98
    v_mul_f32 v35, v35, v99
    v_fma_f32 v220, v220, v200, v200
    buffer_load_dwordx4 v254, s[4:7], s60 offen offset:1024 lds
    v_fma_f32 v221, v221, v200, v200
    v_fma_f32 v222, v222, v200, v200
    v_fma_f32 v223, v223, v200, v200
    v_rcp_f32 v220, v220
    v_rcp_f32 v221, v221
    v_rcp_f32 v222, v222
    buffer_load_dwordx4 v254, s[4:7], s60 offen offset:2048 lds
    v_rcp_f32 v223, v223
    v_mul_f32 v32, v32, v220
    v_mul_f32 v33, v33, v221
    v_mul_f32 v34, v34, v222
    v_mul_f32 v35, v35, v223
    v_cvt_pk_bf16_f32 v224, v32, v33
    buffer_load_dwordx4 v254, s[4:7], s60 offen offset:3072 lds
    v_cvt_pk_bf16_f32 v225, v34, v35
    v_fmac_f32 v48, v192, v212
    v_fmac_f32 v49, v192, v213
    v_fmac_f32 v50, v192, v214
    v_fmac_f32 v51, v192, v215
    v_mul_f32 v220, v196, v48
    v_mul_f32 v221, v196, v49
    s_waitcnt vmcnt(9) lgkmcnt(0)
    s_barrier
    s_add_u32 m0, s61, 131072
    s_add_u32 s59, s62, 163840
    buffer_load_dwordx4 v254, s[4:7], s59 offen lds
    v_mul_f32 v222, v196, v50
    v_mul_f32 v223, v196, v51
    v_fmac_f32 v112, v192, v216
    v_fmac_f32 v113, v192, v217
    v_fmac_f32 v114, v192, v218
    buffer_load_dwordx4 v254, s[4:7], s59 offen offset:1024 lds
    v_fmac_f32 v115, v192, v219
    v_exp_f32 v220, v220
    v_exp_f32 v221, v221
    v_exp_f32 v222, v222
    v_exp_f32 v223, v223
    v_mul_f32 v48, v48, v112
    buffer_load_dwordx4 v254, s[4:7], s59 offen offset:2048 lds
    v_mul_f32 v49, v49, v113
    v_mul_f32 v50, v50, v114
    v_mul_f32 v51, v51, v115
    v_fma_f32 v220, v220, v200, v200
    v_fma_f32 v221, v221, v200, v200
    buffer_load_dwordx4 v254, s[4:7], s59 offen offset:3072 lds
    v_fma_f32 v222, v222, v200, v200
    v_fma_f32 v223, v223, v200, v200
    v_rcp_f32 v220, v220
    v_rcp_f32 v221, v221
    v_rcp_f32 v222, v222
    v_rcp_f32 v223, v223
    s_waitcnt lgkmcnt(0)
    s_barrier
    s_add_u32 m0, s61, 135168
    s_add_u32 s60, s62, 167936
    buffer_load_dwordx4 v254, s[4:7], s60 offen lds
    v_mul_f32 v48, v48, v220
    v_mul_f32 v49, v49, v221
    v_mul_f32 v50, v50, v222
    v_mul_f32 v51, v51, v223
    v_cvt_pk_bf16_f32 v226, v48, v49
    buffer_load_dwordx4 v254, s[4:7], s60 offen offset:1024 lds
    v_cvt_pk_bf16_f32 v227, v50, v51
    s_add_u32 s55, s64, 131072
    buffer_store_dwordx4 v[224:227], v254, s[4:7], s55 offen sc0 sc1
    v_fmac_f32 v36, v193, v204
    v_fmac_f32 v37, v193, v205
    v_fmac_f32 v38, v193, v206
    v_fmac_f32 v39, v193, v207
    buffer_load_dwordx4 v254, s[4:7], s60 offen offset:2048 lds
    v_mul_f32 v220, v197, v36
    v_mul_f32 v221, v197, v37
    v_mul_f32 v222, v197, v38
    v_mul_f32 v223, v197, v39
    v_fmac_f32 v100, v193, v208
    v_fmac_f32 v101, v193, v209
    buffer_load_dwordx4 v254, s[4:7], s60 offen offset:3072 lds
    v_fmac_f32 v102, v193, v210
    v_fmac_f32 v103, v193, v211
    v_exp_f32 v220, v220
    v_exp_f32 v221, v221
    v_exp_f32 v222, v222
    v_exp_f32 v223, v223
    s_waitcnt vmcnt(9) lgkmcnt(0)
    s_barrier
    s_lshl_b32 s55, s41, 2
    s_add_u32 s55, s55, s42
    s_add_u32 s55, s55, s54
    s_add_u32 s55, s55, 4096
    v_mov_b32 v252, 0
    v_mov_b32 v253, 1
    s_mov_b64 exec, 1
    s_cmp_eq_u32 s45, 0
    s_cbranch_scc1 st_11
    buffer_store_byte v253, v252, s[4:7], s55 offen sc0 sc1
    s_branch st_12
st_11:
    buffer_store_byte v253, v252, s[4:7], s55 offen
st_12:
    s_mov_b64 exec, -1
    s_add_u32 m0, s61, 98304
    s_add_u32 s59, s62, 180224
    buffer_load_dwordx4 v254, s[4:7], s59 offen lds
    v_mul_f32 v36, v36, v100
    v_mul_f32 v37, v37, v101
    v_mul_f32 v38, v38, v102
    v_mul_f32 v39, v39, v103
    v_fma_f32 v220, v220, v201, v201
    v_fma_f32 v221, v221, v201, v201
    buffer_load_dwordx4 v254, s[4:7], s59 offen offset:1024 lds
    v_fma_f32 v222, v222, v201, v201
    v_fma_f32 v223, v223, v201, v201
    v_rcp_f32 v220, v220
    v_rcp_f32 v221, v221
    v_rcp_f32 v222, v222
    v_rcp_f32 v223, v223
    v_mul_f32 v36, v36, v220
    buffer_load_dwordx4 v254, s[4:7], s59 offen offset:2048 lds
    v_mul_f32 v37, v37, v221
    v_mul_f32 v38, v38, v222
    v_mul_f32 v39, v39, v223
    v_cvt_pk_bf16_f32 v228, v36, v37
    v_cvt_pk_bf16_f32 v229, v38, v39
    v_fmac_f32 v52, v193, v212
    buffer_load_dwordx4 v254, s[4:7], s59 offen offset:3072 lds
    v_fmac_f32 v53, v193, v213
    v_fmac_f32 v54, v193, v214
    v_fmac_f32 v55, v193, v215
    v_mul_f32 v220, v197, v52
    v_mul_f32 v221, v197, v53
    v_mul_f32 v222, v197, v54
    v_mul_f32 v223, v197, v55
    s_waitcnt lgkmcnt(0)
    s_barrier
    s_add_u32 m0, s61, 102400
    s_add_u32 s60, s62, 184320
    buffer_load_dwordx4 v254, s[4:7], s60 offen lds
    v_fmac_f32 v116, v193, v216
    v_fmac_f32 v117, v193, v217
    v_fmac_f32 v118, v193, v218
    v_fmac_f32 v119, v193, v219
    v_exp_f32 v220, v220
    buffer_load_dwordx4 v254, s[4:7], s60 offen offset:1024 lds
    v_exp_f32 v221, v221
    v_exp_f32 v222, v222
    v_exp_f32 v223, v223
    v_mul_f32 v52, v52, v116
    v_mul_f32 v53, v53, v117
    v_mul_f32 v54, v54, v118
    buffer_load_dwordx4 v254, s[4:7], s60 offen offset:2048 lds
    v_mul_f32 v55, v55, v119
    v_fma_f32 v220, v220, v201, v201
    v_fma_f32 v221, v221, v201, v201
    v_fma_f32 v222, v222, v201, v201
    v_fma_f32 v223, v223, v201, v201
    buffer_load_dwordx4 v254, s[4:7], s60 offen offset:3072 lds
    v_rcp_f32 v220, v220
    v_rcp_f32 v221, v221
    v_rcp_f32 v222, v222
    v_rcp_f32 v223, v223
    v_mul_f32 v52, v52, v220
    v_mul_f32 v53, v53, v221
    s_waitcnt vmcnt(9) lgkmcnt(0)
    s_barrier
    s_add_u32 m0, s61, 114688
    s_add_u32 s59, s62, 196608
    buffer_load_dwordx4 v254, s[4:7], s59 offen lds
    v_mul_f32 v54, v54, v222
    v_mul_f32 v55, v55, v223
    v_cvt_pk_bf16_f32 v230, v52, v53
    v_cvt_pk_bf16_f32 v231, v54, v55
    s_add_u32 s55, s64, 133120
    buffer_store_dwordx4 v[228:231], v254, s[4:7], s55 offen sc0 sc1
    buffer_load_dwordx4 v254, s[4:7], s59 offen offset:1024 lds
    v_fmac_f32 v40, v194, v204
    v_fmac_f32 v41, v194, v205
    v_fmac_f32 v42, v194, v206
    v_fmac_f32 v43, v194, v207
    v_mul_f32 v220, v198, v40
    v_mul_f32 v221, v198, v41
    buffer_load_dwordx4 v254, s[4:7], s59 offen offset:2048 lds
    v_mul_f32 v222, v198, v42
    v_mul_f32 v223, v198, v43
    v_fmac_f32 v104, v194, v208
    v_fmac_f32 v105, v194, v209
    v_fmac_f32 v106, v194, v210
    v_fmac_f32 v107, v194, v211
    buffer_load_dwordx4 v254, s[4:7], s59 offen offset:3072 lds
    v_exp_f32 v220, v220
    v_exp_f32 v221, v221
    v_exp_f32 v222, v222
    v_exp_f32 v223, v223
    v_mul_f32 v40, v40, v104
    v_mul_f32 v41, v41, v105
    s_waitcnt lgkmcnt(0)
    s_barrier
    s_add_u32 m0, s61, 118784
    s_add_u32 s60, s62, 200704
    buffer_load_dwordx4 v254, s[4:7], s60 offen lds
    v_mul_f32 v42, v42, v106
    v_mul_f32 v43, v43, v107
    v_fma_f32 v220, v220, v202, v202
    v_fma_f32 v221, v221, v202, v202
    v_fma_f32 v222, v222, v202, v202
    v_fma_f32 v223, v223, v202, v202
    buffer_load_dwordx4 v254, s[4:7], s60 offen offset:1024 lds
    v_rcp_f32 v220, v220
    v_rcp_f32 v221, v221
    v_rcp_f32 v222, v222
    v_rcp_f32 v223, v223
    v_mul_f32 v40, v40, v220
    v_mul_f32 v41, v41, v221
    v_mul_f32 v42, v42, v222
    buffer_load_dwordx4 v254, s[4:7], s60 offen offset:2048 lds
    v_mul_f32 v43, v43, v223
    v_cvt_pk_bf16_f32 v224, v40, v41
    v_cvt_pk_bf16_f32 v225, v42, v43
    v_fmac_f32 v56, v194, v212
    v_fmac_f32 v57, v194, v213
    v_fmac_f32 v58, v194, v214
    buffer_load_dwordx4 v254, s[4:7], s60 offen offset:3072 lds
    v_fmac_f32 v59, v194, v215
    v_mul_f32 v220, v198, v56
    v_mul_f32 v221, v198, v57
    v_mul_f32 v222, v198, v58
    v_mul_f32 v223, v198, v59
    v_fmac_f32 v120, v194, v216
    v_fmac_f32 v121, v194, v217
    s_waitcnt vmcnt(9) lgkmcnt(0)
    s_barrier
    s_add_u32 m0, s61, 131072
    s_add_u32 s59, s62, 212992
    buffer_load_dwordx4 v254, s[4:7], s59 offen lds
    v_fmac_f32 v122, v194, v218
    v_fmac_f32 v123, v194, v219
    v_exp_f32 v220, v220
    v_exp_f32 v221, v221
    v_exp_f32 v222, v222
    buffer_load_dwordx4 v254, s[4:7], s59 offen offset:1024 lds
    v_exp_f32 v223, v223
    v_mul_f32 v56, v56, v120
    v_mul_f32 v57, v57, v121
    v_mul_f32 v58, v58, v122
    v_mul_f32 v59, v59, v123
    v_fma_f32 v220, v220, v202, v202
    buffer_load_dwordx4 v254, s[4:7], s59 offen offset:2048 lds
    v_fma_f32 v221, v221, v202, v202
    v_fma_f32 v222, v222, v202, v202
    v_fma_f32 v223, v223, v202, v202
    v_rcp_f32 v220, v220
    v_rcp_f32 v221, v221
    buffer_load_dwordx4 v254, s[4:7], s59 offen offset:3072 lds
    v_rcp_f32 v222, v222
    v_rcp_f32 v223, v223
    v_mul_f32 v56, v56, v220
    v_mul_f32 v57, v57, v221
    v_mul_f32 v58, v58, v222
    v_mul_f32 v59, v59, v223
    s_waitcnt lgkmcnt(0)
    s_barrier
    s_add_u32 m0, s61, 135168
    s_add_u32 s60, s62, 217088
    buffer_load_dwordx4 v254, s[4:7], s60 offen lds
    v_cvt_pk_bf16_f32 v226, v56, v57
    v_cvt_pk_bf16_f32 v227, v58, v59
    s_add_u32 s55, s64, 135168
    buffer_store_dwordx4 v[224:227], v254, s[4:7], s55 offen sc0 sc1
    v_fmac_f32 v44, v195, v204
    v_fmac_f32 v45, v195, v205
    buffer_load_dwordx4 v254, s[4:7], s60 offen offset:1024 lds
    v_fmac_f32 v46, v195, v206
    v_fmac_f32 v47, v195, v207
    v_mul_f32 v220, v199, v44
    v_mul_f32 v221, v199, v45
    v_mul_f32 v222, v199, v46
    v_mul_f32 v223, v199, v47
    buffer_load_dwordx4 v254, s[4:7], s60 offen offset:2048 lds
    v_fmac_f32 v108, v195, v208
    v_fmac_f32 v109, v195, v209
    v_fmac_f32 v110, v195, v210
    v_fmac_f32 v111, v195, v211
    v_exp_f32 v220, v220
    v_exp_f32 v221, v221
    buffer_load_dwordx4 v254, s[4:7], s60 offen offset:3072 lds
    v_exp_f32 v222, v222
    v_exp_f32 v223, v223
    v_mul_f32 v44, v44, v108
    v_mul_f32 v45, v45, v109
    v_mul_f32 v46, v46, v110
    v_mul_f32 v47, v47, v111
    s_waitcnt vmcnt(9) lgkmcnt(0)
    s_barrier
    s_add_u32 m0, s61, 98304
    s_add_u32 s59, s62, 229376
    buffer_load_dwordx4 v254, s[4:7], s59 offen lds
    v_fma_f32 v220, v220, v203, v203
    v_fma_f32 v221, v221, v203, v203
    v_fma_f32 v222, v222, v203, v203
    v_fma_f32 v223, v223, v203, v203
    v_rcp_f32 v220, v220
    v_rcp_f32 v221, v221
    buffer_load_dwordx4 v254, s[4:7], s59 offen offset:1024 lds
    v_rcp_f32 v222, v222
    v_rcp_f32 v223, v223
    v_mul_f32 v44, v44, v220
    v_mul_f32 v45, v45, v221
    v_mul_f32 v46, v46, v222
    v_mul_f32 v47, v47, v223
    v_cvt_pk_bf16_f32 v228, v44, v45
    buffer_load_dwordx4 v254, s[4:7], s59 offen offset:2048 lds
    v_cvt_pk_bf16_f32 v229, v46, v47
    v_fmac_f32 v60, v195, v212
    v_fmac_f32 v61, v195, v213
    v_fmac_f32 v62, v195, v214
    v_fmac_f32 v63, v195, v215
    v_mul_f32 v220, v199, v60
    buffer_load_dwordx4 v254, s[4:7], s59 offen offset:3072 lds
    v_mul_f32 v221, v199, v61
    v_mul_f32 v222, v199, v62
    v_mul_f32 v223, v199, v63
    v_fmac_f32 v124, v195, v216
    v_fmac_f32 v125, v195, v217
    v_fmac_f32 v126, v195, v218
    v_fmac_f32 v127, v195, v219
    s_waitcnt lgkmcnt(0)
    s_barrier
    s_add_u32 m0, s61, 102400
    s_add_u32 s60, s62, 233472
    buffer_load_dwordx4 v254, s[4:7], s60 offen lds
    v_exp_f32 v220, v220
    v_exp_f32 v221, v221
    v_exp_f32 v222, v222
    v_exp_f32 v223, v223
    v_mul_f32 v60, v60, v124
    buffer_load_dwordx4 v254, s[4:7], s60 offen offset:1024 lds
    v_mul_f32 v61, v61, v125
    v_mul_f32 v62, v62, v126
    v_mul_f32 v63, v63, v127
    v_fma_f32 v220, v220, v203, v203
    v_fma_f32 v221, v221, v203, v203
    v_fma_f32 v222, v222, v203, v203
    buffer_load_dwordx4 v254, s[4:7], s60 offen offset:2048 lds
    v_fma_f32 v223, v223, v203, v203
    v_rcp_f32 v220, v220
    v_rcp_f32 v221, v221
    v_rcp_f32 v222, v222
    v_rcp_f32 v223, v223
    buffer_load_dwordx4 v254, s[4:7], s60 offen offset:3072 lds
    v_mul_f32 v60, v60, v220
    v_mul_f32 v61, v61, v221
    v_mul_f32 v62, v62, v222
    v_mul_f32 v63, v63, v223
    v_cvt_pk_bf16_f32 v230, v60, v61
    v_cvt_pk_bf16_f32 v231, v62, v63
    s_waitcnt vmcnt(8) lgkmcnt(0)
    s_barrier
    s_and_b32 s66, s51, 1
    s_lshl_b32 s66, s66, 5
    v_lshrrev_b32 v252, 2, v254
    v_min_u32 v252, 28, v252
    s_add_u32 s55, s54, 4096
    s_add_u32 s55, s55, s66
    buffer_load_dword v232, v252, s[4:7], s55 offen sc0 sc1
    s_add_u32 m0, s61, 114688
    s_add_u32 s59, s62, 245760
    buffer_load_dwordx4 v254, s[4:7], s59 offen lds
    buffer_load_dwordx4 v254, s[4:7], s59 offen offset:1024 lds
    buffer_load_dwordx4 v254, s[4:7], s59 offen offset:2048 lds
    buffer_load_dwordx4 v254, s[4:7], s59 offen offset:3072 lds
    s_add_u32 s55, s64, 137216
    buffer_store_dwordx4 v[228:231], v254, s[4:7], s55 offen sc0 sc1
    s_waitcnt lgkmcnt(0)
    s_barrier
    s_add_u32 m0, s61, 118784
    s_add_u32 s60, s62, 249856
    buffer_load_dwordx4 v254, s[4:7], s60 offen lds
    v_lshlrev_b32 v128, 16, v160
    v_and_b32 v129, 0xffff0000, v160
    v_lshlrev_b32 v130, 16, v161
    v_and_b32 v131, 0xffff0000, v161
    v_lshlrev_b32 v144, 16, v162
    v_and_b32 v145, 0xffff0000, v162
    buffer_load_dwordx4 v254, s[4:7], s60 offen offset:1024 lds
    v_lshlrev_b32 v146, 16, v163
    v_and_b32 v147, 0xffff0000, v163
    v_lshlrev_b32 v132, 16, v164
    v_and_b32 v133, 0xffff0000, v164
    v_lshlrev_b32 v134, 16, v165
    v_and_b32 v135, 0xffff0000, v165
    v_lshlrev_b32 v148, 16, v166
    v_and_b32 v149, 0xffff0000, v166
    buffer_load_dwordx4 v254, s[4:7], s60 offen offset:2048 lds
    v_lshlrev_b32 v150, 16, v167
    v_and_b32 v151, 0xffff0000, v167
    v_lshlrev_b32 v136, 16, v168
    v_and_b32 v137, 0xffff0000, v168
    v_lshlrev_b32 v138, 16, v169
    v_and_b32 v139, 0xffff0000, v169
    v_lshlrev_b32 v152, 16, v170
    v_and_b32 v153, 0xffff0000, v170
    buffer_load_dwordx4 v254, s[4:7], s60 offen offset:3072 lds
    v_lshlrev_b32 v154, 16, v171
    v_and_b32 v155, 0xffff0000, v171
    v_lshlrev_b32 v140, 16, v172
    v_and_b32 v141, 0xffff0000, v172
    v_lshlrev_b32 v142, 16, v173
    v_and_b32 v143, 0xffff0000, v173
    v_lshlrev_b32 v156, 16, v174
    v_and_b32 v157, 0xffff0000, v174
    s_waitcnt vmcnt(10) lgkmcnt(0)
    s_barrier
    s_waitcnt vmcnt(9)
    v_cmp_ne_u32 vcc, 0x01010101, v232
    s_cbranch_vccz ap_13
    v_lshrrev_b32 v252, 2, v254
    s_add_u32 s55, s54, 4096
    s_add_u32 s55, s55, s66
    s_mov_b32 s56, 262144
    s_mov_b32 s57, 0x01010101
    s_mov_b64 exec, 0xff
poll_14:
    buffer_load_dword v253, v252, s[4:7], s55 offen sc0 sc1
    s_waitcnt vmcnt(0)
    v_cmp_ne_u32 vcc, s57, v253
    s_cbranch_vccz pd_15
    s_sleep 1
    s_sub_u32 s56, s56, 1
    s_cmp_lg_u32 s56, 0
    s_cbranch_scc1 poll_14
pd_15:
    s_mov_b64 exec, -1
ap_13:
    s_add_u32 m0, s61, 131072
    s_add_u32 s59, s63, 0
    buffer_load_dwordx4 v254, s[4:7], s59 offen lds
    v_lshlrev_b32 v158, 16, v175
    v_and_b32 v159, 0xffff0000, v175
    v_mov_b32 v160, 0
    v_mov_b32 v161, 0
    v_mov_b32 v162, 0
    v_mov_b32 v163, 0
    v_mov_b32 v164, 0
    buffer_load_dwordx4 v254, s[4:7], s59 offen offset:1024 lds
    v_mov_b32 v165, 0
    v_mov_b32 v166, 0
    v_mov_b32 v167, 0
    v_mov_b32 v168, 0
    v_mov_b32 v169, 0
    v_mov_b32 v170, 0
    v_mov_b32 v171, 0
    v_mov_b32 v172, 0
    buffer_load_dwordx4 v254, s[4:7], s59 offen offset:2048 lds
    v_mov_b32 v173, 0
    v_mov_b32 v174, 0
    v_mov_b32 v175, 0
    v_mov_b32 v176, 0
    v_mov_b32 v177, 0
    v_mov_b32 v178, 0
    v_mov_b32 v179, 0
    buffer_load_dwordx4 v254, s[4:7], s59 offen offset:3072 lds
    v_mov_b32 v180, 0
    v_mov_b32 v181, 0
    v_mov_b32 v182, 0
    v_mov_b32 v183, 0
    v_mov_b32 v184, 0
    v_mov_b32 v185, 0
    v_mov_b32 v186, 0
    v_mov_b32 v187, 0
    s_waitcnt lgkmcnt(0)
    s_barrier
    s_add_u32 m0, s61, 135168
    s_add_u32 s60, s63, 4096
    buffer_load_dwordx4 v254, s[4:7], s60 offen lds
    v_mov_b32 v188, 0
    buffer_load_dwordx4 v254, s[4:7], s60 offen offset:1024 lds
    v_mov_b32 v189, 0
    buffer_load_dwordx4 v254, s[4:7], s60 offen offset:2048 lds
    v_mov_b32 v190, 0
    buffer_load_dwordx4 v254, s[4:7], s60 offen offset:3072 lds
    v_mov_b32 v191, 0
    s_waitcnt vmcnt(8) lgkmcnt(0)
    s_barrier
    s_lshl_b32 s55, s41, 2
    s_add_u32 s55, s55, s42
    s_add_u32 s55, s55, s54
    s_add_u32 s55, s55, 4160
    v_mov_b32 v252, 0
    v_mov_b32 v253, 1
    s_mov_b64 exec, 1
    s_cmp_eq_u32 s45, 0
    s_cbranch_scc1 st_16
    buffer_store_byte v253, v252, s[4:7], s55 offen sc0 sc1
    s_branch st_17
st_16:
    buffer_store_byte v253, v252, s[4:7], s55 offen
st_17:
    s_mov_b64 exec, -1
    s_add_u32 m0, s61, 98304
    s_add_u32 s59, s63, 16384
    buffer_load_dwordx4 v254, s[4:7], s59 offen lds
    buffer_load_dwordx4 v254, s[4:7], s59 offen offset:1024 lds
    buffer_load_dwordx4 v254, s[4:7], s59 offen offset:2048 lds
    buffer_load_dwordx4 v254, s[4:7], s59 offen offset:3072 lds
    s_waitcnt lgkmcnt(0)
    s_barrier
    s_add_u32 m0, s61, 102400
    s_add_u32 s60, s63, 20480
    buffer_load_dwordx4 v254, s[4:7], s60 offen lds
    buffer_load_dwordx4 v254, s[4:7], s60 offen offset:1024 lds
    buffer_load_dwordx4 v254, s[4:7], s60 offen offset:2048 lds
    buffer_load_dwordx4 v254, s[4:7], s60 offen offset:3072 lds
    s_waitcnt vmcnt(9) lgkmcnt(0)
    s_barrier
    s_waitcnt vmcnt(0)
    s_setprio 0
    s_branch X_g4
X_w:
    s_setprio 1
    s_waitcnt lgkmcnt(0)
    s_barrier
    s_nop 7
    s_add_u32 m0, s61, 0
    s_add_u32 s59, s63, 1376256
    buffer_load_dwordx4 v236, s[16:19], s59 offen lds
    s_lshl_b32 s55, s51, 14
    s_lshl_b32 s56, s43, 13
    s_add_u32 s55, s55, s56
    s_lshl_b32 s56, s44, 10
    s_add_u32 s55, s55, s56
    s_add_u32 s55, s55, s49
    buffer_load_dwordx4 v[160:163], v254, s[4:7], s55 offen offset:0
    buffer_load_dwordx4 v[164:167], v254, s[4:7], s55 offen offset:2048
    s_add_u32 s55, s55, 4096
    buffer_load_dwordx4 v[168:171], v254, s[4:7], s55 offen offset:0
    buffer_load_dwordx4 v[172:175], v254, s[4:7], s55 offen offset:2048
    s_lshl_b32 s55, s43, 9
    s_add_u32 s55, s55, 153600
    v_and_b32 v232, 0xf0, v254
    v_lshrrev_b32 v232, 1, v232
    v_add_u32 v232, s55, v232
    ds_read_b64 v[220:221], v232 offset:0
    buffer_load_dwordx4 v237, s[16:19], s59 offen offset:1024 lds
    ds_read_b64 v[222:223], v232 offset:128
    ds_read_b64 v[224:225], v232 offset:256
    ds_read_b64 v[226:227], v232 offset:384
    buffer_load_dwordx4 v238, s[16:19], s59 offen offset:2048 lds
    s_waitcnt lgkmcnt(0)
    v_sub_f32 v192, 0, v220
    v_mul_f32 v196, 0xbfb8aa3b, v221
    v_mul_f32 v200, v221, v221
    s_add_u32 m0, s61, 3072
    s_add_u32 s60, s63, 1490944
    buffer_load_dwordx4 v236, s[16:19], s60 offen lds
    v_sub_f32 v193, 0, v222
    v_mul_f32 v197, 0xbfb8aa3b, v223
    v_mul_f32 v201, v223, v223
    buffer_load_dwordx4 v237, s[16:19], s60 offen offset:1024 lds
    v_sub_f32 v194, 0, v224
    v_mul_f32 v198, 0xbfb8aa3b, v225
    v_mul_f32 v202, v225, v225
    buffer_load_dwordx4 v238, s[16:19], s60 offen offset:2048 lds
    v_sub_f32 v195, 0, v226
    v_mul_f32 v199, 0xbfb8aa3b, v227
    v_mul_f32 v203, v227, v227
    v_rcp_f32 v200, v200
    s_waitcnt lgkmcnt(0)
    s_barrier
    s_add_u32 m0, s61, 16384
    s_add_u32 s59, s63, 1605632
    buffer_load_dwordx4 v236, s[16:19], s59 offen lds
    v_rcp_f32 v201, v201
    v_rcp_f32 v202, v202
    v_rcp_f32 v203, v203
    buffer_load_dwordx4 v237, s[16:19], s59 offen offset:1024 lds
    s_nop 0
    s_lshl_b32 s55, s44, 8
    s_add_u32 s55, s55, 155520
    v_lshrrev_b32 v235, 8, v254
    v_lshlrev_b32 v235, 4, v235
    v_add_u32 v235, s55, v235
    ds_read_b128 v[204:207], v235 offset:0
    ds_read_b128 v[208:211], v235 offset:512
    buffer_load_dwordx4 v238, s[16:19], s59 offen offset:2048 lds
    ds_read_b128 v[212:215], v235 offset:64
    ds_read_b128 v[216:219], v235 offset:576
    s_waitcnt lgkmcnt(0)
    v_fmac_f32 v0, v192, v204
    s_add_u32 m0, s61, 19456
    s_add_u32 s60, s63, 1720320
    buffer_load_dwordx4 v236, s[16:19], s60 offen lds
    v_fmac_f32 v1, v192, v205
    v_fmac_f32 v2, v192, v206
    v_fmac_f32 v3, v192, v207
    buffer_load_dwordx4 v237, s[16:19], s60 offen offset:1024 lds
    v_mul_f32 v220, v196, v0
    v_mul_f32 v221, v196, v1
    v_mul_f32 v222, v196, v2
    v_mul_f32 v223, v196, v3
    buffer_load_dwordx4 v238, s[16:19], s60 offen offset:2048 lds
    v_fmac_f32 v64, v192, v208
    v_fmac_f32 v65, v192, v209
    v_fmac_f32 v66, v192, v210
    v_fmac_f32 v67, v192, v211
    s_waitcnt lgkmcnt(0)
    s_barrier
    s_add_u32 m0, s61, 32768
    s_add_u32 s59, s63, 1835008
    buffer_load_dwordx4 v236, s[16:19], s59 offen lds
    v_exp_f32 v220, v220
    v_exp_f32 v221, v221
    v_exp_f32 v222, v222
    buffer_load_dwordx4 v237, s[16:19], s59 offen offset:1024 lds
    v_exp_f32 v223, v223
    v_mul_f32 v0, v0, v64
    v_mul_f32 v1, v1, v65
    buffer_load_dwordx4 v238, s[16:19], s59 offen offset:2048 lds
    v_mul_f32 v2, v2, v66
    v_mul_f32 v3, v3, v67
    v_fma_f32 v220, v220, v200, v200
    s_add_u32 m0, s61, 35840
    s_add_u32 s60, s63, 1949696
    buffer_load_dwordx4 v236, s[16:19], s60 offen lds
    v_fma_f32 v221, v221, v200, v200
    v_fma_f32 v222, v222, v200, v200
    v_fma_f32 v223, v223, v200, v200
    buffer_load_dwordx4 v237, s[16:19], s60 offen offset:1024 lds
    v_rcp_f32 v220, v220
    v_rcp_f32 v221, v221
    v_rcp_f32 v222, v222
    buffer_load_dwordx4 v238, s[16:19], s60 offen offset:2048 lds
    v_rcp_f32 v223, v223
    v_mul_f32 v0, v0, v220
    v_mul_f32 v1, v1, v221
    s_waitcnt lgkmcnt(0)
    s_barrier
    s_add_u32 m0, s61, 49152
    s_add_u32 s59, s63, 2064384
    buffer_load_dwordx4 v236, s[16:19], s59 offen lds
    v_mul_f32 v2, v2, v222
    v_mul_f32 v3, v3, v223
    v_cvt_pk_bf16_f32 v224, v0, v1
    buffer_load_dwordx4 v237, s[16:19], s59 offen offset:1024 lds
    v_cvt_pk_bf16_f32 v225, v2, v3
    v_fmac_f32 v16, v192, v212
    v_fmac_f32 v17, v192, v213
    v_fmac_f32 v18, v192, v214
    buffer_load_dwordx4 v238, s[16:19], s59 offen offset:2048 lds
    v_fmac_f32 v19, v192, v215
    v_mul_f32 v220, v196, v16
    v_mul_f32 v221, v196, v17
    v_mul_f32 v222, v196, v18
    s_add_u32 m0, s61, 52224
    s_add_u32 s60, s63, 2179072
    buffer_load_dwordx4 v236, s[16:19], s60 offen lds
    v_mul_f32 v223, v196, v19
    v_fmac_f32 v80, v192, v216
    v_fmac_f32 v81, v192, v217
    buffer_load_dwordx4 v237, s[16:19], s60 offen offset:1024 lds
    v_fmac_f32 v82, v192, v218
    v_fmac_f32 v83, v192, v219
    v_exp_f32 v220, v220
    v_exp_f32 v221, v221
    buffer_load_dwordx4 v238, s[16:19], s60 offen offset:2048 lds
    v_exp_f32 v222, v222
    v_exp_f32 v223, v223
    v_mul_f32 v16, v16, v80
    v_mul_f32 v17, v17, v81
    s_waitcnt lgkmcnt(0)
    s_barrier
    s_add_u32 m0, s61, 65536
    s_add_u32 s59, s63, 2293760
    buffer_load_dwordx4 v236, s[16:19], s59 offen lds
    v_mul_f32 v18, v18, v82
    v_mul_f32 v19, v19, v83
    v_fma_f32 v220, v220, v200, v200
    buffer_load_dwordx4 v237, s[16:19], s59 offen offset:1024 lds
    v_fma_f32 v221, v221, v200, v200
    v_fma_f32 v222, v222, v200, v200
    v_fma_f32 v223, v223, v200, v200
    buffer_load_dwordx4 v238, s[16:19], s59 offen offset:2048 lds
    v_rcp_f32 v220, v220
    v_rcp_f32 v221, v221
    v_rcp_f32 v222, v222
    s_add_u32 m0, s61, 68608
    s_add_u32 s60, s63, 2408448
    buffer_load_dwordx4 v236, s[16:19], s60 offen lds
    v_rcp_f32 v223, v223
    v_mul_f32 v16, v16, v220
    v_mul_f32 v17, v17, v221
    buffer_load_dwordx4 v237, s[16:19], s60 offen offset:1024 lds
    v_mul_f32 v18, v18, v222
    v_mul_f32 v19, v19, v223
    v_cvt_pk_bf16_f32 v226, v16, v17
    buffer_load_dwordx4 v238, s[16:19], s60 offen offset:2048 lds
    v_cvt_pk_bf16_f32 v227, v18, v19
    s_add_u32 s55, s64, 0
    buffer_store_dwordx4 v[224:227], v254, s[4:7], s55 offen sc0 sc1
    v_fmac_f32 v4, v193, v204
    v_fmac_f32 v5, v193, v205
    s_waitcnt vmcnt(25) lgkmcnt(0)
    s_barrier
    s_add_u32 m0, s61, 81920
    s_add_u32 s59, s63, 2523136
    buffer_load_dwordx4 v236, s[16:19], s59 offen lds
    v_fmac_f32 v6, v193, v206
    v_fmac_f32 v7, v193, v207
    v_mul_f32 v220, v197, v4
    buffer_load_dwordx4 v237, s[16:19], s59 offen offset:1024 lds
    v_mul_f32 v221, v197, v5
    v_mul_f32 v222, v197, v6
    v_mul_f32 v223, v197, v7
    v_fmac_f32 v68, v193, v208
    buffer_load_dwordx4 v238, s[16:19], s59 offen offset:2048 lds
    v_fmac_f32 v69, v193, v209
    v_fmac_f32 v70, v193, v210
    v_fmac_f32 v71, v193, v211
    v_exp_f32 v220, v220
    s_add_u32 m0, s61, 84992
    s_add_u32 s60, s63, 2637824
    buffer_load_dwordx4 v236, s[16:19], s60 offen lds
    v_exp_f32 v221, v221
    v_exp_f32 v222, v222
    v_exp_f32 v223, v223
    buffer_load_dwordx4 v237, s[16:19], s60 offen offset:1024 lds
    v_mul_f32 v4, v4, v68
    v_mul_f32 v5, v5, v69
    v_mul_f32 v6, v6, v70
    v_mul_f32 v7, v7, v71
    buffer_load_dwordx4 v238, s[16:19], s60 offen offset:2048 lds
    v_fma_f32 v220, v220, v201, v201
    v_fma_f32 v221, v221, v201, v201
    v_fma_f32 v222, v222, v201, v201
    v_fma_f32 v223, v223, v201, v201
    s_waitcnt vmcnt(25) lgkmcnt(0)
    s_barrier
    s_add_u32 m0, s61, 0
    s_add_u32 s59, s63, 2752512
    buffer_load_dwordx4 v236, s[16:19], s59 offen lds
    v_rcp_f32 v220, v220
    v_rcp_f32 v221, v221
    v_rcp_f32 v222, v222
    buffer_load_dwordx4 v237, s[16:19], s59 offen offset:1024 lds
    v_rcp_f32 v223, v223
    v_mul_f32 v4, v4, v220
    v_mul_f32 v5, v5, v221
    v_mul_f32 v6, v6, v222
    buffer_load_dwordx4 v238, s[16:19], s59 offen offset:2048 lds
    v_mul_f32 v7, v7, v223
    v_cvt_pk_bf16_f32 v228, v4, v5
    v_cvt_pk_bf16_f32 v229, v6, v7
    v_fmac_f32 v20, v193, v212
    s_add_u32 m0, s61, 3072
    s_add_u32 s60, s63, 2867200
    buffer_load_dwordx4 v236, s[16:19], s60 offen lds
    v_fmac_f32 v21, v193, v213
    v_fmac_f32 v22, v193, v214
    v_fmac_f32 v23, v193, v215
    buffer_load_dwordx4 v237, s[16:19], s60 offen offset:1024 lds
    v_mul_f32 v220, v197, v20
    v_mul_f32 v221, v197, v21
    v_mul_f32 v222, v197, v22
    v_mul_f32 v223, v197, v23
    buffer_load_dwordx4 v238, s[16:19], s60 offen offset:2048 lds
    v_fmac_f32 v84, v193, v216
    v_fmac_f32 v85, v193, v217
    v_fmac_f32 v86, v193, v218
    v_fmac_f32 v87, v193, v219
    s_waitcnt vmcnt(25) lgkmcnt(0)
    s_barrier
    s_add_u32 m0, s61, 16384
    s_add_u32 s59, s63, 2981888
    buffer_load_dwordx4 v236, s[16:19], s59 offen lds
    v_exp_f32 v220, v220
    v_exp_f32 v221, v221
    v_exp_f32 v222, v222
    buffer_load_dwordx4 v237, s[16:19], s59 offen offset:1024 lds
    v_exp_f32 v223, v223
    v_mul_f32 v20, v20, v84
    v_mul_f32 v21, v21, v85
    buffer_load_dwordx4 v238, s[16:19], s59 offen offset:2048 lds
    v_mul_f32 v22, v22, v86
    v_mul_f32 v23, v23, v87
    v_fma_f32 v220, v220, v201, v201
    s_add_u32 m0, s61, 19456
    s_add_u32 s60, s63, 3096576
    buffer_load_dwordx4 v236, s[16:19], s60 offen lds
    v_fma_f32 v221, v221, v201, v201
    v_fma_f32 v222, v222, v201, v201
    v_fma_f32 v223, v223, v201, v201
    buffer_load_dwordx4 v237, s[16:19], s60 offen offset:1024 lds
    v_rcp_f32 v220, v220
    v_rcp_f32 v221, v221
    v_rcp_f32 v222, v222
    buffer_load_dwordx4 v238, s[16:19], s60 offen offset:2048 lds
    v_rcp_f32 v223, v223
    v_mul_f32 v20, v20, v220
    v_mul_f32 v21, v21, v221
    s_waitcnt vmcnt(25) lgkmcnt(0)
    s_barrier
    s_add_u32 m0, s61, 32768
    s_add_u32 s59, s63, 3211264
    buffer_load_dwordx4 v236, s[16:19], s59 offen lds
    v_mul_f32 v22, v22, v222
    v_mul_f32 v23, v23, v223
    v_cvt_pk_bf16_f32 v230, v20, v21
    buffer_load_dwordx4 v237, s[16:19], s59 offen offset:1024 lds
    v_cvt_pk_bf16_f32 v231, v22, v23
    s_add_u32 s55, s64, 2048
    buffer_store_dwordx4 v[228:231], v254, s[4:7], s55 offen sc0 sc1
    v_fmac_f32 v8, v194, v204
    buffer_load_dwordx4 v238, s[16:19], s59 offen offset:2048 lds
    v_fmac_f32 v9, v194, v205
    v_fmac_f32 v10, v194, v206
    v_fmac_f32 v11, v194, v207
    v_mul_f32 v220, v198, v8
    s_add_u32 m0, s61, 35840
    s_add_u32 s60, s63, 3325952
    buffer_load_dwordx4 v236, s[16:19], s60 offen lds
    v_mul_f32 v221, v198, v9
    v_mul_f32 v222, v198, v10
    v_mul_f32 v223, v198, v11
    buffer_load_dwordx4 v237, s[16:19], s60 offen offset:1024 lds
    v_fmac_f32 v72, v194, v208
    v_fmac_f32 v73, v194, v209
    v_fmac_f32 v74, v194, v210
    buffer_load_dwordx4 v238, s[16:19], s60 offen offset:2048 lds
    v_fmac_f32 v75, v194, v211
    v_exp_f32 v220, v220
    v_exp_f32 v221, v221
    v_exp_f32 v222, v222
    s_waitcnt vmcnt(26) lgkmcnt(0)
    s_barrier
    s_add_u32 m0, s61, 49152
    s_add_u32 s59, s63, 3440640
    buffer_load_dwordx4 v236, s[16:19], s59 offen lds
    v_exp_f32 v223, v223
    v_mul_f32 v8, v8, v72
    v_mul_f32 v9, v9, v73
    buffer_load_dwordx4 v237, s[16:19], s59 offen offset:1024 lds
    v_mul_f32 v10, v10, v74
    v_mul_f32 v11, v11, v75
    v_fma_f32 v220, v220, v202, v202
    v_fma_f32 v221, v221, v202, v202
    buffer_load_dwordx4 v238, s[16:19], s59 offen offset:2048 lds
    v_fma_f32 v222, v222, v202, v202
    v_fma_f32 v223, v223, v202, v202
    v_rcp_f32 v220, v220
    s_add_u32 m0, s61, 52224
    s_add_u32 s60, s63, 3555328
    buffer_load_dwordx4 v236, s[16:19], s60 offen lds
    v_rcp_f32 v221, v221
    v_rcp_f32 v222, v222
    v_rcp_f32 v223, v223
    v_mul_f32 v8, v8, v220
    buffer_load_dwordx4 v237, s[16:19], s60 offen offset:1024 lds
    v_mul_f32 v9, v9, v221
    v_mul_f32 v10, v10, v222
    v_mul_f32 v11, v11, v223
    buffer_load_dwordx4 v238, s[16:19], s60 offen offset:2048 lds
    v_cvt_pk_bf16_f32 v224, v8, v9
    v_cvt_pk_bf16_f32 v225, v10, v11
    v_fmac_f32 v24, v194, v212
    v_fmac_f32 v25, v194, v213
    s_waitcnt vmcnt(25) lgkmcnt(0)
    s_barrier
    s_add_u32 m0, s61, 65536
    s_add_u32 s59, s63, 3670016
    buffer_load_dwordx4 v236, s[16:19], s59 offen lds
    v_fmac_f32 v26, v194, v214
    v_fmac_f32 v27, v194, v215
    v_mul_f32 v220, v198, v24
    buffer_load_dwordx4 v237, s[16:19], s59 offen offset:1024 lds
    v_mul_f32 v221, v198, v25
    v_mul_f32 v222, v198, v26
    v_mul_f32 v223, v198, v27
    v_fmac_f32 v88, v194, v216
    buffer_load_dwordx4 v238, s[16:19], s59 offen offset:2048 lds
    v_fmac_f32 v89, v194, v217
    v_fmac_f32 v90, v194, v218
    v_fmac_f32 v91, v194, v219
    v_exp_f32 v220, v220
    s_add_u32 m0, s61, 68608
    s_add_u32 s60, s63, 3784704
    buffer_load_dwordx4 v236, s[16:19], s60 offen lds
    v_exp_f32 v221, v221
    v_exp_f32 v222, v222
    v_exp_f32 v223, v223
    buffer_load_dwordx4 v237, s[16:19], s60 offen offset:1024 lds
    v_mul_f32 v24, v24, v88
    v_mul_f32 v25, v25, v89
    v_mul_f32 v26, v26, v90
    v_mul_f32 v27, v27, v91
    buffer_load_dwordx4 v238, s[16:19], s60 offen offset:2048 lds
    v_fma_f32 v220, v220, v202, v202
    v_fma_f32 v221, v221, v202, v202
    v_fma_f32 v222, v222, v202, v202
    v_fma_f32 v223, v223, v202, v202
    s_waitcnt vmcnt(25) lgkmcnt(0)
    s_barrier
    s_add_u32 m0, s61, 81920
    s_add_u32 s59, s63, 3899392
    buffer_load_dwordx4 v236, s[16:19], s59 offen lds
    v_rcp_f32 v220, v220
    v_rcp_f32 v221, v221
    v_rcp_f32 v222, v222
    buffer_load_dwordx4 v237, s[16:19], s59 offen offset:1024 lds
    v_rcp_f32 v223, v223
    v_mul_f32 v24, v24, v220
    v_mul_f32 v25, v25, v221
    buffer_load_dwordx4 v238, s[16:19], s59 offen offset:2048 lds
    v_mul_f32 v26, v26, v222
    v_mul_f32 v27, v27, v223
    v_cvt_pk_bf16_f32 v226, v24, v25
    s_add_u32 m0, s61, 84992
    s_add_u32 s60, s63, 4014080
    buffer_load_dwordx4 v236, s[16:19], s60 offen lds
    v_cvt_pk_bf16_f32 v227, v26, v27
    s_add_u32 s55, s64, 4096
    buffer_store_dwordx4 v[224:227], v254, s[4:7], s55 offen sc0 sc1
    v_fmac_f32 v12, v195, v204
    buffer_load_dwordx4 v237, s[16:19], s60 offen offset:1024 lds
    v_fmac_f32 v13, v195, v205
    v_fmac_f32 v14, v195, v206
    v_fmac_f32 v15, v195, v207
    buffer_load_dwordx4 v238, s[16:19], s60 offen offset:2048 lds
    v_mul_f32 v220, v199, v12
    v_mul_f32 v221, v199, v13
    v_mul_f32 v222, v199, v14
    v_mul_f32 v223, v199, v15
    s_waitcnt vmcnt(26) lgkmcnt(0)
    s_barrier
    s_add_u32 m0, s61, 0
    s_add_u32 s59, s63, 4128768
    buffer_load_dwordx4 v236, s[16:19], s59 offen lds
    v_fmac_f32 v76, v195, v208
    v_fmac_f32 v77, v195, v209
    v_fmac_f32 v78, v195, v210
    buffer_load_dwordx4 v237, s[16:19], s59 offen offset:1024 lds
    v_fmac_f32 v79, v195, v211
    v_exp_f32 v220, v220
    v_exp_f32 v221, v221
    buffer_load_dwordx4 v238, s[16:19], s59 offen offset:2048 lds
    v_exp_f32 v222, v222
    v_exp_f32 v223, v223
    v_mul_f32 v12, v12, v76
    s_add_u32 m0, s61, 3072
    s_add_u32 s60, s63, 4243456
    buffer_load_dwordx4 v236, s[16:19], s60 offen lds
    v_mul_f32 v13, v13, v77
    v_mul_f32 v14, v14, v78
    v_mul_f32 v15, v15, v79
    buffer_load_dwordx4 v237, s[16:19], s60 offen offset:1024 lds
    v_fma_f32 v220, v220, v203, v203
    v_fma_f32 v221, v221, v203, v203
    v_fma_f32 v222, v222, v203, v203
    buffer_load_dwordx4 v238, s[16:19], s60 offen offset:2048 lds
    v_fma_f32 v223, v223, v203, v203
    v_rcp_f32 v220, v220
    v_rcp_f32 v221, v221
    v_rcp_f32 v222, v222
    s_waitcnt vmcnt(25) lgkmcnt(0)
    s_barrier
    s_add_u32 m0, s61, 16384
    s_add_u32 s59, s63, 4358144
    buffer_load_dwordx4 v236, s[16:19], s59 offen lds
    v_rcp_f32 v223, v223
    v_mul_f32 v12, v12, v220
    v_mul_f32 v13, v13, v221
    buffer_load_dwordx4 v237, s[16:19], s59 offen offset:1024 lds
    v_mul_f32 v14, v14, v222
    v_mul_f32 v15, v15, v223
    v_cvt_pk_bf16_f32 v228, v12, v13
    v_cvt_pk_bf16_f32 v229, v14, v15
    buffer_load_dwordx4 v238, s[16:19], s59 offen offset:2048 lds
    v_fmac_f32 v28, v195, v212
    v_fmac_f32 v29, v195, v213
    v_fmac_f32 v30, v195, v214
    v_fmac_f32 v31, v195, v215
    s_add_u32 m0, s61, 19456
    s_add_u32 s60, s63, 4472832
    buffer_load_dwordx4 v236, s[16:19], s60 offen lds
    v_mul_f32 v220, v199, v28
    v_mul_f32 v221, v199, v29
    v_mul_f32 v222, v199, v30
    buffer_load_dwordx4 v237, s[16:19], s60 offen offset:1024 lds
    v_mul_f32 v223, v199, v31
    v_fmac_f32 v92, v195, v216
    v_fmac_f32 v93, v195, v217
    v_fmac_f32 v94, v195, v218
    buffer_load_dwordx4 v238, s[16:19], s60 offen offset:2048 lds
    v_fmac_f32 v95, v195, v219
    v_exp_f32 v220, v220
    v_exp_f32 v221, v221
    v_exp_f32 v222, v222
    s_waitcnt vmcnt(25) lgkmcnt(0)
    s_barrier
    s_add_u32 m0, s61, 32768
    s_add_u32 s59, s63, 4587520
    buffer_load_dwordx4 v236, s[16:19], s59 offen lds
    v_exp_f32 v223, v223
    v_mul_f32 v28, v28, v92
    v_mul_f32 v29, v29, v93
    buffer_load_dwordx4 v237, s[16:19], s59 offen offset:1024 lds
    v_mul_f32 v30, v30, v94
    v_mul_f32 v31, v31, v95
    v_fma_f32 v220, v220, v203, v203
    buffer_load_dwordx4 v238, s[16:19], s59 offen offset:2048 lds
    v_fma_f32 v221, v221, v203, v203
    v_fma_f32 v222, v222, v203, v203
    v_fma_f32 v223, v223, v203, v203
    s_add_u32 m0, s61, 35840
    s_add_u32 s60, s63, 4702208
    buffer_load_dwordx4 v236, s[16:19], s60 offen lds
    v_rcp_f32 v220, v220
    v_rcp_f32 v221, v221
    v_rcp_f32 v222, v222
    buffer_load_dwordx4 v237, s[16:19], s60 offen offset:1024 lds
    v_rcp_f32 v223, v223
    v_mul_f32 v28, v28, v220
    v_mul_f32 v29, v29, v221
    buffer_load_dwordx4 v238, s[16:19], s60 offen offset:2048 lds
    v_mul_f32 v30, v30, v222
    v_mul_f32 v31, v31, v223
    v_cvt_pk_bf16_f32 v230, v28, v29
    v_cvt_pk_bf16_f32 v231, v30, v31
    s_waitcnt vmcnt(25) lgkmcnt(0)
    s_barrier
    s_add_u32 m0, s61, 49152
    s_add_u32 s59, s63, 4816896
    buffer_load_dwordx4 v236, s[16:19], s59 offen lds
    s_add_u32 s55, s64, 6144
    buffer_store_dwordx4 v[228:231], v254, s[4:7], s55 offen sc0 sc1
    ds_read_b128 v[204:207], v235 offset:128
    ds_read_b128 v[208:211], v235 offset:640
    buffer_load_dwordx4 v237, s[16:19], s59 offen offset:1024 lds
    ds_read_b128 v[212:215], v235 offset:192
    ds_read_b128 v[216:219], v235 offset:704
    s_waitcnt lgkmcnt(0)
    buffer_load_dwordx4 v238, s[16:19], s59 offen offset:2048 lds
    v_fmac_f32 v32, v192, v204
    v_fmac_f32 v33, v192, v205
    v_fmac_f32 v34, v192, v206
    s_add_u32 m0, s61, 52224
    s_add_u32 s60, s63, 4931584
    buffer_load_dwordx4 v236, s[16:19], s60 offen lds
    v_fmac_f32 v35, v192, v207
    v_mul_f32 v220, v196, v32
    v_mul_f32 v221, v196, v33
    buffer_load_dwordx4 v237, s[16:19], s60 offen offset:1024 lds
    v_mul_f32 v222, v196, v34
    v_mul_f32 v223, v196, v35
    v_fmac_f32 v96, v192, v208
    buffer_load_dwordx4 v238, s[16:19], s60 offen offset:2048 lds
    v_fmac_f32 v97, v192, v209
    v_fmac_f32 v98, v192, v210
    v_fmac_f32 v99, v192, v211
    v_exp_f32 v220, v220
    s_waitcnt vmcnt(25) lgkmcnt(0)
    s_barrier
    s_add_u32 m0, s61, 65536
    s_add_u32 s59, s63, 5046272
    buffer_load_dwordx4 v236, s[16:19], s59 offen lds
    v_exp_f32 v221, v221
    v_exp_f32 v222, v222
    v_exp_f32 v223, v223
    buffer_load_dwordx4 v237, s[16:19], s59 offen offset:1024 lds
    v_mul_f32 v32, v32, v96
    v_mul_f32 v33, v33, v97
    v_mul_f32 v34, v34, v98
    buffer_load_dwordx4 v238, s[16:19], s59 offen offset:2048 lds
    v_mul_f32 v35, v35, v99
    v_fma_f32 v220, v220, v200, v200
    v_fma_f32 v221, v221, v200, v200
    s_add_u32 m0, s61, 68608
    s_add_u32 s60, s63, 5160960
    buffer_load_dwordx4 v236, s[16:19], s60 offen lds
    v_fma_f32 v222, v222, v200, v200
    v_fma_f32 v223, v223, v200, v200
    v_rcp_f32 v220, v220
    buffer_load_dwordx4 v237, s[16:19], s60 offen offset:1024 lds
    v_rcp_f32 v221, v221
    v_rcp_f32 v222, v222
    v_rcp_f32 v223, v223
    buffer_load_dwordx4 v238, s[16:19], s60 offen offset:2048 lds
    v_mul_f32 v32, v32, v220
    v_mul_f32 v33, v33, v221
    v_mul_f32 v34, v34, v222
    v_mul_f32 v35, v35, v223
    s_waitcnt vmcnt(25) lgkmcnt(0)
    s_barrier
    s_add_u32 m0, s61, 81920
    s_add_u32 s59, s63, 5275648
    buffer_load_dwordx4 v236, s[16:19], s59 offen lds
    v_cvt_pk_bf16_f32 v224, v32, v33
    v_cvt_pk_bf16_f32 v225, v34, v35
    v_fmac_f32 v48, v192, v212
    buffer_load_dwordx4 v237, s[16:19], s59 offen offset:1024 lds
    v_fmac_f32 v49, v192, v213
    v_fmac_f32 v50, v192, v214
    v_fmac_f32 v51, v192, v215
    v_mul_f32 v220, v196, v48
    buffer_load_dwordx4 v238, s[16:19], s59 offen offset:2048 lds
    v_mul_f32 v221, v196, v49
    v_mul_f32 v222, v196, v50
    v_mul_f32 v223, v196, v51
    v_fmac_f32 v112, v192, v216
    s_add_u32 m0, s61, 84992
    s_add_u32 s60, s63, 5390336
    buffer_load_dwordx4 v236, s[16:19], s60 offen lds
    v_fmac_f32 v113, v192, v217
    v_fmac_f32 v114, v192, v218
    v_fmac_f32 v115, v192, v219
    buffer_load_dwordx4 v237, s[16:19], s60 offen offset:1024 lds
    v_exp_f32 v220, v220
    v_exp_f32 v221, v221
    v_exp_f32 v222, v222
    v_exp_f32 v223, v223
    buffer_load_dwordx4 v238, s[16:19], s60 offen offset:2048 lds
    v_mul_f32 v48, v48, v112
    v_mul_f32 v49, v49, v113
    v_mul_f32 v50, v50, v114
    v_mul_f32 v51, v51, v115
    s_waitcnt vmcnt(25) lgkmcnt(0)
    s_barrier
    s_add_u32 m0, s61, 0
    s_add_u32 s59, s63, 5505024
    buffer_load_dwordx4 v236, s[16:19], s59 offen lds
    v_fma_f32 v220, v220, v200, v200
    v_fma_f32 v221, v221, v200, v200
    v_fma_f32 v222, v222, v200, v200
    buffer_load_dwordx4 v237, s[16:19], s59 offen offset:1024 lds
    v_fma_f32 v223, v223, v200, v200
    v_rcp_f32 v220, v220
    v_rcp_f32 v221, v221
    buffer_load_dwordx4 v238, s[16:19], s59 offen offset:2048 lds
    v_rcp_f32 v222, v222
    v_rcp_f32 v223, v223
    v_mul_f32 v48, v48, v220
    s_add_u32 m0, s61, 3072
    s_add_u32 s60, s63, 5619712
    buffer_load_dwordx4 v236, s[16:19], s60 offen lds
    v_mul_f32 v49, v49, v221
    v_mul_f32 v50, v50, v222
    v_mul_f32 v51, v51, v223
    buffer_load_dwordx4 v237, s[16:19], s60 offen offset:1024 lds
    v_cvt_pk_bf16_f32 v226, v48, v49
    v_cvt_pk_bf16_f32 v227, v50, v51
    s_add_u32 s55, s64, 131072
    buffer_store_dwordx4 v[224:227], v254, s[4:7], s55 offen sc0 sc1
    buffer_load_dwordx4 v238, s[16:19], s60 offen offset:2048 lds
    v_fmac_f32 v36, v193, v204
    v_fmac_f32 v37, v193, v205
    v_fmac_f32 v38, v193, v206
    v_fmac_f32 v39, v193, v207
    s_waitcnt vmcnt(26) lgkmcnt(0)
    s_barrier
    s_add_u32 m0, s61, 16384
    s_add_u32 s59, s63, 5734400
    buffer_load_dwordx4 v236, s[16:19], s59 offen lds
    v_mul_f32 v220, v197, v36
    v_mul_f32 v221, v197, v37
    v_mul_f32 v222, v197, v38
    buffer_load_dwordx4 v237, s[16:19], s59 offen offset:1024 lds
    v_mul_f32 v223, v197, v39
    v_fmac_f32 v100, v193, v208
    v_fmac_f32 v101, v193, v209
    v_fmac_f32 v102, v193, v210
    buffer_load_dwordx4 v238, s[16:19], s59 offen offset:2048 lds
    v_fmac_f32 v103, v193, v211
    v_exp_f32 v220, v220
    v_exp_f32 v221, v221
    s_add_u32 m0, s61, 19456
    s_add_u32 s60, s63, 5849088
    buffer_load_dwordx4 v236, s[16:19], s60 offen lds
    v_exp_f32 v222, v222
    v_exp_f32 v223, v223
    v_mul_f32 v36, v36, v100
    v_mul_f32 v37, v37, v101
    buffer_load_dwordx4 v237, s[16:19], s60 offen offset:1024 lds
    v_mul_f32 v38, v38, v102
    v_mul_f32 v39, v39, v103
    v_fma_f32 v220, v220, v201, v201
    buffer_load_dwordx4 v238, s[16:19], s60 offen offset:2048 lds
    v_fma_f32 v221, v221, v201, v201
    v_fma_f32 v222, v222, v201, v201
    v_fma_f32 v223, v223, v201, v201
    v_rcp_f32 v220, v220
    s_waitcnt vmcnt(25) lgkmcnt(0)
    s_barrier
    s_add_u32 m0, s61, 32768
    s_add_u32 s59, s63, 5963776
    buffer_load_dwordx4 v236, s[16:19], s59 offen lds
    v_rcp_f32 v221, v221
    v_rcp_f32 v222, v222
    v_rcp_f32 v223, v223
    buffer_load_dwordx4 v237, s[16:19], s59 offen offset:1024 lds
    v_mul_f32 v36, v36, v220
    v_mul_f32 v37, v37, v221
    v_mul_f32 v38, v38, v222
    v_mul_f32 v39, v39, v223
    buffer_load_dwordx4 v238, s[16:19], s59 offen offset:2048 lds
    v_cvt_pk_bf16_f32 v228, v36, v37
    v_cvt_pk_bf16_f32 v229, v38, v39
    v_fmac_f32 v52, v193, v212
    v_fmac_f32 v53, v193, v213
    s_add_u32 m0, s61, 35840
    s_add_u32 s60, s63, 6078464
    buffer_load_dwordx4 v236, s[16:19], s60 offen lds
    v_fmac_f32 v54, v193, v214
    v_fmac_f32 v55, v193, v215
    v_mul_f32 v220, v197, v52
    buffer_load_dwordx4 v237, s[16:19], s60 offen offset:1024 lds
    v_mul_f32 v221, v197, v53
    v_mul_f32 v222, v197, v54
    v_mul_f32 v223, v197, v55
    v_fmac_f32 v116, v193, v216
    buffer_load_dwordx4 v238, s[16:19], s60 offen offset:2048 lds
    v_fmac_f32 v117, v193, v217
    v_fmac_f32 v118, v193, v218
    v_fmac_f32 v119, v193, v219
    v_exp_f32 v220, v220
    s_waitcnt vmcnt(25) lgkmcnt(0)
    s_barrier
    s_lshl_b32 s55, s41, 2
    s_add_u32 s55, s55, s42
    s_add_u32 s55, s55, s54
    s_add_u32 s55, s55, 4096
    v_mov_b32 v252, 0
    v_mov_b32 v253, 1
    s_mov_b64 exec, 1
    s_cmp_eq_u32 s45, 0
    s_cbranch_scc1 st_18
    buffer_store_byte v253, v252, s[4:7], s55 offen sc0 sc1
    s_branch st_19
st_18:
    buffer_store_byte v253, v252, s[4:7], s55 offen
st_19:
    s_mov_b64 exec, -1
    s_add_u32 m0, s61, 49152
    s_add_u32 s59, s63, 6193152
    buffer_load_dwordx4 v236, s[16:19], s59 offen lds
    v_exp_f32 v221, v221
    v_exp_f32 v222, v222
    v_exp_f32 v223, v223
    buffer_load_dwordx4 v237, s[16:19], s59 offen offset:1024 lds
    v_mul_f32 v52, v52, v116
    v_mul_f32 v53, v53, v117
    v_mul_f32 v54, v54, v118
    buffer_load_dwordx4 v238, s[16:19], s59 offen offset:2048 lds
    v_mul_f32 v55, v55, v119
    v_fma_f32 v220, v220, v201, v201
    v_fma_f32 v221, v221, v201, v201
    s_add_u32 m0, s61, 52224
    s_add_u32 s60, s63, 6307840
    buffer_load_dwordx4 v236, s[16:19], s60 offen lds
    v_fma_f32 v222, v222, v201, v201
    v_fma_f32 v223, v223, v201, v201
    v_rcp_f32 v220, v220
    buffer_load_dwordx4 v237, s[16:19], s60 offen offset:1024 lds
    v_rcp_f32 v221, v221
    v_rcp_f32 v222, v222
    v_rcp_f32 v223, v223
    buffer_load_dwordx4 v238, s[16:19], s60 offen offset:2048 lds
    v_mul_f32 v52, v52, v220
    v_mul_f32 v53, v53, v221
    v_mul_f32 v54, v54, v222
    v_mul_f32 v55, v55, v223
    s_waitcnt vmcnt(26) lgkmcnt(0)
    s_barrier
    s_add_u32 m0, s61, 65536
    s_add_u32 s59, s63, 6422528
    buffer_load_dwordx4 v236, s[16:19], s59 offen lds
    v_cvt_pk_bf16_f32 v230, v52, v53
    v_cvt_pk_bf16_f32 v231, v54, v55
    s_add_u32 s55, s64, 133120
    buffer_store_dwordx4 v[228:231], v254, s[4:7], s55 offen sc0 sc1
    buffer_load_dwordx4 v237, s[16:19], s59 offen offset:1024 lds
    v_fmac_f32 v40, v194, v204
    v_fmac_f32 v41, v194, v205
    v_fmac_f32 v42, v194, v206
    buffer_load_dwordx4 v238, s[16:19], s59 offen offset:2048 lds
    v_fmac_f32 v43, v194, v207
    v_mul_f32 v220, v198, v40
    v_mul_f32 v221, v198, v41
    s_add_u32 m0, s61, 68608
    s_add_u32 s60, s63, 6537216
    buffer_load_dwordx4 v236, s[16:19], s60 offen lds
    v_mul_f32 v222, v198, v42
    v_mul_f32 v223, v198, v43
    v_fmac_f32 v104, v194, v208
    buffer_load_dwordx4 v237, s[16:19], s60 offen offset:1024 lds
    v_fmac_f32 v105, v194, v209
    v_fmac_f32 v106, v194, v210
    v_fmac_f32 v107, v194, v211
    buffer_load_dwordx4 v238, s[16:19], s60 offen offset:2048 lds
    v_exp_f32 v220, v220
    v_exp_f32 v221, v221
    v_exp_f32 v222, v222
    v_exp_f32 v223, v223
    s_waitcnt vmcnt(26) lgkmcnt(0)
    s_barrier
    s_add_u32 m0, s61, 81920
    s_add_u32 s59, s63, 6651904
    buffer_load_dwordx4 v236, s[16:19], s59 offen lds
    v_mul_f32 v40, v40, v104
    v_mul_f32 v41, v41, v105
    v_mul_f32 v42, v42, v106
    buffer_load_dwordx4 v237, s[16:19], s59 offen offset:1024 lds
    v_mul_f32 v43, v43, v107
    v_fma_f32 v220, v220, v202, v202
    v_fma_f32 v221, v221, v202, v202
    v_fma_f32 v222, v222, v202, v202
    buffer_load_dwordx4 v238, s[16:19], s59 offen offset:2048 lds
    v_fma_f32 v223, v223, v202, v202
    v_rcp_f32 v220, v220
    v_rcp_f32 v221, v221
    v_rcp_f32 v222, v222
    s_add_u32 m0, s61, 84992
    s_add_u32 s60, s63, 6766592
    buffer_load_dwordx4 v236, s[16:19], s60 offen lds
    v_rcp_f32 v223, v223
    v_mul_f32 v40, v40, v220
    v_mul_f32 v41, v41, v221
    buffer_load_dwordx4 v237, s[16:19], s60 offen offset:1024 lds
    v_mul_f32 v42, v42, v222
    v_mul_f32 v43, v43, v223
    v_cvt_pk_bf16_f32 v224, v40, v41
    v_cvt_pk_bf16_f32 v225, v42, v43
    buffer_load_dwordx4 v238, s[16:19], s60 offen offset:2048 lds
    v_fmac_f32 v56, v194, v212
    v_fmac_f32 v57, v194, v213
    v_fmac_f32 v58, v194, v214
    v_fmac_f32 v59, v194, v215
    s_waitcnt vmcnt(26) lgkmcnt(0)
    s_barrier
    s_add_u32 m0, s61, 0
    s_add_u32 s59, s63, 6881280
    buffer_load_dwordx4 v236, s[16:19], s59 offen lds
    v_mul_f32 v220, v198, v56
    v_mul_f32 v221, v198, v57
    v_mul_f32 v222, v198, v58
    buffer_load_dwordx4 v237, s[16:19], s59 offen offset:1024 lds
    v_mul_f32 v223, v198, v59
    v_fmac_f32 v120, v194, v216
    v_fmac_f32 v121, v194, v217
    v_fmac_f32 v122, v194, v218
    buffer_load_dwordx4 v238, s[16:19], s59 offen offset:2048 lds
    v_fmac_f32 v123, v194, v219
    v_exp_f32 v220, v220
    v_exp_f32 v221, v221
    s_add_u32 m0, s61, 3072
    s_add_u32 s60, s63, 6995968
    buffer_load_dwordx4 v236, s[16:19], s60 offen lds
    v_exp_f32 v222, v222
    v_exp_f32 v223, v223
    v_mul_f32 v56, v56, v120
    v_mul_f32 v57, v57, v121
    buffer_load_dwordx4 v237, s[16:19], s60 offen offset:1024 lds
    v_mul_f32 v58, v58, v122
    v_mul_f32 v59, v59, v123
    v_fma_f32 v220, v220, v202, v202
    buffer_load_dwordx4 v238, s[16:19], s60 offen offset:2048 lds
    v_fma_f32 v221, v221, v202, v202
    v_fma_f32 v222, v222, v202, v202
    v_fma_f32 v223, v223, v202, v202
    v_rcp_f32 v220, v220
    s_waitcnt vmcnt(26) lgkmcnt(0)
    s_barrier
    s_add_u32 m0, s61, 16384
    s_add_u32 s59, s63, 7110656
    buffer_load_dwordx4 v236, s[16:19], s59 offen lds
    v_rcp_f32 v221, v221
    v_rcp_f32 v222, v222
    v_rcp_f32 v223, v223
    buffer_load_dwordx4 v237, s[16:19], s59 offen offset:1024 lds
    v_mul_f32 v56, v56, v220
    v_mul_f32 v57, v57, v221
    v_mul_f32 v58, v58, v222
    buffer_load_dwordx4 v238, s[16:19], s59 offen offset:2048 lds
    v_mul_f32 v59, v59, v223
    v_cvt_pk_bf16_f32 v226, v56, v57
    v_cvt_pk_bf16_f32 v227, v58, v59
    s_add_u32 s55, s64, 135168
    buffer_store_dwordx4 v[224:227], v254, s[4:7], s55 offen sc0 sc1
    s_add_u32 m0, s61, 19456
    s_add_u32 s60, s63, 7225344
    buffer_load_dwordx4 v236, s[16:19], s60 offen lds
    v_fmac_f32 v44, v195, v204
    v_fmac_f32 v45, v195, v205
    v_fmac_f32 v46, v195, v206
    buffer_load_dwordx4 v237, s[16:19], s60 offen offset:1024 lds
    v_fmac_f32 v47, v195, v207
    v_mul_f32 v220, v199, v44
    v_mul_f32 v221, v199, v45
    buffer_load_dwordx4 v238, s[16:19], s60 offen offset:2048 lds
    v_mul_f32 v222, v199, v46
    v_mul_f32 v223, v199, v47
    v_fmac_f32 v108, v195, v208
    v_fmac_f32 v109, v195, v209
    s_waitcnt vmcnt(26) lgkmcnt(0)
    s_barrier
    s_add_u32 m0, s67, 32768
    s_add_u32 s59, s68, 0
    buffer_load_dwordx4 v239, s[20:23], s59 offen lds
    v_fmac_f32 v110, v195, v210
    v_fmac_f32 v111, v195, v211
    buffer_load_dwordx4 v240, s[20:23], s59 offen offset:1024 lds
    v_exp_f32 v220, v220
    v_exp_f32 v221, v221
    buffer_load_dwordx4 v241, s[20:23], s59 offen offset:2048 lds
    v_exp_f32 v222, v222
    v_exp_f32 v223, v223
    buffer_load_dwordx4 v242, s[20:23], s59 offen offset:3072 lds
    v_mul_f32 v44, v44, v108
    v_mul_f32 v45, v45, v109
    v_mul_f32 v46, v46, v110
    s_add_u32 m0, s67, 36864
    s_add_u32 s60, s68, 32768
    buffer_load_dwordx4 v239, s[20:23], s60 offen lds
    v_mul_f32 v47, v47, v111
    v_fma_f32 v220, v220, v203, v203
    buffer_load_dwordx4 v240, s[20:23], s60 offen offset:1024 lds
    v_fma_f32 v221, v221, v203, v203
    v_fma_f32 v222, v222, v203, v203
    buffer_load_dwordx4 v241, s[20:23], s60 offen offset:2048 lds
    v_fma_f32 v223, v223, v203, v203
    v_rcp_f32 v220, v220
    buffer_load_dwordx4 v242, s[20:23], s60 offen offset:3072 lds
    v_rcp_f32 v221, v221
    v_rcp_f32 v222, v222
    v_rcp_f32 v223, v223
    s_waitcnt vmcnt(27) lgkmcnt(0)
    s_barrier
    s_add_u32 m0, s67, 49152
    s_add_u32 s59, s68, 655360
    buffer_load_dwordx4 v239, s[20:23], s59 offen lds
    v_mul_f32 v44, v44, v220
    v_mul_f32 v45, v45, v221
    buffer_load_dwordx4 v240, s[20:23], s59 offen offset:1024 lds
    v_mul_f32 v46, v46, v222
    v_mul_f32 v47, v47, v223
    v_cvt_pk_bf16_f32 v228, v44, v45
    buffer_load_dwordx4 v241, s[20:23], s59 offen offset:2048 lds
    v_cvt_pk_bf16_f32 v229, v46, v47
    v_fmac_f32 v60, v195, v212
    v_fmac_f32 v61, v195, v213
    buffer_load_dwordx4 v242, s[20:23], s59 offen offset:3072 lds
    v_fmac_f32 v62, v195, v214
    v_fmac_f32 v63, v195, v215
    v_mul_f32 v220, v199, v60
    s_add_u32 m0, s67, 53248
    s_add_u32 s60, s68, 688128
    buffer_load_dwordx4 v239, s[20:23], s60 offen lds
    v_mul_f32 v221, v199, v61
    v_mul_f32 v222, v199, v62
    buffer_load_dwordx4 v240, s[20:23], s60 offen offset:1024 lds
    v_mul_f32 v223, v199, v63
    v_fmac_f32 v124, v195, v216
    v_fmac_f32 v125, v195, v217
    buffer_load_dwordx4 v241, s[20:23], s60 offen offset:2048 lds
    v_fmac_f32 v126, v195, v218
    v_fmac_f32 v127, v195, v219
    v_exp_f32 v220, v220
    buffer_load_dwordx4 v242, s[20:23], s60 offen offset:3072 lds
    v_exp_f32 v221, v221
    v_exp_f32 v222, v222
    v_exp_f32 v223, v223
    s_waitcnt vmcnt(29) lgkmcnt(0)
    s_barrier
    s_add_u32 m0, s67, 65536
    s_add_u32 s59, s68, 917504
    buffer_load_dwordx4 v239, s[20:23], s59 offen lds
    v_mul_f32 v60, v60, v124
    v_mul_f32 v61, v61, v125
    buffer_load_dwordx4 v240, s[20:23], s59 offen offset:1024 lds
    v_mul_f32 v62, v62, v126
    v_mul_f32 v63, v63, v127
    buffer_load_dwordx4 v241, s[20:23], s59 offen offset:2048 lds
    v_fma_f32 v220, v220, v203, v203
    v_fma_f32 v221, v221, v203, v203
    v_fma_f32 v222, v222, v203, v203
    buffer_load_dwordx4 v242, s[20:23], s59 offen offset:3072 lds
    v_fma_f32 v223, v223, v203, v203
    v_rcp_f32 v220, v220
    s_add_u32 m0, s67, 69632
    s_add_u32 s60, s68, 950272
    buffer_load_dwordx4 v239, s[20:23], s60 offen lds
    v_rcp_f32 v221, v221
    v_rcp_f32 v222, v222
    buffer_load_dwordx4 v240, s[20:23], s60 offen offset:1024 lds
    v_rcp_f32 v223, v223
    v_mul_f32 v60, v60, v220
    v_mul_f32 v61, v61, v221
    buffer_load_dwordx4 v241, s[20:23], s60 offen offset:2048 lds
    v_mul_f32 v62, v62, v222
    v_mul_f32 v63, v63, v223
    buffer_load_dwordx4 v242, s[20:23], s60 offen offset:3072 lds
    v_cvt_pk_bf16_f32 v230, v60, v61
    v_cvt_pk_bf16_f32 v231, v62, v63
    s_add_u32 s55, s64, 137216
    buffer_store_dwordx4 v[228:231], v254, s[4:7], s55 offen sc0 sc1
    s_waitcnt vmcnt(32) lgkmcnt(0)
    s_barrier
    s_add_u32 m0, s67, 81920
    s_add_u32 s59, s68, 1572864
    buffer_load_dwordx4 v239, s[20:23], s59 offen lds
    buffer_load_dwordx4 v240, s[20:23], s59 offen offset:1024 lds
    buffer_load_dwordx4 v241, s[20:23], s59 offen offset:2048 lds
    buffer_load_dwordx4 v242, s[20:23], s59 offen offset:3072 lds
    s_add_u32 m0, s67, 86016
    s_add_u32 s60, s68, 1605632
    buffer_load_dwordx4 v239, s[20:23], s60 offen lds
    buffer_load_dwordx4 v240, s[20:23], s60 offen offset:1024 lds
    buffer_load_dwordx4 v241, s[20:23], s60 offen offset:2048 lds
    buffer_load_dwordx4 v242, s[20:23], s60 offen offset:3072 lds
    s_waitcnt vmcnt(33) lgkmcnt(0)
    s_barrier
    s_add_u32 m0, s67, 0
    s_add_u32 s59, s68, 1835008
    buffer_load_dwordx4 v239, s[20:23], s59 offen lds
    v_lshlrev_b32 v128, 16, v160
    v_and_b32 v129, 0xffff0000, v160
    buffer_load_dwordx4 v240, s[20:23], s59 offen offset:1024 lds
    v_lshlrev_b32 v130, 16, v161
    v_and_b32 v131, 0xffff0000, v161
    v_lshlrev_b32 v144, 16, v162
    buffer_load_dwordx4 v241, s[20:23], s59 offen offset:2048 lds
    v_and_b32 v145, 0xffff0000, v162
    v_lshlrev_b32 v146, 16, v163
    v_and_b32 v147, 0xffff0000, v163
    v_lshlrev_b32 v132, 16, v164
    buffer_load_dwordx4 v242, s[20:23], s59 offen offset:3072 lds
    v_and_b32 v133, 0xffff0000, v164
    v_lshlrev_b32 v134, 16, v165
    v_and_b32 v135, 0xffff0000, v165
    s_add_u32 m0, s67, 4096
    s_add_u32 s60, s68, 1867776
    buffer_load_dwordx4 v239, s[20:23], s60 offen lds
    v_lshlrev_b32 v148, 16, v166
    v_and_b32 v149, 0xffff0000, v166
    v_lshlrev_b32 v150, 16, v167
    buffer_load_dwordx4 v240, s[20:23], s60 offen offset:1024 lds
    v_and_b32 v151, 0xffff0000, v167
    v_lshlrev_b32 v136, 16, v168
    v_and_b32 v137, 0xffff0000, v168
    v_lshlrev_b32 v138, 16, v169
    buffer_load_dwordx4 v241, s[20:23], s60 offen offset:2048 lds
    v_and_b32 v139, 0xffff0000, v169
    v_lshlrev_b32 v152, 16, v170
    v_and_b32 v153, 0xffff0000, v170
    buffer_load_dwordx4 v242, s[20:23], s60 offen offset:3072 lds
    v_lshlrev_b32 v154, 16, v171
    v_and_b32 v155, 0xffff0000, v171
    v_lshlrev_b32 v140, 16, v172
    v_and_b32 v141, 0xffff0000, v172
    s_waitcnt vmcnt(33) lgkmcnt(0)
    s_barrier
    s_add_u32 m0, s67, 16384
    s_add_u32 s59, s68, 2490368
    buffer_load_dwordx4 v239, s[20:23], s59 offen lds
    v_lshlrev_b32 v142, 16, v173
    v_and_b32 v143, 0xffff0000, v173
    v_lshlrev_b32 v156, 16, v174
    v_and_b32 v157, 0xffff0000, v174
    buffer_load_dwordx4 v240, s[20:23], s59 offen offset:1024 lds
    v_lshlrev_b32 v158, 16, v175
    v_and_b32 v159, 0xffff0000, v175
    v_mov_b32 v160, 0
    v_mov_b32 v161, 0
    v_mov_b32 v162, 0
    buffer_load_dwordx4 v241, s[20:23], s59 offen offset:2048 lds
    v_mov_b32 v163, 0
    v_mov_b32 v164, 0
    v_mov_b32 v165, 0
    v_mov_b32 v166, 0
    v_mov_b32 v167, 0
    buffer_load_dwordx4 v242, s[20:23], s59 offen offset:3072 lds
    v_mov_b32 v168, 0
    v_mov_b32 v169, 0
    v_mov_b32 v170, 0
    v_mov_b32 v171, 0
    v_mov_b32 v172, 0
    s_add_u32 m0, s67, 20480
    s_add_u32 s60, s68, 2523136
    buffer_load_dwordx4 v239, s[20:23], s60 offen lds
    v_mov_b32 v173, 0
    v_mov_b32 v174, 0
    v_mov_b32 v175, 0
    v_mov_b32 v176, 0
    buffer_load_dwordx4 v240, s[20:23], s60 offen offset:1024 lds
    v_mov_b32 v177, 0
    v_mov_b32 v178, 0
    v_mov_b32 v179, 0
    v_mov_b32 v180, 0
    v_mov_b32 v181, 0
    buffer_load_dwordx4 v241, s[20:23], s60 offen offset:2048 lds
    v_mov_b32 v182, 0
    v_mov_b32 v183, 0
    v_mov_b32 v184, 0
    v_mov_b32 v185, 0
    v_mov_b32 v186, 0
    buffer_load_dwordx4 v242, s[20:23], s60 offen offset:3072 lds
    v_mov_b32 v187, 0
    v_mov_b32 v188, 0
    v_mov_b32 v189, 0
    v_mov_b32 v190, 0
    v_mov_b32 v191, 0
    s_waitcnt vmcnt(24)
    s_lshl_b32 s55, s41, 2
    s_add_u32 s55, s55, s42
    s_add_u32 s55, s55, s54
    s_add_u32 s55, s55, 4160
    v_mov_b32 v252, 0
    v_mov_b32 v253, 1
    s_mov_b64 exec, 1
    s_cmp_eq_u32 s45, 0
    s_cbranch_scc1 st_20
    buffer_store_byte v253, v252, s[4:7], s55 offen sc0 sc1
    s_branch st_21
st_20:
    buffer_store_byte v253, v252, s[4:7], s55 offen
st_21:
    s_mov_b64 exec, -1
    s_setprio 0
X_g4:
    ds_read_b64_tr_b16 v[32:33], v244 offset:32768
    ds_read_b64_tr_b16 v[34:35], v244 offset:36864
    ds_read_b128 v[0:3], v243 offset:32768
    ds_read_b128 v[4:7], v243 offset:34816
    ds_read_b128 v[8:11], v243 offset:36864
    ds_read_b128 v[12:15], v243 offset:38912
    ds_read_b64_tr_b16 v[36:37], v245 offset:32768
    ds_read_b64_tr_b16 v[38:39], v245 offset:36864
    ds_read_b64_tr_b16 v[40:41], v246 offset:32768
    ds_read_b64_tr_b16 v[42:43], v246 offset:36864
    ds_read_b64_tr_b16 v[44:45], v247 offset:32768
    ds_read_b64_tr_b16 v[46:47], v247 offset:36864
    s_lshl_b32 s55, s51, 14
    s_lshl_b32 s56, s42, 12
    s_add_u32 s55, s55, s56
    s_add_u32 s55, s55, s47
    s_add_u32 s62, s55, 50331648
    s_xor_b32 s63, s62, 16384
    s_mov_b32 s58, 4
    .p2align 3
loop_22:
    s_waitcnt lgkmcnt(0)
    .p2align 3
    v_mfma_f32_16x16x32_bf16 v[128:131], v[32:35], v[0:3], v[128:131]
    ds_read_b64_tr_b16 v[48:49], v244 offset:40960
    v_mfma_f32_16x16x32_bf16 v[132:135], v[32:35], v[4:7], v[132:135]
    ds_read_b64_tr_b16 v[50:51], v244 offset:45056
    v_mfma_f32_16x16x32_bf16 v[136:139], v[32:35], v[8:11], v[136:139]
    ds_read_b128 v[16:19], v243 offset:33792
    v_mfma_f32_16x16x32_bf16 v[140:143], v[32:35], v[12:15], v[140:143]
    ds_read_b128 v[20:23], v243 offset:35840
    v_mfma_f32_16x16x32_bf16 v[144:147], v[36:39], v[0:3], v[144:147]
    ds_read_b128 v[24:27], v243 offset:37888
    v_mfma_f32_16x16x32_bf16 v[148:151], v[36:39], v[4:7], v[148:151]
    ds_read_b128 v[28:31], v243 offset:39936
    v_mfma_f32_16x16x32_bf16 v[152:155], v[36:39], v[8:11], v[152:155]
    ds_read_b64_tr_b16 v[52:53], v245 offset:40960
    v_mfma_f32_16x16x32_bf16 v[156:159], v[36:39], v[12:15], v[156:159]
    ds_read_b64_tr_b16 v[54:55], v245 offset:45056
    v_mfma_f32_16x16x32_bf16 v[160:163], v[40:43], v[0:3], v[160:163]
    ds_read_b64_tr_b16 v[56:57], v246 offset:40960
    v_mfma_f32_16x16x32_bf16 v[164:167], v[40:43], v[4:7], v[164:167]
    ds_read_b64_tr_b16 v[58:59], v246 offset:45056
    v_mfma_f32_16x16x32_bf16 v[168:171], v[40:43], v[8:11], v[168:171]
    ds_read_b64_tr_b16 v[60:61], v247 offset:40960
    v_mfma_f32_16x16x32_bf16 v[172:175], v[40:43], v[12:15], v[172:175]
    ds_read_b64_tr_b16 v[62:63], v247 offset:45056
    v_mfma_f32_16x16x32_bf16 v[176:179], v[44:47], v[0:3], v[176:179]
    v_mfma_f32_16x16x32_bf16 v[180:183], v[44:47], v[4:7], v[180:183]
    v_mfma_f32_16x16x32_bf16 v[184:187], v[44:47], v[8:11], v[184:187]
    v_mfma_f32_16x16x32_bf16 v[188:191], v[44:47], v[12:15], v[188:191]
    s_waitcnt vmcnt(32) lgkmcnt(0)
    s_barrier
    .p2align 3
    v_mfma_f32_16x16x32_bf16 v[128:131], v[48:51], v[16:19], v[128:131]
    ds_read_b64_tr_b16 v[32:33], v248 offset:0
    v_mfma_f32_16x16x32_bf16 v[132:135], v[48:51], v[20:23], v[132:135]
    ds_read_b64_tr_b16 v[34:35], v248 offset:4096
    v_mfma_f32_16x16x32_bf16 v[136:139], v[48:51], v[24:27], v[136:139]
    ds_read_b128 v[0:3], v243 offset:0
    v_mfma_f32_16x16x32_bf16 v[140:143], v[48:51], v[28:31], v[140:143]
    ds_read_b128 v[4:7], v243 offset:2048
    v_mfma_f32_16x16x32_bf16 v[144:147], v[52:55], v[16:19], v[144:147]
    ds_read_b128 v[8:11], v243 offset:4096
    v_mfma_f32_16x16x32_bf16 v[148:151], v[52:55], v[20:23], v[148:151]
    ds_read_b128 v[12:15], v243 offset:6144
    v_mfma_f32_16x16x32_bf16 v[152:155], v[52:55], v[24:27], v[152:155]
    ds_read_b64_tr_b16 v[36:37], v249 offset:0
    v_mfma_f32_16x16x32_bf16 v[156:159], v[52:55], v[28:31], v[156:159]
    ds_read_b64_tr_b16 v[38:39], v249 offset:4096
    v_mfma_f32_16x16x32_bf16 v[160:163], v[56:59], v[16:19], v[160:163]
    ds_read_b64_tr_b16 v[40:41], v250 offset:0
    v_mfma_f32_16x16x32_bf16 v[164:167], v[56:59], v[20:23], v[164:167]
    ds_read_b64_tr_b16 v[42:43], v250 offset:4096
    v_mfma_f32_16x16x32_bf16 v[168:171], v[56:59], v[24:27], v[168:171]
    ds_read_b64_tr_b16 v[44:45], v251 offset:0
    v_mfma_f32_16x16x32_bf16 v[172:175], v[56:59], v[28:31], v[172:175]
    ds_read_b64_tr_b16 v[46:47], v251 offset:4096
    v_mfma_f32_16x16x32_bf16 v[176:179], v[60:63], v[16:19], v[176:179]
    v_mfma_f32_16x16x32_bf16 v[180:183], v[60:63], v[20:23], v[180:183]
    v_mfma_f32_16x16x32_bf16 v[184:187], v[60:63], v[24:27], v[184:187]
    v_mfma_f32_16x16x32_bf16 v[188:191], v[60:63], v[28:31], v[188:191]
    s_waitcnt lgkmcnt(0)
    .p2align 3
    v_mfma_f32_16x16x32_bf16 v[128:131], v[32:35], v[0:3], v[128:131]
    ds_read_b64_tr_b16 v[48:49], v248 offset:8192
    v_mfma_f32_16x16x32_bf16 v[132:135], v[32:35], v[4:7], v[132:135]
    ds_read_b64_tr_b16 v[50:51], v248 offset:12288
    v_mfma_f32_16x16x32_bf16 v[136:139], v[32:35], v[8:11], v[136:139]
    ds_read_b128 v[16:19], v243 offset:1024
    v_mfma_f32_16x16x32_bf16 v[140:143], v[32:35], v[12:15], v[140:143]
    ds_read_b128 v[20:23], v243 offset:3072
    v_mfma_f32_16x16x32_bf16 v[144:147], v[36:39], v[0:3], v[144:147]
    ds_read_b128 v[24:27], v243 offset:5120
    v_mfma_f32_16x16x32_bf16 v[148:151], v[36:39], v[4:7], v[148:151]
    ds_read_b128 v[28:31], v243 offset:7168
    v_mfma_f32_16x16x32_bf16 v[152:155], v[36:39], v[8:11], v[152:155]
    ds_read_b64_tr_b16 v[52:53], v249 offset:8192
    v_mfma_f32_16x16x32_bf16 v[156:159], v[36:39], v[12:15], v[156:159]
    ds_read_b64_tr_b16 v[54:55], v249 offset:12288
    v_mfma_f32_16x16x32_bf16 v[160:163], v[40:43], v[0:3], v[160:163]
    ds_read_b64_tr_b16 v[56:57], v250 offset:8192
    v_mfma_f32_16x16x32_bf16 v[164:167], v[40:43], v[4:7], v[164:167]
    ds_read_b64_tr_b16 v[58:59], v250 offset:12288
    v_mfma_f32_16x16x32_bf16 v[168:171], v[40:43], v[8:11], v[168:171]
    ds_read_b64_tr_b16 v[60:61], v251 offset:8192
    v_mfma_f32_16x16x32_bf16 v[172:175], v[40:43], v[12:15], v[172:175]
    ds_read_b64_tr_b16 v[62:63], v251 offset:12288
    v_mfma_f32_16x16x32_bf16 v[176:179], v[44:47], v[0:3], v[176:179]
    v_mfma_f32_16x16x32_bf16 v[180:183], v[44:47], v[4:7], v[180:183]
    v_mfma_f32_16x16x32_bf16 v[184:187], v[44:47], v[8:11], v[184:187]
    v_mfma_f32_16x16x32_bf16 v[188:191], v[44:47], v[12:15], v[188:191]
    s_waitcnt vmcnt(24) lgkmcnt(0)
    s_barrier
    .p2align 3
    v_mfma_f32_16x16x32_bf16 v[128:131], v[48:51], v[16:19], v[128:131]
    ds_read_b64_tr_b16 v[32:33], v248 offset:16384
    v_mfma_f32_16x16x32_bf16 v[132:135], v[48:51], v[20:23], v[132:135]
    ds_read_b64_tr_b16 v[34:35], v248 offset:20480
    v_mfma_f32_16x16x32_bf16 v[136:139], v[48:51], v[24:27], v[136:139]
    ds_read_b128 v[0:3], v243 offset:16384
    v_mfma_f32_16x16x32_bf16 v[140:143], v[48:51], v[28:31], v[140:143]
    ds_read_b128 v[4:7], v243 offset:18432
    v_mfma_f32_16x16x32_bf16 v[144:147], v[52:55], v[16:19], v[144:147]
    ds_read_b128 v[8:11], v243 offset:20480
    v_mfma_f32_16x16x32_bf16 v[148:151], v[52:55], v[20:23], v[148:151]
    ds_read_b128 v[12:15], v243 offset:22528
    v_mfma_f32_16x16x32_bf16 v[152:155], v[52:55], v[24:27], v[152:155]
    ds_read_b64_tr_b16 v[36:37], v249 offset:16384
    v_mfma_f32_16x16x32_bf16 v[156:159], v[52:55], v[28:31], v[156:159]
    ds_read_b64_tr_b16 v[38:39], v249 offset:20480
    v_mfma_f32_16x16x32_bf16 v[160:163], v[56:59], v[16:19], v[160:163]
    ds_read_b64_tr_b16 v[40:41], v250 offset:16384
    v_mfma_f32_16x16x32_bf16 v[164:167], v[56:59], v[20:23], v[164:167]
    ds_read_b64_tr_b16 v[42:43], v250 offset:20480
    v_mfma_f32_16x16x32_bf16 v[168:171], v[56:59], v[24:27], v[168:171]
    ds_read_b64_tr_b16 v[44:45], v251 offset:16384
    v_mfma_f32_16x16x32_bf16 v[172:175], v[56:59], v[28:31], v[172:175]
    ds_read_b64_tr_b16 v[46:47], v251 offset:20480
    v_mfma_f32_16x16x32_bf16 v[176:179], v[60:63], v[16:19], v[176:179]
    v_mfma_f32_16x16x32_bf16 v[180:183], v[60:63], v[20:23], v[180:183]
    v_mfma_f32_16x16x32_bf16 v[184:187], v[60:63], v[24:27], v[184:187]
    v_mfma_f32_16x16x32_bf16 v[188:191], v[60:63], v[28:31], v[188:191]
    s_waitcnt lgkmcnt(0)
    .p2align 3
    v_mfma_f32_16x16x32_bf16 v[128:131], v[32:35], v[0:3], v[128:131]
    ds_read_b64_tr_b16 v[48:49], v248 offset:24576
    v_mfma_f32_16x16x32_bf16 v[132:135], v[32:35], v[4:7], v[132:135]
    ds_read_b64_tr_b16 v[50:51], v248 offset:28672
    v_mfma_f32_16x16x32_bf16 v[136:139], v[32:35], v[8:11], v[136:139]
    ds_read_b128 v[16:19], v243 offset:17408
    v_mfma_f32_16x16x32_bf16 v[140:143], v[32:35], v[12:15], v[140:143]
    ds_read_b128 v[20:23], v243 offset:19456
    v_mfma_f32_16x16x32_bf16 v[144:147], v[36:39], v[0:3], v[144:147]
    ds_read_b128 v[24:27], v243 offset:21504
    v_mfma_f32_16x16x32_bf16 v[148:151], v[36:39], v[4:7], v[148:151]
    ds_read_b128 v[28:31], v243 offset:23552
    v_mfma_f32_16x16x32_bf16 v[152:155], v[36:39], v[8:11], v[152:155]
    ds_read_b64_tr_b16 v[52:53], v249 offset:24576
    v_mfma_f32_16x16x32_bf16 v[156:159], v[36:39], v[12:15], v[156:159]
    ds_read_b64_tr_b16 v[54:55], v249 offset:28672
    v_mfma_f32_16x16x32_bf16 v[160:163], v[40:43], v[0:3], v[160:163]
    ds_read_b64_tr_b16 v[56:57], v250 offset:24576
    v_mfma_f32_16x16x32_bf16 v[164:167], v[40:43], v[4:7], v[164:167]
    ds_read_b64_tr_b16 v[58:59], v250 offset:28672
    v_mfma_f32_16x16x32_bf16 v[168:171], v[40:43], v[8:11], v[168:171]
    ds_read_b64_tr_b16 v[60:61], v251 offset:24576
    v_mfma_f32_16x16x32_bf16 v[172:175], v[40:43], v[12:15], v[172:175]
    ds_read_b64_tr_b16 v[62:63], v251 offset:28672
    v_mfma_f32_16x16x32_bf16 v[176:179], v[44:47], v[0:3], v[176:179]
    v_mfma_f32_16x16x32_bf16 v[180:183], v[44:47], v[4:7], v[180:183]
    v_mfma_f32_16x16x32_bf16 v[184:187], v[44:47], v[8:11], v[184:187]
    v_mfma_f32_16x16x32_bf16 v[188:191], v[44:47], v[12:15], v[188:191]
    s_waitcnt vmcnt(16) lgkmcnt(0)
    s_barrier
    .p2align 3
    v_mfma_f32_16x16x32_bf16 v[128:131], v[48:51], v[16:19], v[128:131]
    ds_read_b64_tr_b16 v[32:33], v248 offset:32768
    v_mfma_f32_16x16x32_bf16 v[132:135], v[48:51], v[20:23], v[132:135]
    ds_read_b64_tr_b16 v[34:35], v248 offset:36864
    v_mfma_f32_16x16x32_bf16 v[136:139], v[48:51], v[24:27], v[136:139]
    ds_read_b128 v[0:3], v243 offset:32768
    v_mfma_f32_16x16x32_bf16 v[140:143], v[48:51], v[28:31], v[140:143]
    ds_read_b128 v[4:7], v243 offset:34816
    v_mfma_f32_16x16x32_bf16 v[144:147], v[52:55], v[16:19], v[144:147]
    ds_read_b128 v[8:11], v243 offset:36864
    v_mfma_f32_16x16x32_bf16 v[148:151], v[52:55], v[20:23], v[148:151]
    ds_read_b128 v[12:15], v243 offset:38912
    v_mfma_f32_16x16x32_bf16 v[152:155], v[52:55], v[24:27], v[152:155]
    ds_read_b64_tr_b16 v[36:37], v249 offset:32768
    v_mfma_f32_16x16x32_bf16 v[156:159], v[52:55], v[28:31], v[156:159]
    ds_read_b64_tr_b16 v[38:39], v249 offset:36864
    v_mfma_f32_16x16x32_bf16 v[160:163], v[56:59], v[16:19], v[160:163]
    ds_read_b64_tr_b16 v[40:41], v250 offset:32768
    v_mfma_f32_16x16x32_bf16 v[164:167], v[56:59], v[20:23], v[164:167]
    ds_read_b64_tr_b16 v[42:43], v250 offset:36864
    v_mfma_f32_16x16x32_bf16 v[168:171], v[56:59], v[24:27], v[168:171]
    ds_read_b64_tr_b16 v[44:45], v251 offset:32768
    v_mfma_f32_16x16x32_bf16 v[172:175], v[56:59], v[28:31], v[172:175]
    ds_read_b64_tr_b16 v[46:47], v251 offset:36864
    v_mfma_f32_16x16x32_bf16 v[176:179], v[60:63], v[16:19], v[176:179]
    v_mfma_f32_16x16x32_bf16 v[180:183], v[60:63], v[20:23], v[180:183]
    v_mfma_f32_16x16x32_bf16 v[184:187], v[60:63], v[24:27], v[184:187]
    v_mfma_f32_16x16x32_bf16 v[188:191], v[60:63], v[28:31], v[188:191]
    s_waitcnt lgkmcnt(0)
    .p2align 3
    v_mfma_f32_16x16x32_bf16 v[128:131], v[32:35], v[0:3], v[128:131]
    ds_read_b64_tr_b16 v[48:49], v248 offset:40960
    v_mfma_f32_16x16x32_bf16 v[132:135], v[32:35], v[4:7], v[132:135]
    ds_read_b64_tr_b16 v[50:51], v248 offset:45056
    v_mfma_f32_16x16x32_bf16 v[136:139], v[32:35], v[8:11], v[136:139]
    ds_read_b128 v[16:19], v243 offset:33792
    v_mfma_f32_16x16x32_bf16 v[140:143], v[32:35], v[12:15], v[140:143]
    ds_read_b128 v[20:23], v243 offset:35840
    v_mfma_f32_16x16x32_bf16 v[144:147], v[36:39], v[0:3], v[144:147]
    ds_read_b128 v[24:27], v243 offset:37888
    v_mfma_f32_16x16x32_bf16 v[148:151], v[36:39], v[4:7], v[148:151]
    ds_read_b128 v[28:31], v243 offset:39936
    v_mfma_f32_16x16x32_bf16 v[152:155], v[36:39], v[8:11], v[152:155]
    ds_read_b64_tr_b16 v[52:53], v249 offset:40960
    v_mfma_f32_16x16x32_bf16 v[156:159], v[36:39], v[12:15], v[156:159]
    ds_read_b64_tr_b16 v[54:55], v249 offset:45056
    v_mfma_f32_16x16x32_bf16 v[160:163], v[40:43], v[0:3], v[160:163]
    ds_read_b64_tr_b16 v[56:57], v250 offset:40960
    v_mfma_f32_16x16x32_bf16 v[164:167], v[40:43], v[4:7], v[164:167]
    ds_read_b64_tr_b16 v[58:59], v250 offset:45056
    v_mfma_f32_16x16x32_bf16 v[168:171], v[40:43], v[8:11], v[168:171]
    ds_read_b64_tr_b16 v[60:61], v251 offset:40960
    v_mfma_f32_16x16x32_bf16 v[172:175], v[40:43], v[12:15], v[172:175]
    ds_read_b64_tr_b16 v[62:63], v251 offset:45056
    v_mfma_f32_16x16x32_bf16 v[176:179], v[44:47], v[0:3], v[176:179]
    v_mfma_f32_16x16x32_bf16 v[180:183], v[44:47], v[4:7], v[180:183]
    v_mfma_f32_16x16x32_bf16 v[184:187], v[44:47], v[8:11], v[184:187]
    v_mfma_f32_16x16x32_bf16 v[188:191], v[44:47], v[12:15], v[188:191]
    s_waitcnt vmcnt(8) lgkmcnt(0)
    s_barrier
    .p2align 3
    v_mfma_f32_16x16x32_bf16 v[128:131], v[48:51], v[16:19], v[128:131]
    ds_read_b64_tr_b16 v[32:33], v244 offset:0
    v_mfma_f32_16x16x32_bf16 v[132:135], v[48:51], v[20:23], v[132:135]
    ds_read_b64_tr_b16 v[34:35], v244 offset:4096
    v_mfma_f32_16x16x32_bf16 v[136:139], v[48:51], v[24:27], v[136:139]
    ds_read_b128 v[0:3], v243 offset:0
    v_mfma_f32_16x16x32_bf16 v[140:143], v[48:51], v[28:31], v[140:143]
    ds_read_b128 v[4:7], v243 offset:2048
    v_mfma_f32_16x16x32_bf16 v[144:147], v[52:55], v[16:19], v[144:147]
    ds_read_b128 v[8:11], v243 offset:4096
    v_mfma_f32_16x16x32_bf16 v[148:151], v[52:55], v[20:23], v[148:151]
    ds_read_b128 v[12:15], v243 offset:6144
    v_mfma_f32_16x16x32_bf16 v[152:155], v[52:55], v[24:27], v[152:155]
    ds_read_b64_tr_b16 v[36:37], v245 offset:0
    v_mfma_f32_16x16x32_bf16 v[156:159], v[52:55], v[28:31], v[156:159]
    ds_read_b64_tr_b16 v[38:39], v245 offset:4096
    v_mfma_f32_16x16x32_bf16 v[160:163], v[56:59], v[16:19], v[160:163]
    ds_read_b64_tr_b16 v[40:41], v246 offset:0
    v_mfma_f32_16x16x32_bf16 v[164:167], v[56:59], v[20:23], v[164:167]
    ds_read_b64_tr_b16 v[42:43], v246 offset:4096
    v_mfma_f32_16x16x32_bf16 v[168:171], v[56:59], v[24:27], v[168:171]
    ds_read_b64_tr_b16 v[44:45], v247 offset:0
    v_mfma_f32_16x16x32_bf16 v[172:175], v[56:59], v[28:31], v[172:175]
    ds_read_b64_tr_b16 v[46:47], v247 offset:4096
    v_mfma_f32_16x16x32_bf16 v[176:179], v[60:63], v[16:19], v[176:179]
    v_mfma_f32_16x16x32_bf16 v[180:183], v[60:63], v[20:23], v[180:183]
    v_mfma_f32_16x16x32_bf16 v[184:187], v[60:63], v[24:27], v[184:187]
    v_mfma_f32_16x16x32_bf16 v[188:191], v[60:63], v[28:31], v[188:191]
    s_waitcnt lgkmcnt(0)
    .p2align 3
    v_mfma_f32_16x16x32_bf16 v[128:131], v[32:35], v[0:3], v[128:131]
    ds_read_b64_tr_b16 v[48:49], v244 offset:8192
    v_mfma_f32_16x16x32_bf16 v[132:135], v[32:35], v[4:7], v[132:135]
    ds_read_b64_tr_b16 v[50:51], v244 offset:12288
    v_mfma_f32_16x16x32_bf16 v[136:139], v[32:35], v[8:11], v[136:139]
    ds_read_b128 v[16:19], v243 offset:1024
    v_mfma_f32_16x16x32_bf16 v[140:143], v[32:35], v[12:15], v[140:143]
    ds_read_b128 v[20:23], v243 offset:3072
    v_mfma_f32_16x16x32_bf16 v[144:147], v[36:39], v[0:3], v[144:147]
    ds_read_b128 v[24:27], v243 offset:5120
    v_mfma_f32_16x16x32_bf16 v[148:151], v[36:39], v[4:7], v[148:151]
    ds_read_b128 v[28:31], v243 offset:7168
    v_mfma_f32_16x16x32_bf16 v[152:155], v[36:39], v[8:11], v[152:155]
    ds_read_b64_tr_b16 v[52:53], v245 offset:8192
    v_mfma_f32_16x16x32_bf16 v[156:159], v[36:39], v[12:15], v[156:159]
    ds_read_b64_tr_b16 v[54:55], v245 offset:12288
    v_mfma_f32_16x16x32_bf16 v[160:163], v[40:43], v[0:3], v[160:163]
    ds_read_b64_tr_b16 v[56:57], v246 offset:8192
    v_mfma_f32_16x16x32_bf16 v[164:167], v[40:43], v[4:7], v[164:167]
    ds_read_b64_tr_b16 v[58:59], v246 offset:12288
    v_mfma_f32_16x16x32_bf16 v[168:171], v[40:43], v[8:11], v[168:171]
    ds_read_b64_tr_b16 v[60:61], v247 offset:8192
    v_mfma_f32_16x16x32_bf16 v[172:175], v[40:43], v[12:15], v[172:175]
    ds_read_b64_tr_b16 v[62:63], v247 offset:12288
    v_mfma_f32_16x16x32_bf16 v[176:179], v[44:47], v[0:3], v[176:179]
    v_mfma_f32_16x16x32_bf16 v[180:183], v[44:47], v[4:7], v[180:183]
    v_mfma_f32_16x16x32_bf16 v[184:187], v[44:47], v[8:11], v[184:187]
    v_mfma_f32_16x16x32_bf16 v[188:191], v[44:47], v[12:15], v[188:191]
    s_waitcnt vmcnt(0) lgkmcnt(0)
    s_barrier
    .p2align 3
    v_mfma_f32_16x16x32_bf16 v[128:131], v[48:51], v[16:19], v[128:131]
    ds_read_b64_tr_b16 v[32:33], v244 offset:16384
    v_mfma_f32_16x16x32_bf16 v[132:135], v[48:51], v[20:23], v[132:135]
    ds_read_b64_tr_b16 v[34:35], v244 offset:20480
    v_mfma_f32_16x16x32_bf16 v[136:139], v[48:51], v[24:27], v[136:139]
    ds_read_b128 v[0:3], v243 offset:16384
    v_mfma_f32_16x16x32_bf16 v[140:143], v[48:51], v[28:31], v[140:143]
    ds_read_b128 v[4:7], v243 offset:18432
    v_mfma_f32_16x16x32_bf16 v[144:147], v[52:55], v[16:19], v[144:147]
    ds_read_b128 v[8:11], v243 offset:20480
    v_mfma_f32_16x16x32_bf16 v[148:151], v[52:55], v[20:23], v[148:151]
    ds_read_b128 v[12:15], v243 offset:22528
    v_mfma_f32_16x16x32_bf16 v[152:155], v[52:55], v[24:27], v[152:155]
    ds_read_b64_tr_b16 v[36:37], v245 offset:16384
    v_mfma_f32_16x16x32_bf16 v[156:159], v[52:55], v[28:31], v[156:159]
    ds_read_b64_tr_b16 v[38:39], v245 offset:20480
    v_mfma_f32_16x16x32_bf16 v[160:163], v[56:59], v[16:19], v[160:163]
    ds_read_b64_tr_b16 v[40:41], v246 offset:16384
    v_mfma_f32_16x16x32_bf16 v[164:167], v[56:59], v[20:23], v[164:167]
    ds_read_b64_tr_b16 v[42:43], v246 offset:20480
    v_mfma_f32_16x16x32_bf16 v[168:171], v[56:59], v[24:27], v[168:171]
    ds_read_b64_tr_b16 v[44:45], v247 offset:16384
    v_mfma_f32_16x16x32_bf16 v[172:175], v[56:59], v[28:31], v[172:175]
    ds_read_b64_tr_b16 v[46:47], v247 offset:20480
    v_mfma_f32_16x16x32_bf16 v[176:179], v[60:63], v[16:19], v[176:179]
    v_mfma_f32_16x16x32_bf16 v[180:183], v[60:63], v[20:23], v[180:183]
    v_mfma_f32_16x16x32_bf16 v[184:187], v[60:63], v[24:27], v[184:187]
    v_mfma_f32_16x16x32_bf16 v[188:191], v[60:63], v[28:31], v[188:191]
    s_waitcnt lgkmcnt(0)
    .p2align 3
    v_mfma_f32_16x16x32_bf16 v[128:131], v[32:35], v[0:3], v[128:131]
    ds_read_b64_tr_b16 v[48:49], v244 offset:24576
    v_mfma_f32_16x16x32_bf16 v[132:135], v[32:35], v[4:7], v[132:135]
    ds_read_b64_tr_b16 v[50:51], v244 offset:28672
    v_mfma_f32_16x16x32_bf16 v[136:139], v[32:35], v[8:11], v[136:139]
    ds_read_b128 v[16:19], v243 offset:17408
    v_mfma_f32_16x16x32_bf16 v[140:143], v[32:35], v[12:15], v[140:143]
    ds_read_b128 v[20:23], v243 offset:19456
    v_mfma_f32_16x16x32_bf16 v[144:147], v[36:39], v[0:3], v[144:147]
    ds_read_b128 v[24:27], v243 offset:21504
    v_mfma_f32_16x16x32_bf16 v[148:151], v[36:39], v[4:7], v[148:151]
    ds_read_b128 v[28:31], v243 offset:23552
    v_mfma_f32_16x16x32_bf16 v[152:155], v[36:39], v[8:11], v[152:155]
    ds_read_b64_tr_b16 v[52:53], v245 offset:24576
    v_mfma_f32_16x16x32_bf16 v[156:159], v[36:39], v[12:15], v[156:159]
    ds_read_b64_tr_b16 v[54:55], v245 offset:28672
    v_mfma_f32_16x16x32_bf16 v[160:163], v[40:43], v[0:3], v[160:163]
    ds_read_b64_tr_b16 v[56:57], v246 offset:24576
    v_mfma_f32_16x16x32_bf16 v[164:167], v[40:43], v[4:7], v[164:167]
    ds_read_b64_tr_b16 v[58:59], v246 offset:28672
    v_mfma_f32_16x16x32_bf16 v[168:171], v[40:43], v[8:11], v[168:171]
    ds_read_b64_tr_b16 v[60:61], v247 offset:24576
    v_mfma_f32_16x16x32_bf16 v[172:175], v[40:43], v[12:15], v[172:175]
    ds_read_b64_tr_b16 v[62:63], v247 offset:28672
    v_mfma_f32_16x16x32_bf16 v[176:179], v[44:47], v[0:3], v[176:179]
    v_mfma_f32_16x16x32_bf16 v[180:183], v[44:47], v[4:7], v[180:183]
    v_mfma_f32_16x16x32_bf16 v[184:187], v[44:47], v[8:11], v[184:187]
    v_mfma_f32_16x16x32_bf16 v[188:191], v[44:47], v[12:15], v[188:191]
    s_waitcnt lgkmcnt(0)
    s_barrier
    .p2align 3
    v_mfma_f32_16x16x32_bf16 v[128:131], v[48:51], v[16:19], v[128:131]
    ds_read_b64_tr_b16 v[32:33], v244 offset:32768
    v_mfma_f32_16x16x32_bf16 v[132:135], v[48:51], v[20:23], v[132:135]
    ds_read_b64_tr_b16 v[34:35], v244 offset:36864
    v_mfma_f32_16x16x32_bf16 v[136:139], v[48:51], v[24:27], v[136:139]
    ds_read_b128 v[0:3], v243 offset:32768
    v_mfma_f32_16x16x32_bf16 v[140:143], v[48:51], v[28:31], v[140:143]
    ds_read_b128 v[4:7], v243 offset:34816
    v_mfma_f32_16x16x32_bf16 v[144:147], v[52:55], v[16:19], v[144:147]
    ds_read_b128 v[8:11], v243 offset:36864
    v_mfma_f32_16x16x32_bf16 v[148:151], v[52:55], v[20:23], v[148:151]
    ds_read_b128 v[12:15], v243 offset:38912
    v_mfma_f32_16x16x32_bf16 v[152:155], v[52:55], v[24:27], v[152:155]
    ds_read_b64_tr_b16 v[36:37], v245 offset:32768
    v_mfma_f32_16x16x32_bf16 v[156:159], v[52:55], v[28:31], v[156:159]
    ds_read_b64_tr_b16 v[38:39], v245 offset:36864
    v_mfma_f32_16x16x32_bf16 v[160:163], v[56:59], v[16:19], v[160:163]
    ds_read_b64_tr_b16 v[40:41], v246 offset:32768
    v_mfma_f32_16x16x32_bf16 v[164:167], v[56:59], v[20:23], v[164:167]
    ds_read_b64_tr_b16 v[42:43], v246 offset:36864
    v_mfma_f32_16x16x32_bf16 v[168:171], v[56:59], v[24:27], v[168:171]
    ds_read_b64_tr_b16 v[44:45], v247 offset:32768
    v_mfma_f32_16x16x32_bf16 v[172:175], v[56:59], v[28:31], v[172:175]
    ds_read_b64_tr_b16 v[46:47], v247 offset:36864
    v_mfma_f32_16x16x32_bf16 v[176:179], v[60:63], v[16:19], v[176:179]
    v_mfma_f32_16x16x32_bf16 v[180:183], v[60:63], v[20:23], v[180:183]
    s_sub_u32 s58, s58, 1
    s_cmp_lg_u32 s58, 0
    .p2align 3
    v_mfma_f32_16x16x32_bf16 v[184:187], v[60:63], v[24:27], v[184:187]
    v_mfma_f32_16x16x32_bf16 v[188:191], v[60:63], v[28:31], v[188:191]
    s_cbranch_scc1 loop_22
    s_waitcnt lgkmcnt(0)
    .p2align 3
    v_mfma_f32_16x16x32_bf16 v[128:131], v[32:35], v[0:3], v[128:131]
    ds_read_b64_tr_b16 v[48:49], v244 offset:40960
    v_mfma_f32_16x16x32_bf16 v[132:135], v[32:35], v[4:7], v[132:135]
    ds_read_b64_tr_b16 v[50:51], v244 offset:45056
    v_mfma_f32_16x16x32_bf16 v[136:139], v[32:35], v[8:11], v[136:139]
    ds_read_b128 v[16:19], v243 offset:33792
    v_mfma_f32_16x16x32_bf16 v[140:143], v[32:35], v[12:15], v[140:143]
    ds_read_b128 v[20:23], v243 offset:35840
    v_mfma_f32_16x16x32_bf16 v[144:147], v[36:39], v[0:3], v[144:147]
    ds_read_b128 v[24:27], v243 offset:37888
    v_mfma_f32_16x16x32_bf16 v[148:151], v[36:39], v[4:7], v[148:151]
    ds_read_b128 v[28:31], v243 offset:39936
    v_mfma_f32_16x16x32_bf16 v[152:155], v[36:39], v[8:11], v[152:155]
    ds_read_b64_tr_b16 v[52:53], v245 offset:40960
    v_mfma_f32_16x16x32_bf16 v[156:159], v[36:39], v[12:15], v[156:159]
    ds_read_b64_tr_b16 v[54:55], v245 offset:45056
    v_mfma_f32_16x16x32_bf16 v[160:163], v[40:43], v[0:3], v[160:163]
    ds_read_b64_tr_b16 v[56:57], v246 offset:40960
    v_mfma_f32_16x16x32_bf16 v[164:167], v[40:43], v[4:7], v[164:167]
    ds_read_b64_tr_b16 v[58:59], v246 offset:45056
    v_mfma_f32_16x16x32_bf16 v[168:171], v[40:43], v[8:11], v[168:171]
    ds_read_b64_tr_b16 v[60:61], v247 offset:40960
    v_mfma_f32_16x16x32_bf16 v[172:175], v[40:43], v[12:15], v[172:175]
    ds_read_b64_tr_b16 v[62:63], v247 offset:45056
    v_mfma_f32_16x16x32_bf16 v[176:179], v[44:47], v[0:3], v[176:179]
    v_mfma_f32_16x16x32_bf16 v[180:183], v[44:47], v[4:7], v[180:183]
    v_mfma_f32_16x16x32_bf16 v[184:187], v[44:47], v[8:11], v[184:187]
    v_mfma_f32_16x16x32_bf16 v[188:191], v[44:47], v[12:15], v[188:191]
    s_waitcnt lgkmcnt(0)
    s_barrier
    .p2align 3
    v_mfma_f32_16x16x32_bf16 v[128:131], v[48:51], v[16:19], v[128:131]
    ds_read_b64_tr_b16 v[32:33], v248 offset:0
    v_mfma_f32_16x16x32_bf16 v[132:135], v[48:51], v[20:23], v[132:135]
    ds_read_b64_tr_b16 v[34:35], v248 offset:4096
    v_mfma_f32_16x16x32_bf16 v[136:139], v[48:51], v[24:27], v[136:139]
    ds_read_b128 v[0:3], v243 offset:0
    v_mfma_f32_16x16x32_bf16 v[140:143], v[48:51], v[28:31], v[140:143]
    ds_read_b128 v[4:7], v243 offset:2048
    v_mfma_f32_16x16x32_bf16 v[144:147], v[52:55], v[16:19], v[144:147]
    ds_read_b128 v[8:11], v243 offset:4096
    v_mfma_f32_16x16x32_bf16 v[148:151], v[52:55], v[20:23], v[148:151]
    ds_read_b128 v[12:15], v243 offset:6144
    v_mfma_f32_16x16x32_bf16 v[152:155], v[52:55], v[24:27], v[152:155]
    ds_read_b64_tr_b16 v[36:37], v249 offset:0
    v_mfma_f32_16x16x32_bf16 v[156:159], v[52:55], v[28:31], v[156:159]
    ds_read_b64_tr_b16 v[38:39], v249 offset:4096
    v_mfma_f32_16x16x32_bf16 v[160:163], v[56:59], v[16:19], v[160:163]
    ds_read_b64_tr_b16 v[40:41], v250 offset:0
    v_mfma_f32_16x16x32_bf16 v[164:167], v[56:59], v[20:23], v[164:167]
    ds_read_b64_tr_b16 v[42:43], v250 offset:4096
    v_mfma_f32_16x16x32_bf16 v[168:171], v[56:59], v[24:27], v[168:171]
    ds_read_b64_tr_b16 v[44:45], v251 offset:0
    v_mfma_f32_16x16x32_bf16 v[172:175], v[56:59], v[28:31], v[172:175]
    ds_read_b64_tr_b16 v[46:47], v251 offset:4096
    v_mfma_f32_16x16x32_bf16 v[176:179], v[60:63], v[16:19], v[176:179]
    v_mfma_f32_16x16x32_bf16 v[180:183], v[60:63], v[20:23], v[180:183]
    v_mfma_f32_16x16x32_bf16 v[184:187], v[60:63], v[24:27], v[184:187]
    v_mfma_f32_16x16x32_bf16 v[188:191], v[60:63], v[28:31], v[188:191]
    s_waitcnt lgkmcnt(0)
    .p2align 3
    v_mfma_f32_16x16x32_bf16 v[128:131], v[32:35], v[0:3], v[128:131]
    ds_read_b64_tr_b16 v[48:49], v248 offset:8192
    v_mfma_f32_16x16x32_bf16 v[132:135], v[32:35], v[4:7], v[132:135]
    ds_read_b64_tr_b16 v[50:51], v248 offset:12288
    v_mfma_f32_16x16x32_bf16 v[136:139], v[32:35], v[8:11], v[136:139]
    ds_read_b128 v[16:19], v243 offset:1024
    v_mfma_f32_16x16x32_bf16 v[140:143], v[32:35], v[12:15], v[140:143]
    ds_read_b128 v[20:23], v243 offset:3072
    v_mfma_f32_16x16x32_bf16 v[144:147], v[36:39], v[0:3], v[144:147]
    ds_read_b128 v[24:27], v243 offset:5120
    v_mfma_f32_16x16x32_bf16 v[148:151], v[36:39], v[4:7], v[148:151]
    ds_read_b128 v[28:31], v243 offset:7168
    v_mfma_f32_16x16x32_bf16 v[152:155], v[36:39], v[8:11], v[152:155]
    ds_read_b64_tr_b16 v[52:53], v249 offset:8192
    v_mfma_f32_16x16x32_bf16 v[156:159], v[36:39], v[12:15], v[156:159]
    ds_read_b64_tr_b16 v[54:55], v249 offset:12288
    v_mfma_f32_16x16x32_bf16 v[160:163], v[40:43], v[0:3], v[160:163]
    ds_read_b64_tr_b16 v[56:57], v250 offset:8192
    v_mfma_f32_16x16x32_bf16 v[164:167], v[40:43], v[4:7], v[164:167]
    ds_read_b64_tr_b16 v[58:59], v250 offset:12288
    v_mfma_f32_16x16x32_bf16 v[168:171], v[40:43], v[8:11], v[168:171]
    ds_read_b64_tr_b16 v[60:61], v251 offset:8192
    v_mfma_f32_16x16x32_bf16 v[172:175], v[40:43], v[12:15], v[172:175]
    ds_read_b64_tr_b16 v[62:63], v251 offset:12288
    v_mfma_f32_16x16x32_bf16 v[176:179], v[44:47], v[0:3], v[176:179]
    v_mfma_f32_16x16x32_bf16 v[180:183], v[44:47], v[4:7], v[180:183]
    v_mfma_f32_16x16x32_bf16 v[184:187], v[44:47], v[8:11], v[184:187]
    v_mfma_f32_16x16x32_bf16 v[188:191], v[44:47], v[12:15], v[188:191]
    s_waitcnt lgkmcnt(0)
    s_barrier
    .p2align 3
    v_mfma_f32_16x16x32_bf16 v[128:131], v[48:51], v[16:19], v[128:131]
    ds_read_b64_tr_b16 v[32:33], v248 offset:16384
    v_mfma_f32_16x16x32_bf16 v[132:135], v[48:51], v[20:23], v[132:135]
    ds_read_b64_tr_b16 v[34:35], v248 offset:20480
    v_mfma_f32_16x16x32_bf16 v[136:139], v[48:51], v[24:27], v[136:139]
    ds_read_b128 v[0:3], v243 offset:16384
    v_mfma_f32_16x16x32_bf16 v[140:143], v[48:51], v[28:31], v[140:143]
    ds_read_b128 v[4:7], v243 offset:18432
    v_mfma_f32_16x16x32_bf16 v[144:147], v[52:55], v[16:19], v[144:147]
    ds_read_b128 v[8:11], v243 offset:20480
    v_mfma_f32_16x16x32_bf16 v[148:151], v[52:55], v[20:23], v[148:151]
    ds_read_b128 v[12:15], v243 offset:22528
    v_mfma_f32_16x16x32_bf16 v[152:155], v[52:55], v[24:27], v[152:155]
    ds_read_b64_tr_b16 v[36:37], v249 offset:16384
    v_mfma_f32_16x16x32_bf16 v[156:159], v[52:55], v[28:31], v[156:159]
    ds_read_b64_tr_b16 v[38:39], v249 offset:20480
    v_mfma_f32_16x16x32_bf16 v[160:163], v[56:59], v[16:19], v[160:163]
    ds_read_b64_tr_b16 v[40:41], v250 offset:16384
    v_mfma_f32_16x16x32_bf16 v[164:167], v[56:59], v[20:23], v[164:167]
    ds_read_b64_tr_b16 v[42:43], v250 offset:20480
    v_mfma_f32_16x16x32_bf16 v[168:171], v[56:59], v[24:27], v[168:171]
    ds_read_b64_tr_b16 v[44:45], v251 offset:16384
    v_mfma_f32_16x16x32_bf16 v[172:175], v[56:59], v[28:31], v[172:175]
    ds_read_b64_tr_b16 v[46:47], v251 offset:20480
    v_mfma_f32_16x16x32_bf16 v[176:179], v[60:63], v[16:19], v[176:179]
    v_mfma_f32_16x16x32_bf16 v[180:183], v[60:63], v[20:23], v[180:183]
    v_mfma_f32_16x16x32_bf16 v[184:187], v[60:63], v[24:27], v[184:187]
    v_mfma_f32_16x16x32_bf16 v[188:191], v[60:63], v[28:31], v[188:191]
    s_waitcnt lgkmcnt(0)
    .p2align 3
    v_mfma_f32_16x16x32_bf16 v[128:131], v[32:35], v[0:3], v[128:131]
    ds_read_b64_tr_b16 v[48:49], v248 offset:24576
    v_mfma_f32_16x16x32_bf16 v[132:135], v[32:35], v[4:7], v[132:135]
    ds_read_b64_tr_b16 v[50:51], v248 offset:28672
    v_mfma_f32_16x16x32_bf16 v[136:139], v[32:35], v[8:11], v[136:139]
    ds_read_b128 v[16:19], v243 offset:17408
    v_mfma_f32_16x16x32_bf16 v[140:143], v[32:35], v[12:15], v[140:143]
    ds_read_b128 v[20:23], v243 offset:19456
    v_mfma_f32_16x16x32_bf16 v[144:147], v[36:39], v[0:3], v[144:147]
    ds_read_b128 v[24:27], v243 offset:21504
    v_mfma_f32_16x16x32_bf16 v[148:151], v[36:39], v[4:7], v[148:151]
    ds_read_b128 v[28:31], v243 offset:23552
    v_mfma_f32_16x16x32_bf16 v[152:155], v[36:39], v[8:11], v[152:155]
    ds_read_b64_tr_b16 v[52:53], v249 offset:24576
    v_mfma_f32_16x16x32_bf16 v[156:159], v[36:39], v[12:15], v[156:159]
    ds_read_b64_tr_b16 v[54:55], v249 offset:28672
    v_mfma_f32_16x16x32_bf16 v[160:163], v[40:43], v[0:3], v[160:163]
    ds_read_b64_tr_b16 v[56:57], v250 offset:24576
    v_mfma_f32_16x16x32_bf16 v[164:167], v[40:43], v[4:7], v[164:167]
    ds_read_b64_tr_b16 v[58:59], v250 offset:28672
    v_mfma_f32_16x16x32_bf16 v[168:171], v[40:43], v[8:11], v[168:171]
    ds_read_b64_tr_b16 v[60:61], v251 offset:24576
    v_mfma_f32_16x16x32_bf16 v[172:175], v[40:43], v[12:15], v[172:175]
    ds_read_b64_tr_b16 v[62:63], v251 offset:28672
    v_mfma_f32_16x16x32_bf16 v[176:179], v[44:47], v[0:3], v[176:179]
    v_mfma_f32_16x16x32_bf16 v[180:183], v[44:47], v[4:7], v[180:183]
    v_mfma_f32_16x16x32_bf16 v[184:187], v[44:47], v[8:11], v[184:187]
    v_mfma_f32_16x16x32_bf16 v[188:191], v[44:47], v[12:15], v[188:191]
    s_waitcnt lgkmcnt(0)
    s_barrier
    .p2align 3
    v_mfma_f32_16x16x32_bf16 v[128:131], v[48:51], v[16:19], v[128:131]
    ds_read_b64_tr_b16 v[32:33], v248 offset:32768
    v_mfma_f32_16x16x32_bf16 v[132:135], v[48:51], v[20:23], v[132:135]
    ds_read_b64_tr_b16 v[34:35], v248 offset:36864
    v_mfma_f32_16x16x32_bf16 v[136:139], v[48:51], v[24:27], v[136:139]
    ds_read_b128 v[0:3], v243 offset:32768
    v_mfma_f32_16x16x32_bf16 v[140:143], v[48:51], v[28:31], v[140:143]
    ds_read_b128 v[4:7], v243 offset:34816
    v_mfma_f32_16x16x32_bf16 v[144:147], v[52:55], v[16:19], v[144:147]
    ds_read_b128 v[8:11], v243 offset:36864
    v_mfma_f32_16x16x32_bf16 v[148:151], v[52:55], v[20:23], v[148:151]
    ds_read_b128 v[12:15], v243 offset:38912
    v_mfma_f32_16x16x32_bf16 v[152:155], v[52:55], v[24:27], v[152:155]
    ds_read_b64_tr_b16 v[36:37], v249 offset:32768
    v_mfma_f32_16x16x32_bf16 v[156:159], v[52:55], v[28:31], v[156:159]
    ds_read_b64_tr_b16 v[38:39], v249 offset:36864
    v_mfma_f32_16x16x32_bf16 v[160:163], v[56:59], v[16:19], v[160:163]
    ds_read_b64_tr_b16 v[40:41], v250 offset:32768
    v_mfma_f32_16x16x32_bf16 v[164:167], v[56:59], v[20:23], v[164:167]
    ds_read_b64_tr_b16 v[42:43], v250 offset:36864
    v_mfma_f32_16x16x32_bf16 v[168:171], v[56:59], v[24:27], v[168:171]
    ds_read_b64_tr_b16 v[44:45], v251 offset:32768
    v_mfma_f32_16x16x32_bf16 v[172:175], v[56:59], v[28:31], v[172:175]
    ds_read_b64_tr_b16 v[46:47], v251 offset:36864
    v_mfma_f32_16x16x32_bf16 v[176:179], v[60:63], v[16:19], v[176:179]
    v_mfma_f32_16x16x32_bf16 v[180:183], v[60:63], v[20:23], v[180:183]
    v_mfma_f32_16x16x32_bf16 v[184:187], v[60:63], v[24:27], v[184:187]
    v_mfma_f32_16x16x32_bf16 v[188:191], v[60:63], v[28:31], v[188:191]
    s_waitcnt lgkmcnt(0)
    .p2align 3
    v_mfma_f32_16x16x32_bf16 v[128:131], v[32:35], v[0:3], v[128:131]
    ds_read_b64_tr_b16 v[48:49], v248 offset:40960
    v_mfma_f32_16x16x32_bf16 v[132:135], v[32:35], v[4:7], v[132:135]
    ds_read_b64_tr_b16 v[50:51], v248 offset:45056
    v_mfma_f32_16x16x32_bf16 v[136:139], v[32:35], v[8:11], v[136:139]
    ds_read_b128 v[16:19], v243 offset:33792
    v_mfma_f32_16x16x32_bf16 v[140:143], v[32:35], v[12:15], v[140:143]
    ds_read_b128 v[20:23], v243 offset:35840
    v_mfma_f32_16x16x32_bf16 v[144:147], v[36:39], v[0:3], v[144:147]
    ds_read_b128 v[24:27], v243 offset:37888
    v_mfma_f32_16x16x32_bf16 v[148:151], v[36:39], v[4:7], v[148:151]
    ds_read_b128 v[28:31], v243 offset:39936
    v_mfma_f32_16x16x32_bf16 v[152:155], v[36:39], v[8:11], v[152:155]
    ds_read_b64_tr_b16 v[52:53], v249 offset:40960
    v_mfma_f32_16x16x32_bf16 v[156:159], v[36:39], v[12:15], v[156:159]
    ds_read_b64_tr_b16 v[54:55], v249 offset:45056
    v_mfma_f32_16x16x32_bf16 v[160:163], v[40:43], v[0:3], v[160:163]
    ds_read_b64_tr_b16 v[56:57], v250 offset:40960
    v_mfma_f32_16x16x32_bf16 v[164:167], v[40:43], v[4:7], v[164:167]
    ds_read_b64_tr_b16 v[58:59], v250 offset:45056
    v_mfma_f32_16x16x32_bf16 v[168:171], v[40:43], v[8:11], v[168:171]
    ds_read_b64_tr_b16 v[60:61], v251 offset:40960
    v_mfma_f32_16x16x32_bf16 v[172:175], v[40:43], v[12:15], v[172:175]
    ds_read_b64_tr_b16 v[62:63], v251 offset:45056
    v_mfma_f32_16x16x32_bf16 v[176:179], v[44:47], v[0:3], v[176:179]
    v_mfma_f32_16x16x32_bf16 v[180:183], v[44:47], v[4:7], v[180:183]
    v_mfma_f32_16x16x32_bf16 v[184:187], v[44:47], v[8:11], v[184:187]
    v_mfma_f32_16x16x32_bf16 v[188:191], v[44:47], v[12:15], v[188:191]
    s_waitcnt lgkmcnt(0)
    s_barrier
    .p2align 3
    v_mfma_f32_16x16x32_bf16 v[128:131], v[48:51], v[16:19], v[128:131]
    v_mfma_f32_16x16x32_bf16 v[132:135], v[48:51], v[20:23], v[132:135]
    v_mfma_f32_16x16x32_bf16 v[136:139], v[48:51], v[24:27], v[136:139]
    v_mfma_f32_16x16x32_bf16 v[140:143], v[48:51], v[28:31], v[140:143]
    v_mfma_f32_16x16x32_bf16 v[144:147], v[52:55], v[16:19], v[144:147]
    v_mfma_f32_16x16x32_bf16 v[148:151], v[52:55], v[20:23], v[148:151]
    v_mfma_f32_16x16x32_bf16 v[152:155], v[52:55], v[24:27], v[152:155]
    v_mfma_f32_16x16x32_bf16 v[156:159], v[52:55], v[28:31], v[156:159]
    v_mfma_f32_16x16x32_bf16 v[160:163], v[56:59], v[16:19], v[160:163]
    v_mfma_f32_16x16x32_bf16 v[164:167], v[56:59], v[20:23], v[164:167]
    v_mfma_f32_16x16x32_bf16 v[168:171], v[56:59], v[24:27], v[168:171]
    v_mfma_f32_16x16x32_bf16 v[172:175], v[56:59], v[28:31], v[172:175]
    v_mfma_f32_16x16x32_bf16 v[176:179], v[60:63], v[16:19], v[176:179]
    v_mfma_f32_16x16x32_bf16 v[180:183], v[60:63], v[20:23], v[180:183]
    v_mfma_f32_16x16x32_bf16 v[184:187], v[60:63], v[24:27], v[184:187]
    v_mfma_f32_16x16x32_bf16 v[188:191], v[60:63], v[28:31], v[188:191]
    s_nop 7
    v_cvt_pk_bf16_f32 v64, v160, v161
    v_cvt_pk_bf16_f32 v65, v162, v163
    v_cvt_pk_bf16_f32 v66, v176, v177
    v_cvt_pk_bf16_f32 v67, v178, v179
    v_min_u32 v64, -2, v64
    v_min_u32 v65, -2, v65
    v_min_u32 v66, -2, v66
    v_min_u32 v67, -2, v67
    buffer_store_dwordx4 v[64:67], v254, s[4:7], s62 offen offset:0 sc0 sc1
    v_cvt_pk_bf16_f32 v68, v164, v165
    v_cvt_pk_bf16_f32 v69, v166, v167
    v_cvt_pk_bf16_f32 v70, v180, v181
    v_cvt_pk_bf16_f32 v71, v182, v183
    v_min_u32 v68, -2, v68
    v_min_u32 v69, -2, v69
    v_min_u32 v70, -2, v70
    v_min_u32 v71, -2, v71
    buffer_store_dwordx4 v[68:71], v254, s[4:7], s62 offen offset:1024 sc0 sc1
    v_cvt_pk_bf16_f32 v72, v168, v169
    v_cvt_pk_bf16_f32 v73, v170, v171
    v_cvt_pk_bf16_f32 v74, v184, v185
    v_cvt_pk_bf16_f32 v75, v186, v187
    v_min_u32 v72, -2, v72
    v_min_u32 v73, -2, v73
    v_min_u32 v74, -2, v74
    v_min_u32 v75, -2, v75
    buffer_store_dwordx4 v[72:75], v254, s[4:7], s62 offen offset:2048 sc0 sc1
    v_cvt_pk_bf16_f32 v76, v172, v173
    v_cvt_pk_bf16_f32 v77, v174, v175
    v_cvt_pk_bf16_f32 v78, v188, v189
    v_cvt_pk_bf16_f32 v79, v190, v191
    v_min_u32 v76, -2, v76
    v_min_u32 v77, -2, v77
    v_min_u32 v78, -2, v78
    v_min_u32 v79, -2, v79
    buffer_store_dwordx4 v[76:79], v254, s[4:7], s62 offen offset:3072 sc0 sc1
    s_mov_b32 s56, 262144
poll_23:
    buffer_load_dwordx4 v[80:83], v254, s[4:7], s63 offen offset:0 sc0 sc1
    buffer_load_dwordx4 v[84:87], v254, s[4:7], s63 offen offset:1024 sc0 sc1
    buffer_load_dwordx4 v[88:91], v254, s[4:7], s63 offen offset:2048 sc0 sc1
    buffer_load_dwordx4 v[92:95], v254, s[4:7], s63 offen offset:3072 sc0 sc1
    s_waitcnt vmcnt(0)
    v_max3_u32 v192, v80, v81, v82
    v_max3_u32 v193, v83, v84, v85
    v_max3_u32 v192, v192, v86, v87
    v_max3_u32 v193, v193, v88, v89
    v_max3_u32 v192, v192, v90, v91
    v_max3_u32 v193, v193, v92, v93
    v_max3_u32 v192, v192, v94, v95
    v_max_u32 v192, v192, v193
    v_cmp_eq_u32 vcc, -1, v192
    s_cbranch_vccz pd_24
    s_sub_u32 s56, s56, 1
    s_cmp_lg_u32 s56, 0
    s_cbranch_scc1 poll_23
pd_24:
    v_lshlrev_b32 v160, 16, v80
    v_and_b32 v161, 0xffff0000, v80
    v_lshlrev_b32 v162, 16, v81
    v_and_b32 v163, 0xffff0000, v81
    v_pk_add_f32 v[128:129], v[128:129], v[160:161]
    v_pk_add_f32 v[130:131], v[130:131], v[162:163]
    v_lshlrev_b32 v160, 16, v82
    v_and_b32 v161, 0xffff0000, v82
    v_lshlrev_b32 v162, 16, v83
    v_and_b32 v163, 0xffff0000, v83
    v_pk_add_f32 v[144:145], v[144:145], v[160:161]
    v_pk_add_f32 v[146:147], v[146:147], v[162:163]
    v_lshlrev_b32 v160, 16, v84
    v_and_b32 v161, 0xffff0000, v84
    v_lshlrev_b32 v162, 16, v85
    v_and_b32 v163, 0xffff0000, v85
    v_pk_add_f32 v[132:133], v[132:133], v[160:161]
    v_pk_add_f32 v[134:135], v[134:135], v[162:163]
    v_lshlrev_b32 v160, 16, v86
    v_and_b32 v161, 0xffff0000, v86
    v_lshlrev_b32 v162, 16, v87
    v_and_b32 v163, 0xffff0000, v87
    v_pk_add_f32 v[148:149], v[148:149], v[160:161]
    v_pk_add_f32 v[150:151], v[150:151], v[162:163]
    v_lshlrev_b32 v160, 16, v88
    v_and_b32 v161, 0xffff0000, v88
    v_lshlrev_b32 v162, 16, v89
    v_and_b32 v163, 0xffff0000, v89
    v_pk_add_f32 v[136:137], v[136:137], v[160:161]
    v_pk_add_f32 v[138:139], v[138:139], v[162:163]
    v_lshlrev_b32 v160, 16, v90
    v_and_b32 v161, 0xffff0000, v90
    v_lshlrev_b32 v162, 16, v91
    v_and_b32 v163, 0xffff0000, v91
    v_pk_add_f32 v[152:153], v[152:153], v[160:161]
    v_pk_add_f32 v[154:155], v[154:155], v[162:163]
    v_lshlrev_b32 v160, 16, v92
    v_and_b32 v161, 0xffff0000, v92
    v_lshlrev_b32 v162, 16, v93
    v_and_b32 v163, 0xffff0000, v93
    v_pk_add_f32 v[140:141], v[140:141], v[160:161]
    v_pk_add_f32 v[142:143], v[142:143], v[162:163]
    v_lshlrev_b32 v160, 16, v94
    v_and_b32 v161, 0xffff0000, v94
    v_lshlrev_b32 v162, 16, v95
    v_and_b32 v163, 0xffff0000, v95
    v_pk_add_f32 v[156:157], v[156:157], v[160:161]
    v_pk_add_f32 v[158:159], v[158:159], v[162:163]
    s_cmp_lg_u32 s46, 0
    s_cbranch_scc1 X_fin
    s_lshl_b32 s55, s51, 14
    s_lshl_b32 s56, s43, 13
    s_add_u32 s55, s55, s56
    s_lshl_b32 s56, s44, 10
    s_add_u32 s55, s55, s56
    s_add_u32 s59, s55, s48
    s_add_u32 s60, s59, 4096
    v_cvt_pk_bf16_f32 v216, v128, v129
    v_cvt_pk_bf16_f32 v217, v130, v131
    v_cvt_pk_bf16_f32 v218, v144, v145
    v_cvt_pk_bf16_f32 v219, v146, v147
    buffer_store_dwordx4 v[216:219], v254, s[4:7], s59 offen offset:0 sc0 sc1
    v_cvt_pk_bf16_f32 v220, v132, v133
    v_cvt_pk_bf16_f32 v221, v134, v135
    v_cvt_pk_bf16_f32 v222, v148, v149
    v_cvt_pk_bf16_f32 v223, v150, v151
    buffer_store_dwordx4 v[220:223], v254, s[4:7], s59 offen offset:2048 sc0 sc1
    v_cvt_pk_bf16_f32 v224, v136, v137
    v_cvt_pk_bf16_f32 v225, v138, v139
    v_cvt_pk_bf16_f32 v226, v152, v153
    v_cvt_pk_bf16_f32 v227, v154, v155
    buffer_store_dwordx4 v[224:227], v254, s[4:7], s60 offen offset:0 sc0 sc1
    v_cvt_pk_bf16_f32 v228, v140, v141
    v_cvt_pk_bf16_f32 v229, v142, v143
    v_cvt_pk_bf16_f32 v230, v156, v157
    v_cvt_pk_bf16_f32 v231, v158, v159
    buffer_store_dwordx4 v[228:231], v254, s[4:7], s60 offen offset:2048 sc0 sc1
    v_mov_b32 v240, 0x3f803f80
    v_mov_b32 v232, 0
    v_mov_b32 v236, 0
    v_mov_b32 v233, 0
    v_mov_b32 v237, 0
    v_mov_b32 v234, 0
    v_mov_b32 v238, 0
    v_mov_b32 v235, 0
    v_mov_b32 v239, 0
    v_dot2_f32_bf16 v232, v216, v240, v232
    v_dot2_f32_bf16 v236, v216, v216, v236
    v_dot2_f32_bf16 v233, v220, v240, v233
    v_dot2_f32_bf16 v237, v220, v220, v237
    v_dot2_f32_bf16 v234, v224, v240, v234
    v_dot2_f32_bf16 v238, v224, v224, v238
    v_dot2_f32_bf16 v235, v228, v240, v235
    v_dot2_f32_bf16 v239, v228, v228, v239
    v_dot2_f32_bf16 v232, v217, v240, v232
    v_dot2_f32_bf16 v236, v217, v217, v236
    v_dot2_f32_bf16 v233, v221, v240, v233
    v_dot2_f32_bf16 v237, v221, v221, v237
    v_dot2_f32_bf16 v234, v225, v240, v234
    v_dot2_f32_bf16 v238, v225, v225, v238
    v_dot2_f32_bf16 v235, v229, v240, v235
    v_dot2_f32_bf16 v239, v229, v229, v239
    v_dot2_f32_bf16 v232, v218, v240, v232
    v_dot2_f32_bf16 v236, v218, v218, v236
    v_dot2_f32_bf16 v233, v222, v240, v233
    v_dot2_f32_bf16 v237, v222, v222, v237
    v_dot2_f32_bf16 v234, v226, v240, v234
    v_dot2_f32_bf16 v238, v226, v226, v238
    v_dot2_f32_bf16 v235, v230, v240, v235
    v_dot2_f32_bf16 v239, v230, v230, v239
    v_dot2_f32_bf16 v232, v219, v240, v232
    v_dot2_f32_bf16 v236, v219, v219, v236
    v_dot2_f32_bf16 v233, v223, v240, v233
    v_dot2_f32_bf16 v237, v223, v223, v237
    v_dot2_f32_bf16 v234, v227, v240, v234
    v_dot2_f32_bf16 v238, v227, v227, v238
    v_dot2_f32_bf16 v235, v231, v240, v235
    v_dot2_f32_bf16 v239, v231, v231, v239
    s_nop 3
    v_permlane32_swap_b32 v232, v234
    v_permlane32_swap_b32 v233, v235
    v_permlane32_swap_b32 v236, v238
    v_permlane32_swap_b32 v237, v239
    v_add_f32 v232, v232, v234
    v_add_f32 v233, v233, v235
    v_add_f32 v236, v236, v238
    v_add_f32 v237, v237, v239
    s_nop 1
    v_permlane16_swap_b32 v232, v233
    v_permlane16_swap_b32 v236, v237
    v_add_f32 v232, v232, v233
    v_add_f32 v233, v236, v237
    s_lshl_b32 s55, s51, 11
    s_lshl_b32 s56, s44, 10
    s_add_u32 s55, s55, s56
    s_lshl_b32 s56, s43, 9
    s_add_u32 s55, s55, s56
    s_add_u32 s59, s55, s53
    v_lshrrev_b32 v236, 1, v254
    s_waitcnt vmcnt(0)
    s_barrier
    buffer_store_dwordx2 v[232:233], v236, s[4:7], s59 offen sc0 sc1
    s_mov_b32 s46, 1
    s_add_u32 s47, s47, 4194304
    s_add_u32 s49, s49, 8388608
    s_add_u32 s50, s50, 14680064
    s_add_u32 s52, s52, 1048576
    s_add_u32 s54, s54, 16384
    s_branch X_layer
X_fin:
    v_and_b32 v192, 0xf0, v254
    v_lshlrev_b32 v192, 7, v192
    v_and_b32 v193, 0x100, v254
    v_lshrrev_b32 v193, 3, v193
    v_add_u32 v192, v192, v193
    v_and_b32 v193, 0x200, v254
    v_lshrrev_b32 v193, 5, v193
    v_add_u32 v192, v192, v193
    s_lshl_b32 s55, s40, 18
    s_lshl_b32 s56, s43, 17
    s_add_u32 s55, s55, s56
    s_lshl_b32 s56, s51, 7
    s_add_u32 s55, s55, s56
    s_lshl_b32 s56, s44, 6
    s_add_u32 s55, s55, s56
    v_cvt_pk_bf16_f32 v0, v128, v129
    v_cvt_pk_bf16_f32 v1, v130, v131
    v_cvt_pk_bf16_f32 v2, v144, v145
    v_cvt_pk_bf16_f32 v3, v146, v147
    s_nop 1
    v_permlane16_swap_b32 v0, v2
    v_permlane16_swap_b32 v1, v3
    buffer_store_dwordx4 v[0:3], v192, s[28:31], s55 offen
    s_add_u32 s55, s55, 32768
    v_cvt_pk_bf16_f32 v4, v132, v133
    v_cvt_pk_bf16_f32 v5, v134, v135
    v_cvt_pk_bf16_f32 v6, v148, v149
    v_cvt_pk_bf16_f32 v7, v150, v151
    s_nop 1
    v_permlane16_swap_b32 v4, v6
    v_permlane16_swap_b32 v5, v7
    buffer_store_dwordx4 v[4:7], v192, s[28:31], s55 offen
    s_add_u32 s55, s55, 32768
    v_cvt_pk_bf16_f32 v8, v136, v137
    v_cvt_pk_bf16_f32 v9, v138, v139
    v_cvt_pk_bf16_f32 v10, v152, v153
    v_cvt_pk_bf16_f32 v11, v154, v155
    s_nop 1
    v_permlane16_swap_b32 v8, v10
    v_permlane16_swap_b32 v9, v11
    buffer_store_dwordx4 v[8:11], v192, s[28:31], s55 offen
    s_add_u32 s55, s55, 32768
    v_cvt_pk_bf16_f32 v12, v140, v141
    v_cvt_pk_bf16_f32 v13, v142, v143
    v_cvt_pk_bf16_f32 v14, v156, v157
    v_cvt_pk_bf16_f32 v15, v158, v159
    s_nop 1
    v_permlane16_swap_b32 v12, v14
    v_permlane16_swap_b32 v13, v15
    buffer_store_dwordx4 v[12:15], v192, s[28:31], s55 offen
    s_add_u32 s55, s55, 32768
    s_endpgm
Y_start:
    s_cmp_ge_u32 s42, 2
    s_cbranch_scc1 YW_start
YA_layer:
    s_cmp_eq_u32 s42, 1
    s_cbranch_scc1 YS_g1
    s_cmp_lg_u32 s46, 0
    s_cbranch_scc1 ya_25
    s_mov_b32 s36, s24
    s_mov_b32 s37, s25
    s_mov_b32 s38, s26
    s_mov_b32 s39, s27
    v_lshrrev_b32 v224, 7, v254
    v_and_b32 v225, 0x70, v254
    v_and_b32 v226, 6, v224
    v_lshlrev_b32 v226, 4, v226
    v_xor_b32 v225, v225, v226
    v_lshl_add_u32 v200, v224, 11, v225
    v_add_u32 v201, 15360, v200
    v_add_u32 v202, 30720, v200
    v_add_u32 v203, 46080, v200
    s_lshl_b32 s62, s40, 18
    s_mov_b32 s63, 65536
    s_mov_b32 s65, 128
    s_branch ya_26
ya_25:
    s_mov_b32 s36, s4
    s_mov_b32 s37, s5
    s_mov_b32 s38, s6
    s_mov_b32 s39, s7
    v_mov_b32 v200, v254
    v_mov_b32 v201, v254
    v_mov_b32 v202, v254
    v_mov_b32 v203, v254
    s_mov_b32 s62, s48
    s_mov_b32 s63, 4096
    s_mov_b32 s65, 16384
ya_26:
    s_mov_b32 s94, s51
    s_mul_i32 s93, s94, s65
    s_add_u32 s93, s93, s62
    s_cmp_eq_u32 s46, 0
    s_cbranch_scc1 gw_27
    s_barrier
    s_cmp_lg_u32 s42, 0
    s_cbranch_scc1 wf_28
    s_lshl_b32 s55, s51, 2
    s_add_u32 s55, s55, s54
    s_add_u32 s55, s55, 4294959104
    v_mov_b32 v252, 0
    v_mov_b32 v250, 0x01010101
    s_mov_b64 exec, 1
    buffer_store_dword v250, v252, s[4:7], s55 offen sc0 sc1
    s_mov_b64 exec, -1
wf_28:
    s_mov_b32 s60, 4294950912
    v_lshrrev_b32 v252, 2, v254
    s_add_u32 s55, s54, 8192
    s_add_u32 s55, s55, s60
    s_mov_b32 s56, 262144
    s_mov_b32 s57, 0x01010101
    s_mov_b64 exec, 0xffff
poll_29:
    buffer_load_dword v253, v252, s[4:7], s55 offen sc0 sc1
    s_waitcnt vmcnt(0)
    v_cmp_ne_u32 vcc, s57, v253
    s_cbranch_vccz pd_30
    s_sleep 1
    s_sub_u32 s56, s56, 1
    s_cmp_lg_u32 s56, 0
    s_cbranch_scc1 poll_29
pd_30:
    s_mov_b64 exec, -1
gw_27:
    s_mov_b32 m0, 100352
    s_nop 0
    buffer_load_dwordx4 v200, s[36:39], s93 offen lds
    buffer_load_dwordx4 v201, s[36:39], s93 offen offset:1024 lds
    buffer_load_dwordx4 v202, s[36:39], s93 offen offset:2048 lds
    buffer_load_dwordx4 v203, s[36:39], s93 offen offset:3072 lds
    s_add_u32 s93, s93, s63
    s_mov_b32 m0, 104448
    s_nop 0
    buffer_load_dwordx4 v200, s[36:39], s93 offen lds
    buffer_load_dwordx4 v201, s[36:39], s93 offen offset:1024 lds
    buffer_load_dwordx4 v202, s[36:39], s93 offen offset:2048 lds
    buffer_load_dwordx4 v203, s[36:39], s93 offen offset:3072 lds
    s_add_u32 s93, s93, s63
    s_add_u32 s93, s93, s63
    s_add_u32 s94, s94, 1
    s_and_b32 s94, s94, 15
    s_mul_i32 s93, s94, s65
    s_add_u32 s93, s93, s62
    s_mov_b32 m0, 118784
    s_nop 0
    buffer_load_dwordx4 v200, s[36:39], s93 offen lds
    buffer_load_dwordx4 v201, s[36:39], s93 offen offset:1024 lds
    buffer_load_dwordx4 v202, s[36:39], s93 offen offset:2048 lds
    buffer_load_dwordx4 v203, s[36:39], s93 offen offset:3072 lds
    s_add_u32 s93, s93, s63
    s_mov_b32 m0, 122880
    s_nop 0
    buffer_load_dwordx4 v200, s[36:39], s93 offen lds
    buffer_load_dwordx4 v201, s[36:39], s93 offen offset:1024 lds
    buffer_load_dwordx4 v202, s[36:39], s93 offen offset:2048 lds
    buffer_load_dwordx4 v203, s[36:39], s93 offen offset:3072 lds
    s_add_u32 s93, s93, s63
    s_add_u32 s93, s93, s63
    s_add_u32 s94, s94, 1
    s_and_b32 s94, s94, 15
    s_mul_i32 s93, s94, s65
    s_add_u32 s93, s93, s62
    s_mov_b32 m0, 137216
    s_nop 0
    buffer_load_dwordx4 v200, s[36:39], s93 offen lds
    buffer_load_dwordx4 v201, s[36:39], s93 offen offset:1024 lds
    buffer_load_dwordx4 v202, s[36:39], s93 offen offset:2048 lds
    buffer_load_dwordx4 v203, s[36:39], s93 offen offset:3072 lds
    s_add_u32 s93, s93, s63
    s_mov_b32 m0, 141312
    s_nop 0
    buffer_load_dwordx4 v200, s[36:39], s93 offen lds
    buffer_load_dwordx4 v201, s[36:39], s93 offen offset:1024 lds
    buffer_load_dwordx4 v202, s[36:39], s93 offen offset:2048 lds
    buffer_load_dwordx4 v203, s[36:39], s93 offen offset:3072 lds
    s_add_u32 s93, s93, s63
    s_mov_b32 m0, 145408
    s_nop 0
    buffer_load_dwordx4 v200, s[36:39], s93 offen lds
    buffer_load_dwordx4 v201, s[36:39], s93 offen offset:1024 lds
    buffer_load_dwordx4 v202, s[36:39], s93 offen offset:2048 lds
    buffer_load_dwordx4 v203, s[36:39], s93 offen offset:3072 lds
    s_add_u32 s93, s93, s63
    s_mov_b32 m0, 149504
    s_nop 0
    buffer_load_dwordx4 v200, s[36:39], s93 offen lds
    buffer_load_dwordx4 v201, s[36:39], s93 offen offset:1024 lds
    buffer_load_dwordx4 v202, s[36:39], s93 offen offset:2048 lds
    buffer_load_dwordx4 v203, s[36:39], s93 offen offset:3072 lds
    s_add_u32 s94, s94, 1
    s_and_b32 s94, s94, 15
    s_mul_i32 s93, s94, s65
    s_add_u32 s93, s93, s62
    s_waitcnt vmcnt(24)
    s_barrier
    s_barrier
    s_waitcnt vmcnt(16)
    s_barrier
    s_mov_b32 m0, 100352
    s_nop 0
    buffer_load_dwordx4 v200, s[36:39], s93 offen lds
    buffer_load_dwordx4 v201, s[36:39], s93 offen offset:1024 lds
    buffer_load_dwordx4 v202, s[36:39], s93 offen offset:2048 lds
    buffer_load_dwordx4 v203, s[36:39], s93 offen offset:3072 lds
    s_add_u32 s93, s93, s63
    s_mov_b32 m0, 104448
    s_nop 0
    buffer_load_dwordx4 v200, s[36:39], s93 offen lds
    buffer_load_dwordx4 v201, s[36:39], s93 offen offset:1024 lds
    buffer_load_dwordx4 v202, s[36:39], s93 offen offset:2048 lds
    buffer_load_dwordx4 v203, s[36:39], s93 offen offset:3072 lds
    s_add_u32 s93, s93, s63
    s_barrier
    s_mov_b32 m0, 108544
    s_nop 0
    buffer_load_dwordx4 v200, s[36:39], s93 offen lds
    buffer_load_dwordx4 v201, s[36:39], s93 offen offset:1024 lds
    buffer_load_dwordx4 v202, s[36:39], s93 offen offset:2048 lds
    buffer_load_dwordx4 v203, s[36:39], s93 offen offset:3072 lds
    s_add_u32 s93, s93, s63
    s_mov_b32 m0, 112640
    s_nop 0
    buffer_load_dwordx4 v200, s[36:39], s93 offen lds
    buffer_load_dwordx4 v201, s[36:39], s93 offen offset:1024 lds
    buffer_load_dwordx4 v202, s[36:39], s93 offen offset:2048 lds
    buffer_load_dwordx4 v203, s[36:39], s93 offen offset:3072 lds
    s_add_u32 s94, s94, 1
    s_and_b32 s94, s94, 15
    s_mul_i32 s93, s94, s65
    s_add_u32 s93, s93, s62
    s_waitcnt vmcnt(16)
    s_barrier
    s_mov_b32 m0, 118784
    s_nop 0
    buffer_load_dwordx4 v200, s[36:39], s93 offen lds
    buffer_load_dwordx4 v201, s[36:39], s93 offen offset:1024 lds
    buffer_load_dwordx4 v202, s[36:39], s93 offen offset:2048 lds
    buffer_load_dwordx4 v203, s[36:39], s93 offen offset:3072 lds
    s_add_u32 s93, s93, s63
    s_mov_b32 m0, 122880
    s_nop 0
    buffer_load_dwordx4 v200, s[36:39], s93 offen lds
    buffer_load_dwordx4 v201, s[36:39], s93 offen offset:1024 lds
    buffer_load_dwordx4 v202, s[36:39], s93 offen offset:2048 lds
    buffer_load_dwordx4 v203, s[36:39], s93 offen offset:3072 lds
    s_add_u32 s93, s93, s63
    s_barrier
    s_mov_b32 m0, 126976
    s_nop 0
    buffer_load_dwordx4 v200, s[36:39], s93 offen lds
    buffer_load_dwordx4 v201, s[36:39], s93 offen offset:1024 lds
    buffer_load_dwordx4 v202, s[36:39], s93 offen offset:2048 lds
    buffer_load_dwordx4 v203, s[36:39], s93 offen offset:3072 lds
    s_add_u32 s93, s93, s63
    s_mov_b32 m0, 131072
    s_nop 0
    buffer_load_dwordx4 v200, s[36:39], s93 offen lds
    buffer_load_dwordx4 v201, s[36:39], s93 offen offset:1024 lds
    buffer_load_dwordx4 v202, s[36:39], s93 offen offset:2048 lds
    buffer_load_dwordx4 v203, s[36:39], s93 offen offset:3072 lds
    s_add_u32 s94, s94, 1
    s_and_b32 s94, s94, 15
    s_mul_i32 s93, s94, s65
    s_add_u32 s93, s93, s62
    s_waitcnt vmcnt(16)
    s_barrier
    s_mov_b32 m0, 137216
    s_nop 0
    buffer_load_dwordx4 v200, s[36:39], s93 offen lds
    buffer_load_dwordx4 v201, s[36:39], s93 offen offset:1024 lds
    buffer_load_dwordx4 v202, s[36:39], s93 offen offset:2048 lds
    buffer_load_dwordx4 v203, s[36:39], s93 offen offset:3072 lds
    s_add_u32 s93, s93, s63
    s_mov_b32 m0, 141312
    s_nop 0
    buffer_load_dwordx4 v200, s[36:39], s93 offen lds
    buffer_load_dwordx4 v201, s[36:39], s93 offen offset:1024 lds
    buffer_load_dwordx4 v202, s[36:39], s93 offen offset:2048 lds
    buffer_load_dwordx4 v203, s[36:39], s93 offen offset:3072 lds
    s_add_u32 s93, s93, s63
    s_barrier
    s_mov_b32 m0, 145408
    s_nop 0
    buffer_load_dwordx4 v200, s[36:39], s93 offen lds
    buffer_load_dwordx4 v201, s[36:39], s93 offen offset:1024 lds
    buffer_load_dwordx4 v202, s[36:39], s93 offen offset:2048 lds
    buffer_load_dwordx4 v203, s[36:39], s93 offen offset:3072 lds
    s_add_u32 s93, s93, s63
    s_mov_b32 m0, 149504
    s_nop 0
    buffer_load_dwordx4 v200, s[36:39], s93 offen lds
    buffer_load_dwordx4 v201, s[36:39], s93 offen offset:1024 lds
    buffer_load_dwordx4 v202, s[36:39], s93 offen offset:2048 lds
    buffer_load_dwordx4 v203, s[36:39], s93 offen offset:3072 lds
    s_add_u32 s94, s94, 1
    s_and_b32 s94, s94, 15
    s_mul_i32 s93, s94, s65
    s_add_u32 s93, s93, s62
    s_waitcnt vmcnt(16)
    s_barrier
    s_mov_b32 m0, 100352
    s_nop 0
    buffer_load_dwordx4 v200, s[36:39], s93 offen lds
    buffer_load_dwordx4 v201, s[36:39], s93 offen offset:1024 lds
    buffer_load_dwordx4 v202, s[36:39], s93 offen offset:2048 lds
    buffer_load_dwordx4 v203, s[36:39], s93 offen offset:3072 lds
    s_add_u32 s93, s93, s63
    s_mov_b32 m0, 104448
    s_nop 0
    buffer_load_dwordx4 v200, s[36:39], s93 offen lds
    buffer_load_dwordx4 v201, s[36:39], s93 offen offset:1024 lds
    buffer_load_dwordx4 v202, s[36:39], s93 offen offset:2048 lds
    buffer_load_dwordx4 v203, s[36:39], s93 offen offset:3072 lds
    s_add_u32 s93, s93, s63
    s_barrier
    s_mov_b32 m0, 108544
    s_nop 0
    buffer_load_dwordx4 v200, s[36:39], s93 offen lds
    buffer_load_dwordx4 v201, s[36:39], s93 offen offset:1024 lds
    buffer_load_dwordx4 v202, s[36:39], s93 offen offset:2048 lds
    buffer_load_dwordx4 v203, s[36:39], s93 offen offset:3072 lds
    s_add_u32 s93, s93, s63
    s_mov_b32 m0, 112640
    s_nop 0
    buffer_load_dwordx4 v200, s[36:39], s93 offen lds
    buffer_load_dwordx4 v201, s[36:39], s93 offen offset:1024 lds
    buffer_load_dwordx4 v202, s[36:39], s93 offen offset:2048 lds
    buffer_load_dwordx4 v203, s[36:39], s93 offen offset:3072 lds
    s_add_u32 s94, s94, 1
    s_and_b32 s94, s94, 15
    s_mul_i32 s93, s94, s65
    s_add_u32 s93, s93, s62
    s_waitcnt vmcnt(16)
    s_barrier
    s_mov_b32 m0, 118784
    s_nop 0
    buffer_load_dwordx4 v200, s[36:39], s93 offen lds
    buffer_load_dwordx4 v201, s[36:39], s93 offen offset:1024 lds
    buffer_load_dwordx4 v202, s[36:39], s93 offen offset:2048 lds
    buffer_load_dwordx4 v203, s[36:39], s93 offen offset:3072 lds
    s_add_u32 s93, s93, s63
    s_mov_b32 m0, 122880
    s_nop 0
    buffer_load_dwordx4 v200, s[36:39], s93 offen lds
    buffer_load_dwordx4 v201, s[36:39], s93 offen offset:1024 lds
    buffer_load_dwordx4 v202, s[36:39], s93 offen offset:2048 lds
    buffer_load_dwordx4 v203, s[36:39], s93 offen offset:3072 lds
    s_add_u32 s93, s93, s63
    s_barrier
    s_mov_b32 m0, 126976
    s_nop 0
    buffer_load_dwordx4 v200, s[36:39], s93 offen lds
    buffer_load_dwordx4 v201, s[36:39], s93 offen offset:1024 lds
    buffer_load_dwordx4 v202, s[36:39], s93 offen offset:2048 lds
    buffer_load_dwordx4 v203, s[36:39], s93 offen offset:3072 lds
    s_add_u32 s93, s93, s63
    s_mov_b32 m0, 131072
    s_nop 0
    buffer_load_dwordx4 v200, s[36:39], s93 offen lds
    buffer_load_dwordx4 v201, s[36:39], s93 offen offset:1024 lds
    buffer_load_dwordx4 v202, s[36:39], s93 offen offset:2048 lds
    buffer_load_dwordx4 v203, s[36:39], s93 offen offset:3072 lds
    s_add_u32 s94, s94, 1
    s_and_b32 s94, s94, 15
    s_mul_i32 s93, s94, s65
    s_add_u32 s93, s93, s62
    s_waitcnt vmcnt(16)
    s_barrier
    s_mov_b32 m0, 137216
    s_nop 0
    buffer_load_dwordx4 v200, s[36:39], s93 offen lds
    buffer_load_dwordx4 v201, s[36:39], s93 offen offset:1024 lds
    buffer_load_dwordx4 v202, s[36:39], s93 offen offset:2048 lds
    buffer_load_dwordx4 v203, s[36:39], s93 offen offset:3072 lds
    s_add_u32 s93, s93, s63
    s_mov_b32 m0, 141312
    s_nop 0
    buffer_load_dwordx4 v200, s[36:39], s93 offen lds
    buffer_load_dwordx4 v201, s[36:39], s93 offen offset:1024 lds
    buffer_load_dwordx4 v202, s[36:39], s93 offen offset:2048 lds
    buffer_load_dwordx4 v203, s[36:39], s93 offen offset:3072 lds
    s_add_u32 s93, s93, s63
    s_barrier
    s_mov_b32 m0, 145408
    s_nop 0
    buffer_load_dwordx4 v200, s[36:39], s93 offen lds
    buffer_load_dwordx4 v201, s[36:39], s93 offen offset:1024 lds
    buffer_load_dwordx4 v202, s[36:39], s93 offen offset:2048 lds
    buffer_load_dwordx4 v203, s[36:39], s93 offen offset:3072 lds
    s_add_u32 s93, s93, s63
    s_mov_b32 m0, 149504
    s_nop 0
    buffer_load_dwordx4 v200, s[36:39], s93 offen lds
    buffer_load_dwordx4 v201, s[36:39], s93 offen offset:1024 lds
    buffer_load_dwordx4 v202, s[36:39], s93 offen offset:2048 lds
    buffer_load_dwordx4 v203, s[36:39], s93 offen offset:3072 lds
    s_add_u32 s94, s94, 1
    s_and_b32 s94, s94, 15
    s_mul_i32 s93, s94, s65
    s_add_u32 s93, s93, s62
    s_waitcnt vmcnt(16)
    s_barrier
    s_mov_b32 m0, 100352
    s_nop 0
    buffer_load_dwordx4 v200, s[36:39], s93 offen lds
    buffer_load_dwordx4 v201, s[36:39], s93 offen offset:1024 lds
    buffer_load_dwordx4 v202, s[36:39], s93 offen offset:2048 lds
    buffer_load_dwordx4 v203, s[36:39], s93 offen offset:3072 lds
    s_add_u32 s93, s93, s63
    s_mov_b32 m0, 104448
    s_nop 0
    buffer_load_dwordx4 v200, s[36:39], s93 offen lds
    buffer_load_dwordx4 v201, s[36:39], s93 offen offset:1024 lds
    buffer_load_dwordx4 v202, s[36:39], s93 offen offset:2048 lds
    buffer_load_dwordx4 v203, s[36:39], s93 offen offset:3072 lds
    s_add_u32 s93, s93, s63
    s_barrier
    s_mov_b32 m0, 108544
    s_nop 0
    buffer_load_dwordx4 v200, s[36:39], s93 offen lds
    buffer_load_dwordx4 v201, s[36:39], s93 offen offset:1024 lds
    buffer_load_dwordx4 v202, s[36:39], s93 offen offset:2048 lds
    buffer_load_dwordx4 v203, s[36:39], s93 offen offset:3072 lds
    s_add_u32 s93, s93, s63
    s_mov_b32 m0, 112640
    s_nop 0
    buffer_load_dwordx4 v200, s[36:39], s93 offen lds
    buffer_load_dwordx4 v201, s[36:39], s93 offen offset:1024 lds
    buffer_load_dwordx4 v202, s[36:39], s93 offen offset:2048 lds
    buffer_load_dwordx4 v203, s[36:39], s93 offen offset:3072 lds
    s_add_u32 s94, s94, 1
    s_and_b32 s94, s94, 15
    s_mul_i32 s93, s94, s65
    s_add_u32 s93, s93, s62
    s_waitcnt vmcnt(16)
    s_barrier
    s_mov_b32 m0, 118784
    s_nop 0
    buffer_load_dwordx4 v200, s[36:39], s93 offen lds
    buffer_load_dwordx4 v201, s[36:39], s93 offen offset:1024 lds
    buffer_load_dwordx4 v202, s[36:39], s93 offen offset:2048 lds
    buffer_load_dwordx4 v203, s[36:39], s93 offen offset:3072 lds
    s_add_u32 s93, s93, s63
    s_mov_b32 m0, 122880
    s_nop 0
    buffer_load_dwordx4 v200, s[36:39], s93 offen lds
    buffer_load_dwordx4 v201, s[36:39], s93 offen offset:1024 lds
    buffer_load_dwordx4 v202, s[36:39], s93 offen offset:2048 lds
    buffer_load_dwordx4 v203, s[36:39], s93 offen offset:3072 lds
    s_add_u32 s93, s93, s63
    s_barrier
    s_mov_b32 m0, 126976
    s_nop 0
    buffer_load_dwordx4 v200, s[36:39], s93 offen lds
    buffer_load_dwordx4 v201, s[36:39], s93 offen offset:1024 lds
    buffer_load_dwordx4 v202, s[36:39], s93 offen offset:2048 lds
    buffer_load_dwordx4 v203, s[36:39], s93 offen offset:3072 lds
    s_add_u32 s93, s93, s63
    s_mov_b32 m0, 131072
    s_nop 0
    buffer_load_dwordx4 v200, s[36:39], s93 offen lds
    buffer_load_dwordx4 v201, s[36:39], s93 offen offset:1024 lds
    buffer_load_dwordx4 v202, s[36:39], s93 offen offset:2048 lds
    buffer_load_dwordx4 v203, s[36:39], s93 offen offset:3072 lds
    s_add_u32 s94, s94, 1
    s_and_b32 s94, s94, 15
    s_mul_i32 s93, s94, s65
    s_add_u32 s93, s93, s62
    s_waitcnt vmcnt(16)
    s_barrier
    s_mov_b32 m0, 137216
    s_nop 0
    buffer_load_dwordx4 v200, s[36:39], s93 offen lds
    buffer_load_dwordx4 v201, s[36:39], s93 offen offset:1024 lds
    buffer_load_dwordx4 v202, s[36:39], s93 offen offset:2048 lds
    buffer_load_dwordx4 v203, s[36:39], s93 offen offset:3072 lds
    s_add_u32 s93, s93, s63
    s_mov_b32 m0, 141312
    s_nop 0
    buffer_load_dwordx4 v200, s[36:39], s93 offen lds
    buffer_load_dwordx4 v201, s[36:39], s93 offen offset:1024 lds
    buffer_load_dwordx4 v202, s[36:39], s93 offen offset:2048 lds
    buffer_load_dwordx4 v203, s[36:39], s93 offen offset:3072 lds
    s_add_u32 s93, s93, s63
    s_barrier
    s_mov_b32 m0, 145408
    s_nop 0
    buffer_load_dwordx4 v200, s[36:39], s93 offen lds
    buffer_load_dwordx4 v201, s[36:39], s93 offen offset:1024 lds
    buffer_load_dwordx4 v202, s[36:39], s93 offen offset:2048 lds
    buffer_load_dwordx4 v203, s[36:39], s93 offen offset:3072 lds
    s_add_u32 s93, s93, s63
    s_mov_b32 m0, 149504
    s_nop 0
    buffer_load_dwordx4 v200, s[36:39], s93 offen lds
    buffer_load_dwordx4 v201, s[36:39], s93 offen offset:1024 lds
    buffer_load_dwordx4 v202, s[36:39], s93 offen offset:2048 lds
    buffer_load_dwordx4 v203, s[36:39], s93 offen offset:3072 lds
    s_add_u32 s94, s94, 1
    s_and_b32 s94, s94, 15
    s_mul_i32 s93, s94, s65
    s_add_u32 s93, s93, s62
    s_waitcnt vmcnt(16)
    s_barrier
    s_mov_b32 m0, 100352
    s_nop 0
    buffer_load_dwordx4 v200, s[36:39], s93 offen lds
    buffer_load_dwordx4 v201, s[36:39], s93 offen offset:1024 lds
    buffer_load_dwordx4 v202, s[36:39], s93 offen offset:2048 lds
    buffer_load_dwordx4 v203, s[36:39], s93 offen offset:3072 lds
    s_add_u32 s93, s93, s63
    s_mov_b32 m0, 104448
    s_nop 0
    buffer_load_dwordx4 v200, s[36:39], s93 offen lds
    buffer_load_dwordx4 v201, s[36:39], s93 offen offset:1024 lds
    buffer_load_dwordx4 v202, s[36:39], s93 offen offset:2048 lds
    buffer_load_dwordx4 v203, s[36:39], s93 offen offset:3072 lds
    s_add_u32 s93, s93, s63
    s_barrier
    s_mov_b32 m0, 108544
    s_nop 0
    buffer_load_dwordx4 v200, s[36:39], s93 offen lds
    buffer_load_dwordx4 v201, s[36:39], s93 offen offset:1024 lds
    buffer_load_dwordx4 v202, s[36:39], s93 offen offset:2048 lds
    buffer_load_dwordx4 v203, s[36:39], s93 offen offset:3072 lds
    s_add_u32 s93, s93, s63
    s_mov_b32 m0, 112640
    s_nop 0
    buffer_load_dwordx4 v200, s[36:39], s93 offen lds
    buffer_load_dwordx4 v201, s[36:39], s93 offen offset:1024 lds
    buffer_load_dwordx4 v202, s[36:39], s93 offen offset:2048 lds
    buffer_load_dwordx4 v203, s[36:39], s93 offen offset:3072 lds
    s_add_u32 s94, s94, 1
    s_and_b32 s94, s94, 15
    s_mul_i32 s93, s94, s65
    s_add_u32 s93, s93, s62
    s_waitcnt vmcnt(16)
    s_barrier
    s_mov_b32 m0, 118784
    s_nop 0
    buffer_load_dwordx4 v200, s[36:39], s93 offen lds
    buffer_load_dwordx4 v201, s[36:39], s93 offen offset:1024 lds
    buffer_load_dwordx4 v202, s[36:39], s93 offen offset:2048 lds
    buffer_load_dwordx4 v203, s[36:39], s93 offen offset:3072 lds
    s_add_u32 s93, s93, s63
    s_mov_b32 m0, 122880
    s_nop 0
    buffer_load_dwordx4 v200, s[36:39], s93 offen lds
    buffer_load_dwordx4 v201, s[36:39], s93 offen offset:1024 lds
    buffer_load_dwordx4 v202, s[36:39], s93 offen offset:2048 lds
    buffer_load_dwordx4 v203, s[36:39], s93 offen offset:3072 lds
    s_add_u32 s93, s93, s63
    s_barrier
    s_mov_b32 m0, 126976
    s_nop 0
    buffer_load_dwordx4 v200, s[36:39], s93 offen lds
    buffer_load_dwordx4 v201, s[36:39], s93 offen offset:1024 lds
    buffer_load_dwordx4 v202, s[36:39], s93 offen offset:2048 lds
    buffer_load_dwordx4 v203, s[36:39], s93 offen offset:3072 lds
    s_add_u32 s93, s93, s63
    s_mov_b32 m0, 131072
    s_nop 0
    buffer_load_dwordx4 v200, s[36:39], s93 offen lds
    buffer_load_dwordx4 v201, s[36:39], s93 offen offset:1024 lds
    buffer_load_dwordx4 v202, s[36:39], s93 offen offset:2048 lds
    buffer_load_dwordx4 v203, s[36:39], s93 offen offset:3072 lds
    s_add_u32 s94, s94, 1
    s_and_b32 s94, s94, 15
    s_mul_i32 s93, s94, s65
    s_add_u32 s93, s93, s62
    s_waitcnt vmcnt(16)
    s_barrier
    s_mov_b32 m0, 137216
    s_nop 0
    buffer_load_dwordx4 v200, s[36:39], s93 offen lds
    buffer_load_dwordx4 v201, s[36:39], s93 offen offset:1024 lds
    buffer_load_dwordx4 v202, s[36:39], s93 offen offset:2048 lds
    buffer_load_dwordx4 v203, s[36:39], s93 offen offset:3072 lds
    s_add_u32 s93, s93, s63
    s_mov_b32 m0, 141312
    s_nop 0
    buffer_load_dwordx4 v200, s[36:39], s93 offen lds
    buffer_load_dwordx4 v201, s[36:39], s93 offen offset:1024 lds
    buffer_load_dwordx4 v202, s[36:39], s93 offen offset:2048 lds
    buffer_load_dwordx4 v203, s[36:39], s93 offen offset:3072 lds
    s_add_u32 s93, s93, s63
    s_barrier
    s_mov_b32 m0, 145408
    s_nop 0
    buffer_load_dwordx4 v200, s[36:39], s93 offen lds
    buffer_load_dwordx4 v201, s[36:39], s93 offen offset:1024 lds
    buffer_load_dwordx4 v202, s[36:39], s93 offen offset:2048 lds
    buffer_load_dwordx4 v203, s[36:39], s93 offen offset:3072 lds
    s_add_u32 s93, s93, s63
    s_mov_b32 m0, 149504
    s_nop 0
    buffer_load_dwordx4 v200, s[36:39], s93 offen lds
    buffer_load_dwordx4 v201, s[36:39], s93 offen offset:1024 lds
    buffer_load_dwordx4 v202, s[36:39], s93 offen offset:2048 lds
    buffer_load_dwordx4 v203, s[36:39], s93 offen offset:3072 lds
    s_add_u32 s94, s94, 1
    s_and_b32 s94, s94, 15
    s_mul_i32 s93, s94, s65
    s_add_u32 s93, s93, s62
    s_waitcnt vmcnt(16)
    s_barrier
    s_mov_b32 m0, 100352
    s_nop 0
    buffer_load_dwordx4 v200, s[36:39], s93 offen lds
    buffer_load_dwordx4 v201, s[36:39], s93 offen offset:1024 lds
    buffer_load_dwordx4 v202, s[36:39], s93 offen offset:2048 lds
    buffer_load_dwordx4 v203, s[36:39], s93 offen offset:3072 lds
    s_add_u32 s93, s93, s63
    s_mov_b32 m0, 104448
    s_nop 0
    buffer_load_dwordx4 v200, s[36:39], s93 offen lds
    buffer_load_dwordx4 v201, s[36:39], s93 offen offset:1024 lds
    buffer_load_dwordx4 v202, s[36:39], s93 offen offset:2048 lds
    buffer_load_dwordx4 v203, s[36:39], s93 offen offset:3072 lds
    s_add_u32 s93, s93, s63
    s_barrier
    s_mov_b32 m0, 108544
    s_nop 0
    buffer_load_dwordx4 v200, s[36:39], s93 offen lds
    buffer_load_dwordx4 v201, s[36:39], s93 offen offset:1024 lds
    buffer_load_dwordx4 v202, s[36:39], s93 offen offset:2048 lds
    buffer_load_dwordx4 v203, s[36:39], s93 offen offset:3072 lds
    s_add_u32 s93, s93, s63
    s_mov_b32 m0, 112640
    s_nop 0
    buffer_load_dwordx4 v200, s[36:39], s93 offen lds
    buffer_load_dwordx4 v201, s[36:39], s93 offen offset:1024 lds
    buffer_load_dwordx4 v202, s[36:39], s93 offen offset:2048 lds
    buffer_load_dwordx4 v203, s[36:39], s93 offen offset:3072 lds
    s_add_u32 s94, s94, 1
    s_and_b32 s94, s94, 15
    s_mul_i32 s93, s94, s65
    s_add_u32 s93, s93, s62
    s_waitcnt vmcnt(16)
    s_barrier
    s_barrier
    s_waitcnt vmcnt(0)
    s_barrier
    s_barrier
    s_barrier
    v_mov_b32 v224, 157568
    ds_read_b32 v224, v224
    s_waitcnt lgkmcnt(0)
    v_readfirstlane_b32 s45, v224
    s_branch YA_g2
YS_g1:
    s_cmp_lg_u32 s46, 0
    s_cbranch_scc1 ya_31
    s_mov_b32 s36, s24
    s_mov_b32 s37, s25
    s_mov_b32 s38, s26
    s_mov_b32 s39, s27
    v_lshrrev_b32 v224, 7, v254
    v_and_b32 v225, 0x70, v254
    v_and_b32 v226, 6, v224
    v_lshlrev_b32 v226, 4, v226
    v_xor_b32 v225, v225, v226
    v_lshl_add_u32 v200, v224, 11, v225
    v_add_u32 v201, 15360, v200
    v_add_u32 v202, 30720, v200
    v_add_u32 v203, 46080, v200
    s_lshl_b32 s62, s40, 18
    s_mov_b32 s63, 65536
    s_mov_b32 s65, 128
    s_branch ya_32
ya_31:
    s_mov_b32 s36, s4
    s_mov_b32 s37, s5
    s_mov_b32 s38, s6
    s_mov_b32 s39, s7
    v_mov_b32 v200, v254
    v_mov_b32 v201, v254
    v_mov_b32 v202, v254
    v_mov_b32 v203, v254
    s_mov_b32 s62, s48
    s_mov_b32 s63, 4096
    s_mov_b32 s65, 16384
ya_32:
    s_mov_b32 s94, s51
    s_mul_i32 s93, s94, s65
    s_add_u32 s93, s93, s62
    s_cmp_eq_u32 s46, 0
    s_cbranch_scc1 gw_33
    s_barrier
    s_cmp_lg_u32 s42, 0
    s_cbranch_scc1 wf_34
    s_lshl_b32 s55, s51, 2
    s_add_u32 s55, s55, s54
    s_add_u32 s55, s55, 4294959104
    v_mov_b32 v252, 0
    v_mov_b32 v250, 0x01010101
    s_mov_b64 exec, 1
    buffer_store_dword v250, v252, s[4:7], s55 offen sc0 sc1
    s_mov_b64 exec, -1
wf_34:
    s_mov_b32 s60, 4294950912
    v_lshrrev_b32 v252, 2, v254
    s_add_u32 s55, s54, 8192
    s_add_u32 s55, s55, s60
    s_mov_b32 s56, 262144
    s_mov_b32 s57, 0x01010101
    s_mov_b64 exec, 0xffff
poll_35:
    buffer_load_dword v253, v252, s[4:7], s55 offen sc0 sc1
    s_waitcnt vmcnt(0)
    v_cmp_ne_u32 vcc, s57, v253
    s_cbranch_vccz pd_36
    s_sleep 1
    s_sub_u32 s56, s56, 1
    s_cmp_lg_u32 s56, 0
    s_cbranch_scc1 poll_35
pd_36:
    s_mov_b64 exec, -1
gw_33:
    s_add_u32 s93, s93, s63
    s_add_u32 s93, s93, s63
    s_mov_b32 m0, 108544
    s_nop 0
    buffer_load_dwordx4 v200, s[36:39], s93 offen lds
    buffer_load_dwordx4 v201, s[36:39], s93 offen offset:1024 lds
    buffer_load_dwordx4 v202, s[36:39], s93 offen offset:2048 lds
    buffer_load_dwordx4 v203, s[36:39], s93 offen offset:3072 lds
    s_add_u32 s93, s93, s63
    s_mov_b32 m0, 112640
    s_nop 0
    buffer_load_dwordx4 v200, s[36:39], s93 offen lds
    buffer_load_dwordx4 v201, s[36:39], s93 offen offset:1024 lds
    buffer_load_dwordx4 v202, s[36:39], s93 offen offset:2048 lds
    buffer_load_dwordx4 v203, s[36:39], s93 offen offset:3072 lds
    s_add_u32 s94, s94, 1
    s_and_b32 s94, s94, 15
    s_mul_i32 s93, s94, s65
    s_add_u32 s93, s93, s62
    s_add_u32 s93, s93, s63
    s_add_u32 s93, s93, s63
    s_mov_b32 m0, 126976
    s_nop 0
    buffer_load_dwordx4 v200, s[36:39], s93 offen lds
    buffer_load_dwordx4 v201, s[36:39], s93 offen offset:1024 lds
    buffer_load_dwordx4 v202, s[36:39], s93 offen offset:2048 lds
    buffer_load_dwordx4 v203, s[36:39], s93 offen offset:3072 lds
    s_add_u32 s93, s93, s63
    s_mov_b32 m0, 131072
    s_nop 0
    buffer_load_dwordx4 v200, s[36:39], s93 offen lds
    buffer_load_dwordx4 v201, s[36:39], s93 offen offset:1024 lds
    buffer_load_dwordx4 v202, s[36:39], s93 offen offset:2048 lds
    buffer_load_dwordx4 v203, s[36:39], s93 offen offset:3072 lds
    s_add_u32 s94, s94, 1
    s_and_b32 s94, s94, 15
    s_mul_i32 s93, s94, s65
    s_add_u32 s93, s93, s62
    s_cmp_lg_u32 s46, 0
    s_cbranch_scc1 ys_37
    s_setprio 1
    v_mov_b32 v226, 0
    v_mov_b32 v227, 0
    v_lshrrev_b32 v224, 1, v254
    s_lshl_b32 s55, s2, 7
    s_add_u32 s55, s55, 71303168
    s_mov_b64 exec, 0xffff
    buffer_store_dwordx2 v[226:227], v224, s[4:7], s55 offen sc0 sc1
    s_mov_b64 exec, 0xf
    v_add_u32 v224, 157584, v224
    ds_write_b64 v224, v[226:227]
    s_mov_b64 exec, -1
    v_lshlrev_b32 v224, 6, v254
    s_lshl_b32 s55, s2, 2
    s_add_u32 s55, s55, 71565312
    s_mov_b64 exec, 3
    buffer_store_dword v226, v224, s[4:7], s55 offen sc0 sc1
    s_mov_b64 exec, -1
    s_load_dwordx4 s[80:83], s[0:1], 32
    s_lshr_b32 s55, s2, 1
    s_waitcnt lgkmcnt(0)
    s_cmp_lt_u32 s55, 56
    s_cselect_b32 s72, s80, s82
    s_cselect_b32 s73, s81, s83
    s_cselect_b32 s56, 0, 56
    s_sub_u32 s55, s55, s56
    s_mov_b32 s74, 7340032
    s_mov_b32 s75, 0x00020000
    s_lshl_b32 s76, s55, 7
    s_and_b32 s55, s2, 1
    s_mul_i32 s55, s55, 3670016
    s_add_u32 s76, s76, s55
    s_cmp_lt_u32 s2, 224
    s_cselect_b32 s76, s76, 2130706432
    v_lshrrev_b32 v140, 7, v254
    v_mul_u32_u24 v140, 7168, v140
    v_and_b32 v224, 0x70, v254
    v_add_u32 v140, v140, v224
    v_mov_b32 v128, 0
    v_mov_b32 v129, 0
    v_mov_b32 v130, 0
    v_mov_b32 v131, 0
    v_mov_b32 v132, 0
    v_mov_b32 v133, 0
    v_mov_b32 v134, 0
    v_mov_b32 v135, 0
    s_getreg_b32 s77, hwreg(HW_REG_XCC_ID, 0, 4)
    s_mul_i32 s55, s77, s77
    s_lshl_b32 s55, s55, 15
    s_lshl_b32 s77, s77, 6
    s_add_u32 s77, s77, s55
    s_add_u32 s77, s77, 1
    s_waitcnt vmcnt(10)
    s_barrier
    s_waitcnt lgkmcnt(0)
    s_barrier
    s_waitcnt vmcnt(0) lgkmcnt(0)
    s_barrier
    v_mov_b32 v224, s77
    s_and_b32 s55, s2, 7
    s_lshl_b32 s55, s55, 5
    v_mov_b32 v225, 0
    s_mov_b64 exec, 1
    buffer_atomic_add v224, v225, s[32:35], s55 offen sc1
    s_mov_b64 exec, -1
    v_lshlrev_b32 v224, 3, v254
    s_lshl_b32 s55, s2, 13
    buffer_load_dword v144, v224, s[12:15], s55 offen
    s_waitcnt lgkmcnt(0)
    s_barrier
    buffer_load_dwordx4 v[0:3], v140, s[72:75], s76 offen
    s_add_u32 s76, s76, 57344
    buffer_load_dwordx4 v[4:7], v140, s[72:75], s76 offen
    s_add_u32 s76, s76, 57344
    buffer_load_dwordx4 v[8:11], v140, s[72:75], s76 offen
    s_add_u32 s76, s76, 57344
    buffer_load_dwordx4 v[12:15], v140, s[72:75], s76 offen
    s_add_u32 s76, s76, 57344
    s_waitcnt lgkmcnt(0)
    s_barrier
    v_mov_b32 v224, 0
    v_mov_b32 v225, 1
    s_lshl_b32 s55, s2, 2
    s_add_u32 s55, s55, 71565312
    s_mov_b64 exec, 1
    buffer_store_dword v225, v224, s[4:7], s55 offen sc0 sc1
    s_mov_b64 exec, -1
    buffer_load_dwordx4 v[16:19], v140, s[72:75], s76 offen
    s_add_u32 s76, s76, 57344
    buffer_load_dwordx4 v[20:23], v140, s[72:75], s76 offen
    s_add_u32 s76, s76, 57344
    buffer_load_dwordx4 v[24:27], v140, s[72:75], s76 offen
    s_add_u32 s76, s76, 57344
    buffer_load_dwordx4 v[28:31], v140, s[72:75], s76 offen
    s_add_u32 s76, s76, 57344
    s_waitcnt lgkmcnt(0)
    s_barrier
    buffer_load_dwordx4 v[32:35], v140, s[72:75], s76 offen
    s_add_u32 s76, s76, 57344
    buffer_load_dwordx4 v[36:39], v140, s[72:75], s76 offen
    s_add_u32 s76, s76, 57344
    buffer_load_dwordx4 v[40:43], v140, s[72:75], s76 offen
    s_add_u32 s76, s76, 57344
    buffer_load_dwordx4 v[44:47], v140, s[72:75], s76 offen
    s_add_u32 s76, s76, 57344
    s_waitcnt lgkmcnt(0)
    s_barrier
    buffer_load_dwordx4 v[48:51], v140, s[72:75], s76 offen
    s_add_u32 s76, s76, 57344
    buffer_load_dwordx4 v[52:55], v140, s[72:75], s76 offen
    s_add_u32 s76, s76, 57344
    buffer_load_dwordx4 v[56:59], v140, s[72:75], s76 offen
    s_add_u32 s76, s76, 57344
    buffer_load_dwordx4 v[60:63], v140, s[72:75], s76 offen
    s_add_u32 s76, s76, 57344
    s_waitcnt lgkmcnt(0)
    s_barrier
    buffer_load_dwordx4 v[64:67], v140, s[72:75], s76 offen
    s_add_u32 s76, s76, 57344
    buffer_load_dwordx4 v[68:71], v140, s[72:75], s76 offen
    s_add_u32 s76, s76, 57344
    buffer_load_dwordx4 v[72:75], v140, s[72:75], s76 offen
    s_add_u32 s76, s76, 57344
    buffer_load_dwordx4 v[76:79], v140, s[72:75], s76 offen
    s_add_u32 s76, s76, 57344
    s_waitcnt lgkmcnt(0)
    s_barrier
    buffer_load_dwordx4 v[80:83], v140, s[72:75], s76 offen
    s_add_u32 s76, s76, 57344
    buffer_load_dwordx4 v[84:87], v140, s[72:75], s76 offen
    s_add_u32 s76, s76, 57344
    buffer_load_dwordx4 v[88:91], v140, s[72:75], s76 offen
    s_add_u32 s76, s76, 57344
    buffer_load_dwordx4 v[92:95], v140, s[72:75], s76 offen
    s_add_u32 s76, s76, 57344
    s_waitcnt lgkmcnt(0)
    s_barrier
    buffer_load_dwordx4 v[96:99], v140, s[72:75], s76 offen
    s_add_u32 s76, s76, 57344
    buffer_load_dwordx4 v[100:103], v140, s[72:75], s76 offen
    s_add_u32 s76, s76, 57344
    buffer_load_dwordx4 v[104:107], v140, s[72:75], s76 offen
    s_add_u32 s76, s76, 57344
    buffer_load_dwordx4 v[108:111], v140, s[72:75], s76 offen
    s_add_u32 s76, s76, 57344
    s_waitcnt vmcnt(28)
    v_lshlrev_b32 v224, 16, v0
    v_and_b32 v225, 0xffff0000, v0
    v_add_f32 v128, v128, v224
    v_add_f32 v129, v129, v225
    v_lshlrev_b32 v224, 16, v1
    v_and_b32 v225, 0xffff0000, v1
    v_add_f32 v130, v130, v224
    v_add_f32 v131, v131, v225
    v_lshlrev_b32 v224, 16, v2
    v_and_b32 v225, 0xffff0000, v2
    v_add_f32 v132, v132, v224
    v_add_f32 v133, v133, v225
    v_lshlrev_b32 v224, 16, v3
    v_and_b32 v225, 0xffff0000, v3
    v_add_f32 v134, v134, v224
    v_add_f32 v135, v135, v225
    s_waitcnt vmcnt(27)
    v_lshlrev_b32 v224, 16, v4
    v_and_b32 v225, 0xffff0000, v4
    v_add_f32 v128, v128, v224
    v_add_f32 v129, v129, v225
    v_lshlrev_b32 v224, 16, v5
    v_and_b32 v225, 0xffff0000, v5
    v_add_f32 v130, v130, v224
    v_add_f32 v131, v131, v225
    v_lshlrev_b32 v224, 16, v6
    v_and_b32 v225, 0xffff0000, v6
    v_add_f32 v132, v132, v224
    v_add_f32 v133, v133, v225
    v_lshlrev_b32 v224, 16, v7
    v_and_b32 v225, 0xffff0000, v7
    v_add_f32 v134, v134, v224
    v_add_f32 v135, v135, v225
    s_waitcnt vmcnt(26)
    v_lshlrev_b32 v224, 16, v8
    v_and_b32 v225, 0xffff0000, v8
    v_add_f32 v128, v128, v224
    v_add_f32 v129, v129, v225
    v_lshlrev_b32 v224, 16, v9
    v_and_b32 v225, 0xffff0000, v9
    v_add_f32 v130, v130, v224
    v_add_f32 v131, v131, v225
    v_lshlrev_b32 v224, 16, v10
    v_and_b32 v225, 0xffff0000, v10
    v_add_f32 v132, v132, v224
    v_add_f32 v133, v133, v225
    v_lshlrev_b32 v224, 16, v11
    v_and_b32 v225, 0xffff0000, v11
    v_add_f32 v134, v134, v224
    v_add_f32 v135, v135, v225
    s_waitcnt lgkmcnt(0)
    s_barrier
    buffer_load_dwordx4 v[112:115], v140, s[72:75], s76 offen
    s_add_u32 s76, s76, 57344
    buffer_load_dwordx4 v[116:119], v140, s[72:75], s76 offen
    s_add_u32 s76, s76, 57344
    buffer_load_dwordx4 v[120:123], v140, s[72:75], s76 offen
    s_add_u32 s76, s76, 57344
    buffer_load_dwordx4 v[124:127], v140, s[72:75], s76 offen
    s_add_u32 s76, s76, 57344
    s_waitcnt vmcnt(29)
    v_lshlrev_b32 v224, 16, v12
    v_and_b32 v225, 0xffff0000, v12
    v_add_f32 v128, v128, v224
    v_add_f32 v129, v129, v225
    v_lshlrev_b32 v224, 16, v13
    v_and_b32 v225, 0xffff0000, v13
    v_add_f32 v130, v130, v224
    v_add_f32 v131, v131, v225
    v_lshlrev_b32 v224, 16, v14
    v_and_b32 v225, 0xffff0000, v14
    v_add_f32 v132, v132, v224
    v_add_f32 v133, v133, v225
    v_lshlrev_b32 v224, 16, v15
    v_and_b32 v225, 0xffff0000, v15
    v_add_f32 v134, v134, v224
    v_add_f32 v135, v135, v225
    s_waitcnt vmcnt(27)
    v_lshlrev_b32 v224, 16, v16
    v_and_b32 v225, 0xffff0000, v16
    v_add_f32 v128, v128, v224
    v_add_f32 v129, v129, v225
    v_lshlrev_b32 v224, 16, v17
    v_and_b32 v225, 0xffff0000, v17
    v_add_f32 v130, v130, v224
    v_add_f32 v131, v131, v225
    v_lshlrev_b32 v224, 16, v18
    v_and_b32 v225, 0xffff0000, v18
    v_add_f32 v132, v132, v224
    v_add_f32 v133, v133, v225
    v_lshlrev_b32 v224, 16, v19
    v_and_b32 v225, 0xffff0000, v19
    v_add_f32 v134, v134, v224
    v_add_f32 v135, v135, v225
    s_waitcnt vmcnt(26)
    v_lshlrev_b32 v224, 16, v20
    v_and_b32 v225, 0xffff0000, v20
    v_add_f32 v128, v128, v224
    v_add_f32 v129, v129, v225
    v_lshlrev_b32 v224, 16, v21
    v_and_b32 v225, 0xffff0000, v21
    v_add_f32 v130, v130, v224
    v_add_f32 v131, v131, v225
    v_lshlrev_b32 v224, 16, v22
    v_and_b32 v225, 0xffff0000, v22
    v_add_f32 v132, v132, v224
    v_add_f32 v133, v133, v225
    v_lshlrev_b32 v224, 16, v23
    v_and_b32 v225, 0xffff0000, v23
    v_add_f32 v134, v134, v224
    v_add_f32 v135, v135, v225
    s_waitcnt lgkmcnt(0)
    s_barrier
    buffer_load_dwordx4 v[0:3], v140, s[72:75], s76 offen
    s_add_u32 s76, s76, 57344
    buffer_load_dwordx4 v[4:7], v140, s[72:75], s76 offen
    s_add_u32 s76, s76, 57344
    buffer_load_dwordx4 v[8:11], v140, s[72:75], s76 offen
    s_add_u32 s76, s76, 57344
    buffer_load_dwordx4 v[12:15], v140, s[72:75], s76 offen
    s_add_u32 s76, s76, 57344
    s_waitcnt vmcnt(29)
    v_lshlrev_b32 v224, 16, v24
    v_and_b32 v225, 0xffff0000, v24
    v_add_f32 v128, v128, v224
    v_add_f32 v129, v129, v225
    v_lshlrev_b32 v224, 16, v25
    v_and_b32 v225, 0xffff0000, v25
    v_add_f32 v130, v130, v224
    v_add_f32 v131, v131, v225
    v_lshlrev_b32 v224, 16, v26
    v_and_b32 v225, 0xffff0000, v26
    v_add_f32 v132, v132, v224
    v_add_f32 v133, v133, v225
    v_lshlrev_b32 v224, 16, v27
    v_and_b32 v225, 0xffff0000, v27
    v_add_f32 v134, v134, v224
    v_add_f32 v135, v135, v225
    s_waitcnt vmcnt(28)
    v_lshlrev_b32 v224, 16, v28
    v_and_b32 v225, 0xffff0000, v28
    v_add_f32 v128, v128, v224
    v_add_f32 v129, v129, v225
    v_lshlrev_b32 v224, 16, v29
    v_and_b32 v225, 0xffff0000, v29
    v_add_f32 v130, v130, v224
    v_add_f32 v131, v131, v225
    v_lshlrev_b32 v224, 16, v30
    v_and_b32 v225, 0xffff0000, v30
    v_add_f32 v132, v132, v224
    v_add_f32 v133, v133, v225
    v_lshlrev_b32 v224, 16, v31
    v_and_b32 v225, 0xffff0000, v31
    v_add_f32 v134, v134, v224
    v_add_f32 v135, v135, v225
    s_waitcnt vmcnt(27)
    v_lshlrev_b32 v224, 16, v32
    v_and_b32 v225, 0xffff0000, v32
    v_add_f32 v128, v128, v224
    v_add_f32 v129, v129, v225
    v_lshlrev_b32 v224, 16, v33
    v_and_b32 v225, 0xffff0000, v33
    v_add_f32 v130, v130, v224
    v_add_f32 v131, v131, v225
    v_lshlrev_b32 v224, 16, v34
    v_and_b32 v225, 0xffff0000, v34
    v_add_f32 v132, v132, v224
    v_add_f32 v133, v133, v225
    v_lshlrev_b32 v224, 16, v35
    v_and_b32 v225, 0xffff0000, v35
    v_add_f32 v134, v134, v224
    v_add_f32 v135, v135, v225
    s_waitcnt lgkmcnt(0)
    s_barrier
    buffer_load_dwordx4 v[16:19], v140, s[72:75], s76 offen
    s_add_u32 s76, s76, 57344
    buffer_load_dwordx4 v[20:23], v140, s[72:75], s76 offen
    s_add_u32 s76, s76, 57344
    buffer_load_dwordx4 v[24:27], v140, s[72:75], s76 offen
    s_add_u32 s76, s76, 57344
    buffer_load_dwordx4 v[28:31], v140, s[72:75], s76 offen
    s_add_u32 s76, s76, 57344
    s_waitcnt vmcnt(30)
    v_lshlrev_b32 v224, 16, v36
    v_and_b32 v225, 0xffff0000, v36
    v_add_f32 v128, v128, v224
    v_add_f32 v129, v129, v225
    v_lshlrev_b32 v224, 16, v37
    v_and_b32 v225, 0xffff0000, v37
    v_add_f32 v130, v130, v224
    v_add_f32 v131, v131, v225
    v_lshlrev_b32 v224, 16, v38
    v_and_b32 v225, 0xffff0000, v38
    v_add_f32 v132, v132, v224
    v_add_f32 v133, v133, v225
    v_lshlrev_b32 v224, 16, v39
    v_and_b32 v225, 0xffff0000, v39
    v_add_f32 v134, v134, v224
    v_add_f32 v135, v135, v225
    s_waitcnt vmcnt(29)
    v_lshlrev_b32 v224, 16, v40
    v_and_b32 v225, 0xffff0000, v40
    v_add_f32 v128, v128, v224
    v_add_f32 v129, v129, v225
    v_lshlrev_b32 v224, 16, v41
    v_and_b32 v225, 0xffff0000, v41
    v_add_f32 v130, v130, v224
    v_add_f32 v131, v131, v225
    v_lshlrev_b32 v224, 16, v42
    v_and_b32 v225, 0xffff0000, v42
    v_add_f32 v132, v132, v224
    v_add_f32 v133, v133, v225
    v_lshlrev_b32 v224, 16, v43
    v_and_b32 v225, 0xffff0000, v43
    v_add_f32 v134, v134, v224
    v_add_f32 v135, v135, v225
    s_waitcnt vmcnt(28)
    v_lshlrev_b32 v224, 16, v44
    v_and_b32 v225, 0xffff0000, v44
    v_add_f32 v128, v128, v224
    v_add_f32 v129, v129, v225
    v_lshlrev_b32 v224, 16, v45
    v_and_b32 v225, 0xffff0000, v45
    v_add_f32 v130, v130, v224
    v_add_f32 v131, v131, v225
    v_lshlrev_b32 v224, 16, v46
    v_and_b32 v225, 0xffff0000, v46
    v_add_f32 v132, v132, v224
    v_add_f32 v133, v133, v225
    v_lshlrev_b32 v224, 16, v47
    v_and_b32 v225, 0xffff0000, v47
    v_add_f32 v134, v134, v224
    v_add_f32 v135, v135, v225
    s_waitcnt lgkmcnt(0)
    s_barrier
    buffer_load_dwordx4 v[32:35], v140, s[72:75], s76 offen
    s_add_u32 s76, s76, 57344
    buffer_load_dwordx4 v[36:39], v140, s[72:75], s76 offen
    s_add_u32 s76, s76, 57344
    buffer_load_dwordx4 v[40:43], v140, s[72:75], s76 offen
    s_add_u32 s76, s76, 57344
    buffer_load_dwordx4 v[44:47], v140, s[72:75], s76 offen
    s_add_u32 s76, s76, 57344
    s_waitcnt vmcnt(31)
    v_lshlrev_b32 v224, 16, v48
    v_and_b32 v225, 0xffff0000, v48
    v_add_f32 v128, v128, v224
    v_add_f32 v129, v129, v225
    v_lshlrev_b32 v224, 16, v49
    v_and_b32 v225, 0xffff0000, v49
    v_add_f32 v130, v130, v224
    v_add_f32 v131, v131, v225
    v_lshlrev_b32 v224, 16, v50
    v_and_b32 v225, 0xffff0000, v50
    v_add_f32 v132, v132, v224
    v_add_f32 v133, v133, v225
    v_lshlrev_b32 v224, 16, v51
    v_and_b32 v225, 0xffff0000, v51
    v_add_f32 v134, v134, v224
    v_add_f32 v135, v135, v225
    s_waitcnt vmcnt(30)
    v_lshlrev_b32 v224, 16, v52
    v_and_b32 v225, 0xffff0000, v52
    v_add_f32 v128, v128, v224
    v_add_f32 v129, v129, v225
    v_lshlrev_b32 v224, 16, v53
    v_and_b32 v225, 0xffff0000, v53
    v_add_f32 v130, v130, v224
    v_add_f32 v131, v131, v225
    v_lshlrev_b32 v224, 16, v54
    v_and_b32 v225, 0xffff0000, v54
    v_add_f32 v132, v132, v224
    v_add_f32 v133, v133, v225
    v_lshlrev_b32 v224, 16, v55
    v_and_b32 v225, 0xffff0000, v55
    v_add_f32 v134, v134, v224
    v_add_f32 v135, v135, v225
    s_waitcnt vmcnt(29)
    v_lshlrev_b32 v224, 16, v56
    v_and_b32 v225, 0xffff0000, v56
    v_add_f32 v128, v128, v224
    v_add_f32 v129, v129, v225
    v_lshlrev_b32 v224, 16, v57
    v_and_b32 v225, 0xffff0000, v57
    v_add_f32 v130, v130, v224
    v_add_f32 v131, v131, v225
    v_lshlrev_b32 v224, 16, v58
    v_and_b32 v225, 0xffff0000, v58
    v_add_f32 v132, v132, v224
    v_add_f32 v133, v133, v225
    v_lshlrev_b32 v224, 16, v59
    v_and_b32 v225, 0xffff0000, v59
    v_add_f32 v134, v134, v224
    v_add_f32 v135, v135, v225
    s_waitcnt lgkmcnt(0)
    s_barrier
    buffer_load_dwordx4 v[48:51], v140, s[72:75], s76 offen
    s_add_u32 s76, s76, 57344
    buffer_load_dwordx4 v[52:55], v140, s[72:75], s76 offen
    s_add_u32 s76, s76, 57344
    buffer_load_dwordx4 v[56:59], v140, s[72:75], s76 offen
    s_add_u32 s76, s76, 57344
    s_waitcnt vmcnt(31)
    v_lshlrev_b32 v224, 16, v60
    v_and_b32 v225, 0xffff0000, v60
    v_add_f32 v128, v128, v224
    v_add_f32 v129, v129, v225
    v_lshlrev_b32 v224, 16, v61
    v_and_b32 v225, 0xffff0000, v61
    v_add_f32 v130, v130, v224
    v_add_f32 v131, v131, v225
    v_lshlrev_b32 v224, 16, v62
    v_and_b32 v225, 0xffff0000, v62
    v_add_f32 v132, v132, v224
    v_add_f32 v133, v133, v225
    v_lshlrev_b32 v224, 16, v63
    v_and_b32 v225, 0xffff0000, v63
    v_add_f32 v134, v134, v224
    v_add_f32 v135, v135, v225
    s_waitcnt vmcnt(30)
    v_lshlrev_b32 v224, 16, v64
    v_and_b32 v225, 0xffff0000, v64
    v_add_f32 v128, v128, v224
    v_add_f32 v129, v129, v225
    v_lshlrev_b32 v224, 16, v65
    v_and_b32 v225, 0xffff0000, v65
    v_add_f32 v130, v130, v224
    v_add_f32 v131, v131, v225
    v_lshlrev_b32 v224, 16, v66
    v_and_b32 v225, 0xffff0000, v66
    v_add_f32 v132, v132, v224
    v_add_f32 v133, v133, v225
    v_lshlrev_b32 v224, 16, v67
    v_and_b32 v225, 0xffff0000, v67
    v_add_f32 v134, v134, v224
    v_add_f32 v135, v135, v225
    s_waitcnt vmcnt(29)
    v_lshlrev_b32 v224, 16, v68
    v_and_b32 v225, 0xffff0000, v68
    v_add_f32 v128, v128, v224
    v_add_f32 v129, v129, v225
    v_lshlrev_b32 v224, 16, v69
    v_and_b32 v225, 0xffff0000, v69
    v_add_f32 v130, v130, v224
    v_add_f32 v131, v131, v225
    v_lshlrev_b32 v224, 16, v70
    v_and_b32 v225, 0xffff0000, v70
    v_add_f32 v132, v132, v224
    v_add_f32 v133, v133, v225
    v_lshlrev_b32 v224, 16, v71
    v_and_b32 v225, 0xffff0000, v71
    v_add_f32 v134, v134, v224
    v_add_f32 v135, v135, v225
    s_waitcnt lgkmcnt(0)
    s_barrier
    buffer_load_dwordx4 v[60:63], v140, s[72:75], s76 offen
    s_add_u32 s76, s76, 57344
    buffer_load_dwordx4 v[64:67], v140, s[72:75], s76 offen
    s_add_u32 s76, s76, 57344
    buffer_load_dwordx4 v[68:71], v140, s[72:75], s76 offen
    s_add_u32 s76, s76, 57344
    s_waitcnt vmcnt(31)
    v_lshlrev_b32 v224, 16, v72
    v_and_b32 v225, 0xffff0000, v72
    v_add_f32 v128, v128, v224
    v_add_f32 v129, v129, v225
    v_lshlrev_b32 v224, 16, v73
    v_and_b32 v225, 0xffff0000, v73
    v_add_f32 v130, v130, v224
    v_add_f32 v131, v131, v225
    v_lshlrev_b32 v224, 16, v74
    v_and_b32 v225, 0xffff0000, v74
    v_add_f32 v132, v132, v224
    v_add_f32 v133, v133, v225
    v_lshlrev_b32 v224, 16, v75
    v_and_b32 v225, 0xffff0000, v75
    v_add_f32 v134, v134, v224
    v_add_f32 v135, v135, v225
    s_waitcnt vmcnt(30)
    v_lshlrev_b32 v224, 16, v76
    v_and_b32 v225, 0xffff0000, v76
    v_add_f32 v128, v128, v224
    v_add_f32 v129, v129, v225
    v_lshlrev_b32 v224, 16, v77
    v_and_b32 v225, 0xffff0000, v77
    v_add_f32 v130, v130, v224
    v_add_f32 v131, v131, v225
    v_lshlrev_b32 v224, 16, v78
    v_and_b32 v225, 0xffff0000, v78
    v_add_f32 v132, v132, v224
    v_add_f32 v133, v133, v225
    v_lshlrev_b32 v224, 16, v79
    v_and_b32 v225, 0xffff0000, v79
    v_add_f32 v134, v134, v224
    v_add_f32 v135, v135, v225
    s_waitcnt vmcnt(29)
    v_lshlrev_b32 v224, 16, v80
    v_and_b32 v225, 0xffff0000, v80
    v_add_f32 v128, v128, v224
    v_add_f32 v129, v129, v225
    v_lshlrev_b32 v224, 16, v81
    v_and_b32 v225, 0xffff0000, v81
    v_add_f32 v130, v130, v224
    v_add_f32 v131, v131, v225
    v_lshlrev_b32 v224, 16, v82
    v_and_b32 v225, 0xffff0000, v82
    v_add_f32 v132, v132, v224
    v_add_f32 v133, v133, v225
    v_lshlrev_b32 v224, 16, v83
    v_and_b32 v225, 0xffff0000, v83
    v_add_f32 v134, v134, v224
    v_add_f32 v135, v135, v225
    s_waitcnt lgkmcnt(0)
    s_barrier
    buffer_load_dwordx4 v[72:75], v140, s[72:75], s76 offen
    s_add_u32 s76, s76, 57344
    buffer_load_dwordx4 v[76:79], v140, s[72:75], s76 offen
    s_add_u32 s76, s76, 57344
    buffer_load_dwordx4 v[80:83], v140, s[72:75], s76 offen
    s_add_u32 s76, s76, 57344
    s_waitcnt vmcnt(31)
    v_lshlrev_b32 v224, 16, v84
    v_and_b32 v225, 0xffff0000, v84
    v_add_f32 v128, v128, v224
    v_add_f32 v129, v129, v225
    v_lshlrev_b32 v224, 16, v85
    v_and_b32 v225, 0xffff0000, v85
    v_add_f32 v130, v130, v224
    v_add_f32 v131, v131, v225
    v_lshlrev_b32 v224, 16, v86
    v_and_b32 v225, 0xffff0000, v86
    v_add_f32 v132, v132, v224
    v_add_f32 v133, v133, v225
    v_lshlrev_b32 v224, 16, v87
    v_and_b32 v225, 0xffff0000, v87
    v_add_f32 v134, v134, v224
    v_add_f32 v135, v135, v225
    s_waitcnt vmcnt(30)
    v_lshlrev_b32 v224, 16, v88
    v_and_b32 v225, 0xffff0000, v88
    v_add_f32 v128, v128, v224
    v_add_f32 v129, v129, v225
    v_lshlrev_b32 v224, 16, v89
    v_and_b32 v225, 0xffff0000, v89
    v_add_f32 v130, v130, v224
    v_add_f32 v131, v131, v225
    v_lshlrev_b32 v224, 16, v90
    v_and_b32 v225, 0xffff0000, v90
    v_add_f32 v132, v132, v224
    v_add_f32 v133, v133, v225
    v_lshlrev_b32 v224, 16, v91
    v_and_b32 v225, 0xffff0000, v91
    v_add_f32 v134, v134, v224
    v_add_f32 v135, v135, v225
    s_waitcnt vmcnt(29)
    v_lshlrev_b32 v224, 16, v92
    v_and_b32 v225, 0xffff0000, v92
    v_add_f32 v128, v128, v224
    v_add_f32 v129, v129, v225
    v_lshlrev_b32 v224, 16, v93
    v_and_b32 v225, 0xffff0000, v93
    v_add_f32 v130, v130, v224
    v_add_f32 v131, v131, v225
    v_lshlrev_b32 v224, 16, v94
    v_and_b32 v225, 0xffff0000, v94
    v_add_f32 v132, v132, v224
    v_add_f32 v133, v133, v225
    v_lshlrev_b32 v224, 16, v95
    v_and_b32 v225, 0xffff0000, v95
    v_add_f32 v134, v134, v224
    v_add_f32 v135, v135, v225
    s_waitcnt lgkmcnt(0)
    s_barrier
    buffer_load_dwordx4 v[84:87], v140, s[72:75], s76 offen
    s_add_u32 s76, s76, 57344
    buffer_load_dwordx4 v[88:91], v140, s[72:75], s76 offen
    s_add_u32 s76, s76, 57344
    buffer_load_dwordx4 v[92:95], v140, s[72:75], s76 offen
    s_add_u32 s76, s76, 57344
    s_waitcnt vmcnt(31)
    v_lshlrev_b32 v224, 16, v96
    v_and_b32 v225, 0xffff0000, v96
    v_add_f32 v128, v128, v224
    v_add_f32 v129, v129, v225
    v_lshlrev_b32 v224, 16, v97
    v_and_b32 v225, 0xffff0000, v97
    v_add_f32 v130, v130, v224
    v_add_f32 v131, v131, v225
    v_lshlrev_b32 v224, 16, v98
    v_and_b32 v225, 0xffff0000, v98
    v_add_f32 v132, v132, v224
    v_add_f32 v133, v133, v225
    v_lshlrev_b32 v224, 16, v99
    v_and_b32 v225, 0xffff0000, v99
    v_add_f32 v134, v134, v224
    v_add_f32 v135, v135, v225
    s_waitcnt vmcnt(30)
    v_lshlrev_b32 v224, 16, v100
    v_and_b32 v225, 0xffff0000, v100
    v_add_f32 v128, v128, v224
    v_add_f32 v129, v129, v225
    v_lshlrev_b32 v224, 16, v101
    v_and_b32 v225, 0xffff0000, v101
    v_add_f32 v130, v130, v224
    v_add_f32 v131, v131, v225
    v_lshlrev_b32 v224, 16, v102
    v_and_b32 v225, 0xffff0000, v102
    v_add_f32 v132, v132, v224
    v_add_f32 v133, v133, v225
    v_lshlrev_b32 v224, 16, v103
    v_and_b32 v225, 0xffff0000, v103
    v_add_f32 v134, v134, v224
    v_add_f32 v135, v135, v225
    s_waitcnt vmcnt(29)
    v_lshlrev_b32 v224, 16, v104
    v_and_b32 v225, 0xffff0000, v104
    v_add_f32 v128, v128, v224
    v_add_f32 v129, v129, v225
    v_lshlrev_b32 v224, 16, v105
    v_and_b32 v225, 0xffff0000, v105
    v_add_f32 v130, v130, v224
    v_add_f32 v131, v131, v225
    v_lshlrev_b32 v224, 16, v106
    v_and_b32 v225, 0xffff0000, v106
    v_add_f32 v132, v132, v224
    v_add_f32 v133, v133, v225
    v_lshlrev_b32 v224, 16, v107
    v_and_b32 v225, 0xffff0000, v107
    v_add_f32 v134, v134, v224
    v_add_f32 v135, v135, v225
    s_waitcnt lgkmcnt(0)
    s_barrier
    buffer_load_dwordx4 v[96:99], v140, s[72:75], s76 offen
    s_add_u32 s76, s76, 57344
    buffer_load_dwordx4 v[100:103], v140, s[72:75], s76 offen
    s_add_u32 s76, s76, 57344
    buffer_load_dwordx4 v[104:107], v140, s[72:75], s76 offen
    s_add_u32 s76, s76, 57344
    s_waitcnt vmcnt(31)
    v_lshlrev_b32 v224, 16, v108
    v_and_b32 v225, 0xffff0000, v108
    v_add_f32 v128, v128, v224
    v_add_f32 v129, v129, v225
    v_lshlrev_b32 v224, 16, v109
    v_and_b32 v225, 0xffff0000, v109
    v_add_f32 v130, v130, v224
    v_add_f32 v131, v131, v225
    v_lshlrev_b32 v224, 16, v110
    v_and_b32 v225, 0xffff0000, v110
    v_add_f32 v132, v132, v224
    v_add_f32 v133, v133, v225
    v_lshlrev_b32 v224, 16, v111
    v_and_b32 v225, 0xffff0000, v111
    v_add_f32 v134, v134, v224
    v_add_f32 v135, v135, v225
    s_waitcnt vmcnt(30)
    v_lshlrev_b32 v224, 16, v112
    v_and_b32 v225, 0xffff0000, v112
    v_add_f32 v128, v128, v224
    v_add_f32 v129, v129, v225
    v_lshlrev_b32 v224, 16, v113
    v_and_b32 v225, 0xffff0000, v113
    v_add_f32 v130, v130, v224
    v_add_f32 v131, v131, v225
    v_lshlrev_b32 v224, 16, v114
    v_and_b32 v225, 0xffff0000, v114
    v_add_f32 v132, v132, v224
    v_add_f32 v133, v133, v225
    v_lshlrev_b32 v224, 16, v115
    v_and_b32 v225, 0xffff0000, v115
    v_add_f32 v134, v134, v224
    v_add_f32 v135, v135, v225
    s_waitcnt vmcnt(29)
    v_lshlrev_b32 v224, 16, v116
    v_and_b32 v225, 0xffff0000, v116
    v_add_f32 v128, v128, v224
    v_add_f32 v129, v129, v225
    v_lshlrev_b32 v224, 16, v117
    v_and_b32 v225, 0xffff0000, v117
    v_add_f32 v130, v130, v224
    v_add_f32 v131, v131, v225
    v_lshlrev_b32 v224, 16, v118
    v_and_b32 v225, 0xffff0000, v118
    v_add_f32 v132, v132, v224
    v_add_f32 v133, v133, v225
    v_lshlrev_b32 v224, 16, v119
    v_and_b32 v225, 0xffff0000, v119
    v_add_f32 v134, v134, v224
    v_add_f32 v135, v135, v225
    s_waitcnt lgkmcnt(0)
    s_barrier
    buffer_load_dwordx4 v[108:111], v140, s[72:75], s76 offen
    s_add_u32 s76, s76, 57344
    buffer_load_dwordx4 v[112:115], v140, s[72:75], s76 offen
    s_add_u32 s76, s76, 57344
    buffer_load_dwordx4 v[116:119], v140, s[72:75], s76 offen
    s_add_u32 s76, s76, 57344
    s_waitcnt vmcnt(31)
    v_lshlrev_b32 v224, 16, v120
    v_and_b32 v225, 0xffff0000, v120
    v_add_f32 v128, v128, v224
    v_add_f32 v129, v129, v225
    v_lshlrev_b32 v224, 16, v121
    v_and_b32 v225, 0xffff0000, v121
    v_add_f32 v130, v130, v224
    v_add_f32 v131, v131, v225
    v_lshlrev_b32 v224, 16, v122
    v_and_b32 v225, 0xffff0000, v122
    v_add_f32 v132, v132, v224
    v_add_f32 v133, v133, v225
    v_lshlrev_b32 v224, 16, v123
    v_and_b32 v225, 0xffff0000, v123
    v_add_f32 v134, v134, v224
    v_add_f32 v135, v135, v225
    s_waitcnt vmcnt(30)
    v_lshlrev_b32 v224, 16, v124
    v_and_b32 v225, 0xffff0000, v124
    v_add_f32 v128, v128, v224
    v_add_f32 v129, v129, v225
    v_lshlrev_b32 v224, 16, v125
    v_and_b32 v225, 0xffff0000, v125
    v_add_f32 v130, v130, v224
    v_add_f32 v131, v131, v225
    v_lshlrev_b32 v224, 16, v126
    v_and_b32 v225, 0xffff0000, v126
    v_add_f32 v132, v132, v224
    v_add_f32 v133, v133, v225
    v_lshlrev_b32 v224, 16, v127
    v_and_b32 v225, 0xffff0000, v127
    v_add_f32 v134, v134, v224
    v_add_f32 v135, v135, v225
    s_waitcnt vmcnt(29)
    v_lshlrev_b32 v224, 16, v0
    v_and_b32 v225, 0xffff0000, v0
    v_add_f32 v128, v128, v224
    v_add_f32 v129, v129, v225
    v_lshlrev_b32 v224, 16, v1
    v_and_b32 v225, 0xffff0000, v1
    v_add_f32 v130, v130, v224
    v_add_f32 v131, v131, v225
    v_lshlrev_b32 v224, 16, v2
    v_and_b32 v225, 0xffff0000, v2
    v_add_f32 v132, v132, v224
    v_add_f32 v133, v133, v225
    v_lshlrev_b32 v224, 16, v3
    v_and_b32 v225, 0xffff0000, v3
    v_add_f32 v134, v134, v224
    v_add_f32 v135, v135, v225
    s_waitcnt lgkmcnt(0)
    s_barrier
    s_waitcnt vmcnt(28)
    v_lshlrev_b32 v224, 16, v4
    v_and_b32 v225, 0xffff0000, v4
    v_add_f32 v128, v128, v224
    v_add_f32 v129, v129, v225
    v_lshlrev_b32 v224, 16, v5
    v_and_b32 v225, 0xffff0000, v5
    v_add_f32 v130, v130, v224
    v_add_f32 v131, v131, v225
    v_lshlrev_b32 v224, 16, v6
    v_and_b32 v225, 0xffff0000, v6
    v_add_f32 v132, v132, v224
    v_add_f32 v133, v133, v225
    v_lshlrev_b32 v224, 16, v7
    v_and_b32 v225, 0xffff0000, v7
    v_add_f32 v134, v134, v224
    v_add_f32 v135, v135, v225
    s_waitcnt vmcnt(27)
    v_lshlrev_b32 v224, 16, v8
    v_and_b32 v225, 0xffff0000, v8
    v_add_f32 v128, v128, v224
    v_add_f32 v129, v129, v225
    v_lshlrev_b32 v224, 16, v9
    v_and_b32 v225, 0xffff0000, v9
    v_add_f32 v130, v130, v224
    v_add_f32 v131, v131, v225
    v_lshlrev_b32 v224, 16, v10
    v_and_b32 v225, 0xffff0000, v10
    v_add_f32 v132, v132, v224
    v_add_f32 v133, v133, v225
    v_lshlrev_b32 v224, 16, v11
    v_and_b32 v225, 0xffff0000, v11
    v_add_f32 v134, v134, v224
    v_add_f32 v135, v135, v225
    s_waitcnt vmcnt(26)
    v_lshlrev_b32 v224, 16, v12
    v_and_b32 v225, 0xffff0000, v12
    v_add_f32 v128, v128, v224
    v_add_f32 v129, v129, v225
    v_lshlrev_b32 v224, 16, v13
    v_and_b32 v225, 0xffff0000, v13
    v_add_f32 v130, v130, v224
    v_add_f32 v131, v131, v225
    v_lshlrev_b32 v224, 16, v14
    v_and_b32 v225, 0xffff0000, v14
    v_add_f32 v132, v132, v224
    v_add_f32 v133, v133, v225
    v_lshlrev_b32 v224, 16, v15
    v_and_b32 v225, 0xffff0000, v15
    v_add_f32 v134, v134, v224
    v_add_f32 v135, v135, v225
    s_waitcnt lgkmcnt(0)
    s_barrier
    s_waitcnt vmcnt(25)
    v_lshlrev_b32 v224, 16, v16
    v_and_b32 v225, 0xffff0000, v16
    v_add_f32 v128, v128, v224
    v_add_f32 v129, v129, v225
    v_lshlrev_b32 v224, 16, v17
    v_and_b32 v225, 0xffff0000, v17
    v_add_f32 v130, v130, v224
    v_add_f32 v131, v131, v225
    v_lshlrev_b32 v224, 16, v18
    v_and_b32 v225, 0xffff0000, v18
    v_add_f32 v132, v132, v224
    v_add_f32 v133, v133, v225
    v_lshlrev_b32 v224, 16, v19
    v_and_b32 v225, 0xffff0000, v19
    v_add_f32 v134, v134, v224
    v_add_f32 v135, v135, v225
    s_waitcnt vmcnt(24)
    v_lshlrev_b32 v224, 16, v20
    v_and_b32 v225, 0xffff0000, v20
    v_add_f32 v128, v128, v224
    v_add_f32 v129, v129, v225
    v_lshlrev_b32 v224, 16, v21
    v_and_b32 v225, 0xffff0000, v21
    v_add_f32 v130, v130, v224
    v_add_f32 v131, v131, v225
    v_lshlrev_b32 v224, 16, v22
    v_and_b32 v225, 0xffff0000, v22
    v_add_f32 v132, v132, v224
    v_add_f32 v133, v133, v225
    v_lshlrev_b32 v224, 16, v23
    v_and_b32 v225, 0xffff0000, v23
    v_add_f32 v134, v134, v224
    v_add_f32 v135, v135, v225
    s_waitcnt vmcnt(23)
    v_lshlrev_b32 v224, 16, v24
    v_and_b32 v225, 0xffff0000, v24
    v_add_f32 v128, v128, v224
    v_add_f32 v129, v129, v225
    v_lshlrev_b32 v224, 16, v25
    v_and_b32 v225, 0xffff0000, v25
    v_add_f32 v130, v130, v224
    v_add_f32 v131, v131, v225
    v_lshlrev_b32 v224, 16, v26
    v_and_b32 v225, 0xffff0000, v26
    v_add_f32 v132, v132, v224
    v_add_f32 v133, v133, v225
    v_lshlrev_b32 v224, 16, v27
    v_and_b32 v225, 0xffff0000, v27
    v_add_f32 v134, v134, v224
    v_add_f32 v135, v135, v225
    s_waitcnt lgkmcnt(0)
    s_barrier
    s_waitcnt vmcnt(22)
    v_lshlrev_b32 v224, 16, v28
    v_and_b32 v225, 0xffff0000, v28
    v_add_f32 v128, v128, v224
    v_add_f32 v129, v129, v225
    v_lshlrev_b32 v224, 16, v29
    v_and_b32 v225, 0xffff0000, v29
    v_add_f32 v130, v130, v224
    v_add_f32 v131, v131, v225
    v_lshlrev_b32 v224, 16, v30
    v_and_b32 v225, 0xffff0000, v30
    v_add_f32 v132, v132, v224
    v_add_f32 v133, v133, v225
    v_lshlrev_b32 v224, 16, v31
    v_and_b32 v225, 0xffff0000, v31
    v_add_f32 v134, v134, v224
    v_add_f32 v135, v135, v225
    s_waitcnt vmcnt(21)
    v_lshlrev_b32 v224, 16, v32
    v_and_b32 v225, 0xffff0000, v32
    v_add_f32 v128, v128, v224
    v_add_f32 v129, v129, v225
    v_lshlrev_b32 v224, 16, v33
    v_and_b32 v225, 0xffff0000, v33
    v_add_f32 v130, v130, v224
    v_add_f32 v131, v131, v225
    v_lshlrev_b32 v224, 16, v34
    v_and_b32 v225, 0xffff0000, v34
    v_add_f32 v132, v132, v224
    v_add_f32 v133, v133, v225
    v_lshlrev_b32 v224, 16, v35
    v_and_b32 v225, 0xffff0000, v35
    v_add_f32 v134, v134, v224
    v_add_f32 v135, v135, v225
    s_waitcnt vmcnt(20)
    v_lshlrev_b32 v224, 16, v36
    v_and_b32 v225, 0xffff0000, v36
    v_add_f32 v128, v128, v224
    v_add_f32 v129, v129, v225
    v_lshlrev_b32 v224, 16, v37
    v_and_b32 v225, 0xffff0000, v37
    v_add_f32 v130, v130, v224
    v_add_f32 v131, v131, v225
    v_lshlrev_b32 v224, 16, v38
    v_and_b32 v225, 0xffff0000, v38
    v_add_f32 v132, v132, v224
    v_add_f32 v133, v133, v225
    v_lshlrev_b32 v224, 16, v39
    v_and_b32 v225, 0xffff0000, v39
    v_add_f32 v134, v134, v224
    v_add_f32 v135, v135, v225
    s_waitcnt lgkmcnt(0)
    s_barrier
    v_lshlrev_b32 v224, 1, v254
    s_mov_b32 s56, 262144
    s_mov_b64 exec, 0xff
hs_39:
    buffer_load_dword v225, v224, s[32:35], 0 offen sc0 sc1
    s_waitcnt vmcnt(0)
    v_and_b32 v226, 63, v225
    v_cmp_ne_u32 vcc, 32, v226
    s_cbranch_vccz hs_40
    s_sleep 1
    s_sub_u32 s56, s56, 1
    s_cmp_lg_u32 s56, 0
    s_cbranch_scc1 hs_39
hs_40:
    s_mov_b64 exec, -1
    s_and_b32 s55, s2, 7
    s_nop 3
    v_readlane_b32 s55, v225, s55
    s_lshl_b32 s56, s77, 5
    s_nop 3
    s_cmp_lg_u32 s55, s56
    s_cselect_b32 s55, 1, 0
    v_mov_b32 v224, 157568
    v_mov_b32 v225, s55
    ds_write_b32 v224, v225
    s_mov_b32 s55, 71565312
    s_mov_b32 s56, 262144
p4_41:
    buffer_load_dwordx4 v[144:147], v254, s[4:7], s55 offen sc0 sc1
    s_waitcnt vmcnt(0)
    v_and_b32 v144, v144, v145
    v_and_b32 v146, v146, v147
    v_and_b32 v144, v144, v146
    v_cmp_ne_u32 vcc, 1, v144
    s_cbranch_vccz p4_42
    s_sleep 1
    s_sub_u32 s56, s56, 1
    s_cmp_lg_u32 s56, 0
    s_cbranch_scc1 p4_41
p4_42:
    v_lshrrev_b32 v224, 1, v254
    s_lshl_b32 s55, s40, 10
    s_add_u32 s55, s55, 70254464
    buffer_load_dwordx2 v[144:145], v224, s[4:7], s55 offen offset:0 sc1
    buffer_load_dwordx2 v[146:147], v224, s[4:7], s55 offen offset:512 sc1
    buffer_load_dwordx2 v[148:149], v224, s[4:7], s55 offen offset:1024 sc1
    v_lshrrev_b32 v225, 8, v254
    v_and_b32 v224, 0xf0, v254
    v_lshl_add_u32 v224, v225, 12, v224
    s_lshl_b32 s55, s51, 8
    s_add_u32 s55, s55, 70516736
    buffer_load_dwordx4 v[152:155], v224, s[4:7], s55 offen sc1
    s_add_u32 s55, s55, 12288
    buffer_load_dwordx4 v[156:159], v224, s[4:7], s55 offen sc1
    s_add_u32 s55, s55, 12288
    buffer_load_dwordx4 v[160:163], v224, s[4:7], s55 offen sc1
    s_add_u32 s55, s55, 12288
    buffer_load_dwordx4 v[164:167], v224, s[4:7], s55 offen sc1
    s_add_u32 s55, s55, 12288
    buffer_load_dwordx4 v[168:171], v224, s[4:7], s55 offen sc1
    s_add_u32 s55, s55, 12288
    buffer_load_dwordx4 v[172:175], v224, s[4:7], s55 offen sc1
    s_add_u32 s55, s55, 12288
    buffer_load_dwordx4 v[176:179], v224, s[4:7], s55 offen sc1
    s_add_u32 s55, s55, 12288
    buffer_load_dwordx4 v[180:183], v224, s[4:7], s55 offen sc1
    s_add_u32 s55, s55, 12288
    s_mov_b32 s78, s55
    v_mov_b32 v141, v224
    s_waitcnt lgkmcnt(0)
    s_barrier
    s_waitcnt vmcnt(8)
    s_cmp_eq_u32 s40, 0
    s_cselect_b32 s70, 0xffff, 0
    s_mov_b32 s71, 0
    v_cndmask_b32 v144, v144, 0, s[70:71]
    v_cndmask_b32 v145, v145, 0, s[70:71]
    v_mul_f32 v144, 0x3a800000, v144
    v_mul_f32 v145, 0x3a800000, v145
    v_fma_f32 v145, -v144, v144, v145
    v_max_f32 v145, 0, v145
    v_cvt_pk_bf16_f32 v144, v144, v144
    v_lshlrev_b32 v144, 16, v144
    v_cvt_pk_bf16_f32 v145, v145, v145
    v_lshlrev_b32 v145, 16, v145
    v_add_f32 v145, 0x3727c5ac, v145
    v_cvt_pk_bf16_f32 v145, v145, v145
    v_lshlrev_b32 v145, 16, v145
    v_sqrt_f32 v145, v145
    s_nop 0
    v_cvt_pk_bf16_f32 v145, v145, v145
    v_lshlrev_b32 v145, 16, v145
    v_rcp_f32 v145, v145
    s_nop 0
    v_mul_f32 v146, 0x3a800000, v146
    v_mul_f32 v147, 0x3a800000, v147
    v_fma_f32 v147, -v146, v146, v147
    v_max_f32 v147, 0, v147
    v_cvt_pk_bf16_f32 v146, v146, v146
    v_lshlrev_b32 v146, 16, v146
    v_cvt_pk_bf16_f32 v147, v147, v147
    v_lshlrev_b32 v147, 16, v147
    v_add_f32 v147, 0x3727c5ac, v147
    v_cvt_pk_bf16_f32 v147, v147, v147
    v_lshlrev_b32 v147, 16, v147
    v_sqrt_f32 v147, v147
    s_nop 0
    v_cvt_pk_bf16_f32 v147, v147, v147
    v_lshlrev_b32 v147, 16, v147
    v_rcp_f32 v147, v147
    s_nop 0
    v_mul_f32 v148, 0x3a800000, v148
    v_mul_f32 v149, 0x3a800000, v149
    v_fma_f32 v149, -v148, v148, v149
    v_max_f32 v149, 0, v149
    v_cvt_pk_bf16_f32 v148, v148, v148
    v_lshlrev_b32 v148, 16, v148
    v_cvt_pk_bf16_f32 v149, v149, v149
    v_lshlrev_b32 v149, 16, v149
    v_add_f32 v149, 0x3727c5ac, v149
    v_cvt_pk_bf16_f32 v149, v149, v149
    v_lshlrev_b32 v149, 16, v149
    v_sqrt_f32 v149, v149
    s_nop 0
    v_cvt_pk_bf16_f32 v149, v149, v149
    v_lshlrev_b32 v149, 16, v149
    v_rcp_f32 v149, v149
    s_nop 0
    v_lshrrev_b32 v224, 1, v254
    v_add_u32 v224, 153600, v224
    ds_write_b64 v224, v[144:145]
    ds_write_b64 v224, v[146:147] offset:512
    s_mov_b64 exec, 0xffff
    ds_write_b64 v224, v[148:149] offset:1024
    s_mov_b64 exec, -1
    s_waitcnt lgkmcnt(0)
    s_barrier
    s_waitcnt vmcnt(0)
    v_add_f32 v152, v152, v156
    v_add_f32 v153, v153, v157
    v_add_f32 v154, v154, v158
    v_add_f32 v155, v155, v159
    v_add_f32 v152, v152, v160
    v_add_f32 v153, v153, v161
    v_add_f32 v154, v154, v162
    v_add_f32 v155, v155, v163
    v_add_f32 v152, v152, v164
    v_add_f32 v153, v153, v165
    v_add_f32 v154, v154, v166
    v_add_f32 v155, v155, v167
    v_add_f32 v152, v152, v168
    v_add_f32 v153, v153, v169
    v_add_f32 v154, v154, v170
    v_add_f32 v155, v155, v171
    v_add_f32 v152, v152, v172
    v_add_f32 v153, v153, v173
    v_add_f32 v154, v154, v174
    v_add_f32 v155, v155, v175
    v_add_f32 v152, v152, v176
    v_add_f32 v153, v153, v177
    v_add_f32 v154, v154, v178
    v_add_f32 v155, v155, v179
    v_add_f32 v152, v152, v180
    v_add_f32 v153, v153, v181
    v_add_f32 v154, v154, v182
    v_add_f32 v155, v155, v183
    s_nop 1
    buffer_load_dwordx4 v[156:159], v141, s[4:7], s78 offen sc1
    s_add_u32 s78, s78, 12288
    buffer_load_dwordx4 v[160:163], v141, s[4:7], s78 offen sc1
    s_add_u32 s78, s78, 12288
    buffer_load_dwordx4 v[164:167], v141, s[4:7], s78 offen sc1
    s_add_u32 s78, s78, 12288
    buffer_load_dwordx4 v[168:171], v141, s[4:7], s78 offen sc1
    s_add_u32 s78, s78, 12288
    buffer_load_dwordx4 v[172:175], v141, s[4:7], s78 offen sc1
    s_add_u32 s78, s78, 12288
    buffer_load_dwordx4 v[176:179], v141, s[4:7], s78 offen sc1
    s_add_u32 s78, s78, 12288
    buffer_load_dwordx4 v[180:183], v141, s[4:7], s78 offen sc1
    s_add_u32 s78, s78, 12288
    buffer_load_dwordx4 v[184:187], v141, s[4:7], s78 offen sc1
    s_add_u32 s78, s78, 12288
    s_waitcnt lgkmcnt(0)
    s_barrier
    s_waitcnt lgkmcnt(0)
    s_barrier
    v_lshlrev_b32 v224, 16, v40
    v_and_b32 v225, 0xffff0000, v40
    v_add_f32 v128, v128, v224
    v_add_f32 v129, v129, v225
    v_lshlrev_b32 v224, 16, v41
    v_and_b32 v225, 0xffff0000, v41
    v_add_f32 v130, v130, v224
    v_add_f32 v131, v131, v225
    v_lshlrev_b32 v224, 16, v42
    v_and_b32 v225, 0xffff0000, v42
    v_add_f32 v132, v132, v224
    v_add_f32 v133, v133, v225
    v_lshlrev_b32 v224, 16, v43
    v_and_b32 v225, 0xffff0000, v43
    v_add_f32 v134, v134, v224
    v_add_f32 v135, v135, v225
    v_lshlrev_b32 v224, 16, v44
    v_and_b32 v225, 0xffff0000, v44
    v_add_f32 v128, v128, v224
    v_add_f32 v129, v129, v225
    v_lshlrev_b32 v224, 16, v45
    v_and_b32 v225, 0xffff0000, v45
    v_add_f32 v130, v130, v224
    v_add_f32 v131, v131, v225
    v_lshlrev_b32 v224, 16, v46
    v_and_b32 v225, 0xffff0000, v46
    v_add_f32 v132, v132, v224
    v_add_f32 v133, v133, v225
    v_lshlrev_b32 v224, 16, v47
    v_and_b32 v225, 0xffff0000, v47
    v_add_f32 v134, v134, v224
    v_add_f32 v135, v135, v225
    v_lshlrev_b32 v224, 16, v48
    v_and_b32 v225, 0xffff0000, v48
    v_add_f32 v128, v128, v224
    v_add_f32 v129, v129, v225
    v_lshlrev_b32 v224, 16, v49
    v_and_b32 v225, 0xffff0000, v49
    v_add_f32 v130, v130, v224
    v_add_f32 v131, v131, v225
    v_lshlrev_b32 v224, 16, v50
    v_and_b32 v225, 0xffff0000, v50
    v_add_f32 v132, v132, v224
    v_add_f32 v133, v133, v225
    v_lshlrev_b32 v224, 16, v51
    v_and_b32 v225, 0xffff0000, v51
    v_add_f32 v134, v134, v224
    v_add_f32 v135, v135, v225
    s_waitcnt vmcnt(0)
    v_add_f32 v152, v152, v156
    v_add_f32 v153, v153, v157
    v_add_f32 v154, v154, v158
    v_add_f32 v155, v155, v159
    v_add_f32 v152, v152, v160
    v_add_f32 v153, v153, v161
    v_add_f32 v154, v154, v162
    v_add_f32 v155, v155, v163
    v_add_f32 v152, v152, v164
    v_add_f32 v153, v153, v165
    v_add_f32 v154, v154, v166
    v_add_f32 v155, v155, v167
    v_add_f32 v152, v152, v168
    v_add_f32 v153, v153, v169
    v_add_f32 v154, v154, v170
    v_add_f32 v155, v155, v171
    v_add_f32 v152, v152, v172
    v_add_f32 v153, v153, v173
    v_add_f32 v154, v154, v174
    v_add_f32 v155, v155, v175
    v_add_f32 v152, v152, v176
    v_add_f32 v153, v153, v177
    v_add_f32 v154, v154, v178
    v_add_f32 v155, v155, v179
    v_add_f32 v152, v152, v180
    v_add_f32 v153, v153, v181
    v_add_f32 v154, v154, v182
    v_add_f32 v155, v155, v183
    v_add_f32 v152, v152, v184
    v_add_f32 v153, v153, v185
    v_add_f32 v154, v154, v186
    v_add_f32 v155, v155, v187
    v_add_u32 v224, 154752, v254
    s_mov_b32 s70, -1
    s_mov_b32 s71, 0xffff
    s_mov_b64 exec, s[70:71]
    ds_write_b128 v224, v[152:155]
    s_mov_b64 exec, -1
    s_waitcnt lgkmcnt(0)
    s_barrier
    v_lshlrev_b32 v224, 16, v52
    v_and_b32 v225, 0xffff0000, v52
    v_add_f32 v128, v128, v224
    v_add_f32 v129, v129, v225
    v_lshlrev_b32 v224, 16, v53
    v_and_b32 v225, 0xffff0000, v53
    v_add_f32 v130, v130, v224
    v_add_f32 v131, v131, v225
    v_lshlrev_b32 v224, 16, v54
    v_and_b32 v225, 0xffff0000, v54
    v_add_f32 v132, v132, v224
    v_add_f32 v133, v133, v225
    v_lshlrev_b32 v224, 16, v55
    v_and_b32 v225, 0xffff0000, v55
    v_add_f32 v134, v134, v224
    v_add_f32 v135, v135, v225
    v_lshlrev_b32 v224, 16, v56
    v_and_b32 v225, 0xffff0000, v56
    v_add_f32 v128, v128, v224
    v_add_f32 v129, v129, v225
    v_lshlrev_b32 v224, 16, v57
    v_and_b32 v225, 0xffff0000, v57
    v_add_f32 v130, v130, v224
    v_add_f32 v131, v131, v225
    v_lshlrev_b32 v224, 16, v58
    v_and_b32 v225, 0xffff0000, v58
    v_add_f32 v132, v132, v224
    v_add_f32 v133, v133, v225
    v_lshlrev_b32 v224, 16, v59
    v_and_b32 v225, 0xffff0000, v59
    v_add_f32 v134, v134, v224
    v_add_f32 v135, v135, v225
    v_lshlrev_b32 v224, 16, v60
    v_and_b32 v225, 0xffff0000, v60
    v_add_f32 v128, v128, v224
    v_add_f32 v129, v129, v225
    v_lshlrev_b32 v224, 16, v61
    v_and_b32 v225, 0xffff0000, v61
    v_add_f32 v130, v130, v224
    v_add_f32 v131, v131, v225
    v_lshlrev_b32 v224, 16, v62
    v_and_b32 v225, 0xffff0000, v62
    v_add_f32 v132, v132, v224
    v_add_f32 v133, v133, v225
    v_lshlrev_b32 v224, 16, v63
    v_and_b32 v225, 0xffff0000, v63
    v_add_f32 v134, v134, v224
    v_add_f32 v135, v135, v225
    buffer_load_dwordx4 v[120:123], v140, s[72:75], s76 offen
    s_add_u32 s76, s76, 57344
    buffer_load_dwordx4 v[124:127], v140, s[72:75], s76 offen
    s_add_u32 s76, s76, 57344
    s_waitcnt lgkmcnt(0)
    s_barrier
    v_lshlrev_b32 v224, 16, v64
    v_and_b32 v225, 0xffff0000, v64
    v_add_f32 v128, v128, v224
    v_add_f32 v129, v129, v225
    v_lshlrev_b32 v224, 16, v65
    v_and_b32 v225, 0xffff0000, v65
    v_add_f32 v130, v130, v224
    v_add_f32 v131, v131, v225
    v_lshlrev_b32 v224, 16, v66
    v_and_b32 v225, 0xffff0000, v66
    v_add_f32 v132, v132, v224
    v_add_f32 v133, v133, v225
    v_lshlrev_b32 v224, 16, v67
    v_and_b32 v225, 0xffff0000, v67
    v_add_f32 v134, v134, v224
    v_add_f32 v135, v135, v225
    v_lshlrev_b32 v224, 16, v68
    v_and_b32 v225, 0xffff0000, v68
    v_add_f32 v128, v128, v224
    v_add_f32 v129, v129, v225
    v_lshlrev_b32 v224, 16, v69
    v_and_b32 v225, 0xffff0000, v69
    v_add_f32 v130, v130, v224
    v_add_f32 v131, v131, v225
    v_lshlrev_b32 v224, 16, v70
    v_and_b32 v225, 0xffff0000, v70
    v_add_f32 v132, v132, v224
    v_add_f32 v133, v133, v225
    v_lshlrev_b32 v224, 16, v71
    v_and_b32 v225, 0xffff0000, v71
    v_add_f32 v134, v134, v224
    v_add_f32 v135, v135, v225
    v_lshlrev_b32 v224, 16, v72
    v_and_b32 v225, 0xffff0000, v72
    v_add_f32 v128, v128, v224
    v_add_f32 v129, v129, v225
    v_lshlrev_b32 v224, 16, v73
    v_and_b32 v225, 0xffff0000, v73
    v_add_f32 v130, v130, v224
    v_add_f32 v131, v131, v225
    v_lshlrev_b32 v224, 16, v74
    v_and_b32 v225, 0xffff0000, v74
    v_add_f32 v132, v132, v224
    v_add_f32 v133, v133, v225
    v_lshlrev_b32 v224, 16, v75
    v_and_b32 v225, 0xffff0000, v75
    v_add_f32 v134, v134, v224
    v_add_f32 v135, v135, v225
    s_waitcnt lgkmcnt(0)
    s_barrier
    v_lshlrev_b32 v224, 16, v76
    v_and_b32 v225, 0xffff0000, v76
    v_add_f32 v128, v128, v224
    v_add_f32 v129, v129, v225
    v_lshlrev_b32 v224, 16, v77
    v_and_b32 v225, 0xffff0000, v77
    v_add_f32 v130, v130, v224
    v_add_f32 v131, v131, v225
    v_lshlrev_b32 v224, 16, v78
    v_and_b32 v225, 0xffff0000, v78
    v_add_f32 v132, v132, v224
    v_add_f32 v133, v133, v225
    v_lshlrev_b32 v224, 16, v79
    v_and_b32 v225, 0xffff0000, v79
    v_add_f32 v134, v134, v224
    v_add_f32 v135, v135, v225
    v_lshlrev_b32 v224, 16, v80
    v_and_b32 v225, 0xffff0000, v80
    v_add_f32 v128, v128, v224
    v_add_f32 v129, v129, v225
    v_lshlrev_b32 v224, 16, v81
    v_and_b32 v225, 0xffff0000, v81
    v_add_f32 v130, v130, v224
    v_add_f32 v131, v131, v225
    v_lshlrev_b32 v224, 16, v82
    v_and_b32 v225, 0xffff0000, v82
    v_add_f32 v132, v132, v224
    v_add_f32 v133, v133, v225
    v_lshlrev_b32 v224, 16, v83
    v_and_b32 v225, 0xffff0000, v83
    v_add_f32 v134, v134, v224
    v_add_f32 v135, v135, v225
    v_lshlrev_b32 v224, 16, v84
    v_and_b32 v225, 0xffff0000, v84
    v_add_f32 v128, v128, v224
    v_add_f32 v129, v129, v225
    v_lshlrev_b32 v224, 16, v85
    v_and_b32 v225, 0xffff0000, v85
    v_add_f32 v130, v130, v224
    v_add_f32 v131, v131, v225
    v_lshlrev_b32 v224, 16, v86
    v_and_b32 v225, 0xffff0000, v86
    v_add_f32 v132, v132, v224
    v_add_f32 v133, v133, v225
    v_lshlrev_b32 v224, 16, v87
    v_and_b32 v225, 0xffff0000, v87
    v_add_f32 v134, v134, v224
    v_add_f32 v135, v135, v225
    s_waitcnt lgkmcnt(0)
    s_barrier
    v_lshlrev_b32 v224, 16, v88
    v_and_b32 v225, 0xffff0000, v88
    v_add_f32 v128, v128, v224
    v_add_f32 v129, v129, v225
    v_lshlrev_b32 v224, 16, v89
    v_and_b32 v225, 0xffff0000, v89
    v_add_f32 v130, v130, v224
    v_add_f32 v131, v131, v225
    v_lshlrev_b32 v224, 16, v90
    v_and_b32 v225, 0xffff0000, v90
    v_add_f32 v132, v132, v224
    v_add_f32 v133, v133, v225
    v_lshlrev_b32 v224, 16, v91
    v_and_b32 v225, 0xffff0000, v91
    v_add_f32 v134, v134, v224
    v_add_f32 v135, v135, v225
    v_lshlrev_b32 v224, 16, v92
    v_and_b32 v225, 0xffff0000, v92
    v_add_f32 v128, v128, v224
    v_add_f32 v129, v129, v225
    v_lshlrev_b32 v224, 16, v93
    v_and_b32 v225, 0xffff0000, v93
    v_add_f32 v130, v130, v224
    v_add_f32 v131, v131, v225
    v_lshlrev_b32 v224, 16, v94
    v_and_b32 v225, 0xffff0000, v94
    v_add_f32 v132, v132, v224
    v_add_f32 v133, v133, v225
    v_lshlrev_b32 v224, 16, v95
    v_and_b32 v225, 0xffff0000, v95
    v_add_f32 v134, v134, v224
    v_add_f32 v135, v135, v225
    v_lshlrev_b32 v224, 16, v96
    v_and_b32 v225, 0xffff0000, v96
    v_add_f32 v128, v128, v224
    v_add_f32 v129, v129, v225
    v_lshlrev_b32 v224, 16, v97
    v_and_b32 v225, 0xffff0000, v97
    v_add_f32 v130, v130, v224
    v_add_f32 v131, v131, v225
    v_lshlrev_b32 v224, 16, v98
    v_and_b32 v225, 0xffff0000, v98
    v_add_f32 v132, v132, v224
    v_add_f32 v133, v133, v225
    v_lshlrev_b32 v224, 16, v99
    v_and_b32 v225, 0xffff0000, v99
    v_add_f32 v134, v134, v224
    v_add_f32 v135, v135, v225
    s_waitcnt lgkmcnt(0)
    s_barrier
    v_lshlrev_b32 v224, 16, v100
    v_and_b32 v225, 0xffff0000, v100
    v_add_f32 v128, v128, v224
    v_add_f32 v129, v129, v225
    v_lshlrev_b32 v224, 16, v101
    v_and_b32 v225, 0xffff0000, v101
    v_add_f32 v130, v130, v224
    v_add_f32 v131, v131, v225
    v_lshlrev_b32 v224, 16, v102
    v_and_b32 v225, 0xffff0000, v102
    v_add_f32 v132, v132, v224
    v_add_f32 v133, v133, v225
    v_lshlrev_b32 v224, 16, v103
    v_and_b32 v225, 0xffff0000, v103
    v_add_f32 v134, v134, v224
    v_add_f32 v135, v135, v225
    v_lshlrev_b32 v224, 16, v104
    v_and_b32 v225, 0xffff0000, v104
    v_add_f32 v128, v128, v224
    v_add_f32 v129, v129, v225
    v_lshlrev_b32 v224, 16, v105
    v_and_b32 v225, 0xffff0000, v105
    v_add_f32 v130, v130, v224
    v_add_f32 v131, v131, v225
    v_lshlrev_b32 v224, 16, v106
    v_and_b32 v225, 0xffff0000, v106
    v_add_f32 v132, v132, v224
    v_add_f32 v133, v133, v225
    v_lshlrev_b32 v224, 16, v107
    v_and_b32 v225, 0xffff0000, v107
    v_add_f32 v134, v134, v224
    v_add_f32 v135, v135, v225
    v_lshlrev_b32 v224, 16, v108
    v_and_b32 v225, 0xffff0000, v108
    v_add_f32 v128, v128, v224
    v_add_f32 v129, v129, v225
    v_lshlrev_b32 v224, 16, v109
    v_and_b32 v225, 0xffff0000, v109
    v_add_f32 v130, v130, v224
    v_add_f32 v131, v131, v225
    v_lshlrev_b32 v224, 16, v110
    v_and_b32 v225, 0xffff0000, v110
    v_add_f32 v132, v132, v224
    v_add_f32 v133, v133, v225
    v_lshlrev_b32 v224, 16, v111
    v_and_b32 v225, 0xffff0000, v111
    v_add_f32 v134, v134, v224
    v_add_f32 v135, v135, v225
    v_lshlrev_b32 v224, 16, v112
    v_and_b32 v225, 0xffff0000, v112
    v_add_f32 v128, v128, v224
    v_add_f32 v129, v129, v225
    v_lshlrev_b32 v224, 16, v113
    v_and_b32 v225, 0xffff0000, v113
    v_add_f32 v130, v130, v224
    v_add_f32 v131, v131, v225
    v_lshlrev_b32 v224, 16, v114
    v_and_b32 v225, 0xffff0000, v114
    v_add_f32 v132, v132, v224
    v_add_f32 v133, v133, v225
    v_lshlrev_b32 v224, 16, v115
    v_and_b32 v225, 0xffff0000, v115
    v_add_f32 v134, v134, v224
    v_add_f32 v135, v135, v225
    v_lshlrev_b32 v224, 16, v116
    v_and_b32 v225, 0xffff0000, v116
    v_add_f32 v128, v128, v224
    v_add_f32 v129, v129, v225
    v_lshlrev_b32 v224, 16, v117
    v_and_b32 v225, 0xffff0000, v117
    v_add_f32 v130, v130, v224
    v_add_f32 v131, v131, v225
    v_lshlrev_b32 v224, 16, v118
    v_and_b32 v225, 0xffff0000, v118
    v_add_f32 v132, v132, v224
    v_add_f32 v133, v133, v225
    v_lshlrev_b32 v224, 16, v119
    v_and_b32 v225, 0xffff0000, v119
    v_add_f32 v134, v134, v224
    v_add_f32 v135, v135, v225
    s_waitcnt vmcnt(1)
    v_lshlrev_b32 v224, 16, v120
    v_and_b32 v225, 0xffff0000, v120
    v_add_f32 v128, v128, v224
    v_add_f32 v129, v129, v225
    v_lshlrev_b32 v224, 16, v121
    v_and_b32 v225, 0xffff0000, v121
    v_add_f32 v130, v130, v224
    v_add_f32 v131, v131, v225
    v_lshlrev_b32 v224, 16, v122
    v_and_b32 v225, 0xffff0000, v122
    v_add_f32 v132, v132, v224
    v_add_f32 v133, v133, v225
    v_lshlrev_b32 v224, 16, v123
    v_and_b32 v225, 0xffff0000, v123
    v_add_f32 v134, v134, v224
    v_add_f32 v135, v135, v225
    s_waitcnt vmcnt(0)
    v_lshlrev_b32 v224, 16, v124
    v_and_b32 v225, 0xffff0000, v124
    v_add_f32 v128, v128, v224
    v_add_f32 v129, v129, v225
    v_lshlrev_b32 v224, 16, v125
    v_and_b32 v225, 0xffff0000, v125
    v_add_f32 v130, v130, v224
    v_add_f32 v131, v131, v225
    v_lshlrev_b32 v224, 16, v126
    v_and_b32 v225, 0xffff0000, v126
    v_add_f32 v132, v132, v224
    v_add_f32 v133, v133, v225
    v_lshlrev_b32 v224, 16, v127
    v_and_b32 v225, 0xffff0000, v127
    v_add_f32 v134, v134, v224
    v_add_f32 v135, v135, v225
    s_nop 1
    v_add_f32_dpp v128, v128, v128 row_ror:8 row_mask:0xf bank_mask:0xf
    v_add_f32_dpp v129, v129, v129 row_ror:8 row_mask:0xf bank_mask:0xf
    v_add_f32_dpp v130, v130, v130 row_ror:8 row_mask:0xf bank_mask:0xf
    v_add_f32_dpp v131, v131, v131 row_ror:8 row_mask:0xf bank_mask:0xf
    v_add_f32_dpp v132, v132, v132 row_ror:8 row_mask:0xf bank_mask:0xf
    v_add_f32_dpp v133, v133, v133 row_ror:8 row_mask:0xf bank_mask:0xf
    v_add_f32_dpp v134, v134, v134 row_ror:8 row_mask:0xf bank_mask:0xf
    v_add_f32_dpp v135, v135, v135 row_ror:8 row_mask:0xf bank_mask:0xf
    v_mov_b32 v144, v128
    v_mov_b32 v145, v129
    v_mov_b32 v146, v130
    v_mov_b32 v147, v131
    v_mov_b32 v148, v132
    v_mov_b32 v149, v133
    v_mov_b32 v150, v134
    v_mov_b32 v151, v135
    s_nop 1
    v_permlane16_swap_b32 v128, v144
    v_permlane16_swap_b32 v129, v145
    v_permlane16_swap_b32 v130, v146
    v_permlane16_swap_b32 v131, v147
    v_permlane16_swap_b32 v132, v148
    v_permlane16_swap_b32 v133, v149
    v_permlane16_swap_b32 v134, v150
    v_permlane16_swap_b32 v135, v151
    v_add_f32 v128, v128, v144
    v_add_f32 v129, v129, v145
    v_add_f32 v130, v130, v146
    v_add_f32 v131, v131, v147
    v_add_f32 v132, v132, v148
    v_add_f32 v133, v133, v149
    v_add_f32 v134, v134, v150
    v_add_f32 v135, v135, v151
    v_mov_b32 v144, v128
    v_mov_b32 v145, v129
    v_mov_b32 v146, v130
    v_mov_b32 v147, v131
    v_mov_b32 v148, v132
    v_mov_b32 v149, v133
    v_mov_b32 v150, v134
    v_mov_b32 v151, v135
    s_nop 1
    v_permlane32_swap_b32 v128, v144
    v_permlane32_swap_b32 v129, v145
    v_permlane32_swap_b32 v130, v146
    v_permlane32_swap_b32 v131, v147
    v_permlane32_swap_b32 v132, v148
    v_permlane32_swap_b32 v133, v149
    v_permlane32_swap_b32 v134, v150
    v_permlane32_swap_b32 v135, v151
    v_add_f32 v128, v128, v144
    v_add_f32 v129, v129, v145
    v_add_f32 v130, v130, v146
    v_add_f32 v131, v131, v147
    v_add_f32 v132, v132, v148
    v_add_f32 v133, v133, v149
    v_add_f32 v134, v134, v150
    v_add_f32 v135, v135, v151
    s_lshr_b32 s55, s2, 1
    s_lshl_b32 s55, s55, 8
    s_and_b32 s56, s2, 1
    s_mul_i32 s56, s56, 28672
    s_add_u32 s55, s55, s56
    s_add_u32 s55, s55, 70778880
    s_cmp_lt_u32 s2, 224
    s_cselect_b32 s55, s55, 2130706432
    v_lshlrev_b32 v224, 1, v254
    s_mov_b64 exec, 0xff
    buffer_store_dwordx4 v[128:131], v224, s[4:7], s55 offen sc0 sc1
    buffer_store_dwordx4 v[132:135], v224, s[4:7], s55 offen offset:16 sc0 sc1
    s_waitcnt vmcnt(0)
    v_mov_b32 v224, 0
    v_mov_b32 v225, 1
    s_lshl_b32 s55, s2, 2
    s_add_u32 s55, s55, 71566336
    s_mov_b64 exec, 1
    buffer_store_dword v225, v224, s[4:7], s55 offen sc0 sc1
    s_mov_b64 exec, -1
    s_setprio 0
    s_branch ys_38
ys_37:
    s_setprio 1
    s_waitcnt vmcnt(8)
    s_barrier
    s_waitcnt lgkmcnt(0)
    s_barrier
    s_waitcnt vmcnt(0) lgkmcnt(0)
    s_barrier
    s_waitcnt lgkmcnt(0)
    s_barrier
    s_lshl_b32 s55, s51, 2
    s_add_u32 s55, s55, s54
    s_add_u32 s55, s55, 14336
    v_mov_b32 v252, 0
    v_mov_b32 v250, 0x01010101
    s_mov_b64 exec, 1
    buffer_store_dword v250, v252, s[4:7], s55 offen sc0 sc1
    s_mov_b64 exec, -1
    s_mov_b32 s60, 0
    s_waitcnt lgkmcnt(0)
    s_barrier
    s_waitcnt lgkmcnt(0)
    s_barrier
    s_waitcnt lgkmcnt(0)
    s_barrier
    s_waitcnt lgkmcnt(0)
    s_barrier
    v_lshrrev_b32 v252, 2, v254
    v_min_u32 v252, 60, v252
    s_add_u32 s55, s54, 14336
    s_add_u32 s55, s55, s60
    buffer_load_dword v251, v252, s[4:7], s55 offen sc0 sc1
    s_waitcnt lgkmcnt(0)
    s_barrier
    s_waitcnt lgkmcnt(0)
    s_barrier
    s_waitcnt lgkmcnt(0)
    s_barrier
    s_waitcnt vmcnt(0)
    v_cmp_ne_u32 vcc, 0x01010101, v251
    s_cbranch_vccz ap_43
    v_lshrrev_b32 v252, 2, v254
    s_add_u32 s55, s54, 14336
    s_add_u32 s55, s55, s60
    s_mov_b32 s56, 262144
    s_mov_b32 s57, 0x01010101
    s_mov_b64 exec, 0xffff
poll_44:
    buffer_load_dword v253, v252, s[4:7], s55 offen sc0 sc1
    s_waitcnt vmcnt(0)
    v_cmp_ne_u32 vcc, s57, v253
    s_cbranch_vccz pd_45
    s_sleep 1
    s_sub_u32 s56, s56, 1
    s_cmp_lg_u32 s56, 0
    s_cbranch_scc1 poll_44
pd_45:
    s_mov_b64 exec, -1
ap_43:
    s_add_u32 s55, s53, 0
    buffer_load_dwordx4 v[0:3], v254, s[4:7], s55 offen offset:0
    buffer_load_dwordx4 v[4:7], v254, s[4:7], s55 offen offset:1024
    buffer_load_dwordx4 v[8:11], v254, s[4:7], s55 offen offset:2048
    buffer_load_dwordx4 v[12:15], v254, s[4:7], s55 offen offset:3072
    s_waitcnt lgkmcnt(0)
    s_barrier
    s_add_u32 s55, s53, 4096
    buffer_load_dwordx4 v[16:19], v254, s[4:7], s55 offen offset:0
    buffer_load_dwordx4 v[20:23], v254, s[4:7], s55 offen offset:1024
    buffer_load_dwordx4 v[24:27], v254, s[4:7], s55 offen offset:2048
    buffer_load_dwordx4 v[28:31], v254, s[4:7], s55 offen offset:3072
    s_waitcnt lgkmcnt(0)
    s_barrier
    s_add_u32 s55, s53, 8192
    buffer_load_dwordx4 v[32:35], v254, s[4:7], s55 offen offset:0
    buffer_load_dwordx4 v[36:39], v254, s[4:7], s55 offen offset:1024
    buffer_load_dwordx4 v[40:43], v254, s[4:7], s55 offen offset:2048
    buffer_load_dwordx4 v[44:47], v254, s[4:7], s55 offen offset:3072
    s_waitcnt lgkmcnt(0)
    s_barrier
    s_add_u32 s55, s53, 12288
    buffer_load_dwordx4 v[48:51], v254, s[4:7], s55 offen offset:0
    buffer_load_dwordx4 v[52:55], v254, s[4:7], s55 offen offset:1024
    buffer_load_dwordx4 v[56:59], v254, s[4:7], s55 offen offset:2048
    buffer_load_dwordx4 v[60:63], v254, s[4:7], s55 offen offset:3072
    s_waitcnt lgkmcnt(0)
    s_barrier
    s_add_u32 s55, s53, 16384
    buffer_load_dwordx4 v[64:67], v254, s[4:7], s55 offen offset:0
    buffer_load_dwordx4 v[68:71], v254, s[4:7], s55 offen offset:1024
    buffer_load_dwordx4 v[72:75], v254, s[4:7], s55 offen offset:2048
    buffer_load_dwordx4 v[76:79], v254, s[4:7], s55 offen offset:3072
    s_waitcnt vmcnt(19)
    v_mov_b32 v128, v0
    v_mov_b32 v129, v1
    v_mov_b32 v130, v2
    v_mov_b32 v131, v3
    s_waitcnt vmcnt(18)
    v_add_f32 v128, v128, v4
    v_add_f32 v129, v129, v5
    v_add_f32 v130, v130, v6
    v_add_f32 v131, v131, v7
    s_waitcnt vmcnt(17)
    v_add_f32 v128, v128, v8
    v_add_f32 v129, v129, v9
    v_add_f32 v130, v130, v10
    v_add_f32 v131, v131, v11
    s_waitcnt vmcnt(16)
    v_add_f32 v128, v128, v12
    v_add_f32 v129, v129, v13
    v_add_f32 v130, v130, v14
    v_add_f32 v131, v131, v15
    s_waitcnt lgkmcnt(0)
    s_barrier
    s_add_u32 s55, s53, 20480
    buffer_load_dwordx4 v[80:83], v254, s[4:7], s55 offen offset:0
    buffer_load_dwordx4 v[84:87], v254, s[4:7], s55 offen offset:1024
    buffer_load_dwordx4 v[88:91], v254, s[4:7], s55 offen offset:2048
    buffer_load_dwordx4 v[92:95], v254, s[4:7], s55 offen offset:3072
    s_waitcnt vmcnt(19)
    v_add_f32 v128, v128, v16
    v_add_f32 v129, v129, v17
    v_add_f32 v130, v130, v18
    v_add_f32 v131, v131, v19
    s_waitcnt vmcnt(18)
    v_add_f32 v128, v128, v20
    v_add_f32 v129, v129, v21
    v_add_f32 v130, v130, v22
    v_add_f32 v131, v131, v23
    s_waitcnt vmcnt(17)
    v_add_f32 v128, v128, v24
    v_add_f32 v129, v129, v25
    v_add_f32 v130, v130, v26
    v_add_f32 v131, v131, v27
    s_waitcnt vmcnt(16)
    v_add_f32 v128, v128, v28
    v_add_f32 v129, v129, v29
    v_add_f32 v130, v130, v30
    v_add_f32 v131, v131, v31
    s_waitcnt lgkmcnt(0)
    s_barrier
    s_add_u32 s55, s53, 24576
    buffer_load_dwordx4 v[96:99], v254, s[4:7], s55 offen offset:0
    buffer_load_dwordx4 v[100:103], v254, s[4:7], s55 offen offset:1024
    buffer_load_dwordx4 v[104:107], v254, s[4:7], s55 offen offset:2048
    buffer_load_dwordx4 v[108:111], v254, s[4:7], s55 offen offset:3072
    s_waitcnt vmcnt(19)
    v_add_f32 v128, v128, v32
    v_add_f32 v129, v129, v33
    v_add_f32 v130, v130, v34
    v_add_f32 v131, v131, v35
    s_waitcnt vmcnt(18)
    v_add_f32 v128, v128, v36
    v_add_f32 v129, v129, v37
    v_add_f32 v130, v130, v38
    v_add_f32 v131, v131, v39
    s_waitcnt vmcnt(17)
    v_add_f32 v128, v128, v40
    v_add_f32 v129, v129, v41
    v_add_f32 v130, v130, v42
    v_add_f32 v131, v131, v43
    s_waitcnt vmcnt(16)
    v_add_f32 v128, v128, v44
    v_add_f32 v129, v129, v45
    v_add_f32 v130, v130, v46
    v_add_f32 v131, v131, v47
    s_waitcnt lgkmcnt(0)
    s_barrier
    s_add_u32 s55, s53, 28672
    buffer_load_dwordx4 v[112:115], v254, s[4:7], s55 offen offset:0
    buffer_load_dwordx4 v[116:119], v254, s[4:7], s55 offen offset:1024
    buffer_load_dwordx4 v[120:123], v254, s[4:7], s55 offen offset:2048
    buffer_load_dwordx4 v[124:127], v254, s[4:7], s55 offen offset:3072
    s_waitcnt vmcnt(19)
    v_add_f32 v128, v128, v48
    v_add_f32 v129, v129, v49
    v_add_f32 v130, v130, v50
    v_add_f32 v131, v131, v51
    s_waitcnt vmcnt(18)
    v_add_f32 v128, v128, v52
    v_add_f32 v129, v129, v53
    v_add_f32 v130, v130, v54
    v_add_f32 v131, v131, v55
    s_waitcnt vmcnt(17)
    v_add_f32 v128, v128, v56
    v_add_f32 v129, v129, v57
    v_add_f32 v130, v130, v58
    v_add_f32 v131, v131, v59
    s_waitcnt vmcnt(16)
    v_add_f32 v128, v128, v60
    v_add_f32 v129, v129, v61
    v_add_f32 v130, v130, v62
    v_add_f32 v131, v131, v63
    s_waitcnt lgkmcnt(0)
    s_barrier
    s_cmp_eq_u32 s40, 0
    s_cselect_b32 s59, 0, 128
    s_sub_u32 s60, s60, s59
    v_lshrrev_b32 v252, 2, v254
    v_min_u32 v252, 60, v252
    s_add_u32 s55, s54, 14336
    s_add_u32 s55, s55, s60
    buffer_load_dword v251, v252, s[4:7], s55 offen sc0 sc1
    s_waitcnt vmcnt(16)
    v_add_f32 v128, v128, v64
    v_add_f32 v129, v129, v65
    v_add_f32 v130, v130, v66
    v_add_f32 v131, v131, v67
    s_waitcnt vmcnt(15)
    v_add_f32 v128, v128, v68
    v_add_f32 v129, v129, v69
    v_add_f32 v130, v130, v70
    v_add_f32 v131, v131, v71
    s_waitcnt vmcnt(14)
    v_add_f32 v128, v128, v72
    v_add_f32 v129, v129, v73
    v_add_f32 v130, v130, v74
    v_add_f32 v131, v131, v75
    s_waitcnt vmcnt(13)
    v_add_f32 v128, v128, v76
    v_add_f32 v129, v129, v77
    v_add_f32 v130, v130, v78
    v_add_f32 v131, v131, v79
    s_waitcnt lgkmcnt(0)
    s_barrier
    s_waitcnt vmcnt(12)
    v_add_f32 v128, v128, v80
    v_add_f32 v129, v129, v81
    v_add_f32 v130, v130, v82
    v_add_f32 v131, v131, v83
    s_waitcnt vmcnt(11)
    v_add_f32 v128, v128, v84
    v_add_f32 v129, v129, v85
    v_add_f32 v130, v130, v86
    v_add_f32 v131, v131, v87
    s_waitcnt vmcnt(10)
    v_add_f32 v128, v128, v88
    v_add_f32 v129, v129, v89
    v_add_f32 v130, v130, v90
    v_add_f32 v131, v131, v91
    s_waitcnt vmcnt(9)
    v_add_f32 v128, v128, v92
    v_add_f32 v129, v129, v93
    v_add_f32 v130, v130, v94
    v_add_f32 v131, v131, v95
    s_waitcnt lgkmcnt(0)
    s_barrier
    s_waitcnt vmcnt(8)
    v_add_f32 v128, v128, v96
    v_add_f32 v129, v129, v97
    v_add_f32 v130, v130, v98
    v_add_f32 v131, v131, v99
    s_waitcnt vmcnt(7)
    v_add_f32 v128, v128, v100
    v_add_f32 v129, v129, v101
    v_add_f32 v130, v130, v102
    v_add_f32 v131, v131, v103
    s_waitcnt vmcnt(6)
    v_add_f32 v128, v128, v104
    v_add_f32 v129, v129, v105
    v_add_f32 v130, v130, v106
    v_add_f32 v131, v131, v107
    s_waitcnt vmcnt(5)
    v_add_f32 v128, v128, v108
    v_add_f32 v129, v129, v109
    v_add_f32 v130, v130, v110
    v_add_f32 v131, v131, v111
    s_waitcnt lgkmcnt(0)
    s_barrier
    s_waitcnt vmcnt(4)
    v_add_f32 v128, v128, v112
    v_add_f32 v129, v129, v113
    v_add_f32 v130, v130, v114
    v_add_f32 v131, v131, v115
    s_waitcnt vmcnt(3)
    v_add_f32 v128, v128, v116
    v_add_f32 v129, v129, v117
    v_add_f32 v130, v130, v118
    v_add_f32 v131, v131, v119
    s_waitcnt vmcnt(2)
    v_add_f32 v128, v128, v120
    v_add_f32 v129, v129, v121
    v_add_f32 v130, v130, v122
    v_add_f32 v131, v131, v123
    s_waitcnt vmcnt(1)
    v_add_f32 v128, v128, v124
    v_add_f32 v129, v129, v125
    v_add_f32 v130, v130, v126
    v_add_f32 v131, v131, v127
    s_waitcnt lgkmcnt(0)
    s_barrier
    s_waitcnt vmcnt(0)
    v_cmp_ne_u32 vcc, 0x01010101, v251
    s_cbranch_vccz ap_46
    v_lshrrev_b32 v252, 2, v254
    s_add_u32 s55, s54, 14336
    s_add_u32 s55, s55, s60
    s_mov_b32 s56, 262144
    s_mov_b32 s57, 0x01010101
    s_mov_b64 exec, 0xffff
poll_47:
    buffer_load_dword v253, v252, s[4:7], s55 offen sc0 sc1
    s_waitcnt vmcnt(0)
    v_cmp_ne_u32 vcc, s57, v253
    s_cbranch_vccz pd_48
    s_sleep 1
    s_sub_u32 s56, s56, 1
    s_cmp_lg_u32 s56, 0
    s_cbranch_scc1 poll_47
pd_48:
    s_mov_b64 exec, -1
ap_46:
    s_sub_u32 s55, s53, 31872
    s_cmp_eq_u32 s40, 0
    s_cselect_b32 s55, 2130706432, s55
    v_lshrrev_b32 v224, 7, v254
    v_and_b32 v225, 0x70, v254
    v_lshl_add_u32 v224, v224, 10, v225
    buffer_load_dwordx4 v[0:3], v224, s[4:7], s55 offen
    s_add_u32 s55, s55, 8192
    buffer_load_dwordx4 v[4:7], v224, s[4:7], s55 offen
    s_add_u32 s55, s55, 8192
    buffer_load_dwordx4 v[8:11], v224, s[4:7], s55 offen
    s_add_u32 s55, s55, 8192
    buffer_load_dwordx4 v[12:15], v224, s[4:7], s55 offen
    s_add_u32 s55, s55, 8192
    s_waitcnt lgkmcnt(0)
    s_barrier
    v_mul_f32 v128, 0x3a800000, v128
    v_mul_f32 v129, 0x3a800000, v129
    v_fma_f32 v129, -v128, v128, v129
    v_max_f32 v129, 0, v129
    v_cvt_pk_bf16_f32 v128, v128, v128
    v_lshlrev_b32 v128, 16, v128
    v_cvt_pk_bf16_f32 v129, v129, v129
    v_lshlrev_b32 v129, 16, v129
    v_add_f32 v129, 0x3727c5ac, v129
    v_cvt_pk_bf16_f32 v129, v129, v129
    v_lshlrev_b32 v129, 16, v129
    v_sqrt_f32 v129, v129
    s_nop 0
    v_cvt_pk_bf16_f32 v129, v129, v129
    v_lshlrev_b32 v129, 16, v129
    v_rcp_f32 v129, v129
    s_nop 0
    v_mul_f32 v130, 0x3a800000, v130
    v_mul_f32 v131, 0x3a800000, v131
    v_fma_f32 v131, -v130, v130, v131
    v_max_f32 v131, 0, v131
    v_cvt_pk_bf16_f32 v130, v130, v130
    v_lshlrev_b32 v130, 16, v130
    v_cvt_pk_bf16_f32 v131, v131, v131
    v_lshlrev_b32 v131, 16, v131
    v_add_f32 v131, 0x3727c5ac, v131
    v_cvt_pk_bf16_f32 v131, v131, v131
    v_lshlrev_b32 v131, 16, v131
    v_sqrt_f32 v131, v131
    s_nop 0
    v_cvt_pk_bf16_f32 v131, v131, v131
    v_lshlrev_b32 v131, 16, v131
    v_rcp_f32 v131, v131
    s_nop 0
    v_add_u32 v224, 153728, v254
    ds_write_b128 v224, v[128:131]
    s_waitcnt lgkmcnt(0)
    s_barrier
    s_waitcnt lgkmcnt(0)
    s_barrier
    s_waitcnt lgkmcnt(0)
    s_barrier
    s_waitcnt lgkmcnt(0)
    s_barrier
    s_waitcnt vmcnt(0)
    v_add_f32 v0, v0, v4
    v_add_f32 v8, v8, v12
    v_add_f32 v1, v1, v5
    v_add_f32 v9, v9, v13
    v_add_f32 v2, v2, v6
    v_add_f32 v10, v10, v14
    v_add_f32 v3, v3, v7
    v_add_f32 v11, v11, v15
    v_add_f32 v0, v0, v8
    v_add_f32 v1, v1, v9
    v_add_f32 v2, v2, v10
    v_add_f32 v3, v3, v11
    s_nop 1
    v_add_f32_dpp v0, v0, v0 row_ror:8 row_mask:0xf bank_mask:0xf
    v_add_f32_dpp v1, v1, v1 row_ror:8 row_mask:0xf bank_mask:0xf
    v_add_f32_dpp v2, v2, v2 row_ror:8 row_mask:0xf bank_mask:0xf
    v_add_f32_dpp v3, v3, v3 row_ror:8 row_mask:0xf bank_mask:0xf
    v_mov_b32 v4, v0
    v_mov_b32 v5, v1
    v_mov_b32 v6, v2
    v_mov_b32 v7, v3
    s_nop 1
    v_permlane16_swap_b32 v0, v4
    v_permlane16_swap_b32 v1, v5
    v_permlane16_swap_b32 v2, v6
    v_permlane16_swap_b32 v3, v7
    v_add_f32 v0, v0, v4
    v_add_f32 v1, v1, v5
    v_add_f32 v2, v2, v6
    v_add_f32 v3, v3, v7
    v_mov_b32 v4, v0
    v_mov_b32 v5, v1
    v_mov_b32 v6, v2
    v_mov_b32 v7, v3
    s_nop 1
    v_permlane32_swap_b32 v0, v4
    v_permlane32_swap_b32 v1, v5
    v_permlane32_swap_b32 v2, v6
    v_permlane32_swap_b32 v3, v7
    v_add_f32 v0, v0, v4
    v_add_f32 v1, v1, v5
    v_add_f32 v2, v2, v6
    v_add_f32 v3, v3, v7
    s_waitcnt lgkmcnt(0)
    s_barrier
    v_mul_f32 v0, 0x3a800000, v0
    v_mul_f32 v1, 0x3a800000, v1
    v_fma_f32 v1, -v0, v0, v1
    v_max_f32 v1, 0, v1
    v_cvt_pk_bf16_f32 v0, v0, v0
    v_lshlrev_b32 v0, 16, v0
    v_cvt_pk_bf16_f32 v1, v1, v1
    v_lshlrev_b32 v1, 16, v1
    v_add_f32 v1, 0x3727c5ac, v1
    v_cvt_pk_bf16_f32 v1, v1, v1
    v_lshlrev_b32 v1, 16, v1
    v_sqrt_f32 v1, v1
    s_nop 0
    v_cvt_pk_bf16_f32 v1, v1, v1
    v_lshlrev_b32 v1, 16, v1
    v_rcp_f32 v1, v1
    s_nop 0
    v_mul_f32 v2, 0x3a800000, v2
    v_mul_f32 v3, 0x3a800000, v3
    v_fma_f32 v3, -v2, v2, v3
    v_max_f32 v3, 0, v3
    v_cvt_pk_bf16_f32 v2, v2, v2
    v_lshlrev_b32 v2, 16, v2
    v_cvt_pk_bf16_f32 v3, v3, v3
    v_lshlrev_b32 v3, 16, v3
    v_add_f32 v3, 0x3727c5ac, v3
    v_cvt_pk_bf16_f32 v3, v3, v3
    v_lshlrev_b32 v3, 16, v3
    v_sqrt_f32 v3, v3
    s_nop 0
    v_cvt_pk_bf16_f32 v3, v3, v3
    v_lshlrev_b32 v3, 16, v3
    v_rcp_f32 v3, v3
    s_nop 0
    v_add_u32 v224, 153600, v254
    s_mov_b64 exec, 0xff
    ds_write_b128 v224, v[0:3]
    s_mov_b64 exec, -1
    s_waitcnt lgkmcnt(0)
    s_barrier
    s_waitcnt lgkmcnt(0)
    s_barrier
    s_waitcnt lgkmcnt(0)
    s_barrier
    s_waitcnt lgkmcnt(0)
    s_barrier
    s_setprio 0
ys_38:
    v_mov_b32 v224, 157568
    ds_read_b32 v224, v224
    s_waitcnt lgkmcnt(0)
    v_readfirstlane_b32 s45, v224
YA_g2:
    s_lshl_b32 s61, s43, 13
    s_add_u32 s62, s47, s61
    s_lshl_b32 s94, s51, 14
    s_barrier
    s_cmp_lg_u32 s42, 0
    s_cbranch_scc1 wf_49
    s_lshl_b32 s55, s51, 2
    s_add_u32 s55, s55, s54
    s_add_u32 s55, s55, 0
    v_mov_b32 v252, 0
    v_mov_b32 v250, 0x01010101
    s_mov_b64 exec, 1
    buffer_store_dword v250, v252, s[4:7], s55 offen sc0 sc1
    s_mov_b64 exec, -1
wf_49:
    s_add_u32 m0, s61, 98304
    s_add_u32 s59, s62, s94
    buffer_load_dwordx4 v254, s[4:7], s59 offen lds
    buffer_load_dwordx4 v254, s[4:7], s59 offen offset:1024 lds
    buffer_load_dwordx4 v254, s[4:7], s59 offen offset:2048 lds
    buffer_load_dwordx4 v254, s[4:7], s59 offen offset:3072 lds
    s_add_u32 m0, s61, 102400
    s_add_u32 s60, s59, 4096
    buffer_load_dwordx4 v254, s[4:7], s60 offen lds
    buffer_load_dwordx4 v254, s[4:7], s60 offen offset:1024 lds
    s_add_u32 s94, s94, 16384
    s_and_b32 s94, s94, 0x3ffff
    buffer_load_dwordx4 v254, s[4:7], s60 offen offset:2048 lds
    buffer_load_dwordx4 v254, s[4:7], s60 offen offset:3072 lds
    s_waitcnt vmcnt(0)
    s_barrier
    v_lshrrev_b32 v252, 2, v254
    s_add_u32 s55, s54, 0
    s_mov_b32 s56, 262144
    s_mov_b32 s57, 0x01010101
    s_mov_b64 exec, 0xffff
poll_50:
    buffer_load_dword v253, v252, s[4:7], s55 offen sc0 sc1
    s_waitcnt vmcnt(0)
    v_cmp_ne_u32 vcc, s57, v253
    s_cbranch_vccz pd_51
    s_sleep 1
    s_sub_u32 s56, s56, 1
    s_cmp_lg_u32 s56, 0
    s_cbranch_scc1 poll_50
pd_51:
    s_mov_b64 exec, -1
    s_add_u32 m0, s61, 114688
    s_add_u32 s59, s62, s94
    buffer_load_dwordx4 v254, s[4:7], s59 offen lds
    buffer_load_dwordx4 v254, s[4:7], s59 offen offset:1024 lds
    buffer_load_dwordx4 v254, s[4:7], s59 offen offset:2048 lds
    buffer_load_dwordx4 v254, s[4:7], s59 offen offset:3072 lds
    s_add_u32 m0, s61, 118784
    s_add_u32 s60, s59, 4096
    buffer_load_dwordx4 v254, s[4:7], s60 offen lds
    buffer_load_dwordx4 v254, s[4:7], s60 offen offset:1024 lds
    s_add_u32 s94, s94, 16384
    s_and_b32 s94, s94, 0x3ffff
    buffer_load_dwordx4 v254, s[4:7], s60 offen offset:2048 lds
    buffer_load_dwordx4 v254, s[4:7], s60 offen offset:3072 lds
    s_add_u32 m0, s61, 131072
    s_add_u32 s59, s62, s94
    buffer_load_dwordx4 v254, s[4:7], s59 offen lds
    buffer_load_dwordx4 v254, s[4:7], s59 offen offset:1024 lds
    buffer_load_dwordx4 v254, s[4:7], s59 offen offset:2048 lds
    buffer_load_dwordx4 v254, s[4:7], s59 offen offset:3072 lds
    s_add_u32 m0, s61, 135168
    s_add_u32 s60, s59, 4096
    buffer_load_dwordx4 v254, s[4:7], s60 offen lds
    buffer_load_dwordx4 v254, s[4:7], s60 offen offset:1024 lds
    s_add_u32 s94, s94, 16384
    s_and_b32 s94, s94, 0x3ffff
    buffer_load_dwordx4 v254, s[4:7], s60 offen offset:2048 lds
    buffer_load_dwordx4 v254, s[4:7], s60 offen offset:3072 lds
    s_waitcnt vmcnt(8)
    s_barrier
    s_add_u32 m0, s61, 98304
    s_add_u32 s59, s62, s94
    buffer_load_dwordx4 v254, s[4:7], s59 offen lds
    buffer_load_dwordx4 v254, s[4:7], s59 offen offset:1024 lds
    buffer_load_dwordx4 v254, s[4:7], s59 offen offset:2048 lds
    buffer_load_dwordx4 v254, s[4:7], s59 offen offset:3072 lds
    s_add_u32 m0, s61, 102400
    s_add_u32 s60, s59, 4096
    buffer_load_dwordx4 v254, s[4:7], s60 offen lds
    buffer_load_dwordx4 v254, s[4:7], s60 offen offset:1024 lds
    s_add_u32 s94, s94, 16384
    s_and_b32 s94, s94, 0x3ffff
    buffer_load_dwordx4 v254, s[4:7], s60 offen offset:2048 lds
    buffer_load_dwordx4 v254, s[4:7], s60 offen offset:3072 lds
    s_waitcnt vmcnt(8)
    s_barrier
    s_add_u32 m0, s61, 114688
    s_add_u32 s59, s62, s94
    buffer_load_dwordx4 v254, s[4:7], s59 offen lds
    buffer_load_dwordx4 v254, s[4:7], s59 offen offset:1024 lds
    buffer_load_dwordx4 v254, s[4:7], s59 offen offset:2048 lds
    buffer_load_dwordx4 v254, s[4:7], s59 offen offset:3072 lds
    s_add_u32 m0, s61, 118784
    s_add_u32 s60, s59, 4096
    buffer_load_dwordx4 v254, s[4:7], s60 offen lds
    buffer_load_dwordx4 v254, s[4:7], s60 offen offset:1024 lds
    s_add_u32 s94, s94, 16384
    s_and_b32 s94, s94, 0x3ffff
    buffer_load_dwordx4 v254, s[4:7], s60 offen offset:2048 lds
    buffer_load_dwordx4 v254, s[4:7], s60 offen offset:3072 lds
    s_waitcnt vmcnt(8)
    s_barrier
    s_add_u32 m0, s61, 131072
    s_add_u32 s59, s62, s94
    buffer_load_dwordx4 v254, s[4:7], s59 offen lds
    buffer_load_dwordx4 v254, s[4:7], s59 offen offset:1024 lds
    buffer_load_dwordx4 v254, s[4:7], s59 offen offset:2048 lds
    buffer_load_dwordx4 v254, s[4:7], s59 offen offset:3072 lds
    s_add_u32 m0, s61, 135168
    s_add_u32 s60, s59, 4096
    buffer_load_dwordx4 v254, s[4:7], s60 offen lds
    buffer_load_dwordx4 v254, s[4:7], s60 offen offset:1024 lds
    s_add_u32 s94, s94, 16384
    s_and_b32 s94, s94, 0x3ffff
    buffer_load_dwordx4 v254, s[4:7], s60 offen offset:2048 lds
    buffer_load_dwordx4 v254, s[4:7], s60 offen offset:3072 lds
    s_waitcnt vmcnt(8)
    s_barrier
    s_add_u32 m0, s61, 98304
    s_add_u32 s59, s62, s94
    buffer_load_dwordx4 v254, s[4:7], s59 offen lds
    buffer_load_dwordx4 v254, s[4:7], s59 offen offset:1024 lds
    buffer_load_dwordx4 v254, s[4:7], s59 offen offset:2048 lds
    buffer_load_dwordx4 v254, s[4:7], s59 offen offset:3072 lds
    s_add_u32 m0, s61, 102400
    s_add_u32 s60, s59, 4096
    buffer_load_dwordx4 v254, s[4:7], s60 offen lds
    buffer_load_dwordx4 v254, s[4:7], s60 offen offset:1024 lds
    s_add_u32 s94, s94, 16384
    s_and_b32 s94, s94, 0x3ffff
    buffer_load_dwordx4 v254, s[4:7], s60 offen offset:2048 lds
    buffer_load_dwordx4 v254, s[4:7], s60 offen offset:3072 lds
    s_waitcnt vmcnt(8)
    s_barrier
    s_add_u32 m0, s61, 114688
    s_add_u32 s59, s62, s94
    buffer_load_dwordx4 v254, s[4:7], s59 offen lds
    buffer_load_dwordx4 v254, s[4:7], s59 offen offset:1024 lds
    buffer_load_dwordx4 v254, s[4:7], s59 offen offset:2048 lds
    buffer_load_dwordx4 v254, s[4:7], s59 offen offset:3072 lds
    s_add_u32 m0, s61, 118784
    s_add_u32 s60, s59, 4096
    buffer_load_dwordx4 v254, s[4:7], s60 offen lds
    buffer_load_dwordx4 v254, s[4:7], s60 offen offset:1024 lds
    s_add_u32 s94, s94, 16384
    s_and_b32 s94, s94, 0x3ffff
    buffer_load_dwordx4 v254, s[4:7], s60 offen offset:2048 lds
    buffer_load_dwordx4 v254, s[4:7], s60 offen offset:3072 lds
    s_waitcnt vmcnt(8)
    s_barrier
    s_add_u32 m0, s61, 131072
    s_add_u32 s59, s62, s94
    buffer_load_dwordx4 v254, s[4:7], s59 offen lds
    buffer_load_dwordx4 v254, s[4:7], s59 offen offset:1024 lds
    buffer_load_dwordx4 v254, s[4:7], s59 offen offset:2048 lds
    buffer_load_dwordx4 v254, s[4:7], s59 offen offset:3072 lds
    s_add_u32 m0, s61, 135168
    s_add_u32 s60, s59, 4096
    buffer_load_dwordx4 v254, s[4:7], s60 offen lds
    buffer_load_dwordx4 v254, s[4:7], s60 offen offset:1024 lds
    s_add_u32 s94, s94, 16384
    s_and_b32 s94, s94, 0x3ffff
    buffer_load_dwordx4 v254, s[4:7], s60 offen offset:2048 lds
    buffer_load_dwordx4 v254, s[4:7], s60 offen offset:3072 lds
    s_waitcnt vmcnt(8)
    s_barrier
    s_add_u32 m0, s61, 98304
    s_add_u32 s59, s62, s94
    buffer_load_dwordx4 v254, s[4:7], s59 offen lds
    buffer_load_dwordx4 v254, s[4:7], s59 offen offset:1024 lds
    buffer_load_dwordx4 v254, s[4:7], s59 offen offset:2048 lds
    buffer_load_dwordx4 v254, s[4:7], s59 offen offset:3072 lds
    s_add_u32 m0, s61, 102400
    s_add_u32 s60, s59, 4096
    buffer_load_dwordx4 v254, s[4:7], s60 offen lds
    buffer_load_dwordx4 v254, s[4:7], s60 offen offset:1024 lds
    s_add_u32 s94, s94, 16384
    s_and_b32 s94, s94, 0x3ffff
    buffer_load_dwordx4 v254, s[4:7], s60 offen offset:2048 lds
    buffer_load_dwordx4 v254, s[4:7], s60 offen offset:3072 lds
    s_waitcnt vmcnt(8)
    s_barrier
    s_add_u32 m0, s61, 114688
    s_add_u32 s59, s62, s94
    buffer_load_dwordx4 v254, s[4:7], s59 offen lds
    buffer_load_dwordx4 v254, s[4:7], s59 offen offset:1024 lds
    buffer_load_dwordx4 v254, s[4:7], s59 offen offset:2048 lds
    buffer_load_dwordx4 v254, s[4:7], s59 offen offset:3072 lds
    s_add_u32 m0, s61, 118784
    s_add_u32 s60, s59, 4096
    buffer_load_dwordx4 v254, s[4:7], s60 offen lds
    buffer_load_dwordx4 v254, s[4:7], s60 offen offset:1024 lds
    s_add_u32 s94, s94, 16384
    s_and_b32 s94, s94, 0x3ffff
    buffer_load_dwordx4 v254, s[4:7], s60 offen offset:2048 lds
    buffer_load_dwordx4 v254, s[4:7], s60 offen offset:3072 lds
    s_waitcnt vmcnt(8)
    s_barrier
    s_add_u32 m0, s61, 131072
    s_add_u32 s59, s62, s94
    buffer_load_dwordx4 v254, s[4:7], s59 offen lds
    buffer_load_dwordx4 v254, s[4:7], s59 offen offset:1024 lds
    buffer_load_dwordx4 v254, s[4:7], s59 offen offset:2048 lds
    buffer_load_dwordx4 v254, s[4:7], s59 offen offset:3072 lds
    s_add_u32 m0, s61, 135168
    s_add_u32 s60, s59, 4096
    buffer_load_dwordx4 v254, s[4:7], s60 offen lds
    buffer_load_dwordx4 v254, s[4:7], s60 offen offset:1024 lds
    s_add_u32 s94, s94, 16384
    s_and_b32 s94, s94, 0x3ffff
    buffer_load_dwordx4 v254, s[4:7], s60 offen offset:2048 lds
    buffer_load_dwordx4 v254, s[4:7], s60 offen offset:3072 lds
    s_waitcnt vmcnt(8)
    s_barrier
    s_add_u32 m0, s61, 98304
    s_add_u32 s59, s62, s94
    buffer_load_dwordx4 v254, s[4:7], s59 offen lds
    buffer_load_dwordx4 v254, s[4:7], s59 offen offset:1024 lds
    buffer_load_dwordx4 v254, s[4:7], s59 offen offset:2048 lds
    buffer_load_dwordx4 v254, s[4:7], s59 offen offset:3072 lds
    s_add_u32 m0, s61, 102400
    s_add_u32 s60, s59, 4096
    buffer_load_dwordx4 v254, s[4:7], s60 offen lds
    buffer_load_dwordx4 v254, s[4:7], s60 offen offset:1024 lds
    s_add_u32 s94, s94, 16384
    s_and_b32 s94, s94, 0x3ffff
    buffer_load_dwordx4 v254, s[4:7], s60 offen offset:2048 lds
    buffer_load_dwordx4 v254, s[4:7], s60 offen offset:3072 lds
    s_waitcnt vmcnt(8)
    s_barrier
    s_add_u32 m0, s61, 114688
    s_add_u32 s59, s62, s94
    buffer_load_dwordx4 v254, s[4:7], s59 offen lds
    buffer_load_dwordx4 v254, s[4:7], s59 offen offset:1024 lds
    buffer_load_dwordx4 v254, s[4:7], s59 offen offset:2048 lds
    buffer_load_dwordx4 v254, s[4:7], s59 offen offset:3072 lds
    s_add_u32 m0, s61, 118784
    s_add_u32 s60, s59, 4096
    buffer_load_dwordx4 v254, s[4:7], s60 offen lds
    buffer_load_dwordx4 v254, s[4:7], s60 offen offset:1024 lds
    s_add_u32 s94, s94, 16384
    s_and_b32 s94, s94, 0x3ffff
    buffer_load_dwordx4 v254, s[4:7], s60 offen offset:2048 lds
    buffer_load_dwordx4 v254, s[4:7], s60 offen offset:3072 lds
    s_waitcnt vmcnt(8)
    s_barrier
    s_add_u32 m0, s61, 131072
    s_add_u32 s59, s62, s94
    buffer_load_dwordx4 v254, s[4:7], s59 offen lds
    buffer_load_dwordx4 v254, s[4:7], s59 offen offset:1024 lds
    buffer_load_dwordx4 v254, s[4:7], s59 offen offset:2048 lds
    buffer_load_dwordx4 v254, s[4:7], s59 offen offset:3072 lds
    s_add_u32 m0, s61, 135168
    s_add_u32 s60, s59, 4096
    buffer_load_dwordx4 v254, s[4:7], s60 offen lds
    buffer_load_dwordx4 v254, s[4:7], s60 offen offset:1024 lds
    s_add_u32 s94, s94, 16384
    s_and_b32 s94, s94, 0x3ffff
    buffer_load_dwordx4 v254, s[4:7], s60 offen offset:2048 lds
    buffer_load_dwordx4 v254, s[4:7], s60 offen offset:3072 lds
    s_waitcnt vmcnt(8)
    s_barrier
    s_add_u32 m0, s61, 98304
    s_add_u32 s59, s62, s94
    buffer_load_dwordx4 v254, s[4:7], s59 offen lds
    buffer_load_dwordx4 v254, s[4:7], s59 offen offset:1024 lds
    buffer_load_dwordx4 v254, s[4:7], s59 offen offset:2048 lds
    buffer_load_dwordx4 v254, s[4:7], s59 offen offset:3072 lds
    s_add_u32 m0, s61, 102400
    s_add_u32 s60, s59, 4096
    buffer_load_dwordx4 v254, s[4:7], s60 offen lds
    buffer_load_dwordx4 v254, s[4:7], s60 offen offset:1024 lds
    s_add_u32 s94, s94, 16384
    s_and_b32 s94, s94, 0x3ffff
    buffer_load_dwordx4 v254, s[4:7], s60 offen offset:2048 lds
    buffer_load_dwordx4 v254, s[4:7], s60 offen offset:3072 lds
    s_waitcnt vmcnt(8)
    s_barrier
    s_waitcnt vmcnt(0)
    s_barrier
    s_barrier
    s_setprio 1
    s_add_u32 s62, s49, s61
    s_lshl_b32 s94, s51, 14
    s_barrier
    s_cmp_lg_u32 s42, 0
    s_cbranch_scc1 wf_52
    s_lshl_b32 s55, s51, 2
    s_add_u32 s55, s55, s54
    s_add_u32 s55, s55, 2048
    v_mov_b32 v252, 0
    v_mov_b32 v250, 0x01010101
    s_mov_b64 exec, 1
    buffer_store_dword v250, v252, s[4:7], s55 offen sc0 sc1
    s_mov_b64 exec, -1
wf_52:
    s_add_u32 m0, s61, 98304
    s_add_u32 s59, s62, s94
    buffer_load_dwordx4 v254, s[4:7], s59 offen lds
    buffer_load_dwordx4 v254, s[4:7], s59 offen offset:1024 lds
    buffer_load_dwordx4 v254, s[4:7], s59 offen offset:2048 lds
    buffer_load_dwordx4 v254, s[4:7], s59 offen offset:3072 lds
    s_add_u32 m0, s61, 102400
    s_add_u32 s60, s59, 4096
    buffer_load_dwordx4 v254, s[4:7], s60 offen lds
    buffer_load_dwordx4 v254, s[4:7], s60 offen offset:1024 lds
    s_add_u32 s94, s94, 16384
    s_and_b32 s94, s94, 0x3ffff
    buffer_load_dwordx4 v254, s[4:7], s60 offen offset:2048 lds
    buffer_load_dwordx4 v254, s[4:7], s60 offen offset:3072 lds
    s_waitcnt vmcnt(0)
    s_barrier
    s_waitcnt lgkmcnt(0)
    s_barrier
    v_lshrrev_b32 v252, 2, v254
    s_add_u32 s55, s54, 2048
    s_mov_b32 s56, 262144
    s_mov_b32 s57, 0x01010101
    s_mov_b64 exec, 0xffff
poll_53:
    buffer_load_dword v253, v252, s[4:7], s55 offen sc0 sc1
    s_waitcnt vmcnt(0)
    v_cmp_ne_u32 vcc, s57, v253
    s_cbranch_vccz pd_54
    s_sleep 1
    s_sub_u32 s56, s56, 1
    s_cmp_lg_u32 s56, 0
    s_cbranch_scc1 poll_53
pd_54:
    s_mov_b64 exec, -1
    s_add_u32 m0, s61, 114688
    s_add_u32 s59, s62, s94
    buffer_load_dwordx4 v254, s[4:7], s59 offen lds
    buffer_load_dwordx4 v254, s[4:7], s59 offen offset:1024 lds
    buffer_load_dwordx4 v254, s[4:7], s59 offen offset:2048 lds
    buffer_load_dwordx4 v254, s[4:7], s59 offen offset:3072 lds
    s_add_u32 m0, s61, 118784
    s_add_u32 s60, s59, 4096
    buffer_load_dwordx4 v254, s[4:7], s60 offen lds
    buffer_load_dwordx4 v254, s[4:7], s60 offen offset:1024 lds
    s_add_u32 s94, s94, 16384
    s_and_b32 s94, s94, 0x3ffff
    buffer_load_dwordx4 v254, s[4:7], s60 offen offset:2048 lds
    buffer_load_dwordx4 v254, s[4:7], s60 offen offset:3072 lds
    s_add_u32 m0, s61, 131072
    s_add_u32 s59, s62, s94
    buffer_load_dwordx4 v254, s[4:7], s59 offen lds
    buffer_load_dwordx4 v254, s[4:7], s59 offen offset:1024 lds
    buffer_load_dwordx4 v254, s[4:7], s59 offen offset:2048 lds
    buffer_load_dwordx4 v254, s[4:7], s59 offen offset:3072 lds
    s_add_u32 m0, s61, 135168
    s_add_u32 s60, s59, 4096
    buffer_load_dwordx4 v254, s[4:7], s60 offen lds
    buffer_load_dwordx4 v254, s[4:7], s60 offen offset:1024 lds
    s_add_u32 s94, s94, 16384
    s_and_b32 s94, s94, 0x3ffff
    buffer_load_dwordx4 v254, s[4:7], s60 offen offset:2048 lds
    buffer_load_dwordx4 v254, s[4:7], s60 offen offset:3072 lds
    s_waitcnt vmcnt(8) lgkmcnt(0)
    s_barrier
    s_add_u32 m0, s61, 98304
    s_add_u32 s59, s62, s94
    buffer_load_dwordx4 v254, s[4:7], s59 offen lds
    buffer_load_dwordx4 v254, s[4:7], s59 offen offset:1024 lds
    buffer_load_dwordx4 v254, s[4:7], s59 offen offset:2048 lds
    buffer_load_dwordx4 v254, s[4:7], s59 offen offset:3072 lds
    s_waitcnt lgkmcnt(0)
    s_barrier
    s_cmp_lg_u32 s42, 0
    s_cbranch_scc1 wf_55
    s_lshl_b32 s55, s51, 2
    s_add_u32 s55, s55, s54
    s_add_u32 s55, s55, 12288
    v_mov_b32 v252, 0
    v_mov_b32 v250, 0x01010101
    s_mov_b64 exec, 1
    buffer_store_dword v250, v252, s[4:7], s55 offen sc0 sc1
    s_mov_b64 exec, -1
wf_55:
    s_add_u32 m0, s61, 102400
    s_add_u32 s60, s59, 4096
    buffer_load_dwordx4 v254, s[4:7], s60 offen lds
    buffer_load_dwordx4 v254, s[4:7], s60 offen offset:1024 lds
    s_add_u32 s94, s94, 16384
    s_and_b32 s94, s94, 0x3ffff
    buffer_load_dwordx4 v254, s[4:7], s60 offen offset:2048 lds
    buffer_load_dwordx4 v254, s[4:7], s60 offen offset:3072 lds
    s_waitcnt vmcnt(8) lgkmcnt(0)
    s_barrier
    s_cmp_lg_u32 s46, 0
    s_cbranch_scc1 cs_56
    s_mov_b32 s55, 71566336
    s_mov_b32 s56, 262144
p4_57:
    buffer_load_dwordx4 v[96:99], v254, s[4:7], s55 offen sc0 sc1
    s_waitcnt vmcnt(0)
    v_and_b32 v96, v96, v97
    v_and_b32 v98, v98, v99
    v_and_b32 v96, v96, v98
    v_cmp_ne_u32 vcc, 1, v96
    s_cbranch_vccz p4_58
    s_sleep 1
    s_sub_u32 s56, s56, 1
    s_cmp_lg_u32 s56, 0
    s_cbranch_scc1 p4_57
p4_58:
cs_56:
    s_and_b32 s55, s41, 1
    s_mul_i32 s56, s55, 384
    s_xor_b32 s55, s55, 1
    s_lshl_b32 s55, s55, 9
    s_cmp_eq_u32 s43, 0
    s_cselect_b32 s55, s56, s55
    s_mul_i32 s56, s41, 896
    s_add_u32 s55, s55, s56
    s_add_u32 s55, s55, 70778880
    s_cmp_eq_u32 s46, 0
    s_cselect_b32 s55, s55, 2130706432
    v_lshrrev_b32 v224, 9, v254
    v_mul_u32_u24 v224, 14336, v224
    v_and_b32 v225, 0x1f0, v254
    v_add_u32 v224, v224, v225
    buffer_load_dwordx4 v[96:99], v224, s[4:7], s55 offen sc1
    s_add_u32 s55, s55, 28672
    buffer_load_dwordx4 v[100:103], v224, s[4:7], s55 offen sc1
    s_add_u32 m0, s61, 114688
    s_add_u32 s59, s62, s94
    buffer_load_dwordx4 v254, s[4:7], s59 offen lds
    buffer_load_dwordx4 v254, s[4:7], s59 offen offset:1024 lds
    buffer_load_dwordx4 v254, s[4:7], s59 offen offset:2048 lds
    buffer_load_dwordx4 v254, s[4:7], s59 offen offset:3072 lds
    s_waitcnt lgkmcnt(0)
    s_barrier
    s_add_u32 m0, s61, 118784
    s_add_u32 s60, s59, 4096
    buffer_load_dwordx4 v254, s[4:7], s60 offen lds
    buffer_load_dwordx4 v254, s[4:7], s60 offen offset:1024 lds
    s_add_u32 s94, s94, 16384
    s_and_b32 s94, s94, 0x3ffff
    buffer_load_dwordx4 v254, s[4:7], s60 offen offset:2048 lds
    buffer_load_dwordx4 v254, s[4:7], s60 offen offset:3072 lds
    s_waitcnt vmcnt(10) lgkmcnt(0)
    s_barrier
    s_add_u32 m0, s61, 131072
    s_add_u32 s59, s62, s94
    buffer_load_dwordx4 v254, s[4:7], s59 offen lds
    buffer_load_dwordx4 v254, s[4:7], s59 offen offset:1024 lds
    buffer_load_dwordx4 v254, s[4:7], s59 offen offset:2048 lds
    buffer_load_dwordx4 v254, s[4:7], s59 offen offset:3072 lds
    s_waitcnt lgkmcnt(0)
    s_barrier
    v_lshrrev_b32 v252, 2, v254
    v_min_u32 v252, 60, v252
    s_add_u32 s55, s54, 12288
    buffer_load_dword v251, v252, s[4:7], s55 offen sc0 sc1
    s_waitcnt vmcnt(13)
    s_cmp_lg_u32 s46, 0
    s_cbranch_scc1 cs_59
    v_add_f32 v96, v96, v100
    v_add_f32 v97, v97, v101
    v_add_f32 v98, v98, v102
    v_add_f32 v99, v99, v103
    s_lshl_b32 s55, s43, 10
    s_add_u32 s55, s55, 155520
    v_add_u32 v224, s55, v254
    ds_write_b128 v224, v[96:99]
cs_59:
    s_add_u32 m0, s61, 135168
    s_add_u32 s60, s59, 4096
    buffer_load_dwordx4 v254, s[4:7], s60 offen lds
    buffer_load_dwordx4 v254, s[4:7], s60 offen offset:1024 lds
    s_add_u32 s94, s94, 16384
    s_and_b32 s94, s94, 0x3ffff
    buffer_load_dwordx4 v254, s[4:7], s60 offen offset:2048 lds
    buffer_load_dwordx4 v254, s[4:7], s60 offen offset:3072 lds
    s_waitcnt vmcnt(9) lgkmcnt(0)
    s_barrier
    s_add_u32 m0, s61, 98304
    s_add_u32 s59, s62, s94
    buffer_load_dwordx4 v254, s[4:7], s59 offen lds
    buffer_load_dwordx4 v254, s[4:7], s59 offen offset:1024 lds
    buffer_load_dwordx4 v254, s[4:7], s59 offen offset:2048 lds
    buffer_load_dwordx4 v254, s[4:7], s59 offen offset:3072 lds
    s_waitcnt lgkmcnt(0)
    s_barrier
    s_waitcnt vmcnt(8)
    v_cmp_ne_u32 vcc, 0x01010101, v251
    s_cbranch_vccz ap_60
    v_lshrrev_b32 v252, 2, v254
    s_add_u32 s55, s54, 12288
    s_mov_b32 s56, 262144
    s_mov_b32 s57, 0x01010101
    s_mov_b64 exec, 0xffff
poll_61:
    buffer_load_dword v253, v252, s[4:7], s55 offen sc0 sc1
    s_waitcnt vmcnt(0)
    v_cmp_ne_u32 vcc, s57, v253
    s_cbranch_vccz pd_62
    s_sleep 1
    s_sub_u32 s56, s56, 1
    s_cmp_lg_u32 s56, 0
    s_cbranch_scc1 poll_61
pd_62:
    s_mov_b64 exec, -1
ap_60:
    v_and_b32 v226, 0x1f0, v254
    v_and_b32 v227, 0x200, v254
    v_lshl_add_u32 v227, v227, 1, v226
    s_lshl_b32 s68, s43, 9
    s_add_u32 s68, s68, s52
    s_add_u32 m0, s61, 102400
    s_add_u32 s60, s59, 4096
    buffer_load_dwordx4 v254, s[4:7], s60 offen lds
    s_add_u32 s55, s68, 0
    buffer_load_dwordx4 v[96:99], v227, s[4:7], s55 offen offset:0
    buffer_load_dwordx4 v254, s[4:7], s60 offen offset:1024 lds
    s_add_u32 s94, s94, 16384
    s_and_b32 s94, s94, 0x3ffff
    buffer_load_dwordx4 v[100:103], v227, s[4:7], s55 offen offset:2048
    buffer_load_dwordx4 v254, s[4:7], s60 offen offset:2048 lds
    s_add_u32 s55, s68, 4096
    buffer_load_dwordx4 v[104:107], v227, s[4:7], s55 offen offset:0
    buffer_load_dwordx4 v254, s[4:7], s60 offen offset:3072 lds
    buffer_load_dwordx4 v[108:111], v227, s[4:7], s55 offen offset:2048
    s_waitcnt vmcnt(12) lgkmcnt(0)
    s_barrier
    s_add_u32 m0, s61, 114688
    s_add_u32 s59, s62, s94
    buffer_load_dwordx4 v254, s[4:7], s59 offen lds
    s_add_u32 s55, s68, 8192
    buffer_load_dwordx4 v[112:115], v227, s[4:7], s55 offen offset:0
    buffer_load_dwordx4 v254, s[4:7], s59 offen offset:1024 lds
    buffer_load_dwordx4 v[116:119], v227, s[4:7], s55 offen offset:2048
    buffer_load_dwordx4 v254, s[4:7], s59 offen offset:2048 lds
    s_add_u32 s55, s68, 12288
    buffer_load_dwordx4 v[120:123], v227, s[4:7], s55 offen offset:0
    buffer_load_dwordx4 v254, s[4:7], s59 offen offset:3072 lds
    buffer_load_dwordx4 v[124:127], v227, s[4:7], s55 offen offset:2048
    s_waitcnt lgkmcnt(0)
    s_barrier
    s_add_u32 m0, s61, 118784
    s_add_u32 s60, s59, 4096
    buffer_load_dwordx4 v254, s[4:7], s60 offen lds
    s_add_u32 s55, s68, 16384
    buffer_load_dwordx4 v[128:131], v227, s[4:7], s55 offen offset:0
    buffer_load_dwordx4 v254, s[4:7], s60 offen offset:1024 lds
    s_add_u32 s94, s94, 16384
    s_and_b32 s94, s94, 0x3ffff
    buffer_load_dwordx4 v[132:135], v227, s[4:7], s55 offen offset:2048
    buffer_load_dwordx4 v254, s[4:7], s60 offen offset:2048 lds
    s_add_u32 s55, s68, 20480
    buffer_load_dwordx4 v[136:139], v227, s[4:7], s55 offen offset:0
    buffer_load_dwordx4 v254, s[4:7], s60 offen offset:3072 lds
    buffer_load_dwordx4 v[140:143], v227, s[4:7], s55 offen offset:2048
    s_waitcnt vmcnt(17) lgkmcnt(0)
    s_barrier
    s_add_u32 m0, s61, 131072
    s_add_u32 s59, s62, s94
    buffer_load_dwordx4 v254, s[4:7], s59 offen lds
    s_add_u32 s55, s68, 24576
    buffer_load_dwordx4 v[144:147], v227, s[4:7], s55 offen offset:0
    buffer_load_dwordx4 v254, s[4:7], s59 offen offset:1024 lds
    buffer_load_dwordx4 v[148:151], v227, s[4:7], s55 offen offset:2048
    buffer_load_dwordx4 v254, s[4:7], s59 offen offset:2048 lds
    s_add_u32 s55, s68, 28672
    buffer_load_dwordx4 v[152:155], v227, s[4:7], s55 offen offset:0
    buffer_load_dwordx4 v254, s[4:7], s59 offen offset:3072 lds
    buffer_load_dwordx4 v[156:159], v227, s[4:7], s55 offen offset:2048
    s_waitcnt lgkmcnt(0)
    s_barrier
    s_waitcnt vmcnt(24)
    s_add_u32 m0, s61, 135168
    s_add_u32 s60, s59, 4096
    buffer_load_dwordx4 v254, s[4:7], s60 offen lds
    v_mov_b32 v192, v96
    v_mov_b32 v193, v97
    v_mov_b32 v194, v98
    v_mov_b32 v195, v99
    buffer_load_dwordx4 v254, s[4:7], s60 offen offset:1024 lds
    s_add_u32 s94, s94, 16384
    s_and_b32 s94, s94, 0x3ffff
    v_add_f32 v192, v192, v100
    v_add_f32 v193, v193, v101
    v_add_f32 v194, v194, v102
    v_add_f32 v195, v195, v103
    buffer_load_dwordx4 v254, s[4:7], s60 offen offset:2048 lds
    v_add_f32 v192, v192, v104
    v_add_f32 v193, v193, v105
    v_add_f32 v194, v194, v106
    v_add_f32 v195, v195, v107
    buffer_load_dwordx4 v254, s[4:7], s60 offen offset:3072 lds
    v_add_f32 v192, v192, v108
    v_add_f32 v193, v193, v109
    v_add_f32 v194, v194, v110
    v_add_f32 v195, v195, v111
    s_waitcnt vmcnt(13) lgkmcnt(0)
    s_barrier
    s_add_u32 m0, s61, 98304
    s_add_u32 s59, s62, s94
    buffer_load_dwordx4 v254, s[4:7], s59 offen lds
    v_add_f32 v192, v192, v112
    v_add_f32 v193, v193, v113
    v_add_f32 v194, v194, v114
    v_add_f32 v195, v195, v115
    buffer_load_dwordx4 v254, s[4:7], s59 offen offset:1024 lds
    v_add_f32 v192, v192, v116
    v_add_f32 v193, v193, v117
    v_add_f32 v194, v194, v118
    v_add_f32 v195, v195, v119
    buffer_load_dwordx4 v254, s[4:7], s59 offen offset:2048 lds
    v_add_f32 v192, v192, v120
    v_add_f32 v193, v193, v121
    v_add_f32 v194, v194, v122
    v_add_f32 v195, v195, v123
    buffer_load_dwordx4 v254, s[4:7], s59 offen offset:3072 lds
    v_add_f32 v192, v192, v124
    v_add_f32 v193, v193, v125
    v_add_f32 v194, v194, v126
    v_add_f32 v195, v195, v127
    s_waitcnt lgkmcnt(0)
    s_barrier
    s_waitcnt vmcnt(16)
    s_add_u32 m0, s61, 102400
    s_add_u32 s60, s59, 4096
    buffer_load_dwordx4 v254, s[4:7], s60 offen lds
    v_add_f32 v192, v192, v128
    v_add_f32 v193, v193, v129
    v_add_f32 v194, v194, v130
    v_add_f32 v195, v195, v131
    buffer_load_dwordx4 v254, s[4:7], s60 offen offset:1024 lds
    s_add_u32 s94, s94, 16384
    s_and_b32 s94, s94, 0x3ffff
    v_add_f32 v192, v192, v132
    v_add_f32 v193, v193, v133
    v_add_f32 v194, v194, v134
    v_add_f32 v195, v195, v135
    buffer_load_dwordx4 v254, s[4:7], s60 offen offset:2048 lds
    v_add_f32 v192, v192, v136
    v_add_f32 v193, v193, v137
    v_add_f32 v194, v194, v138
    v_add_f32 v195, v195, v139
    buffer_load_dwordx4 v254, s[4:7], s60 offen offset:3072 lds
    v_add_f32 v192, v192, v140
    v_add_f32 v193, v193, v141
    v_add_f32 v194, v194, v142
    v_add_f32 v195, v195, v143
    s_waitcnt vmcnt(8) lgkmcnt(0)
    s_barrier
    s_add_u32 m0, s61, 114688
    s_add_u32 s59, s62, s94
    buffer_load_dwordx4 v254, s[4:7], s59 offen lds
    v_add_f32 v192, v192, v144
    v_add_f32 v193, v193, v145
    v_add_f32 v194, v194, v146
    v_add_f32 v195, v195, v147
    buffer_load_dwordx4 v254, s[4:7], s59 offen offset:1024 lds
    v_add_f32 v192, v192, v148
    v_add_f32 v193, v193, v149
    v_add_f32 v194, v194, v150
    v_add_f32 v195, v195, v151
    buffer_load_dwordx4 v254, s[4:7], s59 offen offset:2048 lds
    v_add_f32 v192, v192, v152
    v_add_f32 v193, v193, v153
    v_add_f32 v194, v194, v154
    v_add_f32 v195, v195, v155
    buffer_load_dwordx4 v254, s[4:7], s59 offen offset:3072 lds
    v_add_f32 v192, v192, v156
    v_add_f32 v193, v193, v157
    v_add_f32 v194, v194, v158
    v_add_f32 v195, v195, v159
    s_waitcnt lgkmcnt(0)
    s_barrier
    s_add_u32 m0, s61, 118784
    s_add_u32 s60, s59, 4096
    buffer_load_dwordx4 v254, s[4:7], s60 offen lds
    v_mov_b32 v96, v192
    v_mov_b32 v97, v193
    v_mov_b32 v98, v194
    buffer_load_dwordx4 v254, s[4:7], s60 offen offset:1024 lds
    s_add_u32 s94, s94, 16384
    s_and_b32 s94, s94, 0x3ffff
    v_mov_b32 v99, v195
    s_nop 1
    v_permlane32_swap_b32 v192, v96
    buffer_load_dwordx4 v254, s[4:7], s60 offen offset:2048 lds
    v_permlane32_swap_b32 v193, v97
    v_permlane32_swap_b32 v194, v98
    v_permlane32_swap_b32 v195, v99
    buffer_load_dwordx4 v254, s[4:7], s60 offen offset:3072 lds
    v_add_f32 v192, v192, v96
    v_add_f32 v193, v193, v97
    v_add_f32 v194, v194, v98
    v_add_f32 v195, v195, v99
    s_waitcnt vmcnt(8) lgkmcnt(0)
    s_barrier
    s_add_u32 m0, s61, 131072
    s_add_u32 s59, s62, s94
    buffer_load_dwordx4 v254, s[4:7], s59 offen lds
    v_mul_f32 v192, 0x3a800000, v192
    v_mul_f32 v193, 0x3a800000, v193
    v_fma_f32 v193, -v192, v192, v193
    v_max_f32 v193, 0, v193
    buffer_load_dwordx4 v254, s[4:7], s59 offen offset:1024 lds
    v_cvt_pk_bf16_f32 v192, v192, v192
    v_lshlrev_b32 v192, 16, v192
    v_cvt_pk_bf16_f32 v193, v193, v193
    v_lshlrev_b32 v193, 16, v193
    buffer_load_dwordx4 v254, s[4:7], s59 offen offset:2048 lds
    v_add_f32 v193, 0x3727c5ac, v193
    v_cvt_pk_bf16_f32 v193, v193, v193
    v_lshlrev_b32 v193, 16, v193
    v_sqrt_f32 v193, v193
    buffer_load_dwordx4 v254, s[4:7], s59 offen offset:3072 lds
    s_nop 0
    v_cvt_pk_bf16_f32 v193, v193, v193
    v_lshlrev_b32 v193, 16, v193
    v_rcp_f32 v193, v193
    s_nop 0
    s_waitcnt lgkmcnt(0)
    s_barrier
    s_add_u32 m0, s61, 135168
    s_add_u32 s60, s59, 4096
    buffer_load_dwordx4 v254, s[4:7], s60 offen lds
    v_mul_f32 v194, 0x3a800000, v194
    v_mul_f32 v195, 0x3a800000, v195
    v_fma_f32 v195, -v194, v194, v195
    v_max_f32 v195, 0, v195
    buffer_load_dwordx4 v254, s[4:7], s60 offen offset:1024 lds
    s_add_u32 s94, s94, 16384
    s_and_b32 s94, s94, 0x3ffff
    v_cvt_pk_bf16_f32 v194, v194, v194
    v_lshlrev_b32 v194, 16, v194
    v_cvt_pk_bf16_f32 v195, v195, v195
    v_lshlrev_b32 v195, 16, v195
    v_add_f32 v195, 0x3727c5ac, v195
    buffer_load_dwordx4 v254, s[4:7], s60 offen offset:2048 lds
    v_cvt_pk_bf16_f32 v195, v195, v195
    v_lshlrev_b32 v195, 16, v195
    v_sqrt_f32 v195, v195
    s_nop 0
    buffer_load_dwordx4 v254, s[4:7], s60 offen offset:3072 lds
    v_cvt_pk_bf16_f32 v195, v195, v195
    v_lshlrev_b32 v195, 16, v195
    v_rcp_f32 v195, v195
    s_nop 0
    s_lshl_b32 s55, s43, 9
    s_add_u32 s55, s55, 153600
    v_add_u32 v226, s55, v226
    ds_write_b128 v226, v[192:195]
    s_waitcnt vmcnt(8) lgkmcnt(0)
    s_barrier
    s_add_u32 m0, s61, 98304
    s_add_u32 s59, s62, s94
    buffer_load_dwordx4 v254, s[4:7], s59 offen lds
    buffer_load_dwordx4 v254, s[4:7], s59 offen offset:1024 lds
    buffer_load_dwordx4 v254, s[4:7], s59 offen offset:2048 lds
    buffer_load_dwordx4 v254, s[4:7], s59 offen offset:3072 lds
    s_waitcnt lgkmcnt(0)
    s_barrier
    s_add_u32 m0, s61, 102400
    s_add_u32 s60, s59, 4096
    buffer_load_dwordx4 v254, s[4:7], s60 offen lds
    buffer_load_dwordx4 v254, s[4:7], s60 offen offset:1024 lds
    s_add_u32 s94, s94, 16384
    s_and_b32 s94, s94, 0x3ffff
    buffer_load_dwordx4 v254, s[4:7], s60 offen offset:2048 lds
    buffer_load_dwordx4 v254, s[4:7], s60 offen offset:3072 lds
    s_waitcnt vmcnt(8) lgkmcnt(0)
    s_barrier
    s_add_u32 m0, s61, 114688
    s_add_u32 s59, s62, s94
    buffer_load_dwordx4 v254, s[4:7], s59 offen lds
    buffer_load_dwordx4 v254, s[4:7], s59 offen offset:1024 lds
    buffer_load_dwordx4 v254, s[4:7], s59 offen offset:2048 lds
    buffer_load_dwordx4 v254, s[4:7], s59 offen offset:3072 lds
    s_waitcnt lgkmcnt(0)
    s_barrier
    s_add_u32 m0, s61, 118784
    s_add_u32 s60, s59, 4096
    buffer_load_dwordx4 v254, s[4:7], s60 offen lds
    s_lshl_b32 s55, s43, 9
    s_add_u32 s55, s55, 153600
    v_and_b32 v224, 0xf0, v254
    v_lshrrev_b32 v224, 1, v224
    v_add_u32 v224, s55, v224
    ds_read_b64 v[96:97], v224 offset:0
    ds_read_b64 v[98:99], v224 offset:128
    ds_read_b64 v[100:101], v224 offset:256
    buffer_load_dwordx4 v254, s[4:7], s60 offen offset:1024 lds
    s_add_u32 s94, s94, 16384
    s_and_b32 s94, s94, 0x3ffff
    ds_read_b64 v[102:103], v224 offset:384
    s_waitcnt lgkmcnt(0)
    v_sub_f32 v196, 0, v96
    v_mul_f32 v184, 0xbfb8aa3b, v97
    v_mul_f32 v188, v97, v97
    buffer_load_dwordx4 v254, s[4:7], s60 offen offset:2048 lds
    v_sub_f32 v197, 0, v98
    v_mul_f32 v185, 0xbfb8aa3b, v99
    v_mul_f32 v189, v99, v99
    v_sub_f32 v198, 0, v100
    buffer_load_dwordx4 v254, s[4:7], s60 offen offset:3072 lds
    v_mul_f32 v186, 0xbfb8aa3b, v101
    v_mul_f32 v190, v101, v101
    v_sub_f32 v199, 0, v102
    v_mul_f32 v187, 0xbfb8aa3b, v103
    v_mul_f32 v191, v103, v103
    s_waitcnt vmcnt(8) lgkmcnt(0)
    s_barrier
    s_add_u32 m0, s61, 131072
    s_add_u32 s59, s62, s94
    buffer_load_dwordx4 v254, s[4:7], s59 offen lds
    v_rcp_f32 v188, v188
    v_rcp_f32 v189, v189
    v_rcp_f32 v190, v190
    v_rcp_f32 v191, v191
    buffer_load_dwordx4 v254, s[4:7], s59 offen offset:1024 lds
    s_nop 0
    v_lshrrev_b32 v224, 8, v254
    v_lshlrev_b32 v224, 4, v224
    v_add_u32 v224, 156544, v224
    s_lshl_b32 s55, s44, 8
    v_add_u32 v225, s55, v224
    buffer_load_dwordx4 v254, s[4:7], s59 offen offset:2048 lds
    s_lshl_b32 s55, s44, 6
    v_add_u32 v224, s55, v224
    ds_read_b128 v[96:99], v225 offset:0
    ds_read_b128 v[100:103], v225 offset:64
    ds_read_b128 v[104:107], v224 offset:128
    ds_read_b128 v[108:111], v225 offset:512
    buffer_load_dwordx4 v254, s[4:7], s59 offen offset:3072 lds
    ds_read_b128 v[112:115], v225 offset:576
    ds_read_b128 v[116:119], v224 offset:640
    s_waitcnt lgkmcnt(0)
    v_mul_f32 v0, v196, v96
    v_mul_f32 v1, v196, v97
    s_waitcnt lgkmcnt(0)
    s_barrier
    s_add_u32 m0, s61, 135168
    s_add_u32 s60, s59, 4096
    buffer_load_dwordx4 v254, s[4:7], s60 offen lds
    v_mul_f32 v2, v196, v98
    v_mul_f32 v3, v196, v99
    v_mul_f32 v4, v197, v96
    v_mul_f32 v5, v197, v97
    v_mul_f32 v6, v197, v98
    buffer_load_dwordx4 v254, s[4:7], s60 offen offset:1024 lds
    s_add_u32 s94, s94, 16384
    s_and_b32 s94, s94, 0x3ffff
    v_mul_f32 v7, v197, v99
    v_mul_f32 v8, v198, v96
    v_mul_f32 v9, v198, v97
    v_mul_f32 v10, v198, v98
    v_mul_f32 v11, v198, v99
    buffer_load_dwordx4 v254, s[4:7], s60 offen offset:2048 lds
    v_mul_f32 v12, v199, v96
    v_mul_f32 v13, v199, v97
    v_mul_f32 v14, v199, v98
    v_mul_f32 v15, v199, v99
    v_mul_f32 v16, v196, v100
    buffer_load_dwordx4 v254, s[4:7], s60 offen offset:3072 lds
    v_mul_f32 v17, v196, v101
    v_mul_f32 v18, v196, v102
    v_mul_f32 v19, v196, v103
    v_mul_f32 v20, v197, v100
    v_mul_f32 v21, v197, v101
    s_waitcnt vmcnt(8) lgkmcnt(0)
    s_barrier
    s_add_u32 m0, s61, 98304
    s_add_u32 s59, s62, s94
    buffer_load_dwordx4 v254, s[4:7], s59 offen lds
    v_mul_f32 v22, v197, v102
    v_mul_f32 v23, v197, v103
    v_mul_f32 v24, v198, v100
    v_mul_f32 v25, v198, v101
    v_mul_f32 v26, v198, v102
    buffer_load_dwordx4 v254, s[4:7], s59 offen offset:1024 lds
    v_mul_f32 v27, v198, v103
    v_mul_f32 v28, v199, v100
    v_mul_f32 v29, v199, v101
    v_mul_f32 v30, v199, v102
    v_mul_f32 v31, v199, v103
    buffer_load_dwordx4 v254, s[4:7], s59 offen offset:2048 lds
    v_mul_f32 v32, v196, v104
    v_mul_f32 v33, v196, v105
    v_mul_f32 v34, v196, v106
    v_mul_f32 v35, v196, v107
    v_mul_f32 v36, v197, v104
    buffer_load_dwordx4 v254, s[4:7], s59 offen offset:3072 lds
    v_mul_f32 v37, v197, v105
    v_mul_f32 v38, v197, v106
    v_mul_f32 v39, v197, v107
    v_mul_f32 v40, v198, v104
    v_mul_f32 v41, v198, v105
    s_waitcnt lgkmcnt(0)
    s_barrier
    s_add_u32 m0, s61, 102400
    s_add_u32 s60, s59, 4096
    buffer_load_dwordx4 v254, s[4:7], s60 offen lds
    v_mul_f32 v42, v198, v106
    v_mul_f32 v43, v198, v107
    v_mul_f32 v44, v199, v104
    v_mul_f32 v45, v199, v105
    v_mul_f32 v46, v199, v106
    buffer_load_dwordx4 v254, s[4:7], s60 offen offset:1024 lds
    s_add_u32 s94, s94, 16384
    s_and_b32 s94, s94, 0x3ffff
    v_mul_f32 v47, v199, v107
    v_mul_f32 v48, v196, v108
    v_mul_f32 v49, v196, v109
    v_mul_f32 v50, v196, v110
    v_mul_f32 v51, v196, v111
    buffer_load_dwordx4 v254, s[4:7], s60 offen offset:2048 lds
    v_mul_f32 v52, v197, v108
    v_mul_f32 v53, v197, v109
    v_mul_f32 v54, v197, v110
    v_mul_f32 v55, v197, v111
    v_mul_f32 v56, v198, v108
    buffer_load_dwordx4 v254, s[4:7], s60 offen offset:3072 lds
    v_mul_f32 v57, v198, v109
    v_mul_f32 v58, v198, v110
    v_mul_f32 v59, v198, v111
    v_mul_f32 v60, v199, v108
    v_mul_f32 v61, v199, v109
    s_waitcnt vmcnt(8) lgkmcnt(0)
    s_barrier
    s_add_u32 m0, s61, 114688
    s_add_u32 s59, s62, 0
    buffer_load_dwordx4 v254, s[4:7], s59 offen lds
    v_mul_f32 v62, v199, v110
    v_mul_f32 v63, v199, v111
    v_mul_f32 v64, v196, v112
    v_mul_f32 v65, v196, v113
    v_mul_f32 v66, v196, v114
    buffer_load_dwordx4 v254, s[4:7], s59 offen offset:1024 lds
    v_mul_f32 v67, v196, v115
    v_mul_f32 v68, v197, v112
    v_mul_f32 v69, v197, v113
    v_mul_f32 v70, v197, v114
    v_mul_f32 v71, v197, v115
    buffer_load_dwordx4 v254, s[4:7], s59 offen offset:2048 lds
    v_mul_f32 v72, v198, v112
    v_mul_f32 v73, v198, v113
    v_mul_f32 v74, v198, v114
    v_mul_f32 v75, v198, v115
    v_mul_f32 v76, v199, v112
    buffer_load_dwordx4 v254, s[4:7], s59 offen offset:3072 lds
    v_mul_f32 v77, v199, v113
    v_mul_f32 v78, v199, v114
    v_mul_f32 v79, v199, v115
    v_mul_f32 v80, v196, v116
    v_mul_f32 v81, v196, v117
    s_waitcnt lgkmcnt(0)
    s_barrier
    s_add_u32 m0, s61, 118784
    s_add_u32 s60, s62, 4096
    buffer_load_dwordx4 v254, s[4:7], s60 offen lds
    v_mul_f32 v82, v196, v118
    v_mul_f32 v83, v196, v119
    v_mul_f32 v84, v197, v116
    v_mul_f32 v85, v197, v117
    buffer_load_dwordx4 v254, s[4:7], s60 offen offset:1024 lds
    v_mul_f32 v86, v197, v118
    v_mul_f32 v87, v197, v119
    v_mul_f32 v88, v198, v116
    v_mul_f32 v89, v198, v117
    v_mul_f32 v90, v198, v118
    buffer_load_dwordx4 v254, s[4:7], s60 offen offset:2048 lds
    v_mul_f32 v91, v198, v119
    v_mul_f32 v92, v199, v116
    v_mul_f32 v93, v199, v117
    v_mul_f32 v94, v199, v118
    v_mul_f32 v95, v199, v119
    buffer_load_dwordx4 v254, s[4:7], s60 offen offset:3072 lds
    s_lshl_b32 s55, s43, 13
    s_add_u32 s55, s55, 98304
    v_add_u32 v176, s55, v254
    v_lshrrev_b32 v224, 6, v254
    v_mul_u32_u24 v224, 192, v224
    v_and_b32 v225, 0x30, v254
    v_lshrrev_b32 v225, 1, v225
    s_waitcnt vmcnt(8) lgkmcnt(0)
    s_barrier
    s_add_u32 m0, s61, 131072
    s_add_u32 s59, s62, 16384
    buffer_load_dwordx4 v254, s[4:7], s59 offen lds
    v_add_u32 v224, v224, v225
    v_lshrrev_b32 v225, 8, v254
    v_and_b32 v225, 1, v225
    buffer_load_dwordx4 v254, s[4:7], s59 offen offset:1024 lds
    s_lshl_b32 s55, s44, 2
    v_xor_b32 v226, s55, v225
    v_lshl_add_u32 v177, v226, 5, v224
    v_xor_b32 v226, 1, v226
    buffer_load_dwordx4 v254, s[4:7], s59 offen offset:2048 lds
    v_lshl_add_u32 v178, v226, 5, v224
    s_add_u32 s55, s44, 2
    v_xor_b32 v226, s55, v225
    v_lshl_add_u32 v179, v226, 5, v224
    buffer_load_dwordx4 v254, s[4:7], s59 offen offset:3072 lds
    v_add_u32 v180, 49152, v177
    v_add_u32 v181, 49152, v178
    v_add_u32 v182, 49152, v179
    s_waitcnt lgkmcnt(0)
    s_barrier
    s_add_u32 m0, s61, 135168
    s_add_u32 s60, s62, 20480
    buffer_load_dwordx4 v254, s[4:7], s60 offen lds
    buffer_load_dwordx4 v254, s[4:7], s60 offen offset:1024 lds
    buffer_load_dwordx4 v254, s[4:7], s60 offen offset:2048 lds
    buffer_load_dwordx4 v254, s[4:7], s60 offen offset:3072 lds
    s_waitcnt vmcnt(8) lgkmcnt(0)
    s_barrier
    s_waitcnt vmcnt(0)
    s_setprio 0
    s_branch Y_g3b
YW_start:
    v_lshrrev_b32 v224, 7, v254
    v_and_b32 v225, 0x70, v254
    v_and_b32 v226, 6, v224
    v_lshlrev_b32 v226, 4, v226
    v_xor_b32 v225, v225, v226
    v_and_b32 v226, 4, v224
    v_add_u32 v224, v224, v226
    v_mul_u32_u24 v224, 6144, v224
    v_add_u32 v224, v224, v225
    s_cmp_eq_u32 s43, 0
    s_mov_b32 s55, 4096
    s_cselect_b32 s55, s55, 30720
    v_add_u32 v200, s55, v224
    v_subrev_u32 v200, 4096, v200
    s_cmp_eq_u32 s43, 0
    s_mov_b32 s55, 101376
    s_cselect_b32 s55, s55, 128000
    v_add_u32 v201, s55, v224
    v_subrev_u32 v201, 4096, v201
    s_cmp_eq_u32 s43, 0
    s_mov_b32 s55, 26624
    s_cselect_b32 s55, s55, 6144
    v_add_u32 v202, s55, v224
    v_subrev_u32 v202, 4096, v202
    s_cmp_eq_u32 s43, 0
    s_mov_b32 s55, 126976
    s_cselect_b32 s55, s55, 106496
    v_add_u32 v203, s55, v224
    v_subrev_u32 v203, 4096, v203
    s_cmp_eq_u32 s43, 0
    s_mov_b32 s55, 5120
    s_cselect_b32 s55, s55, 31744
    v_add_u32 v204, s55, v224
    v_subrev_u32 v204, 4096, v204
    s_cmp_eq_u32 s43, 0
    s_mov_b32 s55, 102400
    s_cselect_b32 s55, s55, 129024
    v_add_u32 v205, s55, v224
    v_subrev_u32 v205, 4096, v205
    s_mul_i32 s61, s43, 6144
    s_lshl_b32 s62, s51, 7
    s_lshl_b32 s94, s51, 1
    s_mul_i32 s59, s94, 196608
    s_add_u32 m0, s61, 0
    s_add_u32 s59, s59, s62
    buffer_load_dwordx4 v200, s[8:11], s59 offen lds
    buffer_load_dwordx4 v201, s[8:11], s59 offen offset:1024 lds
    s_add_u32 s94, s94, 1
    s_and_b32 s94, s94, 31
    buffer_load_dwordx4 v202, s[8:11], s59 offen offset:2048 lds
    s_add_u32 m0, s61, 3072
    s_add_u32 s60, s59, 0
    buffer_load_dwordx4 v203, s[8:11], s60 offen lds
    buffer_load_dwordx4 v204, s[8:11], s60 offen offset:1024 lds
    buffer_load_dwordx4 v205, s[8:11], s60 offen offset:2048 lds
    s_mul_i32 s59, s94, 196608
    s_add_u32 m0, s61, 16384
    s_add_u32 s59, s59, s62
    buffer_load_dwordx4 v200, s[8:11], s59 offen lds
    buffer_load_dwordx4 v201, s[8:11], s59 offen offset:1024 lds
    s_add_u32 s94, s94, 1
    s_and_b32 s94, s94, 31
    buffer_load_dwordx4 v202, s[8:11], s59 offen offset:2048 lds
    s_add_u32 m0, s61, 19456
    s_add_u32 s60, s59, 0
    buffer_load_dwordx4 v203, s[8:11], s60 offen lds
    buffer_load_dwordx4 v204, s[8:11], s60 offen offset:1024 lds
    buffer_load_dwordx4 v205, s[8:11], s60 offen offset:2048 lds
    s_mul_i32 s59, s94, 196608
    s_add_u32 m0, s61, 32768
    s_add_u32 s59, s59, s62
    buffer_load_dwordx4 v200, s[8:11], s59 offen lds
    buffer_load_dwordx4 v201, s[8:11], s59 offen offset:1024 lds
    s_add_u32 s94, s94, 1
    s_and_b32 s94, s94, 31
    buffer_load_dwordx4 v202, s[8:11], s59 offen offset:2048 lds
    s_add_u32 m0, s61, 35840
    s_add_u32 s60, s59, 0
    buffer_load_dwordx4 v203, s[8:11], s60 offen lds
    buffer_load_dwordx4 v204, s[8:11], s60 offen offset:1024 lds
    buffer_load_dwordx4 v205, s[8:11], s60 offen offset:2048 lds
    s_mul_i32 s59, s94, 196608
    s_add_u32 m0, s61, 49152
    s_add_u32 s59, s59, s62
    buffer_load_dwordx4 v200, s[8:11], s59 offen lds
    buffer_load_dwordx4 v201, s[8:11], s59 offen offset:1024 lds
    s_add_u32 s94, s94, 1
    s_and_b32 s94, s94, 31
    buffer_load_dwordx4 v202, s[8:11], s59 offen offset:2048 lds
    s_add_u32 m0, s61, 52224
    s_add_u32 s60, s59, 0
    buffer_load_dwordx4 v203, s[8:11], s60 offen lds
    buffer_load_dwordx4 v204, s[8:11], s60 offen offset:1024 lds
    buffer_load_dwordx4 v205, s[8:11], s60 offen offset:2048 lds
    s_mul_i32 s59, s94, 196608
    s_add_u32 m0, s61, 65536
    s_add_u32 s59, s59, s62
    buffer_load_dwordx4 v200, s[8:11], s59 offen lds
    buffer_load_dwordx4 v201, s[8:11], s59 offen offset:1024 lds
    s_add_u32 s94, s94, 1
    s_and_b32 s94, s94, 31
    buffer_load_dwordx4 v202, s[8:11], s59 offen offset:2048 lds
    s_add_u32 m0, s61, 68608
    s_add_u32 s60, s59, 0
    buffer_load_dwordx4 v203, s[8:11], s60 offen lds
    buffer_load_dwordx4 v204, s[8:11], s60 offen offset:1024 lds
    buffer_load_dwordx4 v205, s[8:11], s60 offen offset:2048 lds
    s_mul_i32 s59, s94, 196608
    s_add_u32 m0, s61, 81920
    s_add_u32 s59, s59, s62
    buffer_load_dwordx4 v200, s[8:11], s59 offen lds
    buffer_load_dwordx4 v201, s[8:11], s59 offen offset:1024 lds
    s_add_u32 s94, s94, 1
    s_and_b32 s94, s94, 31
    buffer_load_dwordx4 v202, s[8:11], s59 offen offset:2048 lds
    s_add_u32 m0, s61, 84992
    s_add_u32 s60, s59, 0
    buffer_load_dwordx4 v203, s[8:11], s60 offen lds
    buffer_load_dwordx4 v204, s[8:11], s60 offen offset:1024 lds
    buffer_load_dwordx4 v205, s[8:11], s60 offen offset:2048 lds
YW_layer:
    s_cmp_lg_u32 s46, 0
    s_cbranch_scc1 ya_63
    s_mov_b32 s36, s24
    s_mov_b32 s37, s25
    s_mov_b32 s38, s26
    s_mov_b32 s39, s27
    v_lshrrev_b32 v224, 7, v254
    v_and_b32 v225, 0x70, v254
    v_and_b32 v226, 6, v224
    v_lshlrev_b32 v226, 4, v226
    v_xor_b32 v225, v225, v226
    v_lshl_add_u32 v221, v224, 11, v225
    s_lshl_b32 s64, s40, 18
    s_sub_u32 s64, s64, 32768
    s_lshl_b32 s55, s43, 14
    s_add_u32 s64, s64, s55
    s_mov_b32 s66, 128
    s_branch ya_64
ya_63:
    s_mov_b32 s36, s4
    s_mov_b32 s37, s5
    s_mov_b32 s38, s6
    s_mov_b32 s39, s7
    v_mov_b32 v221, v254
    s_sub_u32 s64, s48, 247808
    s_lshl_b32 s55, s43, 10
    s_add_u32 s64, s64, s55
    s_mov_b32 s66, 16384
ya_64:
    s_cmp_eq_u32 s40, 0
    s_cselect_b32 s64, 2130706432, s64
    s_lshl_b32 s65, s43, 10
    s_mov_b32 s95, s51
    s_cmp_eq_u32 s46, 0
    s_cbranch_scc1 gw_65
    s_barrier
    s_cmp_eq_u32 s40, 0
    s_cbranch_scc1 gw_65
    s_mov_b32 s60, 4294950784
    v_lshrrev_b32 v252, 2, v254
    s_add_u32 s55, s54, 8192
    s_add_u32 s55, s55, s60
    s_mov_b32 s56, 262144
    s_mov_b32 s57, 0x01010101
    s_mov_b64 exec, 0xffff
poll_66:
    buffer_load_dword v253, v252, s[4:7], s55 offen sc0 sc1
    s_waitcnt vmcnt(0)
    v_cmp_ne_u32 vcc, s57, v253
    s_cbranch_vccz pd_67
    s_sleep 1
    s_sub_u32 s56, s56, 1
    s_cmp_lg_u32 s56, 0
    s_cbranch_scc1 poll_66
pd_67:
    s_mov_b64 exec, -1
gw_65:
    s_mul_i32 s93, s95, s66
    s_add_u32 m0, s65, 98304
    s_add_u32 s93, s93, s64
    buffer_load_dwordx4 v221, s[36:39], s93 offen lds
    s_add_u32 s95, s95, 1
    s_and_b32 s95, s95, 15
    s_mul_i32 s93, s95, s66
    s_add_u32 m0, s65, 116736
    s_add_u32 s93, s93, s64
    buffer_load_dwordx4 v221, s[36:39], s93 offen lds
    s_add_u32 s95, s95, 1
    s_and_b32 s95, s95, 15
    s_mul_i32 s93, s95, s66
    s_add_u32 m0, s65, 135168
    s_add_u32 s93, s93, s64
    buffer_load_dwordx4 v221, s[36:39], s93 offen lds
    s_add_u32 s95, s95, 1
    s_and_b32 s95, s95, 15
    s_waitcnt vmcnt(2)
    s_barrier
    s_setprio 1
    s_barrier
    s_mul_i32 s59, s94, 196608
    s_add_u32 m0, s61, 0
    s_add_u32 s59, s59, s62
    buffer_load_dwordx4 v200, s[8:11], s59 offen lds
    buffer_load_dwordx4 v201, s[8:11], s59 offen offset:1024 lds
    s_add_u32 s94, s94, 1
    s_and_b32 s94, s94, 31
    buffer_load_dwordx4 v202, s[8:11], s59 offen offset:2048 lds
    s_add_u32 m0, s61, 3072
    s_add_u32 s60, s59, 0
    buffer_load_dwordx4 v203, s[8:11], s60 offen lds
    buffer_load_dwordx4 v204, s[8:11], s60 offen offset:1024 lds
    buffer_load_dwordx4 v205, s[8:11], s60 offen offset:2048 lds
    s_waitcnt vmcnt(7)
    s_barrier
    s_mul_i32 s93, s95, s66
    s_add_u32 m0, s65, 98304
    s_add_u32 s93, s93, s64
    buffer_load_dwordx4 v221, s[36:39], s93 offen lds
    s_add_u32 s95, s95, 1
    s_and_b32 s95, s95, 15
    s_mul_i32 s59, s94, 196608
    s_add_u32 m0, s61, 16384
    s_add_u32 s59, s59, s62
    buffer_load_dwordx4 v200, s[8:11], s59 offen lds
    buffer_load_dwordx4 v201, s[8:11], s59 offen offset:1024 lds
    s_add_u32 s94, s94, 1
    s_and_b32 s94, s94, 31
    buffer_load_dwordx4 v202, s[8:11], s59 offen offset:2048 lds
    s_add_u32 m0, s61, 19456
    s_add_u32 s60, s59, 0
    buffer_load_dwordx4 v203, s[8:11], s60 offen lds
    buffer_load_dwordx4 v204, s[8:11], s60 offen offset:1024 lds
    buffer_load_dwordx4 v205, s[8:11], s60 offen offset:2048 lds
    s_barrier
    s_mul_i32 s59, s94, 196608
    s_add_u32 m0, s61, 32768
    s_add_u32 s59, s59, s62
    buffer_load_dwordx4 v200, s[8:11], s59 offen lds
    buffer_load_dwordx4 v201, s[8:11], s59 offen offset:1024 lds
    s_add_u32 s94, s94, 1
    s_and_b32 s94, s94, 31
    buffer_load_dwordx4 v202, s[8:11], s59 offen offset:2048 lds
    s_add_u32 m0, s61, 35840
    s_add_u32 s60, s59, 0
    buffer_load_dwordx4 v203, s[8:11], s60 offen lds
    buffer_load_dwordx4 v204, s[8:11], s60 offen offset:1024 lds
    buffer_load_dwordx4 v205, s[8:11], s60 offen offset:2048 lds
    s_waitcnt vmcnt(19)
    s_barrier
    s_mul_i32 s93, s95, s66
    s_add_u32 m0, s65, 116736
    s_add_u32 s93, s93, s64
    buffer_load_dwordx4 v221, s[36:39], s93 offen lds
    s_add_u32 s95, s95, 1
    s_and_b32 s95, s95, 15
    s_mul_i32 s59, s94, 196608
    s_add_u32 m0, s61, 49152
    s_add_u32 s59, s59, s62
    buffer_load_dwordx4 v200, s[8:11], s59 offen lds
    buffer_load_dwordx4 v201, s[8:11], s59 offen offset:1024 lds
    s_add_u32 s94, s94, 1
    s_and_b32 s94, s94, 31
    buffer_load_dwordx4 v202, s[8:11], s59 offen offset:2048 lds
    s_add_u32 m0, s61, 52224
    s_add_u32 s60, s59, 0
    buffer_load_dwordx4 v203, s[8:11], s60 offen lds
    buffer_load_dwordx4 v204, s[8:11], s60 offen offset:1024 lds
    buffer_load_dwordx4 v205, s[8:11], s60 offen offset:2048 lds
    s_barrier
    s_mul_i32 s59, s94, 196608
    s_add_u32 m0, s61, 65536
    s_add_u32 s59, s59, s62
    buffer_load_dwordx4 v200, s[8:11], s59 offen lds
    buffer_load_dwordx4 v201, s[8:11], s59 offen offset:1024 lds
    s_add_u32 s94, s94, 1
    s_and_b32 s94, s94, 31
    buffer_load_dwordx4 v202, s[8:11], s59 offen offset:2048 lds
    s_add_u32 m0, s61, 68608
    s_add_u32 s60, s59, 0
    buffer_load_dwordx4 v203, s[8:11], s60 offen lds
    buffer_load_dwordx4 v204, s[8:11], s60 offen offset:1024 lds
    buffer_load_dwordx4 v205, s[8:11], s60 offen offset:2048 lds
    s_waitcnt vmcnt(25)
    s_barrier
    s_mul_i32 s93, s95, s66
    s_add_u32 m0, s65, 135168
    s_add_u32 s93, s93, s64
    buffer_load_dwordx4 v221, s[36:39], s93 offen lds
    s_add_u32 s95, s95, 1
    s_and_b32 s95, s95, 15
    s_mul_i32 s59, s94, 196608
    s_add_u32 m0, s61, 81920
    s_add_u32 s59, s59, s62
    buffer_load_dwordx4 v200, s[8:11], s59 offen lds
    buffer_load_dwordx4 v201, s[8:11], s59 offen offset:1024 lds
    s_add_u32 s94, s94, 1
    s_and_b32 s94, s94, 31
    buffer_load_dwordx4 v202, s[8:11], s59 offen offset:2048 lds
    s_add_u32 m0, s61, 84992
    s_add_u32 s60, s59, 0
    buffer_load_dwordx4 v203, s[8:11], s60 offen lds
    buffer_load_dwordx4 v204, s[8:11], s60 offen offset:1024 lds
    buffer_load_dwordx4 v205, s[8:11], s60 offen offset:2048 lds
    s_waitcnt vmcnt(26)
    s_barrier
    s_mul_i32 s59, s94, 196608
    s_add_u32 m0, s61, 0
    s_add_u32 s59, s59, s62
    buffer_load_dwordx4 v200, s[8:11], s59 offen lds
    buffer_load_dwordx4 v201, s[8:11], s59 offen offset:1024 lds
    s_add_u32 s94, s94, 1
    s_and_b32 s94, s94, 31
    buffer_load_dwordx4 v202, s[8:11], s59 offen offset:2048 lds
    s_add_u32 m0, s61, 3072
    s_add_u32 s60, s59, 0
    buffer_load_dwordx4 v203, s[8:11], s60 offen lds
    buffer_load_dwordx4 v204, s[8:11], s60 offen offset:1024 lds
    buffer_load_dwordx4 v205, s[8:11], s60 offen offset:2048 lds
    s_waitcnt vmcnt(25)
    s_barrier
    s_mul_i32 s93, s95, s66
    s_add_u32 m0, s65, 98304
    s_add_u32 s93, s93, s64
    buffer_load_dwordx4 v221, s[36:39], s93 offen lds
    s_add_u32 s95, s95, 1
    s_and_b32 s95, s95, 15
    s_mul_i32 s59, s94, 196608
    s_add_u32 m0, s61, 16384
    s_add_u32 s59, s59, s62
    buffer_load_dwordx4 v200, s[8:11], s59 offen lds
    buffer_load_dwordx4 v201, s[8:11], s59 offen offset:1024 lds
    s_add_u32 s94, s94, 1
    s_and_b32 s94, s94, 31
    buffer_load_dwordx4 v202, s[8:11], s59 offen offset:2048 lds
    s_add_u32 m0, s61, 19456
    s_add_u32 s60, s59, 0
    buffer_load_dwordx4 v203, s[8:11], s60 offen lds
    buffer_load_dwordx4 v204, s[8:11], s60 offen offset:1024 lds
    buffer_load_dwordx4 v205, s[8:11], s60 offen offset:2048 lds
    s_waitcnt vmcnt(26)
    s_barrier
    s_mul_i32 s59, s94, 196608
    s_add_u32 m0, s61, 32768
    s_add_u32 s59, s59, s62
    buffer_load_dwordx4 v200, s[8:11], s59 offen lds
    buffer_load_dwordx4 v201, s[8:11], s59 offen offset:1024 lds
    s_add_u32 s94, s94, 1
    s_and_b32 s94, s94, 31
    buffer_load_dwordx4 v202, s[8:11], s59 offen offset:2048 lds
    s_add_u32 m0, s61, 35840
    s_add_u32 s60, s59, 0
    buffer_load_dwordx4 v203, s[8:11], s60 offen lds
    buffer_load_dwordx4 v204, s[8:11], s60 offen offset:1024 lds
    buffer_load_dwordx4 v205, s[8:11], s60 offen offset:2048 lds
    v_lshrrev_b32 v224, 7, v254
    v_and_b32 v225, 0x70, v254
    v_and_b32 v226, 6, v224
    v_lshlrev_b32 v226, 4, v226
    v_xor_b32 v225, v225, v226
    v_lshl_add_u32 v206, v224, 11, v225
    v_add_u32 v207, 15360, v206
    v_add_u32 v208, 30720, v206
    v_add_u32 v209, 46080, v206
    s_lshl_b32 s67, s43, 13
    s_lshl_b32 s68, s51, 7
    s_waitcnt vmcnt(25)
    s_barrier
    s_mul_i32 s93, s95, s66
    s_add_u32 m0, s65, 116736
    s_add_u32 s93, s93, s64
    buffer_load_dwordx4 v221, s[36:39], s93 offen lds
    s_add_u32 s95, s95, 1
    s_and_b32 s95, s95, 15
    s_mul_i32 s59, s94, 196608
    s_add_u32 m0, s61, 49152
    s_add_u32 s59, s59, s62
    buffer_load_dwordx4 v200, s[8:11], s59 offen lds
    buffer_load_dwordx4 v201, s[8:11], s59 offen offset:1024 lds
    s_add_u32 s94, s94, 1
    s_and_b32 s94, s94, 31
    buffer_load_dwordx4 v202, s[8:11], s59 offen offset:2048 lds
    s_add_u32 m0, s61, 52224
    s_add_u32 s60, s59, 0
    buffer_load_dwordx4 v203, s[8:11], s60 offen lds
    buffer_load_dwordx4 v204, s[8:11], s60 offen offset:1024 lds
    buffer_load_dwordx4 v205, s[8:11], s60 offen offset:2048 lds
    s_waitcnt vmcnt(26)
    s_barrier
    s_mul_i32 s59, s94, 196608
    s_add_u32 m0, s61, 65536
    s_add_u32 s59, s59, s62
    buffer_load_dwordx4 v200, s[8:11], s59 offen lds
    buffer_load_dwordx4 v201, s[8:11], s59 offen offset:1024 lds
    s_add_u32 s94, s94, 1
    s_and_b32 s94, s94, 31
    buffer_load_dwordx4 v202, s[8:11], s59 offen offset:2048 lds
    s_add_u32 m0, s61, 68608
    s_add_u32 s60, s59, 0
    buffer_load_dwordx4 v203, s[8:11], s60 offen lds
    buffer_load_dwordx4 v204, s[8:11], s60 offen offset:1024 lds
    buffer_load_dwordx4 v205, s[8:11], s60 offen offset:2048 lds
    s_waitcnt vmcnt(25)
    s_barrier
    s_mul_i32 s93, s95, s66
    s_add_u32 m0, s65, 135168
    s_add_u32 s93, s93, s64
    buffer_load_dwordx4 v221, s[36:39], s93 offen lds
    s_add_u32 s95, s95, 1
    s_and_b32 s95, s95, 15
    s_mul_i32 s59, s94, 196608
    s_add_u32 m0, s61, 81920
    s_add_u32 s59, s59, s62
    buffer_load_dwordx4 v200, s[8:11], s59 offen lds
    buffer_load_dwordx4 v201, s[8:11], s59 offen offset:1024 lds
    s_add_u32 s94, s94, 1
    s_and_b32 s94, s94, 31
    buffer_load_dwordx4 v202, s[8:11], s59 offen offset:2048 lds
    s_add_u32 m0, s61, 84992
    s_add_u32 s60, s59, 0
    buffer_load_dwordx4 v203, s[8:11], s60 offen lds
    buffer_load_dwordx4 v204, s[8:11], s60 offen offset:1024 lds
    buffer_load_dwordx4 v205, s[8:11], s60 offen offset:2048 lds
    s_waitcnt vmcnt(26)
    s_barrier
    s_mul_i32 s59, s94, 196608
    s_add_u32 m0, s61, 0
    s_add_u32 s59, s59, s62
    buffer_load_dwordx4 v200, s[8:11], s59 offen lds
    buffer_load_dwordx4 v201, s[8:11], s59 offen offset:1024 lds
    s_add_u32 s94, s94, 1
    s_and_b32 s94, s94, 31
    buffer_load_dwordx4 v202, s[8:11], s59 offen offset:2048 lds
    s_add_u32 m0, s61, 3072
    s_add_u32 s60, s59, 0
    buffer_load_dwordx4 v203, s[8:11], s60 offen lds
    buffer_load_dwordx4 v204, s[8:11], s60 offen offset:1024 lds
    buffer_load_dwordx4 v205, s[8:11], s60 offen offset:2048 lds
    s_waitcnt vmcnt(25)
    s_barrier
    s_mul_i32 s93, s95, s66
    s_add_u32 m0, s65, 98304
    s_add_u32 s93, s93, s64
    buffer_load_dwordx4 v221, s[36:39], s93 offen lds
    s_add_u32 s95, s95, 1
    s_and_b32 s95, s95, 15
    s_mul_i32 s59, s94, 196608
    s_add_u32 m0, s61, 16384
    s_add_u32 s59, s59, s62
    buffer_load_dwordx4 v200, s[8:11], s59 offen lds
    buffer_load_dwordx4 v201, s[8:11], s59 offen offset:1024 lds
    s_add_u32 s94, s94, 1
    s_and_b32 s94, s94, 31
    buffer_load_dwordx4 v202, s[8:11], s59 offen offset:2048 lds
    s_add_u32 m0, s61, 19456
    s_add_u32 s60, s59, 0
    buffer_load_dwordx4 v203, s[8:11], s60 offen lds
    buffer_load_dwordx4 v204, s[8:11], s60 offen offset:1024 lds
    buffer_load_dwordx4 v205, s[8:11], s60 offen offset:2048 lds
    s_waitcnt vmcnt(26)
    s_barrier
    s_mul_i32 s59, s94, 196608
    s_add_u32 m0, s61, 32768
    s_add_u32 s59, s59, s62
    buffer_load_dwordx4 v200, s[8:11], s59 offen lds
    buffer_load_dwordx4 v201, s[8:11], s59 offen offset:1024 lds
    s_add_u32 s94, s94, 1
    s_and_b32 s94, s94, 31
    buffer_load_dwordx4 v202, s[8:11], s59 offen offset:2048 lds
    s_add_u32 m0, s61, 35840
    s_add_u32 s60, s59, 0
    buffer_load_dwordx4 v203, s[8:11], s60 offen lds
    buffer_load_dwordx4 v204, s[8:11], s60 offen offset:1024 lds
    buffer_load_dwordx4 v205, s[8:11], s60 offen offset:2048 lds
    s_waitcnt vmcnt(25)
    s_barrier
    s_mul_i32 s93, s95, s66
    s_add_u32 m0, s65, 116736
    s_add_u32 s93, s93, s64
    buffer_load_dwordx4 v221, s[36:39], s93 offen lds
    s_add_u32 s95, s95, 1
    s_and_b32 s95, s95, 15
    s_mul_i32 s59, s94, 196608
    s_add_u32 m0, s61, 49152
    s_add_u32 s59, s59, s62
    buffer_load_dwordx4 v200, s[8:11], s59 offen lds
    buffer_load_dwordx4 v201, s[8:11], s59 offen offset:1024 lds
    s_add_u32 s94, s94, 1
    s_and_b32 s94, s94, 31
    buffer_load_dwordx4 v202, s[8:11], s59 offen offset:2048 lds
    s_add_u32 m0, s61, 52224
    s_add_u32 s60, s59, 0
    buffer_load_dwordx4 v203, s[8:11], s60 offen lds
    buffer_load_dwordx4 v204, s[8:11], s60 offen offset:1024 lds
    buffer_load_dwordx4 v205, s[8:11], s60 offen offset:2048 lds
    s_waitcnt vmcnt(26)
    s_barrier
    s_mul_i32 s59, s94, 196608
    s_add_u32 m0, s61, 65536
    s_add_u32 s59, s59, s62
    buffer_load_dwordx4 v200, s[8:11], s59 offen lds
    buffer_load_dwordx4 v201, s[8:11], s59 offen offset:1024 lds
    s_add_u32 s94, s94, 1
    s_and_b32 s94, s94, 31
    buffer_load_dwordx4 v202, s[8:11], s59 offen offset:2048 lds
    s_add_u32 m0, s61, 68608
    s_add_u32 s60, s59, 0
    buffer_load_dwordx4 v203, s[8:11], s60 offen lds
    buffer_load_dwordx4 v204, s[8:11], s60 offen offset:1024 lds
    buffer_load_dwordx4 v205, s[8:11], s60 offen offset:2048 lds
    s_waitcnt vmcnt(25)
    s_barrier
    s_mul_i32 s93, s95, s66
    s_add_u32 m0, s65, 135168
    s_add_u32 s93, s93, s64
    buffer_load_dwordx4 v221, s[36:39], s93 offen lds
    s_add_u32 s95, s95, 1
    s_and_b32 s95, s95, 15
    s_mul_i32 s59, s94, 196608
    s_add_u32 m0, s61, 81920
    s_add_u32 s59, s59, s62
    buffer_load_dwordx4 v200, s[8:11], s59 offen lds
    buffer_load_dwordx4 v201, s[8:11], s59 offen offset:1024 lds
    s_add_u32 s94, s94, 1
    s_and_b32 s94, s94, 31
    buffer_load_dwordx4 v202, s[8:11], s59 offen offset:2048 lds
    s_add_u32 m0, s61, 84992
    s_add_u32 s60, s59, 0
    buffer_load_dwordx4 v203, s[8:11], s60 offen lds
    buffer_load_dwordx4 v204, s[8:11], s60 offen offset:1024 lds
    buffer_load_dwordx4 v205, s[8:11], s60 offen offset:2048 lds
    s_waitcnt vmcnt(26)
    s_barrier
    s_mul_i32 s59, s94, 196608
    s_add_u32 m0, s61, 0
    s_add_u32 s59, s59, s62
    buffer_load_dwordx4 v200, s[8:11], s59 offen lds
    buffer_load_dwordx4 v201, s[8:11], s59 offen offset:1024 lds
    s_add_u32 s94, s94, 1
    s_and_b32 s94, s94, 31
    buffer_load_dwordx4 v202, s[8:11], s59 offen offset:2048 lds
    s_add_u32 m0, s61, 3072
    s_add_u32 s60, s59, 0
    buffer_load_dwordx4 v203, s[8:11], s60 offen lds
    buffer_load_dwordx4 v204, s[8:11], s60 offen offset:1024 lds
    buffer_load_dwordx4 v205, s[8:11], s60 offen offset:2048 lds
    s_waitcnt vmcnt(25)
    s_barrier
    s_mul_i32 s93, s95, s66
    s_add_u32 m0, s65, 98304
    s_add_u32 s93, s93, s64
    buffer_load_dwordx4 v221, s[36:39], s93 offen lds
    s_add_u32 s95, s95, 1
    s_and_b32 s95, s95, 15
    s_mul_i32 s59, s94, 196608
    s_add_u32 m0, s61, 16384
    s_add_u32 s59, s59, s62
    buffer_load_dwordx4 v200, s[8:11], s59 offen lds
    buffer_load_dwordx4 v201, s[8:11], s59 offen offset:1024 lds
    s_add_u32 s94, s94, 1
    s_and_b32 s94, s94, 31
    buffer_load_dwordx4 v202, s[8:11], s59 offen offset:2048 lds
    s_add_u32 m0, s61, 19456
    s_add_u32 s60, s59, 0
    buffer_load_dwordx4 v203, s[8:11], s60 offen lds
    buffer_load_dwordx4 v204, s[8:11], s60 offen offset:1024 lds
    buffer_load_dwordx4 v205, s[8:11], s60 offen offset:2048 lds
    s_waitcnt vmcnt(26)
    s_barrier
    s_mul_i32 s59, s94, 196608
    s_add_u32 m0, s61, 32768
    s_add_u32 s59, s59, s62
    buffer_load_dwordx4 v200, s[8:11], s59 offen lds
    buffer_load_dwordx4 v201, s[8:11], s59 offen offset:1024 lds
    s_add_u32 s94, s94, 1
    s_and_b32 s94, s94, 31
    buffer_load_dwordx4 v202, s[8:11], s59 offen offset:2048 lds
    s_add_u32 m0, s61, 35840
    s_add_u32 s60, s59, 0
    buffer_load_dwordx4 v203, s[8:11], s60 offen lds
    buffer_load_dwordx4 v204, s[8:11], s60 offen offset:1024 lds
    buffer_load_dwordx4 v205, s[8:11], s60 offen offset:2048 lds
    s_waitcnt vmcnt(25)
    s_barrier
    s_mul_i32 s93, s95, s66
    s_add_u32 m0, s65, 116736
    s_add_u32 s93, s93, s64
    buffer_load_dwordx4 v221, s[36:39], s93 offen lds
    s_add_u32 s95, s95, 1
    s_and_b32 s95, s95, 15
    s_mul_i32 s59, s94, 196608
    s_add_u32 m0, s61, 49152
    s_add_u32 s59, s59, s62
    buffer_load_dwordx4 v200, s[8:11], s59 offen lds
    buffer_load_dwordx4 v201, s[8:11], s59 offen offset:1024 lds
    s_add_u32 s94, s94, 1
    s_and_b32 s94, s94, 31
    buffer_load_dwordx4 v202, s[8:11], s59 offen offset:2048 lds
    s_add_u32 m0, s61, 52224
    s_add_u32 s60, s59, 0
    buffer_load_dwordx4 v203, s[8:11], s60 offen lds
    buffer_load_dwordx4 v204, s[8:11], s60 offen offset:1024 lds
    buffer_load_dwordx4 v205, s[8:11], s60 offen offset:2048 lds
    s_waitcnt vmcnt(26)
    s_barrier
    s_mul_i32 s59, s94, 196608
    s_add_u32 m0, s61, 65536
    s_add_u32 s59, s59, s62
    buffer_load_dwordx4 v200, s[8:11], s59 offen lds
    buffer_load_dwordx4 v201, s[8:11], s59 offen offset:1024 lds
    s_add_u32 s94, s94, 1
    s_and_b32 s94, s94, 31
    buffer_load_dwordx4 v202, s[8:11], s59 offen offset:2048 lds
    s_add_u32 m0, s61, 68608
    s_add_u32 s60, s59, 0
    buffer_load_dwordx4 v203, s[8:11], s60 offen lds
    buffer_load_dwordx4 v204, s[8:11], s60 offen offset:1024 lds
    buffer_load_dwordx4 v205, s[8:11], s60 offen offset:2048 lds
    s_waitcnt vmcnt(25)
    s_barrier
    s_mul_i32 s93, s95, s66
    s_add_u32 m0, s65, 135168
    s_add_u32 s93, s93, s64
    buffer_load_dwordx4 v221, s[36:39], s93 offen lds
    s_add_u32 s95, s95, 1
    s_and_b32 s95, s95, 15
    s_mul_i32 s59, s94, 196608
    s_add_u32 m0, s61, 81920
    s_add_u32 s59, s59, s62
    buffer_load_dwordx4 v200, s[8:11], s59 offen lds
    buffer_load_dwordx4 v201, s[8:11], s59 offen offset:1024 lds
    s_add_u32 s94, s94, 1
    s_and_b32 s94, s94, 31
    buffer_load_dwordx4 v202, s[8:11], s59 offen offset:2048 lds
    s_add_u32 m0, s61, 84992
    s_add_u32 s60, s59, 0
    buffer_load_dwordx4 v203, s[8:11], s60 offen lds
    buffer_load_dwordx4 v204, s[8:11], s60 offen offset:1024 lds
    buffer_load_dwordx4 v205, s[8:11], s60 offen offset:2048 lds
    s_waitcnt vmcnt(26)
    s_barrier
    s_mul_i32 s59, s94, 196608
    s_add_u32 m0, s61, 0
    s_add_u32 s59, s59, s62
    buffer_load_dwordx4 v200, s[8:11], s59 offen lds
    buffer_load_dwordx4 v201, s[8:11], s59 offen offset:1024 lds
    s_add_u32 s94, s94, 1
    s_and_b32 s94, s94, 31
    buffer_load_dwordx4 v202, s[8:11], s59 offen offset:2048 lds
    s_add_u32 m0, s61, 3072
    s_add_u32 s60, s59, 0
    buffer_load_dwordx4 v203, s[8:11], s60 offen lds
    buffer_load_dwordx4 v204, s[8:11], s60 offen offset:1024 lds
    buffer_load_dwordx4 v205, s[8:11], s60 offen offset:2048 lds
    s_waitcnt vmcnt(25)
    s_barrier
    s_mul_i32 s93, s95, s66
    s_add_u32 m0, s65, 98304
    s_add_u32 s93, s93, s64
    buffer_load_dwordx4 v221, s[36:39], s93 offen lds
    s_add_u32 s95, s95, 1
    s_and_b32 s95, s95, 15
    s_mul_i32 s59, s94, 196608
    s_add_u32 m0, s61, 16384
    s_add_u32 s59, s59, s62
    buffer_load_dwordx4 v200, s[8:11], s59 offen lds
    buffer_load_dwordx4 v201, s[8:11], s59 offen offset:1024 lds
    s_add_u32 s94, s94, 1
    s_and_b32 s94, s94, 31
    buffer_load_dwordx4 v202, s[8:11], s59 offen offset:2048 lds
    s_add_u32 m0, s61, 19456
    s_add_u32 s60, s59, 0
    buffer_load_dwordx4 v203, s[8:11], s60 offen lds
    buffer_load_dwordx4 v204, s[8:11], s60 offen offset:1024 lds
    buffer_load_dwordx4 v205, s[8:11], s60 offen offset:2048 lds
    s_waitcnt vmcnt(26)
    s_barrier
    s_add_u32 s94, s51, s43
    s_and_b32 s94, s94, 15
    s_mul_i32 s59, s94, 131072
    s_add_u32 m0, s67, 32768
    s_add_u32 s59, s59, s68
    buffer_load_dwordx4 v206, s[12:15], s59 offen lds
    buffer_load_dwordx4 v207, s[12:15], s59 offen offset:1024 lds
    s_add_u32 s94, s94, 2
    s_and_b32 s94, s94, 15
    buffer_load_dwordx4 v208, s[12:15], s59 offen offset:2048 lds
    buffer_load_dwordx4 v209, s[12:15], s59 offen offset:3072 lds
    s_add_u32 m0, s67, 36864
    s_add_u32 s60, s59, 65536
    buffer_load_dwordx4 v206, s[12:15], s60 offen lds
    buffer_load_dwordx4 v207, s[12:15], s60 offen offset:1024 lds
    buffer_load_dwordx4 v208, s[12:15], s60 offen offset:2048 lds
    buffer_load_dwordx4 v209, s[12:15], s60 offen offset:3072 lds
    s_waitcnt vmcnt(27)
    s_barrier
    s_mul_i32 s59, s94, 131072
    s_add_u32 m0, s67, 49152
    s_add_u32 s59, s59, s68
    buffer_load_dwordx4 v206, s[12:15], s59 offen lds
    buffer_load_dwordx4 v207, s[12:15], s59 offen offset:1024 lds
    s_add_u32 s94, s94, 2
    s_and_b32 s94, s94, 15
    buffer_load_dwordx4 v208, s[12:15], s59 offen offset:2048 lds
    buffer_load_dwordx4 v209, s[12:15], s59 offen offset:3072 lds
    s_add_u32 m0, s67, 53248
    s_add_u32 s60, s59, 65536
    buffer_load_dwordx4 v206, s[12:15], s60 offen lds
    buffer_load_dwordx4 v207, s[12:15], s60 offen offset:1024 lds
    buffer_load_dwordx4 v208, s[12:15], s60 offen offset:2048 lds
    buffer_load_dwordx4 v209, s[12:15], s60 offen offset:3072 lds
    s_waitcnt vmcnt(29)
    s_barrier
    s_mul_i32 s59, s94, 131072
    s_add_u32 m0, s67, 65536
    s_add_u32 s59, s59, s68
    buffer_load_dwordx4 v206, s[12:15], s59 offen lds
    buffer_load_dwordx4 v207, s[12:15], s59 offen offset:1024 lds
    s_add_u32 s94, s94, 2
    s_and_b32 s94, s94, 15
    buffer_load_dwordx4 v208, s[12:15], s59 offen offset:2048 lds
    buffer_load_dwordx4 v209, s[12:15], s59 offen offset:3072 lds
    s_add_u32 m0, s67, 69632
    s_add_u32 s60, s59, 65536
    buffer_load_dwordx4 v206, s[12:15], s60 offen lds
    buffer_load_dwordx4 v207, s[12:15], s60 offen offset:1024 lds
    buffer_load_dwordx4 v208, s[12:15], s60 offen offset:2048 lds
    buffer_load_dwordx4 v209, s[12:15], s60 offen offset:3072 lds
    s_waitcnt vmcnt(30)
    s_barrier
    s_mul_i32 s59, s94, 131072
    s_add_u32 m0, s67, 81920
    s_add_u32 s59, s59, s68
    buffer_load_dwordx4 v206, s[12:15], s59 offen lds
    buffer_load_dwordx4 v207, s[12:15], s59 offen offset:1024 lds
    s_add_u32 s94, s94, 2
    s_and_b32 s94, s94, 15
    buffer_load_dwordx4 v208, s[12:15], s59 offen offset:2048 lds
    buffer_load_dwordx4 v209, s[12:15], s59 offen offset:3072 lds
    s_add_u32 m0, s67, 86016
    s_add_u32 s60, s59, 65536
    buffer_load_dwordx4 v206, s[12:15], s60 offen lds
    buffer_load_dwordx4 v207, s[12:15], s60 offen offset:1024 lds
    buffer_load_dwordx4 v208, s[12:15], s60 offen offset:2048 lds
    buffer_load_dwordx4 v209, s[12:15], s60 offen offset:3072 lds
    s_waitcnt vmcnt(32)
    s_barrier
    s_mul_i32 s59, s94, 131072
    s_add_u32 m0, s67, 0
    s_add_u32 s59, s59, s68
    buffer_load_dwordx4 v206, s[12:15], s59 offen lds
    buffer_load_dwordx4 v207, s[12:15], s59 offen offset:1024 lds
    s_add_u32 s94, s94, 2
    s_and_b32 s94, s94, 15
    buffer_load_dwordx4 v208, s[12:15], s59 offen offset:2048 lds
    buffer_load_dwordx4 v209, s[12:15], s59 offen offset:3072 lds
    s_add_u32 m0, s67, 4096
    s_add_u32 s60, s59, 65536
    buffer_load_dwordx4 v206, s[12:15], s60 offen lds
    buffer_load_dwordx4 v207, s[12:15], s60 offen offset:1024 lds
    buffer_load_dwordx4 v208, s[12:15], s60 offen offset:2048 lds
    buffer_load_dwordx4 v209, s[12:15], s60 offen offset:3072 lds
    s_barrier
    s_mul_i32 s59, s94, 131072
    s_add_u32 m0, s67, 16384
    s_add_u32 s59, s59, s68
    buffer_load_dwordx4 v206, s[12:15], s59 offen lds
    buffer_load_dwordx4 v207, s[12:15], s59 offen offset:1024 lds
    s_add_u32 s94, s94, 2
    s_and_b32 s94, s94, 15
    buffer_load_dwordx4 v208, s[12:15], s59 offen offset:2048 lds
    buffer_load_dwordx4 v209, s[12:15], s59 offen offset:3072 lds
    s_add_u32 m0, s67, 20480
    s_add_u32 s60, s59, 65536
    buffer_load_dwordx4 v206, s[12:15], s60 offen lds
    buffer_load_dwordx4 v207, s[12:15], s60 offen offset:1024 lds
    buffer_load_dwordx4 v208, s[12:15], s60 offen offset:2048 lds
    buffer_load_dwordx4 v209, s[12:15], s60 offen offset:3072 lds
    v_mov_b32 v224, 157568
    ds_read_b32 v224, v224
    s_waitcnt lgkmcnt(0)
    v_readfirstlane_b32 s45, v224
    v_and_b32 v225, 0xf0, v254
    v_lshrrev_b32 v224, 8, v254
    v_and_b32 v226, 7, v224
    v_lshlrev_b32 v226, 5, v226
    v_xor_b32 v226, v225, v226
    v_mul_u32_u24 v224, 7168, v224
    v_add_u32 v210, v224, v226
    v_lshrrev_b32 v224, 8, v254
    v_add_u32 v224, 4, v224
    v_and_b32 v226, 7, v224
    v_lshlrev_b32 v226, 5, v226
    v_xor_b32 v226, v225, v226
    v_mul_u32_u24 v224, 7168, v224
    v_add_u32 v211, v224, v226
    v_subrev_u32 v211, 1024, v211
    v_lshrrev_b32 v224, 8, v254
    v_add_u32 v224, 8, v224
    v_and_b32 v226, 7, v224
    v_lshlrev_b32 v226, 5, v226
    v_xor_b32 v226, v225, v226
    v_mul_u32_u24 v224, 7168, v224
    v_add_u32 v212, v224, v226
    v_subrev_u32 v212, 2048, v212
    v_lshrrev_b32 v224, 8, v254
    v_add_u32 v224, 12, v224
    v_and_b32 v226, 7, v224
    v_lshlrev_b32 v226, 5, v226
    v_xor_b32 v226, v225, v226
    v_mul_u32_u24 v224, 7168, v224
    v_add_u32 v213, v224, v226
    v_subrev_u32 v213, 3072, v213
    s_lshl_b32 s67, s43, 13
    s_mul_i32 s62, s41, 448
    s_and_b32 s55, s41, 1
    s_mul_i32 s55, s55, 192
    s_add_u32 s62, s62, s55
    s_mov_b32 s55, 5462
    v_lshrrev_b32 v224, 4, v254
    v_mul_lo_u32 v225, v224, s55
    v_lshrrev_b32 v225, 16, v225
    v_mul_u32_u24 v226, 12, v225
    v_sub_u32 v224, v224, v226
    v_lshrrev_b32 v226, 1, v225
    v_and_b32 v226, 2, v226
    v_xor_b32 v224, v224, v226
    v_mul_u32_u24 v225, 7168, v225
    v_lshl_add_u32 v214, v224, 4, v225
    v_lshrrev_b32 v224, 4, v254
    v_add_u32 v224, 64, v224
    v_mul_lo_u32 v225, v224, s55
    v_lshrrev_b32 v225, 16, v225
    v_mul_u32_u24 v226, 12, v225
    v_sub_u32 v224, v224, v226
    v_lshrrev_b32 v226, 1, v225
    v_and_b32 v226, 2, v226
    v_xor_b32 v224, v224, v226
    v_mul_u32_u24 v225, 7168, v225
    v_lshl_add_u32 v215, v224, 4, v225
    v_subrev_u32 v215, 1024, v215
    v_lshrrev_b32 v224, 4, v254
    v_add_u32 v224, 128, v224
    v_mul_lo_u32 v225, v224, s55
    v_lshrrev_b32 v225, 16, v225
    v_mul_u32_u24 v226, 12, v225
    v_sub_u32 v224, v224, v226
    v_lshrrev_b32 v226, 1, v225
    v_and_b32 v226, 2, v226
    v_xor_b32 v224, v224, v226
    v_mul_u32_u24 v225, 7168, v225
    v_lshl_add_u32 v216, v224, 4, v225
    v_subrev_u32 v216, 2048, v216
    s_mul_i32 s61, s43, 6144
    s_mul_i32 s63, s41, 448
    s_and_b32 s55, s41, 1
    s_xor_b32 s55, s55, 1
    s_lshl_b32 s55, s55, 8
    s_add_u32 s63, s63, s55
    s_barrier
    s_waitcnt vmcnt(40)
    s_barrier
    s_barrier
    s_waitcnt vmcnt(32)
    s_barrier
    s_mul_i32 s59, s94, 131072
    s_add_u32 m0, s67, 32768
    s_add_u32 s59, s59, s68
    buffer_load_dwordx4 v206, s[12:15], s59 offen lds
    buffer_load_dwordx4 v207, s[12:15], s59 offen offset:1024 lds
    s_add_u32 s94, s94, 2
    s_and_b32 s94, s94, 15
    buffer_load_dwordx4 v208, s[12:15], s59 offen offset:2048 lds
    buffer_load_dwordx4 v209, s[12:15], s59 offen offset:3072 lds
    s_add_u32 m0, s67, 36864
    s_add_u32 s60, s59, 65536
    buffer_load_dwordx4 v206, s[12:15], s60 offen lds
    buffer_load_dwordx4 v207, s[12:15], s60 offen offset:1024 lds
    buffer_load_dwordx4 v208, s[12:15], s60 offen offset:2048 lds
    buffer_load_dwordx4 v209, s[12:15], s60 offen offset:3072 lds
    s_barrier
    s_waitcnt vmcnt(32)
    s_barrier
    s_mul_i32 s59, s94, 131072
    s_add_u32 m0, s67, 49152
    s_add_u32 s59, s59, s68
    buffer_load_dwordx4 v206, s[12:15], s59 offen lds
    buffer_load_dwordx4 v207, s[12:15], s59 offen offset:1024 lds
    s_add_u32 s94, s94, 2
    s_and_b32 s94, s94, 15
    buffer_load_dwordx4 v208, s[12:15], s59 offen offset:2048 lds
    buffer_load_dwordx4 v209, s[12:15], s59 offen offset:3072 lds
    s_add_u32 m0, s67, 53248
    s_add_u32 s60, s59, 65536
    buffer_load_dwordx4 v206, s[12:15], s60 offen lds
    buffer_load_dwordx4 v207, s[12:15], s60 offen offset:1024 lds
    buffer_load_dwordx4 v208, s[12:15], s60 offen offset:2048 lds
    buffer_load_dwordx4 v209, s[12:15], s60 offen offset:3072 lds
    s_barrier
    s_waitcnt vmcnt(32)
    s_barrier
    s_barrier
    s_waitcnt vmcnt(24)
    s_barrier
    s_barrier
    s_waitcnt vmcnt(16)
    s_barrier
    s_barrier
    s_waitcnt vmcnt(8)
    s_barrier
    s_barrier
    s_waitcnt vmcnt(0)
    s_barrier
    s_lshl_b32 s94, s51, 1
    s_mul_i32 s59, s94, 229376
    s_add_u32 m0, s67, 65536
    s_add_u32 s59, s59, s62
    buffer_load_dwordx4 v210, s[16:19], s59 offen lds
    buffer_load_dwordx4 v211, s[16:19], s59 offen offset:1024 lds
    s_add_u32 s94, s94, 1
    s_and_b32 s94, s94, 31
    buffer_load_dwordx4 v212, s[16:19], s59 offen offset:2048 lds
    buffer_load_dwordx4 v213, s[16:19], s59 offen offset:3072 lds
    s_add_u32 m0, s67, 69632
    s_add_u32 s60, s59, 114688
    buffer_load_dwordx4 v210, s[16:19], s60 offen lds
    buffer_load_dwordx4 v211, s[16:19], s60 offen offset:1024 lds
    buffer_load_dwordx4 v212, s[16:19], s60 offen offset:2048 lds
    buffer_load_dwordx4 v213, s[16:19], s60 offen offset:3072 lds
    s_mul_i32 s59, s94, 229376
    s_add_u32 m0, s67, 81920
    s_add_u32 s59, s59, s62
    buffer_load_dwordx4 v210, s[16:19], s59 offen lds
    buffer_load_dwordx4 v211, s[16:19], s59 offen offset:1024 lds
    s_add_u32 s94, s94, 1
    s_and_b32 s94, s94, 31
    buffer_load_dwordx4 v212, s[16:19], s59 offen offset:2048 lds
    buffer_load_dwordx4 v213, s[16:19], s59 offen offset:3072 lds
    s_add_u32 m0, s67, 86016
    s_add_u32 s60, s59, 114688
    buffer_load_dwordx4 v210, s[16:19], s60 offen lds
    buffer_load_dwordx4 v211, s[16:19], s60 offen offset:1024 lds
    buffer_load_dwordx4 v212, s[16:19], s60 offen offset:2048 lds
    buffer_load_dwordx4 v213, s[16:19], s60 offen offset:3072 lds
    s_barrier
    s_mul_i32 s59, s94, 229376
    s_add_u32 m0, s67, 0
    s_add_u32 s59, s59, s62
    buffer_load_dwordx4 v210, s[16:19], s59 offen lds
    buffer_load_dwordx4 v211, s[16:19], s59 offen offset:1024 lds
    s_add_u32 s94, s94, 1
    s_and_b32 s94, s94, 31
    buffer_load_dwordx4 v212, s[16:19], s59 offen offset:2048 lds
    buffer_load_dwordx4 v213, s[16:19], s59 offen offset:3072 lds
    s_add_u32 m0, s67, 4096
    s_add_u32 s60, s59, 114688
    buffer_load_dwordx4 v210, s[16:19], s60 offen lds
    buffer_load_dwordx4 v211, s[16:19], s60 offen offset:1024 lds
    buffer_load_dwordx4 v212, s[16:19], s60 offen offset:2048 lds
    buffer_load_dwordx4 v213, s[16:19], s60 offen offset:3072 lds
    s_mul_i32 s59, s94, 229376
    s_add_u32 m0, s67, 16384
    s_add_u32 s59, s59, s62
    buffer_load_dwordx4 v210, s[16:19], s59 offen lds
    buffer_load_dwordx4 v211, s[16:19], s59 offen offset:1024 lds
    s_add_u32 s94, s94, 1
    s_and_b32 s94, s94, 31
    buffer_load_dwordx4 v212, s[16:19], s59 offen offset:2048 lds
    buffer_load_dwordx4 v213, s[16:19], s59 offen offset:3072 lds
    s_add_u32 m0, s67, 20480
    s_add_u32 s60, s59, 114688
    buffer_load_dwordx4 v210, s[16:19], s60 offen lds
    buffer_load_dwordx4 v211, s[16:19], s60 offen offset:1024 lds
    buffer_load_dwordx4 v212, s[16:19], s60 offen offset:2048 lds
    buffer_load_dwordx4 v213, s[16:19], s60 offen offset:3072 lds
    s_barrier
    s_mul_i32 s59, s94, 229376
    s_add_u32 m0, s67, 32768
    s_add_u32 s59, s59, s62
    buffer_load_dwordx4 v210, s[16:19], s59 offen lds
    buffer_load_dwordx4 v211, s[16:19], s59 offen offset:1024 lds
    s_add_u32 s94, s94, 1
    s_and_b32 s94, s94, 31
    buffer_load_dwordx4 v212, s[16:19], s59 offen offset:2048 lds
    buffer_load_dwordx4 v213, s[16:19], s59 offen offset:3072 lds
    s_add_u32 m0, s67, 36864
    s_add_u32 s60, s59, 114688
    buffer_load_dwordx4 v210, s[16:19], s60 offen lds
    buffer_load_dwordx4 v211, s[16:19], s60 offen offset:1024 lds
    buffer_load_dwordx4 v212, s[16:19], s60 offen offset:2048 lds
    buffer_load_dwordx4 v213, s[16:19], s60 offen offset:3072 lds
    s_mul_i32 s59, s94, 229376
    s_add_u32 m0, s67, 49152
    s_add_u32 s59, s59, s62
    buffer_load_dwordx4 v210, s[16:19], s59 offen lds
    buffer_load_dwordx4 v211, s[16:19], s59 offen offset:1024 lds
    s_add_u32 s94, s94, 1
    s_and_b32 s94, s94, 31
    buffer_load_dwordx4 v212, s[16:19], s59 offen offset:2048 lds
    buffer_load_dwordx4 v213, s[16:19], s59 offen offset:3072 lds
    s_add_u32 m0, s67, 53248
    s_add_u32 s60, s59, 114688
    buffer_load_dwordx4 v210, s[16:19], s60 offen lds
    buffer_load_dwordx4 v211, s[16:19], s60 offen offset:1024 lds
    buffer_load_dwordx4 v212, s[16:19], s60 offen offset:2048 lds
    buffer_load_dwordx4 v213, s[16:19], s60 offen offset:3072 lds
    s_setprio 1
    s_barrier
    s_waitcnt vmcnt(40)
    s_barrier
    s_waitcnt vmcnt(32) lgkmcnt(0)
    s_barrier
    s_mul_i32 s59, s94, 229376
    s_add_u32 m0, s67, 65536
    s_add_u32 s59, s59, s62
    buffer_load_dwordx4 v210, s[16:19], s59 offen lds
    buffer_load_dwordx4 v211, s[16:19], s59 offen offset:1024 lds
    s_add_u32 s94, s94, 1
    s_and_b32 s94, s94, 31
    buffer_load_dwordx4 v212, s[16:19], s59 offen offset:2048 lds
    buffer_load_dwordx4 v213, s[16:19], s59 offen offset:3072 lds
    s_add_u32 m0, s67, 69632
    s_add_u32 s60, s59, 114688
    buffer_load_dwordx4 v210, s[16:19], s60 offen lds
    buffer_load_dwordx4 v211, s[16:19], s60 offen offset:1024 lds
    buffer_load_dwordx4 v212, s[16:19], s60 offen offset:2048 lds
    buffer_load_dwordx4 v213, s[16:19], s60 offen offset:3072 lds
    s_waitcnt vmcnt(32) lgkmcnt(0)
    s_barrier
    s_mul_i32 s59, s94, 229376
    s_add_u32 m0, s67, 81920
    s_add_u32 s59, s59, s62
    buffer_load_dwordx4 v210, s[16:19], s59 offen lds
    buffer_load_dwordx4 v211, s[16:19], s59 offen offset:1024 lds
    s_add_u32 s94, s94, 1
    s_and_b32 s94, s94, 31
    buffer_load_dwordx4 v212, s[16:19], s59 offen offset:2048 lds
    buffer_load_dwordx4 v213, s[16:19], s59 offen offset:3072 lds
    s_add_u32 m0, s67, 86016
    s_add_u32 s60, s59, 114688
    buffer_load_dwordx4 v210, s[16:19], s60 offen lds
    buffer_load_dwordx4 v211, s[16:19], s60 offen offset:1024 lds
    buffer_load_dwordx4 v212, s[16:19], s60 offen offset:2048 lds
    buffer_load_dwordx4 v213, s[16:19], s60 offen offset:3072 lds
    s_waitcnt vmcnt(32) lgkmcnt(0)
    s_barrier
    s_mul_i32 s59, s94, 229376
    s_add_u32 m0, s67, 0
    s_add_u32 s59, s59, s62
    buffer_load_dwordx4 v210, s[16:19], s59 offen lds
    buffer_load_dwordx4 v211, s[16:19], s59 offen offset:1024 lds
    s_add_u32 s94, s94, 1
    s_and_b32 s94, s94, 31
    buffer_load_dwordx4 v212, s[16:19], s59 offen offset:2048 lds
    buffer_load_dwordx4 v213, s[16:19], s59 offen offset:3072 lds
    s_add_u32 m0, s67, 4096
    s_add_u32 s60, s59, 114688
    buffer_load_dwordx4 v210, s[16:19], s60 offen lds
    buffer_load_dwordx4 v211, s[16:19], s60 offen offset:1024 lds
    buffer_load_dwordx4 v212, s[16:19], s60 offen offset:2048 lds
    buffer_load_dwordx4 v213, s[16:19], s60 offen offset:3072 lds
    s_waitcnt vmcnt(32) lgkmcnt(0)
    s_barrier
    s_mul_i32 s59, s94, 229376
    s_add_u32 m0, s67, 16384
    s_add_u32 s59, s59, s62
    buffer_load_dwordx4 v210, s[16:19], s59 offen lds
    buffer_load_dwordx4 v211, s[16:19], s59 offen offset:1024 lds
    s_add_u32 s94, s94, 1
    s_and_b32 s94, s94, 31
    buffer_load_dwordx4 v212, s[16:19], s59 offen offset:2048 lds
    buffer_load_dwordx4 v213, s[16:19], s59 offen offset:3072 lds
    s_add_u32 m0, s67, 20480
    s_add_u32 s60, s59, 114688
    buffer_load_dwordx4 v210, s[16:19], s60 offen lds
    buffer_load_dwordx4 v211, s[16:19], s60 offen offset:1024 lds
    buffer_load_dwordx4 v212, s[16:19], s60 offen offset:2048 lds
    buffer_load_dwordx4 v213, s[16:19], s60 offen offset:3072 lds
    s_waitcnt vmcnt(32) lgkmcnt(0)
    s_barrier
    v_lshlrev_b32 v224, 3, v254
    s_lshl_b32 s55, s2, 1
    s_add_u32 s55, s55, s43
    s_lshl_b32 s55, s55, 14
    s_cmp_eq_u32 s46, 0
    s_cselect_b32 s55, s55, 2130706432
    buffer_load_dword v225, v224, s[20:23], s55 offen
    s_add_u32 s55, s55, 8192
    buffer_load_dword v225, v224, s[20:23], s55 offen
    s_mul_i32 s59, s94, 229376
    s_add_u32 m0, s67, 32768
    s_add_u32 s59, s59, s62
    buffer_load_dwordx4 v210, s[16:19], s59 offen lds
    buffer_load_dwordx4 v211, s[16:19], s59 offen offset:1024 lds
    s_add_u32 s94, s94, 1
    s_and_b32 s94, s94, 31
    buffer_load_dwordx4 v212, s[16:19], s59 offen offset:2048 lds
    buffer_load_dwordx4 v213, s[16:19], s59 offen offset:3072 lds
    s_add_u32 m0, s67, 36864
    s_add_u32 s60, s59, 114688
    buffer_load_dwordx4 v210, s[16:19], s60 offen lds
    buffer_load_dwordx4 v211, s[16:19], s60 offen offset:1024 lds
    buffer_load_dwordx4 v212, s[16:19], s60 offen offset:2048 lds
    buffer_load_dwordx4 v213, s[16:19], s60 offen offset:3072 lds
    s_waitcnt vmcnt(34) lgkmcnt(0)
    s_barrier
    s_mul_i32 s59, s94, 229376
    s_add_u32 m0, s67, 49152
    s_add_u32 s59, s59, s62
    buffer_load_dwordx4 v210, s[16:19], s59 offen lds
    buffer_load_dwordx4 v211, s[16:19], s59 offen offset:1024 lds
    s_add_u32 s94, s94, 1
    s_and_b32 s94, s94, 31
    buffer_load_dwordx4 v212, s[16:19], s59 offen offset:2048 lds
    buffer_load_dwordx4 v213, s[16:19], s59 offen offset:3072 lds
    s_add_u32 m0, s67, 53248
    s_add_u32 s60, s59, 114688
    buffer_load_dwordx4 v210, s[16:19], s60 offen lds
    buffer_load_dwordx4 v211, s[16:19], s60 offen offset:1024 lds
    buffer_load_dwordx4 v212, s[16:19], s60 offen offset:2048 lds
    buffer_load_dwordx4 v213, s[16:19], s60 offen offset:3072 lds
    s_waitcnt vmcnt(34) lgkmcnt(0)
    s_barrier
    s_mul_i32 s59, s94, 229376
    s_add_u32 m0, s67, 65536
    s_add_u32 s59, s59, s62
    buffer_load_dwordx4 v210, s[16:19], s59 offen lds
    buffer_load_dwordx4 v211, s[16:19], s59 offen offset:1024 lds
    s_add_u32 s94, s94, 1
    s_and_b32 s94, s94, 31
    buffer_load_dwordx4 v212, s[16:19], s59 offen offset:2048 lds
    buffer_load_dwordx4 v213, s[16:19], s59 offen offset:3072 lds
    s_add_u32 m0, s67, 69632
    s_add_u32 s60, s59, 114688
    buffer_load_dwordx4 v210, s[16:19], s60 offen lds
    buffer_load_dwordx4 v211, s[16:19], s60 offen offset:1024 lds
    buffer_load_dwordx4 v212, s[16:19], s60 offen offset:2048 lds
    buffer_load_dwordx4 v213, s[16:19], s60 offen offset:3072 lds
    s_waitcnt vmcnt(34) lgkmcnt(0)
    s_barrier
    s_mul_i32 s59, s94, 229376
    s_add_u32 m0, s67, 81920
    s_add_u32 s59, s59, s62
    buffer_load_dwordx4 v210, s[16:19], s59 offen lds
    buffer_load_dwordx4 v211, s[16:19], s59 offen offset:1024 lds
    s_add_u32 s94, s94, 1
    s_and_b32 s94, s94, 31
    buffer_load_dwordx4 v212, s[16:19], s59 offen offset:2048 lds
    buffer_load_dwordx4 v213, s[16:19], s59 offen offset:3072 lds
    s_add_u32 m0, s67, 86016
    s_add_u32 s60, s59, 114688
    buffer_load_dwordx4 v210, s[16:19], s60 offen lds
    buffer_load_dwordx4 v211, s[16:19], s60 offen offset:1024 lds
    buffer_load_dwordx4 v212, s[16:19], s60 offen offset:2048 lds
    buffer_load_dwordx4 v213, s[16:19], s60 offen offset:3072 lds
    s_waitcnt vmcnt(34) lgkmcnt(0)
    s_barrier
    s_mul_i32 s59, s94, 229376
    s_add_u32 m0, s67, 0
    s_add_u32 s59, s59, s62
    buffer_load_dwordx4 v210, s[16:19], s59 offen lds
    buffer_load_dwordx4 v211, s[16:19], s59 offen offset:1024 lds
    s_add_u32 s94, s94, 1
    s_and_b32 s94, s94, 31
    buffer_load_dwordx4 v212, s[16:19], s59 offen offset:2048 lds
    buffer_load_dwordx4 v213, s[16:19], s59 offen offset:3072 lds
    s_add_u32 m0, s67, 4096
    s_add_u32 s60, s59, 114688
    buffer_load_dwordx4 v210, s[16:19], s60 offen lds
    buffer_load_dwordx4 v211, s[16:19], s60 offen offset:1024 lds
    buffer_load_dwordx4 v212, s[16:19], s60 offen offset:2048 lds
    buffer_load_dwordx4 v213, s[16:19], s60 offen offset:3072 lds
    s_waitcnt vmcnt(32) lgkmcnt(0)
    s_barrier
    s_mul_i32 s59, s94, 229376
    s_add_u32 m0, s67, 16384
    s_add_u32 s59, s59, s62
    buffer_load_dwordx4 v210, s[16:19], s59 offen lds
    buffer_load_dwordx4 v211, s[16:19], s59 offen offset:1024 lds
    s_add_u32 s94, s94, 1
    s_and_b32 s94, s94, 31
    buffer_load_dwordx4 v212, s[16:19], s59 offen offset:2048 lds
    buffer_load_dwordx4 v213, s[16:19], s59 offen offset:3072 lds
    s_add_u32 m0, s67, 20480
    s_add_u32 s60, s59, 114688
    buffer_load_dwordx4 v210, s[16:19], s60 offen lds
    buffer_load_dwordx4 v211, s[16:19], s60 offen offset:1024 lds
    buffer_load_dwordx4 v212, s[16:19], s60 offen offset:2048 lds
    buffer_load_dwordx4 v213, s[16:19], s60 offen offset:3072 lds
    s_waitcnt vmcnt(32) lgkmcnt(0)
    s_barrier
    s_mul_i32 s59, s94, 229376
    s_add_u32 m0, s67, 32768
    s_add_u32 s59, s59, s62
    buffer_load_dwordx4 v210, s[16:19], s59 offen lds
    buffer_load_dwordx4 v211, s[16:19], s59 offen offset:1024 lds
    s_add_u32 s94, s94, 1
    s_and_b32 s94, s94, 31
    buffer_load_dwordx4 v212, s[16:19], s59 offen offset:2048 lds
    buffer_load_dwordx4 v213, s[16:19], s59 offen offset:3072 lds
    s_add_u32 m0, s67, 36864
    s_add_u32 s60, s59, 114688
    buffer_load_dwordx4 v210, s[16:19], s60 offen lds
    buffer_load_dwordx4 v211, s[16:19], s60 offen offset:1024 lds
    buffer_load_dwordx4 v212, s[16:19], s60 offen offset:2048 lds
    buffer_load_dwordx4 v213, s[16:19], s60 offen offset:3072 lds
    s_waitcnt vmcnt(32) lgkmcnt(0)
    s_barrier
    s_mul_i32 s59, s94, 229376
    s_add_u32 m0, s67, 49152
    s_add_u32 s59, s59, s62
    buffer_load_dwordx4 v210, s[16:19], s59 offen lds
    buffer_load_dwordx4 v211, s[16:19], s59 offen offset:1024 lds
    s_add_u32 s94, s94, 1
    s_and_b32 s94, s94, 31
    buffer_load_dwordx4 v212, s[16:19], s59 offen offset:2048 lds
    buffer_load_dwordx4 v213, s[16:19], s59 offen offset:3072 lds
    s_add_u32 m0, s67, 53248
    s_add_u32 s60, s59, 114688
    buffer_load_dwordx4 v210, s[16:19], s60 offen lds
    buffer_load_dwordx4 v211, s[16:19], s60 offen offset:1024 lds
    buffer_load_dwordx4 v212, s[16:19], s60 offen offset:2048 lds
    buffer_load_dwordx4 v213, s[16:19], s60 offen offset:3072 lds
    s_waitcnt vmcnt(32) lgkmcnt(0)
    s_barrier
    s_mul_i32 s59, s94, 229376
    s_add_u32 m0, s67, 65536
    s_add_u32 s59, s59, s62
    buffer_load_dwordx4 v210, s[16:19], s59 offen lds
    buffer_load_dwordx4 v211, s[16:19], s59 offen offset:1024 lds
    s_add_u32 s94, s94, 1
    s_and_b32 s94, s94, 31
    buffer_load_dwordx4 v212, s[16:19], s59 offen offset:2048 lds
    buffer_load_dwordx4 v213, s[16:19], s59 offen offset:3072 lds
    s_add_u32 m0, s67, 69632
    s_add_u32 s60, s59, 114688
    buffer_load_dwordx4 v210, s[16:19], s60 offen lds
    buffer_load_dwordx4 v211, s[16:19], s60 offen offset:1024 lds
    buffer_load_dwordx4 v212, s[16:19], s60 offen offset:2048 lds
    buffer_load_dwordx4 v213, s[16:19], s60 offen offset:3072 lds
    s_waitcnt vmcnt(32) lgkmcnt(0)
    s_barrier
    s_mul_i32 s59, s94, 229376
    s_add_u32 m0, s67, 81920
    s_add_u32 s59, s59, s62
    buffer_load_dwordx4 v210, s[16:19], s59 offen lds
    buffer_load_dwordx4 v211, s[16:19], s59 offen offset:1024 lds
    s_add_u32 s94, s94, 1
    s_and_b32 s94, s94, 31
    buffer_load_dwordx4 v212, s[16:19], s59 offen offset:2048 lds
    buffer_load_dwordx4 v213, s[16:19], s59 offen offset:3072 lds
    s_add_u32 m0, s67, 86016
    s_add_u32 s60, s59, 114688
    buffer_load_dwordx4 v210, s[16:19], s60 offen lds
    buffer_load_dwordx4 v211, s[16:19], s60 offen offset:1024 lds
    buffer_load_dwordx4 v212, s[16:19], s60 offen offset:2048 lds
    buffer_load_dwordx4 v213, s[16:19], s60 offen offset:3072 lds
    s_waitcnt vmcnt(32) lgkmcnt(0)
    s_barrier
    s_mul_i32 s59, s94, 229376
    s_add_u32 m0, s67, 0
    s_add_u32 s59, s59, s62
    buffer_load_dwordx4 v210, s[16:19], s59 offen lds
    buffer_load_dwordx4 v211, s[16:19], s59 offen offset:1024 lds
    s_add_u32 s94, s94, 1
    s_and_b32 s94, s94, 31
    buffer_load_dwordx4 v212, s[16:19], s59 offen offset:2048 lds
    buffer_load_dwordx4 v213, s[16:19], s59 offen offset:3072 lds
    s_add_u32 m0, s67, 4096
    s_add_u32 s60, s59, 114688
    buffer_load_dwordx4 v210, s[16:19], s60 offen lds
    buffer_load_dwordx4 v211, s[16:19], s60 offen offset:1024 lds
    buffer_load_dwordx4 v212, s[16:19], s60 offen offset:2048 lds
    buffer_load_dwordx4 v213, s[16:19], s60 offen offset:3072 lds
    s_waitcnt vmcnt(32) lgkmcnt(0)
    s_barrier
    s_mul_i32 s59, s94, 229376
    s_add_u32 m0, s67, 16384
    s_add_u32 s59, s59, s62
    buffer_load_dwordx4 v210, s[16:19], s59 offen lds
    buffer_load_dwordx4 v211, s[16:19], s59 offen offset:1024 lds
    s_add_u32 s94, s94, 1
    s_and_b32 s94, s94, 31
    buffer_load_dwordx4 v212, s[16:19], s59 offen offset:2048 lds
    buffer_load_dwordx4 v213, s[16:19], s59 offen offset:3072 lds
    s_add_u32 m0, s67, 20480
    s_add_u32 s60, s59, 114688
    buffer_load_dwordx4 v210, s[16:19], s60 offen lds
    buffer_load_dwordx4 v211, s[16:19], s60 offen offset:1024 lds
    buffer_load_dwordx4 v212, s[16:19], s60 offen offset:2048 lds
    buffer_load_dwordx4 v213, s[16:19], s60 offen offset:3072 lds
    s_waitcnt vmcnt(32) lgkmcnt(0)
    s_barrier
    s_mul_i32 s59, s94, 229376
    s_add_u32 m0, s67, 32768
    s_add_u32 s59, s59, s62
    buffer_load_dwordx4 v210, s[16:19], s59 offen lds
    buffer_load_dwordx4 v211, s[16:19], s59 offen offset:1024 lds
    s_add_u32 s94, s94, 1
    s_and_b32 s94, s94, 31
    buffer_load_dwordx4 v212, s[16:19], s59 offen offset:2048 lds
    buffer_load_dwordx4 v213, s[16:19], s59 offen offset:3072 lds
    s_add_u32 m0, s67, 36864
    s_add_u32 s60, s59, 114688
    buffer_load_dwordx4 v210, s[16:19], s60 offen lds
    buffer_load_dwordx4 v211, s[16:19], s60 offen offset:1024 lds
    buffer_load_dwordx4 v212, s[16:19], s60 offen offset:2048 lds
    buffer_load_dwordx4 v213, s[16:19], s60 offen offset:3072 lds
    s_waitcnt vmcnt(32) lgkmcnt(0)
    s_barrier
    s_mul_i32 s59, s94, 229376
    s_add_u32 m0, s67, 49152
    s_add_u32 s59, s59, s62
    buffer_load_dwordx4 v210, s[16:19], s59 offen lds
    buffer_load_dwordx4 v211, s[16:19], s59 offen offset:1024 lds
    s_add_u32 s94, s94, 1
    s_and_b32 s94, s94, 31
    buffer_load_dwordx4 v212, s[16:19], s59 offen offset:2048 lds
    buffer_load_dwordx4 v213, s[16:19], s59 offen offset:3072 lds
    s_add_u32 m0, s67, 53248
    s_add_u32 s60, s59, 114688
    buffer_load_dwordx4 v210, s[16:19], s60 offen lds
    buffer_load_dwordx4 v211, s[16:19], s60 offen offset:1024 lds
    buffer_load_dwordx4 v212, s[16:19], s60 offen offset:2048 lds
    buffer_load_dwordx4 v213, s[16:19], s60 offen offset:3072 lds
    s_waitcnt vmcnt(32) lgkmcnt(0)
    s_barrier
    s_mul_i32 s59, s94, 229376
    s_add_u32 m0, s67, 65536
    s_add_u32 s59, s59, s62
    buffer_load_dwordx4 v210, s[16:19], s59 offen lds
    buffer_load_dwordx4 v211, s[16:19], s59 offen offset:1024 lds
    s_add_u32 s94, s94, 1
    s_and_b32 s94, s94, 31
    buffer_load_dwordx4 v212, s[16:19], s59 offen offset:2048 lds
    buffer_load_dwordx4 v213, s[16:19], s59 offen offset:3072 lds
    s_add_u32 m0, s67, 69632
    s_add_u32 s60, s59, 114688
    buffer_load_dwordx4 v210, s[16:19], s60 offen lds
    buffer_load_dwordx4 v211, s[16:19], s60 offen offset:1024 lds
    buffer_load_dwordx4 v212, s[16:19], s60 offen offset:2048 lds
    buffer_load_dwordx4 v213, s[16:19], s60 offen offset:3072 lds
    s_waitcnt vmcnt(32) lgkmcnt(0)
    s_barrier
    s_mul_i32 s59, s94, 229376
    s_add_u32 m0, s67, 81920
    s_add_u32 s59, s59, s62
    buffer_load_dwordx4 v210, s[16:19], s59 offen lds
    buffer_load_dwordx4 v211, s[16:19], s59 offen offset:1024 lds
    s_add_u32 s94, s94, 1
    s_and_b32 s94, s94, 31
    buffer_load_dwordx4 v212, s[16:19], s59 offen offset:2048 lds
    buffer_load_dwordx4 v213, s[16:19], s59 offen offset:3072 lds
    s_add_u32 m0, s67, 86016
    s_add_u32 s60, s59, 114688
    buffer_load_dwordx4 v210, s[16:19], s60 offen lds
    buffer_load_dwordx4 v211, s[16:19], s60 offen offset:1024 lds
    buffer_load_dwordx4 v212, s[16:19], s60 offen offset:2048 lds
    buffer_load_dwordx4 v213, s[16:19], s60 offen offset:3072 lds
    s_waitcnt vmcnt(32) lgkmcnt(0)
    s_barrier
    s_mul_i32 s59, s94, 229376
    s_add_u32 m0, s67, 0
    s_add_u32 s59, s59, s62
    buffer_load_dwordx4 v210, s[16:19], s59 offen lds
    buffer_load_dwordx4 v211, s[16:19], s59 offen offset:1024 lds
    s_add_u32 s94, s94, 1
    s_and_b32 s94, s94, 31
    buffer_load_dwordx4 v212, s[16:19], s59 offen offset:2048 lds
    buffer_load_dwordx4 v213, s[16:19], s59 offen offset:3072 lds
    s_add_u32 m0, s67, 4096
    s_add_u32 s60, s59, 114688
    buffer_load_dwordx4 v210, s[16:19], s60 offen lds
    buffer_load_dwordx4 v211, s[16:19], s60 offen offset:1024 lds
    buffer_load_dwordx4 v212, s[16:19], s60 offen offset:2048 lds
    buffer_load_dwordx4 v213, s[16:19], s60 offen offset:3072 lds
    s_waitcnt vmcnt(32) lgkmcnt(0)
    s_barrier
    s_mul_i32 s59, s94, 229376
    s_add_u32 m0, s67, 16384
    s_add_u32 s59, s59, s62
    buffer_load_dwordx4 v210, s[16:19], s59 offen lds
    buffer_load_dwordx4 v211, s[16:19], s59 offen offset:1024 lds
    s_add_u32 s94, s94, 1
    s_and_b32 s94, s94, 31
    buffer_load_dwordx4 v212, s[16:19], s59 offen offset:2048 lds
    buffer_load_dwordx4 v213, s[16:19], s59 offen offset:3072 lds
    s_add_u32 m0, s67, 20480
    s_add_u32 s60, s59, 114688
    buffer_load_dwordx4 v210, s[16:19], s60 offen lds
    buffer_load_dwordx4 v211, s[16:19], s60 offen offset:1024 lds
    buffer_load_dwordx4 v212, s[16:19], s60 offen offset:2048 lds
    buffer_load_dwordx4 v213, s[16:19], s60 offen offset:3072 lds
    s_waitcnt vmcnt(32) lgkmcnt(0)
    s_barrier
    s_mul_i32 s59, s94, 229376
    s_add_u32 m0, s67, 32768
    s_add_u32 s59, s59, s62
    buffer_load_dwordx4 v210, s[16:19], s59 offen lds
    s_lshl_b32 s55, s43, 9
    s_add_u32 s55, s55, 153600
    v_and_b32 v224, 0xf0, v254
    v_lshrrev_b32 v224, 1, v224
    v_add_u32 v224, s55, v224
    ds_read_b64 v[96:97], v224 offset:0
    buffer_load_dwordx4 v211, s[16:19], s59 offen offset:1024 lds
    s_add_u32 s94, s94, 1
    s_and_b32 s94, s94, 31
    ds_read_b64 v[98:99], v224 offset:128
    ds_read_b64 v[100:101], v224 offset:256
    buffer_load_dwordx4 v212, s[16:19], s59 offen offset:2048 lds
    ds_read_b64 v[102:103], v224 offset:384
    s_waitcnt lgkmcnt(0)
    buffer_load_dwordx4 v213, s[16:19], s59 offen offset:3072 lds
    v_sub_f32 v196, 0, v96
    v_mul_f32 v184, 0xbfb8aa3b, v97
    v_mul_f32 v188, v97, v97
    s_add_u32 m0, s67, 36864
    s_add_u32 s60, s59, 114688
    buffer_load_dwordx4 v210, s[16:19], s60 offen lds
    v_sub_f32 v197, 0, v98
    v_mul_f32 v185, 0xbfb8aa3b, v99
    buffer_load_dwordx4 v211, s[16:19], s60 offen offset:1024 lds
    v_mul_f32 v189, v99, v99
    v_sub_f32 v198, 0, v100
    buffer_load_dwordx4 v212, s[16:19], s60 offen offset:2048 lds
    v_mul_f32 v186, 0xbfb8aa3b, v101
    v_mul_f32 v190, v101, v101
    buffer_load_dwordx4 v213, s[16:19], s60 offen offset:3072 lds
    v_sub_f32 v199, 0, v102
    v_mul_f32 v187, 0xbfb8aa3b, v103
    v_mul_f32 v191, v103, v103
    s_waitcnt vmcnt(32) lgkmcnt(0)
    s_barrier
    s_mul_i32 s59, s94, 229376
    s_add_u32 m0, s67, 49152
    s_add_u32 s59, s59, s62
    buffer_load_dwordx4 v210, s[16:19], s59 offen lds
    v_rcp_f32 v188, v188
    v_rcp_f32 v189, v189
    buffer_load_dwordx4 v211, s[16:19], s59 offen offset:1024 lds
    s_add_u32 s94, s94, 1
    s_and_b32 s94, s94, 31
    v_rcp_f32 v190, v190
    v_rcp_f32 v191, v191
    buffer_load_dwordx4 v212, s[16:19], s59 offen offset:2048 lds
    s_nop 0
    v_lshrrev_b32 v224, 8, v254
    v_lshlrev_b32 v224, 4, v224
    buffer_load_dwordx4 v213, s[16:19], s59 offen offset:3072 lds
    v_add_u32 v224, 156544, v224
    s_lshl_b32 s55, s44, 8
    v_add_u32 v225, s55, v224
    s_add_u32 m0, s67, 53248
    s_add_u32 s60, s59, 114688
    buffer_load_dwordx4 v210, s[16:19], s60 offen lds
    s_lshl_b32 s55, s44, 6
    v_add_u32 v224, s55, v224
    ds_read_b128 v[96:99], v225 offset:0
    buffer_load_dwordx4 v211, s[16:19], s60 offen offset:1024 lds
    ds_read_b128 v[100:103], v225 offset:64
    ds_read_b128 v[104:107], v224 offset:128
    ds_read_b128 v[108:111], v225 offset:512
    buffer_load_dwordx4 v212, s[16:19], s60 offen offset:2048 lds
    ds_read_b128 v[112:115], v225 offset:576
    ds_read_b128 v[116:119], v224 offset:640
    buffer_load_dwordx4 v213, s[16:19], s60 offen offset:3072 lds
    s_waitcnt lgkmcnt(0)
    v_mul_f32 v0, v196, v96
    v_mul_f32 v1, v196, v97
    s_waitcnt vmcnt(32) lgkmcnt(0)
    s_barrier
    s_mul_i32 s59, s94, 229376
    s_add_u32 m0, s67, 65536
    s_add_u32 s59, s59, s62
    buffer_load_dwordx4 v210, s[16:19], s59 offen lds
    v_mul_f32 v2, v196, v98
    v_mul_f32 v3, v196, v99
    buffer_load_dwordx4 v211, s[16:19], s59 offen offset:1024 lds
    s_add_u32 s94, s94, 1
    s_and_b32 s94, s94, 31
    v_mul_f32 v4, v197, v96
    v_mul_f32 v5, v197, v97
    v_mul_f32 v6, v197, v98
    buffer_load_dwordx4 v212, s[16:19], s59 offen offset:2048 lds
    v_mul_f32 v7, v197, v99
    v_mul_f32 v8, v198, v96
    buffer_load_dwordx4 v213, s[16:19], s59 offen offset:3072 lds
    v_mul_f32 v9, v198, v97
    v_mul_f32 v10, v198, v98
    v_mul_f32 v11, v198, v99
    s_add_u32 m0, s67, 69632
    s_add_u32 s60, s59, 114688
    buffer_load_dwordx4 v210, s[16:19], s60 offen lds
    v_mul_f32 v12, v199, v96
    v_mul_f32 v13, v199, v97
    buffer_load_dwordx4 v211, s[16:19], s60 offen offset:1024 lds
    v_mul_f32 v14, v199, v98
    v_mul_f32 v15, v199, v99
    v_mul_f32 v16, v196, v100
    buffer_load_dwordx4 v212, s[16:19], s60 offen offset:2048 lds
    v_mul_f32 v17, v196, v101
    v_mul_f32 v18, v196, v102
    buffer_load_dwordx4 v213, s[16:19], s60 offen offset:3072 lds
    v_mul_f32 v19, v196, v103
    v_mul_f32 v20, v197, v100
    v_mul_f32 v21, v197, v101
    s_waitcnt vmcnt(32) lgkmcnt(0)
    s_barrier
    s_mul_i32 s59, s94, 229376
    s_add_u32 m0, s67, 81920
    s_add_u32 s59, s59, s62
    buffer_load_dwordx4 v210, s[16:19], s59 offen lds
    v_mul_f32 v22, v197, v102
    v_mul_f32 v23, v197, v103
    buffer_load_dwordx4 v211, s[16:19], s59 offen offset:1024 lds
    s_add_u32 s94, s94, 1
    s_and_b32 s94, s94, 31
    v_mul_f32 v24, v198, v100
    v_mul_f32 v25, v198, v101
    v_mul_f32 v26, v198, v102
    buffer_load_dwordx4 v212, s[16:19], s59 offen offset:2048 lds
    v_mul_f32 v27, v198, v103
    v_mul_f32 v28, v199, v100
    buffer_load_dwordx4 v213, s[16:19], s59 offen offset:3072 lds
    v_mul_f32 v29, v199, v101
    v_mul_f32 v30, v199, v102
    v_mul_f32 v31, v199, v103
    s_add_u32 m0, s67, 86016
    s_add_u32 s60, s59, 114688
    buffer_load_dwordx4 v210, s[16:19], s60 offen lds
    v_mul_f32 v32, v196, v104
    v_mul_f32 v33, v196, v105
    buffer_load_dwordx4 v211, s[16:19], s60 offen offset:1024 lds
    v_mul_f32 v34, v196, v106
    v_mul_f32 v35, v196, v107
    v_mul_f32 v36, v197, v104
    buffer_load_dwordx4 v212, s[16:19], s60 offen offset:2048 lds
    v_mul_f32 v37, v197, v105
    v_mul_f32 v38, v197, v106
    buffer_load_dwordx4 v213, s[16:19], s60 offen offset:3072 lds
    v_mul_f32 v39, v197, v107
    v_mul_f32 v40, v198, v104
    v_mul_f32 v41, v198, v105
    s_waitcnt vmcnt(32) lgkmcnt(0)
    s_barrier
    s_add_u32 m0, s61, 0
    s_add_u32 s59, s63, 0
    buffer_load_dwordx4 v214, s[16:19], s59 offen lds
    v_mul_f32 v42, v198, v106
    v_mul_f32 v43, v198, v107
    v_mul_f32 v44, v199, v104
    buffer_load_dwordx4 v215, s[16:19], s59 offen offset:1024 lds
    v_mul_f32 v45, v199, v105
    v_mul_f32 v46, v199, v106
    v_mul_f32 v47, v199, v107
    buffer_load_dwordx4 v216, s[16:19], s59 offen offset:2048 lds
    v_mul_f32 v48, v196, v108
    v_mul_f32 v49, v196, v109
    v_mul_f32 v50, v196, v110
    v_mul_f32 v51, v196, v111
    s_add_u32 m0, s61, 3072
    s_add_u32 s60, s63, 114688
    buffer_load_dwordx4 v214, s[16:19], s60 offen lds
    v_mul_f32 v52, v197, v108
    v_mul_f32 v53, v197, v109
    v_mul_f32 v54, v197, v110
    buffer_load_dwordx4 v215, s[16:19], s60 offen offset:1024 lds
    v_mul_f32 v55, v197, v111
    v_mul_f32 v56, v198, v108
    v_mul_f32 v57, v198, v109
    buffer_load_dwordx4 v216, s[16:19], s60 offen offset:2048 lds
    v_mul_f32 v58, v198, v110
    v_mul_f32 v59, v198, v111
    v_mul_f32 v60, v199, v108
    v_mul_f32 v61, v199, v109
    s_waitcnt vmcnt(30) lgkmcnt(0)
    s_barrier
    s_add_u32 m0, s61, 16384
    s_add_u32 s59, s63, 229376
    buffer_load_dwordx4 v214, s[16:19], s59 offen lds
    v_mul_f32 v62, v199, v110
    v_mul_f32 v63, v199, v111
    v_mul_f32 v64, v196, v112
    buffer_load_dwordx4 v215, s[16:19], s59 offen offset:1024 lds
    v_mul_f32 v65, v196, v113
    v_mul_f32 v66, v196, v114
    v_mul_f32 v67, v196, v115
    buffer_load_dwordx4 v216, s[16:19], s59 offen offset:2048 lds
    v_mul_f32 v68, v197, v112
    v_mul_f32 v69, v197, v113
    v_mul_f32 v70, v197, v114
    v_mul_f32 v71, v197, v115
    s_add_u32 m0, s61, 19456
    s_add_u32 s60, s63, 344064
    buffer_load_dwordx4 v214, s[16:19], s60 offen lds
    v_mul_f32 v72, v198, v112
    v_mul_f32 v73, v198, v113
    v_mul_f32 v74, v198, v114
    buffer_load_dwordx4 v215, s[16:19], s60 offen offset:1024 lds
    v_mul_f32 v75, v198, v115
    v_mul_f32 v76, v199, v112
    v_mul_f32 v77, v199, v113
    buffer_load_dwordx4 v216, s[16:19], s60 offen offset:2048 lds
    v_mul_f32 v78, v199, v114
    v_mul_f32 v79, v199, v115
    v_mul_f32 v80, v196, v116
    v_mul_f32 v81, v196, v117
    s_waitcnt vmcnt(28) lgkmcnt(0)
    s_barrier
    s_add_u32 m0, s61, 32768
    s_add_u32 s59, s63, 458752
    buffer_load_dwordx4 v214, s[16:19], s59 offen lds
    v_mul_f32 v82, v196, v118
    v_mul_f32 v83, v196, v119
    v_mul_f32 v84, v197, v116
    buffer_load_dwordx4 v215, s[16:19], s59 offen offset:1024 lds
    v_mul_f32 v85, v197, v117
    v_mul_f32 v86, v197, v118
    v_mul_f32 v87, v197, v119
    buffer_load_dwordx4 v216, s[16:19], s59 offen offset:2048 lds
    v_mul_f32 v88, v198, v116
    v_mul_f32 v89, v198, v117
    v_mul_f32 v90, v198, v118
    s_add_u32 m0, s61, 35840
    s_add_u32 s60, s63, 573440
    buffer_load_dwordx4 v214, s[16:19], s60 offen lds
    v_mul_f32 v91, v198, v119
    v_mul_f32 v92, v199, v116
    v_mul_f32 v93, v199, v117
    buffer_load_dwordx4 v215, s[16:19], s60 offen offset:1024 lds
    v_mul_f32 v94, v199, v118
    v_mul_f32 v95, v199, v119
    s_lshl_b32 s55, s43, 13
    s_add_u32 s55, s55, 98304
    v_add_u32 v176, s55, v254
    buffer_load_dwordx4 v216, s[16:19], s60 offen offset:2048 lds
    v_lshrrev_b32 v224, 6, v254
    v_mul_u32_u24 v224, 192, v224
    v_and_b32 v225, 0x30, v254
    v_lshrrev_b32 v225, 1, v225
    s_waitcnt vmcnt(26) lgkmcnt(0)
    s_barrier
    s_add_u32 m0, s61, 49152
    s_add_u32 s59, s63, 688128
    buffer_load_dwordx4 v214, s[16:19], s59 offen lds
    v_add_u32 v224, v224, v225
    v_lshrrev_b32 v225, 8, v254
    buffer_load_dwordx4 v215, s[16:19], s59 offen offset:1024 lds
    v_and_b32 v225, 1, v225
    s_lshl_b32 s55, s44, 2
    v_xor_b32 v226, s55, v225
    buffer_load_dwordx4 v216, s[16:19], s59 offen offset:2048 lds
    v_lshl_add_u32 v177, v226, 5, v224
    v_xor_b32 v226, 1, v226
    s_add_u32 m0, s61, 52224
    s_add_u32 s60, s63, 802816
    buffer_load_dwordx4 v214, s[16:19], s60 offen lds
    v_lshl_add_u32 v178, v226, 5, v224
    s_add_u32 s55, s44, 2
    v_xor_b32 v226, s55, v225
    buffer_load_dwordx4 v215, s[16:19], s60 offen offset:1024 lds
    v_lshl_add_u32 v179, v226, 5, v224
    v_add_u32 v180, 49152, v177
    buffer_load_dwordx4 v216, s[16:19], s60 offen offset:2048 lds
    v_add_u32 v181, 49152, v178
    v_add_u32 v182, 49152, v179
    s_waitcnt vmcnt(24) lgkmcnt(0)
    s_barrier
    s_add_u32 m0, s61, 65536
    s_add_u32 s59, s63, 917504
    buffer_load_dwordx4 v214, s[16:19], s59 offen lds
    buffer_load_dwordx4 v215, s[16:19], s59 offen offset:1024 lds
    buffer_load_dwordx4 v216, s[16:19], s59 offen offset:2048 lds
    s_add_u32 m0, s61, 68608
    s_add_u32 s60, s63, 1032192
    buffer_load_dwordx4 v214, s[16:19], s60 offen lds
    buffer_load_dwordx4 v215, s[16:19], s60 offen offset:1024 lds
    buffer_load_dwordx4 v216, s[16:19], s60 offen offset:2048 lds
    s_waitcnt vmcnt(24) lgkmcnt(0)
    s_barrier
    s_add_u32 m0, s61, 81920
    s_add_u32 s59, s63, 1146880
    buffer_load_dwordx4 v214, s[16:19], s59 offen lds
    buffer_load_dwordx4 v215, s[16:19], s59 offen offset:1024 lds
    buffer_load_dwordx4 v216, s[16:19], s59 offen offset:2048 lds
    s_add_u32 m0, s61, 84992
    s_add_u32 s60, s63, 1261568
    buffer_load_dwordx4 v214, s[16:19], s60 offen lds
    buffer_load_dwordx4 v215, s[16:19], s60 offen offset:1024 lds
    buffer_load_dwordx4 v216, s[16:19], s60 offen offset:2048 lds
    s_setprio 0
Y_g3b:
    ds_read_b64_tr_b16 v[128:129], v177 offset:0
    ds_read_b64_tr_b16 v[130:131], v177 offset:3072
    ds_read_b128 v[96:99], v176 offset:16384
    ds_read_b128 v[100:103], v176 offset:18432
    ds_read_b128 v[104:107], v176 offset:20480
    ds_read_b128 v[108:111], v176 offset:22528
    ds_read_b64_tr_b16 v[140:141], v177 offset:6144
    ds_read_b64_tr_b16 v[142:143], v177 offset:9216
    ds_read_b64_tr_b16 v[132:133], v178 offset:0
    ds_read_b64_tr_b16 v[134:135], v178 offset:3072
    ds_read_b64_tr_b16 v[144:145], v178 offset:6144
    ds_read_b64_tr_b16 v[146:147], v178 offset:9216
    ds_read_b64_tr_b16 v[136:137], v179 offset:0
    ds_read_b64_tr_b16 v[138:139], v179 offset:3072
    ds_read_b64_tr_b16 v[148:149], v179 offset:6144
    ds_read_b64_tr_b16 v[150:151], v179 offset:9216
    s_lshr_b32 s55, s41, 3
    s_mul_i32 s55, s55, 458752
    s_add_u32 s55, s55, s50
    s_lshl_b32 s56, s43, 13
    s_add_u32 s55, s55, s56
    s_and_b32 s56, s41, 7
    s_add_u32 s56, s56, 16
    s_lshl_b32 s56, s56, 14
    s_add_u32 s64, s55, s56
    s_lshl_b32 s56, s44, 10
    s_add_u32 s64, s64, s56
    s_and_b32 s56, s41, 6
    s_add_u32 s56, s56, 48
    s_lshl_b32 s56, s56, 13
    s_add_u32 s65, s55, s56
    s_and_b32 s56, s41, 1
    s_lshl_b32 s56, s56, 10
    s_add_u32 s65, s65, s56
    s_mov_b32 s58, 5
    .p2align 3
loop_68:
    s_waitcnt vmcnt(24) lgkmcnt(0)
    s_barrier
    .p2align 3
    v_mfma_f32_16x16x32_bf16 v[0:3], v[128:131], v[96:99], v[0:3]
    ds_read_b64_tr_b16 v[152:153], v177 offset:16384
    v_mfma_f32_16x16x32_bf16 v[4:7], v[128:131], v[100:103], v[4:7]
    ds_read_b64_tr_b16 v[154:155], v177 offset:19456
    v_mfma_f32_16x16x32_bf16 v[8:11], v[128:131], v[104:107], v[8:11]
    ds_read_b128 v[112:115], v176 offset:17408
    v_mfma_f32_16x16x32_bf16 v[12:15], v[128:131], v[108:111], v[12:15]
    ds_read_b128 v[116:119], v176 offset:19456
    v_mfma_f32_16x16x32_bf16 v[48:51], v[140:143], v[96:99], v[48:51]
    ds_read_b128 v[120:123], v176 offset:21504
    v_mfma_f32_16x16x32_bf16 v[52:55], v[140:143], v[100:103], v[52:55]
    ds_read_b128 v[124:127], v176 offset:23552
    v_mfma_f32_16x16x32_bf16 v[56:59], v[140:143], v[104:107], v[56:59]
    ds_read_b64_tr_b16 v[164:165], v177 offset:22528
    v_mfma_f32_16x16x32_bf16 v[60:63], v[140:143], v[108:111], v[60:63]
    ds_read_b64_tr_b16 v[166:167], v177 offset:25600
    v_mfma_f32_16x16x32_bf16 v[16:19], v[132:135], v[96:99], v[16:19]
    v_mfma_f32_16x16x32_bf16 v[20:23], v[132:135], v[100:103], v[20:23]
    ds_read_b64_tr_b16 v[156:157], v178 offset:16384
    v_mfma_f32_16x16x32_bf16 v[24:27], v[132:135], v[104:107], v[24:27]
    ds_read_b64_tr_b16 v[158:159], v178 offset:19456
    v_mfma_f32_16x16x32_bf16 v[28:31], v[132:135], v[108:111], v[28:31]
    ds_read_b64_tr_b16 v[168:169], v178 offset:22528
    v_mfma_f32_16x16x32_bf16 v[64:67], v[144:147], v[96:99], v[64:67]
    ds_read_b64_tr_b16 v[170:171], v178 offset:25600
    v_mfma_f32_16x16x32_bf16 v[68:71], v[144:147], v[100:103], v[68:71]
    ds_read_b64_tr_b16 v[160:161], v179 offset:16384
    v_mfma_f32_16x16x32_bf16 v[72:75], v[144:147], v[104:107], v[72:75]
    ds_read_b64_tr_b16 v[162:163], v179 offset:19456
    v_mfma_f32_16x16x32_bf16 v[76:79], v[144:147], v[108:111], v[76:79]
    ds_read_b64_tr_b16 v[172:173], v179 offset:22528
    v_mfma_f32_16x16x32_bf16 v[32:35], v[136:139], v[96:99], v[32:35]
    ds_read_b64_tr_b16 v[174:175], v179 offset:25600
    v_mfma_f32_16x16x32_bf16 v[36:39], v[136:139], v[100:103], v[36:39]
    v_mfma_f32_16x16x32_bf16 v[40:43], v[136:139], v[104:107], v[40:43]
    v_mfma_f32_16x16x32_bf16 v[44:47], v[136:139], v[108:111], v[44:47]
    v_mfma_f32_16x16x32_bf16 v[80:83], v[148:151], v[96:99], v[80:83]
    v_mfma_f32_16x16x32_bf16 v[84:87], v[148:151], v[100:103], v[84:87]
    v_mfma_f32_16x16x32_bf16 v[88:91], v[148:151], v[104:107], v[88:91]
    v_mfma_f32_16x16x32_bf16 v[92:95], v[148:151], v[108:111], v[92:95]
    s_waitcnt vmcnt(18) lgkmcnt(0)
    s_barrier
    .p2align 3
    v_mfma_f32_16x16x32_bf16 v[0:3], v[152:155], v[112:115], v[0:3]
    ds_read_b64_tr_b16 v[128:129], v177 offset:32768
    v_mfma_f32_16x16x32_bf16 v[4:7], v[152:155], v[116:119], v[4:7]
    ds_read_b64_tr_b16 v[130:131], v177 offset:35840
    v_mfma_f32_16x16x32_bf16 v[8:11], v[152:155], v[120:123], v[8:11]
    ds_read_b128 v[96:99], v176 offset:32768
    v_mfma_f32_16x16x32_bf16 v[12:15], v[152:155], v[124:127], v[12:15]
    ds_read_b128 v[100:103], v176 offset:34816
    v_mfma_f32_16x16x32_bf16 v[48:51], v[164:167], v[112:115], v[48:51]
    ds_read_b128 v[104:107], v176 offset:36864
    v_mfma_f32_16x16x32_bf16 v[52:55], v[164:167], v[116:119], v[52:55]
    ds_read_b128 v[108:111], v176 offset:38912
    v_mfma_f32_16x16x32_bf16 v[56:59], v[164:167], v[120:123], v[56:59]
    ds_read_b64_tr_b16 v[140:141], v177 offset:38912
    v_mfma_f32_16x16x32_bf16 v[60:63], v[164:167], v[124:127], v[60:63]
    ds_read_b64_tr_b16 v[142:143], v177 offset:41984
    v_mfma_f32_16x16x32_bf16 v[16:19], v[156:159], v[112:115], v[16:19]
    v_mfma_f32_16x16x32_bf16 v[20:23], v[156:159], v[116:119], v[20:23]
    ds_read_b64_tr_b16 v[132:133], v178 offset:32768
    v_mfma_f32_16x16x32_bf16 v[24:27], v[156:159], v[120:123], v[24:27]
    ds_read_b64_tr_b16 v[134:135], v178 offset:35840
    v_mfma_f32_16x16x32_bf16 v[28:31], v[156:159], v[124:127], v[28:31]
    ds_read_b64_tr_b16 v[144:145], v178 offset:38912
    v_mfma_f32_16x16x32_bf16 v[64:67], v[168:171], v[112:115], v[64:67]
    ds_read_b64_tr_b16 v[146:147], v178 offset:41984
    v_mfma_f32_16x16x32_bf16 v[68:71], v[168:171], v[116:119], v[68:71]
    ds_read_b64_tr_b16 v[136:137], v179 offset:32768
    v_mfma_f32_16x16x32_bf16 v[72:75], v[168:171], v[120:123], v[72:75]
    ds_read_b64_tr_b16 v[138:139], v179 offset:35840
    v_mfma_f32_16x16x32_bf16 v[76:79], v[168:171], v[124:127], v[76:79]
    ds_read_b64_tr_b16 v[148:149], v179 offset:38912
    v_mfma_f32_16x16x32_bf16 v[32:35], v[160:163], v[112:115], v[32:35]
    ds_read_b64_tr_b16 v[150:151], v179 offset:41984
    v_mfma_f32_16x16x32_bf16 v[36:39], v[160:163], v[116:119], v[36:39]
    v_mfma_f32_16x16x32_bf16 v[40:43], v[160:163], v[120:123], v[40:43]
    v_mfma_f32_16x16x32_bf16 v[44:47], v[160:163], v[124:127], v[44:47]
    v_mfma_f32_16x16x32_bf16 v[80:83], v[172:175], v[112:115], v[80:83]
    v_mfma_f32_16x16x32_bf16 v[84:87], v[172:175], v[116:119], v[84:87]
    v_mfma_f32_16x16x32_bf16 v[88:91], v[172:175], v[120:123], v[88:91]
    v_mfma_f32_16x16x32_bf16 v[92:95], v[172:175], v[124:127], v[92:95]
    s_waitcnt vmcnt(12) lgkmcnt(0)
    s_barrier
    .p2align 3
    v_mfma_f32_16x16x32_bf16 v[0:3], v[128:131], v[96:99], v[0:3]
    ds_read_b64_tr_b16 v[152:153], v180 offset:0
    v_mfma_f32_16x16x32_bf16 v[4:7], v[128:131], v[100:103], v[4:7]
    ds_read_b64_tr_b16 v[154:155], v180 offset:3072
    v_mfma_f32_16x16x32_bf16 v[8:11], v[128:131], v[104:107], v[8:11]
    ds_read_b128 v[112:115], v176 offset:33792
    v_mfma_f32_16x16x32_bf16 v[12:15], v[128:131], v[108:111], v[12:15]
    ds_read_b128 v[116:119], v176 offset:35840
    v_mfma_f32_16x16x32_bf16 v[48:51], v[140:143], v[96:99], v[48:51]
    ds_read_b128 v[120:123], v176 offset:37888
    v_mfma_f32_16x16x32_bf16 v[52:55], v[140:143], v[100:103], v[52:55]
    ds_read_b128 v[124:127], v176 offset:39936
    v_mfma_f32_16x16x32_bf16 v[56:59], v[140:143], v[104:107], v[56:59]
    ds_read_b64_tr_b16 v[164:165], v180 offset:6144
    v_mfma_f32_16x16x32_bf16 v[60:63], v[140:143], v[108:111], v[60:63]
    ds_read_b64_tr_b16 v[166:167], v180 offset:9216
    v_mfma_f32_16x16x32_bf16 v[16:19], v[132:135], v[96:99], v[16:19]
    v_mfma_f32_16x16x32_bf16 v[20:23], v[132:135], v[100:103], v[20:23]
    ds_read_b64_tr_b16 v[156:157], v181 offset:0
    v_mfma_f32_16x16x32_bf16 v[24:27], v[132:135], v[104:107], v[24:27]
    ds_read_b64_tr_b16 v[158:159], v181 offset:3072
    v_mfma_f32_16x16x32_bf16 v[28:31], v[132:135], v[108:111], v[28:31]
    ds_read_b64_tr_b16 v[168:169], v181 offset:6144
    v_mfma_f32_16x16x32_bf16 v[64:67], v[144:147], v[96:99], v[64:67]
    ds_read_b64_tr_b16 v[170:171], v181 offset:9216
    v_mfma_f32_16x16x32_bf16 v[68:71], v[144:147], v[100:103], v[68:71]
    ds_read_b64_tr_b16 v[160:161], v182 offset:0
    v_mfma_f32_16x16x32_bf16 v[72:75], v[144:147], v[104:107], v[72:75]
    ds_read_b64_tr_b16 v[162:163], v182 offset:3072
    v_mfma_f32_16x16x32_bf16 v[76:79], v[144:147], v[108:111], v[76:79]
    ds_read_b64_tr_b16 v[172:173], v182 offset:6144
    v_mfma_f32_16x16x32_bf16 v[32:35], v[136:139], v[96:99], v[32:35]
    ds_read_b64_tr_b16 v[174:175], v182 offset:9216
    v_mfma_f32_16x16x32_bf16 v[36:39], v[136:139], v[100:103], v[36:39]
    v_mfma_f32_16x16x32_bf16 v[40:43], v[136:139], v[104:107], v[40:43]
    v_mfma_f32_16x16x32_bf16 v[44:47], v[136:139], v[108:111], v[44:47]
    v_mfma_f32_16x16x32_bf16 v[80:83], v[148:151], v[96:99], v[80:83]
    v_mfma_f32_16x16x32_bf16 v[84:87], v[148:151], v[100:103], v[84:87]
    v_mfma_f32_16x16x32_bf16 v[88:91], v[148:151], v[104:107], v[88:91]
    v_mfma_f32_16x16x32_bf16 v[92:95], v[148:151], v[108:111], v[92:95]
    s_waitcnt vmcnt(6) lgkmcnt(0)
    s_barrier
    .p2align 3
    v_mfma_f32_16x16x32_bf16 v[0:3], v[152:155], v[112:115], v[0:3]
    ds_read_b64_tr_b16 v[128:129], v180 offset:16384
    v_mfma_f32_16x16x32_bf16 v[4:7], v[152:155], v[116:119], v[4:7]
    ds_read_b64_tr_b16 v[130:131], v180 offset:19456
    v_mfma_f32_16x16x32_bf16 v[8:11], v[152:155], v[120:123], v[8:11]
    ds_read_b128 v[96:99], v176 offset:0
    v_mfma_f32_16x16x32_bf16 v[12:15], v[152:155], v[124:127], v[12:15]
    ds_read_b128 v[100:103], v176 offset:2048
    v_mfma_f32_16x16x32_bf16 v[48:51], v[164:167], v[112:115], v[48:51]
    ds_read_b128 v[104:107], v176 offset:4096
    v_mfma_f32_16x16x32_bf16 v[52:55], v[164:167], v[116:119], v[52:55]
    ds_read_b128 v[108:111], v176 offset:6144
    v_mfma_f32_16x16x32_bf16 v[56:59], v[164:167], v[120:123], v[56:59]
    ds_read_b64_tr_b16 v[140:141], v180 offset:22528
    v_mfma_f32_16x16x32_bf16 v[60:63], v[164:167], v[124:127], v[60:63]
    ds_read_b64_tr_b16 v[142:143], v180 offset:25600
    v_mfma_f32_16x16x32_bf16 v[16:19], v[156:159], v[112:115], v[16:19]
    v_mfma_f32_16x16x32_bf16 v[20:23], v[156:159], v[116:119], v[20:23]
    ds_read_b64_tr_b16 v[132:133], v181 offset:16384
    v_mfma_f32_16x16x32_bf16 v[24:27], v[156:159], v[120:123], v[24:27]
    ds_read_b64_tr_b16 v[134:135], v181 offset:19456
    v_mfma_f32_16x16x32_bf16 v[28:31], v[156:159], v[124:127], v[28:31]
    ds_read_b64_tr_b16 v[144:145], v181 offset:22528
    v_mfma_f32_16x16x32_bf16 v[64:67], v[168:171], v[112:115], v[64:67]
    ds_read_b64_tr_b16 v[146:147], v181 offset:25600
    v_mfma_f32_16x16x32_bf16 v[68:71], v[168:171], v[116:119], v[68:71]
    ds_read_b64_tr_b16 v[136:137], v182 offset:16384
    v_mfma_f32_16x16x32_bf16 v[72:75], v[168:171], v[120:123], v[72:75]
    ds_read_b64_tr_b16 v[138:139], v182 offset:19456
    v_mfma_f32_16x16x32_bf16 v[76:79], v[168:171], v[124:127], v[76:79]
    ds_read_b64_tr_b16 v[148:149], v182 offset:22528
    v_mfma_f32_16x16x32_bf16 v[32:35], v[160:163], v[112:115], v[32:35]
    ds_read_b64_tr_b16 v[150:151], v182 offset:25600
    v_mfma_f32_16x16x32_bf16 v[36:39], v[160:163], v[116:119], v[36:39]
    v_mfma_f32_16x16x32_bf16 v[40:43], v[160:163], v[120:123], v[40:43]
    v_mfma_f32_16x16x32_bf16 v[44:47], v[160:163], v[124:127], v[44:47]
    v_mfma_f32_16x16x32_bf16 v[80:83], v[172:175], v[112:115], v[80:83]
    v_mfma_f32_16x16x32_bf16 v[84:87], v[172:175], v[116:119], v[84:87]
    v_mfma_f32_16x16x32_bf16 v[88:91], v[172:175], v[120:123], v[88:91]
    v_mfma_f32_16x16x32_bf16 v[92:95], v[172:175], v[124:127], v[92:95]
    s_waitcnt vmcnt(0) lgkmcnt(0)
    s_barrier
    .p2align 3
    v_mfma_f32_16x16x32_bf16 v[0:3], v[128:131], v[96:99], v[0:3]
    ds_read_b64_tr_b16 v[152:153], v180 offset:32768
    v_mfma_f32_16x16x32_bf16 v[4:7], v[128:131], v[100:103], v[4:7]
    ds_read_b64_tr_b16 v[154:155], v180 offset:35840
    v_mfma_f32_16x16x32_bf16 v[8:11], v[128:131], v[104:107], v[8:11]
    ds_read_b128 v[112:115], v176 offset:1024
    v_mfma_f32_16x16x32_bf16 v[12:15], v[128:131], v[108:111], v[12:15]
    ds_read_b128 v[116:119], v176 offset:3072
    v_mfma_f32_16x16x32_bf16 v[48:51], v[140:143], v[96:99], v[48:51]
    ds_read_b128 v[120:123], v176 offset:5120
    v_mfma_f32_16x16x32_bf16 v[52:55], v[140:143], v[100:103], v[52:55]
    ds_read_b128 v[124:127], v176 offset:7168
    v_mfma_f32_16x16x32_bf16 v[56:59], v[140:143], v[104:107], v[56:59]
    ds_read_b64_tr_b16 v[164:165], v180 offset:38912
    v_mfma_f32_16x16x32_bf16 v[60:63], v[140:143], v[108:111], v[60:63]
    ds_read_b64_tr_b16 v[166:167], v180 offset:41984
    v_mfma_f32_16x16x32_bf16 v[16:19], v[132:135], v[96:99], v[16:19]
    v_mfma_f32_16x16x32_bf16 v[20:23], v[132:135], v[100:103], v[20:23]
    ds_read_b64_tr_b16 v[156:157], v181 offset:32768
    v_mfma_f32_16x16x32_bf16 v[24:27], v[132:135], v[104:107], v[24:27]
    ds_read_b64_tr_b16 v[158:159], v181 offset:35840
    v_mfma_f32_16x16x32_bf16 v[28:31], v[132:135], v[108:111], v[28:31]
    ds_read_b64_tr_b16 v[168:169], v181 offset:38912
    v_mfma_f32_16x16x32_bf16 v[64:67], v[144:147], v[96:99], v[64:67]
    ds_read_b64_tr_b16 v[170:171], v181 offset:41984
    v_mfma_f32_16x16x32_bf16 v[68:71], v[144:147], v[100:103], v[68:71]
    ds_read_b64_tr_b16 v[160:161], v182 offset:32768
    v_mfma_f32_16x16x32_bf16 v[72:75], v[144:147], v[104:107], v[72:75]
    ds_read_b64_tr_b16 v[162:163], v182 offset:35840
    v_mfma_f32_16x16x32_bf16 v[76:79], v[144:147], v[108:111], v[76:79]
    ds_read_b64_tr_b16 v[172:173], v182 offset:38912
    v_mfma_f32_16x16x32_bf16 v[32:35], v[136:139], v[96:99], v[32:35]
    ds_read_b64_tr_b16 v[174:175], v182 offset:41984
    v_mfma_f32_16x16x32_bf16 v[36:39], v[136:139], v[100:103], v[36:39]
    v_mfma_f32_16x16x32_bf16 v[40:43], v[136:139], v[104:107], v[40:43]
    v_mfma_f32_16x16x32_bf16 v[44:47], v[136:139], v[108:111], v[44:47]
    v_mfma_f32_16x16x32_bf16 v[80:83], v[148:151], v[96:99], v[80:83]
    v_mfma_f32_16x16x32_bf16 v[84:87], v[148:151], v[100:103], v[84:87]
    v_mfma_f32_16x16x32_bf16 v[88:91], v[148:151], v[104:107], v[88:91]
    v_mfma_f32_16x16x32_bf16 v[92:95], v[148:151], v[108:111], v[92:95]
    s_waitcnt lgkmcnt(0)
    s_barrier
    .p2align 3
    v_mfma_f32_16x16x32_bf16 v[0:3], v[152:155], v[112:115], v[0:3]
    ds_read_b64_tr_b16 v[128:129], v177 offset:0
    v_mfma_f32_16x16x32_bf16 v[4:7], v[152:155], v[116:119], v[4:7]
    ds_read_b64_tr_b16 v[130:131], v177 offset:3072
    v_mfma_f32_16x16x32_bf16 v[8:11], v[152:155], v[120:123], v[8:11]
    ds_read_b128 v[96:99], v176 offset:16384
    v_mfma_f32_16x16x32_bf16 v[12:15], v[152:155], v[124:127], v[12:15]
    ds_read_b128 v[100:103], v176 offset:18432
    v_mfma_f32_16x16x32_bf16 v[48:51], v[164:167], v[112:115], v[48:51]
    ds_read_b128 v[104:107], v176 offset:20480
    v_mfma_f32_16x16x32_bf16 v[52:55], v[164:167], v[116:119], v[52:55]
    ds_read_b128 v[108:111], v176 offset:22528
    v_mfma_f32_16x16x32_bf16 v[56:59], v[164:167], v[120:123], v[56:59]
    ds_read_b64_tr_b16 v[140:141], v177 offset:6144
    v_mfma_f32_16x16x32_bf16 v[60:63], v[164:167], v[124:127], v[60:63]
    ds_read_b64_tr_b16 v[142:143], v177 offset:9216
    v_mfma_f32_16x16x32_bf16 v[16:19], v[156:159], v[112:115], v[16:19]
    v_mfma_f32_16x16x32_bf16 v[20:23], v[156:159], v[116:119], v[20:23]
    ds_read_b64_tr_b16 v[132:133], v178 offset:0
    v_mfma_f32_16x16x32_bf16 v[24:27], v[156:159], v[120:123], v[24:27]
    ds_read_b64_tr_b16 v[134:135], v178 offset:3072
    v_mfma_f32_16x16x32_bf16 v[28:31], v[156:159], v[124:127], v[28:31]
    ds_read_b64_tr_b16 v[144:145], v178 offset:6144
    v_mfma_f32_16x16x32_bf16 v[64:67], v[168:171], v[112:115], v[64:67]
    ds_read_b64_tr_b16 v[146:147], v178 offset:9216
    v_mfma_f32_16x16x32_bf16 v[68:71], v[168:171], v[116:119], v[68:71]
    ds_read_b64_tr_b16 v[136:137], v179 offset:0
    v_mfma_f32_16x16x32_bf16 v[72:75], v[168:171], v[120:123], v[72:75]
    ds_read_b64_tr_b16 v[138:139], v179 offset:3072
    v_mfma_f32_16x16x32_bf16 v[76:79], v[168:171], v[124:127], v[76:79]
    ds_read_b64_tr_b16 v[148:149], v179 offset:6144
    v_mfma_f32_16x16x32_bf16 v[32:35], v[160:163], v[112:115], v[32:35]
    ds_read_b64_tr_b16 v[150:151], v179 offset:9216
    v_mfma_f32_16x16x32_bf16 v[36:39], v[160:163], v[116:119], v[36:39]
    v_mfma_f32_16x16x32_bf16 v[40:43], v[160:163], v[120:123], v[40:43]
    v_mfma_f32_16x16x32_bf16 v[44:47], v[160:163], v[124:127], v[44:47]
    v_mfma_f32_16x16x32_bf16 v[80:83], v[172:175], v[112:115], v[80:83]
    s_sub_u32 s58, s58, 1
    s_cmp_lg_u32 s58, 0
    .p2align 3
    v_mfma_f32_16x16x32_bf16 v[84:87], v[172:175], v[116:119], v[84:87]
    v_mfma_f32_16x16x32_bf16 v[88:91], v[172:175], v[120:123], v[88:91]
    v_mfma_f32_16x16x32_bf16 v[92:95], v[172:175], v[124:127], v[92:95]
    s_cbranch_scc1 loop_68
    s_waitcnt lgkmcnt(0)
    s_barrier
    .p2align 3
    v_mfma_f32_16x16x32_bf16 v[0:3], v[128:131], v[96:99], v[0:3]
    ds_read_b64_tr_b16 v[152:153], v177 offset:16384
    v_mfma_f32_16x16x32_bf16 v[4:7], v[128:131], v[100:103], v[4:7]
    ds_read_b64_tr_b16 v[154:155], v177 offset:19456
    v_mfma_f32_16x16x32_bf16 v[8:11], v[128:131], v[104:107], v[8:11]
    ds_read_b128 v[112:115], v176 offset:17408
    v_mfma_f32_16x16x32_bf16 v[12:15], v[128:131], v[108:111], v[12:15]
    ds_read_b128 v[116:119], v176 offset:19456
    v_mfma_f32_16x16x32_bf16 v[48:51], v[140:143], v[96:99], v[48:51]
    ds_read_b128 v[120:123], v176 offset:21504
    v_mfma_f32_16x16x32_bf16 v[52:55], v[140:143], v[100:103], v[52:55]
    ds_read_b128 v[124:127], v176 offset:23552
    v_mfma_f32_16x16x32_bf16 v[56:59], v[140:143], v[104:107], v[56:59]
    ds_read_b64_tr_b16 v[164:165], v177 offset:22528
    v_mfma_f32_16x16x32_bf16 v[60:63], v[140:143], v[108:111], v[60:63]
    ds_read_b64_tr_b16 v[166:167], v177 offset:25600
    v_mfma_f32_16x16x32_bf16 v[16:19], v[132:135], v[96:99], v[16:19]
    v_mfma_f32_16x16x32_bf16 v[20:23], v[132:135], v[100:103], v[20:23]
    ds_read_b64_tr_b16 v[156:157], v178 offset:16384
    v_mfma_f32_16x16x32_bf16 v[24:27], v[132:135], v[104:107], v[24:27]
    ds_read_b64_tr_b16 v[158:159], v178 offset:19456
    v_mfma_f32_16x16x32_bf16 v[28:31], v[132:135], v[108:111], v[28:31]
    ds_read_b64_tr_b16 v[168:169], v178 offset:22528
    v_mfma_f32_16x16x32_bf16 v[64:67], v[144:147], v[96:99], v[64:67]
    ds_read_b64_tr_b16 v[170:171], v178 offset:25600
    v_mfma_f32_16x16x32_bf16 v[68:71], v[144:147], v[100:103], v[68:71]
    ds_read_b64_tr_b16 v[160:161], v179 offset:16384
    v_mfma_f32_16x16x32_bf16 v[72:75], v[144:147], v[104:107], v[72:75]
    ds_read_b64_tr_b16 v[162:163], v179 offset:19456
    v_mfma_f32_16x16x32_bf16 v[76:79], v[144:147], v[108:111], v[76:79]
    ds_read_b64_tr_b16 v[172:173], v179 offset:22528
    v_mfma_f32_16x16x32_bf16 v[32:35], v[136:139], v[96:99], v[32:35]
    ds_read_b64_tr_b16 v[174:175], v179 offset:25600
    v_mfma_f32_16x16x32_bf16 v[36:39], v[136:139], v[100:103], v[36:39]
    v_mfma_f32_16x16x32_bf16 v[40:43], v[136:139], v[104:107], v[40:43]
    v_mfma_f32_16x16x32_bf16 v[44:47], v[136:139], v[108:111], v[44:47]
    v_mfma_f32_16x16x32_bf16 v[80:83], v[148:151], v[96:99], v[80:83]
    v_mfma_f32_16x16x32_bf16 v[84:87], v[148:151], v[100:103], v[84:87]
    v_mfma_f32_16x16x32_bf16 v[88:91], v[148:151], v[104:107], v[88:91]
    v_mfma_f32_16x16x32_bf16 v[92:95], v[148:151], v[108:111], v[92:95]
    s_waitcnt lgkmcnt(0)
    s_barrier
    .p2align 3
    v_mfma_f32_16x16x32_bf16 v[0:3], v[152:155], v[112:115], v[0:3]
    v_mfma_f32_16x16x32_bf16 v[4:7], v[152:155], v[116:119], v[4:7]
    v_mfma_f32_16x16x32_bf16 v[8:11], v[152:155], v[120:123], v[8:11]
    v_mfma_f32_16x16x32_bf16 v[12:15], v[152:155], v[124:127], v[12:15]
    v_mfma_f32_16x16x32_bf16 v[48:51], v[164:167], v[112:115], v[48:51]
    v_mfma_f32_16x16x32_bf16 v[52:55], v[164:167], v[116:119], v[52:55]
    v_mfma_f32_16x16x32_bf16 v[56:59], v[164:167], v[120:123], v[56:59]
    v_mfma_f32_16x16x32_bf16 v[60:63], v[164:167], v[124:127], v[60:63]
    v_mfma_f32_16x16x32_bf16 v[16:19], v[156:159], v[112:115], v[16:19]
    v_mfma_f32_16x16x32_bf16 v[20:23], v[156:159], v[116:119], v[20:23]
    v_mfma_f32_16x16x32_bf16 v[24:27], v[156:159], v[120:123], v[24:27]
    v_mfma_f32_16x16x32_bf16 v[28:31], v[156:159], v[124:127], v[28:31]
    v_mfma_f32_16x16x32_bf16 v[64:67], v[168:171], v[112:115], v[64:67]
    v_mfma_f32_16x16x32_bf16 v[68:71], v[168:171], v[116:119], v[68:71]
    v_mfma_f32_16x16x32_bf16 v[72:75], v[168:171], v[120:123], v[72:75]
    v_mfma_f32_16x16x32_bf16 v[76:79], v[168:171], v[124:127], v[76:79]
    v_mfma_f32_16x16x32_bf16 v[32:35], v[160:163], v[112:115], v[32:35]
    v_mfma_f32_16x16x32_bf16 v[36:39], v[160:163], v[116:119], v[36:39]
    v_mfma_f32_16x16x32_bf16 v[40:43], v[160:163], v[120:123], v[40:43]
    v_mfma_f32_16x16x32_bf16 v[44:47], v[160:163], v[124:127], v[44:47]
    v_mfma_f32_16x16x32_bf16 v[80:83], v[172:175], v[112:115], v[80:83]
    v_mfma_f32_16x16x32_bf16 v[84:87], v[172:175], v[116:119], v[84:87]
    v_mfma_f32_16x16x32_bf16 v[88:91], v[172:175], v[120:123], v[88:91]
    v_mfma_f32_16x16x32_bf16 v[92:95], v[172:175], v[124:127], v[92:95]
    s_cmp_ge_u32 s42, 2
    s_cbranch_scc1 YW_g4
    s_setprio 1
    s_and_b32 s55, s51, 1
    s_mul_i32 s55, s55, 458752
    s_add_u32 s63, s50, s55
    s_add_u32 s63, s63, s61
    s_and_b32 s66, s51, 1
    s_lshl_b32 s66, s66, 5
    s_add_u32 m0, s61, 114688
    s_add_u32 s59, s63, 32768
    buffer_load_dwordx4 v254, s[4:7], s59 offen lds
    buffer_load_dwordx4 v254, s[4:7], s59 offen offset:1024 lds
    buffer_load_dwordx4 v254, s[4:7], s59 offen offset:2048 lds
    buffer_load_dwordx4 v254, s[4:7], s59 offen offset:3072 lds
    s_add_u32 m0, s61, 118784
    s_add_u32 s60, s63, 36864
    buffer_load_dwordx4 v254, s[4:7], s60 offen lds
    buffer_load_dwordx4 v254, s[4:7], s60 offen offset:1024 lds
    buffer_load_dwordx4 v254, s[4:7], s60 offen offset:2048 lds
    buffer_load_dwordx4 v254, s[4:7], s60 offen offset:3072 lds
    s_nop 7
    v_mul_f32 v96, v184, v0
    v_mul_f32 v97, v184, v1
    v_mul_f32 v98, v184, v2
    v_mul_f32 v99, v184, v3
    v_exp_f32 v96, v96
    v_exp_f32 v97, v97
    v_exp_f32 v98, v98
    v_exp_f32 v99, v99
    v_mul_f32 v0, v0, v48
    v_mul_f32 v1, v1, v49
    v_mul_f32 v2, v2, v50
    v_mul_f32 v3, v3, v51
    s_barrier
    s_add_u32 m0, s61, 131072
    s_add_u32 s59, s63, 49152
    buffer_load_dwordx4 v254, s[4:7], s59 offen lds
    v_fma_f32 v96, v96, v188, v188
    v_fma_f32 v97, v97, v188, v188
    v_fma_f32 v98, v98, v188, v188
    buffer_load_dwordx4 v254, s[4:7], s59 offen offset:1024 lds
    v_fma_f32 v99, v99, v188, v188
    v_rcp_f32 v96, v96
    v_rcp_f32 v97, v97
    buffer_load_dwordx4 v254, s[4:7], s59 offen offset:2048 lds
    v_rcp_f32 v98, v98
    v_rcp_f32 v99, v99
    v_mul_f32 v0, v0, v96
    buffer_load_dwordx4 v254, s[4:7], s59 offen offset:3072 lds
    v_mul_f32 v1, v1, v97
    v_mul_f32 v2, v2, v98
    v_mul_f32 v3, v3, v99
    v_cvt_pk_bf16_f32 v100, v0, v1
    s_add_u32 m0, s61, 135168
    s_add_u32 s60, s63, 53248
    buffer_load_dwordx4 v254, s[4:7], s60 offen lds
    v_cvt_pk_bf16_f32 v101, v2, v3
    v_mul_f32 v96, v184, v16
    v_mul_f32 v97, v184, v17
    buffer_load_dwordx4 v254, s[4:7], s60 offen offset:1024 lds
    v_mul_f32 v98, v184, v18
    v_mul_f32 v99, v184, v19
    v_exp_f32 v96, v96
    buffer_load_dwordx4 v254, s[4:7], s60 offen offset:2048 lds
    v_exp_f32 v97, v97
    v_exp_f32 v98, v98
    v_exp_f32 v99, v99
    buffer_load_dwordx4 v254, s[4:7], s60 offen offset:3072 lds
    v_mul_f32 v16, v16, v64
    v_mul_f32 v17, v17, v65
    v_mul_f32 v18, v18, v66
    v_mul_f32 v19, v19, v67
    s_waitcnt vmcnt(8)
    s_barrier
    s_add_u32 m0, s61, 98304
    s_add_u32 s59, s63, 65536
    buffer_load_dwordx4 v254, s[4:7], s59 offen lds
    v_fma_f32 v96, v96, v188, v188
    v_fma_f32 v97, v97, v188, v188
    buffer_load_dwordx4 v254, s[4:7], s59 offen offset:1024 lds
    v_fma_f32 v98, v98, v188, v188
    v_fma_f32 v99, v99, v188, v188
    v_rcp_f32 v96, v96
    buffer_load_dwordx4 v254, s[4:7], s59 offen offset:2048 lds
    v_rcp_f32 v97, v97
    v_rcp_f32 v98, v98
    v_rcp_f32 v99, v99
    buffer_load_dwordx4 v254, s[4:7], s59 offen offset:3072 lds
    v_mul_f32 v16, v16, v96
    v_mul_f32 v17, v17, v97
    v_mul_f32 v18, v18, v98
    s_add_u32 m0, s61, 102400
    s_add_u32 s60, s63, 69632
    buffer_load_dwordx4 v254, s[4:7], s60 offen lds
    v_mul_f32 v19, v19, v99
    v_cvt_pk_bf16_f32 v102, v16, v17
    v_cvt_pk_bf16_f32 v103, v18, v19
    buffer_load_dwordx4 v254, s[4:7], s60 offen offset:1024 lds
    s_add_u32 s55, s64, 0
    buffer_store_dwordx4 v[100:103], v254, s[4:7], s55 offen sc0 sc1
    v_mul_f32 v96, v185, v4
    v_mul_f32 v97, v185, v5
    buffer_load_dwordx4 v254, s[4:7], s60 offen offset:2048 lds
    v_mul_f32 v98, v185, v6
    v_mul_f32 v99, v185, v7
    v_exp_f32 v96, v96
    buffer_load_dwordx4 v254, s[4:7], s60 offen offset:3072 lds
    v_exp_f32 v97, v97
    v_exp_f32 v98, v98
    v_exp_f32 v99, v99
    s_waitcnt vmcnt(9)
    s_barrier
    s_add_u32 m0, s61, 114688
    s_add_u32 s59, s63, 81920
    buffer_load_dwordx4 v254, s[4:7], s59 offen lds
    v_mul_f32 v4, v4, v52
    v_mul_f32 v5, v5, v53
    v_mul_f32 v6, v6, v54
    buffer_load_dwordx4 v254, s[4:7], s59 offen offset:1024 lds
    v_mul_f32 v7, v7, v55
    v_fma_f32 v96, v96, v189, v189
    v_fma_f32 v97, v97, v189, v189
    buffer_load_dwordx4 v254, s[4:7], s59 offen offset:2048 lds
    v_fma_f32 v98, v98, v189, v189
    v_fma_f32 v99, v99, v189, v189
    v_rcp_f32 v96, v96
    buffer_load_dwordx4 v254, s[4:7], s59 offen offset:3072 lds
    v_rcp_f32 v97, v97
    v_rcp_f32 v98, v98
    v_rcp_f32 v99, v99
    v_mul_f32 v4, v4, v96
    s_add_u32 m0, s61, 118784
    s_add_u32 s60, s63, 86016
    buffer_load_dwordx4 v254, s[4:7], s60 offen lds
    v_mul_f32 v5, v5, v97
    v_mul_f32 v6, v6, v98
    v_mul_f32 v7, v7, v99
    buffer_load_dwordx4 v254, s[4:7], s60 offen offset:1024 lds
    v_cvt_pk_bf16_f32 v104, v4, v5
    v_cvt_pk_bf16_f32 v105, v6, v7
    v_mul_f32 v96, v185, v20
    buffer_load_dwordx4 v254, s[4:7], s60 offen offset:2048 lds
    v_mul_f32 v97, v185, v21
    v_mul_f32 v98, v185, v22
    v_mul_f32 v99, v185, v23
    buffer_load_dwordx4 v254, s[4:7], s60 offen offset:3072 lds
    v_exp_f32 v96, v96
    v_exp_f32 v97, v97
    v_exp_f32 v98, v98
    v_exp_f32 v99, v99
    s_waitcnt vmcnt(8)
    s_barrier
    s_add_u32 m0, s61, 131072
    s_add_u32 s59, s63, 98304
    buffer_load_dwordx4 v254, s[4:7], s59 offen lds
    v_mul_f32 v20, v20, v68
    v_mul_f32 v21, v21, v69
    v_mul_f32 v22, v22, v70
    buffer_load_dwordx4 v254, s[4:7], s59 offen offset:1024 lds
    v_mul_f32 v23, v23, v71
    v_fma_f32 v96, v96, v189, v189
    v_fma_f32 v97, v97, v189, v189
    buffer_load_dwordx4 v254, s[4:7], s59 offen offset:2048 lds
    v_fma_f32 v98, v98, v189, v189
    v_fma_f32 v99, v99, v189, v189
    v_rcp_f32 v96, v96
    buffer_load_dwordx4 v254, s[4:7], s59 offen offset:3072 lds
    v_rcp_f32 v97, v97
    v_rcp_f32 v98, v98
    v_rcp_f32 v99, v99
    s_add_u32 m0, s61, 135168
    s_add_u32 s60, s63, 102400
    buffer_load_dwordx4 v254, s[4:7], s60 offen lds
    v_mul_f32 v20, v20, v96
    v_mul_f32 v21, v21, v97
    v_mul_f32 v22, v22, v98
    buffer_load_dwordx4 v254, s[4:7], s60 offen offset:1024 lds
    v_mul_f32 v23, v23, v99
    v_cvt_pk_bf16_f32 v106, v20, v21
    v_cvt_pk_bf16_f32 v107, v22, v23
    buffer_load_dwordx4 v254, s[4:7], s60 offen offset:2048 lds
    s_add_u32 s55, s64, 2048
    buffer_store_dwordx4 v[104:107], v254, s[4:7], s55 offen sc0 sc1
    v_mul_f32 v96, v186, v8
    v_mul_f32 v97, v186, v9
    buffer_load_dwordx4 v254, s[4:7], s60 offen offset:3072 lds
    v_mul_f32 v98, v186, v10
    v_mul_f32 v99, v186, v11
    v_exp_f32 v96, v96
    v_exp_f32 v97, v97
    s_waitcnt vmcnt(9)
    s_barrier
    v_lshrrev_b32 v252, 2, v254
    v_min_u32 v252, 28, v252
    s_add_u32 s55, s54, 4160
    s_add_u32 s55, s55, s66
    buffer_load_dword v251, v252, s[4:7], s55 offen sc0 sc1
    s_add_u32 m0, s61, 98304
    s_add_u32 s59, s63, 114688
    buffer_load_dwordx4 v254, s[4:7], s59 offen lds
    v_exp_f32 v98, v98
    v_exp_f32 v99, v99
    v_mul_f32 v8, v8, v56
    buffer_load_dwordx4 v254, s[4:7], s59 offen offset:1024 lds
    v_mul_f32 v9, v9, v57
    v_mul_f32 v10, v10, v58
    v_mul_f32 v11, v11, v59
    buffer_load_dwordx4 v254, s[4:7], s59 offen offset:2048 lds
    v_fma_f32 v96, v96, v190, v190
    v_fma_f32 v97, v97, v190, v190
    v_fma_f32 v98, v98, v190, v190
    buffer_load_dwordx4 v254, s[4:7], s59 offen offset:3072 lds
    v_fma_f32 v99, v99, v190, v190
    v_rcp_f32 v96, v96
    v_rcp_f32 v97, v97
    v_rcp_f32 v98, v98
    s_add_u32 m0, s61, 102400
    s_add_u32 s60, s63, 118784
    buffer_load_dwordx4 v254, s[4:7], s60 offen lds
    v_rcp_f32 v99, v99
    v_mul_f32 v8, v8, v96
    v_mul_f32 v9, v9, v97
    buffer_load_dwordx4 v254, s[4:7], s60 offen offset:1024 lds
    v_mul_f32 v10, v10, v98
    v_mul_f32 v11, v11, v99
    v_cvt_pk_bf16_f32 v100, v8, v9
    buffer_load_dwordx4 v254, s[4:7], s60 offen offset:2048 lds
    v_cvt_pk_bf16_f32 v101, v10, v11
    v_mul_f32 v96, v186, v24
    v_mul_f32 v97, v186, v25
    buffer_load_dwordx4 v254, s[4:7], s60 offen offset:3072 lds
    v_mul_f32 v98, v186, v26
    v_mul_f32 v99, v186, v27
    v_exp_f32 v96, v96
    v_exp_f32 v97, v97
    s_waitcnt vmcnt(9)
    s_barrier
    s_waitcnt vmcnt(8)
    v_cmp_ne_u32 vcc, 0x01010101, v251
    s_cbranch_vccz ap_69
    v_lshrrev_b32 v252, 2, v254
    s_add_u32 s55, s54, 4160
    s_add_u32 s55, s55, s66
    s_mov_b32 s56, 262144
    s_mov_b32 s57, 0x01010101
    s_mov_b64 exec, 0xff
poll_70:
    buffer_load_dword v253, v252, s[4:7], s55 offen sc0 sc1
    s_waitcnt vmcnt(0)
    v_cmp_ne_u32 vcc, s57, v253
    s_cbranch_vccz pd_71
    s_sleep 1
    s_sub_u32 s56, s56, 1
    s_cmp_lg_u32 s56, 0
    s_cbranch_scc1 poll_70
pd_71:
    s_mov_b64 exec, -1
ap_69:
    s_add_u32 m0, s61, 114688
    s_add_u32 s59, s63, 131072
    buffer_load_dwordx4 v254, s[4:7], s59 offen lds
    v_exp_f32 v98, v98
    v_exp_f32 v99, v99
    v_mul_f32 v24, v24, v72
    buffer_load_dwordx4 v254, s[4:7], s59 offen offset:1024 lds
    v_mul_f32 v25, v25, v73
    v_mul_f32 v26, v26, v74
    v_mul_f32 v27, v27, v75
    buffer_load_dwordx4 v254, s[4:7], s59 offen offset:2048 lds
    v_fma_f32 v96, v96, v190, v190
    v_fma_f32 v97, v97, v190, v190
    v_fma_f32 v98, v98, v190, v190
    buffer_load_dwordx4 v254, s[4:7], s59 offen offset:3072 lds
    v_fma_f32 v99, v99, v190, v190
    v_rcp_f32 v96, v96
    v_rcp_f32 v97, v97
    s_add_u32 m0, s61, 118784
    s_add_u32 s60, s63, 135168
    buffer_load_dwordx4 v254, s[4:7], s60 offen lds
    v_rcp_f32 v98, v98
    v_rcp_f32 v99, v99
    v_mul_f32 v24, v24, v96
    buffer_load_dwordx4 v254, s[4:7], s60 offen offset:1024 lds
    v_mul_f32 v25, v25, v97
    v_mul_f32 v26, v26, v98
    v_mul_f32 v27, v27, v99
    buffer_load_dwordx4 v254, s[4:7], s60 offen offset:2048 lds
    v_cvt_pk_bf16_f32 v102, v24, v25
    v_cvt_pk_bf16_f32 v103, v26, v27
    s_add_u32 s55, s64, 4096
    buffer_store_dwordx4 v[100:103], v254, s[4:7], s55 offen sc0 sc1
    buffer_load_dwordx4 v254, s[4:7], s60 offen offset:3072 lds
    v_mul_f32 v96, v187, v12
    v_mul_f32 v97, v187, v13
    v_mul_f32 v98, v187, v14
    v_mul_f32 v99, v187, v15
    s_waitcnt vmcnt(9)
    s_barrier
    s_add_u32 m0, s61, 131072
    s_add_u32 s59, s63, 147456
    buffer_load_dwordx4 v254, s[4:7], s59 offen lds
    v_exp_f32 v96, v96
    v_exp_f32 v97, v97
    v_exp_f32 v98, v98
    buffer_load_dwordx4 v254, s[4:7], s59 offen offset:1024 lds
    v_exp_f32 v99, v99
    v_mul_f32 v12, v12, v60
    v_mul_f32 v13, v13, v61
    buffer_load_dwordx4 v254, s[4:7], s59 offen offset:2048 lds
    v_mul_f32 v14, v14, v62
    v_mul_f32 v15, v15, v63
    v_fma_f32 v96, v96, v191, v191
    buffer_load_dwordx4 v254, s[4:7], s59 offen offset:3072 lds
    v_fma_f32 v97, v97, v191, v191
    v_fma_f32 v98, v98, v191, v191
    v_fma_f32 v99, v99, v191, v191
    v_rcp_f32 v96, v96
    s_add_u32 m0, s61, 135168
    s_add_u32 s60, s63, 151552
    buffer_load_dwordx4 v254, s[4:7], s60 offen lds
    v_rcp_f32 v97, v97
    v_rcp_f32 v98, v98
    v_rcp_f32 v99, v99
    buffer_load_dwordx4 v254, s[4:7], s60 offen offset:1024 lds
    v_mul_f32 v12, v12, v96
    v_mul_f32 v13, v13, v97
    v_mul_f32 v14, v14, v98
    buffer_load_dwordx4 v254, s[4:7], s60 offen offset:2048 lds
    v_mul_f32 v15, v15, v99
    v_cvt_pk_bf16_f32 v104, v12, v13
    v_cvt_pk_bf16_f32 v105, v14, v15
    buffer_load_dwordx4 v254, s[4:7], s60 offen offset:3072 lds
    v_mul_f32 v96, v187, v28
    v_mul_f32 v97, v187, v29
    v_mul_f32 v98, v187, v30
    v_mul_f32 v99, v187, v31
    s_waitcnt vmcnt(8)
    s_barrier
    s_add_u32 m0, s61, 98304
    s_add_u32 s59, s63, 163840
    buffer_load_dwordx4 v254, s[4:7], s59 offen lds
    v_exp_f32 v96, v96
    v_exp_f32 v97, v97
    buffer_load_dwordx4 v254, s[4:7], s59 offen offset:1024 lds
    v_exp_f32 v98, v98
    v_exp_f32 v99, v99
    v_mul_f32 v28, v28, v76
    buffer_load_dwordx4 v254, s[4:7], s59 offen offset:2048 lds
    v_mul_f32 v29, v29, v77
    v_mul_f32 v30, v30, v78
    v_mul_f32 v31, v31, v79
    buffer_load_dwordx4 v254, s[4:7], s59 offen offset:3072 lds
    v_fma_f32 v96, v96, v191, v191
    v_fma_f32 v97, v97, v191, v191
    v_fma_f32 v98, v98, v191, v191
    s_add_u32 m0, s61, 102400
    s_add_u32 s60, s63, 167936
    buffer_load_dwordx4 v254, s[4:7], s60 offen lds
    v_fma_f32 v99, v99, v191, v191
    v_rcp_f32 v96, v96
    v_rcp_f32 v97, v97
    buffer_load_dwordx4 v254, s[4:7], s60 offen offset:1024 lds
    v_rcp_f32 v98, v98
    v_rcp_f32 v99, v99
    v_mul_f32 v28, v28, v96
    buffer_load_dwordx4 v254, s[4:7], s60 offen offset:2048 lds
    v_mul_f32 v29, v29, v97
    v_mul_f32 v30, v30, v98
    v_mul_f32 v31, v31, v99
    buffer_load_dwordx4 v254, s[4:7], s60 offen offset:3072 lds
    v_cvt_pk_bf16_f32 v106, v28, v29
    v_cvt_pk_bf16_f32 v107, v30, v31
    s_add_u32 s55, s64, 6144
    buffer_store_dwordx4 v[104:107], v254, s[4:7], s55 offen sc0 sc1
    s_waitcnt vmcnt(9)
    s_barrier
    s_add_u32 m0, s61, 114688
    s_add_u32 s59, s63, 180224
    buffer_load_dwordx4 v254, s[4:7], s59 offen lds
    v_lshrrev_b32 v120, 1, v254
    s_lshl_b32 s55, s43, 11
    s_add_u32 s55, s55, 157632
    v_add_u32 v120, s55, v120
    buffer_load_dwordx4 v254, s[4:7], s59 offen offset:1024 lds
    v_mul_f32 v96, v186, v40
    v_mul_f32 v97, v186, v41
    v_mul_f32 v98, v186, v42
    buffer_load_dwordx4 v254, s[4:7], s59 offen offset:2048 lds
    v_mul_f32 v99, v186, v43
    v_exp_f32 v96, v96
    buffer_load_dwordx4 v254, s[4:7], s59 offen offset:3072 lds
    v_exp_f32 v97, v97
    v_exp_f32 v98, v98
    v_exp_f32 v99, v99
    s_add_u32 m0, s61, 118784
    s_add_u32 s60, s63, 184320
    buffer_load_dwordx4 v254, s[4:7], s60 offen lds
    v_mul_f32 v40, v40, v88
    v_mul_f32 v41, v41, v89
    v_mul_f32 v42, v42, v90
    buffer_load_dwordx4 v254, s[4:7], s60 offen offset:1024 lds
    v_mul_f32 v43, v43, v91
    v_fma_f32 v96, v96, v190, v190
    buffer_load_dwordx4 v254, s[4:7], s60 offen offset:2048 lds
    v_fma_f32 v97, v97, v190, v190
    v_fma_f32 v98, v98, v190, v190
    v_fma_f32 v99, v99, v190, v190
    buffer_load_dwordx4 v254, s[4:7], s60 offen offset:3072 lds
    v_rcp_f32 v96, v96
    v_rcp_f32 v97, v97
    v_rcp_f32 v98, v98
    s_waitcnt vmcnt(9)
    s_barrier
    s_add_u32 m0, s61, 131072
    s_add_u32 s59, s63, 196608
    buffer_load_dwordx4 v254, s[4:7], s59 offen lds
    v_rcp_f32 v99, v99
    v_mul_f32 v40, v40, v96
    v_mul_f32 v41, v41, v97
    buffer_load_dwordx4 v254, s[4:7], s59 offen offset:1024 lds
    v_mul_f32 v42, v42, v98
    v_mul_f32 v43, v43, v99
    v_cvt_pk_bf16_f32 v108, v40, v41
    buffer_load_dwordx4 v254, s[4:7], s59 offen offset:2048 lds
    v_cvt_pk_bf16_f32 v109, v42, v43
    ds_write_b64 v120, v[108:109] offset:1024
    v_mul_f32 v96, v187, v44
    buffer_load_dwordx4 v254, s[4:7], s59 offen offset:3072 lds
    v_mul_f32 v97, v187, v45
    v_mul_f32 v98, v187, v46
    v_mul_f32 v99, v187, v47
    v_exp_f32 v96, v96
    s_add_u32 m0, s61, 135168
    s_add_u32 s60, s63, 200704
    buffer_load_dwordx4 v254, s[4:7], s60 offen lds
    v_exp_f32 v97, v97
    v_exp_f32 v98, v98
    v_exp_f32 v99, v99
    buffer_load_dwordx4 v254, s[4:7], s60 offen offset:1024 lds
    v_mul_f32 v44, v44, v92
    v_mul_f32 v45, v45, v93
    v_mul_f32 v46, v46, v94
    buffer_load_dwordx4 v254, s[4:7], s60 offen offset:2048 lds
    v_mul_f32 v47, v47, v95
    v_fma_f32 v96, v96, v191, v191
    v_fma_f32 v97, v97, v191, v191
    buffer_load_dwordx4 v254, s[4:7], s60 offen offset:3072 lds
    v_fma_f32 v98, v98, v191, v191
    v_fma_f32 v99, v99, v191, v191
    v_rcp_f32 v96, v96
    v_rcp_f32 v97, v97
    s_waitcnt vmcnt(8)
    s_barrier
    s_add_u32 m0, s61, 98304
    s_add_u32 s59, s63, 212992
    buffer_load_dwordx4 v254, s[4:7], s59 offen lds
    v_rcp_f32 v98, v98
    v_rcp_f32 v99, v99
    v_mul_f32 v44, v44, v96
    buffer_load_dwordx4 v254, s[4:7], s59 offen offset:1024 lds
    v_mul_f32 v45, v45, v97
    v_mul_f32 v46, v46, v98
    v_mul_f32 v47, v47, v99
    buffer_load_dwordx4 v254, s[4:7], s59 offen offset:2048 lds
    v_cvt_pk_bf16_f32 v110, v44, v45
    v_cvt_pk_bf16_f32 v111, v46, v47
    ds_write_b64 v120, v[110:111] offset:1536
    buffer_load_dwordx4 v254, s[4:7], s59 offen offset:3072 lds
    s_waitcnt lgkmcnt(0)
    v_mul_f32 v96, v184, v32
    v_mul_f32 v97, v184, v33
    s_add_u32 m0, s61, 102400
    s_add_u32 s60, s63, 217088
    buffer_load_dwordx4 v254, s[4:7], s60 offen lds
    v_mul_f32 v98, v184, v34
    v_mul_f32 v99, v184, v35
    v_exp_f32 v96, v96
    buffer_load_dwordx4 v254, s[4:7], s60 offen offset:1024 lds
    v_exp_f32 v97, v97
    v_exp_f32 v98, v98
    v_exp_f32 v99, v99
    buffer_load_dwordx4 v254, s[4:7], s60 offen offset:2048 lds
    v_mul_f32 v32, v32, v80
    v_mul_f32 v33, v33, v81
    v_mul_f32 v34, v34, v82
    buffer_load_dwordx4 v254, s[4:7], s60 offen offset:3072 lds
    v_mul_f32 v35, v35, v83
    v_fma_f32 v96, v96, v188, v188
    v_fma_f32 v97, v97, v188, v188
    v_fma_f32 v98, v98, v188, v188
    s_waitcnt vmcnt(8)
    s_barrier
    s_lshl_b32 s55, s41, 2
    s_add_u32 s55, s55, s42
    s_add_u32 s55, s55, s54
    s_add_u32 s55, s55, 6144
    v_mov_b32 v252, 0
    v_mov_b32 v253, 1
    s_mov_b64 exec, 1
    s_cmp_eq_u32 s45, 0
    s_cbranch_scc1 st_72
    buffer_store_byte v253, v252, s[4:7], s55 offen sc0 sc1
    s_branch st_73
st_72:
    buffer_store_byte v253, v252, s[4:7], s55 offen
st_73:
    s_mov_b64 exec, -1
    s_add_u32 m0, s61, 114688
    s_add_u32 s59, s63, 229376
    buffer_load_dwordx4 v254, s[4:7], s59 offen lds
    v_fma_f32 v99, v99, v188, v188
    v_rcp_f32 v96, v96
    v_rcp_f32 v97, v97
    buffer_load_dwordx4 v254, s[4:7], s59 offen offset:1024 lds
    v_rcp_f32 v98, v98
    v_rcp_f32 v99, v99
    v_mul_f32 v32, v32, v96
    buffer_load_dwordx4 v254, s[4:7], s59 offen offset:2048 lds
    v_mul_f32 v33, v33, v97
    v_mul_f32 v34, v34, v98
    v_mul_f32 v35, v35, v99
    buffer_load_dwordx4 v254, s[4:7], s59 offen offset:3072 lds
    v_cvt_pk_bf16_f32 v112, v32, v33
    v_cvt_pk_bf16_f32 v113, v34, v35
    v_mul_f32 v96, v185, v36
    v_mul_f32 v97, v185, v37
    s_add_u32 m0, s61, 118784
    s_add_u32 s60, s63, 233472
    buffer_load_dwordx4 v254, s[4:7], s60 offen lds
    v_mul_f32 v98, v185, v38
    v_mul_f32 v99, v185, v39
    v_exp_f32 v96, v96
    buffer_load_dwordx4 v254, s[4:7], s60 offen offset:1024 lds
    v_exp_f32 v97, v97
    v_exp_f32 v98, v98
    v_exp_f32 v99, v99
    buffer_load_dwordx4 v254, s[4:7], s60 offen offset:2048 lds
    v_mul_f32 v36, v36, v84
    v_mul_f32 v37, v37, v85
    v_mul_f32 v38, v38, v86
    buffer_load_dwordx4 v254, s[4:7], s60 offen offset:3072 lds
    v_mul_f32 v39, v39, v87
    v_fma_f32 v96, v96, v189, v189
    v_fma_f32 v97, v97, v189, v189
    v_fma_f32 v98, v98, v189, v189
    s_waitcnt vmcnt(9)
    s_barrier
    v_lshrrev_b32 v252, 2, v254
    v_min_u32 v252, 28, v252
    s_add_u32 s55, s54, 6144
    s_add_u32 s55, s55, s66
    buffer_load_dword v251, v252, s[4:7], s55 offen sc0 sc1
    s_add_u32 m0, s61, 131072
    s_add_u32 s59, s63, 245760
    buffer_load_dwordx4 v254, s[4:7], s59 offen lds
    v_fma_f32 v99, v99, v189, v189
    buffer_load_dwordx4 v254, s[4:7], s59 offen offset:1024 lds
    v_rcp_f32 v96, v96
    buffer_load_dwordx4 v254, s[4:7], s59 offen offset:2048 lds
    v_rcp_f32 v97, v97
    v_rcp_f32 v98, v98
    buffer_load_dwordx4 v254, s[4:7], s59 offen offset:3072 lds
    v_rcp_f32 v99, v99
    s_add_u32 m0, s61, 135168
    s_add_u32 s60, s63, 249856
    buffer_load_dwordx4 v254, s[4:7], s60 offen lds
    v_mul_f32 v36, v36, v96
    buffer_load_dwordx4 v254, s[4:7], s60 offen offset:1024 lds
    v_mul_f32 v37, v37, v97
    v_mul_f32 v38, v38, v98
    buffer_load_dwordx4 v254, s[4:7], s60 offen offset:2048 lds
    v_mul_f32 v39, v39, v99
    buffer_load_dwordx4 v254, s[4:7], s60 offen offset:3072 lds
    v_cvt_pk_bf16_f32 v116, v36, v37
    v_cvt_pk_bf16_f32 v117, v38, v39
    s_waitcnt vmcnt(9)
    s_barrier
    s_waitcnt vmcnt(8)
    v_cmp_ne_u32 vcc, 0x01010101, v251
    s_cbranch_vccz ap_74
    v_lshrrev_b32 v252, 2, v254
    s_add_u32 s55, s54, 6144
    s_add_u32 s55, s55, s66
    s_mov_b32 s56, 262144
    s_mov_b32 s57, 0x01010101
    s_mov_b64 exec, 0xff
poll_75:
    buffer_load_dword v253, v252, s[4:7], s55 offen sc0 sc1
    s_waitcnt vmcnt(0)
    v_cmp_ne_u32 vcc, s57, v253
    s_cbranch_vccz pd_76
    s_sleep 1
    s_sub_u32 s56, s56, 1
    s_cmp_lg_u32 s56, 0
    s_cbranch_scc1 poll_75
pd_76:
    s_mov_b64 exec, -1
ap_74:
    s_add_u32 m0, s61, 98304
    s_add_u32 s59, s63, 262144
    buffer_load_dwordx4 v254, s[4:7], s59 offen lds
    buffer_load_dwordx4 v254, s[4:7], s59 offen offset:1024 lds
    ds_read_b64 v[114:115], v120 offset:0
    buffer_load_dwordx4 v254, s[4:7], s59 offen offset:2048 lds
    buffer_load_dwordx4 v254, s[4:7], s59 offen offset:3072 lds
    ds_read_b64 v[118:119], v120 offset:512
    s_add_u32 m0, s61, 102400
    s_add_u32 s60, s63, 266240
    buffer_load_dwordx4 v254, s[4:7], s60 offen lds
    s_waitcnt lgkmcnt(0)
    buffer_load_dwordx4 v254, s[4:7], s60 offen offset:1024 lds
    buffer_load_dwordx4 v254, s[4:7], s60 offen offset:2048 lds
    s_add_u32 s55, s65, 0
    buffer_store_dwordx4 v[112:115], v254, s[4:7], s55 offen sc0 sc1
    buffer_load_dwordx4 v254, s[4:7], s60 offen offset:3072 lds
    s_add_u32 s55, s65, 2048
    buffer_store_dwordx4 v[116:119], v254, s[4:7], s55 offen sc0 sc1
    s_waitcnt vmcnt(10)
    s_barrier
    s_add_u32 m0, s61, 114688
    s_add_u32 s59, s63, 278528
    buffer_load_dwordx4 v254, s[4:7], s59 offen lds
    buffer_load_dwordx4 v254, s[4:7], s59 offen offset:1024 lds
    buffer_load_dwordx4 v254, s[4:7], s59 offen offset:2048 lds
    buffer_load_dwordx4 v254, s[4:7], s59 offen offset:3072 lds
    s_add_u32 m0, s61, 118784
    s_add_u32 s60, s63, 282624
    buffer_load_dwordx4 v254, s[4:7], s60 offen lds
    buffer_load_dwordx4 v254, s[4:7], s60 offen offset:1024 lds
    buffer_load_dwordx4 v254, s[4:7], s60 offen offset:2048 lds
    buffer_load_dwordx4 v254, s[4:7], s60 offen offset:3072 lds
    s_waitcnt vmcnt(9)
    s_barrier
    s_add_u32 m0, s61, 131072
    s_add_u32 s59, s63, 294912
    buffer_load_dwordx4 v254, s[4:7], s59 offen lds
    buffer_load_dwordx4 v254, s[4:7], s59 offen offset:1024 lds
    buffer_load_dwordx4 v254, s[4:7], s59 offen offset:2048 lds
    buffer_load_dwordx4 v254, s[4:7], s59 offen offset:3072 lds
    s_add_u32 m0, s61, 135168
    s_add_u32 s60, s63, 299008
    buffer_load_dwordx4 v254, s[4:7], s60 offen lds
    buffer_load_dwordx4 v254, s[4:7], s60 offen offset:1024 lds
    buffer_load_dwordx4 v254, s[4:7], s60 offen offset:2048 lds
    buffer_load_dwordx4 v254, s[4:7], s60 offen offset:3072 lds
    s_waitcnt vmcnt(8)
    s_barrier
    s_lshl_b32 s55, s41, 2
    s_add_u32 s55, s55, s42
    s_add_u32 s55, s55, s54
    s_add_u32 s55, s55, 6208
    v_mov_b32 v252, 0
    v_mov_b32 v253, 1
    s_mov_b64 exec, 1
    s_cmp_eq_u32 s45, 0
    s_cbranch_scc1 st_77
    buffer_store_byte v253, v252, s[4:7], s55 offen sc0 sc1
    s_branch st_78
st_77:
    buffer_store_byte v253, v252, s[4:7], s55 offen
st_78:
    s_mov_b64 exec, -1
    s_add_u32 m0, s61, 98304
    s_add_u32 s59, s63, 311296
    buffer_load_dwordx4 v254, s[4:7], s59 offen lds
    buffer_load_dwordx4 v254, s[4:7], s59 offen offset:1024 lds
    buffer_load_dwordx4 v254, s[4:7], s59 offen offset:2048 lds
    buffer_load_dwordx4 v254, s[4:7], s59 offen offset:3072 lds
    s_add_u32 m0, s61, 102400
    s_add_u32 s60, s63, 315392
    buffer_load_dwordx4 v254, s[4:7], s60 offen lds
    buffer_load_dwordx4 v254, s[4:7], s60 offen offset:1024 lds
    buffer_load_dwordx4 v254, s[4:7], s60 offen offset:2048 lds
    buffer_load_dwordx4 v254, s[4:7], s60 offen offset:3072 lds
    s_waitcnt vmcnt(9)
    s_barrier
    s_add_u32 m0, s61, 114688
    s_add_u32 s59, s63, 327680
    buffer_load_dwordx4 v254, s[4:7], s59 offen lds
    buffer_load_dwordx4 v254, s[4:7], s59 offen offset:1024 lds
    buffer_load_dwordx4 v254, s[4:7], s59 offen offset:2048 lds
    buffer_load_dwordx4 v254, s[4:7], s59 offen offset:3072 lds
    s_add_u32 m0, s61, 118784
    s_add_u32 s60, s63, 331776
    buffer_load_dwordx4 v254, s[4:7], s60 offen lds
    buffer_load_dwordx4 v254, s[4:7], s60 offen offset:1024 lds
    buffer_load_dwordx4 v254, s[4:7], s60 offen offset:2048 lds
    buffer_load_dwordx4 v254, s[4:7], s60 offen offset:3072 lds
    s_waitcnt vmcnt(8)
    s_barrier
    s_add_u32 m0, s61, 131072
    s_add_u32 s59, s63, 344064
    buffer_load_dwordx4 v254, s[4:7], s59 offen lds
    buffer_load_dwordx4 v254, s[4:7], s59 offen offset:1024 lds
    buffer_load_dwordx4 v254, s[4:7], s59 offen offset:2048 lds
    buffer_load_dwordx4 v254, s[4:7], s59 offen offset:3072 lds
    s_add_u32 m0, s61, 135168
    s_add_u32 s60, s63, 348160
    buffer_load_dwordx4 v254, s[4:7], s60 offen lds
    buffer_load_dwordx4 v254, s[4:7], s60 offen offset:1024 lds
    buffer_load_dwordx4 v254, s[4:7], s60 offen offset:2048 lds
    buffer_load_dwordx4 v254, s[4:7], s60 offen offset:3072 lds
    s_waitcnt vmcnt(8)
    s_barrier
    s_add_u32 m0, s61, 98304
    s_add_u32 s59, s63, 360448
    buffer_load_dwordx4 v254, s[4:7], s59 offen lds
    buffer_load_dwordx4 v254, s[4:7], s59 offen offset:1024 lds
    buffer_load_dwordx4 v254, s[4:7], s59 offen offset:2048 lds
    buffer_load_dwordx4 v254, s[4:7], s59 offen offset:3072 lds
    s_add_u32 m0, s61, 102400
    s_add_u32 s60, s63, 364544
    buffer_load_dwordx4 v254, s[4:7], s60 offen lds
    buffer_load_dwordx4 v254, s[4:7], s60 offen offset:1024 lds
    buffer_load_dwordx4 v254, s[4:7], s60 offen offset:2048 lds
    buffer_load_dwordx4 v254, s[4:7], s60 offen offset:3072 lds
    s_waitcnt vmcnt(8)
    s_barrier
    v_lshrrev_b32 v252, 2, v254
    v_min_u32 v252, 28, v252
    s_add_u32 s55, s54, 6208
    s_add_u32 s55, s55, s66
    buffer_load_dword v251, v252, s[4:7], s55 offen sc0 sc1
    s_add_u32 m0, s61, 114688
    s_add_u32 s59, s63, 376832
    buffer_load_dwordx4 v254, s[4:7], s59 offen lds
    buffer_load_dwordx4 v254, s[4:7], s59 offen offset:1024 lds
    buffer_load_dwordx4 v254, s[4:7], s59 offen offset:2048 lds
    buffer_load_dwordx4 v254, s[4:7], s59 offen offset:3072 lds
    s_add_u32 m0, s61, 118784
    s_add_u32 s60, s63, 380928
    buffer_load_dwordx4 v254, s[4:7], s60 offen lds
    buffer_load_dwordx4 v254, s[4:7], s60 offen offset:1024 lds
    buffer_load_dwordx4 v254, s[4:7], s60 offen offset:2048 lds
    buffer_load_dwordx4 v254, s[4:7], s60 offen offset:3072 lds
    s_waitcnt vmcnt(9)
    s_barrier
    s_waitcnt vmcnt(8)
    v_cmp_ne_u32 vcc, 0x01010101, v251
    s_cbranch_vccz ap_79
    v_lshrrev_b32 v252, 2, v254
    s_add_u32 s55, s54, 6208
    s_add_u32 s55, s55, s66
    s_mov_b32 s56, 262144
    s_mov_b32 s57, 0x01010101
    s_mov_b64 exec, 0xff
poll_80:
    buffer_load_dword v253, v252, s[4:7], s55 offen sc0 sc1
    s_waitcnt vmcnt(0)
    v_cmp_ne_u32 vcc, s57, v253
    s_cbranch_vccz pd_81
    s_sleep 1
    s_sub_u32 s56, s56, 1
    s_cmp_lg_u32 s56, 0
    s_cbranch_scc1 poll_80
pd_81:
    s_mov_b64 exec, -1
ap_79:
    s_add_u32 m0, s61, 131072
    s_add_u32 s59, s63, 393216
    buffer_load_dwordx4 v254, s[4:7], s59 offen lds
    buffer_load_dwordx4 v254, s[4:7], s59 offen offset:1024 lds
    buffer_load_dwordx4 v254, s[4:7], s59 offen offset:2048 lds
    buffer_load_dwordx4 v254, s[4:7], s59 offen offset:3072 lds
    s_add_u32 m0, s61, 135168
    s_add_u32 s60, s63, 397312
    buffer_load_dwordx4 v254, s[4:7], s60 offen lds
    buffer_load_dwordx4 v254, s[4:7], s60 offen offset:1024 lds
    buffer_load_dwordx4 v254, s[4:7], s60 offen offset:2048 lds
    buffer_load_dwordx4 v254, s[4:7], s60 offen offset:3072 lds
    s_waitcnt vmcnt(8)
    s_barrier
    s_add_u32 m0, s61, 98304
    s_add_u32 s59, s63, 409600
    buffer_load_dwordx4 v254, s[4:7], s59 offen lds
    buffer_load_dwordx4 v254, s[4:7], s59 offen offset:1024 lds
    buffer_load_dwordx4 v254, s[4:7], s59 offen offset:2048 lds
    buffer_load_dwordx4 v254, s[4:7], s59 offen offset:3072 lds
    s_add_u32 m0, s61, 102400
    s_add_u32 s60, s63, 413696
    buffer_load_dwordx4 v254, s[4:7], s60 offen lds
    buffer_load_dwordx4 v254, s[4:7], s60 offen offset:1024 lds
    buffer_load_dwordx4 v254, s[4:7], s60 offen offset:2048 lds
    buffer_load_dwordx4 v254, s[4:7], s60 offen offset:3072 lds
    s_waitcnt vmcnt(8)
    s_barrier
    s_add_u32 m0, s61, 114688
    s_add_u32 s59, s63, 425984
    buffer_load_dwordx4 v254, s[4:7], s59 offen lds
    buffer_load_dwordx4 v254, s[4:7], s59 offen offset:1024 lds
    buffer_load_dwordx4 v254, s[4:7], s59 offen offset:2048 lds
    buffer_load_dwordx4 v254, s[4:7], s59 offen offset:3072 lds
    s_add_u32 m0, s61, 118784
    s_add_u32 s60, s63, 430080
    buffer_load_dwordx4 v254, s[4:7], s60 offen lds
    buffer_load_dwordx4 v254, s[4:7], s60 offen offset:1024 lds
    buffer_load_dwordx4 v254, s[4:7], s60 offen offset:2048 lds
    buffer_load_dwordx4 v254, s[4:7], s60 offen offset:3072 lds
    s_waitcnt vmcnt(8)
    s_barrier
    s_add_u32 m0, s61, 131072
    s_add_u32 s59, s63, 442368
    buffer_load_dwordx4 v254, s[4:7], s59 offen lds
    buffer_load_dwordx4 v254, s[4:7], s59 offen offset:1024 lds
    buffer_load_dwordx4 v254, s[4:7], s59 offen offset:2048 lds
    buffer_load_dwordx4 v254, s[4:7], s59 offen offset:3072 lds
    s_add_u32 m0, s61, 135168
    s_add_u32 s60, s63, 446464
    buffer_load_dwordx4 v254, s[4:7], s60 offen lds
    buffer_load_dwordx4 v254, s[4:7], s60 offen offset:1024 lds
    buffer_load_dwordx4 v254, s[4:7], s60 offen offset:2048 lds
    buffer_load_dwordx4 v254, s[4:7], s60 offen offset:3072 lds
    s_waitcnt vmcnt(8)
    s_barrier
    s_waitcnt vmcnt(0)
    s_barrier
    s_barrier
    s_setprio 0
    s_cmp_lg_u32 s46, 0
    s_cbranch_scc1 K_end
    s_mov_b32 s46, 1
    s_add_u32 s47, s47, 4194304
    s_add_u32 s49, s49, 8388608
    s_add_u32 s50, s50, 14680064
    s_add_u32 s52, s52, 1048576
    s_add_u32 s54, s54, 16384
    s_branch YA_layer
YW_g4:
    s_setprio 1
    v_and_b32 v225, 0xf0, v254
    v_lshrrev_b32 v224, 8, v254
    v_and_b32 v226, 7, v224
    v_lshlrev_b32 v226, 5, v226
    v_xor_b32 v226, v225, v226
    v_mul_u32_u24 v224, 2048, v224
    v_add_u32 v217, v224, v226
    v_lshrrev_b32 v224, 8, v254
    v_add_u32 v224, 4, v224
    v_and_b32 v226, 7, v224
    v_lshlrev_b32 v226, 5, v226
    v_xor_b32 v226, v225, v226
    v_mul_u32_u24 v224, 2048, v224
    v_add_u32 v218, v224, v226
    v_subrev_u32 v218, 1024, v218
    v_lshrrev_b32 v224, 8, v254
    v_add_u32 v224, 8, v224
    v_and_b32 v226, 7, v224
    v_lshlrev_b32 v226, 5, v226
    v_xor_b32 v226, v225, v226
    v_mul_u32_u24 v224, 2048, v224
    v_add_u32 v219, v224, v226
    v_subrev_u32 v219, 2048, v219
    v_lshrrev_b32 v224, 8, v254
    v_add_u32 v224, 12, v224
    v_and_b32 v226, 7, v224
    v_lshlrev_b32 v226, 5, v226
    v_xor_b32 v226, v225, v226
    v_mul_u32_u24 v224, 2048, v224
    v_add_u32 v220, v224, v226
    v_subrev_u32 v220, 3072, v220
    s_lshl_b32 s67, s43, 13
    s_and_b32 s55, s51, 1
    s_mul_i32 s68, s55, 3670016
    s_lshr_b32 s55, s51, 1
    s_lshl_b32 s55, s55, 8
    s_add_u32 s68, s68, s55
    s_mul_i32 s55, s43, 196608
    s_add_u32 s69, s68, s55
    s_lshl_b32 s55, s43, 17
    s_add_u32 s68, s68, s55
    s_nop 7
    v_mul_f32 v96, v184, v0
    v_mul_f32 v97, v184, v1
    v_mul_f32 v98, v184, v2
    v_mul_f32 v99, v184, v3
    v_exp_f32 v96, v96
    v_exp_f32 v97, v97
    v_exp_f32 v98, v98
    v_exp_f32 v99, v99
    v_mul_f32 v0, v0, v48
    v_mul_f32 v1, v1, v49
    v_mul_f32 v2, v2, v50
    v_mul_f32 v3, v3, v51
    s_barrier
    s_add_u32 m0, s67, 32768
    s_add_u32 s59, s68, 2752512
    buffer_load_dwordx4 v217, s[20:23], s59 offen lds
    v_fma_f32 v96, v96, v188, v188
    v_fma_f32 v97, v97, v188, v188
    v_fma_f32 v98, v98, v188, v188
    buffer_load_dwordx4 v218, s[20:23], s59 offen offset:1024 lds
    v_fma_f32 v99, v99, v188, v188
    v_rcp_f32 v96, v96
    v_rcp_f32 v97, v97
    buffer_load_dwordx4 v219, s[20:23], s59 offen offset:2048 lds
    v_rcp_f32 v98, v98
    v_rcp_f32 v99, v99
    v_mul_f32 v0, v0, v96
    buffer_load_dwordx4 v220, s[20:23], s59 offen offset:3072 lds
    v_mul_f32 v1, v1, v97
    v_mul_f32 v2, v2, v98
    v_mul_f32 v3, v3, v99
    v_cvt_pk_bf16_f32 v100, v0, v1
    s_add_u32 m0, s67, 36864
    s_add_u32 s60, s68, 2785280
    buffer_load_dwordx4 v217, s[20:23], s60 offen lds
    v_cvt_pk_bf16_f32 v101, v2, v3
    v_mul_f32 v96, v184, v16
    v_mul_f32 v97, v184, v17
    buffer_load_dwordx4 v218, s[20:23], s60 offen offset:1024 lds
    v_mul_f32 v98, v184, v18
    v_mul_f32 v99, v184, v19
    v_exp_f32 v96, v96
    buffer_load_dwordx4 v219, s[20:23], s60 offen offset:2048 lds
    v_exp_f32 v97, v97
    v_exp_f32 v98, v98
    v_exp_f32 v99, v99
    buffer_load_dwordx4 v220, s[20:23], s60 offen offset:3072 lds
    v_mul_f32 v16, v16, v64
    v_mul_f32 v17, v17, v65
    v_mul_f32 v18, v18, v66
    v_mul_f32 v19, v19, v67
    s_barrier
    s_add_u32 m0, s67, 49152
    s_add_u32 s59, s68, 3407872
    buffer_load_dwordx4 v217, s[20:23], s59 offen lds
    v_fma_f32 v96, v96, v188, v188
    v_fma_f32 v97, v97, v188, v188
    buffer_load_dwordx4 v218, s[20:23], s59 offen offset:1024 lds
    v_fma_f32 v98, v98, v188, v188
    v_fma_f32 v99, v99, v188, v188
    v_rcp_f32 v96, v96
    buffer_load_dwordx4 v219, s[20:23], s59 offen offset:2048 lds
    v_rcp_f32 v97, v97
    v_rcp_f32 v98, v98
    v_rcp_f32 v99, v99
    buffer_load_dwordx4 v220, s[20:23], s59 offen offset:3072 lds
    v_mul_f32 v16, v16, v96
    v_mul_f32 v17, v17, v97
    v_mul_f32 v18, v18, v98
    s_add_u32 m0, s67, 53248
    s_add_u32 s60, s68, 3440640
    buffer_load_dwordx4 v217, s[20:23], s60 offen lds
    v_mul_f32 v19, v19, v99
    v_cvt_pk_bf16_f32 v102, v16, v17
    v_cvt_pk_bf16_f32 v103, v18, v19
    buffer_load_dwordx4 v218, s[20:23], s60 offen offset:1024 lds
    s_add_u32 s55, s64, 0
    buffer_store_dwordx4 v[100:103], v254, s[4:7], s55 offen sc0 sc1
    v_mul_f32 v96, v185, v4
    v_mul_f32 v97, v185, v5
    buffer_load_dwordx4 v219, s[20:23], s60 offen offset:2048 lds
    v_mul_f32 v98, v185, v6
    v_mul_f32 v99, v185, v7
    v_exp_f32 v96, v96
    buffer_load_dwordx4 v220, s[20:23], s60 offen offset:3072 lds
    v_exp_f32 v97, v97
    v_exp_f32 v98, v98
    v_exp_f32 v99, v99
    s_barrier
    s_add_u32 m0, s67, 65536
    s_add_u32 s59, s68, 65536
    buffer_load_dwordx4 v217, s[20:23], s59 offen lds
    v_mul_f32 v4, v4, v52
    v_mul_f32 v5, v5, v53
    v_mul_f32 v6, v6, v54
    buffer_load_dwordx4 v218, s[20:23], s59 offen offset:1024 lds
    v_mul_f32 v7, v7, v55
    v_fma_f32 v96, v96, v189, v189
    v_fma_f32 v97, v97, v189, v189
    buffer_load_dwordx4 v219, s[20:23], s59 offen offset:2048 lds
    v_fma_f32 v98, v98, v189, v189
    v_fma_f32 v99, v99, v189, v189
    v_rcp_f32 v96, v96
    buffer_load_dwordx4 v220, s[20:23], s59 offen offset:3072 lds
    v_rcp_f32 v97, v97
    v_rcp_f32 v98, v98
    v_rcp_f32 v99, v99
    v_mul_f32 v4, v4, v96
    s_add_u32 m0, s67, 69632
    s_add_u32 s60, s68, 98304
    buffer_load_dwordx4 v217, s[20:23], s60 offen lds
    v_mul_f32 v5, v5, v97
    v_mul_f32 v6, v6, v98
    v_mul_f32 v7, v7, v99
    buffer_load_dwordx4 v218, s[20:23], s60 offen offset:1024 lds
    v_cvt_pk_bf16_f32 v104, v4, v5
    v_cvt_pk_bf16_f32 v105, v6, v7
    v_mul_f32 v96, v185, v20
    buffer_load_dwordx4 v219, s[20:23], s60 offen offset:2048 lds
    v_mul_f32 v97, v185, v21
    v_mul_f32 v98, v185, v22
    v_mul_f32 v99, v185, v23
    buffer_load_dwordx4 v220, s[20:23], s60 offen offset:3072 lds
    v_exp_f32 v96, v96
    v_exp_f32 v97, v97
    v_exp_f32 v98, v98
    v_exp_f32 v99, v99
    s_barrier
    s_add_u32 m0, s67, 81920
    s_add_u32 s59, s68, 720896
    buffer_load_dwordx4 v217, s[20:23], s59 offen lds
    v_mul_f32 v20, v20, v68
    v_mul_f32 v21, v21, v69
    v_mul_f32 v22, v22, v70
    buffer_load_dwordx4 v218, s[20:23], s59 offen offset:1024 lds
    v_mul_f32 v23, v23, v71
    v_fma_f32 v96, v96, v189, v189
    v_fma_f32 v97, v97, v189, v189
    buffer_load_dwordx4 v219, s[20:23], s59 offen offset:2048 lds
    v_fma_f32 v98, v98, v189, v189
    v_fma_f32 v99, v99, v189, v189
    v_rcp_f32 v96, v96
    buffer_load_dwordx4 v220, s[20:23], s59 offen offset:3072 lds
    v_rcp_f32 v97, v97
    v_rcp_f32 v98, v98
    v_rcp_f32 v99, v99
    s_add_u32 m0, s67, 86016
    s_add_u32 s60, s68, 753664
    buffer_load_dwordx4 v217, s[20:23], s60 offen lds
    v_mul_f32 v20, v20, v96
    v_mul_f32 v21, v21, v97
    v_mul_f32 v22, v22, v98
    buffer_load_dwordx4 v218, s[20:23], s60 offen offset:1024 lds
    v_mul_f32 v23, v23, v99
    v_cvt_pk_bf16_f32 v106, v20, v21
    v_cvt_pk_bf16_f32 v107, v22, v23
    buffer_load_dwordx4 v219, s[20:23], s60 offen offset:2048 lds
    s_add_u32 s55, s64, 2048
    buffer_store_dwordx4 v[104:107], v254, s[4:7], s55 offen sc0 sc1
    v_mul_f32 v96, v186, v8
    v_mul_f32 v97, v186, v9
    buffer_load_dwordx4 v220, s[20:23], s60 offen offset:3072 lds
    v_mul_f32 v98, v186, v10
    v_mul_f32 v99, v186, v11
    v_exp_f32 v96, v96
    v_exp_f32 v97, v97
    s_barrier
    s_add_u32 m0, s67, 0
    s_add_u32 s59, s68, 983040
    buffer_load_dwordx4 v217, s[20:23], s59 offen lds
    v_exp_f32 v98, v98
    v_exp_f32 v99, v99
    v_mul_f32 v8, v8, v56
    buffer_load_dwordx4 v218, s[20:23], s59 offen offset:1024 lds
    v_mul_f32 v9, v9, v57
    v_mul_f32 v10, v10, v58
    v_mul_f32 v11, v11, v59
    buffer_load_dwordx4 v219, s[20:23], s59 offen offset:2048 lds
    v_fma_f32 v96, v96, v190, v190
    v_fma_f32 v97, v97, v190, v190
    v_fma_f32 v98, v98, v190, v190
    buffer_load_dwordx4 v220, s[20:23], s59 offen offset:3072 lds
    v_fma_f32 v99, v99, v190, v190
    v_rcp_f32 v96, v96
    v_rcp_f32 v97, v97
    v_rcp_f32 v98, v98
    s_add_u32 m0, s67, 4096
    s_add_u32 s60, s68, 1015808
    buffer_load_dwordx4 v217, s[20:23], s60 offen lds
    v_rcp_f32 v99, v99
    v_mul_f32 v8, v8, v96
    v_mul_f32 v9, v9, v97
    buffer_load_dwordx4 v218, s[20:23], s60 offen offset:1024 lds
    v_mul_f32 v10, v10, v98
    v_mul_f32 v11, v11, v99
    v_cvt_pk_bf16_f32 v100, v8, v9
    buffer_load_dwordx4 v219, s[20:23], s60 offen offset:2048 lds
    v_cvt_pk_bf16_f32 v101, v10, v11
    v_mul_f32 v96, v186, v24
    v_mul_f32 v97, v186, v25
    buffer_load_dwordx4 v220, s[20:23], s60 offen offset:3072 lds
    v_mul_f32 v98, v186, v26
    v_mul_f32 v99, v186, v27
    v_exp_f32 v96, v96
    v_exp_f32 v97, v97
    s_waitcnt vmcnt(34)
    s_barrier
    s_add_u32 m0, s67, 16384
    s_add_u32 s59, s68, 1638400
    buffer_load_dwordx4 v217, s[20:23], s59 offen lds
    v_exp_f32 v98, v98
    v_exp_f32 v99, v99
    v_mul_f32 v24, v24, v72
    buffer_load_dwordx4 v218, s[20:23], s59 offen offset:1024 lds
    v_mul_f32 v25, v25, v73
    v_mul_f32 v26, v26, v74
    v_mul_f32 v27, v27, v75
    buffer_load_dwordx4 v219, s[20:23], s59 offen offset:2048 lds
    v_fma_f32 v96, v96, v190, v190
    v_fma_f32 v97, v97, v190, v190
    v_fma_f32 v98, v98, v190, v190
    buffer_load_dwordx4 v220, s[20:23], s59 offen offset:3072 lds
    v_fma_f32 v99, v99, v190, v190
    v_rcp_f32 v96, v96
    v_rcp_f32 v97, v97
    s_add_u32 m0, s67, 20480
    s_add_u32 s60, s68, 1671168
    buffer_load_dwordx4 v217, s[20:23], s60 offen lds
    v_rcp_f32 v98, v98
    v_rcp_f32 v99, v99
    v_mul_f32 v24, v24, v96
    buffer_load_dwordx4 v218, s[20:23], s60 offen offset:1024 lds
    v_mul_f32 v25, v25, v97
    v_mul_f32 v26, v26, v98
    v_mul_f32 v27, v27, v99
    buffer_load_dwordx4 v219, s[20:23], s60 offen offset:2048 lds
    v_cvt_pk_bf16_f32 v102, v24, v25
    v_cvt_pk_bf16_f32 v103, v26, v27
    s_add_u32 s55, s64, 4096
    buffer_store_dwordx4 v[100:103], v254, s[4:7], s55 offen sc0 sc1
    buffer_load_dwordx4 v220, s[20:23], s60 offen offset:3072 lds
    v_mul_f32 v96, v187, v12
    v_mul_f32 v97, v187, v13
    v_mul_f32 v98, v187, v14
    v_mul_f32 v99, v187, v15
    s_waitcnt vmcnt(34)
    s_barrier
    s_add_u32 m0, s67, 32768
    s_add_u32 s59, s68, 1900544
    buffer_load_dwordx4 v217, s[20:23], s59 offen lds
    v_exp_f32 v96, v96
    v_exp_f32 v97, v97
    v_exp_f32 v98, v98
    buffer_load_dwordx4 v218, s[20:23], s59 offen offset:1024 lds
    v_exp_f32 v99, v99
    v_mul_f32 v12, v12, v60
    v_mul_f32 v13, v13, v61
    buffer_load_dwordx4 v219, s[20:23], s59 offen offset:2048 lds
    v_mul_f32 v14, v14, v62
    v_mul_f32 v15, v15, v63
    v_fma_f32 v96, v96, v191, v191
    buffer_load_dwordx4 v220, s[20:23], s59 offen offset:3072 lds
    v_fma_f32 v97, v97, v191, v191
    v_fma_f32 v98, v98, v191, v191
    v_fma_f32 v99, v99, v191, v191
    v_rcp_f32 v96, v96
    s_add_u32 m0, s67, 36864
    s_add_u32 s60, s68, 1933312
    buffer_load_dwordx4 v217, s[20:23], s60 offen lds
    v_rcp_f32 v97, v97
    v_rcp_f32 v98, v98
    v_rcp_f32 v99, v99
    buffer_load_dwordx4 v218, s[20:23], s60 offen offset:1024 lds
    v_mul_f32 v12, v12, v96
    v_mul_f32 v13, v13, v97
    v_mul_f32 v14, v14, v98
    buffer_load_dwordx4 v219, s[20:23], s60 offen offset:2048 lds
    v_mul_f32 v15, v15, v99
    v_cvt_pk_bf16_f32 v104, v12, v13
    v_cvt_pk_bf16_f32 v105, v14, v15
    buffer_load_dwordx4 v220, s[20:23], s60 offen offset:3072 lds
    v_mul_f32 v96, v187, v28
    v_mul_f32 v97, v187, v29
    v_mul_f32 v98, v187, v30
    v_mul_f32 v99, v187, v31
    s_waitcnt vmcnt(34)
    s_barrier
    s_add_u32 m0, s67, 49152
    s_add_u32 s59, s68, 2555904
    buffer_load_dwordx4 v217, s[20:23], s59 offen lds
    v_exp_f32 v96, v96
    v_exp_f32 v97, v97
    buffer_load_dwordx4 v218, s[20:23], s59 offen offset:1024 lds
    v_exp_f32 v98, v98
    v_exp_f32 v99, v99
    v_mul_f32 v28, v28, v76
    buffer_load_dwordx4 v219, s[20:23], s59 offen offset:2048 lds
    v_mul_f32 v29, v29, v77
    v_mul_f32 v30, v30, v78
    v_mul_f32 v31, v31, v79
    buffer_load_dwordx4 v220, s[20:23], s59 offen offset:3072 lds
    v_fma_f32 v96, v96, v191, v191
    v_fma_f32 v97, v97, v191, v191
    v_fma_f32 v98, v98, v191, v191
    s_add_u32 m0, s67, 53248
    s_add_u32 s60, s68, 2588672
    buffer_load_dwordx4 v217, s[20:23], s60 offen lds
    v_fma_f32 v99, v99, v191, v191
    v_rcp_f32 v96, v96
    v_rcp_f32 v97, v97
    buffer_load_dwordx4 v218, s[20:23], s60 offen offset:1024 lds
    v_rcp_f32 v98, v98
    v_rcp_f32 v99, v99
    v_mul_f32 v28, v28, v96
    buffer_load_dwordx4 v219, s[20:23], s60 offen offset:2048 lds
    v_mul_f32 v29, v29, v97
    v_mul_f32 v30, v30, v98
    v_mul_f32 v31, v31, v99
    buffer_load_dwordx4 v220, s[20:23], s60 offen offset:3072 lds
    v_cvt_pk_bf16_f32 v106, v28, v29
    v_cvt_pk_bf16_f32 v107, v30, v31
    s_add_u32 s55, s64, 6144
    buffer_store_dwordx4 v[104:107], v254, s[4:7], s55 offen sc0 sc1
    s_waitcnt vmcnt(34)
    s_barrier
    s_add_u32 m0, s67, 65536
    s_add_u32 s59, s68, 2818048
    buffer_load_dwordx4 v217, s[20:23], s59 offen lds
    v_lshrrev_b32 v120, 1, v254
    s_lshl_b32 s55, s43, 11
    s_add_u32 s55, s55, 157632
    v_add_u32 v120, s55, v120
    buffer_load_dwordx4 v218, s[20:23], s59 offen offset:1024 lds
    v_mul_f32 v96, v184, v32
    v_mul_f32 v97, v184, v33
    v_mul_f32 v98, v184, v34
    buffer_load_dwordx4 v219, s[20:23], s59 offen offset:2048 lds
    v_mul_f32 v99, v184, v35
    v_exp_f32 v96, v96
    buffer_load_dwordx4 v220, s[20:23], s59 offen offset:3072 lds
    v_exp_f32 v97, v97
    v_exp_f32 v98, v98
    v_exp_f32 v99, v99
    s_add_u32 m0, s67, 69632
    s_add_u32 s60, s68, 2850816
    buffer_load_dwordx4 v217, s[20:23], s60 offen lds
    v_mul_f32 v32, v32, v80
    v_mul_f32 v33, v33, v81
    v_mul_f32 v34, v34, v82
    buffer_load_dwordx4 v218, s[20:23], s60 offen offset:1024 lds
    v_mul_f32 v35, v35, v83
    v_fma_f32 v96, v96, v188, v188
    buffer_load_dwordx4 v219, s[20:23], s60 offen offset:2048 lds
    v_fma_f32 v97, v97, v188, v188
    v_fma_f32 v98, v98, v188, v188
    v_fma_f32 v99, v99, v188, v188
    buffer_load_dwordx4 v220, s[20:23], s60 offen offset:3072 lds
    v_rcp_f32 v96, v96
    v_rcp_f32 v97, v97
    v_rcp_f32 v98, v98
    s_waitcnt vmcnt(34)
    s_barrier
    s_add_u32 m0, s67, 81920
    s_add_u32 s59, s68, 3473408
    buffer_load_dwordx4 v217, s[20:23], s59 offen lds
    v_rcp_f32 v99, v99
    v_mul_f32 v32, v32, v96
    v_mul_f32 v33, v33, v97
    buffer_load_dwordx4 v218, s[20:23], s59 offen offset:1024 lds
    v_mul_f32 v34, v34, v98
    v_mul_f32 v35, v35, v99
    v_cvt_pk_bf16_f32 v108, v32, v33
    buffer_load_dwordx4 v219, s[20:23], s59 offen offset:2048 lds
    v_cvt_pk_bf16_f32 v109, v34, v35
    ds_write_b64 v120, v[108:109] offset:0
    v_mul_f32 v96, v185, v36
    buffer_load_dwordx4 v220, s[20:23], s59 offen offset:3072 lds
    v_mul_f32 v97, v185, v37
    v_mul_f32 v98, v185, v38
    v_mul_f32 v99, v185, v39
    v_exp_f32 v96, v96
    s_add_u32 m0, s67, 86016
    s_add_u32 s60, s68, 3506176
    buffer_load_dwordx4 v217, s[20:23], s60 offen lds
    v_exp_f32 v97, v97
    v_exp_f32 v98, v98
    v_exp_f32 v99, v99
    buffer_load_dwordx4 v218, s[20:23], s60 offen offset:1024 lds
    v_mul_f32 v36, v36, v84
    v_mul_f32 v37, v37, v85
    v_mul_f32 v38, v38, v86
    buffer_load_dwordx4 v219, s[20:23], s60 offen offset:2048 lds
    v_mul_f32 v39, v39, v87
    v_fma_f32 v96, v96, v189, v189
    v_fma_f32 v97, v97, v189, v189
    buffer_load_dwordx4 v220, s[20:23], s60 offen offset:3072 lds
    v_fma_f32 v98, v98, v189, v189
    v_fma_f32 v99, v99, v189, v189
    v_rcp_f32 v96, v96
    v_rcp_f32 v97, v97
    s_waitcnt vmcnt(33)
    s_barrier
    s_add_u32 m0, s67, 0
    s_add_u32 s59, s68, 262144
    buffer_load_dwordx4 v217, s[20:23], s59 offen lds
    v_rcp_f32 v98, v98
    v_rcp_f32 v99, v99
    v_mul_f32 v36, v36, v96
    buffer_load_dwordx4 v218, s[20:23], s59 offen offset:1024 lds
    v_mul_f32 v37, v37, v97
    v_mul_f32 v38, v38, v98
    v_mul_f32 v39, v39, v99
    buffer_load_dwordx4 v219, s[20:23], s59 offen offset:2048 lds
    v_cvt_pk_bf16_f32 v110, v36, v37
    v_cvt_pk_bf16_f32 v111, v38, v39
    ds_write_b64 v120, v[110:111] offset:512
    buffer_load_dwordx4 v220, s[20:23], s59 offen offset:3072 lds
    s_waitcnt lgkmcnt(0)
    v_mul_f32 v96, v186, v40
    v_mul_f32 v97, v186, v41
    s_add_u32 m0, s67, 4096
    s_add_u32 s60, s68, 294912
    buffer_load_dwordx4 v217, s[20:23], s60 offen lds
    v_mul_f32 v98, v186, v42
    v_mul_f32 v99, v186, v43
    v_exp_f32 v96, v96
    buffer_load_dwordx4 v218, s[20:23], s60 offen offset:1024 lds
    v_exp_f32 v97, v97
    v_exp_f32 v98, v98
    v_exp_f32 v99, v99
    buffer_load_dwordx4 v219, s[20:23], s60 offen offset:2048 lds
    v_mul_f32 v40, v40, v88
    v_mul_f32 v41, v41, v89
    v_mul_f32 v42, v42, v90
    buffer_load_dwordx4 v220, s[20:23], s60 offen offset:3072 lds
    v_mul_f32 v43, v43, v91
    v_fma_f32 v96, v96, v190, v190
    v_fma_f32 v97, v97, v190, v190
    v_fma_f32 v98, v98, v190, v190
    s_waitcnt vmcnt(24)
    s_barrier
    s_lshl_b32 s55, s41, 2
    s_add_u32 s55, s55, s42
    s_add_u32 s55, s55, s54
    s_add_u32 s55, s55, 6144
    v_mov_b32 v252, 0
    v_mov_b32 v253, 1
    s_mov_b64 exec, 1
    s_cmp_eq_u32 s45, 0
    s_cbranch_scc1 st_82
    buffer_store_byte v253, v252, s[4:7], s55 offen sc0 sc1
    s_branch st_83
st_82:
    buffer_store_byte v253, v252, s[4:7], s55 offen
st_83:
    s_mov_b64 exec, -1
    s_add_u32 m0, s67, 16384
    s_add_u32 s59, s68, 458752
    buffer_load_dwordx4 v217, s[20:23], s59 offen lds
    v_fma_f32 v99, v99, v190, v190
    v_rcp_f32 v96, v96
    v_rcp_f32 v97, v97
    buffer_load_dwordx4 v218, s[20:23], s59 offen offset:1024 lds
    v_rcp_f32 v98, v98
    v_rcp_f32 v99, v99
    v_mul_f32 v40, v40, v96
    buffer_load_dwordx4 v219, s[20:23], s59 offen offset:2048 lds
    v_mul_f32 v41, v41, v97
    v_mul_f32 v42, v42, v98
    v_mul_f32 v43, v43, v99
    buffer_load_dwordx4 v220, s[20:23], s59 offen offset:3072 lds
    v_cvt_pk_bf16_f32 v114, v40, v41
    v_cvt_pk_bf16_f32 v115, v42, v43
    v_mul_f32 v96, v187, v44
    v_mul_f32 v97, v187, v45
    s_add_u32 m0, s67, 20480
    s_add_u32 s60, s68, 491520
    buffer_load_dwordx4 v217, s[20:23], s60 offen lds
    v_mul_f32 v98, v187, v46
    v_mul_f32 v99, v187, v47
    v_exp_f32 v96, v96
    buffer_load_dwordx4 v218, s[20:23], s60 offen offset:1024 lds
    v_exp_f32 v97, v97
    v_exp_f32 v98, v98
    v_exp_f32 v99, v99
    buffer_load_dwordx4 v219, s[20:23], s60 offen offset:2048 lds
    v_mul_f32 v44, v44, v92
    v_mul_f32 v45, v45, v93
    v_mul_f32 v46, v46, v94
    buffer_load_dwordx4 v220, s[20:23], s60 offen offset:3072 lds
    v_mul_f32 v47, v47, v95
    v_fma_f32 v96, v96, v191, v191
    v_fma_f32 v97, v97, v191, v191
    v_fma_f32 v98, v98, v191, v191
    s_barrier
    s_add_u32 m0, s67, 32768
    s_add_u32 s59, s68, 1179648
    buffer_load_dwordx4 v217, s[20:23], s59 offen lds
    v_fma_f32 v99, v99, v191, v191
    buffer_load_dwordx4 v218, s[20:23], s59 offen offset:1024 lds
    v_rcp_f32 v96, v96
    buffer_load_dwordx4 v219, s[20:23], s59 offen offset:2048 lds
    v_rcp_f32 v97, v97
    v_rcp_f32 v98, v98
    buffer_load_dwordx4 v220, s[20:23], s59 offen offset:3072 lds
    v_rcp_f32 v99, v99
    s_add_u32 m0, s67, 36864
    s_add_u32 s60, s68, 1212416
    buffer_load_dwordx4 v217, s[20:23], s60 offen lds
    v_mul_f32 v44, v44, v96
    buffer_load_dwordx4 v218, s[20:23], s60 offen offset:1024 lds
    v_mul_f32 v45, v45, v97
    v_mul_f32 v46, v46, v98
    buffer_load_dwordx4 v219, s[20:23], s60 offen offset:2048 lds
    v_mul_f32 v47, v47, v99
    buffer_load_dwordx4 v220, s[20:23], s60 offen offset:3072 lds
    v_cvt_pk_bf16_f32 v118, v44, v45
    v_cvt_pk_bf16_f32 v119, v46, v47
    s_waitcnt vmcnt(33)
    s_barrier
    s_add_u32 m0, s67, 49152
    s_add_u32 s59, s68, 1376256
    buffer_load_dwordx4 v217, s[20:23], s59 offen lds
    ds_read_b64 v[112:113], v120 offset:1024
    ds_read_b64 v[116:117], v120 offset:1536
    buffer_load_dwordx4 v218, s[20:23], s59 offen offset:1024 lds
    s_waitcnt lgkmcnt(0)
    s_add_u32 s55, s65, 4096
    buffer_store_dwordx4 v[112:115], v254, s[4:7], s55 offen sc0 sc1
    buffer_load_dwordx4 v219, s[20:23], s59 offen offset:2048 lds
    s_add_u32 s55, s65, 6144
    buffer_store_dwordx4 v[116:119], v254, s[4:7], s55 offen sc0 sc1
    v_lshrrev_b32 v224, 7, v254
    buffer_load_dwordx4 v220, s[20:23], s59 offen offset:3072 lds
    v_and_b32 v225, 0x70, v254
    v_and_b32 v226, 6, v224
    s_add_u32 m0, s67, 53248
    s_add_u32 s60, s68, 1409024
    buffer_load_dwordx4 v217, s[20:23], s60 offen lds
    v_lshlrev_b32 v226, 4, v226
    v_xor_b32 v225, v225, v226
    buffer_load_dwordx4 v218, s[20:23], s60 offen offset:1024 lds
    v_mul_u32_u24 v224, 6144, v224
    v_add_u32 v224, v224, v225
    buffer_load_dwordx4 v219, s[20:23], s60 offen offset:2048 lds
    s_cmp_eq_u32 s43, 0
    s_mov_b32 s55, 4096
    s_cselect_b32 s55, s55, 104448
    v_add_u32 v200, s55, v224
    v_subrev_u32 v200, 4096, v200
    buffer_load_dwordx4 v220, s[20:23], s60 offen offset:3072 lds
    s_cmp_eq_u32 s43, 0
    s_mov_b32 s55, 52224
    s_cselect_b32 s55, s55, 152576
    v_add_u32 v201, s55, v224
    v_subrev_u32 v201, 4096, v201
    s_cmp_eq_u32 s43, 0
    s_mov_b32 s55, 100352
    s_cselect_b32 s55, s55, 6144
    v_add_u32 v202, s55, v224
    s_waitcnt vmcnt(35)
    s_barrier
    s_add_u32 m0, s67, 65536
    s_add_u32 s59, s68, 2097152
    buffer_load_dwordx4 v217, s[20:23], s59 offen lds
    v_subrev_u32 v202, 4096, v202
    buffer_load_dwordx4 v218, s[20:23], s59 offen offset:1024 lds
    s_cmp_eq_u32 s43, 0
    s_mov_b32 s55, 151552
    s_cselect_b32 s55, s55, 57344
    v_add_u32 v203, s55, v224
    buffer_load_dwordx4 v219, s[20:23], s59 offen offset:2048 lds
    v_subrev_u32 v203, 4096, v203
    buffer_load_dwordx4 v220, s[20:23], s59 offen offset:3072 lds
    s_cmp_eq_u32 s43, 0
    s_mov_b32 s55, 5120
    s_cselect_b32 s55, s55, 105472
    v_add_u32 v204, s55, v224
    v_subrev_u32 v204, 4096, v204
    s_add_u32 m0, s67, 69632
    s_add_u32 s60, s68, 2129920
    buffer_load_dwordx4 v217, s[20:23], s60 offen lds
    s_cmp_eq_u32 s43, 0
    s_mov_b32 s55, 53248
    s_cselect_b32 s55, s55, 153600
    v_add_u32 v205, s55, v224
    buffer_load_dwordx4 v218, s[20:23], s60 offen offset:1024 lds
    v_subrev_u32 v205, 4096, v205
    buffer_load_dwordx4 v219, s[20:23], s60 offen offset:2048 lds
    s_mul_i32 s61, s43, 6144
    buffer_load_dwordx4 v220, s[20:23], s60 offen offset:3072 lds
    s_lshl_b32 s62, s51, 7
    s_cmp_eq_u32 s46, 0
    s_cselect_b32 s62, s62, 2130706432
    s_waitcnt vmcnt(35)
    s_barrier
    s_add_u32 m0, s67, 81920
    s_add_u32 s59, s68, 2293760
    buffer_load_dwordx4 v217, s[20:23], s59 offen lds
    buffer_load_dwordx4 v218, s[20:23], s59 offen offset:1024 lds
    buffer_load_dwordx4 v219, s[20:23], s59 offen offset:2048 lds
    buffer_load_dwordx4 v220, s[20:23], s59 offen offset:3072 lds
    s_add_u32 m0, s67, 86016
    s_add_u32 s60, s68, 2326528
    buffer_load_dwordx4 v217, s[20:23], s60 offen lds
    buffer_load_dwordx4 v218, s[20:23], s60 offen offset:1024 lds
    buffer_load_dwordx4 v219, s[20:23], s60 offen offset:2048 lds
    buffer_load_dwordx4 v220, s[20:23], s60 offen offset:3072 lds
    s_waitcnt vmcnt(21)
    s_barrier
    s_lshl_b32 s55, s41, 2
    s_add_u32 s55, s55, s42
    s_add_u32 s55, s55, s54
    s_add_u32 s55, s55, 6208
    v_mov_b32 v252, 0
    v_mov_b32 v253, 1
    s_mov_b64 exec, 1
    s_cmp_eq_u32 s45, 0
    s_cbranch_scc1 st_84
    buffer_store_byte v253, v252, s[4:7], s55 offen sc0 sc1
    s_branch st_85
st_84:
    buffer_store_byte v253, v252, s[4:7], s55 offen
st_85:
    s_mov_b64 exec, -1
    s_add_u32 m0, s67, 0
    s_add_u32 s59, s68, 3014656
    buffer_load_dwordx4 v217, s[20:23], s59 offen lds
    buffer_load_dwordx4 v218, s[20:23], s59 offen offset:1024 lds
    buffer_load_dwordx4 v219, s[20:23], s59 offen offset:2048 lds
    buffer_load_dwordx4 v220, s[20:23], s59 offen offset:3072 lds
    s_add_u32 m0, s67, 4096
    s_add_u32 s60, s68, 3047424
    buffer_load_dwordx4 v217, s[20:23], s60 offen lds
    buffer_load_dwordx4 v218, s[20:23], s60 offen offset:1024 lds
    buffer_load_dwordx4 v219, s[20:23], s60 offen offset:2048 lds
    buffer_load_dwordx4 v220, s[20:23], s60 offen offset:3072 lds
    s_barrier
    s_add_u32 m0, s67, 16384
    s_add_u32 s59, s68, 3211264
    buffer_load_dwordx4 v217, s[20:23], s59 offen lds
    buffer_load_dwordx4 v218, s[20:23], s59 offen offset:1024 lds
    buffer_load_dwordx4 v219, s[20:23], s59 offen offset:2048 lds
    buffer_load_dwordx4 v220, s[20:23], s59 offen offset:3072 lds
    s_add_u32 m0, s67, 20480
    s_add_u32 s60, s68, 3244032
    buffer_load_dwordx4 v217, s[20:23], s60 offen lds
    buffer_load_dwordx4 v218, s[20:23], s60 offen offset:1024 lds
    buffer_load_dwordx4 v219, s[20:23], s60 offen offset:2048 lds
    buffer_load_dwordx4 v220, s[20:23], s60 offen offset:3072 lds
    s_waitcnt vmcnt(33)
    s_barrier
    s_add_u32 m0, s67, 32768
    s_add_u32 s59, s69, 327680
    buffer_load_dwordx4 v217, s[20:23], s59 offen lds
    buffer_load_dwordx4 v218, s[20:23], s59 offen offset:1024 lds
    buffer_load_dwordx4 v219, s[20:23], s59 offen offset:2048 lds
    buffer_load_dwordx4 v220, s[20:23], s59 offen offset:3072 lds
    s_add_u32 m0, s67, 36864
    s_add_u32 s60, s69, 360448
    buffer_load_dwordx4 v217, s[20:23], s60 offen lds
    buffer_load_dwordx4 v218, s[20:23], s60 offen offset:1024 lds
    buffer_load_dwordx4 v219, s[20:23], s60 offen offset:2048 lds
    buffer_load_dwordx4 v220, s[20:23], s60 offen offset:3072 lds
    s_waitcnt vmcnt(33)
    s_barrier
    s_add_u32 m0, s67, 49152
    s_add_u32 s59, s69, 1245184
    buffer_load_dwordx4 v217, s[20:23], s59 offen lds
    buffer_load_dwordx4 v218, s[20:23], s59 offen offset:1024 lds
    buffer_load_dwordx4 v219, s[20:23], s59 offen offset:2048 lds
    buffer_load_dwordx4 v220, s[20:23], s59 offen offset:3072 lds
    s_add_u32 m0, s67, 53248
    s_add_u32 s60, s69, 1277952
    buffer_load_dwordx4 v217, s[20:23], s60 offen lds
    buffer_load_dwordx4 v218, s[20:23], s60 offen offset:1024 lds
    buffer_load_dwordx4 v219, s[20:23], s60 offen offset:2048 lds
    buffer_load_dwordx4 v220, s[20:23], s60 offen offset:3072 lds
    s_waitcnt vmcnt(33)
    s_barrier
    s_add_u32 m0, s67, 65536
    s_add_u32 s59, s69, 2162688
    buffer_load_dwordx4 v217, s[20:23], s59 offen lds
    buffer_load_dwordx4 v218, s[20:23], s59 offen offset:1024 lds
    buffer_load_dwordx4 v219, s[20:23], s59 offen offset:2048 lds
    buffer_load_dwordx4 v220, s[20:23], s59 offen offset:3072 lds
    s_add_u32 m0, s67, 69632
    s_add_u32 s60, s69, 2195456
    buffer_load_dwordx4 v217, s[20:23], s60 offen lds
    buffer_load_dwordx4 v218, s[20:23], s60 offen offset:1024 lds
    buffer_load_dwordx4 v219, s[20:23], s60 offen offset:2048 lds
    buffer_load_dwordx4 v220, s[20:23], s60 offen offset:3072 lds
    s_waitcnt vmcnt(32)
    s_barrier
    s_add_u32 m0, s67, 81920
    s_add_u32 s59, s69, 3080192
    buffer_load_dwordx4 v217, s[20:23], s59 offen lds
    buffer_load_dwordx4 v218, s[20:23], s59 offen offset:1024 lds
    buffer_load_dwordx4 v219, s[20:23], s59 offen offset:2048 lds
    buffer_load_dwordx4 v220, s[20:23], s59 offen offset:3072 lds
    s_add_u32 m0, s67, 86016
    s_add_u32 s60, s69, 3112960
    buffer_load_dwordx4 v217, s[20:23], s60 offen lds
    buffer_load_dwordx4 v218, s[20:23], s60 offen offset:1024 lds
    buffer_load_dwordx4 v219, s[20:23], s60 offen offset:2048 lds
    buffer_load_dwordx4 v220, s[20:23], s60 offen offset:3072 lds
    s_waitcnt vmcnt(32)
    s_barrier
    s_lshl_b32 s94, s51, 1
    s_mul_i32 s59, s94, 196608
    s_add_u32 m0, s61, 0
    s_add_u32 s59, s59, s62
    buffer_load_dwordx4 v200, s[8:11], s59 offen lds
    buffer_load_dwordx4 v201, s[8:11], s59 offen offset:1024 lds
    s_add_u32 s94, s94, 1
    s_and_b32 s94, s94, 31
    buffer_load_dwordx4 v202, s[8:11], s59 offen offset:2048 lds
    s_add_u32 m0, s61, 3072
    s_add_u32 s60, s59, 0
    buffer_load_dwordx4 v203, s[8:11], s60 offen lds
    buffer_load_dwordx4 v204, s[8:11], s60 offen offset:1024 lds
    buffer_load_dwordx4 v205, s[8:11], s60 offen offset:2048 lds
    s_waitcnt vmcnt(30)
    s_barrier
    s_mul_i32 s59, s94, 196608
    s_add_u32 m0, s61, 16384
    s_add_u32 s59, s59, s62
    buffer_load_dwordx4 v200, s[8:11], s59 offen lds
    buffer_load_dwordx4 v201, s[8:11], s59 offen offset:1024 lds
    s_add_u32 s94, s94, 1
    s_and_b32 s94, s94, 31
    buffer_load_dwordx4 v202, s[8:11], s59 offen offset:2048 lds
    s_add_u32 m0, s61, 19456
    s_add_u32 s60, s59, 0
    buffer_load_dwordx4 v203, s[8:11], s60 offen lds
    buffer_load_dwordx4 v204, s[8:11], s60 offen offset:1024 lds
    buffer_load_dwordx4 v205, s[8:11], s60 offen offset:2048 lds
    s_waitcnt vmcnt(28)
    s_barrier
    s_mul_i32 s59, s94, 196608
    s_add_u32 m0, s61, 32768
    s_add_u32 s59, s59, s62
    buffer_load_dwordx4 v200, s[8:11], s59 offen lds
    buffer_load_dwordx4 v201, s[8:11], s59 offen offset:1024 lds
    s_add_u32 s94, s94, 1
    s_and_b32 s94, s94, 31
    buffer_load_dwordx4 v202, s[8:11], s59 offen offset:2048 lds
    s_add_u32 m0, s61, 35840
    s_add_u32 s60, s59, 0
    buffer_load_dwordx4 v203, s[8:11], s60 offen lds
    buffer_load_dwordx4 v204, s[8:11], s60 offen offset:1024 lds
    buffer_load_dwordx4 v205, s[8:11], s60 offen offset:2048 lds
    s_waitcnt vmcnt(26)
    s_barrier
    s_mul_i32 s59, s94, 196608
    s_add_u32 m0, s61, 49152
    s_add_u32 s59, s59, s62
    buffer_load_dwordx4 v200, s[8:11], s59 offen lds
    buffer_load_dwordx4 v201, s[8:11], s59 offen offset:1024 lds
    s_add_u32 s94, s94, 1
    s_and_b32 s94, s94, 31
    buffer_load_dwordx4 v202, s[8:11], s59 offen offset:2048 lds
    s_add_u32 m0, s61, 52224
    s_add_u32 s60, s59, 0
    buffer_load_dwordx4 v203, s[8:11], s60 offen lds
    buffer_load_dwordx4 v204, s[8:11], s60 offen offset:1024 lds
    buffer_load_dwordx4 v205, s[8:11], s60 offen offset:2048 lds
    s_waitcnt vmcnt(24)
    s_barrier
    s_mul_i32 s59, s94, 196608
    s_add_u32 m0, s61, 65536
    s_add_u32 s59, s59, s62
    buffer_load_dwordx4 v200, s[8:11], s59 offen lds
    buffer_load_dwordx4 v201, s[8:11], s59 offen offset:1024 lds
    s_add_u32 s94, s94, 1
    s_and_b32 s94, s94, 31
    buffer_load_dwordx4 v202, s[8:11], s59 offen offset:2048 lds
    s_add_u32 m0, s61, 68608
    s_add_u32 s60, s59, 0
    buffer_load_dwordx4 v203, s[8:11], s60 offen lds
    buffer_load_dwordx4 v204, s[8:11], s60 offen offset:1024 lds
    buffer_load_dwordx4 v205, s[8:11], s60 offen offset:2048 lds
    s_barrier
    s_mul_i32 s59, s94, 196608
    s_add_u32 m0, s61, 81920
    s_add_u32 s59, s59, s62
    buffer_load_dwordx4 v200, s[8:11], s59 offen lds
    buffer_load_dwordx4 v201, s[8:11], s59 offen offset:1024 lds
    s_add_u32 s94, s94, 1
    s_and_b32 s94, s94, 31
    buffer_load_dwordx4 v202, s[8:11], s59 offen offset:2048 lds
    s_add_u32 m0, s61, 84992
    s_add_u32 s60, s59, 0
    buffer_load_dwordx4 v203, s[8:11], s60 offen lds
    buffer_load_dwordx4 v204, s[8:11], s60 offen offset:1024 lds
    buffer_load_dwordx4 v205, s[8:11], s60 offen offset:2048 lds
    s_setprio 0
    s_cmp_lg_u32 s46, 0
    s_cbranch_scc1 K_end
    s_mov_b32 s46, 1
    s_add_u32 s47, s47, 4194304
    s_add_u32 s49, s49, 8388608
    s_add_u32 s50, s50, 14680064
    s_add_u32 s52, s52, 1048576
    s_add_u32 s54, s54, 16384
    s_branch YW_layer
K_end:
    s_endpgm
.section .rodata,"a"
.p2align 6
.amdhsa_kernel interleave_layers__sliding_local_dilated__glu_gated_swiglu__prompt_kernel
  .amdhsa_next_free_vgpr 256
  .amdhsa_next_free_sgpr 102
  .amdhsa_accum_offset 256
  .amdhsa_group_segment_fixed_size 0
  .amdhsa_kernarg_size 80
  .amdhsa_user_sgpr_count 2
  .amdhsa_user_sgpr_kernarg_segment_ptr 1
  .amdhsa_system_sgpr_workgroup_id_x 1
.end_amdhsa_kernel
```

```asm
; @launch grid=(256,1,1) block=(512,1,1) lds=163840
.amdgcn_target "amdgcn-amd-amdhsa--gfx950"
.text
.globl interleave_layers__sliding_local_dilated__glu_gated_swiglu__prompt_kernel
.p2align 8
.type interleave_layers__sliding_local_dilated__glu_gated_swiglu__prompt_kernel,@function
interleave_layers__sliding_local_dilated__glu_gated_swiglu__prompt_kernel:
    s_cmp_ge_u32 s2, 256
    s_cbranch_scc0 K_go
    s_endpgm
K_go:
    s_load_dwordx4 s[72:75], s[0:1], 0
    s_load_dwordx2 s[76:77], s[0:1], 16
    s_load_dwordx8 s[80:87], s[0:1], 32
    s_load_dwordx4 s[88:91], s[0:1], 64
    v_lshrrev_b32 v1, 6, v0
    v_and_b32 v254, 63, v0
    v_readfirstlane_b32 s3, v1
    v_lshlrev_b32 v254, 4, v254
    v_mov_b32 v255, 0
    s_and_b32 s55, s2, 6
    s_lshl_b32 s55, s55, 1
    s_lshr_b32 s56, s2, 3
    s_and_b32 s56, s56, 3
    s_add_u32 s40, s55, s56
    s_and_b32 s55, s2, 1
    s_lshr_b32 s56, s2, 5
    s_lshl_b32 s41, s55, 3
    s_add_u32 s41, s41, s56
    s_lshl_b32 s51, s56, 1
    s_add_u32 s51, s51, s55
    s_and_b32 s42, s3, 3
    s_and_b32 s43, s3, 1
    s_lshr_b32 s44, s42, 1
    s_mov_b32 s45, 1
    s_mov_b32 s46, 0
    s_lshl_b32 s47, s40, 22
    s_add_u32 s49, s47, 524288
    s_add_u32 s48, s47, 786432
    s_add_u32 s50, s47, 2097152
    s_add_u32 s52, s47, 1835008
    s_add_u32 s53, s52, 32768
    s_lshl_b32 s54, s40, 7
    s_add_u32 s54, s54, 71303168
    s_waitcnt lgkmcnt(0)
    s_mov_b32 s4, s90
    s_mov_b32 s5, s91
    s_mov_b32 s6, 268435456
    s_mov_b32 s7, 0x00020000
    s_mov_b32 s8, s74
    s_mov_b32 s9, s75
    s_mov_b32 s10, 6291456
    s_mov_b32 s11, 0x00020000
    s_mov_b32 s24, s72
    s_mov_b32 s25, s73
    s_mov_b32 s26, 4194304
    s_mov_b32 s27, 0x00020000
    s_mov_b32 s12, s76
    s_mov_b32 s13, s77
    s_mov_b32 s14, 2097152
    s_mov_b32 s15, 0x00020000
    s_cmp_eq_u32 s43, 0
    s_cselect_b32 s16, s80, s82
    s_cselect_b32 s17, s81, s83
    s_mov_b32 s18, 7340032
    s_mov_b32 s19, 0x00020000
    s_mov_b32 s20, s84
    s_mov_b32 s21, s85
    s_mov_b32 s22, 7340032
    s_mov_b32 s23, 0x00020000
    s_mov_b32 s28, s86
    s_mov_b32 s29, s87
    s_mov_b32 s30, 4194304
    s_mov_b32 s31, 0x00020000
    s_mov_b32 s32, s88
    s_mov_b32 s33, s89
    s_mov_b32 s34, 256
    s_mov_b32 s35, 0x00020000
    s_mov_b32 s36, s72
    s_mov_b32 s37, s73
    s_mov_b32 s38, 4194304
    s_mov_b32 s39, 0x00020000
    s_and_b32 s55, s2, 1
    s_lshl_b32 s55, s55, 13
    s_add_u32 s55, s55, 16384
    s_add_u32 s0, s54, s55
    s_cmp_lt_u32 s3, 4
    s_cbranch_scc1 X_start
    s_cmp_lt_u32 s42, 2
    s_cbranch_scc1 YA_start
    v_lshrrev_b32 v224, 7, v254
    v_and_b32 v225, 0x70, v254
    v_and_b32 v226, 6, v224
    v_lshlrev_b32 v226, 4, v226
    v_xor_b32 v225, v225, v226
    v_and_b32 v226, 4, v224
    v_add_u32 v224, v224, v226
    v_mul_u32_u24 v224, 6144, v224
    v_add_u32 v224, v224, v225
    s_cmp_eq_u32 s43, 0
    s_mov_b32 s55, 4096
    s_cselect_b32 s55, s55, 30720
    v_add_u32 v200, s55, v224
    v_subrev_u32 v200, 4096, v200
    s_cmp_eq_u32 s43, 0
    s_mov_b32 s55, 101376
    s_cselect_b32 s55, s55, 128000
    v_add_u32 v201, s55, v224
    v_subrev_u32 v201, 4096, v201
    s_cmp_eq_u32 s43, 0
    s_mov_b32 s55, 26624
    s_cselect_b32 s55, s55, 6144
    v_add_u32 v202, s55, v224
    v_subrev_u32 v202, 4096, v202
    s_cmp_eq_u32 s43, 0
    s_mov_b32 s55, 126976
    s_cselect_b32 s55, s55, 106496
    v_add_u32 v203, s55, v224
    v_subrev_u32 v203, 4096, v203
    s_cmp_eq_u32 s43, 0
    s_mov_b32 s55, 5120
    s_cselect_b32 s55, s55, 31744
    v_add_u32 v204, s55, v224
    v_subrev_u32 v204, 4096, v204
    s_cmp_eq_u32 s43, 0
    s_mov_b32 s55, 102400
    s_cselect_b32 s55, s55, 129024
    v_add_u32 v205, s55, v224
    v_subrev_u32 v205, 4096, v205
    s_mul_i32 s61, s43, 6144
    s_lshl_b32 s62, s51, 7
    s_lshl_b32 s94, s51, 1
    s_mul_i32 s59, s94, 196608
    s_add_u32 m0, s61, 0
    s_add_u32 s59, s59, s62
    buffer_load_dwordx4 v200, s[8:11], s59 offen lds
    buffer_load_dwordx4 v201, s[8:11], s59 offen offset:1024 lds
    s_add_u32 s94, s94, 1
    s_and_b32 s94, s94, 31
    buffer_load_dwordx4 v202, s[8:11], s59 offen offset:2048 lds
    s_add_u32 m0, s61, 3072
    s_add_u32 s60, s59, 0
    buffer_load_dwordx4 v203, s[8:11], s60 offen lds
    buffer_load_dwordx4 v204, s[8:11], s60 offen offset:1024 lds
    buffer_load_dwordx4 v205, s[8:11], s60 offen offset:2048 lds
    v_lshrrev_b32 v224, 7, v254
    v_and_b32 v225, 0x70, v254
    v_and_b32 v226, 6, v224
    v_lshlrev_b32 v226, 4, v226
    v_xor_b32 v225, v225, v226
    v_lshl_add_u32 v221, v224, 11, v225
    s_lshl_b32 s64, s40, 18
    s_sub_u32 s64, s64, 32768
    s_lshl_b32 s55, s43, 14
    s_add_u32 s64, s64, s55
    s_mov_b32 s66, 128
    s_cmp_eq_u32 s40, 0
    s_cselect_b32 s64, 2130706432, s64
    s_lshl_b32 s65, s43, 10
    s_mov_b32 s95, s51
    s_mul_i32 s93, s95, s66
    s_add_u32 m0, s65, 98304
    s_add_u32 s93, s93, s64
    buffer_load_dwordx4 v221, s[36:39], s93 offen lds
    s_add_u32 s95, s95, 2
    s_and_b32 s95, s95, 15
    s_mul_i32 s59, s94, 196608
    s_add_u32 m0, s61, 16384
    s_add_u32 s59, s59, s62
    buffer_load_dwordx4 v200, s[8:11], s59 offen lds
    buffer_load_dwordx4 v201, s[8:11], s59 offen offset:1024 lds
    s_add_u32 s94, s94, 3
    s_and_b32 s94, s94, 31
    buffer_load_dwordx4 v202, s[8:11], s59 offen offset:2048 lds
    s_add_u32 m0, s61, 19456
    s_add_u32 s60, s59, 0
    buffer_load_dwordx4 v203, s[8:11], s60 offen lds
    buffer_load_dwordx4 v204, s[8:11], s60 offen offset:1024 lds
    buffer_load_dwordx4 v205, s[8:11], s60 offen offset:2048 lds
    s_mul_i32 s93, s95, s66
    s_add_u32 m0, s65, 116736
    s_add_u32 s93, s93, s64
    buffer_load_dwordx4 v221, s[36:39], s93 offen lds
    s_add_u32 s95, s95, 2
    s_and_b32 s95, s95, 15
    s_mul_i32 s59, s94, 196608
    s_add_u32 m0, s61, 32768
    s_add_u32 s59, s59, s62
    buffer_load_dwordx4 v200, s[8:11], s59 offen lds
    buffer_load_dwordx4 v201, s[8:11], s59 offen offset:1024 lds
    s_add_u32 s94, s94, 1
    s_and_b32 s94, s94, 31
    buffer_load_dwordx4 v202, s[8:11], s59 offen offset:2048 lds
    s_add_u32 m0, s61, 35840
    s_add_u32 s60, s59, 0
    buffer_load_dwordx4 v203, s[8:11], s60 offen lds
    buffer_load_dwordx4 v204, s[8:11], s60 offen offset:1024 lds
    buffer_load_dwordx4 v205, s[8:11], s60 offen offset:2048 lds
    s_mul_i32 s93, s95, s66
    s_add_u32 m0, s65, 135168
    s_add_u32 s93, s93, s64
    buffer_load_dwordx4 v221, s[36:39], s93 offen lds
    s_add_u32 s95, s95, 2
    s_and_b32 s95, s95, 15
    s_mul_i32 s59, s94, 196608
    s_add_u32 m0, s61, 49152
    s_add_u32 s59, s59, s62
    buffer_load_dwordx4 v200, s[8:11], s59 offen lds
    buffer_load_dwordx4 v201, s[8:11], s59 offen offset:1024 lds
    s_add_u32 s94, s94, 3
    s_and_b32 s94, s94, 31
    buffer_load_dwordx4 v202, s[8:11], s59 offen offset:2048 lds
    s_add_u32 m0, s61, 52224
    s_add_u32 s60, s59, 0
    buffer_load_dwordx4 v203, s[8:11], s60 offen lds
    buffer_load_dwordx4 v204, s[8:11], s60 offen offset:1024 lds
    buffer_load_dwordx4 v205, s[8:11], s60 offen offset:2048 lds
    s_mul_i32 s59, s94, 196608
    s_add_u32 m0, s61, 65536
    s_add_u32 s59, s59, s62
    buffer_load_dwordx4 v200, s[8:11], s59 offen lds
    buffer_load_dwordx4 v201, s[8:11], s59 offen offset:1024 lds
    s_add_u32 s94, s94, 1
    s_and_b32 s94, s94, 31
    buffer_load_dwordx4 v202, s[8:11], s59 offen offset:2048 lds
    s_add_u32 m0, s61, 68608
    s_add_u32 s60, s59, 0
    buffer_load_dwordx4 v203, s[8:11], s60 offen lds
    buffer_load_dwordx4 v204, s[8:11], s60 offen offset:1024 lds
    buffer_load_dwordx4 v205, s[8:11], s60 offen offset:2048 lds
    s_mul_i32 s59, s94, 196608
    s_add_u32 m0, s61, 81920
    s_add_u32 s59, s59, s62
    buffer_load_dwordx4 v200, s[8:11], s59 offen lds
    buffer_load_dwordx4 v201, s[8:11], s59 offen offset:1024 lds
    s_add_u32 s94, s94, 3
    s_and_b32 s94, s94, 31
    buffer_load_dwordx4 v202, s[8:11], s59 offen offset:2048 lds
    s_add_u32 m0, s61, 84992
    s_add_u32 s60, s59, 0
    buffer_load_dwordx4 v203, s[8:11], s60 offen lds
    buffer_load_dwordx4 v204, s[8:11], s60 offen offset:1024 lds
    buffer_load_dwordx4 v205, s[8:11], s60 offen offset:2048 lds
    s_lshr_b32 s55, s2, 1
    s_cmp_lt_u32 s55, 56
    s_cselect_b32 s72, s80, s82
    s_cselect_b32 s73, s81, s83
    s_cselect_b32 s56, 0, 56
    s_sub_u32 s55, s55, s56
    s_mov_b32 s74, 7340032
    s_mov_b32 s75, 0x00020000
    s_lshl_b32 s76, s55, 7
    s_and_b32 s55, s2, 1
    s_mul_i32 s55, s55, 3670016
    s_add_u32 s76, s76, s55
    s_mul_i32 s55, s42, 917504
    s_add_u32 s76, s76, s55
    s_cmp_lt_u32 s2, 224
    s_cselect_b32 s76, s76, 2130706432
    v_lshrrev_b32 v222, 7, v254
    v_mul_u32_u24 v222, 7168, v222
    v_and_b32 v224, 0x70, v254
    v_add_u32 v222, v222, v224
    s_waitcnt vmcnt(32)
    s_branch YW_b
YA_start:
    v_lshrrev_b32 v224, 7, v254
    v_and_b32 v225, 0x70, v254
    v_and_b32 v226, 6, v224
    v_lshlrev_b32 v226, 4, v226
    v_xor_b32 v225, v225, v226
    v_lshl_add_u32 v200, v224, 11, v225
    v_add_u32 v201, 15360, v200
    v_add_u32 v202, 30720, v200
    v_add_u32 v203, 46080, v200
    s_lshl_b32 s62, s40, 18
    s_mov_b32 s63, 65536
    s_mov_b32 s65, 128
    s_mov_b32 s94, s51
    s_mul_i32 s93, s94, s65
    s_add_u32 s93, s93, s62
    s_cmp_eq_u32 s42, 1
    s_cbranch_scc1 YS_start
    s_mov_b32 m0, 100352
    s_nop 0
    buffer_load_dwordx4 v200, s[36:39], s93 offen lds
    buffer_load_dwordx4 v201, s[36:39], s93 offen offset:1024 lds
    buffer_load_dwordx4 v202, s[36:39], s93 offen offset:2048 lds
    buffer_load_dwordx4 v203, s[36:39], s93 offen offset:3072 lds
    s_add_u32 s93, s93, s63
    s_mov_b32 m0, 104448
    s_nop 0
    buffer_load_dwordx4 v200, s[36:39], s93 offen lds
    buffer_load_dwordx4 v201, s[36:39], s93 offen offset:1024 lds
    buffer_load_dwordx4 v202, s[36:39], s93 offen offset:2048 lds
    buffer_load_dwordx4 v203, s[36:39], s93 offen offset:3072 lds
    s_add_u32 s93, s93, s63
    s_add_u32 s93, s93, s63
    s_add_u32 s94, s94, 2
    s_and_b32 s94, s94, 15
    s_mul_i32 s93, s94, s65
    s_add_u32 s93, s93, s62
    s_mov_b32 m0, 118784
    s_nop 0
    buffer_load_dwordx4 v200, s[36:39], s93 offen lds
    buffer_load_dwordx4 v201, s[36:39], s93 offen offset:1024 lds
    buffer_load_dwordx4 v202, s[36:39], s93 offen offset:2048 lds
    buffer_load_dwordx4 v203, s[36:39], s93 offen offset:3072 lds
    s_add_u32 s93, s93, s63
    s_mov_b32 m0, 122880
    s_nop 0
    buffer_load_dwordx4 v200, s[36:39], s93 offen lds
    buffer_load_dwordx4 v201, s[36:39], s93 offen offset:1024 lds
    buffer_load_dwordx4 v202, s[36:39], s93 offen offset:2048 lds
    buffer_load_dwordx4 v203, s[36:39], s93 offen offset:3072 lds
    s_add_u32 s93, s93, s63
    s_add_u32 s93, s93, s63
    s_add_u32 s94, s94, 2
    s_and_b32 s94, s94, 15
    s_mul_i32 s93, s94, s65
    s_add_u32 s93, s93, s62
    s_mov_b32 m0, 137216
    s_nop 0
    buffer_load_dwordx4 v200, s[36:39], s93 offen lds
    buffer_load_dwordx4 v201, s[36:39], s93 offen offset:1024 lds
    buffer_load_dwordx4 v202, s[36:39], s93 offen offset:2048 lds
    buffer_load_dwordx4 v203, s[36:39], s93 offen offset:3072 lds
    s_add_u32 s93, s93, s63
    s_mov_b32 m0, 141312
    s_nop 0
    buffer_load_dwordx4 v200, s[36:39], s93 offen lds
    buffer_load_dwordx4 v201, s[36:39], s93 offen offset:1024 lds
    buffer_load_dwordx4 v202, s[36:39], s93 offen offset:2048 lds
    buffer_load_dwordx4 v203, s[36:39], s93 offen offset:3072 lds
    s_add_u32 s93, s93, s63
    s_mov_b32 m0, 145408
    s_nop 0
    buffer_load_dwordx4 v200, s[36:39], s93 offen lds
    buffer_load_dwordx4 v201, s[36:39], s93 offen offset:1024 lds
    buffer_load_dwordx4 v202, s[36:39], s93 offen offset:2048 lds
    buffer_load_dwordx4 v203, s[36:39], s93 offen offset:3072 lds
    s_add_u32 s93, s93, s63
    s_mov_b32 m0, 149504
    s_nop 0
    buffer_load_dwordx4 v200, s[36:39], s93 offen lds
    buffer_load_dwordx4 v201, s[36:39], s93 offen offset:1024 lds
    buffer_load_dwordx4 v202, s[36:39], s93 offen offset:2048 lds
    buffer_load_dwordx4 v203, s[36:39], s93 offen offset:3072 lds
    s_add_u32 s94, s94, 2
    s_and_b32 s94, s94, 15
    s_mul_i32 s93, s94, s65
    s_add_u32 s93, s93, s62
    s_branch YA0_b
YS_start:
    s_add_u32 s93, s93, s63
    s_add_u32 s93, s93, s63
    s_mov_b32 m0, 108544
    s_nop 0
    buffer_load_dwordx4 v200, s[36:39], s93 offen lds
    buffer_load_dwordx4 v201, s[36:39], s93 offen offset:1024 lds
    buffer_load_dwordx4 v202, s[36:39], s93 offen offset:2048 lds
    buffer_load_dwordx4 v203, s[36:39], s93 offen offset:3072 lds
    s_add_u32 s93, s93, s63
    s_mov_b32 m0, 112640
    s_nop 0
    buffer_load_dwordx4 v200, s[36:39], s93 offen lds
    buffer_load_dwordx4 v201, s[36:39], s93 offen offset:1024 lds
    buffer_load_dwordx4 v202, s[36:39], s93 offen offset:2048 lds
    buffer_load_dwordx4 v203, s[36:39], s93 offen offset:3072 lds
    s_add_u32 s94, s94, 2
    s_and_b32 s94, s94, 15
    s_mul_i32 s93, s94, s65
    s_add_u32 s93, s93, s62
    s_add_u32 s93, s93, s63
    s_add_u32 s93, s93, s63
    s_mov_b32 m0, 126976
    s_nop 0
    buffer_load_dwordx4 v200, s[36:39], s93 offen lds
    buffer_load_dwordx4 v201, s[36:39], s93 offen offset:1024 lds
    buffer_load_dwordx4 v202, s[36:39], s93 offen offset:2048 lds
    buffer_load_dwordx4 v203, s[36:39], s93 offen offset:3072 lds
    s_add_u32 s93, s93, s63
    s_mov_b32 m0, 131072
    s_nop 0
    buffer_load_dwordx4 v200, s[36:39], s93 offen lds
    buffer_load_dwordx4 v201, s[36:39], s93 offen offset:1024 lds
    buffer_load_dwordx4 v202, s[36:39], s93 offen offset:2048 lds
    buffer_load_dwordx4 v203, s[36:39], s93 offen offset:3072 lds
    s_add_u32 s94, s94, 2
    s_and_b32 s94, s94, 15
    s_mul_i32 s93, s94, s65
    s_add_u32 s93, s93, s62
    s_branch YS_first
X_start:
    s_getpc_b64 s[72:73]
K_pc:
    s_mov_b32 s74, K_end-K_pc
    s_mov_b32 s75, 0x00020000
    s_lshr_b32 s55, s2, 3
    s_lshl_b32 s55, s55, 2
    s_add_u32 s55, s55, s42
    s_lshl_b32 s55, s55, 10
    v_lshlrev_b32 v100, 3, v254
    s_mov_b64 exec, 0xff
    buffer_load_dword v101, v100, s[72:75], s55 offen
    s_mov_b64 exec, -1
    v_lshrrev_b32 v100, 7, v254
    v_and_b32 v102, 0x70, v254
    s_cmp_eq_u32 s42, 3
    s_cbranch_scc1 xp_1
    v_mul_u32_u24 v100, 6144, v100
    v_add_u32 v100, v100, v102
    s_mul_i32 s56, s2, 3
    s_add_u32 s56, s56, s42
    s_and_b32 s55, s56, 15
    s_mul_i32 s55, s55, 393216
    s_lshr_b32 s57, s56, 4
    s_lshl_b32 s57, s57, 7
    s_add_u32 s55, s55, s57
    buffer_load_dwordx4 v[0:3], v100, s[8:11], s55 offen
    s_add_u32 s55, s55, 49152
    buffer_load_dwordx4 v[4:7], v100, s[8:11], s55 offen
    s_add_u32 s55, s55, 49152
    buffer_load_dwordx4 v[8:11], v100, s[8:11], s55 offen
    s_add_u32 s55, s55, 49152
    buffer_load_dwordx4 v[12:15], v100, s[8:11], s55 offen
    s_add_u32 s55, s55, 49152
    buffer_load_dwordx4 v[16:19], v100, s[8:11], s55 offen
    s_add_u32 s55, s55, 49152
    buffer_load_dwordx4 v[20:23], v100, s[8:11], s55 offen
    s_add_u32 s55, s55, 49152
    buffer_load_dwordx4 v[24:27], v100, s[8:11], s55 offen
    s_add_u32 s55, s55, 49152
    buffer_load_dwordx4 v[28:31], v100, s[8:11], s55 offen
    s_add_u32 s55, s55, 49152
    v_mov_b32 v64, 0
    v_mov_b32 v65, 0
    v_mov_b32 v66, 0
    v_mov_b32 v67, 0
    v_mov_b32 v68, 0
    v_mov_b32 v69, 0
    v_mov_b32 v70, 0
    v_mov_b32 v71, 0
    v_mov_b32 v102, 0x00003f80
    v_mov_b32 v103, 0x3f800000
    s_waitcnt vmcnt(7)
    v_dot2_f32_bf16 v64, v0, v102, v64
    v_dot2_f32_bf16 v65, v0, v103, v65
    v_dot2_f32_bf16 v66, v1, v102, v66
    v_dot2_f32_bf16 v67, v1, v103, v67
    v_dot2_f32_bf16 v68, v2, v102, v68
    v_dot2_f32_bf16 v69, v2, v103, v69
    v_dot2_f32_bf16 v70, v3, v102, v70
    v_dot2_f32_bf16 v71, v3, v103, v71
    s_waitcnt vmcnt(6)
    v_dot2_f32_bf16 v64, v4, v102, v64
    v_dot2_f32_bf16 v65, v4, v103, v65
    v_dot2_f32_bf16 v66, v5, v102, v66
    v_dot2_f32_bf16 v67, v5, v103, v67
    v_dot2_f32_bf16 v68, v6, v102, v68
    v_dot2_f32_bf16 v69, v6, v103, v69
    v_dot2_f32_bf16 v70, v7, v102, v70
    v_dot2_f32_bf16 v71, v7, v103, v71
    s_waitcnt vmcnt(5)
    v_dot2_f32_bf16 v64, v8, v102, v64
    v_dot2_f32_bf16 v65, v8, v103, v65
    v_dot2_f32_bf16 v66, v9, v102, v66
    v_dot2_f32_bf16 v67, v9, v103, v67
    v_dot2_f32_bf16 v68, v10, v102, v68
    v_dot2_f32_bf16 v69, v10, v103, v69
    v_dot2_f32_bf16 v70, v11, v102, v70
    v_dot2_f32_bf16 v71, v11, v103, v71
    s_waitcnt vmcnt(4)
    v_dot2_f32_bf16 v64, v12, v102, v64
    v_dot2_f32_bf16 v65, v12, v103, v65
    v_dot2_f32_bf16 v66, v13, v102, v66
    v_dot2_f32_bf16 v67, v13, v103, v67
    v_dot2_f32_bf16 v68, v14, v102, v68
    v_dot2_f32_bf16 v69, v14, v103, v69
    v_dot2_f32_bf16 v70, v15, v102, v70
    v_dot2_f32_bf16 v71, v15, v103, v71
    s_waitcnt vmcnt(3)
    v_dot2_f32_bf16 v64, v16, v102, v64
    v_dot2_f32_bf16 v65, v16, v103, v65
    v_dot2_f32_bf16 v66, v17, v102, v66
    v_dot2_f32_bf16 v67, v17, v103, v67
    v_dot2_f32_bf16 v68, v18, v102, v68
    v_dot2_f32_bf16 v69, v18, v103, v69
    v_dot2_f32_bf16 v70, v19, v102, v70
    v_dot2_f32_bf16 v71, v19, v103, v71
    s_waitcnt vmcnt(2)
    v_dot2_f32_bf16 v64, v20, v102, v64
    v_dot2_f32_bf16 v65, v20, v103, v65
    v_dot2_f32_bf16 v66, v21, v102, v66
    v_dot2_f32_bf16 v67, v21, v103, v67
    v_dot2_f32_bf16 v68, v22, v102, v68
    v_dot2_f32_bf16 v69, v22, v103, v69
    v_dot2_f32_bf16 v70, v23, v102, v70
    v_dot2_f32_bf16 v71, v23, v103, v71
    s_waitcnt vmcnt(1)
    v_dot2_f32_bf16 v64, v24, v102, v64
    v_dot2_f32_bf16 v65, v24, v103, v65
    v_dot2_f32_bf16 v66, v25, v102, v66
    v_dot2_f32_bf16 v67, v25, v103, v67
    v_dot2_f32_bf16 v68, v26, v102, v68
    v_dot2_f32_bf16 v69, v26, v103, v69
    v_dot2_f32_bf16 v70, v27, v102, v70
    v_dot2_f32_bf16 v71, v27, v103, v71
    s_waitcnt vmcnt(0)
    v_dot2_f32_bf16 v64, v28, v102, v64
    v_dot2_f32_bf16 v65, v28, v103, v65
    v_dot2_f32_bf16 v66, v29, v102, v66
    v_dot2_f32_bf16 v67, v29, v103, v67
    v_dot2_f32_bf16 v68, v30, v102, v68
    v_dot2_f32_bf16 v69, v30, v103, v69
    v_dot2_f32_bf16 v70, v31, v102, v70
    v_dot2_f32_bf16 v71, v31, v103, v71
    s_nop 3
    v_add_f32_dpp v64, v64, v64 row_ror:8 row_mask:0xf bank_mask:0xf
    v_add_f32_dpp v65, v65, v65 row_ror:8 row_mask:0xf bank_mask:0xf
    v_add_f32_dpp v66, v66, v66 row_ror:8 row_mask:0xf bank_mask:0xf
    v_add_f32_dpp v67, v67, v67 row_ror:8 row_mask:0xf bank_mask:0xf
    v_add_f32_dpp v68, v68, v68 row_ror:8 row_mask:0xf bank_mask:0xf
    v_add_f32_dpp v69, v69, v69 row_ror:8 row_mask:0xf bank_mask:0xf
    v_add_f32_dpp v70, v70, v70 row_ror:8 row_mask:0xf bank_mask:0xf
    v_add_f32_dpp v71, v71, v71 row_ror:8 row_mask:0xf bank_mask:0xf
    v_mov_b32 v80, v64
    v_mov_b32 v81, v65
    v_mov_b32 v82, v66
    v_mov_b32 v83, v67
    v_mov_b32 v84, v68
    v_mov_b32 v85, v69
    v_mov_b32 v86, v70
    v_mov_b32 v87, v71
    s_nop 1
    v_permlane16_swap_b32 v64, v80
    v_permlane16_swap_b32 v65, v81
    v_permlane16_swap_b32 v66, v82
    v_permlane16_swap_b32 v67, v83
    v_permlane16_swap_b32 v68, v84
    v_permlane16_swap_b32 v69, v85
    v_permlane16_swap_b32 v70, v86
    v_permlane16_swap_b32 v71, v87
    v_add_f32 v64, v64, v80
    v_add_f32 v65, v65, v81
    v_add_f32 v66, v66, v82
    v_add_f32 v67, v67, v83
    v_add_f32 v68, v68, v84
    v_add_f32 v69, v69, v85
    v_add_f32 v70, v70, v86
    v_add_f32 v71, v71, v87
    v_mov_b32 v80, v64
    v_mov_b32 v81, v65
    v_mov_b32 v82, v66
    v_mov_b32 v83, v67
    v_mov_b32 v84, v68
    v_mov_b32 v85, v69
    v_mov_b32 v86, v70
    v_mov_b32 v87, v71
    s_nop 1
    v_permlane32_swap_b32 v64, v80
    v_permlane32_swap_b32 v65, v81
    v_permlane32_swap_b32 v66, v82
    v_permlane32_swap_b32 v67, v83
    v_permlane32_swap_b32 v68, v84
    v_permlane32_swap_b32 v69, v85
    v_permlane32_swap_b32 v70, v86
    v_permlane32_swap_b32 v71, v87
    v_add_f32 v64, v64, v80
    v_add_f32 v65, v65, v81
    v_add_f32 v66, v66, v82
    v_add_f32 v67, v67, v83
    v_add_f32 v68, v68, v84
    v_add_f32 v69, v69, v85
    v_add_f32 v70, v70, v86
    v_add_f32 v71, v71, v87
    s_and_b32 s55, s56, 15
    s_mul_i32 s55, s55, 12288
    s_lshl_b32 s57, s57, 1
    s_add_u32 s55, s55, s57
    s_add_u32 s55, s55, 70516736
    v_lshlrev_b32 v100, 1, v254
    s_mov_b64 exec, 0xff
    buffer_store_dwordx4 v[64:67], v100, s[4:7], s55 offen sc0 sc1
    buffer_store_dwordx4 v[68:71], v100, s[4:7], s55 offen offset:16 sc0 sc1
    s_mov_b64 exec, -1
    s_branch xp_2
xp_1:
    v_lshl_add_u32 v100, v100, 11, v102
    s_lshl_b32 s55, s2, 14
    buffer_load_dwordx4 v[0:3], v100, s[24:27], s55 offen offset:0
    buffer_load_dwordx4 v[4:7], v100, s[24:27], s55 offen offset:128
    buffer_load_dwordx4 v[8:11], v100, s[24:27], s55 offen offset:256
    buffer_load_dwordx4 v[12:15], v100, s[24:27], s55 offen offset:384
    buffer_load_dwordx4 v[16:19], v100, s[24:27], s55 offen offset:512
    buffer_load_dwordx4 v[20:23], v100, s[24:27], s55 offen offset:640
    buffer_load_dwordx4 v[24:27], v100, s[24:27], s55 offen offset:768
    buffer_load_dwordx4 v[28:31], v100, s[24:27], s55 offen offset:896
    buffer_load_dwordx4 v[32:35], v100, s[24:27], s55 offen offset:1024
    buffer_load_dwordx4 v[36:39], v100, s[24:27], s55 offen offset:1152
    buffer_load_dwordx4 v[40:43], v100, s[24:27], s55 offen offset:1280
    buffer_load_dwordx4 v[44:47], v100, s[24:27], s55 offen offset:1408
    buffer_load_dwordx4 v[48:51], v100, s[24:27], s55 offen offset:1536
    buffer_load_dwordx4 v[52:55], v100, s[24:27], s55 offen offset:1664
    buffer_load_dwordx4 v[56:59], v100, s[24:27], s55 offen offset:1792
    buffer_load_dwordx4 v[60:63], v100, s[24:27], s55 offen offset:1920
    v_mov_b32 v64, 0
    v_mov_b32 v65, 0
    v_mov_b32 v66, 0
    v_mov_b32 v67, 0
    v_mov_b32 v102, 0x3f803f80
    s_waitcnt vmcnt(15)
    v_dot2_f32_bf16 v64, v0, v102, v64
    v_dot2_f32_bf16 v65, v0, v0, v65
    v_dot2_f32_bf16 v66, v1, v102, v66
    v_dot2_f32_bf16 v67, v1, v1, v67
    v_dot2_f32_bf16 v64, v2, v102, v64
    v_dot2_f32_bf16 v65, v2, v2, v65
    v_dot2_f32_bf16 v66, v3, v102, v66
    v_dot2_f32_bf16 v67, v3, v3, v67
    s_waitcnt vmcnt(14)
    v_dot2_f32_bf16 v64, v4, v102, v64
    v_dot2_f32_bf16 v65, v4, v4, v65
    v_dot2_f32_bf16 v66, v5, v102, v66
    v_dot2_f32_bf16 v67, v5, v5, v67
    v_dot2_f32_bf16 v64, v6, v102, v64
    v_dot2_f32_bf16 v65, v6, v6, v65
    v_dot2_f32_bf16 v66, v7, v102, v66
    v_dot2_f32_bf16 v67, v7, v7, v67
    s_waitcnt vmcnt(13)
    v_dot2_f32_bf16 v64, v8, v102, v64
    v_dot2_f32_bf16 v65, v8, v8, v65
    v_dot2_f32_bf16 v66, v9, v102, v66
    v_dot2_f32_bf16 v67, v9, v9, v67
    v_dot2_f32_bf16 v64, v10, v102, v64
    v_dot2_f32_bf16 v65, v10, v10, v65
    v_dot2_f32_bf16 v66, v11, v102, v66
    v_dot2_f32_bf16 v67, v11, v11, v67
    s_waitcnt vmcnt(12)
    v_dot2_f32_bf16 v64, v12, v102, v64
    v_dot2_f32_bf16 v65, v12, v12, v65
    v_dot2_f32_bf16 v66, v13, v102, v66
    v_dot2_f32_bf16 v67, v13, v13, v67
    v_dot2_f32_bf16 v64, v14, v102, v64
    v_dot2_f32_bf16 v65, v14, v14, v65
    v_dot2_f32_bf16 v66, v15, v102, v66
    v_dot2_f32_bf16 v67, v15, v15, v67
    s_waitcnt vmcnt(11)
    v_dot2_f32_bf16 v64, v16, v102, v64
    v_dot2_f32_bf16 v65, v16, v16, v65
    v_dot2_f32_bf16 v66, v17, v102, v66
    v_dot2_f32_bf16 v67, v17, v17, v67
    v_dot2_f32_bf16 v64, v18, v102, v64
    v_dot2_f32_bf16 v65, v18, v18, v65
    v_dot2_f32_bf16 v66, v19, v102, v66
    v_dot2_f32_bf16 v67, v19, v19, v67
    s_waitcnt vmcnt(10)
    v_dot2_f32_bf16 v64, v20, v102, v64
    v_dot2_f32_bf16 v65, v20, v20, v65
    v_dot2_f32_bf16 v66, v21, v102, v66
    v_dot2_f32_bf16 v67, v21, v21, v67
    v_dot2_f32_bf16 v64, v22, v102, v64
    v_dot2_f32_bf16 v65, v22, v22, v65
    v_dot2_f32_bf16 v66, v23, v102, v66
    v_dot2_f32_bf16 v67, v23, v23, v67
    s_waitcnt vmcnt(9)
    v_dot2_f32_bf16 v64, v24, v102, v64
    v_dot2_f32_bf16 v65, v24, v24, v65
    v_dot2_f32_bf16 v66, v25, v102, v66
    v_dot2_f32_bf16 v67, v25, v25, v67
    v_dot2_f32_bf16 v64, v26, v102, v64
    v_dot2_f32_bf16 v65, v26, v26, v65
    v_dot2_f32_bf16 v66, v27, v102, v66
    v_dot2_f32_bf16 v67, v27, v27, v67
    s_waitcnt vmcnt(8)
    v_dot2_f32_bf16 v64, v28, v102, v64
    v_dot2_f32_bf16 v65, v28, v28, v65
    v_dot2_f32_bf16 v66, v29, v102, v66
    v_dot2_f32_bf16 v67, v29, v29, v67
    v_dot2_f32_bf16 v64, v30, v102, v64
    v_dot2_f32_bf16 v65, v30, v30, v65
    v_dot2_f32_bf16 v66, v31, v102, v66
    v_dot2_f32_bf16 v67, v31, v31, v67
    s_waitcnt vmcnt(7)
    v_dot2_f32_bf16 v64, v32, v102, v64
    v_dot2_f32_bf16 v65, v32, v32, v65
    v_dot2_f32_bf16 v66, v33, v102, v66
    v_dot2_f32_bf16 v67, v33, v33, v67
    v_dot2_f32_bf16 v64, v34, v102, v64
    v_dot2_f32_bf16 v65, v34, v34, v65
    v_dot2_f32_bf16 v66, v35, v102, v66
    v_dot2_f32_bf16 v67, v35, v35, v67
    s_waitcnt vmcnt(6)
    v_dot2_f32_bf16 v64, v36, v102, v64
    v_dot2_f32_bf16 v65, v36, v36, v65
    v_dot2_f32_bf16 v66, v37, v102, v66
    v_dot2_f32_bf16 v67, v37, v37, v67
    v_dot2_f32_bf16 v64, v38, v102, v64
    v_dot2_f32_bf16 v65, v38, v38, v65
    v_dot2_f32_bf16 v66, v39, v102, v66
    v_dot2_f32_bf16 v67, v39, v39, v67
    s_waitcnt vmcnt(5)
    v_dot2_f32_bf16 v64, v40, v102, v64
    v_dot2_f32_bf16 v65, v40, v40, v65
    v_dot2_f32_bf16 v66, v41, v102, v66
    v_dot2_f32_bf16 v67, v41, v41, v67
    v_dot2_f32_bf16 v64, v42, v102, v64
    v_dot2_f32_bf16 v65, v42, v42, v65
    v_dot2_f32_bf16 v66, v43, v102, v66
    v_dot2_f32_bf16 v67, v43, v43, v67
    s_waitcnt vmcnt(4)
    v_dot2_f32_bf16 v64, v44, v102, v64
    v_dot2_f32_bf16 v65, v44, v44, v65
    v_dot2_f32_bf16 v66, v45, v102, v66
    v_dot2_f32_bf16 v67, v45, v45, v67
    v_dot2_f32_bf16 v64, v46, v102, v64
    v_dot2_f32_bf16 v65, v46, v46, v65
    v_dot2_f32_bf16 v66, v47, v102, v66
    v_dot2_f32_bf16 v67, v47, v47, v67
    s_waitcnt vmcnt(3)
    v_dot2_f32_bf16 v64, v48, v102, v64
    v_dot2_f32_bf16 v65, v48, v48, v65
    v_dot2_f32_bf16 v66, v49, v102, v66
    v_dot2_f32_bf16 v67, v49, v49, v67
    v_dot2_f32_bf16 v64, v50, v102, v64
    v_dot2_f32_bf16 v65, v50, v50, v65
    v_dot2_f32_bf16 v66, v51, v102, v66
    v_dot2_f32_bf16 v67, v51, v51, v67
    s_waitcnt vmcnt(2)
    v_dot2_f32_bf16 v64, v52, v102, v64
    v_dot2_f32_bf16 v65, v52, v52, v65
    v_dot2_f32_bf16 v66, v53, v102, v66
    v_dot2_f32_bf16 v67, v53, v53, v67
    v_dot2_f32_bf16 v64, v54, v102, v64
    v_dot2_f32_bf16 v65, v54, v54, v65
    v_dot2_f32_bf16 v66, v55, v102, v66
    v_dot2_f32_bf16 v67, v55, v55, v67
    s_waitcnt vmcnt(1)
    v_dot2_f32_bf16 v64, v56, v102, v64
    v_dot2_f32_bf16 v65, v56, v56, v65
    v_dot2_f32_bf16 v66, v57, v102, v66
    v_dot2_f32_bf16 v67, v57, v57, v67
    v_dot2_f32_bf16 v64, v58, v102, v64
    v_dot2_f32_bf16 v65, v58, v58, v65
    v_dot2_f32_bf16 v66, v59, v102, v66
    v_dot2_f32_bf16 v67, v59, v59, v67
    s_waitcnt vmcnt(0)
    v_dot2_f32_bf16 v64, v60, v102, v64
    v_dot2_f32_bf16 v65, v60, v60, v65
    v_dot2_f32_bf16 v66, v61, v102, v66
    v_dot2_f32_bf16 v67, v61, v61, v67
    v_dot2_f32_bf16 v64, v62, v102, v64
    v_dot2_f32_bf16 v65, v62, v62, v65
    v_dot2_f32_bf16 v66, v63, v102, v66
    v_dot2_f32_bf16 v67, v63, v63, v67
    s_nop 3
    v_add_f32 v64, v64, v66
    v_add_f32 v65, v65, v67
    s_nop 1
    v_add_f32_dpp v64, v64, v64 quad_perm:[1,0,3,2] row_mask:0xf bank_mask:0xf
    v_add_f32_dpp v65, v65, v65 quad_perm:[1,0,3,2] row_mask:0xf bank_mask:0xf
    s_nop 1
    v_add_f32_dpp v64, v64, v64 quad_perm:[2,3,0,1] row_mask:0xf bank_mask:0xf
    v_add_f32_dpp v65, v65, v65 quad_perm:[2,3,0,1] row_mask:0xf bank_mask:0xf
    s_nop 1
    v_add_f32_dpp v64, v64, v64 row_half_mirror row_mask:0xf bank_mask:0xf
    v_add_f32_dpp v65, v65, v65 row_half_mirror row_mask:0xf bank_mask:0xf
    v_lshrrev_b32 v100, 4, v254
    s_lshl_b32 s55, s2, 6
    s_add_u32 s55, s55, 70254592
    s_mov_b32 s70, 0x01010101
    s_mov_b32 s71, 0x01010101
    s_mov_b64 exec, s[70:71]
    buffer_store_dwordx2 v[64:65], v100, s[4:7], s55 offen sc0 sc1
    s_mov_b64 exec, -1
xp_2:
    v_and_b32 v100, 0xf0, v254
    v_lshlrev_b32 v100, 7, v100
    v_lshrrev_b32 v102, 8, v254
    v_lshl_add_u32 v100, v102, 3, v100
    s_lshl_b32 s55, s40, 18
    s_lshl_b32 s56, s43, 17
    s_add_u32 s55, s55, s56
    s_lshl_b32 s56, s51, 7
    s_add_u32 s55, s55, s56
    s_lshl_b32 s56, s44, 6
    s_add_u32 s55, s55, s56
    buffer_load_dwordx2 v[236:237], v100, s[24:27], s55 offen offset:0
    buffer_load_dwordx2 v[238:239], v100, s[24:27], s55 offen offset:32
    s_add_u32 s55, s55, 32768
    buffer_load_dwordx2 v[240:241], v100, s[24:27], s55 offen offset:0
    buffer_load_dwordx2 v[242:243], v100, s[24:27], s55 offen offset:32
    s_add_u32 s55, s55, 32768
    buffer_load_dwordx2 v[244:245], v100, s[24:27], s55 offen offset:0
    buffer_load_dwordx2 v[246:247], v100, s[24:27], s55 offen offset:32
    s_add_u32 s55, s55, 32768
    buffer_load_dwordx2 v[248:249], v100, s[24:27], s55 offen offset:0
    buffer_load_dwordx2 v[250:251], v100, s[24:27], s55 offen offset:32
    s_add_u32 s55, s55, 32768
X_layer:
    v_lshrrev_b32 v206, 4, v254
    v_lshrrev_b32 v207, 8, v254
    v_and_b32 v208, 15, v206
    s_lshl_b32 s55, s44, 13
    s_add_u32 s55, s55, 98304
    s_cmp_lg_u32 s46, 0
    s_cbranch_scc1 g1_3
    v_and_b32 v210, 6, v208
    v_xor_b32 v210, v210, v207
    v_lshlrev_b32 v210, 4, v210
    v_lshl_add_u32 v200, v208, 7, v210
    v_xor_b32 v201, 64, v200
    s_branch g1_4
g1_3:
    v_mov_b32 v200, v254
    v_add_u32 v201, 1024, v254
g1_4:
    v_add_u32 v200, s55, v200
    v_add_u32 v201, s55, v201
    v_lshrrev_b32 v209, 6, v254
    v_lshrrev_b32 v210, 1, v209
    v_and_b32 v210, 3, v210
    s_lshl_b32 s55, s43, 1
    v_xor_b32 v210, s55, v210
    v_lshlrev_b32 v209, 7, v209
    v_lshl_add_u32 v209, v210, 5, v209
    v_and_b32 v210, 0x30, v254
    v_lshrrev_b32 v210, 1, v210
    v_add_u32 v202, v209, v210
    v_xor_b32 v203, 32, v202
    v_add_u32 v204, 49152, v202
    v_add_u32 v205, 49152, v203
    v_mov_b32 v0, 0
    v_mov_b32 v1, 0
    v_mov_b32 v2, 0
    v_mov_b32 v3, 0
    v_mov_b32 v4, 0
    v_mov_b32 v5, 0
    v_mov_b32 v6, 0
    v_mov_b32 v7, 0
    v_mov_b32 v8, 0
    v_mov_b32 v9, 0
    v_mov_b32 v10, 0
    v_mov_b32 v11, 0
    v_mov_b32 v12, 0
    v_mov_b32 v13, 0
    v_mov_b32 v14, 0
    v_mov_b32 v15, 0
    v_mov_b32 v16, 0
    v_mov_b32 v17, 0
    v_mov_b32 v18, 0
    v_mov_b32 v19, 0
    v_mov_b32 v20, 0
    v_mov_b32 v21, 0
    v_mov_b32 v22, 0
    v_mov_b32 v23, 0
    v_mov_b32 v24, 0
    v_mov_b32 v25, 0
    v_mov_b32 v26, 0
    v_mov_b32 v27, 0
    v_mov_b32 v28, 0
    v_mov_b32 v29, 0
    v_mov_b32 v30, 0
    v_mov_b32 v31, 0
    v_mov_b32 v32, 0
    v_mov_b32 v33, 0
    v_mov_b32 v34, 0
    v_mov_b32 v35, 0
    v_mov_b32 v36, 0
    v_mov_b32 v37, 0
    v_mov_b32 v38, 0
    v_mov_b32 v39, 0
    v_mov_b32 v40, 0
    v_mov_b32 v41, 0
    v_mov_b32 v42, 0
    v_mov_b32 v43, 0
    v_mov_b32 v44, 0
    v_mov_b32 v45, 0
    v_mov_b32 v46, 0
    v_mov_b32 v47, 0
    v_mov_b32 v48, 0
    v_mov_b32 v49, 0
    v_mov_b32 v50, 0
    v_mov_b32 v51, 0
    v_mov_b32 v52, 0
    v_mov_b32 v53, 0
    v_mov_b32 v54, 0
    v_mov_b32 v55, 0
    v_mov_b32 v56, 0
    v_mov_b32 v57, 0
    v_mov_b32 v58, 0
    v_mov_b32 v59, 0
    v_mov_b32 v60, 0
    v_mov_b32 v61, 0
    v_mov_b32 v62, 0
    v_mov_b32 v63, 0
    v_mov_b32 v64, 0
    v_mov_b32 v65, 0
    v_mov_b32 v66, 0
    v_mov_b32 v67, 0
    v_mov_b32 v68, 0
    v_mov_b32 v69, 0
    v_mov_b32 v70, 0
    v_mov_b32 v71, 0
    v_mov_b32 v72, 0
    v_mov_b32 v73, 0
    v_mov_b32 v74, 0
    v_mov_b32 v75, 0
    v_mov_b32 v76, 0
    v_mov_b32 v77, 0
    v_mov_b32 v78, 0
    v_mov_b32 v79, 0
    v_mov_b32 v80, 0
    v_mov_b32 v81, 0
    v_mov_b32 v82, 0
    v_mov_b32 v83, 0
    v_mov_b32 v84, 0
    v_mov_b32 v85, 0
    v_mov_b32 v86, 0
    v_mov_b32 v87, 0
    v_mov_b32 v88, 0
    v_mov_b32 v89, 0
    v_mov_b32 v90, 0
    v_mov_b32 v91, 0
    v_mov_b32 v92, 0
    v_mov_b32 v93, 0
    v_mov_b32 v94, 0
    v_mov_b32 v95, 0
    v_mov_b32 v96, 0
    v_mov_b32 v97, 0
    v_mov_b32 v98, 0
    v_mov_b32 v99, 0
    v_mov_b32 v100, 0
    v_mov_b32 v101, 0
    v_mov_b32 v102, 0
    v_mov_b32 v103, 0
    v_mov_b32 v104, 0
    v_mov_b32 v105, 0
    v_mov_b32 v106, 0
    v_mov_b32 v107, 0
    v_mov_b32 v108, 0
    v_mov_b32 v109, 0
    v_mov_b32 v110, 0
    v_mov_b32 v111, 0
    s_lshl_b32 s55, s51, 14
    s_lshl_b32 s56, s44, 13
    s_add_u32 s55, s55, s56
    s_lshl_b32 s56, s43, 10
    s_add_u32 s55, s55, s56
    s_add_u32 s62, s55, s47
    v_lshlrev_b32 v209, 2, v207
    v_sub_u32 v209, v208, v209
    v_cmp_le_i32 s[72:73], 0, v209
    v_cmp_le_i32 s[74:75], 1, v209
    v_cmp_le_i32 s[76:77], 2, v209
    v_cmp_le_i32 s[78:79], 3, v209
    v_and_b32 v210, 1, v208
    v_cmp_eq_u32 s[80:81], 1, v210
    v_sub_u32 v209, v209, v210
    v_mov_b32 v212, 0x0c0c0c0c
    v_mov_b32 v210, 0xc0c0100
    v_mov_b32 v211, 0x1000c0c
    v_cmp_le_i32 vcc, 0, v209
    v_cndmask_b32 v210, v210, v211, s[80:81]
    s_not_b64 s[82:83], vcc
    v_cndmask_b32 v214, v210, v212, vcc
    v_cndmask_b32 v216, v212, v210, vcc
    v_mov_b32 v210, 0xc0c0302
    v_mov_b32 v211, 0x3020c0c
    v_cmp_le_i32 vcc, 2, v209
    v_cndmask_b32 v210, v210, v211, s[80:81]
    s_not_b64 s[84:85], vcc
    v_cndmask_b32 v215, v210, v212, vcc
    v_cndmask_b32 v217, v212, v210, vcc
    s_or_b32 s55, s40, s44
    s_cmp_eq_u32 s55, 0
    s_cselect_b64 s[82:83], s[82:83], 0
    s_cselect_b64 s[84:85], s[84:85], 0
    s_lshl_b32 s55, s44, 8
    s_add_u32 s55, s55, 153600
    v_lshlrev_b32 v218, 2, v208
    v_add_u32 v218, s55, v218
    v_lshlrev_b32 v219, 4, v207
    v_add_u32 v219, s55, v219
    s_lshl_b32 s55, s43, 7
    s_add_u32 s55, s55, 154752
    v_lshlrev_b32 v220, 4, v207
    v_add_u32 v220, s55, v220
    v_lshlrev_b32 v221, 2, v208
    v_add_u32 v221, s55, v221
    v_mov_b32 v222, 0x3f803f80
    v_mov_b32 v223, 0x3f803f80
    v_mov_b32 v224, 0x3f803f80
    v_mov_b32 v225, 0x3f803f80
    v_mov_b32 v213, 157568
    s_cmp_eq_u32 s46, 0
    s_cbranch_scc1 g1_5
    s_waitcnt vmcnt(1)
    s_barrier
g1_5:
    s_barrier
    ds_read_b64_tr_b16 v[152:153], v202 offset:0
    ds_read_b64_tr_b16 v[154:155], v202 offset:2048
    ds_read_b128 v[116:119], v200 offset:2048
    ds_read_b128 v[120:123], v200 offset:4096
    ds_read_b128 v[124:127], v200 offset:6144
    ds_read_b128 v[128:131], v200 offset:8192
    ds_read_b64_tr_b16 v[156:157], v203 offset:0
    ds_read_b64_tr_b16 v[158:159], v203 offset:2048
    ds_read_b64_tr_b16 v[160:161], v202 offset:4096
    ds_read_b64_tr_b16 v[162:163], v202 offset:6144
    ds_read_b128 v[112:115], v200 offset:0
    ds_read_b64_tr_b16 v[164:165], v203 offset:4096
    ds_read_b64_tr_b16 v[166:167], v203 offset:6144
    ds_read_b64_tr_b16 v[168:169], v202 offset:8192
    ds_read_b64_tr_b16 v[170:171], v202 offset:10240
    ds_read_b64_tr_b16 v[172:173], v203 offset:8192
    ds_read_b64_tr_b16 v[174:175], v203 offset:10240
    s_mov_b32 s58, 5
    .p2align 3
loop_6:
    s_waitcnt lgkmcnt(0)
    s_barrier
    .p2align 3
    v_mfma_f32_16x16x32_bf16 v[0:3], v[152:155], v[116:119], v[0:3]
    ds_read_b64_tr_b16 v[176:177], v202 offset:16384
    v_mfma_f32_16x16x32_bf16 v[8:11], v[152:155], v[120:123], v[8:11]
    ds_read_b64_tr_b16 v[178:179], v202 offset:18432
    v_mfma_f32_16x16x32_bf16 v[16:19], v[152:155], v[124:127], v[16:19]
    ds_read_b128 v[136:139], v201 offset:2048
    v_mfma_f32_16x16x32_bf16 v[24:27], v[152:155], v[128:131], v[24:27]
    ds_read_b128 v[140:143], v201 offset:4096
    v_mfma_f32_16x16x32_bf16 v[4:7], v[156:159], v[116:119], v[4:7]
    ds_read_b128 v[144:147], v201 offset:6144
    v_mfma_f32_16x16x32_bf16 v[12:15], v[156:159], v[120:123], v[12:15]
    v_mfma_f32_16x16x32_bf16 v[20:23], v[156:159], v[124:127], v[20:23]
    ds_read_b128 v[148:151], v201 offset:8192
    v_mfma_f32_16x16x32_bf16 v[28:31], v[156:159], v[128:131], v[28:31]
    ds_read_b64_tr_b16 v[180:181], v203 offset:16384
    v_mfma_f32_16x16x32_bf16 v[32:35], v[160:163], v[112:115], v[32:35]
    ds_read_b64_tr_b16 v[182:183], v203 offset:18432
    v_mfma_f32_16x16x32_bf16 v[40:43], v[160:163], v[116:119], v[40:43]
    ds_read_b64_tr_b16 v[184:185], v202 offset:20480
    v_mfma_f32_16x16x32_bf16 v[48:51], v[160:163], v[120:123], v[48:51]
    v_mfma_f32_16x16x32_bf16 v[56:59], v[160:163], v[124:127], v[56:59]
    ds_read_b64_tr_b16 v[186:187], v202 offset:22528
    v_mfma_f32_16x16x32_bf16 v[64:67], v[160:163], v[128:131], v[64:67]
    ds_read_b128 v[132:135], v201 offset:0
    v_mfma_f32_16x16x32_bf16 v[36:39], v[164:167], v[112:115], v[36:39]
    ds_read_b64_tr_b16 v[188:189], v203 offset:20480
    v_mfma_f32_16x16x32_bf16 v[44:47], v[164:167], v[116:119], v[44:47]
    ds_read_b64_tr_b16 v[190:191], v203 offset:22528
    v_mfma_f32_16x16x32_bf16 v[52:55], v[164:167], v[120:123], v[52:55]
    v_mfma_f32_16x16x32_bf16 v[60:63], v[164:167], v[124:127], v[60:63]
    ds_read_b64_tr_b16 v[192:193], v202 offset:24576
    v_mfma_f32_16x16x32_bf16 v[68:71], v[164:167], v[128:131], v[68:71]
    ds_read_b64_tr_b16 v[194:195], v202 offset:26624
    v_mfma_f32_16x16x32_bf16 v[72:75], v[112:115], v[168:171], v[72:75]
    ds_read_b64_tr_b16 v[196:197], v203 offset:24576
    v_mfma_f32_16x16x32_bf16 v[80:83], v[116:119], v[168:171], v[80:83]
    ds_read_b64_tr_b16 v[198:199], v203 offset:26624
    v_mfma_f32_16x16x32_bf16 v[88:91], v[120:123], v[168:171], v[88:91]
    v_mfma_f32_16x16x32_bf16 v[96:99], v[124:127], v[168:171], v[96:99]
    v_mfma_f32_16x16x32_bf16 v[104:107], v[128:131], v[168:171], v[104:107]
    v_mfma_f32_16x16x32_bf16 v[76:79], v[112:115], v[172:175], v[76:79]
    v_mfma_f32_16x16x32_bf16 v[84:87], v[116:119], v[172:175], v[84:87]
    v_mfma_f32_16x16x32_bf16 v[92:95], v[120:123], v[172:175], v[92:95]
    v_mfma_f32_16x16x32_bf16 v[100:103], v[124:127], v[172:175], v[100:103]
    v_mfma_f32_16x16x32_bf16 v[108:111], v[128:131], v[172:175], v[108:111]
    s_waitcnt lgkmcnt(0)
    s_barrier
    .p2align 3
    v_mfma_f32_16x16x32_bf16 v[0:3], v[176:179], v[136:139], v[0:3]
    ds_read_b64_tr_b16 v[152:153], v202 offset:32768
    v_mfma_f32_16x16x32_bf16 v[8:11], v[176:179], v[140:143], v[8:11]
    ds_read_b64_tr_b16 v[154:155], v202 offset:34816
    v_mfma_f32_16x16x32_bf16 v[16:19], v[176:179], v[144:147], v[16:19]
    ds_read_b128 v[116:119], v200 offset:20480
    v_mfma_f32_16x16x32_bf16 v[24:27], v[176:179], v[148:151], v[24:27]
    ds_read_b128 v[120:123], v200 offset:22528
    v_mfma_f32_16x16x32_bf16 v[4:7], v[180:183], v[136:139], v[4:7]
    ds_read_b128 v[124:127], v200 offset:24576
    v_mfma_f32_16x16x32_bf16 v[12:15], v[180:183], v[140:143], v[12:15]
    v_mfma_f32_16x16x32_bf16 v[20:23], v[180:183], v[144:147], v[20:23]
    ds_read_b128 v[128:131], v200 offset:26624
    v_mfma_f32_16x16x32_bf16 v[28:31], v[180:183], v[148:151], v[28:31]
    ds_read_b64_tr_b16 v[156:157], v203 offset:32768
    v_mfma_f32_16x16x32_bf16 v[32:35], v[184:187], v[132:135], v[32:35]
    ds_read_b64_tr_b16 v[158:159], v203 offset:34816
    v_mfma_f32_16x16x32_bf16 v[40:43], v[184:187], v[136:139], v[40:43]
    ds_read_b64_tr_b16 v[160:161], v202 offset:36864
    v_mfma_f32_16x16x32_bf16 v[48:51], v[184:187], v[140:143], v[48:51]
    v_mfma_f32_16x16x32_bf16 v[56:59], v[184:187], v[144:147], v[56:59]
    ds_read_b64_tr_b16 v[162:163], v202 offset:38912
    v_mfma_f32_16x16x32_bf16 v[64:67], v[184:187], v[148:151], v[64:67]
    ds_read_b128 v[112:115], v200 offset:18432
    v_mfma_f32_16x16x32_bf16 v[36:39], v[188:191], v[132:135], v[36:39]
    ds_read_b64_tr_b16 v[164:165], v203 offset:36864
    v_mfma_f32_16x16x32_bf16 v[44:47], v[188:191], v[136:139], v[44:47]
    ds_read_b64_tr_b16 v[166:167], v203 offset:38912
    v_mfma_f32_16x16x32_bf16 v[52:55], v[188:191], v[140:143], v[52:55]
    v_mfma_f32_16x16x32_bf16 v[60:63], v[188:191], v[144:147], v[60:63]
    ds_read_b64_tr_b16 v[168:169], v202 offset:40960
    v_mfma_f32_16x16x32_bf16 v[68:71], v[188:191], v[148:151], v[68:71]
    ds_read_b64_tr_b16 v[170:171], v202 offset:43008
    v_mfma_f32_16x16x32_bf16 v[72:75], v[132:135], v[192:195], v[72:75]
    ds_read_b64_tr_b16 v[172:173], v203 offset:40960
    v_mfma_f32_16x16x32_bf16 v[80:83], v[136:139], v[192:195], v[80:83]
    ds_read_b64_tr_b16 v[174:175], v203 offset:43008
    v_mfma_f32_16x16x32_bf16 v[88:91], v[140:143], v[192:195], v[88:91]
    v_mfma_f32_16x16x32_bf16 v[96:99], v[144:147], v[192:195], v[96:99]
    v_mfma_f32_16x16x32_bf16 v[104:107], v[148:151], v[192:195], v[104:107]
    v_mfma_f32_16x16x32_bf16 v[76:79], v[132:135], v[196:199], v[76:79]
    v_mfma_f32_16x16x32_bf16 v[84:87], v[136:139], v[196:199], v[84:87]
    v_mfma_f32_16x16x32_bf16 v[92:95], v[140:143], v[196:199], v[92:95]
    v_mfma_f32_16x16x32_bf16 v[100:103], v[144:147], v[196:199], v[100:103]
    v_mfma_f32_16x16x32_bf16 v[108:111], v[148:151], v[196:199], v[108:111]
    s_waitcnt vmcnt(0) lgkmcnt(0)
    s_barrier
    .p2align 3
    v_mfma_f32_16x16x32_bf16 v[0:3], v[152:155], v[116:119], v[0:3]
    ds_read_b64_tr_b16 v[176:177], v204 offset:0
    v_mfma_f32_16x16x32_bf16 v[8:11], v[152:155], v[120:123], v[8:11]
    ds_read_b64_tr_b16 v[178:179], v204 offset:2048
    v_mfma_f32_16x16x32_bf16 v[16:19], v[152:155], v[124:127], v[16:19]
    ds_read_b128 v[136:139], v201 offset:20480
    v_mfma_f32_16x16x32_bf16 v[24:27], v[152:155], v[128:131], v[24:27]
    ds_read_b128 v[140:143], v201 offset:22528
    v_mfma_f32_16x16x32_bf16 v[4:7], v[156:159], v[116:119], v[4:7]
    ds_read_b128 v[144:147], v201 offset:24576
    v_mfma_f32_16x16x32_bf16 v[12:15], v[156:159], v[120:123], v[12:15]
    v_mfma_f32_16x16x32_bf16 v[20:23], v[156:159], v[124:127], v[20:23]
    ds_read_b128 v[148:151], v201 offset:26624
    v_mfma_f32_16x16x32_bf16 v[28:31], v[156:159], v[128:131], v[28:31]
    ds_read_b64_tr_b16 v[180:181], v205 offset:0
    v_mfma_f32_16x16x32_bf16 v[32:35], v[160:163], v[112:115], v[32:35]
    ds_read_b64_tr_b16 v[182:183], v205 offset:2048
    v_mfma_f32_16x16x32_bf16 v[40:43], v[160:163], v[116:119], v[40:43]
    ds_read_b64_tr_b16 v[184:185], v204 offset:4096
    v_mfma_f32_16x16x32_bf16 v[48:51], v[160:163], v[120:123], v[48:51]
    v_mfma_f32_16x16x32_bf16 v[56:59], v[160:163], v[124:127], v[56:59]
    ds_read_b64_tr_b16 v[186:187], v204 offset:6144
    v_mfma_f32_16x16x32_bf16 v[64:67], v[160:163], v[128:131], v[64:67]
    ds_read_b128 v[132:135], v201 offset:18432
    v_mfma_f32_16x16x32_bf16 v[36:39], v[164:167], v[112:115], v[36:39]
    ds_read_b64_tr_b16 v[188:189], v205 offset:4096
    v_mfma_f32_16x16x32_bf16 v[44:47], v[164:167], v[116:119], v[44:47]
    ds_read_b64_tr_b16 v[190:191], v205 offset:6144
    v_mfma_f32_16x16x32_bf16 v[52:55], v[164:167], v[120:123], v[52:55]
    v_mfma_f32_16x16x32_bf16 v[60:63], v[164:167], v[124:127], v[60:63]
    ds_read_b64_tr_b16 v[192:193], v204 offset:8192
    v_mfma_f32_16x16x32_bf16 v[68:71], v[164:167], v[128:131], v[68:71]
    ds_read_b64_tr_b16 v[194:195], v204 offset:10240
    v_mfma_f32_16x16x32_bf16 v[72:75], v[112:115], v[168:171], v[72:75]
    ds_read_b64_tr_b16 v[196:197], v205 offset:8192
    v_mfma_f32_16x16x32_bf16 v[80:83], v[116:119], v[168:171], v[80:83]
    ds_read_b64_tr_b16 v[198:199], v205 offset:10240
    v_mfma_f32_16x16x32_bf16 v[88:91], v[120:123], v[168:171], v[88:91]
    v_mfma_f32_16x16x32_bf16 v[96:99], v[124:127], v[168:171], v[96:99]
    v_mfma_f32_16x16x32_bf16 v[104:107], v[128:131], v[168:171], v[104:107]
    v_mfma_f32_16x16x32_bf16 v[76:79], v[112:115], v[172:175], v[76:79]
    v_mfma_f32_16x16x32_bf16 v[84:87], v[116:119], v[172:175], v[84:87]
    v_mfma_f32_16x16x32_bf16 v[92:95], v[120:123], v[172:175], v[92:95]
    v_mfma_f32_16x16x32_bf16 v[100:103], v[124:127], v[172:175], v[100:103]
    v_mfma_f32_16x16x32_bf16 v[108:111], v[128:131], v[172:175], v[108:111]
    s_waitcnt lgkmcnt(0)
    s_barrier
    .p2align 3
    v_mfma_f32_16x16x32_bf16 v[0:3], v[176:179], v[136:139], v[0:3]
    ds_read_b64_tr_b16 v[152:153], v204 offset:16384
    v_mfma_f32_16x16x32_bf16 v[8:11], v[176:179], v[140:143], v[8:11]
    ds_read_b64_tr_b16 v[154:155], v204 offset:18432
    v_mfma_f32_16x16x32_bf16 v[16:19], v[176:179], v[144:147], v[16:19]
    ds_read_b128 v[116:119], v200 offset:38912
    v_mfma_f32_16x16x32_bf16 v[24:27], v[176:179], v[148:151], v[24:27]
    ds_read_b128 v[120:123], v200 offset:40960
    v_mfma_f32_16x16x32_bf16 v[4:7], v[180:183], v[136:139], v[4:7]
    ds_read_b128 v[124:127], v200 offset:43008
    v_mfma_f32_16x16x32_bf16 v[12:15], v[180:183], v[140:143], v[12:15]
    v_mfma_f32_16x16x32_bf16 v[20:23], v[180:183], v[144:147], v[20:23]
    ds_read_b128 v[128:131], v200 offset:45056
    v_mfma_f32_16x16x32_bf16 v[28:31], v[180:183], v[148:151], v[28:31]
    ds_read_b64_tr_b16 v[156:157], v205 offset:16384
    v_mfma_f32_16x16x32_bf16 v[32:35], v[184:187], v[132:135], v[32:35]
    ds_read_b64_tr_b16 v[158:159], v205 offset:18432
    v_mfma_f32_16x16x32_bf16 v[40:43], v[184:187], v[136:139], v[40:43]
    ds_read_b64_tr_b16 v[160:161], v204 offset:20480
    v_mfma_f32_16x16x32_bf16 v[48:51], v[184:187], v[140:143], v[48:51]
    v_mfma_f32_16x16x32_bf16 v[56:59], v[184:187], v[144:147], v[56:59]
    ds_read_b64_tr_b16 v[162:163], v204 offset:22528
    v_mfma_f32_16x16x32_bf16 v[64:67], v[184:187], v[148:151], v[64:67]
    ds_read_b128 v[112:115], v200 offset:36864
    v_mfma_f32_16x16x32_bf16 v[36:39], v[188:191], v[132:135], v[36:39]
    ds_read_b64_tr_b16 v[164:165], v205 offset:20480
    v_mfma_f32_16x16x32_bf16 v[44:47], v[188:191], v[136:139], v[44:47]
    ds_read_b64_tr_b16 v[166:167], v205 offset:22528
    v_mfma_f32_16x16x32_bf16 v[52:55], v[188:191], v[140:143], v[52:55]
    v_mfma_f32_16x16x32_bf16 v[60:63], v[188:191], v[144:147], v[60:63]
    ds_read_b64_tr_b16 v[168:169], v204 offset:24576
    v_mfma_f32_16x16x32_bf16 v[68:71], v[188:191], v[148:151], v[68:71]
    ds_read_b64_tr_b16 v[170:171], v204 offset:26624
    v_mfma_f32_16x16x32_bf16 v[72:75], v[132:135], v[192:195], v[72:75]
    ds_read_b64_tr_b16 v[172:173], v205 offset:24576
    v_mfma_f32_16x16x32_bf16 v[80:83], v[136:139], v[192:195], v[80:83]
    ds_read_b64_tr_b16 v[174:175], v205 offset:26624
    v_mfma_f32_16x16x32_bf16 v[88:91], v[140:143], v[192:195], v[88:91]
    v_mfma_f32_16x16x32_bf16 v[96:99], v[144:147], v[192:195], v[96:99]
    v_mfma_f32_16x16x32_bf16 v[104:107], v[148:151], v[192:195], v[104:107]
    v_mfma_f32_16x16x32_bf16 v[76:79], v[132:135], v[196:199], v[76:79]
    v_mfma_f32_16x16x32_bf16 v[84:87], v[136:139], v[196:199], v[84:87]
    v_mfma_f32_16x16x32_bf16 v[92:95], v[140:143], v[196:199], v[92:95]
    v_mfma_f32_16x16x32_bf16 v[100:103], v[144:147], v[196:199], v[100:103]
    v_mfma_f32_16x16x32_bf16 v[108:111], v[148:151], v[196:199], v[108:111]
    s_waitcnt lgkmcnt(0)
    s_barrier
    .p2align 3
    v_mfma_f32_16x16x32_bf16 v[0:3], v[152:155], v[116:119], v[0:3]
    ds_read_b64_tr_b16 v[176:177], v204 offset:32768
    v_mfma_f32_16x16x32_bf16 v[8:11], v[152:155], v[120:123], v[8:11]
    ds_read_b64_tr_b16 v[178:179], v204 offset:34816
    v_mfma_f32_16x16x32_bf16 v[16:19], v[152:155], v[124:127], v[16:19]
    ds_read_b128 v[136:139], v201 offset:38912
    v_mfma_f32_16x16x32_bf16 v[24:27], v[152:155], v[128:131], v[24:27]
    ds_read_b128 v[140:143], v201 offset:40960
    v_mfma_f32_16x16x32_bf16 v[4:7], v[156:159], v[116:119], v[4:7]
    ds_read_b128 v[144:147], v201 offset:43008
    v_mfma_f32_16x16x32_bf16 v[12:15], v[156:159], v[120:123], v[12:15]
    v_mfma_f32_16x16x32_bf16 v[20:23], v[156:159], v[124:127], v[20:23]
    ds_read_b128 v[148:151], v201 offset:45056
    v_mfma_f32_16x16x32_bf16 v[28:31], v[156:159], v[128:131], v[28:31]
    ds_read_b64_tr_b16 v[180:181], v205 offset:32768
    v_mfma_f32_16x16x32_bf16 v[32:35], v[160:163], v[112:115], v[32:35]
    ds_read_b64_tr_b16 v[182:183], v205 offset:34816
    v_mfma_f32_16x16x32_bf16 v[40:43], v[160:163], v[116:119], v[40:43]
    ds_read_b64_tr_b16 v[184:185], v204 offset:36864
    v_mfma_f32_16x16x32_bf16 v[48:51], v[160:163], v[120:123], v[48:51]
    v_mfma_f32_16x16x32_bf16 v[56:59], v[160:163], v[124:127], v[56:59]
    ds_read_b64_tr_b16 v[186:187], v204 offset:38912
    v_mfma_f32_16x16x32_bf16 v[64:67], v[160:163], v[128:131], v[64:67]
    ds_read_b128 v[132:135], v201 offset:36864
    v_mfma_f32_16x16x32_bf16 v[36:39], v[164:167], v[112:115], v[36:39]
    ds_read_b64_tr_b16 v[188:189], v205 offset:36864
    v_mfma_f32_16x16x32_bf16 v[44:47], v[164:167], v[116:119], v[44:47]
    ds_read_b64_tr_b16 v[190:191], v205 offset:38912
    v_mfma_f32_16x16x32_bf16 v[52:55], v[164:167], v[120:123], v[52:55]
    v_mfma_f32_16x16x32_bf16 v[60:63], v[164:167], v[124:127], v[60:63]
    ds_read_b64_tr_b16 v[192:193], v204 offset:40960
    v_mfma_f32_16x16x32_bf16 v[68:71], v[164:167], v[128:131], v[68:71]
    ds_read_b64_tr_b16 v[194:195], v204 offset:43008
    v_mfma_f32_16x16x32_bf16 v[72:75], v[112:115], v[168:171], v[72:75]
    ds_read_b64_tr_b16 v[196:197], v205 offset:40960
    v_mfma_f32_16x16x32_bf16 v[80:83], v[116:119], v[168:171], v[80:83]
    ds_read_b64_tr_b16 v[198:199], v205 offset:43008
    v_mfma_f32_16x16x32_bf16 v[88:91], v[120:123], v[168:171], v[88:91]
    v_mfma_f32_16x16x32_bf16 v[96:99], v[124:127], v[168:171], v[96:99]
    v_mfma_f32_16x16x32_bf16 v[104:107], v[128:131], v[168:171], v[104:107]
    v_mfma_f32_16x16x32_bf16 v[76:79], v[112:115], v[172:175], v[76:79]
    v_mfma_f32_16x16x32_bf16 v[84:87], v[116:119], v[172:175], v[84:87]
    v_mfma_f32_16x16x32_bf16 v[92:95], v[120:123], v[172:175], v[92:95]
    v_mfma_f32_16x16x32_bf16 v[100:103], v[124:127], v[172:175], v[100:103]
    v_mfma_f32_16x16x32_bf16 v[108:111], v[128:131], v[172:175], v[108:111]
    s_waitcnt lgkmcnt(0)
    s_barrier
    .p2align 3
    v_mfma_f32_16x16x32_bf16 v[0:3], v[176:179], v[136:139], v[0:3]
    ds_read_b64_tr_b16 v[152:153], v202 offset:0
    v_mfma_f32_16x16x32_bf16 v[8:11], v[176:179], v[140:143], v[8:11]
    ds_read_b64_tr_b16 v[154:155], v202 offset:2048
    v_mfma_f32_16x16x32_bf16 v[16:19], v[176:179], v[144:147], v[16:19]
    ds_read_b128 v[116:119], v200 offset:2048
    v_mfma_f32_16x16x32_bf16 v[24:27], v[176:179], v[148:151], v[24:27]
    ds_read_b128 v[120:123], v200 offset:4096
    v_mfma_f32_16x16x32_bf16 v[4:7], v[180:183], v[136:139], v[4:7]
    ds_read_b128 v[124:127], v200 offset:6144
    v_mfma_f32_16x16x32_bf16 v[12:15], v[180:183], v[140:143], v[12:15]
    v_mfma_f32_16x16x32_bf16 v[20:23], v[180:183], v[144:147], v[20:23]
    ds_read_b128 v[128:131], v200 offset:8192
    v_mfma_f32_16x16x32_bf16 v[28:31], v[180:183], v[148:151], v[28:31]
    ds_read_b64_tr_b16 v[156:157], v203 offset:0
    v_mfma_f32_16x16x32_bf16 v[32:35], v[184:187], v[132:135], v[32:35]
    ds_read_b64_tr_b16 v[158:159], v203 offset:2048
    v_mfma_f32_16x16x32_bf16 v[40:43], v[184:187], v[136:139], v[40:43]
    ds_read_b64_tr_b16 v[160:161], v202 offset:4096
    v_mfma_f32_16x16x32_bf16 v[48:51], v[184:187], v[140:143], v[48:51]
    v_mfma_f32_16x16x32_bf16 v[56:59], v[184:187], v[144:147], v[56:59]
    ds_read_b64_tr_b16 v[162:163], v202 offset:6144
    v_mfma_f32_16x16x32_bf16 v[64:67], v[184:187], v[148:151], v[64:67]
    ds_read_b128 v[112:115], v200 offset:0
    v_mfma_f32_16x16x32_bf16 v[36:39], v[188:191], v[132:135], v[36:39]
    ds_read_b64_tr_b16 v[164:165], v203 offset:4096
    v_mfma_f32_16x16x32_bf16 v[44:47], v[188:191], v[136:139], v[44:47]
    ds_read_b64_tr_b16 v[166:167], v203 offset:6144
    v_mfma_f32_16x16x32_bf16 v[52:55], v[188:191], v[140:143], v[52:55]
    v_mfma_f32_16x16x32_bf16 v[60:63], v[188:191], v[144:147], v[60:63]
    ds_read_b64_tr_b16 v[168:169], v202 offset:8192
    v_mfma_f32_16x16x32_bf16 v[68:71], v[188:191], v[148:151], v[68:71]
    ds_read_b64_tr_b16 v[170:171], v202 offset:10240
    v_mfma_f32_16x16x32_bf16 v[72:75], v[132:135], v[192:195], v[72:75]
    ds_read_b64_tr_b16 v[172:173], v203 offset:8192
    v_mfma_f32_16x16x32_bf16 v[80:83], v[136:139], v[192:195], v[80:83]
    ds_read_b64_tr_b16 v[174:175], v203 offset:10240
    v_mfma_f32_16x16x32_bf16 v[88:91], v[140:143], v[192:195], v[88:91]
    v_mfma_f32_16x16x32_bf16 v[96:99], v[144:147], v[192:195], v[96:99]
    v_mfma_f32_16x16x32_bf16 v[104:107], v[148:151], v[192:195], v[104:107]
    v_mfma_f32_16x16x32_bf16 v[76:79], v[132:135], v[196:199], v[76:79]
    v_mfma_f32_16x16x32_bf16 v[84:87], v[136:139], v[196:199], v[84:87]
    s_sub_u32 s58, s58, 1
    s_cmp_lg_u32 s58, 0
    .p2align 3
    v_mfma_f32_16x16x32_bf16 v[92:95], v[140:143], v[196:199], v[92:95]
    v_mfma_f32_16x16x32_bf16 v[100:103], v[144:147], v[196:199], v[100:103]
    v_mfma_f32_16x16x32_bf16 v[108:111], v[148:151], v[196:199], v[108:111]
    s_cbranch_scc1 loop_6
    s_waitcnt lgkmcnt(0)
    s_barrier
    .p2align 3
    v_mfma_f32_16x16x32_bf16 v[0:3], v[152:155], v[116:119], v[0:3]
    ds_read_b64_tr_b16 v[176:177], v202 offset:16384
    v_mfma_f32_16x16x32_bf16 v[8:11], v[152:155], v[120:123], v[8:11]
    ds_read_b64_tr_b16 v[178:179], v202 offset:18432
    v_mfma_f32_16x16x32_bf16 v[16:19], v[152:155], v[124:127], v[16:19]
    ds_read_b128 v[136:139], v201 offset:2048
    v_mfma_f32_16x16x32_bf16 v[24:27], v[152:155], v[128:131], v[24:27]
    ds_read_b128 v[140:143], v201 offset:4096
    v_mfma_f32_16x16x32_bf16 v[4:7], v[156:159], v[116:119], v[4:7]
    ds_read_b128 v[144:147], v201 offset:6144
    v_mfma_f32_16x16x32_bf16 v[12:15], v[156:159], v[120:123], v[12:15]
    v_mfma_f32_16x16x32_bf16 v[20:23], v[156:159], v[124:127], v[20:23]
    ds_read_b128 v[148:151], v201 offset:8192
    v_mfma_f32_16x16x32_bf16 v[28:31], v[156:159], v[128:131], v[28:31]
    ds_read_b64_tr_b16 v[180:181], v203 offset:16384
    v_mfma_f32_16x16x32_bf16 v[32:35], v[160:163], v[112:115], v[32:35]
    ds_read_b64_tr_b16 v[182:183], v203 offset:18432
    v_mfma_f32_16x16x32_bf16 v[40:43], v[160:163], v[116:119], v[40:43]
    ds_read_b64_tr_b16 v[184:185], v202 offset:20480
    v_mfma_f32_16x16x32_bf16 v[48:51], v[160:163], v[120:123], v[48:51]
    v_mfma_f32_16x16x32_bf16 v[56:59], v[160:163], v[124:127], v[56:59]
    ds_read_b64_tr_b16 v[186:187], v202 offset:22528
    v_mfma_f32_16x16x32_bf16 v[64:67], v[160:163], v[128:131], v[64:67]
    ds_read_b128 v[132:135], v201 offset:0
    v_mfma_f32_16x16x32_bf16 v[36:39], v[164:167], v[112:115], v[36:39]
    ds_read_b64_tr_b16 v[188:189], v203 offset:20480
    v_mfma_f32_16x16x32_bf16 v[44:47], v[164:167], v[116:119], v[44:47]
    ds_read_b64_tr_b16 v[190:191], v203 offset:22528
    v_mfma_f32_16x16x32_bf16 v[52:55], v[164:167], v[120:123], v[52:55]
    v_mfma_f32_16x16x32_bf16 v[60:63], v[164:167], v[124:127], v[60:63]
    ds_read_b64_tr_b16 v[192:193], v202 offset:24576
    v_mfma_f32_16x16x32_bf16 v[68:71], v[164:167], v[128:131], v[68:71]
    ds_read_b64_tr_b16 v[194:195], v202 offset:26624
    v_mfma_f32_16x16x32_bf16 v[72:75], v[112:115], v[168:171], v[72:75]
    ds_read_b64_tr_b16 v[196:197], v203 offset:24576
    v_mfma_f32_16x16x32_bf16 v[80:83], v[116:119], v[168:171], v[80:83]
    ds_read_b64_tr_b16 v[198:199], v203 offset:26624
    v_mfma_f32_16x16x32_bf16 v[88:91], v[120:123], v[168:171], v[88:91]
    v_mfma_f32_16x16x32_bf16 v[96:99], v[124:127], v[168:171], v[96:99]
    v_mfma_f32_16x16x32_bf16 v[104:107], v[128:131], v[168:171], v[104:107]
    v_mfma_f32_16x16x32_bf16 v[76:79], v[112:115], v[172:175], v[76:79]
    v_mfma_f32_16x16x32_bf16 v[84:87], v[116:119], v[172:175], v[84:87]
    v_mfma_f32_16x16x32_bf16 v[92:95], v[120:123], v[172:175], v[92:95]
    v_mfma_f32_16x16x32_bf16 v[100:103], v[124:127], v[172:175], v[100:103]
    v_mfma_f32_16x16x32_bf16 v[108:111], v[128:131], v[172:175], v[108:111]
    s_waitcnt lgkmcnt(0)
    s_barrier
    .p2align 3
    v_mfma_f32_16x16x32_bf16 v[0:3], v[176:179], v[136:139], v[0:3]
    ds_read_b128 v[152:155], v220 offset:0
    v_mfma_f32_16x16x32_bf16 v[8:11], v[176:179], v[140:143], v[8:11]
    ds_read_b128 v[156:159], v220 offset:64
    v_mfma_f32_16x16x32_bf16 v[16:19], v[176:179], v[144:147], v[16:19]
    ds_read_b128 v[160:163], v220 offset:256
    v_mfma_f32_16x16x32_bf16 v[24:27], v[176:179], v[148:151], v[24:27]
    ds_read_b128 v[164:167], v220 offset:320
    v_mfma_f32_16x16x32_bf16 v[4:7], v[180:183], v[136:139], v[4:7]
    ds_read_b32 v112, v218 offset:0
    v_mfma_f32_16x16x32_bf16 v[12:15], v[180:183], v[140:143], v[12:15]
    v_mfma_f32_16x16x32_bf16 v[20:23], v[180:183], v[144:147], v[20:23]
    ds_read_b32 v113, v218 offset:64
    v_mfma_f32_16x16x32_bf16 v[28:31], v[180:183], v[148:151], v[28:31]
    ds_read_b32 v114, v218 offset:128
    v_mfma_f32_16x16x32_bf16 v[32:35], v[184:187], v[132:135], v[32:35]
    ds_read_b32 v115, v218 offset:192
    v_mfma_f32_16x16x32_bf16 v[40:43], v[184:187], v[136:139], v[40:43]
    ds_read_b32 v116, v218 offset:256
    v_mfma_f32_16x16x32_bf16 v[48:51], v[184:187], v[140:143], v[48:51]
    v_mfma_f32_16x16x32_bf16 v[56:59], v[184:187], v[144:147], v[56:59]
    ds_read_b32 v118, v218 offset:576
    v_mfma_f32_16x16x32_bf16 v[64:67], v[184:187], v[148:151], v[64:67]
    ds_read_b32 v119, v218 offset:640
    v_mfma_f32_16x16x32_bf16 v[36:39], v[188:191], v[132:135], v[36:39]
    ds_read_b32 v120, v218 offset:704
    v_mfma_f32_16x16x32_bf16 v[44:47], v[188:191], v[136:139], v[44:47]
    ds_read_b32 v121, v218 offset:768
    v_mfma_f32_16x16x32_bf16 v[52:55], v[188:191], v[140:143], v[52:55]
    v_mfma_f32_16x16x32_bf16 v[60:63], v[188:191], v[144:147], v[60:63]
    ds_read_b32 v122, v218 offset:832
    v_mfma_f32_16x16x32_bf16 v[68:71], v[188:191], v[148:151], v[68:71]
    ds_read_b32 v168, v221 offset:512
    v_mfma_f32_16x16x32_bf16 v[72:75], v[132:135], v[192:195], v[72:75]
    ds_read_b32 v169, v221 offset:576
    v_mfma_f32_16x16x32_bf16 v[80:83], v[136:139], v[192:195], v[80:83]
    ds_read_b32 v170, v213
    v_mfma_f32_16x16x32_bf16 v[88:91], v[140:143], v[192:195], v[88:91]
    v_mfma_f32_16x16x32_bf16 v[96:99], v[144:147], v[192:195], v[96:99]
    v_mfma_f32_16x16x32_bf16 v[104:107], v[148:151], v[192:195], v[104:107]
    v_mfma_f32_16x16x32_bf16 v[76:79], v[132:135], v[196:199], v[76:79]
    v_mfma_f32_16x16x32_bf16 v[84:87], v[136:139], v[196:199], v[84:87]
    v_mfma_f32_16x16x32_bf16 v[92:95], v[140:143], v[196:199], v[92:95]
    v_mfma_f32_16x16x32_bf16 v[100:103], v[144:147], v[196:199], v[100:103]
    v_mfma_f32_16x16x32_bf16 v[108:111], v[148:151], v[196:199], v[108:111]
    s_waitcnt lgkmcnt(0)
    .p2align 3
    ds_read_b128 v[132:135], v219 offset:0
    ds_read_b128 v[176:179], v219 offset:576
    ds_read_b128 v[136:139], v219 offset:64
    ds_read_b128 v[180:183], v219 offset:640
    ds_read_b128 v[140:143], v219 offset:128
    ds_read_b128 v[184:187], v219 offset:704
    ds_read_b128 v[144:147], v219 offset:192
    ds_read_b128 v[188:191], v219 offset:768
    ds_read_b128 v[148:151], v219 offset:256
    ds_read_b128 v[192:195], v219 offset:832
    v_pk_fma_f32 v[0:1], v[112:113], v[152:153], v[0:1] op_sel:[1,0,0] op_sel_hi:[1,1,1]
    v_pk_fma_f32 v[2:3], v[112:113], v[154:155], v[2:3] op_sel:[1,0,0] op_sel_hi:[1,1,1]
    v_pk_fma_f32 v[4:5], v[112:113], v[156:157], v[4:5] op_sel:[1,0,0] op_sel_hi:[1,1,1]
    v_pk_fma_f32 v[6:7], v[112:113], v[158:159], v[6:7] op_sel:[1,0,0] op_sel_hi:[1,1,1]
    v_pk_fma_f32 v[8:9], v[114:115], v[152:153], v[8:9] op_sel:[0,0,0] op_sel_hi:[0,1,1]
    v_pk_fma_f32 v[10:11], v[114:115], v[154:155], v[10:11] op_sel:[0,0,0] op_sel_hi:[0,1,1]
    v_pk_fma_f32 v[12:13], v[114:115], v[156:157], v[12:13] op_sel:[0,0,0] op_sel_hi:[0,1,1]
    v_pk_fma_f32 v[14:15], v[114:115], v[158:159], v[14:15] op_sel:[0,0,0] op_sel_hi:[0,1,1]
    v_pk_fma_f32 v[16:17], v[114:115], v[152:153], v[16:17] op_sel:[1,0,0] op_sel_hi:[1,1,1]
    v_pk_fma_f32 v[18:19], v[114:115], v[154:155], v[18:19] op_sel:[1,0,0] op_sel_hi:[1,1,1]
    v_pk_fma_f32 v[20:21], v[114:115], v[156:157], v[20:21] op_sel:[1,0,0] op_sel_hi:[1,1,1]
    v_pk_fma_f32 v[22:23], v[114:115], v[158:159], v[22:23] op_sel:[1,0,0] op_sel_hi:[1,1,1]
    v_pk_fma_f32 v[24:25], v[116:117], v[152:153], v[24:25] op_sel:[0,0,0] op_sel_hi:[0,1,1]
    v_pk_fma_f32 v[26:27], v[116:117], v[154:155], v[26:27] op_sel:[0,0,0] op_sel_hi:[0,1,1]
    v_pk_fma_f32 v[28:29], v[116:117], v[156:157], v[28:29] op_sel:[0,0,0] op_sel_hi:[0,1,1]
    v_pk_fma_f32 v[30:31], v[116:117], v[158:159], v[30:31] op_sel:[0,0,0] op_sel_hi:[0,1,1]
    v_pk_fma_f32 v[32:33], v[112:113], v[160:161], v[32:33] op_sel:[0,0,0] op_sel_hi:[0,1,1]
    v_pk_fma_f32 v[34:35], v[112:113], v[162:163], v[34:35] op_sel:[0,0,0] op_sel_hi:[0,1,1]
    v_pk_fma_f32 v[36:37], v[112:113], v[164:165], v[36:37] op_sel:[0,0,0] op_sel_hi:[0,1,1]
    v_pk_fma_f32 v[38:39], v[112:113], v[166:167], v[38:39] op_sel:[0,0,0] op_sel_hi:[0,1,1]
    v_pk_fma_f32 v[40:41], v[112:113], v[160:161], v[40:41] op_sel:[1,0,0] op_sel_hi:[1,1,1]
    v_pk_fma_f32 v[42:43], v[112:113], v[162:163], v[42:43] op_sel:[1,0,0] op_sel_hi:[1,1,1]
    v_pk_fma_f32 v[44:45], v[112:113], v[164:165], v[44:45] op_sel:[1,0,0] op_sel_hi:[1,1,1]
    v_pk_fma_f32 v[46:47], v[112:113], v[166:167], v[46:47] op_sel:[1,0,0] op_sel_hi:[1,1,1]
    v_pk_fma_f32 v[48:49], v[114:115], v[160:161], v[48:49] op_sel:[0,0,0] op_sel_hi:[0,1,1]
    v_pk_fma_f32 v[50:51], v[114:115], v[162:163], v[50:51] op_sel:[0,0,0] op_sel_hi:[0,1,1]
    v_pk_fma_f32 v[52:53], v[114:115], v[164:165], v[52:53] op_sel:[0,0,0] op_sel_hi:[0,1,1]
    v_pk_fma_f32 v[54:55], v[114:115], v[166:167], v[54:55] op_sel:[0,0,0] op_sel_hi:[0,1,1]
    v_pk_fma_f32 v[56:57], v[114:115], v[160:161], v[56:57] op_sel:[1,0,0] op_sel_hi:[1,1,1]
    v_pk_fma_f32 v[58:59], v[114:115], v[162:163], v[58:59] op_sel:[1,0,0] op_sel_hi:[1,1,1]
    v_pk_fma_f32 v[60:61], v[114:115], v[164:165], v[60:61] op_sel:[1,0,0] op_sel_hi:[1,1,1]
    v_pk_fma_f32 v[62:63], v[114:115], v[166:167], v[62:63] op_sel:[1,0,0] op_sel_hi:[1,1,1]
    v_pk_fma_f32 v[64:65], v[116:117], v[160:161], v[64:65] op_sel:[0,0,0] op_sel_hi:[0,1,1]
    v_pk_fma_f32 v[66:67], v[116:117], v[162:163], v[66:67] op_sel:[0,0,0] op_sel_hi:[0,1,1]
    v_pk_fma_f32 v[68:69], v[116:117], v[164:165], v[68:69] op_sel:[0,0,0] op_sel_hi:[0,1,1]
    v_pk_fma_f32 v[70:71], v[116:117], v[166:167], v[70:71] op_sel:[0,0,0] op_sel_hi:[0,1,1]
    v_cvt_pk_bf16_f32 v0, v0, v1
    v_cvt_pk_bf16_f32 v1, v2, v3
    v_cvt_pk_bf16_f32 v2, v4, v5
    v_cvt_pk_bf16_f32 v3, v6, v7
    v_cvt_pk_bf16_f32 v8, v8, v9
    v_cvt_pk_bf16_f32 v9, v10, v11
    v_cvt_pk_bf16_f32 v10, v12, v13
    v_cvt_pk_bf16_f32 v11, v14, v15
    v_cvt_pk_bf16_f32 v16, v16, v17
    v_cvt_pk_bf16_f32 v17, v18, v19
    v_cvt_pk_bf16_f32 v18, v20, v21
    v_cvt_pk_bf16_f32 v19, v22, v23
    v_cvt_pk_bf16_f32 v24, v24, v25
    v_cvt_pk_bf16_f32 v25, v26, v27
    v_cvt_pk_bf16_f32 v26, v28, v29
    v_cvt_pk_bf16_f32 v27, v30, v31
    v_pk_mul_f32 v[32:33], v[118:119], v[32:33] op_sel:[0,0] op_sel_hi:[0,1]
    v_pk_mul_f32 v[34:35], v[118:119], v[34:35] op_sel:[0,0] op_sel_hi:[0,1]
    v_pk_mul_f32 v[36:37], v[118:119], v[36:37] op_sel:[0,0] op_sel_hi:[0,1]
    v_pk_mul_f32 v[38:39], v[118:119], v[38:39] op_sel:[0,0] op_sel_hi:[0,1]
    v_pk_mul_f32 v[40:41], v[118:119], v[40:41] op_sel:[1,0] op_sel_hi:[1,1]
    v_pk_mul_f32 v[42:43], v[118:119], v[42:43] op_sel:[1,0] op_sel_hi:[1,1]
    v_pk_mul_f32 v[44:45], v[118:119], v[44:45] op_sel:[1,0] op_sel_hi:[1,1]
    v_pk_mul_f32 v[46:47], v[118:119], v[46:47] op_sel:[1,0] op_sel_hi:[1,1]
    v_pk_mul_f32 v[48:49], v[120:121], v[48:49] op_sel:[0,0] op_sel_hi:[0,1]
    v_pk_mul_f32 v[50:51], v[120:121], v[50:51] op_sel:[0,0] op_sel_hi:[0,1]
    v_pk_mul_f32 v[52:53], v[120:121], v[52:53] op_sel:[0,0] op_sel_hi:[0,1]
    v_pk_mul_f32 v[54:55], v[120:121], v[54:55] op_sel:[0,0] op_sel_hi:[0,1]
    v_pk_mul_f32 v[56:57], v[120:121], v[56:57] op_sel:[1,0] op_sel_hi:[1,1]
    v_pk_mul_f32 v[58:59], v[120:121], v[58:59] op_sel:[1,0] op_sel_hi:[1,1]
    v_pk_mul_f32 v[60:61], v[120:121], v[60:61] op_sel:[1,0] op_sel_hi:[1,1]
    v_pk_mul_f32 v[62:63], v[120:121], v[62:63] op_sel:[1,0] op_sel_hi:[1,1]
    v_pk_mul_f32 v[64:65], v[122:123], v[64:65] op_sel:[0,0] op_sel_hi:[0,1]
    v_pk_mul_f32 v[66:67], v[122:123], v[66:67] op_sel:[0,0] op_sel_hi:[0,1]
    v_pk_mul_f32 v[68:69], v[122:123], v[68:69] op_sel:[0,0] op_sel_hi:[0,1]
    v_pk_mul_f32 v[70:71], v[122:123], v[70:71] op_sel:[0,0] op_sel_hi:[0,1]
    v_cvt_pk_bf16_f32 v32, v32, v33
    v_cvt_pk_bf16_f32 v33, v34, v35
    v_cvt_pk_bf16_f32 v34, v36, v37
    v_cvt_pk_bf16_f32 v35, v38, v39
    v_cvt_pk_bf16_f32 v40, v40, v41
    v_cvt_pk_bf16_f32 v41, v42, v43
    v_cvt_pk_bf16_f32 v42, v44, v45
    v_cvt_pk_bf16_f32 v43, v46, v47
    v_cvt_pk_bf16_f32 v48, v48, v49
    v_cvt_pk_bf16_f32 v49, v50, v51
    v_cvt_pk_bf16_f32 v50, v52, v53
    v_cvt_pk_bf16_f32 v51, v54, v55
    v_cvt_pk_bf16_f32 v56, v56, v57
    v_cvt_pk_bf16_f32 v57, v58, v59
    v_cvt_pk_bf16_f32 v58, v60, v61
    v_cvt_pk_bf16_f32 v59, v62, v63
    v_cvt_pk_bf16_f32 v64, v64, v65
    v_cvt_pk_bf16_f32 v65, v66, v67
    v_cvt_pk_bf16_f32 v66, v68, v69
    v_cvt_pk_bf16_f32 v67, v70, v71
    v_readfirstlane_b32 s45, v170
    s_waitcnt lgkmcnt(0)
    v_mfma_f32_16x16x32_bf16 v[4:7], v[40:43], v[0:3], 0
    v_mfma_f32_16x16x32_bf16 v[44:47], v[32:35], v[0:3], 0
    v_mfma_f32_16x16x32_bf16 v[12:15], v[48:51], v[8:11], 0
    v_mfma_f32_16x16x32_bf16 v[52:55], v[40:43], v[8:11], 0
    v_mfma_f32_16x16x32_bf16 v[20:23], v[56:59], v[16:19], 0
    v_mfma_f32_16x16x32_bf16 v[60:63], v[48:51], v[16:19], 0
    v_mfma_f32_16x16x32_bf16 v[28:31], v[64:67], v[24:27], 0
    v_mfma_f32_16x16x32_bf16 v[68:71], v[56:59], v[24:27], 0
    v_pk_fma_f32 v[72:73], v[132:133], v[168:169], v[72:73] op_sel:[0,0,0] op_sel_hi:[1,0,1]
    v_pk_fma_f32 v[74:75], v[134:135], v[168:169], v[74:75] op_sel:[0,0,0] op_sel_hi:[1,0,1]
    v_pk_fma_f32 v[76:77], v[132:133], v[168:169], v[76:77] op_sel:[0,1,0] op_sel_hi:[1,1,1]
    v_pk_fma_f32 v[78:79], v[134:135], v[168:169], v[78:79] op_sel:[0,1,0] op_sel_hi:[1,1,1]
    v_pk_fma_f32 v[80:81], v[136:137], v[168:169], v[80:81] op_sel:[0,0,0] op_sel_hi:[1,0,1]
    v_pk_fma_f32 v[82:83], v[138:139], v[168:169], v[82:83] op_sel:[0,0,0] op_sel_hi:[1,0,1]
    v_pk_fma_f32 v[84:85], v[136:137], v[168:169], v[84:85] op_sel:[0,1,0] op_sel_hi:[1,1,1]
    v_pk_fma_f32 v[86:87], v[138:139], v[168:169], v[86:87] op_sel:[0,1,0] op_sel_hi:[1,1,1]
    v_pk_fma_f32 v[88:89], v[140:141], v[168:169], v[88:89] op_sel:[0,0,0] op_sel_hi:[1,0,1]
    v_pk_fma_f32 v[90:91], v[142:143], v[168:169], v[90:91] op_sel:[0,0,0] op_sel_hi:[1,0,1]
    v_pk_fma_f32 v[92:93], v[140:141], v[168:169], v[92:93] op_sel:[0,1,0] op_sel_hi:[1,1,1]
    v_pk_fma_f32 v[94:95], v[142:143], v[168:169], v[94:95] op_sel:[0,1,0] op_sel_hi:[1,1,1]
    v_pk_fma_f32 v[96:97], v[144:145], v[168:169], v[96:97] op_sel:[0,0,0] op_sel_hi:[1,0,1]
    v_pk_fma_f32 v[98:99], v[146:147], v[168:169], v[98:99] op_sel:[0,0,0] op_sel_hi:[1,0,1]
    v_pk_fma_f32 v[100:101], v[144:145], v[168:169], v[100:101] op_sel:[0,1,0] op_sel_hi:[1,1,1]
    v_pk_fma_f32 v[102:103], v[146:147], v[168:169], v[102:103] op_sel:[0,1,0] op_sel_hi:[1,1,1]
    v_pk_fma_f32 v[104:105], v[148:149], v[168:169], v[104:105] op_sel:[0,0,0] op_sel_hi:[1,0,1]
    v_pk_fma_f32 v[106:107], v[150:151], v[168:169], v[106:107] op_sel:[0,0,0] op_sel_hi:[1,0,1]
    v_pk_fma_f32 v[108:109], v[148:149], v[168:169], v[108:109] op_sel:[0,1,0] op_sel_hi:[1,1,1]
    v_pk_fma_f32 v[110:111], v[150:151], v[168:169], v[110:111] op_sel:[0,1,0] op_sel_hi:[1,1,1]
    v_cndmask_b32 v44, v44, v4, s[72:73]
    v_cndmask_b32 v45, v45, v5, s[74:75]
    v_cndmask_b32 v46, v46, v6, s[76:77]
    v_cndmask_b32 v47, v47, v7, s[78:79]
    v_cndmask_b32 v52, v52, v12, s[72:73]
    v_cndmask_b32 v53, v53, v13, s[74:75]
    v_cndmask_b32 v54, v54, v14, s[76:77]
    v_cndmask_b32 v55, v55, v15, s[78:79]
    v_cndmask_b32 v60, v60, v20, s[72:73]
    v_cndmask_b32 v61, v61, v21, s[74:75]
    v_cndmask_b32 v62, v62, v22, s[76:77]
    v_cndmask_b32 v63, v63, v23, s[78:79]
    v_cndmask_b32 v68, v68, v28, s[72:73]
    v_cndmask_b32 v69, v69, v29, s[74:75]
    v_cndmask_b32 v70, v70, v30, s[76:77]
    v_cndmask_b32 v71, v71, v31, s[78:79]
    v_cndmask_b32 v44, v44, v45, s[80:81]
    v_cndmask_b32 v45, v46, v47, s[80:81]
    v_cndmask_b32 v52, v52, v53, s[80:81]
    v_cndmask_b32 v53, v54, v55, s[80:81]
    v_cndmask_b32 v60, v60, v61, s[80:81]
    v_cndmask_b32 v61, v62, v63, s[80:81]
    v_cndmask_b32 v68, v68, v69, s[80:81]
    v_cndmask_b32 v69, v70, v71, s[80:81]
    v_mov_b32 v209, 0xf149f2ca
    v_cndmask_b32 v44, v44, v209, s[82:83]
    v_cndmask_b32 v45, v45, v209, s[84:85]
    v_max_f32 v46, v44, v45
    v_max_f32 v54, v52, v53
    v_max_f32 v62, v60, v61
    v_max_f32 v70, v68, v69
    v_pk_mul_f32 v[72:73], v[176:177], v[72:73] op_sel:[0,0] op_sel_hi:[1,1]
    v_pk_mul_f32 v[74:75], v[178:179], v[74:75] op_sel:[0,0] op_sel_hi:[1,1]
    v_permlane32_swap_b32 v46, v62
    v_permlane32_swap_b32 v54, v70
    v_max_f32 v46, v46, v62
    v_max_f32 v54, v54, v70
    v_pk_mul_f32 v[76:77], v[176:177], v[76:77] op_sel:[0,0] op_sel_hi:[1,1]
    v_pk_mul_f32 v[78:79], v[178:179], v[78:79] op_sel:[0,0] op_sel_hi:[1,1]
    v_permlane16_swap_b32 v46, v54
    v_max_f32 v46, v46, v54
    v_mov_b32 v54, v46
    v_pk_mul_f32 v[80:81], v[180:181], v[80:81] op_sel:[0,0] op_sel_hi:[1,1]
    v_pk_mul_f32 v[82:83], v[182:183], v[82:83] op_sel:[0,0] op_sel_hi:[1,1]
    v_permlane16_swap_b32 v46, v54
    v_mov_b32 v62, v46
    v_mov_b32 v70, v54
    v_pk_mul_f32 v[84:85], v[180:181], v[84:85] op_sel:[0,0] op_sel_hi:[1,1]
    v_pk_mul_f32 v[86:87], v[182:183], v[86:87] op_sel:[0,0] op_sel_hi:[1,1]
    v_permlane32_swap_b32 v46, v62
    v_permlane32_swap_b32 v54, v70
    v_mul_f32 v119, 0x3e8293ee, v119
    v_mul_f32 v120, 0x3e8293ee, v120
    v_mul_f32 v121, 0x3e8293ee, v121
    v_mul_f32 v122, 0x3e8293ee, v122
    v_sub_f32 v44, v44, v46
    v_sub_f32 v45, v45, v46
    v_sub_f32 v52, v52, v54
    v_sub_f32 v53, v53, v54
    v_sub_f32 v60, v60, v62
    v_sub_f32 v61, v61, v62
    v_sub_f32 v68, v68, v70
    v_sub_f32 v69, v69, v70
    v_mul_f32 v44, v119, v44
    v_mul_f32 v45, v119, v45
    v_mul_f32 v52, v120, v52
    v_mul_f32 v53, v120, v53
    v_mul_f32 v60, v121, v60
    v_mul_f32 v61, v121, v61
    v_mul_f32 v68, v122, v68
    v_mul_f32 v69, v122, v69
    v_exp_f32 v44, v44
    v_exp_f32 v45, v45
    v_exp_f32 v52, v52
    v_exp_f32 v53, v53
    v_exp_f32 v60, v60
    v_exp_f32 v61, v61
    v_exp_f32 v68, v68
    v_exp_f32 v69, v69
    .p2align 3
    v_pk_mul_f32 v[88:89], v[184:185], v[88:89] op_sel:[0,0] op_sel_hi:[1,1]
    v_pk_mul_f32 v[90:91], v[186:187], v[90:91] op_sel:[0,0] op_sel_hi:[1,1]
    v_pk_mul_f32 v[92:93], v[184:185], v[92:93] op_sel:[0,0] op_sel_hi:[1,1]
    v_pk_mul_f32 v[94:95], v[186:187], v[94:95] op_sel:[0,0] op_sel_hi:[1,1]
    v_pk_mul_f32 v[96:97], v[188:189], v[96:97] op_sel:[0,0] op_sel_hi:[1,1]
    v_pk_mul_f32 v[98:99], v[190:191], v[98:99] op_sel:[0,0] op_sel_hi:[1,1]
    v_pk_mul_f32 v[100:101], v[188:189], v[100:101] op_sel:[0,0] op_sel_hi:[1,1]
    v_pk_mul_f32 v[102:103], v[190:191], v[102:103] op_sel:[0,0] op_sel_hi:[1,1]
    v_pk_mul_f32 v[104:105], v[192:193], v[104:105] op_sel:[0,0] op_sel_hi:[1,1]
    v_pk_mul_f32 v[106:107], v[194:195], v[106:107] op_sel:[0,0] op_sel_hi:[1,1]
    v_pk_mul_f32 v[108:109], v[192:193], v[108:109] op_sel:[0,0] op_sel_hi:[1,1]
    v_pk_mul_f32 v[110:111], v[194:195], v[110:111] op_sel:[0,0] op_sel_hi:[1,1]
    v_cvt_pk_bf16_f32 v44, v44, v45
    v_cvt_pk_bf16_f32 v52, v52, v53
    v_cvt_pk_bf16_f32 v60, v60, v61
    v_cvt_pk_bf16_f32 v68, v68, v69
    v_cvt_pk_bf16_f32 v226, v72, v73
    v_cvt_pk_bf16_f32 v227, v74, v75
    v_cvt_pk_bf16_f32 v152, v76, v77
    v_cvt_pk_bf16_f32 v153, v78, v79
    v_cvt_pk_bf16_f32 v228, v80, v81
    v_cvt_pk_bf16_f32 v229, v82, v83
    v_cvt_pk_bf16_f32 v154, v84, v85
    v_cvt_pk_bf16_f32 v155, v86, v87
    v_cvt_pk_bf16_f32 v230, v88, v89
    v_cvt_pk_bf16_f32 v231, v90, v91
    v_cvt_pk_bf16_f32 v156, v92, v93
    v_cvt_pk_bf16_f32 v157, v94, v95
    v_cvt_pk_bf16_f32 v232, v96, v97
    v_cvt_pk_bf16_f32 v233, v98, v99
    v_cvt_pk_bf16_f32 v158, v100, v101
    v_cvt_pk_bf16_f32 v159, v102, v103
    v_cvt_pk_bf16_f32 v234, v104, v105
    v_cvt_pk_bf16_f32 v235, v106, v107
    v_cvt_pk_bf16_f32 v160, v108, v109
    v_cvt_pk_bf16_f32 v161, v110, v111
    v_perm_b32 v4, v44, v44, v214
    v_perm_b32 v5, v44, v44, v215
    v_perm_b32 v6, v44, v44, v216
    v_perm_b32 v7, v44, v44, v217
    v_perm_b32 v12, v52, v52, v214
    v_perm_b32 v13, v52, v52, v215
    v_perm_b32 v14, v52, v52, v216
    v_perm_b32 v15, v52, v52, v217
    v_perm_b32 v20, v60, v60, v214
    v_perm_b32 v21, v60, v60, v215
    v_perm_b32 v22, v60, v60, v216
    v_perm_b32 v23, v60, v60, v217
    v_perm_b32 v28, v68, v68, v214
    v_perm_b32 v29, v68, v68, v215
    v_perm_b32 v30, v68, v68, v216
    v_perm_b32 v31, v68, v68, v217
    s_add_u32 s55, s62, 4096
    v_mfma_f32_16x16x32_bf16 v[0:3], v[222:225], v[4:7], 0
    v_mfma_f32_16x16x32_bf16 v[8:11], v[222:225], v[12:15], 0
    v_mfma_f32_16x16x32_bf16 v[16:19], v[222:225], v[20:23], 0
    v_mfma_f32_16x16x32_bf16 v[24:27], v[222:225], v[28:31], 0
    v_mfma_f32_16x16x32_bf16 v[72:75], v[226:229], v[4:7], 0
    v_mfma_f32_16x16x32_bf16 v[76:79], v[152:155], v[4:7], 0
    v_mfma_f32_16x16x32_bf16 v[80:83], v[228:231], v[12:15], 0
    v_mfma_f32_16x16x32_bf16 v[84:87], v[154:157], v[12:15], 0
    v_mfma_f32_16x16x32_bf16 v[88:91], v[230:233], v[20:23], 0
    v_mfma_f32_16x16x32_bf16 v[92:95], v[156:159], v[20:23], 0
    v_mfma_f32_16x16x32_bf16 v[96:99], v[232:235], v[28:31], 0
    v_mfma_f32_16x16x32_bf16 v[100:103], v[158:161], v[28:31], 0
    v_rcp_f32 v0, v0
    v_rcp_f32 v8, v8
    v_rcp_f32 v16, v16
    v_rcp_f32 v24, v24
    v_pk_mul_f32 v[72:73], v[0:1], v[72:73] op_sel:[0,0] op_sel_hi:[0,1]
    v_pk_mul_f32 v[74:75], v[0:1], v[74:75] op_sel:[0,0] op_sel_hi:[0,1]
    v_pk_mul_f32 v[76:77], v[0:1], v[76:77] op_sel:[0,0] op_sel_hi:[0,1]
    v_pk_mul_f32 v[78:79], v[0:1], v[78:79] op_sel:[0,0] op_sel_hi:[0,1]
    v_cvt_pk_bf16_f32 v72, v72, v73
    v_cvt_pk_bf16_f32 v73, v74, v75
    v_cvt_pk_bf16_f32 v74, v76, v77
    v_cvt_pk_bf16_f32 v75, v78, v79
    buffer_store_dwordx4 v[72:75], v254, s[4:7], s62 offen offset:0 sc0 sc1
    v_pk_mul_f32 v[80:81], v[8:9], v[80:81] op_sel:[0,0] op_sel_hi:[0,1]
    v_pk_mul_f32 v[82:83], v[8:9], v[82:83] op_sel:[0,0] op_sel_hi:[0,1]
    v_pk_mul_f32 v[84:85], v[8:9], v[84:85] op_sel:[0,0] op_sel_hi:[0,1]
    v_pk_mul_f32 v[86:87], v[8:9], v[86:87] op_sel:[0,0] op_sel_hi:[0,1]
    v_cvt_pk_bf16_f32 v80, v80, v81
    v_cvt_pk_bf16_f32 v81, v82, v83
    v_cvt_pk_bf16_f32 v82, v84, v85
    v_cvt_pk_bf16_f32 v83, v86, v87
    buffer_store_dwordx4 v[80:83], v254, s[4:7], s62 offen offset:2048 sc0 sc1
    v_pk_mul_f32 v[88:89], v[16:17], v[88:89] op_sel:[0,0] op_sel_hi:[0,1]
    v_pk_mul_f32 v[90:91], v[16:17], v[90:91] op_sel:[0,0] op_sel_hi:[0,1]
    v_pk_mul_f32 v[92:93], v[16:17], v[92:93] op_sel:[0,0] op_sel_hi:[0,1]
    v_pk_mul_f32 v[94:95], v[16:17], v[94:95] op_sel:[0,0] op_sel_hi:[0,1]
    v_cvt_pk_bf16_f32 v88, v88, v89
    v_cvt_pk_bf16_f32 v89, v90, v91
    v_cvt_pk_bf16_f32 v90, v92, v93
    v_cvt_pk_bf16_f32 v91, v94, v95
    buffer_store_dwordx4 v[88:91], v254, s[4:7], s55 offen offset:0 sc0 sc1
    s_nop 1
    v_pk_mul_f32 v[96:97], v[24:25], v[96:97] op_sel:[0,0] op_sel_hi:[0,1]
    v_pk_mul_f32 v[98:99], v[24:25], v[98:99] op_sel:[0,0] op_sel_hi:[0,1]
    v_pk_mul_f32 v[100:101], v[24:25], v[100:101] op_sel:[0,0] op_sel_hi:[0,1]
    v_pk_mul_f32 v[102:103], v[24:25], v[102:103] op_sel:[0,0] op_sel_hi:[0,1]
    v_cvt_pk_bf16_f32 v96, v96, v97
    v_cvt_pk_bf16_f32 v97, v98, v99
    v_cvt_pk_bf16_f32 v98, v100, v101
    v_cvt_pk_bf16_f32 v99, v102, v103
    buffer_store_dwordx4 v[96:99], v254, s[4:7], s55 offen offset:2048 sc0 sc1
    s_lshl_b32 s55, s43, 13
    s_add_u32 s55, s55, 98304
    v_add_u32 v128, s55, v254
    v_lshrrev_b32 v152, 6, v254
    v_lshrrev_b32 v153, 1, v152
    v_and_b32 v153, 3, v153
    s_lshl_b32 s55, s44, 1
    v_xor_b32 v153, s55, v153
    v_lshlrev_b32 v152, 7, v152
    v_lshl_add_u32 v152, v153, 5, v152
    v_and_b32 v153, 0x30, v254
    v_lshrrev_b32 v153, 1, v153
    v_add_u32 v129, v152, v153
    v_xor_b32 v130, 32, v129
    v_add_u32 v131, 49152, v129
    v_add_u32 v132, 49152, v130
    v_lshlrev_b32 v0, 16, v236
    v_and_b32 v1, 0xffff0000, v236
    v_lshlrev_b32 v2, 16, v237
    v_and_b32 v3, 0xffff0000, v237
    v_lshlrev_b32 v16, 16, v238
    v_and_b32 v17, 0xffff0000, v238
    v_lshlrev_b32 v18, 16, v239
    v_and_b32 v19, 0xffff0000, v239
    v_lshlrev_b32 v4, 16, v240
    v_and_b32 v5, 0xffff0000, v240
    v_lshlrev_b32 v6, 16, v241
    v_and_b32 v7, 0xffff0000, v241
    v_lshlrev_b32 v20, 16, v242
    v_and_b32 v21, 0xffff0000, v242
    v_lshlrev_b32 v22, 16, v243
    v_and_b32 v23, 0xffff0000, v243
    v_lshlrev_b32 v8, 16, v244
    v_and_b32 v9, 0xffff0000, v244
    v_lshlrev_b32 v10, 16, v245
    v_and_b32 v11, 0xffff0000, v245
    v_lshlrev_b32 v24, 16, v246
    v_and_b32 v25, 0xffff0000, v246
    v_lshlrev_b32 v26, 16, v247
    v_and_b32 v27, 0xffff0000, v247
    v_lshlrev_b32 v12, 16, v248
    v_and_b32 v13, 0xffff0000, v248
    v_lshlrev_b32 v14, 16, v249
    v_and_b32 v15, 0xffff0000, v249
    v_lshlrev_b32 v28, 16, v250
    v_and_b32 v29, 0xffff0000, v250
    v_lshlrev_b32 v30, 16, v251
    v_and_b32 v31, 0xffff0000, v251
    s_waitcnt vmcnt(0)
    s_barrier
    s_barrier
    ds_read_b64_tr_b16 v[96:97], v129 offset:32768
    ds_read_b64_tr_b16 v[98:99], v129 offset:34816
    ds_read_b128 v[32:35], v128 offset:0
    ds_read_b128 v[36:39], v128 offset:2048
    ds_read_b128 v[40:43], v128 offset:4096
    ds_read_b128 v[44:47], v128 offset:6144
    ds_read_b64_tr_b16 v[100:101], v130 offset:32768
    ds_read_b64_tr_b16 v[102:103], v130 offset:34816
    ds_read_b64_tr_b16 v[104:105], v129 offset:36864
    ds_read_b64_tr_b16 v[106:107], v129 offset:38912
    ds_read_b128 v[48:51], v128 offset:1024
    ds_read_b128 v[52:55], v128 offset:3072
    ds_read_b128 v[56:59], v128 offset:5120
    ds_read_b128 v[60:63], v128 offset:7168
    ds_read_b64_tr_b16 v[108:109], v130 offset:36864
    ds_read_b64_tr_b16 v[110:111], v130 offset:38912
    s_waitcnt lgkmcnt(0)
    s_barrier
    .p2align 3
    v_mfma_f32_16x16x32_bf16 v[0:3], v[96:99], v[32:35], v[0:3]
    ds_read_b64_tr_b16 v[112:113], v129 offset:40960
    ds_read_b64_tr_b16 v[114:115], v129 offset:43008
    v_mfma_f32_16x16x32_bf16 v[4:7], v[96:99], v[36:39], v[4:7]
    ds_read_b128 v[64:67], v128 offset:16384
    v_mfma_f32_16x16x32_bf16 v[8:11], v[96:99], v[40:43], v[8:11]
    ds_read_b128 v[68:71], v128 offset:18432
    v_mfma_f32_16x16x32_bf16 v[12:15], v[96:99], v[44:47], v[12:15]
    ds_read_b128 v[72:75], v128 offset:20480
    ds_read_b128 v[76:79], v128 offset:22528
    v_mfma_f32_16x16x32_bf16 v[16:19], v[100:103], v[32:35], v[16:19]
    ds_read_b64_tr_b16 v[116:117], v130 offset:40960
    v_mfma_f32_16x16x32_bf16 v[20:23], v[100:103], v[36:39], v[20:23]
    ds_read_b64_tr_b16 v[118:119], v130 offset:43008
    v_mfma_f32_16x16x32_bf16 v[24:27], v[100:103], v[40:43], v[24:27]
    ds_read_b64_tr_b16 v[120:121], v129 offset:45056
    ds_read_b64_tr_b16 v[122:123], v129 offset:47104
    v_mfma_f32_16x16x32_bf16 v[28:31], v[100:103], v[44:47], v[28:31]
    ds_read_b128 v[80:83], v128 offset:17408
    v_mfma_f32_16x16x32_bf16 v[0:3], v[104:107], v[48:51], v[0:3]
    ds_read_b128 v[84:87], v128 offset:19456
    v_mfma_f32_16x16x32_bf16 v[4:7], v[104:107], v[52:55], v[4:7]
    ds_read_b128 v[88:91], v128 offset:21504
    ds_read_b128 v[92:95], v128 offset:23552
    v_mfma_f32_16x16x32_bf16 v[8:11], v[104:107], v[56:59], v[8:11]
    ds_read_b64_tr_b16 v[124:125], v130 offset:45056
    v_mfma_f32_16x16x32_bf16 v[12:15], v[104:107], v[60:63], v[12:15]
    ds_read_b64_tr_b16 v[126:127], v130 offset:47104
    v_mfma_f32_16x16x32_bf16 v[16:19], v[108:111], v[48:51], v[16:19]
    v_mfma_f32_16x16x32_bf16 v[20:23], v[108:111], v[52:55], v[20:23]
    v_mfma_f32_16x16x32_bf16 v[24:27], v[108:111], v[56:59], v[24:27]
    v_mfma_f32_16x16x32_bf16 v[28:31], v[108:111], v[60:63], v[28:31]
    s_waitcnt lgkmcnt(0)
    s_barrier
    .p2align 3
    v_mfma_f32_16x16x32_bf16 v[0:3], v[112:115], v[64:67], v[0:3]
    ds_read_b64_tr_b16 v[96:97], v131 offset:0
    ds_read_b64_tr_b16 v[98:99], v131 offset:2048
    v_mfma_f32_16x16x32_bf16 v[4:7], v[112:115], v[68:71], v[4:7]
    ds_read_b128 v[32:35], v128 offset:32768
    v_mfma_f32_16x16x32_bf16 v[8:11], v[112:115], v[72:75], v[8:11]
    ds_read_b128 v[36:39], v128 offset:34816
    v_mfma_f32_16x16x32_bf16 v[12:15], v[112:115], v[76:79], v[12:15]
    ds_read_b128 v[40:43], v128 offset:36864
    ds_read_b128 v[44:47], v128 offset:38912
    v_mfma_f32_16x16x32_bf16 v[16:19], v[116:119], v[64:67], v[16:19]
    ds_read_b64_tr_b16 v[100:101], v132 offset:0
    v_mfma_f32_16x16x32_bf16 v[20:23], v[116:119], v[68:71], v[20:23]
    ds_read_b64_tr_b16 v[102:103], v132 offset:2048
    v_mfma_f32_16x16x32_bf16 v[24:27], v[116:119], v[72:75], v[24:27]
    ds_read_b64_tr_b16 v[104:105], v131 offset:4096
    ds_read_b64_tr_b16 v[106:107], v131 offset:6144
    v_mfma_f32_16x16x32_bf16 v[28:31], v[116:119], v[76:79], v[28:31]
    ds_read_b128 v[48:51], v128 offset:33792
    v_mfma_f32_16x16x32_bf16 v[0:3], v[120:123], v[80:83], v[0:3]
    ds_read_b128 v[52:55], v128 offset:35840
    v_mfma_f32_16x16x32_bf16 v[4:7], v[120:123], v[84:87], v[4:7]
    ds_read_b128 v[56:59], v128 offset:37888
    ds_read_b128 v[60:63], v128 offset:39936
    v_mfma_f32_16x16x32_bf16 v[8:11], v[120:123], v[88:91], v[8:11]
    ds_read_b64_tr_b16 v[108:109], v132 offset:4096
    v_mfma_f32_16x16x32_bf16 v[12:15], v[120:123], v[92:95], v[12:15]
    ds_read_b64_tr_b16 v[110:111], v132 offset:6144
    v_mfma_f32_16x16x32_bf16 v[16:19], v[124:127], v[80:83], v[16:19]
    v_mfma_f32_16x16x32_bf16 v[20:23], v[124:127], v[84:87], v[20:23]
    v_mfma_f32_16x16x32_bf16 v[24:27], v[124:127], v[88:91], v[24:27]
    v_mfma_f32_16x16x32_bf16 v[28:31], v[124:127], v[92:95], v[28:31]
    s_waitcnt lgkmcnt(0)
    s_barrier
    .p2align 3
    v_mfma_f32_16x16x32_bf16 v[0:3], v[96:99], v[32:35], v[0:3]
    ds_read_b64_tr_b16 v[112:113], v131 offset:8192
    ds_read_b64_tr_b16 v[114:115], v131 offset:10240
    v_mfma_f32_16x16x32_bf16 v[4:7], v[96:99], v[36:39], v[4:7]
    ds_read_b128 v[64:67], v128 offset:0
    v_mfma_f32_16x16x32_bf16 v[8:11], v[96:99], v[40:43], v[8:11]
    ds_read_b128 v[68:71], v128 offset:2048
    v_mfma_f32_16x16x32_bf16 v[12:15], v[96:99], v[44:47], v[12:15]
    ds_read_b128 v[72:75], v128 offset:4096
    ds_read_b128 v[76:79], v128 offset:6144
    v_mfma_f32_16x16x32_bf16 v[16:19], v[100:103], v[32:35], v[16:19]
    ds_read_b64_tr_b16 v[116:117], v132 offset:8192
    v_mfma_f32_16x16x32_bf16 v[20:23], v[100:103], v[36:39], v[20:23]
    ds_read_b64_tr_b16 v[118:119], v132 offset:10240
    v_mfma_f32_16x16x32_bf16 v[24:27], v[100:103], v[40:43], v[24:27]
    ds_read_b64_tr_b16 v[120:121], v131 offset:12288
    ds_read_b64_tr_b16 v[122:123], v131 offset:14336
    v_mfma_f32_16x16x32_bf16 v[28:31], v[100:103], v[44:47], v[28:31]
    ds_read_b128 v[80:83], v128 offset:1024
    v_mfma_f32_16x16x32_bf16 v[0:3], v[104:107], v[48:51], v[0:3]
    ds_read_b128 v[84:87], v128 offset:3072
    v_mfma_f32_16x16x32_bf16 v[4:7], v[104:107], v[52:55], v[4:7]
    ds_read_b128 v[88:91], v128 offset:5120
    ds_read_b128 v[92:95], v128 offset:7168
    v_mfma_f32_16x16x32_bf16 v[8:11], v[104:107], v[56:59], v[8:11]
    ds_read_b64_tr_b16 v[124:125], v132 offset:12288
    v_mfma_f32_16x16x32_bf16 v[12:15], v[104:107], v[60:63], v[12:15]
    ds_read_b64_tr_b16 v[126:127], v132 offset:14336
    v_mfma_f32_16x16x32_bf16 v[16:19], v[108:111], v[48:51], v[16:19]
    v_mfma_f32_16x16x32_bf16 v[20:23], v[108:111], v[52:55], v[20:23]
    v_mfma_f32_16x16x32_bf16 v[24:27], v[108:111], v[56:59], v[24:27]
    v_mfma_f32_16x16x32_bf16 v[28:31], v[108:111], v[60:63], v[28:31]
    s_waitcnt lgkmcnt(0)
    s_barrier
    .p2align 3
    v_mfma_f32_16x16x32_bf16 v[0:3], v[112:115], v[64:67], v[0:3]
    ds_read_b64_tr_b16 v[96:97], v131 offset:16384
    ds_read_b64_tr_b16 v[98:99], v131 offset:18432
    v_mfma_f32_16x16x32_bf16 v[4:7], v[112:115], v[68:71], v[4:7]
    ds_read_b128 v[32:35], v128 offset:16384
    v_mfma_f32_16x16x32_bf16 v[8:11], v[112:115], v[72:75], v[8:11]
    ds_read_b128 v[36:39], v128 offset:18432
    v_mfma_f32_16x16x32_bf16 v[12:15], v[112:115], v[76:79], v[12:15]
    ds_read_b128 v[40:43], v128 offset:20480
    ds_read_b128 v[44:47], v128 offset:22528
    v_mfma_f32_16x16x32_bf16 v[16:19], v[116:119], v[64:67], v[16:19]
    ds_read_b64_tr_b16 v[100:101], v132 offset:16384
    v_mfma_f32_16x16x32_bf16 v[20:23], v[116:119], v[68:71], v[20:23]
    ds_read_b64_tr_b16 v[102:103], v132 offset:18432
    v_mfma_f32_16x16x32_bf16 v[24:27], v[116:119], v[72:75], v[24:27]
    ds_read_b64_tr_b16 v[104:105], v131 offset:20480
    ds_read_b64_tr_b16 v[106:107], v131 offset:22528
    v_mfma_f32_16x16x32_bf16 v[28:31], v[116:119], v[76:79], v[28:31]
    ds_read_b128 v[48:51], v128 offset:17408
    v_mfma_f32_16x16x32_bf16 v[0:3], v[120:123], v[80:83], v[0:3]
    ds_read_b128 v[52:55], v128 offset:19456
    v_mfma_f32_16x16x32_bf16 v[4:7], v[120:123], v[84:87], v[4:7]
    ds_read_b128 v[56:59], v128 offset:21504
    ds_read_b128 v[60:63], v128 offset:23552
    v_mfma_f32_16x16x32_bf16 v[8:11], v[120:123], v[88:91], v[8:11]
    ds_read_b64_tr_b16 v[108:109], v132 offset:20480
    v_mfma_f32_16x16x32_bf16 v[12:15], v[120:123], v[92:95], v[12:15]
    ds_read_b64_tr_b16 v[110:111], v132 offset:22528
    v_mfma_f32_16x16x32_bf16 v[16:19], v[124:127], v[80:83], v[16:19]
    v_mfma_f32_16x16x32_bf16 v[20:23], v[124:127], v[84:87], v[20:23]
    v_mfma_f32_16x16x32_bf16 v[24:27], v[124:127], v[88:91], v[24:27]
    v_mfma_f32_16x16x32_bf16 v[28:31], v[124:127], v[92:95], v[28:31]
    s_waitcnt lgkmcnt(0)
    s_barrier
    .p2align 3
    v_mfma_f32_16x16x32_bf16 v[0:3], v[96:99], v[32:35], v[0:3]
    ds_read_b64_tr_b16 v[112:113], v131 offset:24576
    ds_read_b64_tr_b16 v[114:115], v131 offset:26624
    v_mfma_f32_16x16x32_bf16 v[4:7], v[96:99], v[36:39], v[4:7]
    ds_read_b128 v[64:67], v128 offset:32768
    v_mfma_f32_16x16x32_bf16 v[8:11], v[96:99], v[40:43], v[8:11]
    ds_read_b128 v[68:71], v128 offset:34816
    v_mfma_f32_16x16x32_bf16 v[12:15], v[96:99], v[44:47], v[12:15]
    ds_read_b128 v[72:75], v128 offset:36864
    ds_read_b128 v[76:79], v128 offset:38912
    v_mfma_f32_16x16x32_bf16 v[16:19], v[100:103], v[32:35], v[16:19]
    ds_read_b64_tr_b16 v[116:117], v132 offset:24576
    v_mfma_f32_16x16x32_bf16 v[20:23], v[100:103], v[36:39], v[20:23]
    ds_read_b64_tr_b16 v[118:119], v132 offset:26624
    v_mfma_f32_16x16x32_bf16 v[24:27], v[100:103], v[40:43], v[24:27]
    ds_read_b64_tr_b16 v[120:121], v131 offset:28672
    ds_read_b64_tr_b16 v[122:123], v131 offset:30720
    v_mfma_f32_16x16x32_bf16 v[28:31], v[100:103], v[44:47], v[28:31]
    ds_read_b128 v[80:83], v128 offset:33792
    v_mfma_f32_16x16x32_bf16 v[0:3], v[104:107], v[48:51], v[0:3]
    ds_read_b128 v[84:87], v128 offset:35840
    v_mfma_f32_16x16x32_bf16 v[4:7], v[104:107], v[52:55], v[4:7]
    ds_read_b128 v[88:91], v128 offset:37888
    ds_read_b128 v[92:95], v128 offset:39936
    v_mfma_f32_16x16x32_bf16 v[8:11], v[104:107], v[56:59], v[8:11]
    ds_read_b64_tr_b16 v[124:125], v132 offset:28672
    v_mfma_f32_16x16x32_bf16 v[12:15], v[104:107], v[60:63], v[12:15]
    ds_read_b64_tr_b16 v[126:127], v132 offset:30720
    v_mfma_f32_16x16x32_bf16 v[16:19], v[108:111], v[48:51], v[16:19]
    v_mfma_f32_16x16x32_bf16 v[20:23], v[108:111], v[52:55], v[20:23]
    v_mfma_f32_16x16x32_bf16 v[24:27], v[108:111], v[56:59], v[24:27]
    v_mfma_f32_16x16x32_bf16 v[28:31], v[108:111], v[60:63], v[28:31]
    s_waitcnt lgkmcnt(0)
    s_barrier
    .p2align 3
    v_mfma_f32_16x16x32_bf16 v[0:3], v[112:115], v[64:67], v[0:3]
    ds_read_b64_tr_b16 v[96:97], v131 offset:32768
    ds_read_b64_tr_b16 v[98:99], v131 offset:34816
    v_mfma_f32_16x16x32_bf16 v[4:7], v[112:115], v[68:71], v[4:7]
    ds_read_b128 v[32:35], v128 offset:0
    v_mfma_f32_16x16x32_bf16 v[8:11], v[112:115], v[72:75], v[8:11]
    ds_read_b128 v[36:39], v128 offset:2048
    v_mfma_f32_16x16x32_bf16 v[12:15], v[112:115], v[76:79], v[12:15]
    ds_read_b128 v[40:43], v128 offset:4096
    ds_read_b128 v[44:47], v128 offset:6144
    v_mfma_f32_16x16x32_bf16 v[16:19], v[116:119], v[64:67], v[16:19]
    ds_read_b64_tr_b16 v[100:101], v132 offset:32768
    v_mfma_f32_16x16x32_bf16 v[20:23], v[116:119], v[68:71], v[20:23]
    ds_read_b64_tr_b16 v[102:103], v132 offset:34816
    v_mfma_f32_16x16x32_bf16 v[24:27], v[116:119], v[72:75], v[24:27]
    ds_read_b64_tr_b16 v[104:105], v131 offset:36864
    ds_read_b64_tr_b16 v[106:107], v131 offset:38912
    v_mfma_f32_16x16x32_bf16 v[28:31], v[116:119], v[76:79], v[28:31]
    ds_read_b128 v[48:51], v128 offset:1024
    v_mfma_f32_16x16x32_bf16 v[0:3], v[120:123], v[80:83], v[0:3]
    ds_read_b128 v[52:55], v128 offset:3072
    v_mfma_f32_16x16x32_bf16 v[4:7], v[120:123], v[84:87], v[4:7]
    ds_read_b128 v[56:59], v128 offset:5120
    ds_read_b128 v[60:63], v128 offset:7168
    v_mfma_f32_16x16x32_bf16 v[8:11], v[120:123], v[88:91], v[8:11]
    ds_read_b64_tr_b16 v[108:109], v132 offset:36864
    v_mfma_f32_16x16x32_bf16 v[12:15], v[120:123], v[92:95], v[12:15]
    ds_read_b64_tr_b16 v[110:111], v132 offset:38912
    v_mfma_f32_16x16x32_bf16 v[16:19], v[124:127], v[80:83], v[16:19]
    v_mfma_f32_16x16x32_bf16 v[20:23], v[124:127], v[84:87], v[20:23]
    v_mfma_f32_16x16x32_bf16 v[24:27], v[124:127], v[88:91], v[24:27]
    v_mfma_f32_16x16x32_bf16 v[28:31], v[124:127], v[92:95], v[28:31]
    s_waitcnt lgkmcnt(0)
    s_barrier
    .p2align 3
    v_mfma_f32_16x16x32_bf16 v[0:3], v[96:99], v[32:35], v[0:3]
    ds_read_b64_tr_b16 v[112:113], v131 offset:40960
    ds_read_b64_tr_b16 v[114:115], v131 offset:43008
    v_mfma_f32_16x16x32_bf16 v[4:7], v[96:99], v[36:39], v[4:7]
    ds_read_b128 v[64:67], v128 offset:16384
    v_mfma_f32_16x16x32_bf16 v[8:11], v[96:99], v[40:43], v[8:11]
    ds_read_b128 v[68:71], v128 offset:18432
    v_mfma_f32_16x16x32_bf16 v[12:15], v[96:99], v[44:47], v[12:15]
    ds_read_b128 v[72:75], v128 offset:20480
    ds_read_b128 v[76:79], v128 offset:22528
    v_mfma_f32_16x16x32_bf16 v[16:19], v[100:103], v[32:35], v[16:19]
    ds_read_b64_tr_b16 v[116:117], v132 offset:40960
    v_mfma_f32_16x16x32_bf16 v[20:23], v[100:103], v[36:39], v[20:23]
    ds_read_b64_tr_b16 v[118:119], v132 offset:43008
    v_mfma_f32_16x16x32_bf16 v[24:27], v[100:103], v[40:43], v[24:27]
    ds_read_b64_tr_b16 v[120:121], v131 offset:45056
    ds_read_b64_tr_b16 v[122:123], v131 offset:47104
    v_mfma_f32_16x16x32_bf16 v[28:31], v[100:103], v[44:47], v[28:31]
    ds_read_b128 v[80:83], v128 offset:17408
    v_mfma_f32_16x16x32_bf16 v[0:3], v[104:107], v[48:51], v[0:3]
    ds_read_b128 v[84:87], v128 offset:19456
    v_mfma_f32_16x16x32_bf16 v[4:7], v[104:107], v[52:55], v[4:7]
    ds_read_b128 v[88:91], v128 offset:21504
    ds_read_b128 v[92:95], v128 offset:23552
    v_mfma_f32_16x16x32_bf16 v[8:11], v[104:107], v[56:59], v[8:11]
    ds_read_b64_tr_b16 v[124:125], v132 offset:45056
    v_mfma_f32_16x16x32_bf16 v[12:15], v[104:107], v[60:63], v[12:15]
    ds_read_b64_tr_b16 v[126:127], v132 offset:47104
    v_mfma_f32_16x16x32_bf16 v[16:19], v[108:111], v[48:51], v[16:19]
    v_mfma_f32_16x16x32_bf16 v[20:23], v[108:111], v[52:55], v[20:23]
    v_mfma_f32_16x16x32_bf16 v[24:27], v[108:111], v[56:59], v[24:27]
    v_mfma_f32_16x16x32_bf16 v[28:31], v[108:111], v[60:63], v[28:31]
    s_waitcnt lgkmcnt(0)
    s_barrier
    .p2align 3
    v_mfma_f32_16x16x32_bf16 v[0:3], v[112:115], v[64:67], v[0:3]
    ds_read_b64_tr_b16 v[96:97], v129 offset:0
    ds_read_b64_tr_b16 v[98:99], v129 offset:2048
    v_mfma_f32_16x16x32_bf16 v[4:7], v[112:115], v[68:71], v[4:7]
    ds_read_b128 v[32:35], v128 offset:32768
    v_mfma_f32_16x16x32_bf16 v[8:11], v[112:115], v[72:75], v[8:11]
    ds_read_b128 v[36:39], v128 offset:34816
    v_mfma_f32_16x16x32_bf16 v[12:15], v[112:115], v[76:79], v[12:15]
    ds_read_b128 v[40:43], v128 offset:36864
    ds_read_b128 v[44:47], v128 offset:38912
    v_mfma_f32_16x16x32_bf16 v[16:19], v[116:119], v[64:67], v[16:19]
    ds_read_b64_tr_b16 v[100:101], v130 offset:0
    v_mfma_f32_16x16x32_bf16 v[20:23], v[116:119], v[68:71], v[20:23]
    ds_read_b64_tr_b16 v[102:103], v130 offset:2048
    v_mfma_f32_16x16x32_bf16 v[24:27], v[116:119], v[72:75], v[24:27]
    ds_read_b64_tr_b16 v[104:105], v129 offset:4096
    ds_read_b64_tr_b16 v[106:107], v129 offset:6144
    v_mfma_f32_16x16x32_bf16 v[28:31], v[116:119], v[76:79], v[28:31]
    ds_read_b128 v[48:51], v128 offset:33792
    v_mfma_f32_16x16x32_bf16 v[0:3], v[120:123], v[80:83], v[0:3]
    ds_read_b128 v[52:55], v128 offset:35840
    v_mfma_f32_16x16x32_bf16 v[4:7], v[120:123], v[84:87], v[4:7]
    ds_read_b128 v[56:59], v128 offset:37888
    ds_read_b128 v[60:63], v128 offset:39936
    v_mfma_f32_16x16x32_bf16 v[8:11], v[120:123], v[88:91], v[8:11]
    ds_read_b64_tr_b16 v[108:109], v130 offset:4096
    v_mfma_f32_16x16x32_bf16 v[12:15], v[120:123], v[92:95], v[12:15]
    ds_read_b64_tr_b16 v[110:111], v130 offset:6144
    v_mfma_f32_16x16x32_bf16 v[16:19], v[124:127], v[80:83], v[16:19]
    v_mfma_f32_16x16x32_bf16 v[20:23], v[124:127], v[84:87], v[20:23]
    v_mfma_f32_16x16x32_bf16 v[24:27], v[124:127], v[88:91], v[24:27]
    v_mfma_f32_16x16x32_bf16 v[28:31], v[124:127], v[92:95], v[28:31]
    s_waitcnt lgkmcnt(0)
    s_barrier
    .p2align 3
    v_mfma_f32_16x16x32_bf16 v[0:3], v[96:99], v[32:35], v[0:3]
    ds_read_b64_tr_b16 v[112:113], v129 offset:8192
    ds_read_b64_tr_b16 v[114:115], v129 offset:10240
    v_mfma_f32_16x16x32_bf16 v[4:7], v[96:99], v[36:39], v[4:7]
    ds_read_b128 v[64:67], v128 offset:0
    v_mfma_f32_16x16x32_bf16 v[8:11], v[96:99], v[40:43], v[8:11]
    ds_read_b128 v[68:71], v128 offset:2048
    v_mfma_f32_16x16x32_bf16 v[12:15], v[96:99], v[44:47], v[12:15]
    ds_read_b128 v[72:75], v128 offset:4096
    ds_read_b128 v[76:79], v128 offset:6144
    v_mfma_f32_16x16x32_bf16 v[16:19], v[100:103], v[32:35], v[16:19]
    ds_read_b64_tr_b16 v[116:117], v130 offset:8192
    v_mfma_f32_16x16x32_bf16 v[20:23], v[100:103], v[36:39], v[20:23]
    ds_read_b64_tr_b16 v[118:119], v130 offset:10240
    v_mfma_f32_16x16x32_bf16 v[24:27], v[100:103], v[40:43], v[24:27]
    ds_read_b64_tr_b16 v[120:121], v129 offset:12288
    ds_read_b64_tr_b16 v[122:123], v129 offset:14336
    v_mfma_f32_16x16x32_bf16 v[28:31], v[100:103], v[44:47], v[28:31]
    ds_read_b128 v[80:83], v128 offset:1024
    v_mfma_f32_16x16x32_bf16 v[0:3], v[104:107], v[48:51], v[0:3]
    ds_read_b128 v[84:87], v128 offset:3072
    v_mfma_f32_16x16x32_bf16 v[4:7], v[104:107], v[52:55], v[4:7]
    ds_read_b128 v[88:91], v128 offset:5120
    ds_read_b128 v[92:95], v128 offset:7168
    v_mfma_f32_16x16x32_bf16 v[8:11], v[104:107], v[56:59], v[8:11]
    ds_read_b64_tr_b16 v[124:125], v130 offset:12288
    v_mfma_f32_16x16x32_bf16 v[12:15], v[104:107], v[60:63], v[12:15]
    ds_read_b64_tr_b16 v[126:127], v130 offset:14336
    v_mfma_f32_16x16x32_bf16 v[16:19], v[108:111], v[48:51], v[16:19]
    v_mfma_f32_16x16x32_bf16 v[20:23], v[108:111], v[52:55], v[20:23]
    v_mfma_f32_16x16x32_bf16 v[24:27], v[108:111], v[56:59], v[24:27]
    v_mfma_f32_16x16x32_bf16 v[28:31], v[108:111], v[60:63], v[28:31]
    s_waitcnt lgkmcnt(0)
    s_barrier
    .p2align 3
    v_mfma_f32_16x16x32_bf16 v[0:3], v[112:115], v[64:67], v[0:3]
    ds_read_b64_tr_b16 v[96:97], v129 offset:16384
    ds_read_b64_tr_b16 v[98:99], v129 offset:18432
    v_mfma_f32_16x16x32_bf16 v[4:7], v[112:115], v[68:71], v[4:7]
    ds_read_b128 v[32:35], v128 offset:16384
    v_mfma_f32_16x16x32_bf16 v[8:11], v[112:115], v[72:75], v[8:11]
    ds_read_b128 v[36:39], v128 offset:18432
    v_mfma_f32_16x16x32_bf16 v[12:15], v[112:115], v[76:79], v[12:15]
    ds_read_b128 v[40:43], v128 offset:20480
    ds_read_b128 v[44:47], v128 offset:22528
    v_mfma_f32_16x16x32_bf16 v[16:19], v[116:119], v[64:67], v[16:19]
    ds_read_b64_tr_b16 v[100:101], v130 offset:16384
    v_mfma_f32_16x16x32_bf16 v[20:23], v[116:119], v[68:71], v[20:23]
    ds_read_b64_tr_b16 v[102:103], v130 offset:18432
    v_mfma_f32_16x16x32_bf16 v[24:27], v[116:119], v[72:75], v[24:27]
    ds_read_b64_tr_b16 v[104:105], v129 offset:20480
    ds_read_b64_tr_b16 v[106:107], v129 offset:22528
    v_mfma_f32_16x16x32_bf16 v[28:31], v[116:119], v[76:79], v[28:31]
    ds_read_b128 v[48:51], v128 offset:17408
    v_mfma_f32_16x16x32_bf16 v[0:3], v[120:123], v[80:83], v[0:3]
    ds_read_b128 v[52:55], v128 offset:19456
    v_mfma_f32_16x16x32_bf16 v[4:7], v[120:123], v[84:87], v[4:7]
    ds_read_b128 v[56:59], v128 offset:21504
    ds_read_b128 v[60:63], v128 offset:23552
    v_mfma_f32_16x16x32_bf16 v[8:11], v[120:123], v[88:91], v[8:11]
    ds_read_b64_tr_b16 v[108:109], v130 offset:20480
    v_mfma_f32_16x16x32_bf16 v[12:15], v[120:123], v[92:95], v[12:15]
    ds_read_b64_tr_b16 v[110:111], v130 offset:22528
    v_mfma_f32_16x16x32_bf16 v[16:19], v[124:127], v[80:83], v[16:19]
    v_mfma_f32_16x16x32_bf16 v[20:23], v[124:127], v[84:87], v[20:23]
    v_mfma_f32_16x16x32_bf16 v[24:27], v[124:127], v[88:91], v[24:27]
    v_mfma_f32_16x16x32_bf16 v[28:31], v[124:127], v[92:95], v[28:31]
    s_waitcnt lgkmcnt(0)
    s_barrier
    .p2align 3
    v_mfma_f32_16x16x32_bf16 v[0:3], v[96:99], v[32:35], v[0:3]
    ds_read_b64_tr_b16 v[112:113], v129 offset:24576
    ds_read_b64_tr_b16 v[114:115], v129 offset:26624
    v_mfma_f32_16x16x32_bf16 v[4:7], v[96:99], v[36:39], v[4:7]
    ds_read_b128 v[64:67], v128 offset:32768
    v_mfma_f32_16x16x32_bf16 v[8:11], v[96:99], v[40:43], v[8:11]
    ds_read_b128 v[68:71], v128 offset:34816
    v_mfma_f32_16x16x32_bf16 v[12:15], v[96:99], v[44:47], v[12:15]
    ds_read_b128 v[72:75], v128 offset:36864
    ds_read_b128 v[76:79], v128 offset:38912
    v_mfma_f32_16x16x32_bf16 v[16:19], v[100:103], v[32:35], v[16:19]
    ds_read_b64_tr_b16 v[116:117], v130 offset:24576
    v_mfma_f32_16x16x32_bf16 v[20:23], v[100:103], v[36:39], v[20:23]
    ds_read_b64_tr_b16 v[118:119], v130 offset:26624
    v_mfma_f32_16x16x32_bf16 v[24:27], v[100:103], v[40:43], v[24:27]
    ds_read_b64_tr_b16 v[120:121], v129 offset:28672
    ds_read_b64_tr_b16 v[122:123], v129 offset:30720
    v_mfma_f32_16x16x32_bf16 v[28:31], v[100:103], v[44:47], v[28:31]
    ds_read_b128 v[80:83], v128 offset:33792
    v_mfma_f32_16x16x32_bf16 v[0:3], v[104:107], v[48:51], v[0:3]
    ds_read_b128 v[84:87], v128 offset:35840
    v_mfma_f32_16x16x32_bf16 v[4:7], v[104:107], v[52:55], v[4:7]
    ds_read_b128 v[88:91], v128 offset:37888
    ds_read_b128 v[92:95], v128 offset:39936
    v_mfma_f32_16x16x32_bf16 v[8:11], v[104:107], v[56:59], v[8:11]
    ds_read_b64_tr_b16 v[124:125], v130 offset:28672
    v_mfma_f32_16x16x32_bf16 v[12:15], v[104:107], v[60:63], v[12:15]
    ds_read_b64_tr_b16 v[126:127], v130 offset:30720
    v_mfma_f32_16x16x32_bf16 v[16:19], v[108:111], v[48:51], v[16:19]
    v_mfma_f32_16x16x32_bf16 v[20:23], v[108:111], v[52:55], v[20:23]
    v_mfma_f32_16x16x32_bf16 v[24:27], v[108:111], v[56:59], v[24:27]
    v_mfma_f32_16x16x32_bf16 v[28:31], v[108:111], v[60:63], v[28:31]
    s_waitcnt lgkmcnt(0)
    s_barrier
    .p2align 3
    v_mfma_f32_16x16x32_bf16 v[0:3], v[112:115], v[64:67], v[0:3]
    ds_read_b64_tr_b16 v[96:97], v129 offset:32768
    ds_read_b64_tr_b16 v[98:99], v129 offset:34816
    v_mfma_f32_16x16x32_bf16 v[4:7], v[112:115], v[68:71], v[4:7]
    ds_read_b128 v[32:35], v128 offset:0
    v_mfma_f32_16x16x32_bf16 v[8:11], v[112:115], v[72:75], v[8:11]
    ds_read_b128 v[36:39], v128 offset:2048
    v_mfma_f32_16x16x32_bf16 v[12:15], v[112:115], v[76:79], v[12:15]
    ds_read_b128 v[40:43], v128 offset:4096
    ds_read_b128 v[44:47], v128 offset:6144
    v_mfma_f32_16x16x32_bf16 v[16:19], v[116:119], v[64:67], v[16:19]
    ds_read_b64_tr_b16 v[100:101], v130 offset:32768
    v_mfma_f32_16x16x32_bf16 v[20:23], v[116:119], v[68:71], v[20:23]
    ds_read_b64_tr_b16 v[102:103], v130 offset:34816
    v_mfma_f32_16x16x32_bf16 v[24:27], v[116:119], v[72:75], v[24:27]
    ds_read_b64_tr_b16 v[104:105], v129 offset:36864
    ds_read_b64_tr_b16 v[106:107], v129 offset:38912
    v_mfma_f32_16x16x32_bf16 v[28:31], v[116:119], v[76:79], v[28:31]
    ds_read_b128 v[48:51], v128 offset:1024
    v_mfma_f32_16x16x32_bf16 v[0:3], v[120:123], v[80:83], v[0:3]
    ds_read_b128 v[52:55], v128 offset:3072
    v_mfma_f32_16x16x32_bf16 v[4:7], v[120:123], v[84:87], v[4:7]
    ds_read_b128 v[56:59], v128 offset:5120
    ds_read_b128 v[60:63], v128 offset:7168
    v_mfma_f32_16x16x32_bf16 v[8:11], v[120:123], v[88:91], v[8:11]
    ds_read_b64_tr_b16 v[108:109], v130 offset:36864
    v_mfma_f32_16x16x32_bf16 v[12:15], v[120:123], v[92:95], v[12:15]
    ds_read_b64_tr_b16 v[110:111], v130 offset:38912
    v_mfma_f32_16x16x32_bf16 v[16:19], v[124:127], v[80:83], v[16:19]
    v_mfma_f32_16x16x32_bf16 v[20:23], v[124:127], v[84:87], v[20:23]
    v_mfma_f32_16x16x32_bf16 v[24:27], v[124:127], v[88:91], v[24:27]
    v_mfma_f32_16x16x32_bf16 v[28:31], v[124:127], v[92:95], v[28:31]
    s_waitcnt lgkmcnt(0)
    s_barrier
    .p2align 3
    v_mfma_f32_16x16x32_bf16 v[0:3], v[96:99], v[32:35], v[0:3]
    ds_read_b64_tr_b16 v[112:113], v129 offset:40960
    ds_read_b64_tr_b16 v[114:115], v129 offset:43008
    v_mfma_f32_16x16x32_bf16 v[4:7], v[96:99], v[36:39], v[4:7]
    ds_read_b128 v[64:67], v128 offset:16384
    v_mfma_f32_16x16x32_bf16 v[8:11], v[96:99], v[40:43], v[8:11]
    ds_read_b128 v[68:71], v128 offset:18432
    v_mfma_f32_16x16x32_bf16 v[12:15], v[96:99], v[44:47], v[12:15]
    ds_read_b128 v[72:75], v128 offset:20480
    ds_read_b128 v[76:79], v128 offset:22528
    v_mfma_f32_16x16x32_bf16 v[16:19], v[100:103], v[32:35], v[16:19]
    ds_read_b64_tr_b16 v[116:117], v130 offset:40960
    v_mfma_f32_16x16x32_bf16 v[20:23], v[100:103], v[36:39], v[20:23]
    ds_read_b64_tr_b16 v[118:119], v130 offset:43008
    v_mfma_f32_16x16x32_bf16 v[24:27], v[100:103], v[40:43], v[24:27]
    ds_read_b64_tr_b16 v[120:121], v129 offset:45056
    ds_read_b64_tr_b16 v[122:123], v129 offset:47104
    v_mfma_f32_16x16x32_bf16 v[28:31], v[100:103], v[44:47], v[28:31]
    ds_read_b128 v[80:83], v128 offset:17408
    v_mfma_f32_16x16x32_bf16 v[0:3], v[104:107], v[48:51], v[0:3]
    ds_read_b128 v[84:87], v128 offset:19456
    v_mfma_f32_16x16x32_bf16 v[4:7], v[104:107], v[52:55], v[4:7]
    ds_read_b128 v[88:91], v128 offset:21504
    ds_read_b128 v[92:95], v128 offset:23552
    v_mfma_f32_16x16x32_bf16 v[8:11], v[104:107], v[56:59], v[8:11]
    ds_read_b64_tr_b16 v[124:125], v130 offset:45056
    v_mfma_f32_16x16x32_bf16 v[12:15], v[104:107], v[60:63], v[12:15]
    ds_read_b64_tr_b16 v[126:127], v130 offset:47104
    v_mfma_f32_16x16x32_bf16 v[16:19], v[108:111], v[48:51], v[16:19]
    v_mfma_f32_16x16x32_bf16 v[20:23], v[108:111], v[52:55], v[20:23]
    v_mfma_f32_16x16x32_bf16 v[24:27], v[108:111], v[56:59], v[24:27]
    v_mfma_f32_16x16x32_bf16 v[28:31], v[108:111], v[60:63], v[28:31]
    s_waitcnt lgkmcnt(0)
    s_barrier
    .p2align 3
    v_mfma_f32_16x16x32_bf16 v[0:3], v[112:115], v[64:67], v[0:3]
    ds_read_b64_tr_b16 v[96:97], v131 offset:0
    ds_read_b64_tr_b16 v[98:99], v131 offset:2048
    v_mfma_f32_16x16x32_bf16 v[4:7], v[112:115], v[68:71], v[4:7]
    ds_read_b128 v[32:35], v128 offset:32768
    v_mfma_f32_16x16x32_bf16 v[8:11], v[112:115], v[72:75], v[8:11]
    ds_read_b128 v[36:39], v128 offset:34816
    v_mfma_f32_16x16x32_bf16 v[12:15], v[112:115], v[76:79], v[12:15]
    ds_read_b128 v[40:43], v128 offset:36864
    ds_read_b128 v[44:47], v128 offset:38912
    v_mfma_f32_16x16x32_bf16 v[16:19], v[116:119], v[64:67], v[16:19]
    ds_read_b64_tr_b16 v[100:101], v132 offset:0
    v_mfma_f32_16x16x32_bf16 v[20:23], v[116:119], v[68:71], v[20:23]
    ds_read_b64_tr_b16 v[102:103], v132 offset:2048
    v_mfma_f32_16x16x32_bf16 v[24:27], v[116:119], v[72:75], v[24:27]
    ds_read_b64_tr_b16 v[104:105], v131 offset:4096
    ds_read_b64_tr_b16 v[106:107], v131 offset:6144
    v_mfma_f32_16x16x32_bf16 v[28:31], v[116:119], v[76:79], v[28:31]
    ds_read_b128 v[48:51], v128 offset:33792
    v_mfma_f32_16x16x32_bf16 v[0:3], v[120:123], v[80:83], v[0:3]
    ds_read_b128 v[52:55], v128 offset:35840
    v_mfma_f32_16x16x32_bf16 v[4:7], v[120:123], v[84:87], v[4:7]
    ds_read_b128 v[56:59], v128 offset:37888
    ds_read_b128 v[60:63], v128 offset:39936
    v_mfma_f32_16x16x32_bf16 v[8:11], v[120:123], v[88:91], v[8:11]
    ds_read_b64_tr_b16 v[108:109], v132 offset:4096
    v_mfma_f32_16x16x32_bf16 v[12:15], v[120:123], v[92:95], v[12:15]
    ds_read_b64_tr_b16 v[110:111], v132 offset:6144
    v_mfma_f32_16x16x32_bf16 v[16:19], v[124:127], v[80:83], v[16:19]
    v_mfma_f32_16x16x32_bf16 v[20:23], v[124:127], v[84:87], v[20:23]
    v_mfma_f32_16x16x32_bf16 v[24:27], v[124:127], v[88:91], v[24:27]
    v_mfma_f32_16x16x32_bf16 v[28:31], v[124:127], v[92:95], v[28:31]
    s_waitcnt lgkmcnt(0)
    s_barrier
    .p2align 3
    v_mfma_f32_16x16x32_bf16 v[0:3], v[96:99], v[32:35], v[0:3]
    ds_read_b64_tr_b16 v[112:113], v131 offset:8192
    ds_read_b64_tr_b16 v[114:115], v131 offset:10240
    v_mfma_f32_16x16x32_bf16 v[4:7], v[96:99], v[36:39], v[4:7]
    ds_read_b128 v[64:67], v128 offset:0
    v_mfma_f32_16x16x32_bf16 v[8:11], v[96:99], v[40:43], v[8:11]
    ds_read_b128 v[68:71], v128 offset:2048
    v_mfma_f32_16x16x32_bf16 v[12:15], v[96:99], v[44:47], v[12:15]
    ds_read_b128 v[72:75], v128 offset:4096
    ds_read_b128 v[76:79], v128 offset:6144
    v_mfma_f32_16x16x32_bf16 v[16:19], v[100:103], v[32:35], v[16:19]
    ds_read_b64_tr_b16 v[116:117], v132 offset:8192
    v_mfma_f32_16x16x32_bf16 v[20:23], v[100:103], v[36:39], v[20:23]
    ds_read_b64_tr_b16 v[118:119], v132 offset:10240
    v_mfma_f32_16x16x32_bf16 v[24:27], v[100:103], v[40:43], v[24:27]
    ds_read_b64_tr_b16 v[120:121], v131 offset:12288
    ds_read_b64_tr_b16 v[122:123], v131 offset:14336
    v_mfma_f32_16x16x32_bf16 v[28:31], v[100:103], v[44:47], v[28:31]
    ds_read_b128 v[80:83], v128 offset:1024
    v_mfma_f32_16x16x32_bf16 v[0:3], v[104:107], v[48:51], v[0:3]
    ds_read_b128 v[84:87], v128 offset:3072
    v_mfma_f32_16x16x32_bf16 v[4:7], v[104:107], v[52:55], v[4:7]
    ds_read_b128 v[88:91], v128 offset:5120
    ds_read_b128 v[92:95], v128 offset:7168
    v_mfma_f32_16x16x32_bf16 v[8:11], v[104:107], v[56:59], v[8:11]
    ds_read_b64_tr_b16 v[124:125], v132 offset:12288
    v_mfma_f32_16x16x32_bf16 v[12:15], v[104:107], v[60:63], v[12:15]
    ds_read_b64_tr_b16 v[126:127], v132 offset:14336
    v_mfma_f32_16x16x32_bf16 v[16:19], v[108:111], v[48:51], v[16:19]
    v_mfma_f32_16x16x32_bf16 v[20:23], v[108:111], v[52:55], v[20:23]
    v_mfma_f32_16x16x32_bf16 v[24:27], v[108:111], v[56:59], v[24:27]
    v_mfma_f32_16x16x32_bf16 v[28:31], v[108:111], v[60:63], v[28:31]
    s_waitcnt lgkmcnt(0)
    s_barrier
    .p2align 3
    v_mfma_f32_16x16x32_bf16 v[0:3], v[112:115], v[64:67], v[0:3]
    v_mfma_f32_16x16x32_bf16 v[4:7], v[112:115], v[68:71], v[4:7]
    v_mfma_f32_16x16x32_bf16 v[8:11], v[112:115], v[72:75], v[8:11]
    v_mfma_f32_16x16x32_bf16 v[12:15], v[112:115], v[76:79], v[12:15]
    v_mfma_f32_16x16x32_bf16 v[16:19], v[116:119], v[64:67], v[16:19]
    v_mfma_f32_16x16x32_bf16 v[20:23], v[116:119], v[68:71], v[20:23]
    v_mfma_f32_16x16x32_bf16 v[24:27], v[116:119], v[72:75], v[24:27]
    v_mfma_f32_16x16x32_bf16 v[28:31], v[116:119], v[76:79], v[28:31]
    v_mfma_f32_16x16x32_bf16 v[0:3], v[120:123], v[80:83], v[0:3]
    v_mfma_f32_16x16x32_bf16 v[4:7], v[120:123], v[84:87], v[4:7]
    v_mfma_f32_16x16x32_bf16 v[8:11], v[120:123], v[88:91], v[8:11]
    v_mfma_f32_16x16x32_bf16 v[12:15], v[120:123], v[92:95], v[12:15]
    v_mfma_f32_16x16x32_bf16 v[16:19], v[124:127], v[80:83], v[16:19]
    v_mfma_f32_16x16x32_bf16 v[20:23], v[124:127], v[84:87], v[20:23]
    v_mfma_f32_16x16x32_bf16 v[24:27], v[124:127], v[88:91], v[24:27]
    v_mfma_f32_16x16x32_bf16 v[28:31], v[124:127], v[92:95], v[28:31]
    s_nop 7
    s_lshl_b32 s55, s51, 14
    s_lshl_b32 s56, s43, 13
    s_add_u32 s55, s55, s56
    s_lshl_b32 s56, s44, 10
    s_add_u32 s55, s55, s56
    s_add_u32 s59, s55, s49
    s_add_u32 s60, s59, 4096
    v_cvt_pk_bf16_f32 v136, v0, v1
    v_cvt_pk_bf16_f32 v137, v2, v3
    v_cvt_pk_bf16_f32 v138, v16, v17
    v_cvt_pk_bf16_f32 v139, v18, v19
    buffer_store_dwordx4 v[136:139], v254, s[4:7], s59 offen offset:0 sc0 sc1
    v_cvt_pk_bf16_f32 v140, v4, v5
    v_cvt_pk_bf16_f32 v141, v6, v7
    v_cvt_pk_bf16_f32 v142, v20, v21
    v_cvt_pk_bf16_f32 v143, v22, v23
    buffer_store_dwordx4 v[140:143], v254, s[4:7], s59 offen offset:2048 sc0 sc1
    v_cvt_pk_bf16_f32 v144, v8, v9
    v_cvt_pk_bf16_f32 v145, v10, v11
    v_cvt_pk_bf16_f32 v146, v24, v25
    v_cvt_pk_bf16_f32 v147, v26, v27
    buffer_store_dwordx4 v[144:147], v254, s[4:7], s60 offen offset:0 sc0 sc1
    v_cvt_pk_bf16_f32 v148, v12, v13
    v_cvt_pk_bf16_f32 v149, v14, v15
    v_cvt_pk_bf16_f32 v150, v28, v29
    v_cvt_pk_bf16_f32 v151, v30, v31
    buffer_store_dwordx4 v[148:151], v254, s[4:7], s60 offen offset:2048 sc0 sc1
    v_mov_b32 v168, 0x3f803f80
    v_mov_b32 v160, 0
    v_mov_b32 v164, 0
    v_mov_b32 v161, 0
    v_mov_b32 v165, 0
    v_mov_b32 v162, 0
    v_mov_b32 v166, 0
    v_mov_b32 v163, 0
    v_mov_b32 v167, 0
    v_dot2_f32_bf16 v160, v136, v168, v160
    v_dot2_f32_bf16 v164, v136, v136, v164
    v_dot2_f32_bf16 v161, v140, v168, v161
    v_dot2_f32_bf16 v165, v140, v140, v165
    v_dot2_f32_bf16 v162, v144, v168, v162
    v_dot2_f32_bf16 v166, v144, v144, v166
    v_dot2_f32_bf16 v163, v148, v168, v163
    v_dot2_f32_bf16 v167, v148, v148, v167
    v_dot2_f32_bf16 v160, v137, v168, v160
    v_dot2_f32_bf16 v164, v137, v137, v164
    v_dot2_f32_bf16 v161, v141, v168, v161
    v_dot2_f32_bf16 v165, v141, v141, v165
    v_dot2_f32_bf16 v162, v145, v168, v162
    v_dot2_f32_bf16 v166, v145, v145, v166
    v_dot2_f32_bf16 v163, v149, v168, v163
    v_dot2_f32_bf16 v167, v149, v149, v167
    v_dot2_f32_bf16 v160, v138, v168, v160
    v_dot2_f32_bf16 v164, v138, v138, v164
    v_dot2_f32_bf16 v161, v142, v168, v161
    v_dot2_f32_bf16 v165, v142, v142, v165
    v_dot2_f32_bf16 v162, v146, v168, v162
    v_dot2_f32_bf16 v166, v146, v146, v166
    v_dot2_f32_bf16 v163, v150, v168, v163
    v_dot2_f32_bf16 v167, v150, v150, v167
    v_dot2_f32_bf16 v160, v139, v168, v160
    v_dot2_f32_bf16 v164, v139, v139, v164
    v_dot2_f32_bf16 v161, v143, v168, v161
    v_dot2_f32_bf16 v165, v143, v143, v165
    v_dot2_f32_bf16 v162, v147, v168, v162
    v_dot2_f32_bf16 v166, v147, v147, v166
    v_dot2_f32_bf16 v163, v151, v168, v163
    v_dot2_f32_bf16 v167, v151, v151, v167
    s_nop 3
    v_permlane32_swap_b32 v160, v162
    v_permlane32_swap_b32 v161, v163
    v_permlane32_swap_b32 v164, v166
    v_permlane32_swap_b32 v165, v167
    v_add_f32 v160, v160, v162
    v_add_f32 v161, v161, v163
    v_add_f32 v164, v164, v166
    v_add_f32 v165, v165, v167
    s_nop 1
    v_permlane16_swap_b32 v160, v161
    v_permlane16_swap_b32 v164, v165
    v_add_f32 v160, v160, v161
    v_add_f32 v161, v164, v165
    s_lshl_b32 s55, s51, 11
    s_lshl_b32 s56, s44, 10
    s_add_u32 s55, s55, s56
    s_lshl_b32 s56, s43, 9
    s_add_u32 s55, s55, s56
    s_add_u32 s59, s55, s52
    v_lshrrev_b32 v164, 1, v254
    buffer_store_dwordx2 v[160:161], v164, s[4:7], s59 offen sc0 sc1
    s_lshl_b32 s55, s43, 13
    s_add_u32 s55, s55, 98304
    v_add_u32 v224, s55, v254
    s_lshl_b32 s56, s44, 2
    v_lshrrev_b32 v233, 6, v254
    v_and_b32 v234, 7, v233
    v_xor_b32 v234, s56, v234
    v_lshlrev_b32 v233, 8, v233
    v_lshl_add_u32 v233, v234, 5, v233
    v_and_b32 v234, 0x30, v254
    v_lshrrev_b32 v234, 1, v234
    v_add_u32 v233, v233, v234
    v_xor_b32 v225, 0, v233
    v_xor_b32 v226, 32, v233
    v_xor_b32 v227, 64, v233
    v_xor_b32 v228, 96, v233
    v_add_u32 v229, 49152, v225
    v_add_u32 v230, 49152, v226
    v_add_u32 v231, 49152, v227
    v_add_u32 v232, 49152, v228
    s_cmp_ge_u32 s42, 2
    s_cbranch_scc1 x3_7
    s_lshl_b32 s61, s43, 13
    s_add_u32 s62, s49, s61
    s_and_b32 s55, s51, 1
    s_mul_i32 s55, s55, 458752
    s_add_u32 s63, s50, s55
    s_add_u32 s63, s63, s61
    s_branch x3_8
x3_7:
    s_mov_b32 s55, 5462
    v_lshrrev_b32 v233, 4, v254
    v_mul_lo_u32 v234, v233, s55
    v_lshrrev_b32 v234, 16, v234
    v_mul_u32_u24 v235, 12, v234
    v_sub_u32 v233, v233, v235
    v_lshrrev_b32 v235, 1, v234
    v_and_b32 v235, 2, v235
    v_xor_b32 v233, v233, v235
    v_mul_u32_u24 v234, 7168, v234
    v_lshl_add_u32 v236, v233, 4, v234
    v_lshrrev_b32 v233, 4, v254
    v_add_u32 v233, 64, v233
    v_mul_lo_u32 v234, v233, s55
    v_lshrrev_b32 v234, 16, v234
    v_mul_u32_u24 v235, 12, v234
    v_sub_u32 v233, v233, v235
    v_lshrrev_b32 v235, 1, v234
    v_and_b32 v235, 2, v235
    v_xor_b32 v233, v233, v235
    v_mul_u32_u24 v234, 7168, v234
    v_lshl_add_u32 v237, v233, 4, v234
    v_subrev_u32 v237, 1024, v237
    v_lshrrev_b32 v233, 4, v254
    v_add_u32 v233, 128, v233
    v_mul_lo_u32 v234, v233, s55
    v_lshrrev_b32 v234, 16, v234
    v_mul_u32_u24 v235, 12, v234
    v_sub_u32 v233, v233, v235
    v_lshrrev_b32 v235, 1, v234
    v_and_b32 v235, 2, v235
    v_xor_b32 v233, v233, v235
    v_mul_u32_u24 v234, 7168, v234
    v_lshl_add_u32 v238, v233, 4, v234
    v_subrev_u32 v238, 2048, v238
    s_mul_i32 s61, s43, 6144
    s_mul_i32 s63, s41, 448
    s_and_b32 s55, s41, 1
    s_xor_b32 s55, s55, 1
    s_lshl_b32 s55, s55, 8
    s_add_u32 s63, s63, s55
    v_and_b32 v234, 0xf0, v254
    v_lshrrev_b32 v233, 8, v254
    v_and_b32 v235, 7, v233
    v_lshlrev_b32 v235, 5, v235
    v_xor_b32 v235, v234, v235
    v_mul_u32_u24 v233, 2048, v233
    v_add_u32 v239, v233, v235
    v_lshrrev_b32 v233, 8, v254
    v_add_u32 v233, 4, v233
    v_and_b32 v235, 7, v233
    v_lshlrev_b32 v235, 5, v235
    v_xor_b32 v235, v234, v235
    v_mul_u32_u24 v233, 2048, v233
    v_add_u32 v240, v233, v235
    v_subrev_u32 v240, 1024, v240
    v_lshrrev_b32 v233, 8, v254
    v_add_u32 v233, 8, v233
    v_and_b32 v235, 7, v233
    v_lshlrev_b32 v235, 5, v235
    v_xor_b32 v235, v234, v235
    v_mul_u32_u24 v233, 2048, v233
    v_add_u32 v241, v233, v235
    v_subrev_u32 v241, 2048, v241
    v_lshrrev_b32 v233, 8, v254
    v_add_u32 v233, 12, v233
    v_and_b32 v235, 7, v233
    v_lshlrev_b32 v235, 5, v235
    v_xor_b32 v235, v234, v235
    v_mul_u32_u24 v233, 2048, v233
    v_add_u32 v242, v233, v235
    v_subrev_u32 v242, 3072, v242
    s_lshl_b32 s67, s43, 13
    s_and_b32 s55, s51, 1
    s_mul_i32 s68, s55, 3670016
    s_lshr_b32 s55, s51, 1
    s_lshl_b32 s55, s55, 8
    s_add_u32 s68, s68, s55
    s_mul_i32 s55, s43, 196608
    s_add_u32 s69, s68, s55
    s_lshl_b32 s55, s43, 17
    s_add_u32 s68, s68, s55
x3_8:
    v_mov_b32 v243, v224
    s_and_b32 s56, s51, 1
    s_lshl_b32 s56, s56, 2
    s_lshl_b32 s55, s44, 1
    s_add_u32 s56, s56, s55
    v_lshrrev_b32 v233, 6, v254
    v_and_b32 v234, 7, v233
    v_xor_b32 v234, s56, v234
    v_lshlrev_b32 v233, 8, v233
    v_lshl_add_u32 v233, v234, 5, v233
    v_and_b32 v234, 0x30, v254
    v_lshrrev_b32 v234, 1, v234
    v_add_u32 v233, v233, v234
    v_xor_b32 v244, 0, v233
    v_xor_b32 v245, 32, v233
    v_xor_b32 v246, 128, v233
    v_xor_b32 v247, 160, v233
    v_add_u32 v248, 49152, v244
    v_add_u32 v249, 49152, v245
    v_add_u32 v250, 49152, v246
    v_add_u32 v251, 49152, v247
    v_mov_b32 v0, 0
    v_mov_b32 v1, 0
    v_mov_b32 v2, 0
    v_mov_b32 v3, 0
    v_mov_b32 v4, 0
    v_mov_b32 v5, 0
    v_mov_b32 v6, 0
    v_mov_b32 v7, 0
    v_mov_b32 v8, 0
    v_mov_b32 v9, 0
    v_mov_b32 v10, 0
    v_mov_b32 v11, 0
    v_mov_b32 v12, 0
    v_mov_b32 v13, 0
    v_mov_b32 v14, 0
    v_mov_b32 v15, 0
    v_mov_b32 v16, 0
    v_mov_b32 v17, 0
    v_mov_b32 v18, 0
    v_mov_b32 v19, 0
    v_mov_b32 v20, 0
    v_mov_b32 v21, 0
    v_mov_b32 v22, 0
    v_mov_b32 v23, 0
    v_mov_b32 v24, 0
    v_mov_b32 v25, 0
    v_mov_b32 v26, 0
    v_mov_b32 v27, 0
    v_mov_b32 v28, 0
    v_mov_b32 v29, 0
    v_mov_b32 v30, 0
    v_mov_b32 v31, 0
    v_mov_b32 v32, 0
    v_mov_b32 v33, 0
    v_mov_b32 v34, 0
    v_mov_b32 v35, 0
    v_mov_b32 v36, 0
    v_mov_b32 v37, 0
    v_mov_b32 v38, 0
    v_mov_b32 v39, 0
    v_mov_b32 v40, 0
    v_mov_b32 v41, 0
    v_mov_b32 v42, 0
    v_mov_b32 v43, 0
    v_mov_b32 v44, 0
    v_mov_b32 v45, 0
    v_mov_b32 v46, 0
    v_mov_b32 v47, 0
    v_mov_b32 v48, 0
    v_mov_b32 v49, 0
    v_mov_b32 v50, 0
    v_mov_b32 v51, 0
    v_mov_b32 v52, 0
    v_mov_b32 v53, 0
    v_mov_b32 v54, 0
    v_mov_b32 v55, 0
    v_mov_b32 v56, 0
    v_mov_b32 v57, 0
    v_mov_b32 v58, 0
    v_mov_b32 v59, 0
    v_mov_b32 v60, 0
    v_mov_b32 v61, 0
    v_mov_b32 v62, 0
    v_mov_b32 v63, 0
    v_mov_b32 v64, 0
    v_mov_b32 v65, 0
    v_mov_b32 v66, 0
    v_mov_b32 v67, 0
    v_mov_b32 v68, 0
    v_mov_b32 v69, 0
    v_mov_b32 v70, 0
    v_mov_b32 v71, 0
    v_mov_b32 v72, 0
    v_mov_b32 v73, 0
    v_mov_b32 v74, 0
    v_mov_b32 v75, 0
    v_mov_b32 v76, 0
    v_mov_b32 v77, 0
    v_mov_b32 v78, 0
    v_mov_b32 v79, 0
    v_mov_b32 v80, 0
    v_mov_b32 v81, 0
    v_mov_b32 v82, 0
    v_mov_b32 v83, 0
    v_mov_b32 v84, 0
    v_mov_b32 v85, 0
    v_mov_b32 v86, 0
    v_mov_b32 v87, 0
    v_mov_b32 v88, 0
    v_mov_b32 v89, 0
    v_mov_b32 v90, 0
    v_mov_b32 v91, 0
    v_mov_b32 v92, 0
    v_mov_b32 v93, 0
    v_mov_b32 v94, 0
    v_mov_b32 v95, 0
    v_mov_b32 v96, 0
    v_mov_b32 v97, 0
    v_mov_b32 v98, 0
    v_mov_b32 v99, 0
    v_mov_b32 v100, 0
    v_mov_b32 v101, 0
    v_mov_b32 v102, 0
    v_mov_b32 v103, 0
    v_mov_b32 v104, 0
    v_mov_b32 v105, 0
    v_mov_b32 v106, 0
    v_mov_b32 v107, 0
    v_mov_b32 v108, 0
    v_mov_b32 v109, 0
    v_mov_b32 v110, 0
    v_mov_b32 v111, 0
    v_mov_b32 v112, 0
    v_mov_b32 v113, 0
    v_mov_b32 v114, 0
    v_mov_b32 v115, 0
    v_mov_b32 v116, 0
    v_mov_b32 v117, 0
    v_mov_b32 v118, 0
    v_mov_b32 v119, 0
    v_mov_b32 v120, 0
    v_mov_b32 v121, 0
    v_mov_b32 v122, 0
    v_mov_b32 v123, 0
    v_mov_b32 v124, 0
    v_mov_b32 v125, 0
    v_mov_b32 v126, 0
    v_mov_b32 v127, 0
    s_lshr_b32 s55, s41, 3
    s_mul_i32 s55, s55, 28
    s_and_b32 s56, s41, 7
    s_add_u32 s55, s55, s56
    s_lshl_b32 s55, s55, 14
    s_lshl_b32 s56, s43, 13
    s_add_u32 s55, s55, s56
    s_lshl_b32 s56, s44, 10
    s_add_u32 s55, s55, s56
    s_add_u32 s64, s55, s50
    s_waitcnt vmcnt(1)
    s_barrier
    s_barrier
    ds_read_b64_tr_b16 v[160:161], v229 offset:16384
    ds_read_b64_tr_b16 v[162:163], v229 offset:20480
    ds_read_b128 v[128:131], v224 offset:0
    ds_read_b128 v[132:135], v224 offset:2048
    ds_read_b128 v[136:139], v224 offset:4096
    ds_read_b128 v[140:143], v224 offset:6144
    ds_read_b64_tr_b16 v[176:177], v229 offset:24576
    ds_read_b64_tr_b16 v[178:179], v229 offset:28672
    ds_read_b64_tr_b16 v[164:165], v230 offset:16384
    ds_read_b64_tr_b16 v[166:167], v230 offset:20480
    ds_read_b64_tr_b16 v[180:181], v230 offset:24576
    ds_read_b64_tr_b16 v[182:183], v230 offset:28672
    ds_read_b64_tr_b16 v[168:169], v231 offset:16384
    ds_read_b64_tr_b16 v[170:171], v231 offset:20480
    ds_read_b64_tr_b16 v[184:185], v231 offset:24576
    ds_read_b64_tr_b16 v[186:187], v231 offset:28672
    ds_read_b64_tr_b16 v[172:173], v232 offset:16384
    ds_read_b64_tr_b16 v[174:175], v232 offset:20480
    ds_read_b64_tr_b16 v[188:189], v232 offset:24576
    ds_read_b64_tr_b16 v[190:191], v232 offset:28672
    s_mov_b32 s58, 5
    .p2align 3
loop_9:
    s_waitcnt lgkmcnt(0)
    s_barrier
    .p2align 3
    v_mfma_f32_16x16x32_bf16 v[0:3], v[160:163], v[128:131], v[0:3]
    ds_read_b64_tr_b16 v[192:193], v229 offset:32768
    v_mfma_f32_16x16x32_bf16 v[4:7], v[160:163], v[132:135], v[4:7]
    ds_read_b64_tr_b16 v[194:195], v229 offset:36864
    v_mfma_f32_16x16x32_bf16 v[8:11], v[160:163], v[136:139], v[8:11]
    ds_read_b128 v[144:147], v224 offset:1024
    v_mfma_f32_16x16x32_bf16 v[12:15], v[160:163], v[140:143], v[12:15]
    ds_read_b128 v[148:151], v224 offset:3072
    v_mfma_f32_16x16x32_bf16 v[64:67], v[176:179], v[128:131], v[64:67]
    ds_read_b128 v[152:155], v224 offset:5120
    v_mfma_f32_16x16x32_bf16 v[68:71], v[176:179], v[132:135], v[68:71]
    v_mfma_f32_16x16x32_bf16 v[72:75], v[176:179], v[136:139], v[72:75]
    ds_read_b128 v[156:159], v224 offset:7168
    v_mfma_f32_16x16x32_bf16 v[76:79], v[176:179], v[140:143], v[76:79]
    ds_read_b64_tr_b16 v[208:209], v229 offset:40960
    v_mfma_f32_16x16x32_bf16 v[16:19], v[164:167], v[128:131], v[16:19]
    ds_read_b64_tr_b16 v[210:211], v229 offset:45056
    v_mfma_f32_16x16x32_bf16 v[20:23], v[164:167], v[132:135], v[20:23]
    ds_read_b64_tr_b16 v[196:197], v230 offset:32768
    v_mfma_f32_16x16x32_bf16 v[24:27], v[164:167], v[136:139], v[24:27]
    ds_read_b64_tr_b16 v[198:199], v230 offset:36864
    v_mfma_f32_16x16x32_bf16 v[28:31], v[164:167], v[140:143], v[28:31]
    v_mfma_f32_16x16x32_bf16 v[80:83], v[180:183], v[128:131], v[80:83]
    ds_read_b64_tr_b16 v[212:213], v230 offset:40960
    v_mfma_f32_16x16x32_bf16 v[84:87], v[180:183], v[132:135], v[84:87]
    ds_read_b64_tr_b16 v[214:215], v230 offset:45056
    v_mfma_f32_16x16x32_bf16 v[88:91], v[180:183], v[136:139], v[88:91]
    ds_read_b64_tr_b16 v[200:201], v231 offset:32768
    v_mfma_f32_16x16x32_bf16 v[92:95], v[180:183], v[140:143], v[92:95]
    ds_read_b64_tr_b16 v[202:203], v231 offset:36864
    v_mfma_f32_16x16x32_bf16 v[32:35], v[168:171], v[128:131], v[32:35]
    ds_read_b64_tr_b16 v[216:217], v231 offset:40960
    v_mfma_f32_16x16x32_bf16 v[36:39], v[168:171], v[132:135], v[36:39]
    v_mfma_f32_16x16x32_bf16 v[40:43], v[168:171], v[136:139], v[40:43]
    ds_read_b64_tr_b16 v[218:219], v231 offset:45056
    v_mfma_f32_16x16x32_bf16 v[44:47], v[168:171], v[140:143], v[44:47]
    ds_read_b64_tr_b16 v[204:205], v232 offset:32768
    v_mfma_f32_16x16x32_bf16 v[96:99], v[184:187], v[128:131], v[96:99]
    ds_read_b64_tr_b16 v[206:207], v232 offset:36864
    v_mfma_f32_16x16x32_bf16 v[100:103], v[184:187], v[132:135], v[100:103]
    ds_read_b64_tr_b16 v[220:221], v232 offset:40960
    v_mfma_f32_16x16x32_bf16 v[104:107], v[184:187], v[136:139], v[104:107]
    ds_read_b64_tr_b16 v[222:223], v232 offset:45056
    v_mfma_f32_16x16x32_bf16 v[108:111], v[184:187], v[140:143], v[108:111]
    v_mfma_f32_16x16x32_bf16 v[48:51], v[172:175], v[128:131], v[48:51]
    v_mfma_f32_16x16x32_bf16 v[52:55], v[172:175], v[132:135], v[52:55]
    v_mfma_f32_16x16x32_bf16 v[56:59], v[172:175], v[136:139], v[56:59]
    v_mfma_f32_16x16x32_bf16 v[60:63], v[172:175], v[140:143], v[60:63]
    v_mfma_f32_16x16x32_bf16 v[112:115], v[188:191], v[128:131], v[112:115]
    v_mfma_f32_16x16x32_bf16 v[116:119], v[188:191], v[132:135], v[116:119]
    v_mfma_f32_16x16x32_bf16 v[120:123], v[188:191], v[136:139], v[120:123]
    v_mfma_f32_16x16x32_bf16 v[124:127], v[188:191], v[140:143], v[124:127]
    s_waitcnt lgkmcnt(0)
    s_barrier
    .p2align 3
    v_mfma_f32_16x16x32_bf16 v[0:3], v[192:195], v[144:147], v[0:3]
    ds_read_b64_tr_b16 v[160:161], v225 offset:0
    v_mfma_f32_16x16x32_bf16 v[4:7], v[192:195], v[148:151], v[4:7]
    ds_read_b64_tr_b16 v[162:163], v225 offset:4096
    v_mfma_f32_16x16x32_bf16 v[8:11], v[192:195], v[152:155], v[8:11]
    ds_read_b128 v[128:131], v224 offset:16384
    v_mfma_f32_16x16x32_bf16 v[12:15], v[192:195], v[156:159], v[12:15]
    ds_read_b128 v[132:135], v224 offset:18432
    v_mfma_f32_16x16x32_bf16 v[64:67], v[208:211], v[144:147], v[64:67]
    ds_read_b128 v[136:139], v224 offset:20480
    v_mfma_f32_16x16x32_bf16 v[68:71], v[208:211], v[148:151], v[68:71]
    v_mfma_f32_16x16x32_bf16 v[72:75], v[208:211], v[152:155], v[72:75]
    ds_read_b128 v[140:143], v224 offset:22528
    v_mfma_f32_16x16x32_bf16 v[76:79], v[208:211], v[156:159], v[76:79]
    ds_read_b64_tr_b16 v[176:177], v225 offset:8192
    v_mfma_f32_16x16x32_bf16 v[16:19], v[196:199], v[144:147], v[16:19]
    ds_read_b64_tr_b16 v[178:179], v225 offset:12288
    v_mfma_f32_16x16x32_bf16 v[20:23], v[196:199], v[148:151], v[20:23]
    ds_read_b64_tr_b16 v[164:165], v226 offset:0
    v_mfma_f32_16x16x32_bf16 v[24:27], v[196:199], v[152:155], v[24:27]
    ds_read_b64_tr_b16 v[166:167], v226 offset:4096
    v_mfma_f32_16x16x32_bf16 v[28:31], v[196:199], v[156:159], v[28:31]
    v_mfma_f32_16x16x32_bf16 v[80:83], v[212:215], v[144:147], v[80:83]
    ds_read_b64_tr_b16 v[180:181], v226 offset:8192
    v_mfma_f32_16x16x32_bf16 v[84:87], v[212:215], v[148:151], v[84:87]
    ds_read_b64_tr_b16 v[182:183], v226 offset:12288
    v_mfma_f32_16x16x32_bf16 v[88:91], v[212:215], v[152:155], v[88:91]
    ds_read_b64_tr_b16 v[168:169], v227 offset:0
    v_mfma_f32_16x16x32_bf16 v[92:95], v[212:215], v[156:159], v[92:95]
    ds_read_b64_tr_b16 v[170:171], v227 offset:4096
    v_mfma_f32_16x16x32_bf16 v[32:35], v[200:203], v[144:147], v[32:35]
    ds_read_b64_tr_b16 v[184:185], v227 offset:8192
    v_mfma_f32_16x16x32_bf16 v[36:39], v[200:203], v[148:151], v[36:39]
    v_mfma_f32_16x16x32_bf16 v[40:43], v[200:203], v[152:155], v[40:43]
    ds_read_b64_tr_b16 v[186:187], v227 offset:12288
    v_mfma_f32_16x16x32_bf16 v[44:47], v[200:203], v[156:159], v[44:47]
    ds_read_b64_tr_b16 v[172:173], v228 offset:0
    v_mfma_f32_16x16x32_bf16 v[96:99], v[216:219], v[144:147], v[96:99]
    ds_read_b64_tr_b16 v[174:175], v228 offset:4096
    v_mfma_f32_16x16x32_bf16 v[100:103], v[216:219], v[148:151], v[100:103]
    ds_read_b64_tr_b16 v[188:189], v228 offset:8192
    v_mfma_f32_16x16x32_bf16 v[104:107], v[216:219], v[152:155], v[104:107]
    ds_read_b64_tr_b16 v[190:191], v228 offset:12288
    v_mfma_f32_16x16x32_bf16 v[108:111], v[216:219], v[156:159], v[108:111]
    v_mfma_f32_16x16x32_bf16 v[48:51], v[204:207], v[144:147], v[48:51]
    v_mfma_f32_16x16x32_bf16 v[52:55], v[204:207], v[148:151], v[52:55]
    v_mfma_f32_16x16x32_bf16 v[56:59], v[204:207], v[152:155], v[56:59]
    v_mfma_f32_16x16x32_bf16 v[60:63], v[204:207], v[156:159], v[60:63]
    v_mfma_f32_16x16x32_bf16 v[112:115], v[220:223], v[144:147], v[112:115]
    v_mfma_f32_16x16x32_bf16 v[116:119], v[220:223], v[148:151], v[116:119]
    v_mfma_f32_16x16x32_bf16 v[120:123], v[220:223], v[152:155], v[120:123]
    v_mfma_f32_16x16x32_bf16 v[124:127], v[220:223], v[156:159], v[124:127]
    s_waitcnt vmcnt(0) lgkmcnt(0)
    s_barrier
    .p2align 3
    v_mfma_f32_16x16x32_bf16 v[0:3], v[160:163], v[128:131], v[0:3]
    ds_read_b64_tr_b16 v[192:193], v225 offset:16384
    v_mfma_f32_16x16x32_bf16 v[4:7], v[160:163], v[132:135], v[4:7]
    ds_read_b64_tr_b16 v[194:195], v225 offset:20480
    v_mfma_f32_16x16x32_bf16 v[8:11], v[160:163], v[136:139], v[8:11]
    ds_read_b128 v[144:147], v224 offset:17408
    v_mfma_f32_16x16x32_bf16 v[12:15], v[160:163], v[140:143], v[12:15]
    ds_read_b128 v[148:151], v224 offset:19456
    v_mfma_f32_16x16x32_bf16 v[64:67], v[176:179], v[128:131], v[64:67]
    ds_read_b128 v[152:155], v224 offset:21504
    v_mfma_f32_16x16x32_bf16 v[68:71], v[176:179], v[132:135], v[68:71]
    v_mfma_f32_16x16x32_bf16 v[72:75], v[176:179], v[136:139], v[72:75]
    ds_read_b128 v[156:159], v224 offset:23552
    v_mfma_f32_16x16x32_bf16 v[76:79], v[176:179], v[140:143], v[76:79]
    ds_read_b64_tr_b16 v[208:209], v225 offset:24576
    v_mfma_f32_16x16x32_bf16 v[16:19], v[164:167], v[128:131], v[16:19]
    ds_read_b64_tr_b16 v[210:211], v225 offset:28672
    v_mfma_f32_16x16x32_bf16 v[20:23], v[164:167], v[132:135], v[20:23]
    ds_read_b64_tr_b16 v[196:197], v226 offset:16384
    v_mfma_f32_16x16x32_bf16 v[24:27], v[164:167], v[136:139], v[24:27]
    ds_read_b64_tr_b16 v[198:199], v226 offset:20480
    v_mfma_f32_16x16x32_bf16 v[28:31], v[164:167], v[140:143], v[28:31]
    v_mfma_f32_16x16x32_bf16 v[80:83], v[180:183], v[128:131], v[80:83]
    ds_read_b64_tr_b16 v[212:213], v226 offset:24576
    v_mfma_f32_16x16x32_bf16 v[84:87], v[180:183], v[132:135], v[84:87]
    ds_read_b64_tr_b16 v[214:215], v226 offset:28672
    v_mfma_f32_16x16x32_bf16 v[88:91], v[180:183], v[136:139], v[88:91]
    ds_read_b64_tr_b16 v[200:201], v227 offset:16384
    v_mfma_f32_16x16x32_bf16 v[92:95], v[180:183], v[140:143], v[92:95]
    ds_read_b64_tr_b16 v[202:203], v227 offset:20480
    v_mfma_f32_16x16x32_bf16 v[32:35], v[168:171], v[128:131], v[32:35]
    ds_read_b64_tr_b16 v[216:217], v227 offset:24576
    v_mfma_f32_16x16x32_bf16 v[36:39], v[168:171], v[132:135], v[36:39]
    v_mfma_f32_16x16x32_bf16 v[40:43], v[168:171], v[136:139], v[40:43]
    ds_read_b64_tr_b16 v[218:219], v227 offset:28672
    v_mfma_f32_16x16x32_bf16 v[44:47], v[168:171], v[140:143], v[44:47]
    ds_read_b64_tr_b16 v[204:205], v228 offset:16384
    v_mfma_f32_16x16x32_bf16 v[96:99], v[184:187], v[128:131], v[96:99]
    ds_read_b64_tr_b16 v[206:207], v228 offset:20480
    v_mfma_f32_16x16x32_bf16 v[100:103], v[184:187], v[132:135], v[100:103]
    ds_read_b64_tr_b16 v[220:221], v228 offset:24576
    v_mfma_f32_16x16x32_bf16 v[104:107], v[184:187], v[136:139], v[104:107]
    ds_read_b64_tr_b16 v[222:223], v228 offset:28672
    v_mfma_f32_16x16x32_bf16 v[108:111], v[184:187], v[140:143], v[108:111]
    v_mfma_f32_16x16x32_bf16 v[48:51], v[172:175], v[128:131], v[48:51]
    v_mfma_f32_16x16x32_bf16 v[52:55], v[172:175], v[132:135], v[52:55]
    v_mfma_f32_16x16x32_bf16 v[56:59], v[172:175], v[136:139], v[56:59]
    v_mfma_f32_16x16x32_bf16 v[60:63], v[172:175], v[140:143], v[60:63]
    v_mfma_f32_16x16x32_bf16 v[112:115], v[188:191], v[128:131], v[112:115]
    v_mfma_f32_16x16x32_bf16 v[116:119], v[188:191], v[132:135], v[116:119]
    v_mfma_f32_16x16x32_bf16 v[120:123], v[188:191], v[136:139], v[120:123]
    v_mfma_f32_16x16x32_bf16 v[124:127], v[188:191], v[140:143], v[124:127]
    s_waitcnt lgkmcnt(0)
    s_barrier
    .p2align 3
    v_mfma_f32_16x16x32_bf16 v[0:3], v[192:195], v[144:147], v[0:3]
    ds_read_b64_tr_b16 v[160:161], v225 offset:32768
    v_mfma_f32_16x16x32_bf16 v[4:7], v[192:195], v[148:151], v[4:7]
    ds_read_b64_tr_b16 v[162:163], v225 offset:36864
    v_mfma_f32_16x16x32_bf16 v[8:11], v[192:195], v[152:155], v[8:11]
    ds_read_b128 v[128:131], v224 offset:32768
    v_mfma_f32_16x16x32_bf16 v[12:15], v[192:195], v[156:159], v[12:15]
    ds_read_b128 v[132:135], v224 offset:34816
    v_mfma_f32_16x16x32_bf16 v[64:67], v[208:211], v[144:147], v[64:67]
    ds_read_b128 v[136:139], v224 offset:36864
    v_mfma_f32_16x16x32_bf16 v[68:71], v[208:211], v[148:151], v[68:71]
    v_mfma_f32_16x16x32_bf16 v[72:75], v[208:211], v[152:155], v[72:75]
    ds_read_b128 v[140:143], v224 offset:38912
    v_mfma_f32_16x16x32_bf16 v[76:79], v[208:211], v[156:159], v[76:79]
    ds_read_b64_tr_b16 v[176:177], v225 offset:40960
    v_mfma_f32_16x16x32_bf16 v[16:19], v[196:199], v[144:147], v[16:19]
    ds_read_b64_tr_b16 v[178:179], v225 offset:45056
    v_mfma_f32_16x16x32_bf16 v[20:23], v[196:199], v[148:151], v[20:23]
    ds_read_b64_tr_b16 v[164:165], v226 offset:32768
    v_mfma_f32_16x16x32_bf16 v[24:27], v[196:199], v[152:155], v[24:27]
    ds_read_b64_tr_b16 v[166:167], v226 offset:36864
    v_mfma_f32_16x16x32_bf16 v[28:31], v[196:199], v[156:159], v[28:31]
    v_mfma_f32_16x16x32_bf16 v[80:83], v[212:215], v[144:147], v[80:83]
    ds_read_b64_tr_b16 v[180:181], v226 offset:40960
    v_mfma_f32_16x16x32_bf16 v[84:87], v[212:215], v[148:151], v[84:87]
    ds_read_b64_tr_b16 v[182:183], v226 offset:45056
    v_mfma_f32_16x16x32_bf16 v[88:91], v[212:215], v[152:155], v[88:91]
    ds_read_b64_tr_b16 v[168:169], v227 offset:32768
    v_mfma_f32_16x16x32_bf16 v[92:95], v[212:215], v[156:159], v[92:95]
    ds_read_b64_tr_b16 v[170:171], v227 offset:36864
    v_mfma_f32_16x16x32_bf16 v[32:35], v[200:203], v[144:147], v[32:35]
    ds_read_b64_tr_b16 v[184:185], v227 offset:40960
    v_mfma_f32_16x16x32_bf16 v[36:39], v[200:203], v[148:151], v[36:39]
    v_mfma_f32_16x16x32_bf16 v[40:43], v[200:203], v[152:155], v[40:43]
    ds_read_b64_tr_b16 v[186:187], v227 offset:45056
    v_mfma_f32_16x16x32_bf16 v[44:47], v[200:203], v[156:159], v[44:47]
    ds_read_b64_tr_b16 v[172:173], v228 offset:32768
    v_mfma_f32_16x16x32_bf16 v[96:99], v[216:219], v[144:147], v[96:99]
    ds_read_b64_tr_b16 v[174:175], v228 offset:36864
    v_mfma_f32_16x16x32_bf16 v[100:103], v[216:219], v[148:151], v[100:103]
    ds_read_b64_tr_b16 v[188:189], v228 offset:40960
    v_mfma_f32_16x16x32_bf16 v[104:107], v[216:219], v[152:155], v[104:107]
    ds_read_b64_tr_b16 v[190:191], v228 offset:45056
    v_mfma_f32_16x16x32_bf16 v[108:111], v[216:219], v[156:159], v[108:111]
    v_mfma_f32_16x16x32_bf16 v[48:51], v[204:207], v[144:147], v[48:51]
    v_mfma_f32_16x16x32_bf16 v[52:55], v[204:207], v[148:151], v[52:55]
    v_mfma_f32_16x16x32_bf16 v[56:59], v[204:207], v[152:155], v[56:59]
    v_mfma_f32_16x16x32_bf16 v[60:63], v[204:207], v[156:159], v[60:63]
    v_mfma_f32_16x16x32_bf16 v[112:115], v[220:223], v[144:147], v[112:115]
    v_mfma_f32_16x16x32_bf16 v[116:119], v[220:223], v[148:151], v[116:119]
    v_mfma_f32_16x16x32_bf16 v[120:123], v[220:223], v[152:155], v[120:123]
    v_mfma_f32_16x16x32_bf16 v[124:127], v[220:223], v[156:159], v[124:127]
    s_waitcnt lgkmcnt(0)
    s_barrier
    .p2align 3
    v_mfma_f32_16x16x32_bf16 v[0:3], v[160:163], v[128:131], v[0:3]
    ds_read_b64_tr_b16 v[192:193], v229 offset:0
    v_mfma_f32_16x16x32_bf16 v[4:7], v[160:163], v[132:135], v[4:7]
    ds_read_b64_tr_b16 v[194:195], v229 offset:4096
    v_mfma_f32_16x16x32_bf16 v[8:11], v[160:163], v[136:139], v[8:11]
    ds_read_b128 v[144:147], v224 offset:33792
    v_mfma_f32_16x16x32_bf16 v[12:15], v[160:163], v[140:143], v[12:15]
    ds_read_b128 v[148:151], v224 offset:35840
    v_mfma_f32_16x16x32_bf16 v[64:67], v[176:179], v[128:131], v[64:67]
    ds_read_b128 v[152:155], v224 offset:37888
    v_mfma_f32_16x16x32_bf16 v[68:71], v[176:179], v[132:135], v[68:71]
    v_mfma_f32_16x16x32_bf16 v[72:75], v[176:179], v[136:139], v[72:75]
    ds_read_b128 v[156:159], v224 offset:39936
    v_mfma_f32_16x16x32_bf16 v[76:79], v[176:179], v[140:143], v[76:79]
    ds_read_b64_tr_b16 v[208:209], v229 offset:8192
    v_mfma_f32_16x16x32_bf16 v[16:19], v[164:167], v[128:131], v[16:19]
    ds_read_b64_tr_b16 v[210:211], v229 offset:12288
    v_mfma_f32_16x16x32_bf16 v[20:23], v[164:167], v[132:135], v[20:23]
    ds_read_b64_tr_b16 v[196:197], v230 offset:0
    v_mfma_f32_16x16x32_bf16 v[24:27], v[164:167], v[136:139], v[24:27]
    ds_read_b64_tr_b16 v[198:199], v230 offset:4096
    v_mfma_f32_16x16x32_bf16 v[28:31], v[164:167], v[140:143], v[28:31]
    v_mfma_f32_16x16x32_bf16 v[80:83], v[180:183], v[128:131], v[80:83]
    ds_read_b64_tr_b16 v[212:213], v230 offset:8192
    v_mfma_f32_16x16x32_bf16 v[84:87], v[180:183], v[132:135], v[84:87]
    ds_read_b64_tr_b16 v[214:215], v230 offset:12288
    v_mfma_f32_16x16x32_bf16 v[88:91], v[180:183], v[136:139], v[88:91]
    ds_read_b64_tr_b16 v[200:201], v231 offset:0
    v_mfma_f32_16x16x32_bf16 v[92:95], v[180:183], v[140:143], v[92:95]
    ds_read_b64_tr_b16 v[202:203], v231 offset:4096
    v_mfma_f32_16x16x32_bf16 v[32:35], v[168:171], v[128:131], v[32:35]
    ds_read_b64_tr_b16 v[216:217], v231 offset:8192
    v_mfma_f32_16x16x32_bf16 v[36:39], v[168:171], v[132:135], v[36:39]
    v_mfma_f32_16x16x32_bf16 v[40:43], v[168:171], v[136:139], v[40:43]
    ds_read_b64_tr_b16 v[218:219], v231 offset:12288
    v_mfma_f32_16x16x32_bf16 v[44:47], v[168:171], v[140:143], v[44:47]
    ds_read_b64_tr_b16 v[204:205], v232 offset:0
    v_mfma_f32_16x16x32_bf16 v[96:99], v[184:187], v[128:131], v[96:99]
    ds_read_b64_tr_b16 v[206:207], v232 offset:4096
    v_mfma_f32_16x16x32_bf16 v[100:103], v[184:187], v[132:135], v[100:103]
    ds_read_b64_tr_b16 v[220:221], v232 offset:8192
    v_mfma_f32_16x16x32_bf16 v[104:107], v[184:187], v[136:139], v[104:107]
    ds_read_b64_tr_b16 v[222:223], v232 offset:12288
    v_mfma_f32_16x16x32_bf16 v[108:111], v[184:187], v[140:143], v[108:111]
    v_mfma_f32_16x16x32_bf16 v[48:51], v[172:175], v[128:131], v[48:51]
    v_mfma_f32_16x16x32_bf16 v[52:55], v[172:175], v[132:135], v[52:55]
    v_mfma_f32_16x16x32_bf16 v[56:59], v[172:175], v[136:139], v[56:59]
    v_mfma_f32_16x16x32_bf16 v[60:63], v[172:175], v[140:143], v[60:63]
    v_mfma_f32_16x16x32_bf16 v[112:115], v[188:191], v[128:131], v[112:115]
    v_mfma_f32_16x16x32_bf16 v[116:119], v[188:191], v[132:135], v[116:119]
    v_mfma_f32_16x16x32_bf16 v[120:123], v[188:191], v[136:139], v[120:123]
    v_mfma_f32_16x16x32_bf16 v[124:127], v[188:191], v[140:143], v[124:127]
    s_waitcnt lgkmcnt(0)
    s_barrier
    .p2align 3
    v_mfma_f32_16x16x32_bf16 v[0:3], v[192:195], v[144:147], v[0:3]
    ds_read_b64_tr_b16 v[160:161], v229 offset:16384
    v_mfma_f32_16x16x32_bf16 v[4:7], v[192:195], v[148:151], v[4:7]
    ds_read_b64_tr_b16 v[162:163], v229 offset:20480
    v_mfma_f32_16x16x32_bf16 v[8:11], v[192:195], v[152:155], v[8:11]
    ds_read_b128 v[128:131], v224 offset:0
    v_mfma_f32_16x16x32_bf16 v[12:15], v[192:195], v[156:159], v[12:15]
    ds_read_b128 v[132:135], v224 offset:2048
    v_mfma_f32_16x16x32_bf16 v[64:67], v[208:211], v[144:147], v[64:67]
    ds_read_b128 v[136:139], v224 offset:4096
    v_mfma_f32_16x16x32_bf16 v[68:71], v[208:211], v[148:151], v[68:71]
    v_mfma_f32_16x16x32_bf16 v[72:75], v[208:211], v[152:155], v[72:75]
    ds_read_b128 v[140:143], v224 offset:6144
    v_mfma_f32_16x16x32_bf16 v[76:79], v[208:211], v[156:159], v[76:79]
    ds_read_b64_tr_b16 v[176:177], v229 offset:24576
    v_mfma_f32_16x16x32_bf16 v[16:19], v[196:199], v[144:147], v[16:19]
    ds_read_b64_tr_b16 v[178:179], v229 offset:28672
    v_mfma_f32_16x16x32_bf16 v[20:23], v[196:199], v[148:151], v[20:23]
    ds_read_b64_tr_b16 v[164:165], v230 offset:16384
    v_mfma_f32_16x16x32_bf16 v[24:27], v[196:199], v[152:155], v[24:27]
    ds_read_b64_tr_b16 v[166:167], v230 offset:20480
    v_mfma_f32_16x16x32_bf16 v[28:31], v[196:199], v[156:159], v[28:31]
    v_mfma_f32_16x16x32_bf16 v[80:83], v[212:215], v[144:147], v[80:83]
    ds_read_b64_tr_b16 v[180:181], v230 offset:24576
    v_mfma_f32_16x16x32_bf16 v[84:87], v[212:215], v[148:151], v[84:87]
    ds_read_b64_tr_b16 v[182:183], v230 offset:28672
    v_mfma_f32_16x16x32_bf16 v[88:91], v[212:215], v[152:155], v[88:91]
    ds_read_b64_tr_b16 v[168:169], v231 offset:16384
    v_mfma_f32_16x16x32_bf16 v[92:95], v[212:215], v[156:159], v[92:95]
    ds_read_b64_tr_b16 v[170:171], v231 offset:20480
    v_mfma_f32_16x16x32_bf16 v[32:35], v[200:203], v[144:147], v[32:35]
    ds_read_b64_tr_b16 v[184:185], v231 offset:24576
    v_mfma_f32_16x16x32_bf16 v[36:39], v[200:203], v[148:151], v[36:39]
    v_mfma_f32_16x16x32_bf16 v[40:43], v[200:203], v[152:155], v[40:43]
    ds_read_b64_tr_b16 v[186:187], v231 offset:28672
    v_mfma_f32_16x16x32_bf16 v[44:47], v[200:203], v[156:159], v[44:47]
    ds_read_b64_tr_b16 v[172:173], v232 offset:16384
    v_mfma_f32_16x16x32_bf16 v[96:99], v[216:219], v[144:147], v[96:99]
    ds_read_b64_tr_b16 v[174:175], v232 offset:20480
    v_mfma_f32_16x16x32_bf16 v[100:103], v[216:219], v[148:151], v[100:103]
    ds_read_b64_tr_b16 v[188:189], v232 offset:24576
    v_mfma_f32_16x16x32_bf16 v[104:107], v[216:219], v[152:155], v[104:107]
    ds_read_b64_tr_b16 v[190:191], v232 offset:28672
    v_mfma_f32_16x16x32_bf16 v[108:111], v[216:219], v[156:159], v[108:111]
    v_mfma_f32_16x16x32_bf16 v[48:51], v[204:207], v[144:147], v[48:51]
    v_mfma_f32_16x16x32_bf16 v[52:55], v[204:207], v[148:151], v[52:55]
    v_mfma_f32_16x16x32_bf16 v[56:59], v[204:207], v[152:155], v[56:59]
    v_mfma_f32_16x16x32_bf16 v[60:63], v[204:207], v[156:159], v[60:63]
    v_mfma_f32_16x16x32_bf16 v[112:115], v[220:223], v[144:147], v[112:115]
    s_sub_u32 s58, s58, 1
    s_cmp_lg_u32 s58, 0
    .p2align 3
    v_mfma_f32_16x16x32_bf16 v[116:119], v[220:223], v[148:151], v[116:119]
    v_mfma_f32_16x16x32_bf16 v[120:123], v[220:223], v[152:155], v[120:123]
    v_mfma_f32_16x16x32_bf16 v[124:127], v[220:223], v[156:159], v[124:127]
    s_cbranch_scc1 loop_9
    s_waitcnt lgkmcnt(0)
    s_barrier
    .p2align 3
    v_mfma_f32_16x16x32_bf16 v[0:3], v[160:163], v[128:131], v[0:3]
    ds_read_b64_tr_b16 v[192:193], v229 offset:32768
    v_mfma_f32_16x16x32_bf16 v[4:7], v[160:163], v[132:135], v[4:7]
    ds_read_b64_tr_b16 v[194:195], v229 offset:36864
    v_mfma_f32_16x16x32_bf16 v[8:11], v[160:163], v[136:139], v[8:11]
    ds_read_b128 v[144:147], v224 offset:1024
    v_mfma_f32_16x16x32_bf16 v[12:15], v[160:163], v[140:143], v[12:15]
    ds_read_b128 v[148:151], v224 offset:3072
    v_mfma_f32_16x16x32_bf16 v[64:67], v[176:179], v[128:131], v[64:67]
    ds_read_b128 v[152:155], v224 offset:5120
    v_mfma_f32_16x16x32_bf16 v[68:71], v[176:179], v[132:135], v[68:71]
    v_mfma_f32_16x16x32_bf16 v[72:75], v[176:179], v[136:139], v[72:75]
    ds_read_b128 v[156:159], v224 offset:7168
    v_mfma_f32_16x16x32_bf16 v[76:79], v[176:179], v[140:143], v[76:79]
    ds_read_b64_tr_b16 v[208:209], v229 offset:40960
    v_mfma_f32_16x16x32_bf16 v[16:19], v[164:167], v[128:131], v[16:19]
    ds_read_b64_tr_b16 v[210:211], v229 offset:45056
    v_mfma_f32_16x16x32_bf16 v[20:23], v[164:167], v[132:135], v[20:23]
    ds_read_b64_tr_b16 v[196:197], v230 offset:32768
    v_mfma_f32_16x16x32_bf16 v[24:27], v[164:167], v[136:139], v[24:27]
    ds_read_b64_tr_b16 v[198:199], v230 offset:36864
    v_mfma_f32_16x16x32_bf16 v[28:31], v[164:167], v[140:143], v[28:31]
    v_mfma_f32_16x16x32_bf16 v[80:83], v[180:183], v[128:131], v[80:83]
    ds_read_b64_tr_b16 v[212:213], v230 offset:40960
    v_mfma_f32_16x16x32_bf16 v[84:87], v[180:183], v[132:135], v[84:87]
    ds_read_b64_tr_b16 v[214:215], v230 offset:45056
    v_mfma_f32_16x16x32_bf16 v[88:91], v[180:183], v[136:139], v[88:91]
    ds_read_b64_tr_b16 v[200:201], v231 offset:32768
    v_mfma_f32_16x16x32_bf16 v[92:95], v[180:183], v[140:143], v[92:95]
    ds_read_b64_tr_b16 v[202:203], v231 offset:36864
    v_mfma_f32_16x16x32_bf16 v[32:35], v[168:171], v[128:131], v[32:35]
    ds_read_b64_tr_b16 v[216:217], v231 offset:40960
    v_mfma_f32_16x16x32_bf16 v[36:39], v[168:171], v[132:135], v[36:39]
    v_mfma_f32_16x16x32_bf16 v[40:43], v[168:171], v[136:139], v[40:43]
    ds_read_b64_tr_b16 v[218:219], v231 offset:45056
    v_mfma_f32_16x16x32_bf16 v[44:47], v[168:171], v[140:143], v[44:47]
    ds_read_b64_tr_b16 v[204:205], v232 offset:32768
    v_mfma_f32_16x16x32_bf16 v[96:99], v[184:187], v[128:131], v[96:99]
    ds_read_b64_tr_b16 v[206:207], v232 offset:36864
    v_mfma_f32_16x16x32_bf16 v[100:103], v[184:187], v[132:135], v[100:103]
    ds_read_b64_tr_b16 v[220:221], v232 offset:40960
    v_mfma_f32_16x16x32_bf16 v[104:107], v[184:187], v[136:139], v[104:107]
    ds_read_b64_tr_b16 v[222:223], v232 offset:45056
    v_mfma_f32_16x16x32_bf16 v[108:111], v[184:187], v[140:143], v[108:111]
    v_mfma_f32_16x16x32_bf16 v[48:51], v[172:175], v[128:131], v[48:51]
    v_mfma_f32_16x16x32_bf16 v[52:55], v[172:175], v[132:135], v[52:55]
    v_mfma_f32_16x16x32_bf16 v[56:59], v[172:175], v[136:139], v[56:59]
    v_mfma_f32_16x16x32_bf16 v[60:63], v[172:175], v[140:143], v[60:63]
    v_mfma_f32_16x16x32_bf16 v[112:115], v[188:191], v[128:131], v[112:115]
    v_mfma_f32_16x16x32_bf16 v[116:119], v[188:191], v[132:135], v[116:119]
    v_mfma_f32_16x16x32_bf16 v[120:123], v[188:191], v[136:139], v[120:123]
    v_mfma_f32_16x16x32_bf16 v[124:127], v[188:191], v[140:143], v[124:127]
    s_waitcnt lgkmcnt(0)
    s_barrier
    .p2align 3
    v_mfma_f32_16x16x32_bf16 v[0:3], v[192:195], v[144:147], v[0:3]
    v_mfma_f32_16x16x32_bf16 v[4:7], v[192:195], v[148:151], v[4:7]
    v_mfma_f32_16x16x32_bf16 v[8:11], v[192:195], v[152:155], v[8:11]
    v_mfma_f32_16x16x32_bf16 v[12:15], v[192:195], v[156:159], v[12:15]
    v_mfma_f32_16x16x32_bf16 v[64:67], v[208:211], v[144:147], v[64:67]
    v_mfma_f32_16x16x32_bf16 v[68:71], v[208:211], v[148:151], v[68:71]
    v_mfma_f32_16x16x32_bf16 v[72:75], v[208:211], v[152:155], v[72:75]
    v_mfma_f32_16x16x32_bf16 v[76:79], v[208:211], v[156:159], v[76:79]
    v_mfma_f32_16x16x32_bf16 v[16:19], v[196:199], v[144:147], v[16:19]
    v_mfma_f32_16x16x32_bf16 v[20:23], v[196:199], v[148:151], v[20:23]
    v_mfma_f32_16x16x32_bf16 v[24:27], v[196:199], v[152:155], v[24:27]
    v_mfma_f32_16x16x32_bf16 v[28:31], v[196:199], v[156:159], v[28:31]
    v_mfma_f32_16x16x32_bf16 v[80:83], v[212:215], v[144:147], v[80:83]
    v_mfma_f32_16x16x32_bf16 v[84:87], v[212:215], v[148:151], v[84:87]
    v_mfma_f32_16x16x32_bf16 v[88:91], v[212:215], v[152:155], v[88:91]
    v_mfma_f32_16x16x32_bf16 v[92:95], v[212:215], v[156:159], v[92:95]
    v_mfma_f32_16x16x32_bf16 v[32:35], v[200:203], v[144:147], v[32:35]
    v_mfma_f32_16x16x32_bf16 v[36:39], v[200:203], v[148:151], v[36:39]
    v_mfma_f32_16x16x32_bf16 v[40:43], v[200:203], v[152:155], v[40:43]
    v_mfma_f32_16x16x32_bf16 v[44:47], v[200:203], v[156:159], v[44:47]
    v_mfma_f32_16x16x32_bf16 v[96:99], v[216:219], v[144:147], v[96:99]
    v_mfma_f32_16x16x32_bf16 v[100:103], v[216:219], v[148:151], v[100:103]
    v_mfma_f32_16x16x32_bf16 v[104:107], v[216:219], v[152:155], v[104:107]
    v_mfma_f32_16x16x32_bf16 v[108:111], v[216:219], v[156:159], v[108:111]
    v_mfma_f32_16x16x32_bf16 v[48:51], v[204:207], v[144:147], v[48:51]
    v_mfma_f32_16x16x32_bf16 v[52:55], v[204:207], v[148:151], v[52:55]
    v_mfma_f32_16x16x32_bf16 v[56:59], v[204:207], v[152:155], v[56:59]
    v_mfma_f32_16x16x32_bf16 v[60:63], v[204:207], v[156:159], v[60:63]
    v_mfma_f32_16x16x32_bf16 v[112:115], v[220:223], v[144:147], v[112:115]
    v_mfma_f32_16x16x32_bf16 v[116:119], v[220:223], v[148:151], v[116:119]
    v_mfma_f32_16x16x32_bf16 v[120:123], v[220:223], v[152:155], v[120:123]
    v_mfma_f32_16x16x32_bf16 v[124:127], v[220:223], v[156:159], v[124:127]
    s_cmp_ge_u32 s42, 2
    s_cbranch_scc1 X_w
    s_setprio 1
    s_waitcnt lgkmcnt(0)
    s_barrier
    s_nop 7
    s_add_u32 m0, s61, 98304
    s_add_u32 s59, s62, 32768
    buffer_load_dwordx4 v254, s[4:7], s59 offen lds
    s_lshl_b32 s55, s51, 14
    s_lshl_b32 s56, s43, 13
    s_add_u32 s55, s55, s56
    s_lshl_b32 s56, s44, 10
    s_add_u32 s55, s55, s56
    s_add_u32 s55, s55, s49
    buffer_load_dwordx4 v[160:163], v254, s[4:7], s55 offen offset:0
    buffer_load_dwordx4 v[164:167], v254, s[4:7], s55 offen offset:2048
    s_add_u32 s55, s55, 4096
    buffer_load_dwordx4 v[168:171], v254, s[4:7], s55 offen offset:0
    buffer_load_dwordx4 v[172:175], v254, s[4:7], s55 offen offset:2048
    s_lshl_b32 s55, s43, 9
    s_add_u32 s55, s55, 153600
    v_and_b32 v232, 0xf0, v254
    v_lshrrev_b32 v232, 1, v232
    v_add_u32 v232, s55, v232
    buffer_load_dwordx4 v254, s[4:7], s59 offen offset:1024 lds
    ds_read_b64 v[220:221], v232 offset:0
    ds_read_b64 v[222:223], v232 offset:128
    ds_read_b64 v[224:225], v232 offset:256
    buffer_load_dwordx4 v254, s[4:7], s59 offen offset:2048 lds
    ds_read_b64 v[226:227], v232 offset:384
    s_waitcnt lgkmcnt(0)
    v_sub_f32 v192, 0, v220
    buffer_load_dwordx4 v254, s[4:7], s59 offen offset:3072 lds
    v_mul_f32 v196, 0xbfb8aa3b, v221
    v_mul_f32 v200, v221, v221
    v_sub_f32 v193, 0, v222
    s_add_u32 m0, s61, 102400
    s_add_u32 s60, s62, 36864
    buffer_load_dwordx4 v254, s[4:7], s60 offen lds
    v_mul_f32 v197, 0xbfb8aa3b, v223
    v_mul_f32 v201, v223, v223
    buffer_load_dwordx4 v254, s[4:7], s60 offen offset:1024 lds
    v_sub_f32 v194, 0, v224
    v_mul_f32 v198, 0xbfb8aa3b, v225
    v_mul_f32 v202, v225, v225
    buffer_load_dwordx4 v254, s[4:7], s60 offen offset:2048 lds
    v_sub_f32 v195, 0, v226
    v_mul_f32 v199, 0xbfb8aa3b, v227
    v_mul_f32 v203, v227, v227
    buffer_load_dwordx4 v254, s[4:7], s60 offen offset:3072 lds
    v_rcp_f32 v200, v200
    v_rcp_f32 v201, v201
    v_rcp_f32 v202, v202
    s_waitcnt lgkmcnt(0)
    s_barrier
    s_add_u32 m0, s61, 114688
    s_add_u32 s59, s62, 49152
    buffer_load_dwordx4 v254, s[4:7], s59 offen lds
    v_rcp_f32 v203, v203
    s_nop 0
    s_lshl_b32 s55, s44, 8
    s_add_u32 s55, s55, 155520
    v_lshrrev_b32 v235, 8, v254
    v_lshlrev_b32 v235, 4, v235
    v_add_u32 v235, s55, v235
    ds_read_b128 v[204:207], v235 offset:0
    ds_read_b128 v[208:211], v235 offset:512
    ds_read_b128 v[212:215], v235 offset:64
    buffer_load_dwordx4 v254, s[4:7], s59 offen offset:1024 lds
    ds_read_b128 v[216:219], v235 offset:576
    s_waitcnt lgkmcnt(0)
    v_fmac_f32 v0, v192, v204
    v_fmac_f32 v1, v192, v205
    v_fmac_f32 v2, v192, v206
    v_fmac_f32 v3, v192, v207
    buffer_load_dwordx4 v254, s[4:7], s59 offen offset:2048 lds
    v_mul_f32 v220, v196, v0
    v_mul_f32 v221, v196, v1
    v_mul_f32 v222, v196, v2
    v_mul_f32 v223, v196, v3
    v_fmac_f32 v64, v192, v208
    v_fmac_f32 v65, v192, v209
    buffer_load_dwordx4 v254, s[4:7], s59 offen offset:3072 lds
    v_fmac_f32 v66, v192, v210
    v_fmac_f32 v67, v192, v211
    v_exp_f32 v220, v220
    v_exp_f32 v221, v221
    v_exp_f32 v222, v222
    v_exp_f32 v223, v223
    v_mul_f32 v0, v0, v64
    s_waitcnt lgkmcnt(0)
    s_barrier
    s_add_u32 m0, s61, 118784
    s_add_u32 s60, s62, 53248
    buffer_load_dwordx4 v254, s[4:7], s60 offen lds
    v_mul_f32 v1, v1, v65
    v_mul_f32 v2, v2, v66
    v_mul_f32 v3, v3, v67
    v_fma_f32 v220, v220, v200, v200
    v_fma_f32 v221, v221, v200, v200
    v_fma_f32 v222, v222, v200, v200
    buffer_load_dwordx4 v254, s[4:7], s60 offen offset:1024 lds
    v_fma_f32 v223, v223, v200, v200
    v_rcp_f32 v220, v220
    v_rcp_f32 v221, v221
    v_rcp_f32 v222, v222
    v_rcp_f32 v223, v223
    v_mul_f32 v0, v0, v220
    v_mul_f32 v1, v1, v221
    buffer_load_dwordx4 v254, s[4:7], s60 offen offset:2048 lds
    v_mul_f32 v2, v2, v222
    v_mul_f32 v3, v3, v223
    v_cvt_pk_bf16_f32 v224, v0, v1
    v_cvt_pk_bf16_f32 v225, v2, v3
    v_fmac_f32 v16, v192, v212
    v_fmac_f32 v17, v192, v213
    buffer_load_dwordx4 v254, s[4:7], s60 offen offset:3072 lds
    v_fmac_f32 v18, v192, v214
    v_fmac_f32 v19, v192, v215
    v_mul_f32 v220, v196, v16
    v_mul_f32 v221, v196, v17
    v_mul_f32 v222, v196, v18
    v_mul_f32 v223, v196, v19
    v_fmac_f32 v80, v192, v216
    s_waitcnt vmcnt(8) lgkmcnt(0)
    s_barrier
    s_add_u32 m0, s61, 131072
    s_add_u32 s59, s62, 65536
    buffer_load_dwordx4 v254, s[4:7], s59 offen lds
    v_fmac_f32 v81, v192, v217
    v_fmac_f32 v82, v192, v218
    v_fmac_f32 v83, v192, v219
    v_exp_f32 v220, v220
    v_exp_f32 v221, v221
    buffer_load_dwordx4 v254, s[4:7], s59 offen offset:1024 lds
    v_exp_f32 v222, v222
    v_exp_f32 v223, v223
    v_mul_f32 v16, v16, v80
    v_mul_f32 v17, v17, v81
    v_mul_f32 v18, v18, v82
    v_mul_f32 v19, v19, v83
    buffer_load_dwordx4 v254, s[4:7], s59 offen offset:2048 lds
    v_fma_f32 v220, v220, v200, v200
    v_fma_f32 v221, v221, v200, v200
    v_fma_f32 v222, v222, v200, v200
    v_fma_f32 v223, v223, v200, v200
    v_rcp_f32 v220, v220
    buffer_load_dwordx4 v254, s[4:7], s59 offen offset:3072 lds
    v_rcp_f32 v221, v221
    v_rcp_f32 v222, v222
    v_rcp_f32 v223, v223
    v_mul_f32 v16, v16, v220
    v_mul_f32 v17, v17, v221
    v_mul_f32 v18, v18, v222
    s_waitcnt lgkmcnt(0)
    s_barrier
    s_add_u32 m0, s61, 135168
    s_add_u32 s60, s62, 69632
    buffer_load_dwordx4 v254, s[4:7], s60 offen lds
    v_mul_f32 v19, v19, v223
    v_cvt_pk_bf16_f32 v226, v16, v17
    v_cvt_pk_bf16_f32 v227, v18, v19
    s_add_u32 s55, s64, 0
    buffer_store_dwordx4 v[224:227], v254, s[4:7], s55 offen sc0 sc1
    v_fmac_f32 v4, v193, v204
    buffer_load_dwordx4 v254, s[4:7], s60 offen offset:1024 lds
    v_fmac_f32 v5, v193, v205
    v_fmac_f32 v6, v193, v206
    v_fmac_f32 v7, v193, v207
    v_mul_f32 v220, v197, v4
    v_mul_f32 v221, v197, v5
    v_mul_f32 v222, v197, v6
    buffer_load_dwordx4 v254, s[4:7], s60 offen offset:2048 lds
    v_mul_f32 v223, v197, v7
    v_fmac_f32 v68, v193, v208
    v_fmac_f32 v69, v193, v209
    v_fmac_f32 v70, v193, v210
    v_fmac_f32 v71, v193, v211
    v_exp_f32 v220, v220
    buffer_load_dwordx4 v254, s[4:7], s60 offen offset:3072 lds
    v_exp_f32 v221, v221
    v_exp_f32 v222, v222
    v_exp_f32 v223, v223
    v_mul_f32 v4, v4, v68
    v_mul_f32 v5, v5, v69
    v_mul_f32 v6, v6, v70
    s_waitcnt vmcnt(9) lgkmcnt(0)
    s_barrier
    s_add_u32 m0, s61, 98304
    s_add_u32 s59, s62, 81920
    buffer_load_dwordx4 v254, s[4:7], s59 offen lds
    v_mul_f32 v7, v7, v71
    v_fma_f32 v220, v220, v201, v201
    v_fma_f32 v221, v221, v201, v201
    v_fma_f32 v222, v222, v201, v201
    v_fma_f32 v223, v223, v201, v201
    v_rcp_f32 v220, v220
    buffer_load_dwordx4 v254, s[4:7], s59 offen offset:1024 lds
    v_rcp_f32 v221, v221
    v_rcp_f32 v222, v222
    v_rcp_f32 v223, v223
    v_mul_f32 v4, v4, v220
    v_mul_f32 v5, v5, v221
    v_mul_f32 v6, v6, v222
    v_mul_f32 v7, v7, v223
    buffer_load_dwordx4 v254, s[4:7], s59 offen offset:2048 lds
    v_cvt_pk_bf16_f32 v228, v4, v5
    v_cvt_pk_bf16_f32 v229, v6, v7
    v_fmac_f32 v20, v193, v212
    v_fmac_f32 v21, v193, v213
    v_fmac_f32 v22, v193, v214
    v_fmac_f32 v23, v193, v215
    buffer_load_dwordx4 v254, s[4:7], s59 offen offset:3072 lds
    v_mul_f32 v220, v197, v20
    v_mul_f32 v221, v197, v21
    v_mul_f32 v222, v197, v22
    v_mul_f32 v223, v197, v23
    v_fmac_f32 v84, v193, v216
    v_fmac_f32 v85, v193, v217
    v_fmac_f32 v86, v193, v218
    s_waitcnt lgkmcnt(0)
    s_barrier
    s_add_u32 m0, s61, 102400
    s_add_u32 s60, s62, 86016
    buffer_load_dwordx4 v254, s[4:7], s60 offen lds
    v_fmac_f32 v87, v193, v219
    v_exp_f32 v220, v220
    v_exp_f32 v221, v221
    v_exp_f32 v222, v222
    v_exp_f32 v223, v223
    buffer_load_dwordx4 v254, s[4:7], s60 offen offset:1024 lds
    v_mul_f32 v20, v20, v84
    v_mul_f32 v21, v21, v85
    v_mul_f32 v22, v22, v86
    v_mul_f32 v23, v23, v87
    v_fma_f32 v220, v220, v201, v201
    v_fma_f32 v221, v221, v201, v201
    buffer_load_dwordx4 v254, s[4:7], s60 offen offset:2048 lds
    v_fma_f32 v222, v222, v201, v201
    v_fma_f32 v223, v223, v201, v201
    v_rcp_f32 v220, v220
    v_rcp_f32 v221, v221
    v_rcp_f32 v222, v222
    buffer_load_dwordx4 v254, s[4:7], s60 offen offset:3072 lds
    v_rcp_f32 v223, v223
    v_mul_f32 v20, v20, v220
    v_mul_f32 v21, v21, v221
    v_mul_f32 v22, v22, v222
    v_mul_f32 v23, v23, v223
    v_cvt_pk_bf16_f32 v230, v20, v21
    s_waitcnt vmcnt(8) lgkmcnt(0)
    s_barrier
    s_add_u32 m0, s61, 114688
    s_add_u32 s59, s62, 98304
    buffer_load_dwordx4 v254, s[4:7], s59 offen lds
    v_cvt_pk_bf16_f32 v231, v22, v23
    s_add_u32 s55, s64, 2048
    buffer_store_dwordx4 v[228:231], v254, s[4:7], s55 offen sc0 sc1
    v_fmac_f32 v8, v194, v204
    v_fmac_f32 v9, v194, v205
    v_fmac_f32 v10, v194, v206
    buffer_load_dwordx4 v254, s[4:7], s59 offen offset:1024 lds
    v_fmac_f32 v11, v194, v207
    v_mul_f32 v220, v198, v8
    v_mul_f32 v221, v198, v9
    v_mul_f32 v222, v198, v10
    v_mul_f32 v223, v198, v11
    v_fmac_f32 v72, v194, v208
    buffer_load_dwordx4 v254, s[4:7], s59 offen offset:2048 lds
    v_fmac_f32 v73, v194, v209
    v_fmac_f32 v74, v194, v210
    v_fmac_f32 v75, v194, v211
    v_exp_f32 v220, v220
    v_exp_f32 v221, v221
    v_exp_f32 v222, v222
    buffer_load_dwordx4 v254, s[4:7], s59 offen offset:3072 lds
    v_exp_f32 v223, v223
    v_mul_f32 v8, v8, v72
    v_mul_f32 v9, v9, v73
    v_mul_f32 v10, v10, v74
    v_mul_f32 v11, v11, v75
    v_fma_f32 v220, v220, v202, v202
    s_waitcnt lgkmcnt(0)
    s_barrier
    s_add_u32 m0, s61, 118784
    s_add_u32 s60, s62, 102400
    buffer_load_dwordx4 v254, s[4:7], s60 offen lds
    v_fma_f32 v221, v221, v202, v202
    v_fma_f32 v222, v222, v202, v202
    v_fma_f32 v223, v223, v202, v202
    v_rcp_f32 v220, v220
    v_rcp_f32 v221, v221
    v_rcp_f32 v222, v222
    buffer_load_dwordx4 v254, s[4:7], s60 offen offset:1024 lds
    v_rcp_f32 v223, v223
    v_mul_f32 v8, v8, v220
    v_mul_f32 v9, v9, v221
    v_mul_f32 v10, v10, v222
    v_mul_f32 v11, v11, v223
    v_cvt_pk_bf16_f32 v224, v8, v9
    buffer_load_dwordx4 v254, s[4:7], s60 offen offset:2048 lds
    v_cvt_pk_bf16_f32 v225, v10, v11
    v_fmac_f32 v24, v194, v212
    v_fmac_f32 v25, v194, v213
    v_fmac_f32 v26, v194, v214
    v_fmac_f32 v27, v194, v215
    v_mul_f32 v220, v198, v24
    buffer_load_dwordx4 v254, s[4:7], s60 offen offset:3072 lds
    v_mul_f32 v221, v198, v25
    v_mul_f32 v222, v198, v26
    v_mul_f32 v223, v198, v27
    v_fmac_f32 v88, v194, v216
    v_fmac_f32 v89, v194, v217
    v_fmac_f32 v90, v194, v218
    v_fmac_f32 v91, v194, v219
    s_waitcnt vmcnt(9) lgkmcnt(0)
    s_barrier
    s_add_u32 m0, s61, 131072
    s_add_u32 s59, s62, 114688
    buffer_load_dwordx4 v254, s[4:7], s59 offen lds
    v_exp_f32 v220, v220
    v_exp_f32 v221, v221
    v_exp_f32 v222, v222
    v_exp_f32 v223, v223
    v_mul_f32 v24, v24, v88
    buffer_load_dwordx4 v254, s[4:7], s59 offen offset:1024 lds
    v_mul_f32 v25, v25, v89
    v_mul_f32 v26, v26, v90
    v_mul_f32 v27, v27, v91
    v_fma_f32 v220, v220, v202, v202
    v_fma_f32 v221, v221, v202, v202
    v_fma_f32 v222, v222, v202, v202
    buffer_load_dwordx4 v254, s[4:7], s59 offen offset:2048 lds
    v_fma_f32 v223, v223, v202, v202
    v_rcp_f32 v220, v220
    v_rcp_f32 v221, v221
    v_rcp_f32 v222, v222
    v_rcp_f32 v223, v223
    buffer_load_dwordx4 v254, s[4:7], s59 offen offset:3072 lds
    v_mul_f32 v24, v24, v220
    v_mul_f32 v25, v25, v221
    v_mul_f32 v26, v26, v222
    v_mul_f32 v27, v27, v223
    v_cvt_pk_bf16_f32 v226, v24, v25
    v_cvt_pk_bf16_f32 v227, v26, v27
    s_waitcnt lgkmcnt(0)
    s_barrier
    s_add_u32 m0, s61, 135168
    s_add_u32 s60, s62, 118784
    buffer_load_dwordx4 v254, s[4:7], s60 offen lds
    s_add_u32 s55, s64, 4096
    buffer_store_dwordx4 v[224:227], v254, s[4:7], s55 offen sc0 sc1
    v_fmac_f32 v12, v195, v204
    v_fmac_f32 v13, v195, v205
    v_fmac_f32 v14, v195, v206
    v_fmac_f32 v15, v195, v207
    buffer_load_dwordx4 v254, s[4:7], s60 offen offset:1024 lds
    v_mul_f32 v220, v199, v12
    v_mul_f32 v221, v199, v13
    v_mul_f32 v222, v199, v14
    v_mul_f32 v223, v199, v15
    v_fmac_f32 v76, v195, v208
    v_fmac_f32 v77, v195, v209
    buffer_load_dwordx4 v254, s[4:7], s60 offen offset:2048 lds
    v_fmac_f32 v78, v195, v210
    v_fmac_f32 v79, v195, v211
    v_exp_f32 v220, v220
    v_exp_f32 v221, v221
    v_exp_f32 v222, v222
    v_exp_f32 v223, v223
    buffer_load_dwordx4 v254, s[4:7], s60 offen offset:3072 lds
    v_mul_f32 v12, v12, v76
    v_mul_f32 v13, v13, v77
    v_mul_f32 v14, v14, v78
    v_mul_f32 v15, v15, v79
    v_fma_f32 v220, v220, v203, v203
    v_fma_f32 v221, v221, v203, v203
    s_waitcnt vmcnt(9) lgkmcnt(0)
    s_barrier
    s_add_u32 m0, s61, 98304
    s_add_u32 s59, s62, 131072
    buffer_load_dwordx4 v254, s[4:7], s59 offen lds
    v_fma_f32 v222, v222, v203, v203
    v_fma_f32 v223, v223, v203, v203
    v_rcp_f32 v220, v220
    v_rcp_f32 v221, v221
    v_rcp_f32 v222, v222
    v_rcp_f32 v223, v223
    buffer_load_dwordx4 v254, s[4:7], s59 offen offset:1024 lds
    v_mul_f32 v12, v12, v220
    v_mul_f32 v13, v13, v221
    v_mul_f32 v14, v14, v222
    v_mul_f32 v15, v15, v223
    v_cvt_pk_bf16_f32 v228, v12, v13
    v_cvt_pk_bf16_f32 v229, v14, v15
    buffer_load_dwordx4 v254, s[4:7], s59 offen offset:2048 lds
    v_fmac_f32 v28, v195, v212
    v_fmac_f32 v29, v195, v213
    v_fmac_f32 v30, v195, v214
    v_fmac_f32 v31, v195, v215
    v_mul_f32 v220, v199, v28
    v_mul_f32 v221, v199, v29
    buffer_load_dwordx4 v254, s[4:7], s59 offen offset:3072 lds
    v_mul_f32 v222, v199, v30
    v_mul_f32 v223, v199, v31
    v_fmac_f32 v92, v195, v216
    v_fmac_f32 v93, v195, v217
    v_fmac_f32 v94, v195, v218
    v_fmac_f32 v95, v195, v219
    v_exp_f32 v220, v220
    s_waitcnt lgkmcnt(0)
    s_barrier
    s_add_u32 m0, s61, 102400
    s_add_u32 s60, s62, 135168
    buffer_load_dwordx4 v254, s[4:7], s60 offen lds
    v_exp_f32 v221, v221
    v_exp_f32 v222, v222
    v_exp_f32 v223, v223
    v_mul_f32 v28, v28, v92
    v_mul_f32 v29, v29, v93
    buffer_load_dwordx4 v254, s[4:7], s60 offen offset:1024 lds
    v_mul_f32 v30, v30, v94
    v_mul_f32 v31, v31, v95
    v_fma_f32 v220, v220, v203, v203
    v_fma_f32 v221, v221, v203, v203
    v_fma_f32 v222, v222, v203, v203
    buffer_load_dwordx4 v254, s[4:7], s60 offen offset:2048 lds
    v_fma_f32 v223, v223, v203, v203
    v_rcp_f32 v220, v220
    v_rcp_f32 v221, v221
    v_rcp_f32 v222, v222
    v_rcp_f32 v223, v223
    buffer_load_dwordx4 v254, s[4:7], s60 offen offset:3072 lds
    v_mul_f32 v28, v28, v220
    v_mul_f32 v29, v29, v221
    v_mul_f32 v30, v30, v222
    v_mul_f32 v31, v31, v223
    v_cvt_pk_bf16_f32 v230, v28, v29
    v_cvt_pk_bf16_f32 v231, v30, v31
    s_waitcnt vmcnt(8) lgkmcnt(0)
    s_barrier
    s_add_u32 m0, s61, 114688
    s_add_u32 s59, s62, 147456
    buffer_load_dwordx4 v254, s[4:7], s59 offen lds
    s_add_u32 s55, s64, 6144
    buffer_store_dwordx4 v[228:231], v254, s[4:7], s55 offen sc0 sc1
    ds_read_b128 v[204:207], v235 offset:128
    ds_read_b128 v[208:211], v235 offset:640
    ds_read_b128 v[212:215], v235 offset:192
    ds_read_b128 v[216:219], v235 offset:704
    buffer_load_dwordx4 v254, s[4:7], s59 offen offset:1024 lds
    s_waitcnt lgkmcnt(0)
    v_fmac_f32 v32, v192, v204
    v_fmac_f32 v33, v192, v205
    v_fmac_f32 v34, v192, v206
    v_fmac_f32 v35, v192, v207
    buffer_load_dwordx4 v254, s[4:7], s59 offen offset:2048 lds
    v_mul_f32 v220, v196, v32
    v_mul_f32 v221, v196, v33
    v_mul_f32 v222, v196, v34
    v_mul_f32 v223, v196, v35
    v_fmac_f32 v96, v192, v208
    buffer_load_dwordx4 v254, s[4:7], s59 offen offset:3072 lds
    v_fmac_f32 v97, v192, v209
    v_fmac_f32 v98, v192, v210
    v_fmac_f32 v99, v192, v211
    v_exp_f32 v220, v220
    v_exp_f32 v221, v221
    v_exp_f32 v222, v222
    s_waitcnt lgkmcnt(0)
    s_barrier
    s_add_u32 m0, s61, 118784
    s_add_u32 s60, s62, 151552
    buffer_load_dwordx4 v254, s[4:7], s60 offen lds
    v_exp_f32 v223, v223
    v_mul_f32 v32, v32, v96
    v_mul_f32 v33, v33, v97
    v_mul_f32 v34, v34, v98
    v_mul_f32 v35, v35, v99
    v_fma_f32 v220, v220, v200, v200
    buffer_load_dwordx4 v254, s[4:7], s60 offen offset:1024 lds
    v_fma_f32 v221, v221, v200, v200
    v_fma_f32 v222, v222, v200, v200
    v_fma_f32 v223, v223, v200, v200
    v_rcp_f32 v220, v220
    v_rcp_f32 v221, v221
    v_rcp_f32 v222, v222
    buffer_load_dwordx4 v254, s[4:7], s60 offen offset:2048 lds
    v_rcp_f32 v223, v223
    v_mul_f32 v32, v32, v220
    v_mul_f32 v33, v33, v221
    v_mul_f32 v34, v34, v222
    v_mul_f32 v35, v35, v223
    v_cvt_pk_bf16_f32 v224, v32, v33
    buffer_load_dwordx4 v254, s[4:7], s60 offen offset:3072 lds
    v_cvt_pk_bf16_f32 v225, v34, v35
    v_fmac_f32 v48, v192, v212
    v_fmac_f32 v49, v192, v213
    v_fmac_f32 v50, v192, v214
    v_fmac_f32 v51, v192, v215
    v_mul_f32 v220, v196, v48
    v_mul_f32 v221, v196, v49
    s_waitcnt vmcnt(9) lgkmcnt(0)
    s_barrier
    s_add_u32 m0, s61, 131072
    s_add_u32 s59, s62, 163840
    buffer_load_dwordx4 v254, s[4:7], s59 offen lds
    v_mul_f32 v222, v196, v50
    v_mul_f32 v223, v196, v51
    v_fmac_f32 v112, v192, v216
    v_fmac_f32 v113, v192, v217
    v_fmac_f32 v114, v192, v218
    buffer_load_dwordx4 v254, s[4:7], s59 offen offset:1024 lds
    v_fmac_f32 v115, v192, v219
    v_exp_f32 v220, v220
    v_exp_f32 v221, v221
    v_exp_f32 v222, v222
    v_exp_f32 v223, v223
    v_mul_f32 v48, v48, v112
    buffer_load_dwordx4 v254, s[4:7], s59 offen offset:2048 lds
    v_mul_f32 v49, v49, v113
    v_mul_f32 v50, v50, v114
    v_mul_f32 v51, v51, v115
    v_fma_f32 v220, v220, v200, v200
    v_fma_f32 v221, v221, v200, v200
    buffer_load_dwordx4 v254, s[4:7], s59 offen offset:3072 lds
    v_fma_f32 v222, v222, v200, v200
    v_fma_f32 v223, v223, v200, v200
    v_rcp_f32 v220, v220
    v_rcp_f32 v221, v221
    v_rcp_f32 v222, v222
    v_rcp_f32 v223, v223
    s_waitcnt lgkmcnt(0)
    s_barrier
    s_add_u32 m0, s61, 135168
    s_add_u32 s60, s62, 167936
    buffer_load_dwordx4 v254, s[4:7], s60 offen lds
    v_mul_f32 v48, v48, v220
    v_mul_f32 v49, v49, v221
    v_mul_f32 v50, v50, v222
    v_mul_f32 v51, v51, v223
    v_cvt_pk_bf16_f32 v226, v48, v49
    buffer_load_dwordx4 v254, s[4:7], s60 offen offset:1024 lds
    v_cvt_pk_bf16_f32 v227, v50, v51
    s_add_u32 s55, s64, 131072
    buffer_store_dwordx4 v[224:227], v254, s[4:7], s55 offen sc0 sc1
    v_fmac_f32 v36, v193, v204
    v_fmac_f32 v37, v193, v205
    v_fmac_f32 v38, v193, v206
    v_fmac_f32 v39, v193, v207
    buffer_load_dwordx4 v254, s[4:7], s60 offen offset:2048 lds
    v_mul_f32 v220, v197, v36
    v_mul_f32 v221, v197, v37
    v_mul_f32 v222, v197, v38
    v_mul_f32 v223, v197, v39
    v_fmac_f32 v100, v193, v208
    v_fmac_f32 v101, v193, v209
    buffer_load_dwordx4 v254, s[4:7], s60 offen offset:3072 lds
    v_fmac_f32 v102, v193, v210
    v_fmac_f32 v103, v193, v211
    v_exp_f32 v220, v220
    v_exp_f32 v221, v221
    v_exp_f32 v222, v222
    v_exp_f32 v223, v223
    s_waitcnt vmcnt(9) lgkmcnt(0)
    s_barrier
    s_and_b32 s55, s41, 7
    s_lshl_b32 s55, s55, 2
    s_add_u32 s55, s55, s42
    s_add_u32 s55, s55, s0
    s_add_u32 s55, s55, 2048
    v_mov_b32 v252, 0
    v_mov_b32 v253, 1
    s_mov_b64 exec, 1
    s_cmp_eq_u32 s45, 0
    s_cbranch_scc1 st_10
    buffer_store_byte v253, v252, s[4:7], s55 offen sc0 sc1
    s_branch st_11
st_10:
    buffer_store_byte v253, v252, s[4:7], s55 offen
st_11:
    s_mov_b64 exec, -1
    s_add_u32 m0, s61, 98304
    s_add_u32 s59, s62, 180224
    buffer_load_dwordx4 v254, s[4:7], s59 offen lds
    v_mul_f32 v36, v36, v100
    v_mul_f32 v37, v37, v101
    v_mul_f32 v38, v38, v102
    v_mul_f32 v39, v39, v103
    v_fma_f32 v220, v220, v201, v201
    v_fma_f32 v221, v221, v201, v201
    buffer_load_dwordx4 v254, s[4:7], s59 offen offset:1024 lds
    v_fma_f32 v222, v222, v201, v201
    v_fma_f32 v223, v223, v201, v201
    v_rcp_f32 v220, v220
    v_rcp_f32 v221, v221
    v_rcp_f32 v222, v222
    v_rcp_f32 v223, v223
    v_mul_f32 v36, v36, v220
    buffer_load_dwordx4 v254, s[4:7], s59 offen offset:2048 lds
    v_mul_f32 v37, v37, v221
    v_mul_f32 v38, v38, v222
    v_mul_f32 v39, v39, v223
    v_cvt_pk_bf16_f32 v228, v36, v37
    v_cvt_pk_bf16_f32 v229, v38, v39
    v_fmac_f32 v52, v193, v212
    buffer_load_dwordx4 v254, s[4:7], s59 offen offset:3072 lds
    v_fmac_f32 v53, v193, v213
    v_fmac_f32 v54, v193, v214
    v_fmac_f32 v55, v193, v215
    v_mul_f32 v220, v197, v52
    v_mul_f32 v221, v197, v53
    v_mul_f32 v222, v197, v54
    v_mul_f32 v223, v197, v55
    s_waitcnt lgkmcnt(0)
    s_barrier
    s_add_u32 m0, s61, 102400
    s_add_u32 s60, s62, 184320
    buffer_load_dwordx4 v254, s[4:7], s60 offen lds
    v_fmac_f32 v116, v193, v216
    v_fmac_f32 v117, v193, v217
    v_fmac_f32 v118, v193, v218
    v_fmac_f32 v119, v193, v219
    v_exp_f32 v220, v220
    buffer_load_dwordx4 v254, s[4:7], s60 offen offset:1024 lds
    v_exp_f32 v221, v221
    v_exp_f32 v222, v222
    v_exp_f32 v223, v223
    v_mul_f32 v52, v52, v116
    v_mul_f32 v53, v53, v117
    v_mul_f32 v54, v54, v118
    buffer_load_dwordx4 v254, s[4:7], s60 offen offset:2048 lds
    v_mul_f32 v55, v55, v119
    v_fma_f32 v220, v220, v201, v201
    v_fma_f32 v221, v221, v201, v201
    v_fma_f32 v222, v222, v201, v201
    v_fma_f32 v223, v223, v201, v201
    buffer_load_dwordx4 v254, s[4:7], s60 offen offset:3072 lds
    v_rcp_f32 v220, v220
    v_rcp_f32 v221, v221
    v_rcp_f32 v222, v222
    v_rcp_f32 v223, v223
    v_mul_f32 v52, v52, v220
    v_mul_f32 v53, v53, v221
    s_waitcnt vmcnt(9) lgkmcnt(0)
    s_barrier
    s_add_u32 m0, s61, 114688
    s_add_u32 s59, s62, 196608
    buffer_load_dwordx4 v254, s[4:7], s59 offen lds
    v_mul_f32 v54, v54, v222
    v_mul_f32 v55, v55, v223
    v_cvt_pk_bf16_f32 v230, v52, v53
    v_cvt_pk_bf16_f32 v231, v54, v55
    s_add_u32 s55, s64, 133120
    buffer_store_dwordx4 v[228:231], v254, s[4:7], s55 offen sc0 sc1
    buffer_load_dwordx4 v254, s[4:7], s59 offen offset:1024 lds
    v_fmac_f32 v40, v194, v204
    v_fmac_f32 v41, v194, v205
    v_fmac_f32 v42, v194, v206
    v_fmac_f32 v43, v194, v207
    v_mul_f32 v220, v198, v40
    v_mul_f32 v221, v198, v41
    buffer_load_dwordx4 v254, s[4:7], s59 offen offset:2048 lds
    v_mul_f32 v222, v198, v42
    v_mul_f32 v223, v198, v43
    v_fmac_f32 v104, v194, v208
    v_fmac_f32 v105, v194, v209
    v_fmac_f32 v106, v194, v210
    v_fmac_f32 v107, v194, v211
    buffer_load_dwordx4 v254, s[4:7], s59 offen offset:3072 lds
    v_exp_f32 v220, v220
    v_exp_f32 v221, v221
    v_exp_f32 v222, v222
    v_exp_f32 v223, v223
    v_mul_f32 v40, v40, v104
    v_mul_f32 v41, v41, v105
    s_waitcnt lgkmcnt(0)
    s_barrier
    s_add_u32 m0, s61, 118784
    s_add_u32 s60, s62, 200704
    buffer_load_dwordx4 v254, s[4:7], s60 offen lds
    v_mul_f32 v42, v42, v106
    v_mul_f32 v43, v43, v107
    v_fma_f32 v220, v220, v202, v202
    v_fma_f32 v221, v221, v202, v202
    v_fma_f32 v222, v222, v202, v202
    v_fma_f32 v223, v223, v202, v202
    buffer_load_dwordx4 v254, s[4:7], s60 offen offset:1024 lds
    v_rcp_f32 v220, v220
    v_rcp_f32 v221, v221
    v_rcp_f32 v222, v222
    v_rcp_f32 v223, v223
    v_mul_f32 v40, v40, v220
    v_mul_f32 v41, v41, v221
    v_mul_f32 v42, v42, v222
    buffer_load_dwordx4 v254, s[4:7], s60 offen offset:2048 lds
    v_mul_f32 v43, v43, v223
    v_cvt_pk_bf16_f32 v224, v40, v41
    v_cvt_pk_bf16_f32 v225, v42, v43
    v_fmac_f32 v56, v194, v212
    v_fmac_f32 v57, v194, v213
    v_fmac_f32 v58, v194, v214
    buffer_load_dwordx4 v254, s[4:7], s60 offen offset:3072 lds
    v_fmac_f32 v59, v194, v215
    v_mul_f32 v220, v198, v56
    v_mul_f32 v221, v198, v57
    v_mul_f32 v222, v198, v58
    v_mul_f32 v223, v198, v59
    v_fmac_f32 v120, v194, v216
    v_fmac_f32 v121, v194, v217
    s_waitcnt vmcnt(9) lgkmcnt(0)
    s_barrier
    s_add_u32 m0, s61, 131072
    s_add_u32 s59, s62, 212992
    buffer_load_dwordx4 v254, s[4:7], s59 offen lds
    v_fmac_f32 v122, v194, v218
    v_fmac_f32 v123, v194, v219
    v_exp_f32 v220, v220
    v_exp_f32 v221, v221
    v_exp_f32 v222, v222
    buffer_load_dwordx4 v254, s[4:7], s59 offen offset:1024 lds
    v_exp_f32 v223, v223
    v_mul_f32 v56, v56, v120
    v_mul_f32 v57, v57, v121
    v_mul_f32 v58, v58, v122
    v_mul_f32 v59, v59, v123
    v_fma_f32 v220, v220, v202, v202
    buffer_load_dwordx4 v254, s[4:7], s59 offen offset:2048 lds
    v_fma_f32 v221, v221, v202, v202
    v_fma_f32 v222, v222, v202, v202
    v_fma_f32 v223, v223, v202, v202
    v_rcp_f32 v220, v220
    v_rcp_f32 v221, v221
    buffer_load_dwordx4 v254, s[4:7], s59 offen offset:3072 lds
    v_rcp_f32 v222, v222
    v_rcp_f32 v223, v223
    v_mul_f32 v56, v56, v220
    v_mul_f32 v57, v57, v221
    v_mul_f32 v58, v58, v222
    v_mul_f32 v59, v59, v223
    s_waitcnt lgkmcnt(0)
    s_barrier
    s_add_u32 m0, s61, 135168
    s_add_u32 s60, s62, 217088
    buffer_load_dwordx4 v254, s[4:7], s60 offen lds
    v_cvt_pk_bf16_f32 v226, v56, v57
    v_cvt_pk_bf16_f32 v227, v58, v59
    s_add_u32 s55, s64, 135168
    buffer_store_dwordx4 v[224:227], v254, s[4:7], s55 offen sc0 sc1
    v_fmac_f32 v44, v195, v204
    v_fmac_f32 v45, v195, v205
    buffer_load_dwordx4 v254, s[4:7], s60 offen offset:1024 lds
    v_fmac_f32 v46, v195, v206
    v_fmac_f32 v47, v195, v207
    v_mul_f32 v220, v199, v44
    v_mul_f32 v221, v199, v45
    v_mul_f32 v222, v199, v46
    v_mul_f32 v223, v199, v47
    buffer_load_dwordx4 v254, s[4:7], s60 offen offset:2048 lds
    v_fmac_f32 v108, v195, v208
    v_fmac_f32 v109, v195, v209
    v_fmac_f32 v110, v195, v210
    v_fmac_f32 v111, v195, v211
    v_exp_f32 v220, v220
    v_exp_f32 v221, v221
    buffer_load_dwordx4 v254, s[4:7], s60 offen offset:3072 lds
    v_exp_f32 v222, v222
    v_exp_f32 v223, v223
    v_mul_f32 v44, v44, v108
    v_mul_f32 v45, v45, v109
    v_mul_f32 v46, v46, v110
    v_mul_f32 v47, v47, v111
    s_waitcnt vmcnt(9) lgkmcnt(0)
    s_barrier
    s_add_u32 m0, s61, 98304
    s_add_u32 s59, s62, 229376
    buffer_load_dwordx4 v254, s[4:7], s59 offen lds
    v_fma_f32 v220, v220, v203, v203
    v_fma_f32 v221, v221, v203, v203
    v_fma_f32 v222, v222, v203, v203
    v_fma_f32 v223, v223, v203, v203
    v_rcp_f32 v220, v220
    v_rcp_f32 v221, v221
    buffer_load_dwordx4 v254, s[4:7], s59 offen offset:1024 lds
    v_rcp_f32 v222, v222
    v_rcp_f32 v223, v223
    v_mul_f32 v44, v44, v220
    v_mul_f32 v45, v45, v221
    v_mul_f32 v46, v46, v222
    v_mul_f32 v47, v47, v223
    v_cvt_pk_bf16_f32 v228, v44, v45
    buffer_load_dwordx4 v254, s[4:7], s59 offen offset:2048 lds
    v_cvt_pk_bf16_f32 v229, v46, v47
    v_fmac_f32 v60, v195, v212
    v_fmac_f32 v61, v195, v213
    v_fmac_f32 v62, v195, v214
    v_fmac_f32 v63, v195, v215
    v_mul_f32 v220, v199, v60
    buffer_load_dwordx4 v254, s[4:7], s59 offen offset:3072 lds
    v_mul_f32 v221, v199, v61
    v_mul_f32 v222, v199, v62
    v_mul_f32 v223, v199, v63
    v_fmac_f32 v124, v195, v216
    v_fmac_f32 v125, v195, v217
    v_fmac_f32 v126, v195, v218
    v_fmac_f32 v127, v195, v219
    s_waitcnt lgkmcnt(0)
    s_barrier
    s_add_u32 m0, s61, 102400
    s_add_u32 s60, s62, 233472
    buffer_load_dwordx4 v254, s[4:7], s60 offen lds
    v_exp_f32 v220, v220
    v_exp_f32 v221, v221
    v_exp_f32 v222, v222
    v_exp_f32 v223, v223
    v_mul_f32 v60, v60, v124
    buffer_load_dwordx4 v254, s[4:7], s60 offen offset:1024 lds
    v_mul_f32 v61, v61, v125
    v_mul_f32 v62, v62, v126
    v_mul_f32 v63, v63, v127
    v_fma_f32 v220, v220, v203, v203
    v_fma_f32 v221, v221, v203, v203
    v_fma_f32 v222, v222, v203, v203
    buffer_load_dwordx4 v254, s[4:7], s60 offen offset:2048 lds
    v_fma_f32 v223, v223, v203, v203
    v_rcp_f32 v220, v220
    v_rcp_f32 v221, v221
    v_rcp_f32 v222, v222
    v_rcp_f32 v223, v223
    buffer_load_dwordx4 v254, s[4:7], s60 offen offset:3072 lds
    v_mul_f32 v60, v60, v220
    v_mul_f32 v61, v61, v221
    v_mul_f32 v62, v62, v222
    v_mul_f32 v63, v63, v223
    v_cvt_pk_bf16_f32 v230, v60, v61
    v_cvt_pk_bf16_f32 v231, v62, v63
    s_waitcnt vmcnt(8) lgkmcnt(0)
    s_barrier
    v_lshrrev_b32 v252, 2, v254
    v_min_u32 v252, 28, v252
    s_add_u32 s55, s0, 2048
    buffer_load_dword v232, v252, s[4:7], s55 offen sc0 sc1
    s_add_u32 m0, s61, 114688
    s_add_u32 s59, s62, 245760
    buffer_load_dwordx4 v254, s[4:7], s59 offen lds
    buffer_load_dwordx4 v254, s[4:7], s59 offen offset:1024 lds
    buffer_load_dwordx4 v254, s[4:7], s59 offen offset:2048 lds
    buffer_load_dwordx4 v254, s[4:7], s59 offen offset:3072 lds
    s_add_u32 s55, s64, 137216
    buffer_store_dwordx4 v[228:231], v254, s[4:7], s55 offen sc0 sc1
    s_waitcnt lgkmcnt(0)
    s_barrier
    s_add_u32 m0, s61, 118784
    s_add_u32 s60, s62, 249856
    buffer_load_dwordx4 v254, s[4:7], s60 offen lds
    v_lshlrev_b32 v128, 16, v160
    v_and_b32 v129, 0xffff0000, v160
    v_lshlrev_b32 v130, 16, v161
    v_and_b32 v131, 0xffff0000, v161
    v_lshlrev_b32 v144, 16, v162
    v_and_b32 v145, 0xffff0000, v162
    buffer_load_dwordx4 v254, s[4:7], s60 offen offset:1024 lds
    v_lshlrev_b32 v146, 16, v163
    v_and_b32 v147, 0xffff0000, v163
    v_lshlrev_b32 v132, 16, v164
    v_and_b32 v133, 0xffff0000, v164
    v_lshlrev_b32 v134, 16, v165
    v_and_b32 v135, 0xffff0000, v165
    v_lshlrev_b32 v148, 16, v166
    v_and_b32 v149, 0xffff0000, v166
    buffer_load_dwordx4 v254, s[4:7], s60 offen offset:2048 lds
    v_lshlrev_b32 v150, 16, v167
    v_and_b32 v151, 0xffff0000, v167
    v_lshlrev_b32 v136, 16, v168
    v_and_b32 v137, 0xffff0000, v168
    v_lshlrev_b32 v138, 16, v169
    v_and_b32 v139, 0xffff0000, v169
    v_lshlrev_b32 v152, 16, v170
    v_and_b32 v153, 0xffff0000, v170
    buffer_load_dwordx4 v254, s[4:7], s60 offen offset:3072 lds
    v_lshlrev_b32 v154, 16, v171
    v_and_b32 v155, 0xffff0000, v171
    v_lshlrev_b32 v140, 16, v172
    v_and_b32 v141, 0xffff0000, v172
    v_lshlrev_b32 v142, 16, v173
    v_and_b32 v143, 0xffff0000, v173
    v_lshlrev_b32 v156, 16, v174
    v_and_b32 v157, 0xffff0000, v174
    s_waitcnt vmcnt(10) lgkmcnt(0)
    s_barrier
    s_waitcnt vmcnt(9)
    v_cmp_ne_u32 vcc, 0x01010101, v232
    s_cbranch_vccz ap_12
    v_lshrrev_b32 v252, 2, v254
    v_min_u32 v252, 28, v252
    s_add_u32 s55, s0, 2048
    s_mov_b32 s56, 262144
poll_13:
    buffer_load_dword v253, v252, s[4:7], s55 offen sc0 sc1
    s_waitcnt vmcnt(0)
    v_cmp_ne_u32 vcc, 0x01010101, v253
    s_cbranch_vccz pd_14
    s_sleep 1
    s_sub_u32 s56, s56, 1
    s_cmp_lg_u32 s56, 0
    s_cbranch_scc1 poll_13
pd_14:
ap_12:
    s_add_u32 m0, s61, 131072
    s_add_u32 s59, s63, 0
    buffer_load_dwordx4 v254, s[4:7], s59 offen lds
    v_lshlrev_b32 v158, 16, v175
    v_and_b32 v159, 0xffff0000, v175
    v_mov_b32 v160, 0
    v_mov_b32 v161, 0
    v_mov_b32 v162, 0
    v_mov_b32 v163, 0
    v_mov_b32 v164, 0
    buffer_load_dwordx4 v254, s[4:7], s59 offen offset:1024 lds
    v_mov_b32 v165, 0
    v_mov_b32 v166, 0
    v_mov_b32 v167, 0
    v_mov_b32 v168, 0
    v_mov_b32 v169, 0
    v_mov_b32 v170, 0
    v_mov_b32 v171, 0
    v_mov_b32 v172, 0
    buffer_load_dwordx4 v254, s[4:7], s59 offen offset:2048 lds
    v_mov_b32 v173, 0
    v_mov_b32 v174, 0
    v_mov_b32 v175, 0
    v_mov_b32 v176, 0
    v_mov_b32 v177, 0
    v_mov_b32 v178, 0
    v_mov_b32 v179, 0
    buffer_load_dwordx4 v254, s[4:7], s59 offen offset:3072 lds
    v_mov_b32 v180, 0
    v_mov_b32 v181, 0
    v_mov_b32 v182, 0
    v_mov_b32 v183, 0
    v_mov_b32 v184, 0
    v_mov_b32 v185, 0
    v_mov_b32 v186, 0
    v_mov_b32 v187, 0
    s_waitcnt lgkmcnt(0)
    s_barrier
    s_add_u32 m0, s61, 135168
    s_add_u32 s60, s63, 4096
    buffer_load_dwordx4 v254, s[4:7], s60 offen lds
    v_mov_b32 v188, 0
    buffer_load_dwordx4 v254, s[4:7], s60 offen offset:1024 lds
    v_mov_b32 v189, 0
    buffer_load_dwordx4 v254, s[4:7], s60 offen offset:2048 lds
    v_mov_b32 v190, 0
    buffer_load_dwordx4 v254, s[4:7], s60 offen offset:3072 lds
    v_mov_b32 v191, 0
    s_waitcnt vmcnt(8) lgkmcnt(0)
    s_barrier
    s_and_b32 s55, s41, 7
    s_lshl_b32 s55, s55, 2
    s_add_u32 s55, s55, s42
    s_add_u32 s55, s55, s0
    s_add_u32 s55, s55, 2080
    v_mov_b32 v252, 0
    v_mov_b32 v253, 1
    s_mov_b64 exec, 1
    s_cmp_eq_u32 s45, 0
    s_cbranch_scc1 st_15
    buffer_store_byte v253, v252, s[4:7], s55 offen sc0 sc1
    s_branch st_16
st_15:
    buffer_store_byte v253, v252, s[4:7], s55 offen
st_16:
    s_mov_b64 exec, -1
    s_add_u32 m0, s61, 98304
    s_add_u32 s59, s63, 16384
    buffer_load_dwordx4 v254, s[4:7], s59 offen lds
    buffer_load_dwordx4 v254, s[4:7], s59 offen offset:1024 lds
    buffer_load_dwordx4 v254, s[4:7], s59 offen offset:2048 lds
    buffer_load_dwordx4 v254, s[4:7], s59 offen offset:3072 lds
    s_waitcnt lgkmcnt(0)
    s_barrier
    s_add_u32 m0, s61, 102400
    s_add_u32 s60, s63, 20480
    buffer_load_dwordx4 v254, s[4:7], s60 offen lds
    buffer_load_dwordx4 v254, s[4:7], s60 offen offset:1024 lds
    buffer_load_dwordx4 v254, s[4:7], s60 offen offset:2048 lds
    buffer_load_dwordx4 v254, s[4:7], s60 offen offset:3072 lds
    s_waitcnt vmcnt(9) lgkmcnt(0)
    s_barrier
    s_waitcnt vmcnt(0)
    s_setprio 0
    s_branch X_g4
X_w:
    s_setprio 1
    s_waitcnt lgkmcnt(0)
    s_barrier
    s_nop 7
    s_add_u32 m0, s61, 0
    s_add_u32 s59, s63, 1376256
    buffer_load_dwordx4 v236, s[16:19], s59 offen lds
    s_lshl_b32 s55, s51, 14
    s_lshl_b32 s56, s43, 13
    s_add_u32 s55, s55, s56
    s_lshl_b32 s56, s44, 10
    s_add_u32 s55, s55, s56
    s_add_u32 s55, s55, s49
    buffer_load_dwordx4 v[160:163], v254, s[4:7], s55 offen offset:0
    buffer_load_dwordx4 v[164:167], v254, s[4:7], s55 offen offset:2048
    s_add_u32 s55, s55, 4096
    buffer_load_dwordx4 v[168:171], v254, s[4:7], s55 offen offset:0
    buffer_load_dwordx4 v[172:175], v254, s[4:7], s55 offen offset:2048
    s_lshl_b32 s55, s43, 9
    s_add_u32 s55, s55, 153600
    v_and_b32 v232, 0xf0, v254
    v_lshrrev_b32 v232, 1, v232
    v_add_u32 v232, s55, v232
    ds_read_b64 v[220:221], v232 offset:0
    buffer_load_dwordx4 v237, s[16:19], s59 offen offset:1024 lds
    ds_read_b64 v[222:223], v232 offset:128
    ds_read_b64 v[224:225], v232 offset:256
    ds_read_b64 v[226:227], v232 offset:384
    buffer_load_dwordx4 v238, s[16:19], s59 offen offset:2048 lds
    s_waitcnt lgkmcnt(0)
    v_sub_f32 v192, 0, v220
    v_mul_f32 v196, 0xbfb8aa3b, v221
    v_mul_f32 v200, v221, v221
    s_add_u32 m0, s61, 3072
    s_add_u32 s60, s63, 1490944
    buffer_load_dwordx4 v236, s[16:19], s60 offen lds
    v_sub_f32 v193, 0, v222
    v_mul_f32 v197, 0xbfb8aa3b, v223
    v_mul_f32 v201, v223, v223
    buffer_load_dwordx4 v237, s[16:19], s60 offen offset:1024 lds
    v_sub_f32 v194, 0, v224
    v_mul_f32 v198, 0xbfb8aa3b, v225
    v_mul_f32 v202, v225, v225
    buffer_load_dwordx4 v238, s[16:19], s60 offen offset:2048 lds
    v_sub_f32 v195, 0, v226
    v_mul_f32 v199, 0xbfb8aa3b, v227
    v_mul_f32 v203, v227, v227
    v_rcp_f32 v200, v200
    s_waitcnt lgkmcnt(0)
    s_barrier
    s_add_u32 m0, s61, 16384
    s_add_u32 s59, s63, 1605632
    buffer_load_dwordx4 v236, s[16:19], s59 offen lds
    v_rcp_f32 v201, v201
    v_rcp_f32 v202, v202
    v_rcp_f32 v203, v203
    buffer_load_dwordx4 v237, s[16:19], s59 offen offset:1024 lds
    s_nop 0
    s_lshl_b32 s55, s44, 8
    s_add_u32 s55, s55, 155520
    v_lshrrev_b32 v235, 8, v254
    v_lshlrev_b32 v235, 4, v235
    v_add_u32 v235, s55, v235
    ds_read_b128 v[204:207], v235 offset:0
    ds_read_b128 v[208:211], v235 offset:512
    buffer_load_dwordx4 v238, s[16:19], s59 offen offset:2048 lds
    ds_read_b128 v[212:215], v235 offset:64
    ds_read_b128 v[216:219], v235 offset:576
    s_waitcnt lgkmcnt(0)
    v_fmac_f32 v0, v192, v204
    s_add_u32 m0, s61, 19456
    s_add_u32 s60, s63, 1720320
    buffer_load_dwordx4 v236, s[16:19], s60 offen lds
    v_fmac_f32 v1, v192, v205
    v_fmac_f32 v2, v192, v206
    v_fmac_f32 v3, v192, v207
    buffer_load_dwordx4 v237, s[16:19], s60 offen offset:1024 lds
    v_mul_f32 v220, v196, v0
    v_mul_f32 v221, v196, v1
    v_mul_f32 v222, v196, v2
    v_mul_f32 v223, v196, v3
    buffer_load_dwordx4 v238, s[16:19], s60 offen offset:2048 lds
    v_fmac_f32 v64, v192, v208
    v_fmac_f32 v65, v192, v209
    v_fmac_f32 v66, v192, v210
    v_fmac_f32 v67, v192, v211
    s_waitcnt lgkmcnt(0)
    s_barrier
    s_add_u32 m0, s61, 32768
    s_add_u32 s59, s63, 1835008
    buffer_load_dwordx4 v236, s[16:19], s59 offen lds
    v_exp_f32 v220, v220
    v_exp_f32 v221, v221
    v_exp_f32 v222, v222
    buffer_load_dwordx4 v237, s[16:19], s59 offen offset:1024 lds
    v_exp_f32 v223, v223
    v_mul_f32 v0, v0, v64
    v_mul_f32 v1, v1, v65
    buffer_load_dwordx4 v238, s[16:19], s59 offen offset:2048 lds
    v_mul_f32 v2, v2, v66
    v_mul_f32 v3, v3, v67
    v_fma_f32 v220, v220, v200, v200
    s_add_u32 m0, s61, 35840
    s_add_u32 s60, s63, 1949696
    buffer_load_dwordx4 v236, s[16:19], s60 offen lds
    v_fma_f32 v221, v221, v200, v200
    v_fma_f32 v222, v222, v200, v200
    v_fma_f32 v223, v223, v200, v200
    buffer_load_dwordx4 v237, s[16:19], s60 offen offset:1024 lds
    v_rcp_f32 v220, v220
    v_rcp_f32 v221, v221
    v_rcp_f32 v222, v222
    buffer_load_dwordx4 v238, s[16:19], s60 offen offset:2048 lds
    v_rcp_f32 v223, v223
    v_mul_f32 v0, v0, v220
    v_mul_f32 v1, v1, v221
    s_waitcnt lgkmcnt(0)
    s_barrier
    s_add_u32 m0, s61, 49152
    s_add_u32 s59, s63, 2064384
    buffer_load_dwordx4 v236, s[16:19], s59 offen lds
    v_mul_f32 v2, v2, v222
    v_mul_f32 v3, v3, v223
    v_cvt_pk_bf16_f32 v224, v0, v1
    buffer_load_dwordx4 v237, s[16:19], s59 offen offset:1024 lds
    v_cvt_pk_bf16_f32 v225, v2, v3
    v_fmac_f32 v16, v192, v212
    v_fmac_f32 v17, v192, v213
    v_fmac_f32 v18, v192, v214
    buffer_load_dwordx4 v238, s[16:19], s59 offen offset:2048 lds
    v_fmac_f32 v19, v192, v215
    v_mul_f32 v220, v196, v16
    v_mul_f32 v221, v196, v17
    v_mul_f32 v222, v196, v18
    s_add_u32 m0, s61, 52224
    s_add_u32 s60, s63, 2179072
    buffer_load_dwordx4 v236, s[16:19], s60 offen lds
    v_mul_f32 v223, v196, v19
    v_fmac_f32 v80, v192, v216
    v_fmac_f32 v81, v192, v217
    buffer_load_dwordx4 v237, s[16:19], s60 offen offset:1024 lds
    v_fmac_f32 v82, v192, v218
    v_fmac_f32 v83, v192, v219
    v_exp_f32 v220, v220
    v_exp_f32 v221, v221
    buffer_load_dwordx4 v238, s[16:19], s60 offen offset:2048 lds
    v_exp_f32 v222, v222
    v_exp_f32 v223, v223
    v_mul_f32 v16, v16, v80
    v_mul_f32 v17, v17, v81
    s_waitcnt lgkmcnt(0)
    s_barrier
    s_add_u32 m0, s61, 65536
    s_add_u32 s59, s63, 2293760
    buffer_load_dwordx4 v236, s[16:19], s59 offen lds
    v_mul_f32 v18, v18, v82
    v_mul_f32 v19, v19, v83
    v_fma_f32 v220, v220, v200, v200
    buffer_load_dwordx4 v237, s[16:19], s59 offen offset:1024 lds
    v_fma_f32 v221, v221, v200, v200
    v_fma_f32 v222, v222, v200, v200
    v_fma_f32 v223, v223, v200, v200
    buffer_load_dwordx4 v238, s[16:19], s59 offen offset:2048 lds
    v_rcp_f32 v220, v220
    v_rcp_f32 v221, v221
    v_rcp_f32 v222, v222
    s_add_u32 m0, s61, 68608
    s_add_u32 s60, s63, 2408448
    buffer_load_dwordx4 v236, s[16:19], s60 offen lds
    v_rcp_f32 v223, v223
    v_mul_f32 v16, v16, v220
    v_mul_f32 v17, v17, v221
    buffer_load_dwordx4 v237, s[16:19], s60 offen offset:1024 lds
    v_mul_f32 v18, v18, v222
    v_mul_f32 v19, v19, v223
    v_cvt_pk_bf16_f32 v226, v16, v17
    buffer_load_dwordx4 v238, s[16:19], s60 offen offset:2048 lds
    v_cvt_pk_bf16_f32 v227, v18, v19
    s_add_u32 s55, s64, 0
    buffer_store_dwordx4 v[224:227], v254, s[4:7], s55 offen sc0 sc1
    v_fmac_f32 v4, v193, v204
    v_fmac_f32 v5, v193, v205
    s_waitcnt vmcnt(25) lgkmcnt(0)
    s_barrier
    s_add_u32 m0, s61, 81920
    s_add_u32 s59, s63, 2523136
    buffer_load_dwordx4 v236, s[16:19], s59 offen lds
    v_fmac_f32 v6, v193, v206
    v_fmac_f32 v7, v193, v207
    v_mul_f32 v220, v197, v4
    buffer_load_dwordx4 v237, s[16:19], s59 offen offset:1024 lds
    v_mul_f32 v221, v197, v5
    v_mul_f32 v222, v197, v6
    v_mul_f32 v223, v197, v7
    v_fmac_f32 v68, v193, v208
    buffer_load_dwordx4 v238, s[16:19], s59 offen offset:2048 lds
    v_fmac_f32 v69, v193, v209
    v_fmac_f32 v70, v193, v210
    v_fmac_f32 v71, v193, v211
    v_exp_f32 v220, v220
    s_add_u32 m0, s61, 84992
    s_add_u32 s60, s63, 2637824
    buffer_load_dwordx4 v236, s[16:19], s60 offen lds
    v_exp_f32 v221, v221
    v_exp_f32 v222, v222
    v_exp_f32 v223, v223
    buffer_load_dwordx4 v237, s[16:19], s60 offen offset:1024 lds
    v_mul_f32 v4, v4, v68
    v_mul_f32 v5, v5, v69
    v_mul_f32 v6, v6, v70
    v_mul_f32 v7, v7, v71
    buffer_load_dwordx4 v238, s[16:19], s60 offen offset:2048 lds
    v_fma_f32 v220, v220, v201, v201
    v_fma_f32 v221, v221, v201, v201
    v_fma_f32 v222, v222, v201, v201
    v_fma_f32 v223, v223, v201, v201
    s_waitcnt vmcnt(25) lgkmcnt(0)
    s_barrier
    s_add_u32 m0, s61, 0
    s_add_u32 s59, s63, 2752512
    buffer_load_dwordx4 v236, s[16:19], s59 offen lds
    v_rcp_f32 v220, v220
    v_rcp_f32 v221, v221
    v_rcp_f32 v222, v222
    buffer_load_dwordx4 v237, s[16:19], s59 offen offset:1024 lds
    v_rcp_f32 v223, v223
    v_mul_f32 v4, v4, v220
    v_mul_f32 v5, v5, v221
    v_mul_f32 v6, v6, v222
    buffer_load_dwordx4 v238, s[16:19], s59 offen offset:2048 lds
    v_mul_f32 v7, v7, v223
    v_cvt_pk_bf16_f32 v228, v4, v5
    v_cvt_pk_bf16_f32 v229, v6, v7
    v_fmac_f32 v20, v193, v212
    s_add_u32 m0, s61, 3072
    s_add_u32 s60, s63, 2867200
    buffer_load_dwordx4 v236, s[16:19], s60 offen lds
    v_fmac_f32 v21, v193, v213
    v_fmac_f32 v22, v193, v214
    v_fmac_f32 v23, v193, v215
    buffer_load_dwordx4 v237, s[16:19], s60 offen offset:1024 lds
    v_mul_f32 v220, v197, v20
    v_mul_f32 v221, v197, v21
    v_mul_f32 v222, v197, v22
    v_mul_f32 v223, v197, v23
    buffer_load_dwordx4 v238, s[16:19], s60 offen offset:2048 lds
    v_fmac_f32 v84, v193, v216
    v_fmac_f32 v85, v193, v217
    v_fmac_f32 v86, v193, v218
    v_fmac_f32 v87, v193, v219
    s_waitcnt vmcnt(25) lgkmcnt(0)
    s_barrier
    s_add_u32 m0, s61, 16384
    s_add_u32 s59, s63, 2981888
    buffer_load_dwordx4 v236, s[16:19], s59 offen lds
    v_exp_f32 v220, v220
    v_exp_f32 v221, v221
    v_exp_f32 v222, v222
    buffer_load_dwordx4 v237, s[16:19], s59 offen offset:1024 lds
    v_exp_f32 v223, v223
    v_mul_f32 v20, v20, v84
    v_mul_f32 v21, v21, v85
    buffer_load_dwordx4 v238, s[16:19], s59 offen offset:2048 lds
    v_mul_f32 v22, v22, v86
    v_mul_f32 v23, v23, v87
    v_fma_f32 v220, v220, v201, v201
    s_add_u32 m0, s61, 19456
    s_add_u32 s60, s63, 3096576
    buffer_load_dwordx4 v236, s[16:19], s60 offen lds
    v_fma_f32 v221, v221, v201, v201
    v_fma_f32 v222, v222, v201, v201
    v_fma_f32 v223, v223, v201, v201
    buffer_load_dwordx4 v237, s[16:19], s60 offen offset:1024 lds
    v_rcp_f32 v220, v220
    v_rcp_f32 v221, v221
    v_rcp_f32 v222, v222
    buffer_load_dwordx4 v238, s[16:19], s60 offen offset:2048 lds
    v_rcp_f32 v223, v223
    v_mul_f32 v20, v20, v220
    v_mul_f32 v21, v21, v221
    s_waitcnt vmcnt(25) lgkmcnt(0)
    s_barrier
    s_add_u32 m0, s61, 32768
    s_add_u32 s59, s63, 3211264
    buffer_load_dwordx4 v236, s[16:19], s59 offen lds
    v_mul_f32 v22, v22, v222
    v_mul_f32 v23, v23, v223
    v_cvt_pk_bf16_f32 v230, v20, v21
    buffer_load_dwordx4 v237, s[16:19], s59 offen offset:1024 lds
    v_cvt_pk_bf16_f32 v231, v22, v23
    s_add_u32 s55, s64, 2048
    buffer_store_dwordx4 v[228:231], v254, s[4:7], s55 offen sc0 sc1
    v_fmac_f32 v8, v194, v204
    buffer_load_dwordx4 v238, s[16:19], s59 offen offset:2048 lds
    v_fmac_f32 v9, v194, v205
    v_fmac_f32 v10, v194, v206
    v_fmac_f32 v11, v194, v207
    v_mul_f32 v220, v198, v8
    s_add_u32 m0, s61, 35840
    s_add_u32 s60, s63, 3325952
    buffer_load_dwordx4 v236, s[16:19], s60 offen lds
    v_mul_f32 v221, v198, v9
    v_mul_f32 v222, v198, v10
    v_mul_f32 v223, v198, v11
    buffer_load_dwordx4 v237, s[16:19], s60 offen offset:1024 lds
    v_fmac_f32 v72, v194, v208
    v_fmac_f32 v73, v194, v209
    v_fmac_f32 v74, v194, v210
    buffer_load_dwordx4 v238, s[16:19], s60 offen offset:2048 lds
    v_fmac_f32 v75, v194, v211
    v_exp_f32 v220, v220
    v_exp_f32 v221, v221
    v_exp_f32 v222, v222
    s_waitcnt vmcnt(26) lgkmcnt(0)
    s_barrier
    s_add_u32 m0, s61, 49152
    s_add_u32 s59, s63, 3440640
    buffer_load_dwordx4 v236, s[16:19], s59 offen lds
    v_exp_f32 v223, v223
    v_mul_f32 v8, v8, v72
    v_mul_f32 v9, v9, v73
    buffer_load_dwordx4 v237, s[16:19], s59 offen offset:1024 lds
    v_mul_f32 v10, v10, v74
    v_mul_f32 v11, v11, v75
    v_fma_f32 v220, v220, v202, v202
    v_fma_f32 v221, v221, v202, v202
    buffer_load_dwordx4 v238, s[16:19], s59 offen offset:2048 lds
    v_fma_f32 v222, v222, v202, v202
    v_fma_f32 v223, v223, v202, v202
    v_rcp_f32 v220, v220
    s_add_u32 m0, s61, 52224
    s_add_u32 s60, s63, 3555328
    buffer_load_dwordx4 v236, s[16:19], s60 offen lds
    v_rcp_f32 v221, v221
    v_rcp_f32 v222, v222
    v_rcp_f32 v223, v223
    v_mul_f32 v8, v8, v220
    buffer_load_dwordx4 v237, s[16:19], s60 offen offset:1024 lds
    v_mul_f32 v9, v9, v221
    v_mul_f32 v10, v10, v222
    v_mul_f32 v11, v11, v223
    buffer_load_dwordx4 v238, s[16:19], s60 offen offset:2048 lds
    v_cvt_pk_bf16_f32 v224, v8, v9
    v_cvt_pk_bf16_f32 v225, v10, v11
    v_fmac_f32 v24, v194, v212
    v_fmac_f32 v25, v194, v213
    s_waitcnt vmcnt(25) lgkmcnt(0)
    s_barrier
    s_add_u32 m0, s61, 65536
    s_add_u32 s59, s63, 3670016
    buffer_load_dwordx4 v236, s[16:19], s59 offen lds
    v_fmac_f32 v26, v194, v214
    v_fmac_f32 v27, v194, v215
    v_mul_f32 v220, v198, v24
    buffer_load_dwordx4 v237, s[16:19], s59 offen offset:1024 lds
    v_mul_f32 v221, v198, v25
    v_mul_f32 v222, v198, v26
    v_mul_f32 v223, v198, v27
    v_fmac_f32 v88, v194, v216
    buffer_load_dwordx4 v238, s[16:19], s59 offen offset:2048 lds
    v_fmac_f32 v89, v194, v217
    v_fmac_f32 v90, v194, v218
    v_fmac_f32 v91, v194, v219
    v_exp_f32 v220, v220
    s_add_u32 m0, s61, 68608
    s_add_u32 s60, s63, 3784704
    buffer_load_dwordx4 v236, s[16:19], s60 offen lds
    v_exp_f32 v221, v221
    v_exp_f32 v222, v222
    v_exp_f32 v223, v223
    buffer_load_dwordx4 v237, s[16:19], s60 offen offset:1024 lds
    v_mul_f32 v24, v24, v88
    v_mul_f32 v25, v25, v89
    v_mul_f32 v26, v26, v90
    v_mul_f32 v27, v27, v91
    buffer_load_dwordx4 v238, s[16:19], s60 offen offset:2048 lds
    v_fma_f32 v220, v220, v202, v202
    v_fma_f32 v221, v221, v202, v202
    v_fma_f32 v222, v222, v202, v202
    v_fma_f32 v223, v223, v202, v202
    s_waitcnt vmcnt(25) lgkmcnt(0)
    s_barrier
    s_add_u32 m0, s61, 81920
    s_add_u32 s59, s63, 3899392
    buffer_load_dwordx4 v236, s[16:19], s59 offen lds
    v_rcp_f32 v220, v220
    v_rcp_f32 v221, v221
    v_rcp_f32 v222, v222
    buffer_load_dwordx4 v237, s[16:19], s59 offen offset:1024 lds
    v_rcp_f32 v223, v223
    v_mul_f32 v24, v24, v220
    v_mul_f32 v25, v25, v221
    buffer_load_dwordx4 v238, s[16:19], s59 offen offset:2048 lds
    v_mul_f32 v26, v26, v222
    v_mul_f32 v27, v27, v223
    v_cvt_pk_bf16_f32 v226, v24, v25
    s_add_u32 m0, s61, 84992
    s_add_u32 s60, s63, 4014080
    buffer_load_dwordx4 v236, s[16:19], s60 offen lds
    v_cvt_pk_bf16_f32 v227, v26, v27
    s_add_u32 s55, s64, 4096
    buffer_store_dwordx4 v[224:227], v254, s[4:7], s55 offen sc0 sc1
    v_fmac_f32 v12, v195, v204
    buffer_load_dwordx4 v237, s[16:19], s60 offen offset:1024 lds
    v_fmac_f32 v13, v195, v205
    v_fmac_f32 v14, v195, v206
    v_fmac_f32 v15, v195, v207
    buffer_load_dwordx4 v238, s[16:19], s60 offen offset:2048 lds
    v_mul_f32 v220, v199, v12
    v_mul_f32 v221, v199, v13
    v_mul_f32 v222, v199, v14
    v_mul_f32 v223, v199, v15
    s_waitcnt vmcnt(26) lgkmcnt(0)
    s_barrier
    s_add_u32 m0, s61, 0
    s_add_u32 s59, s63, 4128768
    buffer_load_dwordx4 v236, s[16:19], s59 offen lds
    v_fmac_f32 v76, v195, v208
    v_fmac_f32 v77, v195, v209
    v_fmac_f32 v78, v195, v210
    buffer_load_dwordx4 v237, s[16:19], s59 offen offset:1024 lds
    v_fmac_f32 v79, v195, v211
    v_exp_f32 v220, v220
    v_exp_f32 v221, v221
    buffer_load_dwordx4 v238, s[16:19], s59 offen offset:2048 lds
    v_exp_f32 v222, v222
    v_exp_f32 v223, v223
    v_mul_f32 v12, v12, v76
    s_add_u32 m0, s61, 3072
    s_add_u32 s60, s63, 4243456
    buffer_load_dwordx4 v236, s[16:19], s60 offen lds
    v_mul_f32 v13, v13, v77
    v_mul_f32 v14, v14, v78
    v_mul_f32 v15, v15, v79
    buffer_load_dwordx4 v237, s[16:19], s60 offen offset:1024 lds
    v_fma_f32 v220, v220, v203, v203
    v_fma_f32 v221, v221, v203, v203
    v_fma_f32 v222, v222, v203, v203
    buffer_load_dwordx4 v238, s[16:19], s60 offen offset:2048 lds
    v_fma_f32 v223, v223, v203, v203
    v_rcp_f32 v220, v220
    v_rcp_f32 v221, v221
    v_rcp_f32 v222, v222
    s_waitcnt vmcnt(25) lgkmcnt(0)
    s_barrier
    s_add_u32 m0, s61, 16384
    s_add_u32 s59, s63, 4358144
    buffer_load_dwordx4 v236, s[16:19], s59 offen lds
    v_rcp_f32 v223, v223
    v_mul_f32 v12, v12, v220
    v_mul_f32 v13, v13, v221
    buffer_load_dwordx4 v237, s[16:19], s59 offen offset:1024 lds
    v_mul_f32 v14, v14, v222
    v_mul_f32 v15, v15, v223
    v_cvt_pk_bf16_f32 v228, v12, v13
    v_cvt_pk_bf16_f32 v229, v14, v15
    buffer_load_dwordx4 v238, s[16:19], s59 offen offset:2048 lds
    v_fmac_f32 v28, v195, v212
    v_fmac_f32 v29, v195, v213
    v_fmac_f32 v30, v195, v214
    v_fmac_f32 v31, v195, v215
    s_add_u32 m0, s61, 19456
    s_add_u32 s60, s63, 4472832
    buffer_load_dwordx4 v236, s[16:19], s60 offen lds
    v_mul_f32 v220, v199, v28
    v_mul_f32 v221, v199, v29
    v_mul_f32 v222, v199, v30
    buffer_load_dwordx4 v237, s[16:19], s60 offen offset:1024 lds
    v_mul_f32 v223, v199, v31
    v_fmac_f32 v92, v195, v216
    v_fmac_f32 v93, v195, v217
    v_fmac_f32 v94, v195, v218
    buffer_load_dwordx4 v238, s[16:19], s60 offen offset:2048 lds
    v_fmac_f32 v95, v195, v219
    v_exp_f32 v220, v220
    v_exp_f32 v221, v221
    v_exp_f32 v222, v222
    s_waitcnt vmcnt(25) lgkmcnt(0)
    s_barrier
    s_add_u32 m0, s61, 32768
    s_add_u32 s59, s63, 4587520
    buffer_load_dwordx4 v236, s[16:19], s59 offen lds
    v_exp_f32 v223, v223
    v_mul_f32 v28, v28, v92
    v_mul_f32 v29, v29, v93
    buffer_load_dwordx4 v237, s[16:19], s59 offen offset:1024 lds
    v_mul_f32 v30, v30, v94
    v_mul_f32 v31, v31, v95
    v_fma_f32 v220, v220, v203, v203
    buffer_load_dwordx4 v238, s[16:19], s59 offen offset:2048 lds
    v_fma_f32 v221, v221, v203, v203
    v_fma_f32 v222, v222, v203, v203
    v_fma_f32 v223, v223, v203, v203
    s_add_u32 m0, s61, 35840
    s_add_u32 s60, s63, 4702208
    buffer_load_dwordx4 v236, s[16:19], s60 offen lds
    v_rcp_f32 v220, v220
    v_rcp_f32 v221, v221
    v_rcp_f32 v222, v222
    buffer_load_dwordx4 v237, s[16:19], s60 offen offset:1024 lds
    v_rcp_f32 v223, v223
    v_mul_f32 v28, v28, v220
    v_mul_f32 v29, v29, v221
    buffer_load_dwordx4 v238, s[16:19], s60 offen offset:2048 lds
    v_mul_f32 v30, v30, v222
    v_mul_f32 v31, v31, v223
    v_cvt_pk_bf16_f32 v230, v28, v29
    v_cvt_pk_bf16_f32 v231, v30, v31
    s_waitcnt vmcnt(25) lgkmcnt(0)
    s_barrier
    s_add_u32 m0, s61, 49152
    s_add_u32 s59, s63, 4816896
    buffer_load_dwordx4 v236, s[16:19], s59 offen lds
    s_add_u32 s55, s64, 6144
    buffer_store_dwordx4 v[228:231], v254, s[4:7], s55 offen sc0 sc1
    ds_read_b128 v[204:207], v235 offset:128
    ds_read_b128 v[208:211], v235 offset:640
    buffer_load_dwordx4 v237, s[16:19], s59 offen offset:1024 lds
    ds_read_b128 v[212:215], v235 offset:192
    ds_read_b128 v[216:219], v235 offset:704
    s_waitcnt lgkmcnt(0)
    buffer_load_dwordx4 v238, s[16:19], s59 offen offset:2048 lds
    v_fmac_f32 v32, v192, v204
    v_fmac_f32 v33, v192, v205
    v_fmac_f32 v34, v192, v206
    s_add_u32 m0, s61, 52224
    s_add_u32 s60, s63, 4931584
    buffer_load_dwordx4 v236, s[16:19], s60 offen lds
    v_fmac_f32 v35, v192, v207
    v_mul_f32 v220, v196, v32
    v_mul_f32 v221, v196, v33
    buffer_load_dwordx4 v237, s[16:19], s60 offen offset:1024 lds
    v_mul_f32 v222, v196, v34
    v_mul_f32 v223, v196, v35
    v_fmac_f32 v96, v192, v208
    buffer_load_dwordx4 v238, s[16:19], s60 offen offset:2048 lds
    v_fmac_f32 v97, v192, v209
    v_fmac_f32 v98, v192, v210
    v_fmac_f32 v99, v192, v211
    v_exp_f32 v220, v220
    s_waitcnt vmcnt(25) lgkmcnt(0)
    s_barrier
    s_add_u32 m0, s61, 65536
    s_add_u32 s59, s63, 5046272
    buffer_load_dwordx4 v236, s[16:19], s59 offen lds
    v_exp_f32 v221, v221
    v_exp_f32 v222, v222
    v_exp_f32 v223, v223
    buffer_load_dwordx4 v237, s[16:19], s59 offen offset:1024 lds
    v_mul_f32 v32, v32, v96
    v_mul_f32 v33, v33, v97
    v_mul_f32 v34, v34, v98
    buffer_load_dwordx4 v238, s[16:19], s59 offen offset:2048 lds
    v_mul_f32 v35, v35, v99
    v_fma_f32 v220, v220, v200, v200
    v_fma_f32 v221, v221, v200, v200
    s_add_u32 m0, s61, 68608
    s_add_u32 s60, s63, 5160960
    buffer_load_dwordx4 v236, s[16:19], s60 offen lds
    v_fma_f32 v222, v222, v200, v200
    v_fma_f32 v223, v223, v200, v200
    v_rcp_f32 v220, v220
    buffer_load_dwordx4 v237, s[16:19], s60 offen offset:1024 lds
    v_rcp_f32 v221, v221
    v_rcp_f32 v222, v222
    v_rcp_f32 v223, v223
    buffer_load_dwordx4 v238, s[16:19], s60 offen offset:2048 lds
    v_mul_f32 v32, v32, v220
    v_mul_f32 v33, v33, v221
    v_mul_f32 v34, v34, v222
    v_mul_f32 v35, v35, v223
    s_waitcnt vmcnt(25) lgkmcnt(0)
    s_barrier
    s_add_u32 m0, s61, 81920
    s_add_u32 s59, s63, 5275648
    buffer_load_dwordx4 v236, s[16:19], s59 offen lds
    v_cvt_pk_bf16_f32 v224, v32, v33
    v_cvt_pk_bf16_f32 v225, v34, v35
    v_fmac_f32 v48, v192, v212
    buffer_load_dwordx4 v237, s[16:19], s59 offen offset:1024 lds
    v_fmac_f32 v49, v192, v213
    v_fmac_f32 v50, v192, v214
    v_fmac_f32 v51, v192, v215
    v_mul_f32 v220, v196, v48
    buffer_load_dwordx4 v238, s[16:19], s59 offen offset:2048 lds
    v_mul_f32 v221, v196, v49
    v_mul_f32 v222, v196, v50
    v_mul_f32 v223, v196, v51
    v_fmac_f32 v112, v192, v216
    s_add_u32 m0, s61, 84992
    s_add_u32 s60, s63, 5390336
    buffer_load_dwordx4 v236, s[16:19], s60 offen lds
    v_fmac_f32 v113, v192, v217
    v_fmac_f32 v114, v192, v218
    v_fmac_f32 v115, v192, v219
    buffer_load_dwordx4 v237, s[16:19], s60 offen offset:1024 lds
    v_exp_f32 v220, v220
    v_exp_f32 v221, v221
    v_exp_f32 v222, v222
    v_exp_f32 v223, v223
    buffer_load_dwordx4 v238, s[16:19], s60 offen offset:2048 lds
    v_mul_f32 v48, v48, v112
    v_mul_f32 v49, v49, v113
    v_mul_f32 v50, v50, v114
    v_mul_f32 v51, v51, v115
    s_waitcnt vmcnt(25) lgkmcnt(0)
    s_barrier
    s_add_u32 m0, s61, 0
    s_add_u32 s59, s63, 5505024
    buffer_load_dwordx4 v236, s[16:19], s59 offen lds
    v_fma_f32 v220, v220, v200, v200
    v_fma_f32 v221, v221, v200, v200
    v_fma_f32 v222, v222, v200, v200
    buffer_load_dwordx4 v237, s[16:19], s59 offen offset:1024 lds
    v_fma_f32 v223, v223, v200, v200
    v_rcp_f32 v220, v220
    v_rcp_f32 v221, v221
    buffer_load_dwordx4 v238, s[16:19], s59 offen offset:2048 lds
    v_rcp_f32 v222, v222
    v_rcp_f32 v223, v223
    v_mul_f32 v48, v48, v220
    s_add_u32 m0, s61, 3072
    s_add_u32 s60, s63, 5619712
    buffer_load_dwordx4 v236, s[16:19], s60 offen lds
    v_mul_f32 v49, v49, v221
    v_mul_f32 v50, v50, v222
    v_mul_f32 v51, v51, v223
    buffer_load_dwordx4 v237, s[16:19], s60 offen offset:1024 lds
    v_cvt_pk_bf16_f32 v226, v48, v49
    v_cvt_pk_bf16_f32 v227, v50, v51
    s_add_u32 s55, s64, 131072
    buffer_store_dwordx4 v[224:227], v254, s[4:7], s55 offen sc0 sc1
    buffer_load_dwordx4 v238, s[16:19], s60 offen offset:2048 lds
    v_fmac_f32 v36, v193, v204
    v_fmac_f32 v37, v193, v205
    v_fmac_f32 v38, v193, v206
    v_fmac_f32 v39, v193, v207
    s_waitcnt vmcnt(26) lgkmcnt(0)
    s_barrier
    s_add_u32 m0, s61, 16384
    s_add_u32 s59, s63, 5734400
    buffer_load_dwordx4 v236, s[16:19], s59 offen lds
    v_mul_f32 v220, v197, v36
    v_mul_f32 v221, v197, v37
    v_mul_f32 v222, v197, v38
    buffer_load_dwordx4 v237, s[16:19], s59 offen offset:1024 lds
    v_mul_f32 v223, v197, v39
    v_fmac_f32 v100, v193, v208
    v_fmac_f32 v101, v193, v209
    v_fmac_f32 v102, v193, v210
    buffer_load_dwordx4 v238, s[16:19], s59 offen offset:2048 lds
    v_fmac_f32 v103, v193, v211
    v_exp_f32 v220, v220
    v_exp_f32 v221, v221
    s_add_u32 m0, s61, 19456
    s_add_u32 s60, s63, 5849088
    buffer_load_dwordx4 v236, s[16:19], s60 offen lds
    v_exp_f32 v222, v222
    v_exp_f32 v223, v223
    v_mul_f32 v36, v36, v100
    v_mul_f32 v37, v37, v101
    buffer_load_dwordx4 v237, s[16:19], s60 offen offset:1024 lds
    v_mul_f32 v38, v38, v102
    v_mul_f32 v39, v39, v103
    v_fma_f32 v220, v220, v201, v201
    buffer_load_dwordx4 v238, s[16:19], s60 offen offset:2048 lds
    v_fma_f32 v221, v221, v201, v201
    v_fma_f32 v222, v222, v201, v201
    v_fma_f32 v223, v223, v201, v201
    v_rcp_f32 v220, v220
    s_waitcnt vmcnt(25) lgkmcnt(0)
    s_barrier
    s_add_u32 m0, s61, 32768
    s_add_u32 s59, s63, 5963776
    buffer_load_dwordx4 v236, s[16:19], s59 offen lds
    v_rcp_f32 v221, v221
    v_rcp_f32 v222, v222
    v_rcp_f32 v223, v223
    buffer_load_dwordx4 v237, s[16:19], s59 offen offset:1024 lds
    v_mul_f32 v36, v36, v220
    v_mul_f32 v37, v37, v221
    v_mul_f32 v38, v38, v222
    v_mul_f32 v39, v39, v223
    buffer_load_dwordx4 v238, s[16:19], s59 offen offset:2048 lds
    v_cvt_pk_bf16_f32 v228, v36, v37
    v_cvt_pk_bf16_f32 v229, v38, v39
    v_fmac_f32 v52, v193, v212
    v_fmac_f32 v53, v193, v213
    s_add_u32 m0, s61, 35840
    s_add_u32 s60, s63, 6078464
    buffer_load_dwordx4 v236, s[16:19], s60 offen lds
    v_fmac_f32 v54, v193, v214
    v_fmac_f32 v55, v193, v215
    v_mul_f32 v220, v197, v52
    buffer_load_dwordx4 v237, s[16:19], s60 offen offset:1024 lds
    v_mul_f32 v221, v197, v53
    v_mul_f32 v222, v197, v54
    v_mul_f32 v223, v197, v55
    v_fmac_f32 v116, v193, v216
    buffer_load_dwordx4 v238, s[16:19], s60 offen offset:2048 lds
    v_fmac_f32 v117, v193, v217
    v_fmac_f32 v118, v193, v218
    v_fmac_f32 v119, v193, v219
    v_exp_f32 v220, v220
    s_waitcnt vmcnt(25) lgkmcnt(0)
    s_barrier
    s_and_b32 s55, s41, 7
    s_lshl_b32 s55, s55, 2
    s_add_u32 s55, s55, s42
    s_add_u32 s55, s55, s0
    s_add_u32 s55, s55, 2048
    v_mov_b32 v252, 0
    v_mov_b32 v253, 1
    s_mov_b64 exec, 1
    s_cmp_eq_u32 s45, 0
    s_cbranch_scc1 st_17
    buffer_store_byte v253, v252, s[4:7], s55 offen sc0 sc1
    s_branch st_18
st_17:
    buffer_store_byte v253, v252, s[4:7], s55 offen
st_18:
    s_mov_b64 exec, -1
    s_add_u32 m0, s61, 49152
    s_add_u32 s59, s63, 6193152
    buffer_load_dwordx4 v236, s[16:19], s59 offen lds
    v_exp_f32 v221, v221
    v_exp_f32 v222, v222
    v_exp_f32 v223, v223
    buffer_load_dwordx4 v237, s[16:19], s59 offen offset:1024 lds
    v_mul_f32 v52, v52, v116
    v_mul_f32 v53, v53, v117
    v_mul_f32 v54, v54, v118
    buffer_load_dwordx4 v238, s[16:19], s59 offen offset:2048 lds
    v_mul_f32 v55, v55, v119
    v_fma_f32 v220, v220, v201, v201
    v_fma_f32 v221, v221, v201, v201
    s_add_u32 m0, s61, 52224
    s_add_u32 s60, s63, 6307840
    buffer_load_dwordx4 v236, s[16:19], s60 offen lds
    v_fma_f32 v222, v222, v201, v201
    v_fma_f32 v223, v223, v201, v201
    v_rcp_f32 v220, v220
    buffer_load_dwordx4 v237, s[16:19], s60 offen offset:1024 lds
    v_rcp_f32 v221, v221
    v_rcp_f32 v222, v222
    v_rcp_f32 v223, v223
    buffer_load_dwordx4 v238, s[16:19], s60 offen offset:2048 lds
    v_mul_f32 v52, v52, v220
    v_mul_f32 v53, v53, v221
    v_mul_f32 v54, v54, v222
    v_mul_f32 v55, v55, v223
    s_waitcnt vmcnt(26) lgkmcnt(0)
    s_barrier
    s_add_u32 m0, s61, 65536
    s_add_u32 s59, s63, 6422528
    buffer_load_dwordx4 v236, s[16:19], s59 offen lds
    v_cvt_pk_bf16_f32 v230, v52, v53
    v_cvt_pk_bf16_f32 v231, v54, v55
    s_add_u32 s55, s64, 133120
    buffer_store_dwordx4 v[228:231], v254, s[4:7], s55 offen sc0 sc1
    buffer_load_dwordx4 v237, s[16:19], s59 offen offset:1024 lds
    v_fmac_f32 v40, v194, v204
    v_fmac_f32 v41, v194, v205
    v_fmac_f32 v42, v194, v206
    buffer_load_dwordx4 v238, s[16:19], s59 offen offset:2048 lds
    v_fmac_f32 v43, v194, v207
    v_mul_f32 v220, v198, v40
    v_mul_f32 v221, v198, v41
    s_add_u32 m0, s61, 68608
    s_add_u32 s60, s63, 6537216
    buffer_load_dwordx4 v236, s[16:19], s60 offen lds
    v_mul_f32 v222, v198, v42
    v_mul_f32 v223, v198, v43
    v_fmac_f32 v104, v194, v208
    buffer_load_dwordx4 v237, s[16:19], s60 offen offset:1024 lds
    v_fmac_f32 v105, v194, v209
    v_fmac_f32 v106, v194, v210
    v_fmac_f32 v107, v194, v211
    buffer_load_dwordx4 v238, s[16:19], s60 offen offset:2048 lds
    v_exp_f32 v220, v220
    v_exp_f32 v221, v221
    v_exp_f32 v222, v222
    v_exp_f32 v223, v223
    s_waitcnt vmcnt(26) lgkmcnt(0)
    s_barrier
    s_add_u32 m0, s61, 81920
    s_add_u32 s59, s63, 6651904
    buffer_load_dwordx4 v236, s[16:19], s59 offen lds
    v_mul_f32 v40, v40, v104
    v_mul_f32 v41, v41, v105
    v_mul_f32 v42, v42, v106
    buffer_load_dwordx4 v237, s[16:19], s59 offen offset:1024 lds
    v_mul_f32 v43, v43, v107
    v_fma_f32 v220, v220, v202, v202
    v_fma_f32 v221, v221, v202, v202
    v_fma_f32 v222, v222, v202, v202
    buffer_load_dwordx4 v238, s[16:19], s59 offen offset:2048 lds
    v_fma_f32 v223, v223, v202, v202
    v_rcp_f32 v220, v220
    v_rcp_f32 v221, v221
    v_rcp_f32 v222, v222
    s_add_u32 m0, s61, 84992
    s_add_u32 s60, s63, 6766592
    buffer_load_dwordx4 v236, s[16:19], s60 offen lds
    v_rcp_f32 v223, v223
    v_mul_f32 v40, v40, v220
    v_mul_f32 v41, v41, v221
    buffer_load_dwordx4 v237, s[16:19], s60 offen offset:1024 lds
    v_mul_f32 v42, v42, v222
    v_mul_f32 v43, v43, v223
    v_cvt_pk_bf16_f32 v224, v40, v41
    v_cvt_pk_bf16_f32 v225, v42, v43
    buffer_load_dwordx4 v238, s[16:19], s60 offen offset:2048 lds
    v_fmac_f32 v56, v194, v212
    v_fmac_f32 v57, v194, v213
    v_fmac_f32 v58, v194, v214
    v_fmac_f32 v59, v194, v215
    s_waitcnt vmcnt(26) lgkmcnt(0)
    s_barrier
    s_add_u32 m0, s61, 0
    s_add_u32 s59, s63, 6881280
    buffer_load_dwordx4 v236, s[16:19], s59 offen lds
    v_mul_f32 v220, v198, v56
    v_mul_f32 v221, v198, v57
    v_mul_f32 v222, v198, v58
    buffer_load_dwordx4 v237, s[16:19], s59 offen offset:1024 lds
    v_mul_f32 v223, v198, v59
    v_fmac_f32 v120, v194, v216
    v_fmac_f32 v121, v194, v217
    v_fmac_f32 v122, v194, v218
    buffer_load_dwordx4 v238, s[16:19], s59 offen offset:2048 lds
    v_fmac_f32 v123, v194, v219
    v_exp_f32 v220, v220
    v_exp_f32 v221, v221
    s_add_u32 m0, s61, 3072
    s_add_u32 s60, s63, 6995968
    buffer_load_dwordx4 v236, s[16:19], s60 offen lds
    v_exp_f32 v222, v222
    v_exp_f32 v223, v223
    v_mul_f32 v56, v56, v120
    v_mul_f32 v57, v57, v121
    buffer_load_dwordx4 v237, s[16:19], s60 offen offset:1024 lds
    v_mul_f32 v58, v58, v122
    v_mul_f32 v59, v59, v123
    v_fma_f32 v220, v220, v202, v202
    buffer_load_dwordx4 v238, s[16:19], s60 offen offset:2048 lds
    v_fma_f32 v221, v221, v202, v202
    v_fma_f32 v222, v222, v202, v202
    v_fma_f32 v223, v223, v202, v202
    v_rcp_f32 v220, v220
    s_waitcnt vmcnt(26) lgkmcnt(0)
    s_barrier
    s_add_u32 m0, s61, 16384
    s_add_u32 s59, s63, 7110656
    buffer_load_dwordx4 v236, s[16:19], s59 offen lds
    v_rcp_f32 v221, v221
    v_rcp_f32 v222, v222
    v_rcp_f32 v223, v223
    buffer_load_dwordx4 v237, s[16:19], s59 offen offset:1024 lds
    v_mul_f32 v56, v56, v220
    v_mul_f32 v57, v57, v221
    v_mul_f32 v58, v58, v222
    buffer_load_dwordx4 v238, s[16:19], s59 offen offset:2048 lds
    v_mul_f32 v59, v59, v223
    v_cvt_pk_bf16_f32 v226, v56, v57
    v_cvt_pk_bf16_f32 v227, v58, v59
    s_add_u32 s55, s64, 135168
    buffer_store_dwordx4 v[224:227], v254, s[4:7], s55 offen sc0 sc1
    s_add_u32 m0, s61, 19456
    s_add_u32 s60, s63, 7225344
    buffer_load_dwordx4 v236, s[16:19], s60 offen lds
    v_fmac_f32 v44, v195, v204
    v_fmac_f32 v45, v195, v205
    v_fmac_f32 v46, v195, v206
    buffer_load_dwordx4 v237, s[16:19], s60 offen offset:1024 lds
    v_fmac_f32 v47, v195, v207
    v_mul_f32 v220, v199, v44
    v_mul_f32 v221, v199, v45
    buffer_load_dwordx4 v238, s[16:19], s60 offen offset:2048 lds
    v_mul_f32 v222, v199, v46
    v_mul_f32 v223, v199, v47
    v_fmac_f32 v108, v195, v208
    v_fmac_f32 v109, v195, v209
    s_waitcnt vmcnt(26) lgkmcnt(0)
    s_barrier
    s_add_u32 m0, s67, 32768
    s_add_u32 s59, s68, 0
    buffer_load_dwordx4 v239, s[20:23], s59 offen lds
    v_fmac_f32 v110, v195, v210
    v_fmac_f32 v111, v195, v211
    buffer_load_dwordx4 v240, s[20:23], s59 offen offset:1024 lds
    v_exp_f32 v220, v220
    v_exp_f32 v221, v221
    buffer_load_dwordx4 v241, s[20:23], s59 offen offset:2048 lds
    v_exp_f32 v222, v222
    v_exp_f32 v223, v223
    buffer_load_dwordx4 v242, s[20:23], s59 offen offset:3072 lds
    v_mul_f32 v44, v44, v108
    v_mul_f32 v45, v45, v109
    v_mul_f32 v46, v46, v110
    s_add_u32 m0, s67, 36864
    s_add_u32 s60, s68, 32768
    buffer_load_dwordx4 v239, s[20:23], s60 offen lds
    v_mul_f32 v47, v47, v111
    v_fma_f32 v220, v220, v203, v203
    buffer_load_dwordx4 v240, s[20:23], s60 offen offset:1024 lds
    v_fma_f32 v221, v221, v203, v203
    v_fma_f32 v222, v222, v203, v203
    buffer_load_dwordx4 v241, s[20:23], s60 offen offset:2048 lds
    v_fma_f32 v223, v223, v203, v203
    v_rcp_f32 v220, v220
    buffer_load_dwordx4 v242, s[20:23], s60 offen offset:3072 lds
    v_rcp_f32 v221, v221
    v_rcp_f32 v222, v222
    v_rcp_f32 v223, v223
    s_waitcnt vmcnt(27) lgkmcnt(0)
    s_barrier
    s_add_u32 m0, s67, 49152
    s_add_u32 s59, s68, 655360
    buffer_load_dwordx4 v239, s[20:23], s59 offen lds
    v_mul_f32 v44, v44, v220
    v_mul_f32 v45, v45, v221
    buffer_load_dwordx4 v240, s[20:23], s59 offen offset:1024 lds
    v_mul_f32 v46, v46, v222
    v_mul_f32 v47, v47, v223
    v_cvt_pk_bf16_f32 v228, v44, v45
    buffer_load_dwordx4 v241, s[20:23], s59 offen offset:2048 lds
    v_cvt_pk_bf16_f32 v229, v46, v47
    v_fmac_f32 v60, v195, v212
    v_fmac_f32 v61, v195, v213
    buffer_load_dwordx4 v242, s[20:23], s59 offen offset:3072 lds
    v_fmac_f32 v62, v195, v214
    v_fmac_f32 v63, v195, v215
    v_mul_f32 v220, v199, v60
    s_add_u32 m0, s67, 53248
    s_add_u32 s60, s68, 688128
    buffer_load_dwordx4 v239, s[20:23], s60 offen lds
    v_mul_f32 v221, v199, v61
    v_mul_f32 v222, v199, v62
    buffer_load_dwordx4 v240, s[20:23], s60 offen offset:1024 lds
    v_mul_f32 v223, v199, v63
    v_fmac_f32 v124, v195, v216
    v_fmac_f32 v125, v195, v217
    buffer_load_dwordx4 v241, s[20:23], s60 offen offset:2048 lds
    v_fmac_f32 v126, v195, v218
    v_fmac_f32 v127, v195, v219
    v_exp_f32 v220, v220
    buffer_load_dwordx4 v242, s[20:23], s60 offen offset:3072 lds
    v_exp_f32 v221, v221
    v_exp_f32 v222, v222
    v_exp_f32 v223, v223
    s_waitcnt vmcnt(29) lgkmcnt(0)
    s_barrier
    s_add_u32 m0, s67, 65536
    s_add_u32 s59, s68, 917504
    buffer_load_dwordx4 v239, s[20:23], s59 offen lds
    v_mul_f32 v60, v60, v124
    v_mul_f32 v61, v61, v125
    buffer_load_dwordx4 v240, s[20:23], s59 offen offset:1024 lds
    v_mul_f32 v62, v62, v126
    v_mul_f32 v63, v63, v127
    buffer_load_dwordx4 v241, s[20:23], s59 offen offset:2048 lds
    v_fma_f32 v220, v220, v203, v203
    v_fma_f32 v221, v221, v203, v203
    v_fma_f32 v222, v222, v203, v203
    buffer_load_dwordx4 v242, s[20:23], s59 offen offset:3072 lds
    v_fma_f32 v223, v223, v203, v203
    v_rcp_f32 v220, v220
    s_add_u32 m0, s67, 69632
    s_add_u32 s60, s68, 950272
    buffer_load_dwordx4 v239, s[20:23], s60 offen lds
    v_rcp_f32 v221, v221
    v_rcp_f32 v222, v222
    buffer_load_dwordx4 v240, s[20:23], s60 offen offset:1024 lds
    v_rcp_f32 v223, v223
    v_mul_f32 v60, v60, v220
    v_mul_f32 v61, v61, v221
    buffer_load_dwordx4 v241, s[20:23], s60 offen offset:2048 lds
    v_mul_f32 v62, v62, v222
    v_mul_f32 v63, v63, v223
    buffer_load_dwordx4 v242, s[20:23], s60 offen offset:3072 lds
    v_cvt_pk_bf16_f32 v230, v60, v61
    v_cvt_pk_bf16_f32 v231, v62, v63
    s_add_u32 s55, s64, 137216
    buffer_store_dwordx4 v[228:231], v254, s[4:7], s55 offen sc0 sc1
    s_waitcnt vmcnt(32) lgkmcnt(0)
    s_barrier
    s_add_u32 m0, s67, 81920
    s_add_u32 s59, s68, 1572864
    buffer_load_dwordx4 v239, s[20:23], s59 offen lds
    buffer_load_dwordx4 v240, s[20:23], s59 offen offset:1024 lds
    buffer_load_dwordx4 v241, s[20:23], s59 offen offset:2048 lds
    buffer_load_dwordx4 v242, s[20:23], s59 offen offset:3072 lds
    s_add_u32 m0, s67, 86016
    s_add_u32 s60, s68, 1605632
    buffer_load_dwordx4 v239, s[20:23], s60 offen lds
    buffer_load_dwordx4 v240, s[20:23], s60 offen offset:1024 lds
    buffer_load_dwordx4 v241, s[20:23], s60 offen offset:2048 lds
    buffer_load_dwordx4 v242, s[20:23], s60 offen offset:3072 lds
    s_waitcnt vmcnt(33) lgkmcnt(0)
    s_barrier
    s_add_u32 m0, s67, 0
    s_add_u32 s59, s68, 1835008
    buffer_load_dwordx4 v239, s[20:23], s59 offen lds
    v_lshlrev_b32 v128, 16, v160
    v_and_b32 v129, 0xffff0000, v160
    buffer_load_dwordx4 v240, s[20:23], s59 offen offset:1024 lds
    v_lshlrev_b32 v130, 16, v161
    v_and_b32 v131, 0xffff0000, v161
    v_lshlrev_b32 v144, 16, v162
    buffer_load_dwordx4 v241, s[20:23], s59 offen offset:2048 lds
    v_and_b32 v145, 0xffff0000, v162
    v_lshlrev_b32 v146, 16, v163
    v_and_b32 v147, 0xffff0000, v163
    v_lshlrev_b32 v132, 16, v164
    buffer_load_dwordx4 v242, s[20:23], s59 offen offset:3072 lds
    v_and_b32 v133, 0xffff0000, v164
    v_lshlrev_b32 v134, 16, v165
    v_and_b32 v135, 0xffff0000, v165
    s_add_u32 m0, s67, 4096
    s_add_u32 s60, s68, 1867776
    buffer_load_dwordx4 v239, s[20:23], s60 offen lds
    v_lshlrev_b32 v148, 16, v166
    v_and_b32 v149, 0xffff0000, v166
    v_lshlrev_b32 v150, 16, v167
    buffer_load_dwordx4 v240, s[20:23], s60 offen offset:1024 lds
    v_and_b32 v151, 0xffff0000, v167
    v_lshlrev_b32 v136, 16, v168
    v_and_b32 v137, 0xffff0000, v168
    v_lshlrev_b32 v138, 16, v169
    buffer_load_dwordx4 v241, s[20:23], s60 offen offset:2048 lds
    v_and_b32 v139, 0xffff0000, v169
    v_lshlrev_b32 v152, 16, v170
    v_and_b32 v153, 0xffff0000, v170
    buffer_load_dwordx4 v242, s[20:23], s60 offen offset:3072 lds
    v_lshlrev_b32 v154, 16, v171
    v_and_b32 v155, 0xffff0000, v171
    v_lshlrev_b32 v140, 16, v172
    v_and_b32 v141, 0xffff0000, v172
    s_waitcnt vmcnt(33) lgkmcnt(0)
    s_barrier
    s_add_u32 m0, s67, 16384
    s_add_u32 s59, s68, 2490368
    buffer_load_dwordx4 v239, s[20:23], s59 offen lds
    v_lshlrev_b32 v142, 16, v173
    v_and_b32 v143, 0xffff0000, v173
    v_lshlrev_b32 v156, 16, v174
    v_and_b32 v157, 0xffff0000, v174
    buffer_load_dwordx4 v240, s[20:23], s59 offen offset:1024 lds
    v_lshlrev_b32 v158, 16, v175
    v_and_b32 v159, 0xffff0000, v175
    v_mov_b32 v160, 0
    v_mov_b32 v161, 0
    v_mov_b32 v162, 0
    buffer_load_dwordx4 v241, s[20:23], s59 offen offset:2048 lds
    v_mov_b32 v163, 0
    v_mov_b32 v164, 0
    v_mov_b32 v165, 0
    v_mov_b32 v166, 0
    v_mov_b32 v167, 0
    buffer_load_dwordx4 v242, s[20:23], s59 offen offset:3072 lds
    v_mov_b32 v168, 0
    v_mov_b32 v169, 0
    v_mov_b32 v170, 0
    v_mov_b32 v171, 0
    v_mov_b32 v172, 0
    s_add_u32 m0, s67, 20480
    s_add_u32 s60, s68, 2523136
    buffer_load_dwordx4 v239, s[20:23], s60 offen lds
    v_mov_b32 v173, 0
    v_mov_b32 v174, 0
    v_mov_b32 v175, 0
    v_mov_b32 v176, 0
    buffer_load_dwordx4 v240, s[20:23], s60 offen offset:1024 lds
    v_mov_b32 v177, 0
    v_mov_b32 v178, 0
    v_mov_b32 v179, 0
    v_mov_b32 v180, 0
    v_mov_b32 v181, 0
    buffer_load_dwordx4 v241, s[20:23], s60 offen offset:2048 lds
    v_mov_b32 v182, 0
    v_mov_b32 v183, 0
    v_mov_b32 v184, 0
    v_mov_b32 v185, 0
    v_mov_b32 v186, 0
    buffer_load_dwordx4 v242, s[20:23], s60 offen offset:3072 lds
    v_mov_b32 v187, 0
    v_mov_b32 v188, 0
    v_mov_b32 v189, 0
    v_mov_b32 v190, 0
    v_mov_b32 v191, 0
    s_waitcnt vmcnt(24)
    s_and_b32 s55, s41, 7
    s_lshl_b32 s55, s55, 2
    s_add_u32 s55, s55, s42
    s_add_u32 s55, s55, s0
    s_add_u32 s55, s55, 2080
    v_mov_b32 v252, 0
    v_mov_b32 v253, 1
    s_mov_b64 exec, 1
    s_cmp_eq_u32 s45, 0
    s_cbranch_scc1 st_19
    buffer_store_byte v253, v252, s[4:7], s55 offen sc0 sc1
    s_branch st_20
st_19:
    buffer_store_byte v253, v252, s[4:7], s55 offen
st_20:
    s_mov_b64 exec, -1
    s_setprio 0
X_g4:
    ds_read_b64_tr_b16 v[32:33], v244 offset:32768
    ds_read_b64_tr_b16 v[34:35], v244 offset:36864
    ds_read_b128 v[0:3], v243 offset:32768
    ds_read_b128 v[4:7], v243 offset:34816
    ds_read_b128 v[8:11], v243 offset:36864
    ds_read_b128 v[12:15], v243 offset:38912
    ds_read_b64_tr_b16 v[36:37], v245 offset:32768
    ds_read_b64_tr_b16 v[38:39], v245 offset:36864
    ds_read_b64_tr_b16 v[40:41], v246 offset:32768
    ds_read_b64_tr_b16 v[42:43], v246 offset:36864
    ds_read_b64_tr_b16 v[44:45], v247 offset:32768
    ds_read_b64_tr_b16 v[46:47], v247 offset:36864
    s_lshl_b32 s55, s51, 14
    s_lshl_b32 s56, s42, 12
    s_add_u32 s55, s55, s56
    s_add_u32 s55, s55, s47
    s_add_u32 s62, s55, 1310720
    s_xor_b32 s63, s62, 16384
    s_mov_b32 s58, 4
    .p2align 3
loop_21:
    s_waitcnt lgkmcnt(0)
    .p2align 3
    v_mfma_f32_16x16x32_bf16 v[128:131], v[32:35], v[0:3], v[128:131]
    ds_read_b64_tr_b16 v[48:49], v244 offset:40960
    v_mfma_f32_16x16x32_bf16 v[132:135], v[32:35], v[4:7], v[132:135]
    ds_read_b64_tr_b16 v[50:51], v244 offset:45056
    v_mfma_f32_16x16x32_bf16 v[136:139], v[32:35], v[8:11], v[136:139]
    ds_read_b128 v[16:19], v243 offset:33792
    v_mfma_f32_16x16x32_bf16 v[140:143], v[32:35], v[12:15], v[140:143]
    ds_read_b128 v[20:23], v243 offset:35840
    v_mfma_f32_16x16x32_bf16 v[144:147], v[36:39], v[0:3], v[144:147]
    ds_read_b128 v[24:27], v243 offset:37888
    v_mfma_f32_16x16x32_bf16 v[148:151], v[36:39], v[4:7], v[148:151]
    ds_read_b128 v[28:31], v243 offset:39936
    v_mfma_f32_16x16x32_bf16 v[152:155], v[36:39], v[8:11], v[152:155]
    ds_read_b64_tr_b16 v[52:53], v245 offset:40960
    v_mfma_f32_16x16x32_bf16 v[156:159], v[36:39], v[12:15], v[156:159]
    ds_read_b64_tr_b16 v[54:55], v245 offset:45056
    v_mfma_f32_16x16x32_bf16 v[160:163], v[40:43], v[0:3], v[160:163]
    ds_read_b64_tr_b16 v[56:57], v246 offset:40960
    v_mfma_f32_16x16x32_bf16 v[164:167], v[40:43], v[4:7], v[164:167]
    ds_read_b64_tr_b16 v[58:59], v246 offset:45056
    v_mfma_f32_16x16x32_bf16 v[168:171], v[40:43], v[8:11], v[168:171]
    ds_read_b64_tr_b16 v[60:61], v247 offset:40960
    v_mfma_f32_16x16x32_bf16 v[172:175], v[40:43], v[12:15], v[172:175]
    ds_read_b64_tr_b16 v[62:63], v247 offset:45056
    v_mfma_f32_16x16x32_bf16 v[176:179], v[44:47], v[0:3], v[176:179]
    v_mfma_f32_16x16x32_bf16 v[180:183], v[44:47], v[4:7], v[180:183]
    v_mfma_f32_16x16x32_bf16 v[184:187], v[44:47], v[8:11], v[184:187]
    v_mfma_f32_16x16x32_bf16 v[188:191], v[44:47], v[12:15], v[188:191]
    s_waitcnt vmcnt(32) lgkmcnt(0)
    s_barrier
    .p2align 3
    v_mfma_f32_16x16x32_bf16 v[128:131], v[48:51], v[16:19], v[128:131]
    ds_read_b64_tr_b16 v[32:33], v248 offset:0
    v_mfma_f32_16x16x32_bf16 v[132:135], v[48:51], v[20:23], v[132:135]
    ds_read_b64_tr_b16 v[34:35], v248 offset:4096
    v_mfma_f32_16x16x32_bf16 v[136:139], v[48:51], v[24:27], v[136:139]
    ds_read_b128 v[0:3], v243 offset:0
    v_mfma_f32_16x16x32_bf16 v[140:143], v[48:51], v[28:31], v[140:143]
    ds_read_b128 v[4:7], v243 offset:2048
    v_mfma_f32_16x16x32_bf16 v[144:147], v[52:55], v[16:19], v[144:147]
    ds_read_b128 v[8:11], v243 offset:4096
    v_mfma_f32_16x16x32_bf16 v[148:151], v[52:55], v[20:23], v[148:151]
    ds_read_b128 v[12:15], v243 offset:6144
    v_mfma_f32_16x16x32_bf16 v[152:155], v[52:55], v[24:27], v[152:155]
    ds_read_b64_tr_b16 v[36:37], v249 offset:0
    v_mfma_f32_16x16x32_bf16 v[156:159], v[52:55], v[28:31], v[156:159]
    ds_read_b64_tr_b16 v[38:39], v249 offset:4096
    v_mfma_f32_16x16x32_bf16 v[160:163], v[56:59], v[16:19], v[160:163]
    ds_read_b64_tr_b16 v[40:41], v250 offset:0
    v_mfma_f32_16x16x32_bf16 v[164:167], v[56:59], v[20:23], v[164:167]
    ds_read_b64_tr_b16 v[42:43], v250 offset:4096
    v_mfma_f32_16x16x32_bf16 v[168:171], v[56:59], v[24:27], v[168:171]
    ds_read_b64_tr_b16 v[44:45], v251 offset:0
    v_mfma_f32_16x16x32_bf16 v[172:175], v[56:59], v[28:31], v[172:175]
    ds_read_b64_tr_b16 v[46:47], v251 offset:4096
    v_mfma_f32_16x16x32_bf16 v[176:179], v[60:63], v[16:19], v[176:179]
    v_mfma_f32_16x16x32_bf16 v[180:183], v[60:63], v[20:23], v[180:183]
    v_mfma_f32_16x16x32_bf16 v[184:187], v[60:63], v[24:27], v[184:187]
    v_mfma_f32_16x16x32_bf16 v[188:191], v[60:63], v[28:31], v[188:191]
    s_waitcnt lgkmcnt(0)
    .p2align 3
    v_mfma_f32_16x16x32_bf16 v[128:131], v[32:35], v[0:3], v[128:131]
    ds_read_b64_tr_b16 v[48:49], v248 offset:8192
    v_mfma_f32_16x16x32_bf16 v[132:135], v[32:35], v[4:7], v[132:135]
    ds_read_b64_tr_b16 v[50:51], v248 offset:12288
    v_mfma_f32_16x16x32_bf16 v[136:139], v[32:35], v[8:11], v[136:139]
    ds_read_b128 v[16:19], v243 offset:1024
    v_mfma_f32_16x16x32_bf16 v[140:143], v[32:35], v[12:15], v[140:143]
    ds_read_b128 v[20:23], v243 offset:3072
    v_mfma_f32_16x16x32_bf16 v[144:147], v[36:39], v[0:3], v[144:147]
    ds_read_b128 v[24:27], v243 offset:5120
    v_mfma_f32_16x16x32_bf16 v[148:151], v[36:39], v[4:7], v[148:151]
    ds_read_b128 v[28:31], v243 offset:7168
    v_mfma_f32_16x16x32_bf16 v[152:155], v[36:39], v[8:11], v[152:155]
    ds_read_b64_tr_b16 v[52:53], v249 offset:8192
    v_mfma_f32_16x16x32_bf16 v[156:159], v[36:39], v[12:15], v[156:159]
    ds_read_b64_tr_b16 v[54:55], v249 offset:12288
    v_mfma_f32_16x16x32_bf16 v[160:163], v[40:43], v[0:3], v[160:163]
    ds_read_b64_tr_b16 v[56:57], v250 offset:8192
    v_mfma_f32_16x16x32_bf16 v[164:167], v[40:43], v[4:7], v[164:167]
    ds_read_b64_tr_b16 v[58:59], v250 offset:12288
    v_mfma_f32_16x16x32_bf16 v[168:171], v[40:43], v[8:11], v[168:171]
    ds_read_b64_tr_b16 v[60:61], v251 offset:8192
    v_mfma_f32_16x16x32_bf16 v[172:175], v[40:43], v[12:15], v[172:175]
    ds_read_b64_tr_b16 v[62:63], v251 offset:12288
    v_mfma_f32_16x16x32_bf16 v[176:179], v[44:47], v[0:3], v[176:179]
    v_mfma_f32_16x16x32_bf16 v[180:183], v[44:47], v[4:7], v[180:183]
    v_mfma_f32_16x16x32_bf16 v[184:187], v[44:47], v[8:11], v[184:187]
    v_mfma_f32_16x16x32_bf16 v[188:191], v[44:47], v[12:15], v[188:191]
    s_waitcnt vmcnt(24) lgkmcnt(0)
    s_barrier
    .p2align 3
    v_mfma_f32_16x16x32_bf16 v[128:131], v[48:51], v[16:19], v[128:131]
    ds_read_b64_tr_b16 v[32:33], v248 offset:16384
    v_mfma_f32_16x16x32_bf16 v[132:135], v[48:51], v[20:23], v[132:135]
    ds_read_b64_tr_b16 v[34:35], v248 offset:20480
    v_mfma_f32_16x16x32_bf16 v[136:139], v[48:51], v[24:27], v[136:139]
    ds_read_b128 v[0:3], v243 offset:16384
    v_mfma_f32_16x16x32_bf16 v[140:143], v[48:51], v[28:31], v[140:143]
    ds_read_b128 v[4:7], v243 offset:18432
    v_mfma_f32_16x16x32_bf16 v[144:147], v[52:55], v[16:19], v[144:147]
    ds_read_b128 v[8:11], v243 offset:20480
    v_mfma_f32_16x16x32_bf16 v[148:151], v[52:55], v[20:23], v[148:151]
    ds_read_b128 v[12:15], v243 offset:22528
    v_mfma_f32_16x16x32_bf16 v[152:155], v[52:55], v[24:27], v[152:155]
    ds_read_b64_tr_b16 v[36:37], v249 offset:16384
    v_mfma_f32_16x16x32_bf16 v[156:159], v[52:55], v[28:31], v[156:159]
    ds_read_b64_tr_b16 v[38:39], v249 offset:20480
    v_mfma_f32_16x16x32_bf16 v[160:163], v[56:59], v[16:19], v[160:163]
    ds_read_b64_tr_b16 v[40:41], v250 offset:16384
    v_mfma_f32_16x16x32_bf16 v[164:167], v[56:59], v[20:23], v[164:167]
    ds_read_b64_tr_b16 v[42:43], v250 offset:20480
    v_mfma_f32_16x16x32_bf16 v[168:171], v[56:59], v[24:27], v[168:171]
    ds_read_b64_tr_b16 v[44:45], v251 offset:16384
    v_mfma_f32_16x16x32_bf16 v[172:175], v[56:59], v[28:31], v[172:175]
    ds_read_b64_tr_b16 v[46:47], v251 offset:20480
    v_mfma_f32_16x16x32_bf16 v[176:179], v[60:63], v[16:19], v[176:179]
    v_mfma_f32_16x16x32_bf16 v[180:183], v[60:63], v[20:23], v[180:183]
    v_mfma_f32_16x16x32_bf16 v[184:187], v[60:63], v[24:27], v[184:187]
    v_mfma_f32_16x16x32_bf16 v[188:191], v[60:63], v[28:31], v[188:191]
    s_waitcnt lgkmcnt(0)
    .p2align 3
    v_mfma_f32_16x16x32_bf16 v[128:131], v[32:35], v[0:3], v[128:131]
    ds_read_b64_tr_b16 v[48:49], v248 offset:24576
    v_mfma_f32_16x16x32_bf16 v[132:135], v[32:35], v[4:7], v[132:135]
    ds_read_b64_tr_b16 v[50:51], v248 offset:28672
    v_mfma_f32_16x16x32_bf16 v[136:139], v[32:35], v[8:11], v[136:139]
    ds_read_b128 v[16:19], v243 offset:17408
    v_mfma_f32_16x16x32_bf16 v[140:143], v[32:35], v[12:15], v[140:143]
    ds_read_b128 v[20:23], v243 offset:19456
    v_mfma_f32_16x16x32_bf16 v[144:147], v[36:39], v[0:3], v[144:147]
    ds_read_b128 v[24:27], v243 offset:21504
    v_mfma_f32_16x16x32_bf16 v[148:151], v[36:39], v[4:7], v[148:151]
    ds_read_b128 v[28:31], v243 offset:23552
    v_mfma_f32_16x16x32_bf16 v[152:155], v[36:39], v[8:11], v[152:155]
    ds_read_b64_tr_b16 v[52:53], v249 offset:24576
    v_mfma_f32_16x16x32_bf16 v[156:159], v[36:39], v[12:15], v[156:159]
    ds_read_b64_tr_b16 v[54:55], v249 offset:28672
    v_mfma_f32_16x16x32_bf16 v[160:163], v[40:43], v[0:3], v[160:163]
    ds_read_b64_tr_b16 v[56:57], v250 offset:24576
    v_mfma_f32_16x16x32_bf16 v[164:167], v[40:43], v[4:7], v[164:167]
    ds_read_b64_tr_b16 v[58:59], v250 offset:28672
    v_mfma_f32_16x16x32_bf16 v[168:171], v[40:43], v[8:11], v[168:171]
    ds_read_b64_tr_b16 v[60:61], v251 offset:24576
    v_mfma_f32_16x16x32_bf16 v[172:175], v[40:43], v[12:15], v[172:175]
    ds_read_b64_tr_b16 v[62:63], v251 offset:28672
    v_mfma_f32_16x16x32_bf16 v[176:179], v[44:47], v[0:3], v[176:179]
    v_mfma_f32_16x16x32_bf16 v[180:183], v[44:47], v[4:7], v[180:183]
    v_mfma_f32_16x16x32_bf16 v[184:187], v[44:47], v[8:11], v[184:187]
    v_mfma_f32_16x16x32_bf16 v[188:191], v[44:47], v[12:15], v[188:191]
    s_waitcnt vmcnt(16) lgkmcnt(0)
    s_barrier
    .p2align 3
    v_mfma_f32_16x16x32_bf16 v[128:131], v[48:51], v[16:19], v[128:131]
    ds_read_b64_tr_b16 v[32:33], v248 offset:32768
    v_mfma_f32_16x16x32_bf16 v[132:135], v[48:51], v[20:23], v[132:135]
    ds_read_b64_tr_b16 v[34:35], v248 offset:36864
    v_mfma_f32_16x16x32_bf16 v[136:139], v[48:51], v[24:27], v[136:139]
    ds_read_b128 v[0:3], v243 offset:32768
    v_mfma_f32_16x16x32_bf16 v[140:143], v[48:51], v[28:31], v[140:143]
    ds_read_b128 v[4:7], v243 offset:34816
    v_mfma_f32_16x16x32_bf16 v[144:147], v[52:55], v[16:19], v[144:147]
    ds_read_b128 v[8:11], v243 offset:36864
    v_mfma_f32_16x16x32_bf16 v[148:151], v[52:55], v[20:23], v[148:151]
    ds_read_b128 v[12:15], v243 offset:38912
    v_mfma_f32_16x16x32_bf16 v[152:155], v[52:55], v[24:27], v[152:155]
    ds_read_b64_tr_b16 v[36:37], v249 offset:32768
    v_mfma_f32_16x16x32_bf16 v[156:159], v[52:55], v[28:31], v[156:159]
    ds_read_b64_tr_b16 v[38:39], v249 offset:36864
    v_mfma_f32_16x16x32_bf16 v[160:163], v[56:59], v[16:19], v[160:163]
    ds_read_b64_tr_b16 v[40:41], v250 offset:32768
    v_mfma_f32_16x16x32_bf16 v[164:167], v[56:59], v[20:23], v[164:167]
    ds_read_b64_tr_b16 v[42:43], v250 offset:36864
    v_mfma_f32_16x16x32_bf16 v[168:171], v[56:59], v[24:27], v[168:171]
    ds_read_b64_tr_b16 v[44:45], v251 offset:32768
    v_mfma_f32_16x16x32_bf16 v[172:175], v[56:59], v[28:31], v[172:175]
    ds_read_b64_tr_b16 v[46:47], v251 offset:36864
    v_mfma_f32_16x16x32_bf16 v[176:179], v[60:63], v[16:19], v[176:179]
    v_mfma_f32_16x16x32_bf16 v[180:183], v[60:63], v[20:23], v[180:183]
    v_mfma_f32_16x16x32_bf16 v[184:187], v[60:63], v[24:27], v[184:187]
    v_mfma_f32_16x16x32_bf16 v[188:191], v[60:63], v[28:31], v[188:191]
    s_waitcnt lgkmcnt(0)
    .p2align 3
    v_mfma_f32_16x16x32_bf16 v[128:131], v[32:35], v[0:3], v[128:131]
    ds_read_b64_tr_b16 v[48:49], v248 offset:40960
    v_mfma_f32_16x16x32_bf16 v[132:135], v[32:35], v[4:7], v[132:135]
    ds_read_b64_tr_b16 v[50:51], v248 offset:45056
    v_mfma_f32_16x16x32_bf16 v[136:139], v[32:35], v[8:11], v[136:139]
    ds_read_b128 v[16:19], v243 offset:33792
    v_mfma_f32_16x16x32_bf16 v[140:143], v[32:35], v[12:15], v[140:143]
    ds_read_b128 v[20:23], v243 offset:35840
    v_mfma_f32_16x16x32_bf16 v[144:147], v[36:39], v[0:3], v[144:147]
    ds_read_b128 v[24:27], v243 offset:37888
    v_mfma_f32_16x16x32_bf16 v[148:151], v[36:39], v[4:7], v[148:151]
    ds_read_b128 v[28:31], v243 offset:39936
    v_mfma_f32_16x16x32_bf16 v[152:155], v[36:39], v[8:11], v[152:155]
    ds_read_b64_tr_b16 v[52:53], v249 offset:40960
    v_mfma_f32_16x16x32_bf16 v[156:159], v[36:39], v[12:15], v[156:159]
    ds_read_b64_tr_b16 v[54:55], v249 offset:45056
    v_mfma_f32_16x16x32_bf16 v[160:163], v[40:43], v[0:3], v[160:163]
    ds_read_b64_tr_b16 v[56:57], v250 offset:40960
    v_mfma_f32_16x16x32_bf16 v[164:167], v[40:43], v[4:7], v[164:167]
    ds_read_b64_tr_b16 v[58:59], v250 offset:45056
    v_mfma_f32_16x16x32_bf16 v[168:171], v[40:43], v[8:11], v[168:171]
    ds_read_b64_tr_b16 v[60:61], v251 offset:40960
    v_mfma_f32_16x16x32_bf16 v[172:175], v[40:43], v[12:15], v[172:175]
    ds_read_b64_tr_b16 v[62:63], v251 offset:45056
    v_mfma_f32_16x16x32_bf16 v[176:179], v[44:47], v[0:3], v[176:179]
    v_mfma_f32_16x16x32_bf16 v[180:183], v[44:47], v[4:7], v[180:183]
    v_mfma_f32_16x16x32_bf16 v[184:187], v[44:47], v[8:11], v[184:187]
    v_mfma_f32_16x16x32_bf16 v[188:191], v[44:47], v[12:15], v[188:191]
    s_waitcnt vmcnt(8) lgkmcnt(0)
    s_barrier
    .p2align 3
    v_mfma_f32_16x16x32_bf16 v[128:131], v[48:51], v[16:19], v[128:131]
    ds_read_b64_tr_b16 v[32:33], v244 offset:0
    v_mfma_f32_16x16x32_bf16 v[132:135], v[48:51], v[20:23], v[132:135]
    ds_read_b64_tr_b16 v[34:35], v244 offset:4096
    v_mfma_f32_16x16x32_bf16 v[136:139], v[48:51], v[24:27], v[136:139]
    ds_read_b128 v[0:3], v243 offset:0
    v_mfma_f32_16x16x32_bf16 v[140:143], v[48:51], v[28:31], v[140:143]
    ds_read_b128 v[4:7], v243 offset:2048
    v_mfma_f32_16x16x32_bf16 v[144:147], v[52:55], v[16:19], v[144:147]
    ds_read_b128 v[8:11], v243 offset:4096
    v_mfma_f32_16x16x32_bf16 v[148:151], v[52:55], v[20:23], v[148:151]
    ds_read_b128 v[12:15], v243 offset:6144
    v_mfma_f32_16x16x32_bf16 v[152:155], v[52:55], v[24:27], v[152:155]
    ds_read_b64_tr_b16 v[36:37], v245 offset:0
    v_mfma_f32_16x16x32_bf16 v[156:159], v[52:55], v[28:31], v[156:159]
    ds_read_b64_tr_b16 v[38:39], v245 offset:4096
    v_mfma_f32_16x16x32_bf16 v[160:163], v[56:59], v[16:19], v[160:163]
    ds_read_b64_tr_b16 v[40:41], v246 offset:0
    v_mfma_f32_16x16x32_bf16 v[164:167], v[56:59], v[20:23], v[164:167]
    ds_read_b64_tr_b16 v[42:43], v246 offset:4096
    v_mfma_f32_16x16x32_bf16 v[168:171], v[56:59], v[24:27], v[168:171]
    ds_read_b64_tr_b16 v[44:45], v247 offset:0
    v_mfma_f32_16x16x32_bf16 v[172:175], v[56:59], v[28:31], v[172:175]
    ds_read_b64_tr_b16 v[46:47], v247 offset:4096
    v_mfma_f32_16x16x32_bf16 v[176:179], v[60:63], v[16:19], v[176:179]
    v_mfma_f32_16x16x32_bf16 v[180:183], v[60:63], v[20:23], v[180:183]
    v_mfma_f32_16x16x32_bf16 v[184:187], v[60:63], v[24:27], v[184:187]
    v_mfma_f32_16x16x32_bf16 v[188:191], v[60:63], v[28:31], v[188:191]
    s_waitcnt lgkmcnt(0)
    .p2align 3
    v_mfma_f32_16x16x32_bf16 v[128:131], v[32:35], v[0:3], v[128:131]
    ds_read_b64_tr_b16 v[48:49], v244 offset:8192
    v_mfma_f32_16x16x32_bf16 v[132:135], v[32:35], v[4:7], v[132:135]
    ds_read_b64_tr_b16 v[50:51], v244 offset:12288
    v_mfma_f32_16x16x32_bf16 v[136:139], v[32:35], v[8:11], v[136:139]
    ds_read_b128 v[16:19], v243 offset:1024
    v_mfma_f32_16x16x32_bf16 v[140:143], v[32:35], v[12:15], v[140:143]
    ds_read_b128 v[20:23], v243 offset:3072
    v_mfma_f32_16x16x32_bf16 v[144:147], v[36:39], v[0:3], v[144:147]
    ds_read_b128 v[24:27], v243 offset:5120
    v_mfma_f32_16x16x32_bf16 v[148:151], v[36:39], v[4:7], v[148:151]
    ds_read_b128 v[28:31], v243 offset:7168
    v_mfma_f32_16x16x32_bf16 v[152:155], v[36:39], v[8:11], v[152:155]
    ds_read_b64_tr_b16 v[52:53], v245 offset:8192
    v_mfma_f32_16x16x32_bf16 v[156:159], v[36:39], v[12:15], v[156:159]
    ds_read_b64_tr_b16 v[54:55], v245 offset:12288
    v_mfma_f32_16x16x32_bf16 v[160:163], v[40:43], v[0:3], v[160:163]
    ds_read_b64_tr_b16 v[56:57], v246 offset:8192
    v_mfma_f32_16x16x32_bf16 v[164:167], v[40:43], v[4:7], v[164:167]
    ds_read_b64_tr_b16 v[58:59], v246 offset:12288
    v_mfma_f32_16x16x32_bf16 v[168:171], v[40:43], v[8:11], v[168:171]
    ds_read_b64_tr_b16 v[60:61], v247 offset:8192
    v_mfma_f32_16x16x32_bf16 v[172:175], v[40:43], v[12:15], v[172:175]
    ds_read_b64_tr_b16 v[62:63], v247 offset:12288
    v_mfma_f32_16x16x32_bf16 v[176:179], v[44:47], v[0:3], v[176:179]
    v_mfma_f32_16x16x32_bf16 v[180:183], v[44:47], v[4:7], v[180:183]
    v_mfma_f32_16x16x32_bf16 v[184:187], v[44:47], v[8:11], v[184:187]
    v_mfma_f32_16x16x32_bf16 v[188:191], v[44:47], v[12:15], v[188:191]
    s_waitcnt vmcnt(0) lgkmcnt(0)
    s_barrier
    .p2align 3
    v_mfma_f32_16x16x32_bf16 v[128:131], v[48:51], v[16:19], v[128:131]
    ds_read_b64_tr_b16 v[32:33], v244 offset:16384
    v_mfma_f32_16x16x32_bf16 v[132:135], v[48:51], v[20:23], v[132:135]
    ds_read_b64_tr_b16 v[34:35], v244 offset:20480
    v_mfma_f32_16x16x32_bf16 v[136:139], v[48:51], v[24:27], v[136:139]
    ds_read_b128 v[0:3], v243 offset:16384
    v_mfma_f32_16x16x32_bf16 v[140:143], v[48:51], v[28:31], v[140:143]
    ds_read_b128 v[4:7], v243 offset:18432
    v_mfma_f32_16x16x32_bf16 v[144:147], v[52:55], v[16:19], v[144:147]
    ds_read_b128 v[8:11], v243 offset:20480
    v_mfma_f32_16x16x32_bf16 v[148:151], v[52:55], v[20:23], v[148:151]
    ds_read_b128 v[12:15], v243 offset:22528
    v_mfma_f32_16x16x32_bf16 v[152:155], v[52:55], v[24:27], v[152:155]
    ds_read_b64_tr_b16 v[36:37], v245 offset:16384
    v_mfma_f32_16x16x32_bf16 v[156:159], v[52:55], v[28:31], v[156:159]
    ds_read_b64_tr_b16 v[38:39], v245 offset:20480
    v_mfma_f32_16x16x32_bf16 v[160:163], v[56:59], v[16:19], v[160:163]
    ds_read_b64_tr_b16 v[40:41], v246 offset:16384
    v_mfma_f32_16x16x32_bf16 v[164:167], v[56:59], v[20:23], v[164:167]
    ds_read_b64_tr_b16 v[42:43], v246 offset:20480
    v_mfma_f32_16x16x32_bf16 v[168:171], v[56:59], v[24:27], v[168:171]
    ds_read_b64_tr_b16 v[44:45], v247 offset:16384
    v_mfma_f32_16x16x32_bf16 v[172:175], v[56:59], v[28:31], v[172:175]
    ds_read_b64_tr_b16 v[46:47], v247 offset:20480
    v_mfma_f32_16x16x32_bf16 v[176:179], v[60:63], v[16:19], v[176:179]
    v_mfma_f32_16x16x32_bf16 v[180:183], v[60:63], v[20:23], v[180:183]
    v_mfma_f32_16x16x32_bf16 v[184:187], v[60:63], v[24:27], v[184:187]
    v_mfma_f32_16x16x32_bf16 v[188:191], v[60:63], v[28:31], v[188:191]
    s_waitcnt lgkmcnt(0)
    .p2align 3
    v_mfma_f32_16x16x32_bf16 v[128:131], v[32:35], v[0:3], v[128:131]
    ds_read_b64_tr_b16 v[48:49], v244 offset:24576
    v_mfma_f32_16x16x32_bf16 v[132:135], v[32:35], v[4:7], v[132:135]
    ds_read_b64_tr_b16 v[50:51], v244 offset:28672
    v_mfma_f32_16x16x32_bf16 v[136:139], v[32:35], v[8:11], v[136:139]
    ds_read_b128 v[16:19], v243 offset:17408
    v_mfma_f32_16x16x32_bf16 v[140:143], v[32:35], v[12:15], v[140:143]
    ds_read_b128 v[20:23], v243 offset:19456
    v_mfma_f32_16x16x32_bf16 v[144:147], v[36:39], v[0:3], v[144:147]
    ds_read_b128 v[24:27], v243 offset:21504
    v_mfma_f32_16x16x32_bf16 v[148:151], v[36:39], v[4:7], v[148:151]
    ds_read_b128 v[28:31], v243 offset:23552
    v_mfma_f32_16x16x32_bf16 v[152:155], v[36:39], v[8:11], v[152:155]
    ds_read_b64_tr_b16 v[52:53], v245 offset:24576
    v_mfma_f32_16x16x32_bf16 v[156:159], v[36:39], v[12:15], v[156:159]
    ds_read_b64_tr_b16 v[54:55], v245 offset:28672
    v_mfma_f32_16x16x32_bf16 v[160:163], v[40:43], v[0:3], v[160:163]
    ds_read_b64_tr_b16 v[56:57], v246 offset:24576
    v_mfma_f32_16x16x32_bf16 v[164:167], v[40:43], v[4:7], v[164:167]
    ds_read_b64_tr_b16 v[58:59], v246 offset:28672
    v_mfma_f32_16x16x32_bf16 v[168:171], v[40:43], v[8:11], v[168:171]
    ds_read_b64_tr_b16 v[60:61], v247 offset:24576
    v_mfma_f32_16x16x32_bf16 v[172:175], v[40:43], v[12:15], v[172:175]
    ds_read_b64_tr_b16 v[62:63], v247 offset:28672
    v_mfma_f32_16x16x32_bf16 v[176:179], v[44:47], v[0:3], v[176:179]
    v_mfma_f32_16x16x32_bf16 v[180:183], v[44:47], v[4:7], v[180:183]
    v_mfma_f32_16x16x32_bf16 v[184:187], v[44:47], v[8:11], v[184:187]
    v_mfma_f32_16x16x32_bf16 v[188:191], v[44:47], v[12:15], v[188:191]
    s_waitcnt lgkmcnt(0)
    s_barrier
    .p2align 3
    v_mfma_f32_16x16x32_bf16 v[128:131], v[48:51], v[16:19], v[128:131]
    ds_read_b64_tr_b16 v[32:33], v244 offset:32768
    v_mfma_f32_16x16x32_bf16 v[132:135], v[48:51], v[20:23], v[132:135]
    ds_read_b64_tr_b16 v[34:35], v244 offset:36864
    v_mfma_f32_16x16x32_bf16 v[136:139], v[48:51], v[24:27], v[136:139]
    ds_read_b128 v[0:3], v243 offset:32768
    v_mfma_f32_16x16x32_bf16 v[140:143], v[48:51], v[28:31], v[140:143]
    ds_read_b128 v[4:7], v243 offset:34816
    v_mfma_f32_16x16x32_bf16 v[144:147], v[52:55], v[16:19], v[144:147]
    ds_read_b128 v[8:11], v243 offset:36864
    v_mfma_f32_16x16x32_bf16 v[148:151], v[52:55], v[20:23], v[148:151]
    ds_read_b128 v[12:15], v243 offset:38912
    v_mfma_f32_16x16x32_bf16 v[152:155], v[52:55], v[24:27], v[152:155]
    ds_read_b64_tr_b16 v[36:37], v245 offset:32768
    v_mfma_f32_16x16x32_bf16 v[156:159], v[52:55], v[28:31], v[156:159]
    ds_read_b64_tr_b16 v[38:39], v245 offset:36864
    v_mfma_f32_16x16x32_bf16 v[160:163], v[56:59], v[16:19], v[160:163]
    ds_read_b64_tr_b16 v[40:41], v246 offset:32768
    v_mfma_f32_16x16x32_bf16 v[164:167], v[56:59], v[20:23], v[164:167]
    ds_read_b64_tr_b16 v[42:43], v246 offset:36864
    v_mfma_f32_16x16x32_bf16 v[168:171], v[56:59], v[24:27], v[168:171]
    ds_read_b64_tr_b16 v[44:45], v247 offset:32768
    v_mfma_f32_16x16x32_bf16 v[172:175], v[56:59], v[28:31], v[172:175]
    ds_read_b64_tr_b16 v[46:47], v247 offset:36864
    v_mfma_f32_16x16x32_bf16 v[176:179], v[60:63], v[16:19], v[176:179]
    v_mfma_f32_16x16x32_bf16 v[180:183], v[60:63], v[20:23], v[180:183]
    s_sub_u32 s58, s58, 1
    s_cmp_lg_u32 s58, 0
    .p2align 3
    v_mfma_f32_16x16x32_bf16 v[184:187], v[60:63], v[24:27], v[184:187]
    v_mfma_f32_16x16x32_bf16 v[188:191], v[60:63], v[28:31], v[188:191]
    s_cbranch_scc1 loop_21
    s_waitcnt lgkmcnt(0)
    .p2align 3
    v_mfma_f32_16x16x32_bf16 v[128:131], v[32:35], v[0:3], v[128:131]
    ds_read_b64_tr_b16 v[48:49], v244 offset:40960
    v_mfma_f32_16x16x32_bf16 v[132:135], v[32:35], v[4:7], v[132:135]
    ds_read_b64_tr_b16 v[50:51], v244 offset:45056
    v_mfma_f32_16x16x32_bf16 v[136:139], v[32:35], v[8:11], v[136:139]
    ds_read_b128 v[16:19], v243 offset:33792
    v_mfma_f32_16x16x32_bf16 v[140:143], v[32:35], v[12:15], v[140:143]
    ds_read_b128 v[20:23], v243 offset:35840
    v_mfma_f32_16x16x32_bf16 v[144:147], v[36:39], v[0:3], v[144:147]
    ds_read_b128 v[24:27], v243 offset:37888
    v_mfma_f32_16x16x32_bf16 v[148:151], v[36:39], v[4:7], v[148:151]
    ds_read_b128 v[28:31], v243 offset:39936
    v_mfma_f32_16x16x32_bf16 v[152:155], v[36:39], v[8:11], v[152:155]
    ds_read_b64_tr_b16 v[52:53], v245 offset:40960
    v_mfma_f32_16x16x32_bf16 v[156:159], v[36:39], v[12:15], v[156:159]
    ds_read_b64_tr_b16 v[54:55], v245 offset:45056
    v_mfma_f32_16x16x32_bf16 v[160:163], v[40:43], v[0:3], v[160:163]
    ds_read_b64_tr_b16 v[56:57], v246 offset:40960
    v_mfma_f32_16x16x32_bf16 v[164:167], v[40:43], v[4:7], v[164:167]
    ds_read_b64_tr_b16 v[58:59], v246 offset:45056
    v_mfma_f32_16x16x32_bf16 v[168:171], v[40:43], v[8:11], v[168:171]
    ds_read_b64_tr_b16 v[60:61], v247 offset:40960
    v_mfma_f32_16x16x32_bf16 v[172:175], v[40:43], v[12:15], v[172:175]
    ds_read_b64_tr_b16 v[62:63], v247 offset:45056
    v_mfma_f32_16x16x32_bf16 v[176:179], v[44:47], v[0:3], v[176:179]
    v_mfma_f32_16x16x32_bf16 v[180:183], v[44:47], v[4:7], v[180:183]
    v_mfma_f32_16x16x32_bf16 v[184:187], v[44:47], v[8:11], v[184:187]
    v_mfma_f32_16x16x32_bf16 v[188:191], v[44:47], v[12:15], v[188:191]
    s_waitcnt lgkmcnt(0)
    s_barrier
    .p2align 3
    v_mfma_f32_16x16x32_bf16 v[128:131], v[48:51], v[16:19], v[128:131]
    ds_read_b64_tr_b16 v[32:33], v248 offset:0
    v_mfma_f32_16x16x32_bf16 v[132:135], v[48:51], v[20:23], v[132:135]
    ds_read_b64_tr_b16 v[34:35], v248 offset:4096
    v_mfma_f32_16x16x32_bf16 v[136:139], v[48:51], v[24:27], v[136:139]
    ds_read_b128 v[0:3], v243 offset:0
    v_mfma_f32_16x16x32_bf16 v[140:143], v[48:51], v[28:31], v[140:143]
    ds_read_b128 v[4:7], v243 offset:2048
    v_mfma_f32_16x16x32_bf16 v[144:147], v[52:55], v[16:19], v[144:147]
    ds_read_b128 v[8:11], v243 offset:4096
    v_mfma_f32_16x16x32_bf16 v[148:151], v[52:55], v[20:23], v[148:151]
    ds_read_b128 v[12:15], v243 offset:6144
    v_mfma_f32_16x16x32_bf16 v[152:155], v[52:55], v[24:27], v[152:155]
    ds_read_b64_tr_b16 v[36:37], v249 offset:0
    v_mfma_f32_16x16x32_bf16 v[156:159], v[52:55], v[28:31], v[156:159]
    ds_read_b64_tr_b16 v[38:39], v249 offset:4096
    v_mfma_f32_16x16x32_bf16 v[160:163], v[56:59], v[16:19], v[160:163]
    ds_read_b64_tr_b16 v[40:41], v250 offset:0
    v_mfma_f32_16x16x32_bf16 v[164:167], v[56:59], v[20:23], v[164:167]
    ds_read_b64_tr_b16 v[42:43], v250 offset:4096
    v_mfma_f32_16x16x32_bf16 v[168:171], v[56:59], v[24:27], v[168:171]
    ds_read_b64_tr_b16 v[44:45], v251 offset:0
    v_mfma_f32_16x16x32_bf16 v[172:175], v[56:59], v[28:31], v[172:175]
    ds_read_b64_tr_b16 v[46:47], v251 offset:4096
    v_mfma_f32_16x16x32_bf16 v[176:179], v[60:63], v[16:19], v[176:179]
    v_mfma_f32_16x16x32_bf16 v[180:183], v[60:63], v[20:23], v[180:183]
    v_mfma_f32_16x16x32_bf16 v[184:187], v[60:63], v[24:27], v[184:187]
    v_mfma_f32_16x16x32_bf16 v[188:191], v[60:63], v[28:31], v[188:191]
    s_waitcnt lgkmcnt(0)
    .p2align 3
    v_mfma_f32_16x16x32_bf16 v[128:131], v[32:35], v[0:3], v[128:131]
    ds_read_b64_tr_b16 v[48:49], v248 offset:8192
    v_mfma_f32_16x16x32_bf16 v[132:135], v[32:35], v[4:7], v[132:135]
    ds_read_b64_tr_b16 v[50:51], v248 offset:12288
    v_mfma_f32_16x16x32_bf16 v[136:139], v[32:35], v[8:11], v[136:139]
    ds_read_b128 v[16:19], v243 offset:1024
    v_mfma_f32_16x16x32_bf16 v[140:143], v[32:35], v[12:15], v[140:143]
    ds_read_b128 v[20:23], v243 offset:3072
    v_mfma_f32_16x16x32_bf16 v[144:147], v[36:39], v[0:3], v[144:147]
    ds_read_b128 v[24:27], v243 offset:5120
    v_mfma_f32_16x16x32_bf16 v[148:151], v[36:39], v[4:7], v[148:151]
    ds_read_b128 v[28:31], v243 offset:7168
    v_mfma_f32_16x16x32_bf16 v[152:155], v[36:39], v[8:11], v[152:155]
    ds_read_b64_tr_b16 v[52:53], v249 offset:8192
    v_mfma_f32_16x16x32_bf16 v[156:159], v[36:39], v[12:15], v[156:159]
    ds_read_b64_tr_b16 v[54:55], v249 offset:12288
    v_mfma_f32_16x16x32_bf16 v[160:163], v[40:43], v[0:3], v[160:163]
    ds_read_b64_tr_b16 v[56:57], v250 offset:8192
    v_mfma_f32_16x16x32_bf16 v[164:167], v[40:43], v[4:7], v[164:167]
    ds_read_b64_tr_b16 v[58:59], v250 offset:12288
    v_mfma_f32_16x16x32_bf16 v[168:171], v[40:43], v[8:11], v[168:171]
    ds_read_b64_tr_b16 v[60:61], v251 offset:8192
    v_mfma_f32_16x16x32_bf16 v[172:175], v[40:43], v[12:15], v[172:175]
    ds_read_b64_tr_b16 v[62:63], v251 offset:12288
    v_mfma_f32_16x16x32_bf16 v[176:179], v[44:47], v[0:3], v[176:179]
    v_mfma_f32_16x16x32_bf16 v[180:183], v[44:47], v[4:7], v[180:183]
    v_mfma_f32_16x16x32_bf16 v[184:187], v[44:47], v[8:11], v[184:187]
    v_mfma_f32_16x16x32_bf16 v[188:191], v[44:47], v[12:15], v[188:191]
    s_waitcnt lgkmcnt(0)
    s_barrier
    .p2align 3
    v_mfma_f32_16x16x32_bf16 v[128:131], v[48:51], v[16:19], v[128:131]
    ds_read_b64_tr_b16 v[32:33], v248 offset:16384
    v_mfma_f32_16x16x32_bf16 v[132:135], v[48:51], v[20:23], v[132:135]
    ds_read_b64_tr_b16 v[34:35], v248 offset:20480
    v_mfma_f32_16x16x32_bf16 v[136:139], v[48:51], v[24:27], v[136:139]
    ds_read_b128 v[0:3], v243 offset:16384
    v_mfma_f32_16x16x32_bf16 v[140:143], v[48:51], v[28:31], v[140:143]
    ds_read_b128 v[4:7], v243 offset:18432
    v_mfma_f32_16x16x32_bf16 v[144:147], v[52:55], v[16:19], v[144:147]
    ds_read_b128 v[8:11], v243 offset:20480
    v_mfma_f32_16x16x32_bf16 v[148:151], v[52:55], v[20:23], v[148:151]
    ds_read_b128 v[12:15], v243 offset:22528
    v_mfma_f32_16x16x32_bf16 v[152:155], v[52:55], v[24:27], v[152:155]
    ds_read_b64_tr_b16 v[36:37], v249 offset:16384
    v_mfma_f32_16x16x32_bf16 v[156:159], v[52:55], v[28:31], v[156:159]
    ds_read_b64_tr_b16 v[38:39], v249 offset:20480
    v_mfma_f32_16x16x32_bf16 v[160:163], v[56:59], v[16:19], v[160:163]
    ds_read_b64_tr_b16 v[40:41], v250 offset:16384
    v_mfma_f32_16x16x32_bf16 v[164:167], v[56:59], v[20:23], v[164:167]
    ds_read_b64_tr_b16 v[42:43], v250 offset:20480
    v_mfma_f32_16x16x32_bf16 v[168:171], v[56:59], v[24:27], v[168:171]
    ds_read_b64_tr_b16 v[44:45], v251 offset:16384
    v_mfma_f32_16x16x32_bf16 v[172:175], v[56:59], v[28:31], v[172:175]
    ds_read_b64_tr_b16 v[46:47], v251 offset:20480
    v_mfma_f32_16x16x32_bf16 v[176:179], v[60:63], v[16:19], v[176:179]
    v_mfma_f32_16x16x32_bf16 v[180:183], v[60:63], v[20:23], v[180:183]
    v_mfma_f32_16x16x32_bf16 v[184:187], v[60:63], v[24:27], v[184:187]
    v_mfma_f32_16x16x32_bf16 v[188:191], v[60:63], v[28:31], v[188:191]
    s_waitcnt lgkmcnt(0)
    .p2align 3
    v_mfma_f32_16x16x32_bf16 v[128:131], v[32:35], v[0:3], v[128:131]
    ds_read_b64_tr_b16 v[48:49], v248 offset:24576
    v_mfma_f32_16x16x32_bf16 v[132:135], v[32:35], v[4:7], v[132:135]
    ds_read_b64_tr_b16 v[50:51], v248 offset:28672
    v_mfma_f32_16x16x32_bf16 v[136:139], v[32:35], v[8:11], v[136:139]
    ds_read_b128 v[16:19], v243 offset:17408
    v_mfma_f32_16x16x32_bf16 v[140:143], v[32:35], v[12:15], v[140:143]
    ds_read_b128 v[20:23], v243 offset:19456
    v_mfma_f32_16x16x32_bf16 v[144:147], v[36:39], v[0:3], v[144:147]
    ds_read_b128 v[24:27], v243 offset:21504
    v_mfma_f32_16x16x32_bf16 v[148:151], v[36:39], v[4:7], v[148:151]
    ds_read_b128 v[28:31], v243 offset:23552
    v_mfma_f32_16x16x32_bf16 v[152:155], v[36:39], v[8:11], v[152:155]
    ds_read_b64_tr_b16 v[52:53], v249 offset:24576
    v_mfma_f32_16x16x32_bf16 v[156:159], v[36:39], v[12:15], v[156:159]
    ds_read_b64_tr_b16 v[54:55], v249 offset:28672
    v_mfma_f32_16x16x32_bf16 v[160:163], v[40:43], v[0:3], v[160:163]
    ds_read_b64_tr_b16 v[56:57], v250 offset:24576
    v_mfma_f32_16x16x32_bf16 v[164:167], v[40:43], v[4:7], v[164:167]
    ds_read_b64_tr_b16 v[58:59], v250 offset:28672
    v_mfma_f32_16x16x32_bf16 v[168:171], v[40:43], v[8:11], v[168:171]
    ds_read_b64_tr_b16 v[60:61], v251 offset:24576
    v_mfma_f32_16x16x32_bf16 v[172:175], v[40:43], v[12:15], v[172:175]
    ds_read_b64_tr_b16 v[62:63], v251 offset:28672
    v_mfma_f32_16x16x32_bf16 v[176:179], v[44:47], v[0:3], v[176:179]
    v_mfma_f32_16x16x32_bf16 v[180:183], v[44:47], v[4:7], v[180:183]
    v_mfma_f32_16x16x32_bf16 v[184:187], v[44:47], v[8:11], v[184:187]
    v_mfma_f32_16x16x32_bf16 v[188:191], v[44:47], v[12:15], v[188:191]
    s_waitcnt lgkmcnt(0)
    s_barrier
    .p2align 3
    v_mfma_f32_16x16x32_bf16 v[128:131], v[48:51], v[16:19], v[128:131]
    ds_read_b64_tr_b16 v[32:33], v248 offset:32768
    v_mfma_f32_16x16x32_bf16 v[132:135], v[48:51], v[20:23], v[132:135]
    ds_read_b64_tr_b16 v[34:35], v248 offset:36864
    v_mfma_f32_16x16x32_bf16 v[136:139], v[48:51], v[24:27], v[136:139]
    ds_read_b128 v[0:3], v243 offset:32768
    v_mfma_f32_16x16x32_bf16 v[140:143], v[48:51], v[28:31], v[140:143]
    ds_read_b128 v[4:7], v243 offset:34816
    v_mfma_f32_16x16x32_bf16 v[144:147], v[52:55], v[16:19], v[144:147]
    ds_read_b128 v[8:11], v243 offset:36864
    v_mfma_f32_16x16x32_bf16 v[148:151], v[52:55], v[20:23], v[148:151]
    ds_read_b128 v[12:15], v243 offset:38912
    v_mfma_f32_16x16x32_bf16 v[152:155], v[52:55], v[24:27], v[152:155]
    ds_read_b64_tr_b16 v[36:37], v249 offset:32768
    v_mfma_f32_16x16x32_bf16 v[156:159], v[52:55], v[28:31], v[156:159]
    ds_read_b64_tr_b16 v[38:39], v249 offset:36864
    v_mfma_f32_16x16x32_bf16 v[160:163], v[56:59], v[16:19], v[160:163]
    ds_read_b64_tr_b16 v[40:41], v250 offset:32768
    v_mfma_f32_16x16x32_bf16 v[164:167], v[56:59], v[20:23], v[164:167]
    ds_read_b64_tr_b16 v[42:43], v250 offset:36864
    v_mfma_f32_16x16x32_bf16 v[168:171], v[56:59], v[24:27], v[168:171]
    ds_read_b64_tr_b16 v[44:45], v251 offset:32768
    v_mfma_f32_16x16x32_bf16 v[172:175], v[56:59], v[28:31], v[172:175]
    ds_read_b64_tr_b16 v[46:47], v251 offset:36864
    v_mfma_f32_16x16x32_bf16 v[176:179], v[60:63], v[16:19], v[176:179]
    v_mfma_f32_16x16x32_bf16 v[180:183], v[60:63], v[20:23], v[180:183]
    v_mfma_f32_16x16x32_bf16 v[184:187], v[60:63], v[24:27], v[184:187]
    v_mfma_f32_16x16x32_bf16 v[188:191], v[60:63], v[28:31], v[188:191]
    s_waitcnt lgkmcnt(0)
    .p2align 3
    v_mfma_f32_16x16x32_bf16 v[128:131], v[32:35], v[0:3], v[128:131]
    ds_read_b64_tr_b16 v[48:49], v248 offset:40960
    v_mfma_f32_16x16x32_bf16 v[132:135], v[32:35], v[4:7], v[132:135]
    ds_read_b64_tr_b16 v[50:51], v248 offset:45056
    v_mfma_f32_16x16x32_bf16 v[136:139], v[32:35], v[8:11], v[136:139]
    ds_read_b128 v[16:19], v243 offset:33792
    v_mfma_f32_16x16x32_bf16 v[140:143], v[32:35], v[12:15], v[140:143]
    ds_read_b128 v[20:23], v243 offset:35840
    v_mfma_f32_16x16x32_bf16 v[144:147], v[36:39], v[0:3], v[144:147]
    ds_read_b128 v[24:27], v243 offset:37888
    v_mfma_f32_16x16x32_bf16 v[148:151], v[36:39], v[4:7], v[148:151]
    ds_read_b128 v[28:31], v243 offset:39936
    v_mfma_f32_16x16x32_bf16 v[152:155], v[36:39], v[8:11], v[152:155]
    ds_read_b64_tr_b16 v[52:53], v249 offset:40960
    v_mfma_f32_16x16x32_bf16 v[156:159], v[36:39], v[12:15], v[156:159]
    ds_read_b64_tr_b16 v[54:55], v249 offset:45056
    v_mfma_f32_16x16x32_bf16 v[160:163], v[40:43], v[0:3], v[160:163]
    ds_read_b64_tr_b16 v[56:57], v250 offset:40960
    v_mfma_f32_16x16x32_bf16 v[164:167], v[40:43], v[4:7], v[164:167]
    ds_read_b64_tr_b16 v[58:59], v250 offset:45056
    v_mfma_f32_16x16x32_bf16 v[168:171], v[40:43], v[8:11], v[168:171]
    ds_read_b64_tr_b16 v[60:61], v251 offset:40960
    v_mfma_f32_16x16x32_bf16 v[172:175], v[40:43], v[12:15], v[172:175]
    ds_read_b64_tr_b16 v[62:63], v251 offset:45056
    v_mfma_f32_16x16x32_bf16 v[176:179], v[44:47], v[0:3], v[176:179]
    v_mfma_f32_16x16x32_bf16 v[180:183], v[44:47], v[4:7], v[180:183]
    v_mfma_f32_16x16x32_bf16 v[184:187], v[44:47], v[8:11], v[184:187]
    v_mfma_f32_16x16x32_bf16 v[188:191], v[44:47], v[12:15], v[188:191]
    s_waitcnt lgkmcnt(0)
    s_barrier
    .p2align 3
    v_mfma_f32_16x16x32_bf16 v[128:131], v[48:51], v[16:19], v[128:131]
    v_mfma_f32_16x16x32_bf16 v[132:135], v[48:51], v[20:23], v[132:135]
    v_mfma_f32_16x16x32_bf16 v[136:139], v[48:51], v[24:27], v[136:139]
    v_mfma_f32_16x16x32_bf16 v[140:143], v[48:51], v[28:31], v[140:143]
    v_mfma_f32_16x16x32_bf16 v[144:147], v[52:55], v[16:19], v[144:147]
    v_mfma_f32_16x16x32_bf16 v[148:151], v[52:55], v[20:23], v[148:151]
    v_mfma_f32_16x16x32_bf16 v[152:155], v[52:55], v[24:27], v[152:155]
    v_mfma_f32_16x16x32_bf16 v[156:159], v[52:55], v[28:31], v[156:159]
    v_mfma_f32_16x16x32_bf16 v[160:163], v[56:59], v[16:19], v[160:163]
    v_mfma_f32_16x16x32_bf16 v[164:167], v[56:59], v[20:23], v[164:167]
    v_mfma_f32_16x16x32_bf16 v[168:171], v[56:59], v[24:27], v[168:171]
    v_mfma_f32_16x16x32_bf16 v[172:175], v[56:59], v[28:31], v[172:175]
    v_mfma_f32_16x16x32_bf16 v[176:179], v[60:63], v[16:19], v[176:179]
    v_mfma_f32_16x16x32_bf16 v[180:183], v[60:63], v[20:23], v[180:183]
    v_mfma_f32_16x16x32_bf16 v[184:187], v[60:63], v[24:27], v[184:187]
    v_mfma_f32_16x16x32_bf16 v[188:191], v[60:63], v[28:31], v[188:191]
    s_nop 7
    v_cvt_pk_bf16_f32 v64, v160, v161
    v_cvt_pk_bf16_f32 v65, v162, v163
    v_cvt_pk_bf16_f32 v66, v176, v177
    v_cvt_pk_bf16_f32 v67, v178, v179
    v_min_u32 v64, -2, v64
    v_min_u32 v65, -2, v65
    v_min_u32 v66, -2, v66
    v_min_u32 v67, -2, v67
    buffer_store_dwordx4 v[64:67], v254, s[4:7], s62 offen offset:0 sc0 sc1
    v_cvt_pk_bf16_f32 v68, v164, v165
    v_cvt_pk_bf16_f32 v69, v166, v167
    v_cvt_pk_bf16_f32 v70, v180, v181
    v_cvt_pk_bf16_f32 v71, v182, v183
    v_min_u32 v68, -2, v68
    v_min_u32 v69, -2, v69
    v_min_u32 v70, -2, v70
    v_min_u32 v71, -2, v71
    buffer_store_dwordx4 v[68:71], v254, s[4:7], s62 offen offset:1024 sc0 sc1
    v_cvt_pk_bf16_f32 v72, v168, v169
    v_cvt_pk_bf16_f32 v73, v170, v171
    v_cvt_pk_bf16_f32 v74, v184, v185
    v_cvt_pk_bf16_f32 v75, v186, v187
    v_min_u32 v72, -2, v72
    v_min_u32 v73, -2, v73
    v_min_u32 v74, -2, v74
    v_min_u32 v75, -2, v75
    buffer_store_dwordx4 v[72:75], v254, s[4:7], s62 offen offset:2048 sc0 sc1
    v_cvt_pk_bf16_f32 v76, v172, v173
    v_cvt_pk_bf16_f32 v77, v174, v175
    v_cvt_pk_bf16_f32 v78, v188, v189
    v_cvt_pk_bf16_f32 v79, v190, v191
    v_min_u32 v76, -2, v76
    v_min_u32 v77, -2, v77
    v_min_u32 v78, -2, v78
    v_min_u32 v79, -2, v79
    buffer_store_dwordx4 v[76:79], v254, s[4:7], s62 offen offset:3072 sc0 sc1
    s_mov_b32 s56, 262144
poll_22:
    buffer_load_dwordx4 v[80:83], v254, s[4:7], s63 offen offset:0 sc0 sc1
    buffer_load_dwordx4 v[84:87], v254, s[4:7], s63 offen offset:1024 sc0 sc1
    buffer_load_dwordx4 v[88:91], v254, s[4:7], s63 offen offset:2048 sc0 sc1
    buffer_load_dwordx4 v[92:95], v254, s[4:7], s63 offen offset:3072 sc0 sc1
    s_waitcnt vmcnt(0)
    v_max3_u32 v192, v80, v81, v82
    v_max3_u32 v193, v83, v84, v85
    v_max3_u32 v192, v192, v86, v87
    v_max3_u32 v193, v193, v88, v89
    v_max3_u32 v192, v192, v90, v91
    v_max3_u32 v193, v193, v92, v93
    v_max3_u32 v192, v192, v94, v95
    v_max_u32 v192, v192, v193
    v_cmp_eq_u32 vcc, -1, v192
    s_cbranch_vccz pd_23
    s_sub_u32 s56, s56, 1
    s_cmp_lg_u32 s56, 0
    s_cbranch_scc1 poll_22
pd_23:
    v_lshlrev_b32 v160, 16, v80
    v_and_b32 v161, 0xffff0000, v80
    v_lshlrev_b32 v162, 16, v81
    v_and_b32 v163, 0xffff0000, v81
    v_pk_add_f32 v[128:129], v[128:129], v[160:161]
    v_pk_add_f32 v[130:131], v[130:131], v[162:163]
    v_lshlrev_b32 v160, 16, v82
    v_and_b32 v161, 0xffff0000, v82
    v_lshlrev_b32 v162, 16, v83
    v_and_b32 v163, 0xffff0000, v83
    v_pk_add_f32 v[144:145], v[144:145], v[160:161]
    v_pk_add_f32 v[146:147], v[146:147], v[162:163]
    v_lshlrev_b32 v160, 16, v84
    v_and_b32 v161, 0xffff0000, v84
    v_lshlrev_b32 v162, 16, v85
    v_and_b32 v163, 0xffff0000, v85
    v_pk_add_f32 v[132:133], v[132:133], v[160:161]
    v_pk_add_f32 v[134:135], v[134:135], v[162:163]
    v_lshlrev_b32 v160, 16, v86
    v_and_b32 v161, 0xffff0000, v86
    v_lshlrev_b32 v162, 16, v87
    v_and_b32 v163, 0xffff0000, v87
    v_pk_add_f32 v[148:149], v[148:149], v[160:161]
    v_pk_add_f32 v[150:151], v[150:151], v[162:163]
    v_lshlrev_b32 v160, 16, v88
    v_and_b32 v161, 0xffff0000, v88
    v_lshlrev_b32 v162, 16, v89
    v_and_b32 v163, 0xffff0000, v89
    v_pk_add_f32 v[136:137], v[136:137], v[160:161]
    v_pk_add_f32 v[138:139], v[138:139], v[162:163]
    v_lshlrev_b32 v160, 16, v90
    v_and_b32 v161, 0xffff0000, v90
    v_lshlrev_b32 v162, 16, v91
    v_and_b32 v163, 0xffff0000, v91
    v_pk_add_f32 v[152:153], v[152:153], v[160:161]
    v_pk_add_f32 v[154:155], v[154:155], v[162:163]
    v_lshlrev_b32 v160, 16, v92
    v_and_b32 v161, 0xffff0000, v92
    v_lshlrev_b32 v162, 16, v93
    v_and_b32 v163, 0xffff0000, v93
    v_pk_add_f32 v[140:141], v[140:141], v[160:161]
    v_pk_add_f32 v[142:143], v[142:143], v[162:163]
    v_lshlrev_b32 v160, 16, v94
    v_and_b32 v161, 0xffff0000, v94
    v_lshlrev_b32 v162, 16, v95
    v_and_b32 v163, 0xffff0000, v95
    v_pk_add_f32 v[156:157], v[156:157], v[160:161]
    v_pk_add_f32 v[158:159], v[158:159], v[162:163]
    s_cmp_lg_u32 s46, 0
    s_cbranch_scc1 X_fin
    s_lshl_b32 s55, s51, 14
    s_lshl_b32 s56, s43, 13
    s_add_u32 s55, s55, s56
    s_lshl_b32 s56, s44, 10
    s_add_u32 s55, s55, s56
    s_add_u32 s59, s55, s48
    s_add_u32 s60, s59, 4096
    v_cvt_pk_bf16_f32 v236, v128, v129
    v_cvt_pk_bf16_f32 v237, v130, v131
    v_cvt_pk_bf16_f32 v238, v144, v145
    v_cvt_pk_bf16_f32 v239, v146, v147
    buffer_store_dwordx4 v[236:239], v254, s[4:7], s59 offen offset:0 sc0 sc1
    v_cvt_pk_bf16_f32 v240, v132, v133
    v_cvt_pk_bf16_f32 v241, v134, v135
    v_cvt_pk_bf16_f32 v242, v148, v149
    v_cvt_pk_bf16_f32 v243, v150, v151
    buffer_store_dwordx4 v[240:243], v254, s[4:7], s59 offen offset:2048 sc0 sc1
    v_cvt_pk_bf16_f32 v244, v136, v137
    v_cvt_pk_bf16_f32 v245, v138, v139
    v_cvt_pk_bf16_f32 v246, v152, v153
    v_cvt_pk_bf16_f32 v247, v154, v155
    buffer_store_dwordx4 v[244:247], v254, s[4:7], s60 offen offset:0 sc0 sc1
    v_cvt_pk_bf16_f32 v248, v140, v141
    v_cvt_pk_bf16_f32 v249, v142, v143
    v_cvt_pk_bf16_f32 v250, v156, v157
    v_cvt_pk_bf16_f32 v251, v158, v159
    buffer_store_dwordx4 v[248:251], v254, s[4:7], s60 offen offset:2048 sc0 sc1
    v_mov_b32 v234, 0x3f803f80
    v_mov_b32 v226, 0
    v_mov_b32 v230, 0
    v_mov_b32 v227, 0
    v_mov_b32 v231, 0
    v_mov_b32 v228, 0
    v_mov_b32 v232, 0
    v_mov_b32 v229, 0
    v_mov_b32 v233, 0
    v_dot2_f32_bf16 v226, v236, v234, v226
    v_dot2_f32_bf16 v230, v236, v236, v230
    v_dot2_f32_bf16 v227, v240, v234, v227
    v_dot2_f32_bf16 v231, v240, v240, v231
    v_dot2_f32_bf16 v228, v244, v234, v228
    v_dot2_f32_bf16 v232, v244, v244, v232
    v_dot2_f32_bf16 v229, v248, v234, v229
    v_dot2_f32_bf16 v233, v248, v248, v233
    v_dot2_f32_bf16 v226, v237, v234, v226
    v_dot2_f32_bf16 v230, v237, v237, v230
    v_dot2_f32_bf16 v227, v241, v234, v227
    v_dot2_f32_bf16 v231, v241, v241, v231
    v_dot2_f32_bf16 v228, v245, v234, v228
    v_dot2_f32_bf16 v232, v245, v245, v232
    v_dot2_f32_bf16 v229, v249, v234, v229
    v_dot2_f32_bf16 v233, v249, v249, v233
    v_dot2_f32_bf16 v226, v238, v234, v226
    v_dot2_f32_bf16 v230, v238, v238, v230
    v_dot2_f32_bf16 v227, v242, v234, v227
    v_dot2_f32_bf16 v231, v242, v242, v231
    v_dot2_f32_bf16 v228, v246, v234, v228
    v_dot2_f32_bf16 v232, v246, v246, v232
    v_dot2_f32_bf16 v229, v250, v234, v229
    v_dot2_f32_bf16 v233, v250, v250, v233
    v_dot2_f32_bf16 v226, v239, v234, v226
    v_dot2_f32_bf16 v230, v239, v239, v230
    v_dot2_f32_bf16 v227, v243, v234, v227
    v_dot2_f32_bf16 v231, v243, v243, v231
    v_dot2_f32_bf16 v228, v247, v234, v228
    v_dot2_f32_bf16 v232, v247, v247, v232
    v_dot2_f32_bf16 v229, v251, v234, v229
    v_dot2_f32_bf16 v233, v251, v251, v233
    s_nop 3
    v_permlane32_swap_b32 v226, v228
    v_permlane32_swap_b32 v227, v229
    v_permlane32_swap_b32 v230, v232
    v_permlane32_swap_b32 v231, v233
    v_add_f32 v226, v226, v228
    v_add_f32 v227, v227, v229
    v_add_f32 v230, v230, v232
    v_add_f32 v231, v231, v233
    s_nop 1
    v_permlane16_swap_b32 v226, v227
    v_permlane16_swap_b32 v230, v231
    v_add_f32 v226, v226, v227
    v_add_f32 v227, v230, v231
    s_lshl_b32 s55, s51, 11
    s_lshl_b32 s56, s44, 10
    s_add_u32 s55, s55, s56
    s_lshl_b32 s56, s43, 9
    s_add_u32 s55, s55, s56
    s_add_u32 s59, s55, s53
    v_lshrrev_b32 v230, 1, v254
    buffer_store_dwordx2 v[226:227], v230, s[4:7], s59 offen sc0 sc1
    s_mov_b32 s46, 1
    s_add_u32 s47, s47, 262144
    s_add_u32 s49, s49, 524288
    s_add_u32 s50, s50, 917504
    s_add_u32 s52, s52, 65536
    s_add_u32 s54, s54, 32768
    s_add_u32 s0, s0, 32768
    s_branch X_layer
X_fin:
    v_and_b32 v192, 0xf0, v254
    v_lshlrev_b32 v192, 7, v192
    v_and_b32 v193, 0x100, v254
    v_lshrrev_b32 v193, 3, v193
    v_add_u32 v192, v192, v193
    v_and_b32 v193, 0x200, v254
    v_lshrrev_b32 v193, 5, v193
    v_add_u32 v192, v192, v193
    s_lshl_b32 s55, s40, 18
    s_lshl_b32 s56, s43, 17
    s_add_u32 s55, s55, s56
    s_lshl_b32 s56, s51, 7
    s_add_u32 s55, s55, s56
    s_lshl_b32 s56, s44, 6
    s_add_u32 s55, s55, s56
    v_cvt_pk_bf16_f32 v0, v128, v129
    v_cvt_pk_bf16_f32 v1, v130, v131
    v_cvt_pk_bf16_f32 v2, v144, v145
    v_cvt_pk_bf16_f32 v3, v146, v147
    s_nop 1
    v_permlane16_swap_b32 v0, v2
    v_permlane16_swap_b32 v1, v3
    buffer_store_dwordx4 v[0:3], v192, s[28:31], s55 offen
    s_add_u32 s55, s55, 32768
    v_cvt_pk_bf16_f32 v4, v132, v133
    v_cvt_pk_bf16_f32 v5, v134, v135
    v_cvt_pk_bf16_f32 v6, v148, v149
    v_cvt_pk_bf16_f32 v7, v150, v151
    s_nop 1
    v_permlane16_swap_b32 v4, v6
    v_permlane16_swap_b32 v5, v7
    buffer_store_dwordx4 v[4:7], v192, s[28:31], s55 offen
    s_add_u32 s55, s55, 32768
    v_cvt_pk_bf16_f32 v8, v136, v137
    v_cvt_pk_bf16_f32 v9, v138, v139
    v_cvt_pk_bf16_f32 v10, v152, v153
    v_cvt_pk_bf16_f32 v11, v154, v155
    s_nop 1
    v_permlane16_swap_b32 v8, v10
    v_permlane16_swap_b32 v9, v11
    buffer_store_dwordx4 v[8:11], v192, s[28:31], s55 offen
    s_add_u32 s55, s55, 32768
    v_cvt_pk_bf16_f32 v12, v140, v141
    v_cvt_pk_bf16_f32 v13, v142, v143
    v_cvt_pk_bf16_f32 v14, v156, v157
    v_cvt_pk_bf16_f32 v15, v158, v159
    s_nop 1
    v_permlane16_swap_b32 v12, v14
    v_permlane16_swap_b32 v13, v15
    buffer_store_dwordx4 v[12:15], v192, s[28:31], s55 offen
    s_add_u32 s55, s55, 32768
    s_endpgm
YS_first:
    s_setprio 1
    v_mov_b32 v226, 0
    v_mov_b32 v227, 0
    v_lshrrev_b32 v224, 1, v254
    s_lshl_b32 s55, s2, 8
    s_add_u32 s55, s55, 71303168
    s_mov_b64 exec, 0xffffffff
    buffer_store_dwordx2 v[226:227], v224, s[4:7], s55 offen sc0 sc1
    s_mov_b64 exec, -1
    v_lshlrev_b32 v224, 6, v254
    s_lshl_b32 s55, s2, 2
    s_add_u32 s55, s55, 71565312
    s_mov_b64 exec, 3
    buffer_store_dword v226, v224, s[4:7], s55 offen sc0 sc1
    s_mov_b64 exec, -1
    s_lshr_b32 s55, s2, 1
    s_cmp_lt_u32 s55, 56
    s_cselect_b32 s72, s80, s82
    s_cselect_b32 s73, s81, s83
    s_cselect_b32 s56, 0, 56
    s_sub_u32 s55, s55, s56
    s_mov_b32 s74, 7340032
    s_mov_b32 s75, 0x00020000
    s_lshl_b32 s76, s55, 7
    s_and_b32 s55, s2, 1
    s_mul_i32 s55, s55, 3670016
    s_add_u32 s76, s76, s55
    s_cmp_lt_u32 s2, 224
    s_cselect_b32 s76, s76, 2130706432
    v_lshrrev_b32 v140, 7, v254
    v_mul_u32_u24 v140, 7168, v140
    v_and_b32 v224, 0x70, v254
    v_add_u32 v140, v140, v224
    s_getreg_b32 s77, hwreg(HW_REG_XCC_ID, 0, 4)
    s_mul_i32 s55, s77, s77
    s_lshl_b32 s55, s55, 15
    s_lshl_b32 s77, s77, 6
    s_add_u32 s77, s77, s55
    s_add_u32 s77, s77, 1
    s_waitcnt vmcnt(10)
    s_barrier
    v_lshlrev_b32 v224, 3, v254
    s_lshl_b32 s55, s2, 13
    buffer_load_dword v144, v224, s[12:15], s55 offen
    buffer_load_dwordx4 v[0:3], v140, s[72:75], s76 offen
    s_add_u32 s76, s76, 57344
    buffer_load_dwordx4 v[4:7], v140, s[72:75], s76 offen
    s_add_u32 s76, s76, 57344
    buffer_load_dwordx4 v[8:11], v140, s[72:75], s76 offen
    s_add_u32 s76, s76, 57344
    buffer_load_dwordx4 v[12:15], v140, s[72:75], s76 offen
    s_add_u32 s76, s76, 57344
    buffer_load_dwordx4 v[16:19], v140, s[72:75], s76 offen
    s_add_u32 s76, s76, 57344
    buffer_load_dwordx4 v[20:23], v140, s[72:75], s76 offen
    s_add_u32 s76, s76, 57344
    buffer_load_dwordx4 v[24:27], v140, s[72:75], s76 offen
    s_add_u32 s76, s76, 57344
    buffer_load_dwordx4 v[28:31], v140, s[72:75], s76 offen
    s_add_u32 s76, s76, 57344
    buffer_load_dwordx4 v[32:35], v140, s[72:75], s76 offen
    s_add_u32 s76, s76, 57344
    buffer_load_dwordx4 v[36:39], v140, s[72:75], s76 offen
    s_add_u32 s76, s76, 57344
    buffer_load_dwordx4 v[40:43], v140, s[72:75], s76 offen
    s_add_u32 s76, s76, 57344
    s_waitcnt lgkmcnt(0)
    s_barrier
    buffer_load_dwordx4 v[44:47], v140, s[72:75], s76 offen
    s_add_u32 s76, s76, 57344
    buffer_load_dwordx4 v[48:51], v140, s[72:75], s76 offen
    s_add_u32 s76, s76, 57344
    buffer_load_dwordx4 v[52:55], v140, s[72:75], s76 offen
    s_add_u32 s76, s76, 57344
    buffer_load_dwordx4 v[56:59], v140, s[72:75], s76 offen
    s_add_u32 s76, s76, 57344
    buffer_load_dwordx4 v[60:63], v140, s[72:75], s76 offen
    s_add_u32 s76, s76, 57344
    buffer_load_dwordx4 v[64:67], v140, s[72:75], s76 offen
    s_add_u32 s76, s76, 57344
    buffer_load_dwordx4 v[68:71], v140, s[72:75], s76 offen
    s_add_u32 s76, s76, 57344
    buffer_load_dwordx4 v[72:75], v140, s[72:75], s76 offen
    s_add_u32 s76, s76, 57344
    buffer_load_dwordx4 v[76:79], v140, s[72:75], s76 offen
    s_add_u32 s76, s76, 57344
    buffer_load_dwordx4 v[80:83], v140, s[72:75], s76 offen
    s_add_u32 s76, s76, 57344
    buffer_load_dwordx4 v[84:87], v140, s[72:75], s76 offen
    s_add_u32 s76, s76, 57344
    s_waitcnt vmcnt(23) lgkmcnt(0)
    s_barrier
    v_mov_b32 v224, s77
    s_and_b32 s55, s2, 7
    s_lshl_b32 s55, s55, 5
    v_mov_b32 v225, 0
    s_mov_b64 exec, 1
    buffer_atomic_add v224, v225, s[32:35], s55 offen sc1
    s_mov_b64 exec, -1
    buffer_load_dwordx4 v[88:91], v140, s[72:75], s76 offen
    s_add_u32 s76, s76, 57344
    buffer_load_dwordx4 v[92:95], v140, s[72:75], s76 offen
    s_add_u32 s76, s76, 57344
    buffer_load_dwordx4 v[96:99], v140, s[72:75], s76 offen
    s_add_u32 s76, s76, 57344
    buffer_load_dwordx4 v[100:103], v140, s[72:75], s76 offen
    s_add_u32 s76, s76, 57344
    buffer_load_dwordx4 v[104:107], v140, s[72:75], s76 offen
    s_add_u32 s76, s76, 57344
    buffer_load_dwordx4 v[108:111], v140, s[72:75], s76 offen
    s_add_u32 s76, s76, 57344
    buffer_load_dwordx4 v[112:115], v140, s[72:75], s76 offen
    s_add_u32 s76, s76, 57344
    buffer_load_dwordx4 v[116:119], v140, s[72:75], s76 offen
    s_add_u32 s76, s76, 57344
    buffer_load_dwordx4 v[120:123], v140, s[72:75], s76 offen
    s_add_u32 s76, s76, 57344
    buffer_load_dwordx4 v[124:127], v140, s[72:75], s76 offen
    s_add_u32 s76, s76, 57344
    s_waitcnt lgkmcnt(0)
    s_barrier
    s_waitcnt lgkmcnt(0)
    s_barrier
    v_mov_b32 v252, 0
    v_mov_b32 v250, 1
    s_lshl_b32 s55, s2, 2
    s_add_u32 s55, s55, 71565312
    s_mov_b64 exec, 1
    buffer_store_dword v250, v252, s[4:7], s55 offen sc0 sc1
    s_mov_b64 exec, -1
    s_waitcnt lgkmcnt(0)
    s_barrier
    s_waitcnt lgkmcnt(0)
    s_barrier
    s_waitcnt lgkmcnt(0)
    s_barrier
    s_waitcnt lgkmcnt(0)
    s_barrier
    s_waitcnt lgkmcnt(0)
    s_barrier
    s_waitcnt lgkmcnt(0)
    s_barrier
    s_waitcnt lgkmcnt(0)
    s_barrier
    s_waitcnt lgkmcnt(0)
    s_barrier
    s_waitcnt lgkmcnt(0)
    s_barrier
    v_lshlrev_b32 v227, 1, v254
    v_and_b32 v227, 0xff, v227
    buffer_load_dword v226, v227, s[32:35], 0 offen sc0 sc1
    s_waitcnt lgkmcnt(0)
    s_barrier
    s_waitcnt lgkmcnt(0)
    s_barrier
    s_waitcnt lgkmcnt(0)
    s_barrier
    s_waitcnt vmcnt(0)
    s_mov_b32 s56, 262144
hs_24:
    v_and_b32 v225, 63, v226
    v_cmp_ne_u32 vcc, 32, v225
    s_cbranch_vccz hs_25
    buffer_load_dword v226, v227, s[32:35], 0 offen sc0 sc1
    s_waitcnt vmcnt(0)
    s_sub_u32 s56, s56, 1
    s_cmp_lg_u32 s56, 0
    s_cbranch_scc1 hs_24
hs_25:
    s_mov_b32 s55, 71565312
    buffer_load_dwordx4 v[144:147], v254, s[4:7], s55 offen sc0 sc1
    s_and_b32 s55, s2, 7
    s_nop 3
    v_readlane_b32 s55, v226, s55
    s_lshl_b32 s56, s77, 5
    s_nop 3
    s_cmp_lg_u32 s55, s56
    s_cselect_b32 s55, 1, 0
    v_mov_b32 v224, 157568
    v_mov_b32 v225, s55
    ds_write_b32 v224, v225
    s_waitcnt lgkmcnt(0)
    s_barrier
    s_waitcnt lgkmcnt(0)
    s_barrier
    s_waitcnt lgkmcnt(0)
    s_barrier
    s_waitcnt vmcnt(0)
    v_and_b32 v144, v144, v145
    v_and_b32 v146, v146, v147
    v_and_b32 v144, v144, v146
    v_cmp_ne_u32 vcc, 1, v144
    s_cbranch_vccz a4_26
    s_mov_b32 s55, 71565312
    s_mov_b32 s56, 262144
p4_27:
    buffer_load_dwordx4 v[144:147], v254, s[4:7], s55 offen sc0 sc1
    s_waitcnt vmcnt(0)
    v_and_b32 v144, v144, v145
    v_and_b32 v146, v146, v147
    v_and_b32 v144, v144, v146
    v_cmp_ne_u32 vcc, 1, v144
    s_cbranch_vccz p4_28
    s_sleep 1
    s_sub_u32 s56, s56, 1
    s_cmp_lg_u32 s56, 0
    s_cbranch_scc1 p4_27
p4_28:
a4_26:
    v_lshrrev_b32 v224, 1, v254
    s_lshl_b32 s55, s40, 10
    s_add_u32 s55, s55, 70254464
    buffer_load_dwordx2 v[144:145], v224, s[4:7], s55 offen offset:0 sc1
    buffer_load_dwordx2 v[146:147], v224, s[4:7], s55 offen offset:512 sc1
    buffer_load_dwordx2 v[148:149], v224, s[4:7], s55 offen offset:1024 sc1
    v_lshrrev_b32 v225, 8, v254
    v_and_b32 v224, 0xf0, v254
    v_lshl_add_u32 v141, v225, 12, v224
    s_lshl_b32 s55, s51, 8
    s_add_u32 s78, s55, 70516736
    s_waitcnt lgkmcnt(0)
    s_barrier
    buffer_load_dwordx4 v[156:159], v141, s[4:7], s78 offen sc1
    s_add_u32 s78, s78, 12288
    buffer_load_dwordx4 v[160:163], v141, s[4:7], s78 offen sc1
    s_add_u32 s78, s78, 12288
    buffer_load_dwordx4 v[164:167], v141, s[4:7], s78 offen sc1
    s_add_u32 s78, s78, 12288
    buffer_load_dwordx4 v[168:171], v141, s[4:7], s78 offen sc1
    s_add_u32 s78, s78, 12288
    s_waitcnt lgkmcnt(0)
    s_barrier
    buffer_load_dwordx4 v[172:175], v141, s[4:7], s78 offen sc1
    s_add_u32 s78, s78, 12288
    buffer_load_dwordx4 v[176:179], v141, s[4:7], s78 offen sc1
    s_add_u32 s78, s78, 12288
    buffer_load_dwordx4 v[180:183], v141, s[4:7], s78 offen sc1
    s_add_u32 s78, s78, 12288
    buffer_load_dwordx4 v[184:187], v141, s[4:7], s78 offen sc1
    s_add_u32 s78, s78, 12288
    s_waitcnt lgkmcnt(0)
    s_barrier
    buffer_load_dwordx4 v[188:191], v141, s[4:7], s78 offen sc1
    s_add_u32 s78, s78, 12288
    buffer_load_dwordx4 v[192:195], v141, s[4:7], s78 offen sc1
    s_add_u32 s78, s78, 12288
    buffer_load_dwordx4 v[196:199], v141, s[4:7], s78 offen sc1
    s_add_u32 s78, s78, 12288
    buffer_load_dwordx4 v[200:203], v141, s[4:7], s78 offen sc1
    s_add_u32 s78, s78, 12288
    s_waitcnt lgkmcnt(0)
    s_barrier
    s_waitcnt vmcnt(8)
    v_mov_b32 v152, v156
    v_mov_b32 v153, v157
    v_mov_b32 v154, v158
    v_mov_b32 v155, v159
    v_add_f32 v152, v152, v160
    v_add_f32 v153, v153, v161
    v_add_f32 v154, v154, v162
    v_add_f32 v155, v155, v163
    v_add_f32 v152, v152, v164
    v_add_f32 v153, v153, v165
    v_add_f32 v154, v154, v166
    v_add_f32 v155, v155, v167
    v_add_f32 v152, v152, v168
    v_add_f32 v153, v153, v169
    v_add_f32 v154, v154, v170
    v_add_f32 v155, v155, v171
    buffer_load_dwordx4 v[156:159], v141, s[4:7], s78 offen sc1
    s_add_u32 s78, s78, 12288
    buffer_load_dwordx4 v[160:163], v141, s[4:7], s78 offen sc1
    s_add_u32 s78, s78, 12288
    buffer_load_dwordx4 v[164:167], v141, s[4:7], s78 offen sc1
    s_add_u32 s78, s78, 12288
    buffer_load_dwordx4 v[168:171], v141, s[4:7], s78 offen sc1
    s_add_u32 s78, s78, 12288
    s_waitcnt lgkmcnt(0)
    s_barrier
    s_waitcnt vmcnt(8)
    v_add_f32 v152, v152, v172
    v_add_f32 v153, v153, v173
    v_add_f32 v154, v154, v174
    v_add_f32 v155, v155, v175
    v_add_f32 v152, v152, v176
    v_add_f32 v153, v153, v177
    v_add_f32 v154, v154, v178
    v_add_f32 v155, v155, v179
    v_add_f32 v152, v152, v180
    v_add_f32 v153, v153, v181
    v_add_f32 v154, v154, v182
    v_add_f32 v155, v155, v183
    v_add_f32 v152, v152, v184
    v_add_f32 v153, v153, v185
    v_add_f32 v154, v154, v186
    v_add_f32 v155, v155, v187
    s_waitcnt lgkmcnt(0)
    s_barrier
    s_waitcnt vmcnt(4)
    v_add_f32 v152, v152, v188
    v_add_f32 v153, v153, v189
    v_add_f32 v154, v154, v190
    v_add_f32 v155, v155, v191
    v_add_f32 v152, v152, v192
    v_add_f32 v153, v153, v193
    v_add_f32 v154, v154, v194
    v_add_f32 v155, v155, v195
    v_add_f32 v152, v152, v196
    v_add_f32 v153, v153, v197
    v_add_f32 v154, v154, v198
    v_add_f32 v155, v155, v199
    v_add_f32 v152, v152, v200
    v_add_f32 v153, v153, v201
    v_add_f32 v154, v154, v202
    v_add_f32 v155, v155, v203
    s_waitcnt lgkmcnt(0)
    s_barrier
    s_waitcnt vmcnt(0)
    v_add_f32 v152, v152, v156
    v_add_f32 v153, v153, v157
    v_add_f32 v154, v154, v158
    v_add_f32 v155, v155, v159
    v_add_f32 v152, v152, v160
    v_add_f32 v153, v153, v161
    v_add_f32 v154, v154, v162
    v_add_f32 v155, v155, v163
    v_add_f32 v152, v152, v164
    v_add_f32 v153, v153, v165
    v_add_f32 v154, v154, v166
    v_add_f32 v155, v155, v167
    v_add_f32 v152, v152, v168
    v_add_f32 v153, v153, v169
    v_add_f32 v154, v154, v170
    v_add_f32 v155, v155, v171
    s_waitcnt lgkmcnt(0)
    s_barrier
    v_add_u32 v224, 154752, v254
    s_mov_b32 s70, -1
    s_mov_b32 s71, 0xffff
    s_mov_b64 exec, s[70:71]
    ds_write_b128 v224, v[152:155]
    s_mov_b64 exec, -1
    s_cmp_eq_u32 s40, 0
    s_cselect_b32 s70, 0xffff, 0
    s_mov_b32 s71, 0
    v_cndmask_b32 v144, v144, 0, s[70:71]
    v_cndmask_b32 v145, v145, 0, s[70:71]
    v_lshrrev_b32 v224, 2, v254
    v_add_u32 v224, 153600, v224
    s_waitcnt lgkmcnt(0)
    s_barrier
    v_mul_f32 v144, 0x3a800000, v144
    v_mul_f32 v145, 0x3a800000, v145
    v_fma_f32 v145, -v144, v144, v145
    v_max_f32 v145, 0, v145
    v_cvt_pk_bf16_f32 v144, v144, v144
    v_lshlrev_b32 v144, 16, v144
    v_cvt_pk_bf16_f32 v145, v145, v145
    v_lshlrev_b32 v145, 16, v145
    v_add_f32 v145, 0x3727c5ac, v145
    v_cvt_pk_bf16_f32 v145, v145, v145
    v_lshlrev_b32 v145, 16, v145
    v_sqrt_f32 v145, v145
    s_nop 0
    v_cvt_pk_bf16_f32 v145, v145, v145
    v_lshlrev_b32 v145, 16, v145
    v_rcp_f32 v145, v145
    s_nop 0
    v_sub_f32 v144, 0, v144
    ds_write_b32 v224, v144 offset:0
    ds_write_b32 v224, v145 offset:576
    s_waitcnt lgkmcnt(0)
    s_barrier
    v_mul_f32 v146, 0x3a800000, v146
    v_mul_f32 v147, 0x3a800000, v147
    v_fma_f32 v147, -v146, v146, v147
    v_max_f32 v147, 0, v147
    v_cvt_pk_bf16_f32 v146, v146, v146
    v_lshlrev_b32 v146, 16, v146
    v_cvt_pk_bf16_f32 v147, v147, v147
    v_lshlrev_b32 v147, 16, v147
    v_add_f32 v147, 0x3727c5ac, v147
    v_cvt_pk_bf16_f32 v147, v147, v147
    v_lshlrev_b32 v147, 16, v147
    v_sqrt_f32 v147, v147
    s_nop 0
    v_cvt_pk_bf16_f32 v147, v147, v147
    v_lshlrev_b32 v147, 16, v147
    v_rcp_f32 v147, v147
    s_nop 0
    v_sub_f32 v146, 0, v146
    ds_write_b32 v224, v146 offset:256
    ds_write_b32 v224, v147 offset:832
    s_waitcnt lgkmcnt(0)
    s_barrier
    v_mul_f32 v148, 0x3a800000, v148
    v_mul_f32 v149, 0x3a800000, v149
    v_fma_f32 v149, -v148, v148, v149
    v_max_f32 v149, 0, v149
    v_cvt_pk_bf16_f32 v148, v148, v148
    v_lshlrev_b32 v148, 16, v148
    v_cvt_pk_bf16_f32 v149, v149, v149
    v_lshlrev_b32 v149, 16, v149
    v_add_f32 v149, 0x3727c5ac, v149
    v_cvt_pk_bf16_f32 v149, v149, v149
    v_lshlrev_b32 v149, 16, v149
    v_sqrt_f32 v149, v149
    s_nop 0
    v_cvt_pk_bf16_f32 v149, v149, v149
    v_lshlrev_b32 v149, 16, v149
    v_rcp_f32 v149, v149
    s_nop 0
    v_sub_f32 v148, 0, v148
    s_mov_b64 exec, 0xffff
    ds_write_b32 v224, v148 offset:512
    ds_write_b32 v224, v149 offset:1088
    s_mov_b64 exec, -1
    s_waitcnt lgkmcnt(0)
    s_barrier
    s_waitcnt lgkmcnt(0)
    s_barrier
    s_setprio 0
    v_mov_b32 v132, 0x3f80
    v_lshrrev_b32 v224, 4, v254
    v_and_b32 v225, 1, v224
    v_lshlrev_b32 v225, 4, v225
    v_lshlrev_b32 v225, v225, v132
    v_bfe_u32 v224, v224, 1, 3
    v_cmp_eq_u32 vcc, 0, v224
    s_nop 1
    v_cndmask_b32 v132, 0, v225, vcc
    v_cmp_eq_u32 vcc, 1, v224
    s_nop 1
    v_cndmask_b32 v133, 0, v225, vcc
    v_cmp_eq_u32 vcc, 2, v224
    s_nop 1
    v_cndmask_b32 v134, 0, v225, vcc
    v_cmp_eq_u32 vcc, 3, v224
    s_nop 1
    v_cndmask_b32 v135, 0, v225, vcc
    s_nop 1
    v_mfma_f32_16x16x32_bf16 v[128:131], v[132:135], v[0:3], 0
    v_mfma_f32_16x16x32_bf16 v[128:131], v[132:135], v[4:7], v[128:131]
    v_mfma_f32_16x16x32_bf16 v[128:131], v[132:135], v[8:11], v[128:131]
    v_mfma_f32_16x16x32_bf16 v[128:131], v[132:135], v[12:15], v[128:131]
    v_mfma_f32_16x16x32_bf16 v[128:131], v[132:135], v[16:19], v[128:131]
    v_mfma_f32_16x16x32_bf16 v[128:131], v[132:135], v[20:23], v[128:131]
    v_mfma_f32_16x16x32_bf16 v[128:131], v[132:135], v[24:27], v[128:131]
    v_mfma_f32_16x16x32_bf16 v[128:131], v[132:135], v[28:31], v[128:131]
    v_mfma_f32_16x16x32_bf16 v[128:131], v[132:135], v[32:35], v[128:131]
    v_mfma_f32_16x16x32_bf16 v[128:131], v[132:135], v[36:39], v[128:131]
    v_mfma_f32_16x16x32_bf16 v[128:131], v[132:135], v[40:43], v[128:131]
    v_mfma_f32_16x16x32_bf16 v[128:131], v[132:135], v[44:47], v[128:131]
    v_mfma_f32_16x16x32_bf16 v[128:131], v[132:135], v[48:51], v[128:131]
    v_mfma_f32_16x16x32_bf16 v[128:131], v[132:135], v[52:55], v[128:131]
    v_mfma_f32_16x16x32_bf16 v[128:131], v[132:135], v[56:59], v[128:131]
    v_mfma_f32_16x16x32_bf16 v[128:131], v[132:135], v[60:63], v[128:131]
    v_mfma_f32_16x16x32_bf16 v[128:131], v[132:135], v[64:67], v[128:131]
    v_mfma_f32_16x16x32_bf16 v[128:131], v[132:135], v[68:71], v[128:131]
    v_mfma_f32_16x16x32_bf16 v[128:131], v[132:135], v[72:75], v[128:131]
    v_mfma_f32_16x16x32_bf16 v[128:131], v[132:135], v[76:79], v[128:131]
    v_mfma_f32_16x16x32_bf16 v[128:131], v[132:135], v[80:83], v[128:131]
    v_mfma_f32_16x16x32_bf16 v[128:131], v[132:135], v[84:87], v[128:131]
    v_mfma_f32_16x16x32_bf16 v[128:131], v[132:135], v[88:91], v[128:131]
    v_mfma_f32_16x16x32_bf16 v[128:131], v[132:135], v[92:95], v[128:131]
    v_mfma_f32_16x16x32_bf16 v[128:131], v[132:135], v[96:99], v[128:131]
    v_mfma_f32_16x16x32_bf16 v[128:131], v[132:135], v[100:103], v[128:131]
    v_mfma_f32_16x16x32_bf16 v[128:131], v[132:135], v[104:107], v[128:131]
    v_mfma_f32_16x16x32_bf16 v[128:131], v[132:135], v[108:111], v[128:131]
    v_mfma_f32_16x16x32_bf16 v[128:131], v[132:135], v[112:115], v[128:131]
    v_mfma_f32_16x16x32_bf16 v[128:131], v[132:135], v[116:119], v[128:131]
    v_mfma_f32_16x16x32_bf16 v[128:131], v[132:135], v[120:123], v[128:131]
    v_mfma_f32_16x16x32_bf16 v[128:131], v[132:135], v[124:127], v[128:131]
    s_and_b32 s56, s2, 1
    s_mul_i32 s56, s56, 3
    s_add_u32 s56, s56, s42
    s_mul_i32 s56, s56, 28672
    s_lshr_b32 s55, s2, 1
    s_lshl_b32 s55, s55, 8
    s_add_u32 s55, s55, s56
    s_add_u32 s55, s55, 70750208
    s_cmp_lt_u32 s2, 224
    s_cselect_b32 s55, s55, 2130706432
    v_and_b32 v224, 0x70, v254
    v_lshrrev_b32 v225, 4, v254
    v_and_b32 v225, 16, v225
    v_lshl_add_u32 v224, v224, 1, v225
    s_nop 2
    v_add_f32_dpp v128, v128, v128 row_ror:8 row_mask:0xf bank_mask:0xf
    v_add_f32_dpp v129, v129, v129 row_ror:8 row_mask:0xf bank_mask:0xf
    v_add_f32_dpp v130, v130, v130 row_ror:8 row_mask:0xf bank_mask:0xf
    v_add_f32_dpp v131, v131, v131 row_ror:8 row_mask:0xf bank_mask:0xf
    s_mov_b64 exec, 0x00ff00ff
    buffer_store_dwordx4 v[128:131], v224, s[4:7], s55 offen sc0 sc1
    s_mov_b64 exec, -1
    v_mov_b32 v224, 157568
    ds_read_b32 v224, v224
    s_waitcnt lgkmcnt(0)
    v_readfirstlane_b32 s45, v224
    s_branch YA_g2
YA_layer:
    s_mov_b32 s36, s4
    s_mov_b32 s37, s5
    s_mov_b32 s38, s6
    s_mov_b32 s39, s7
    v_mov_b32 v200, v254
    v_mov_b32 v201, v254
    v_mov_b32 v202, v254
    v_mov_b32 v203, v254
    s_mov_b32 s62, s48
    s_mov_b32 s63, 4096
    s_mov_b32 s65, 16384
    s_mov_b32 s94, s51
    s_mul_i32 s93, s94, s65
    s_add_u32 s93, s93, s62
    s_barrier
    v_lshlrev_b32 v224, 3, v254
    s_lshl_b32 s55, s43, 13
    s_add_u32 s55, s55, s93
    buffer_load_dword v225, v224, s[4:7], s55 offen sc0 sc1
    v_lshrrev_b32 v252, 2, v254
    v_min_u32 v252, 28, v252
    s_add_u32 s55, s0, 64
    s_mov_b32 s56, 262144
poll_30:
    buffer_load_dword v253, v252, s[4:7], s55 offen sc0 sc1
    s_waitcnt vmcnt(0)
    v_cmp_ne_u32 vcc, 0x01010101, v253
    s_cbranch_vccz pd_31
    s_sleep 1
    s_sub_u32 s56, s56, 1
    s_cmp_lg_u32 s56, 0
    s_cbranch_scc1 poll_30
pd_31:
gw_29:
    s_cmp_eq_u32 s42, 1
    s_cbranch_scc1 YS_g1
    s_mov_b32 m0, 100352
    s_nop 0
    buffer_load_dwordx4 v200, s[36:39], s93 offen lds
    buffer_load_dwordx4 v201, s[36:39], s93 offen offset:1024 lds
    buffer_load_dwordx4 v202, s[36:39], s93 offen offset:2048 lds
    buffer_load_dwordx4 v203, s[36:39], s93 offen offset:3072 lds
    s_add_u32 s93, s93, s63
    s_mov_b32 m0, 104448
    s_nop 0
    buffer_load_dwordx4 v200, s[36:39], s93 offen lds
    buffer_load_dwordx4 v201, s[36:39], s93 offen offset:1024 lds
    buffer_load_dwordx4 v202, s[36:39], s93 offen offset:2048 lds
    buffer_load_dwordx4 v203, s[36:39], s93 offen offset:3072 lds
    s_add_u32 s93, s93, s63
    s_add_u32 s93, s93, s63
    s_add_u32 s94, s94, 2
    s_and_b32 s94, s94, 15
    s_mul_i32 s93, s94, s65
    s_add_u32 s93, s93, s62
    s_mov_b32 m0, 118784
    s_nop 0
    buffer_load_dwordx4 v200, s[36:39], s93 offen lds
    buffer_load_dwordx4 v201, s[36:39], s93 offen offset:1024 lds
    buffer_load_dwordx4 v202, s[36:39], s93 offen offset:2048 lds
    buffer_load_dwordx4 v203, s[36:39], s93 offen offset:3072 lds
    s_add_u32 s93, s93, s63
    s_mov_b32 m0, 122880
    s_nop 0
    buffer_load_dwordx4 v200, s[36:39], s93 offen lds
    buffer_load_dwordx4 v201, s[36:39], s93 offen offset:1024 lds
    buffer_load_dwordx4 v202, s[36:39], s93 offen offset:2048 lds
    buffer_load_dwordx4 v203, s[36:39], s93 offen offset:3072 lds
    s_add_u32 s93, s93, s63
    s_add_u32 s93, s93, s63
    s_add_u32 s94, s94, 2
    s_and_b32 s94, s94, 15
    s_mul_i32 s93, s94, s65
    s_add_u32 s93, s93, s62
    s_mov_b32 m0, 137216
    s_nop 0
    buffer_load_dwordx4 v200, s[36:39], s93 offen lds
    buffer_load_dwordx4 v201, s[36:39], s93 offen offset:1024 lds
    buffer_load_dwordx4 v202, s[36:39], s93 offen offset:2048 lds
    buffer_load_dwordx4 v203, s[36:39], s93 offen offset:3072 lds
    s_add_u32 s93, s93, s63
    s_mov_b32 m0, 141312
    s_nop 0
    buffer_load_dwordx4 v200, s[36:39], s93 offen lds
    buffer_load_dwordx4 v201, s[36:39], s93 offen offset:1024 lds
    buffer_load_dwordx4 v202, s[36:39], s93 offen offset:2048 lds
    buffer_load_dwordx4 v203, s[36:39], s93 offen offset:3072 lds
    s_add_u32 s93, s93, s63
    s_mov_b32 m0, 145408
    s_nop 0
    buffer_load_dwordx4 v200, s[36:39], s93 offen lds
    buffer_load_dwordx4 v201, s[36:39], s93 offen offset:1024 lds
    buffer_load_dwordx4 v202, s[36:39], s93 offen offset:2048 lds
    buffer_load_dwordx4 v203, s[36:39], s93 offen offset:3072 lds
    s_add_u32 s93, s93, s63
    s_mov_b32 m0, 149504
    s_nop 0
    buffer_load_dwordx4 v200, s[36:39], s93 offen lds
    buffer_load_dwordx4 v201, s[36:39], s93 offen offset:1024 lds
    buffer_load_dwordx4 v202, s[36:39], s93 offen offset:2048 lds
    buffer_load_dwordx4 v203, s[36:39], s93 offen offset:3072 lds
    s_add_u32 s94, s94, 2
    s_and_b32 s94, s94, 15
    s_mul_i32 s93, s94, s65
    s_add_u32 s93, s93, s62
YA0_b:
    s_waitcnt vmcnt(24)
    s_barrier
    s_barrier
    s_waitcnt vmcnt(16)
    s_barrier
    s_mov_b32 m0, 100352
    s_nop 0
    buffer_load_dwordx4 v200, s[36:39], s93 offen lds
    buffer_load_dwordx4 v201, s[36:39], s93 offen offset:1024 lds
    buffer_load_dwordx4 v202, s[36:39], s93 offen offset:2048 lds
    buffer_load_dwordx4 v203, s[36:39], s93 offen offset:3072 lds
    s_add_u32 s93, s93, s63
    s_mov_b32 m0, 104448
    s_nop 0
    buffer_load_dwordx4 v200, s[36:39], s93 offen lds
    buffer_load_dwordx4 v201, s[36:39], s93 offen offset:1024 lds
    buffer_load_dwordx4 v202, s[36:39], s93 offen offset:2048 lds
    buffer_load_dwordx4 v203, s[36:39], s93 offen offset:3072 lds
    s_add_u32 s93, s93, s63
    s_barrier
    s_mov_b32 m0, 108544
    s_nop 0
    buffer_load_dwordx4 v200, s[36:39], s93 offen lds
    buffer_load_dwordx4 v201, s[36:39], s93 offen offset:1024 lds
    buffer_load_dwordx4 v202, s[36:39], s93 offen offset:2048 lds
    buffer_load_dwordx4 v203, s[36:39], s93 offen offset:3072 lds
    s_add_u32 s93, s93, s63
    s_mov_b32 m0, 112640
    s_nop 0
    buffer_load_dwordx4 v200, s[36:39], s93 offen lds
    buffer_load_dwordx4 v201, s[36:39], s93 offen offset:1024 lds
    buffer_load_dwordx4 v202, s[36:39], s93 offen offset:2048 lds
    buffer_load_dwordx4 v203, s[36:39], s93 offen offset:3072 lds
    s_add_u32 s94, s94, 2
    s_and_b32 s94, s94, 15
    s_mul_i32 s93, s94, s65
    s_add_u32 s93, s93, s62
    s_waitcnt vmcnt(16)
    s_barrier
    s_mov_b32 m0, 118784
    s_nop 0
    buffer_load_dwordx4 v200, s[36:39], s93 offen lds
    buffer_load_dwordx4 v201, s[36:39], s93 offen offset:1024 lds
    buffer_load_dwordx4 v202, s[36:39], s93 offen offset:2048 lds
    buffer_load_dwordx4 v203, s[36:39], s93 offen offset:3072 lds
    s_add_u32 s93, s93, s63
    s_mov_b32 m0, 122880
    s_nop 0
    buffer_load_dwordx4 v200, s[36:39], s93 offen lds
    buffer_load_dwordx4 v201, s[36:39], s93 offen offset:1024 lds
    buffer_load_dwordx4 v202, s[36:39], s93 offen offset:2048 lds
    buffer_load_dwordx4 v203, s[36:39], s93 offen offset:3072 lds
    s_add_u32 s93, s93, s63
    s_barrier
    s_mov_b32 m0, 126976
    s_nop 0
    buffer_load_dwordx4 v200, s[36:39], s93 offen lds
    buffer_load_dwordx4 v201, s[36:39], s93 offen offset:1024 lds
    buffer_load_dwordx4 v202, s[36:39], s93 offen offset:2048 lds
    buffer_load_dwordx4 v203, s[36:39], s93 offen offset:3072 lds
    s_add_u32 s93, s93, s63
    s_mov_b32 m0, 131072
    s_nop 0
    buffer_load_dwordx4 v200, s[36:39], s93 offen lds
    buffer_load_dwordx4 v201, s[36:39], s93 offen offset:1024 lds
    buffer_load_dwordx4 v202, s[36:39], s93 offen offset:2048 lds
    buffer_load_dwordx4 v203, s[36:39], s93 offen offset:3072 lds
    s_add_u32 s94, s94, 2
    s_and_b32 s94, s94, 15
    s_mul_i32 s93, s94, s65
    s_add_u32 s93, s93, s62
    s_waitcnt vmcnt(16)
    s_barrier
    s_mov_b32 m0, 137216
    s_nop 0
    buffer_load_dwordx4 v200, s[36:39], s93 offen lds
    buffer_load_dwordx4 v201, s[36:39], s93 offen offset:1024 lds
    buffer_load_dwordx4 v202, s[36:39], s93 offen offset:2048 lds
    buffer_load_dwordx4 v203, s[36:39], s93 offen offset:3072 lds
    s_add_u32 s93, s93, s63
    s_mov_b32 m0, 141312
    s_nop 0
    buffer_load_dwordx4 v200, s[36:39], s93 offen lds
    buffer_load_dwordx4 v201, s[36:39], s93 offen offset:1024 lds
    buffer_load_dwordx4 v202, s[36:39], s93 offen offset:2048 lds
    buffer_load_dwordx4 v203, s[36:39], s93 offen offset:3072 lds
    s_add_u32 s93, s93, s63
    s_barrier
    s_mov_b32 m0, 145408
    s_nop 0
    buffer_load_dwordx4 v200, s[36:39], s93 offen lds
    buffer_load_dwordx4 v201, s[36:39], s93 offen offset:1024 lds
    buffer_load_dwordx4 v202, s[36:39], s93 offen offset:2048 lds
    buffer_load_dwordx4 v203, s[36:39], s93 offen offset:3072 lds
    s_add_u32 s93, s93, s63
    s_mov_b32 m0, 149504
    s_nop 0
    buffer_load_dwordx4 v200, s[36:39], s93 offen lds
    buffer_load_dwordx4 v201, s[36:39], s93 offen offset:1024 lds
    buffer_load_dwordx4 v202, s[36:39], s93 offen offset:2048 lds
    buffer_load_dwordx4 v203, s[36:39], s93 offen offset:3072 lds
    s_add_u32 s94, s94, 2
    s_and_b32 s94, s94, 15
    s_mul_i32 s93, s94, s65
    s_add_u32 s93, s93, s62
    s_waitcnt vmcnt(16)
    s_barrier
    s_mov_b32 m0, 100352
    s_nop 0
    buffer_load_dwordx4 v200, s[36:39], s93 offen lds
    buffer_load_dwordx4 v201, s[36:39], s93 offen offset:1024 lds
    buffer_load_dwordx4 v202, s[36:39], s93 offen offset:2048 lds
    buffer_load_dwordx4 v203, s[36:39], s93 offen offset:3072 lds
    s_add_u32 s93, s93, s63
    s_mov_b32 m0, 104448
    s_nop 0
    buffer_load_dwordx4 v200, s[36:39], s93 offen lds
    buffer_load_dwordx4 v201, s[36:39], s93 offen offset:1024 lds
    buffer_load_dwordx4 v202, s[36:39], s93 offen offset:2048 lds
    buffer_load_dwordx4 v203, s[36:39], s93 offen offset:3072 lds
    s_add_u32 s93, s93, s63
    s_barrier
    v_lshrrev_b32 v252, 2, v254
    v_min_u32 v252, 60, v252
    s_add_u32 s55, s54, 8192
    buffer_load_dword v251, v252, s[4:7], s55 offen sc0 sc1
    s_mov_b32 m0, 108544
    s_nop 0
    buffer_load_dwordx4 v200, s[36:39], s93 offen lds
    buffer_load_dwordx4 v201, s[36:39], s93 offen offset:1024 lds
    buffer_load_dwordx4 v202, s[36:39], s93 offen offset:2048 lds
    buffer_load_dwordx4 v203, s[36:39], s93 offen offset:3072 lds
    s_add_u32 s93, s93, s63
    s_mov_b32 m0, 112640
    s_nop 0
    buffer_load_dwordx4 v200, s[36:39], s93 offen lds
    buffer_load_dwordx4 v201, s[36:39], s93 offen offset:1024 lds
    buffer_load_dwordx4 v202, s[36:39], s93 offen offset:2048 lds
    buffer_load_dwordx4 v203, s[36:39], s93 offen offset:3072 lds
    s_add_u32 s94, s94, 2
    s_and_b32 s94, s94, 15
    s_mul_i32 s93, s94, s65
    s_add_u32 s93, s93, s62
    s_waitcnt vmcnt(17)
    s_barrier
    s_mov_b32 m0, 118784
    s_nop 0
    buffer_load_dwordx4 v200, s[36:39], s93 offen lds
    buffer_load_dwordx4 v201, s[36:39], s93 offen offset:1024 lds
    buffer_load_dwordx4 v202, s[36:39], s93 offen offset:2048 lds
    buffer_load_dwordx4 v203, s[36:39], s93 offen offset:3072 lds
    s_add_u32 s93, s93, s63
    s_mov_b32 m0, 122880
    s_nop 0
    buffer_load_dwordx4 v200, s[36:39], s93 offen lds
    buffer_load_dwordx4 v201, s[36:39], s93 offen offset:1024 lds
    buffer_load_dwordx4 v202, s[36:39], s93 offen offset:2048 lds
    buffer_load_dwordx4 v203, s[36:39], s93 offen offset:3072 lds
    s_add_u32 s93, s93, s63
    s_barrier
    s_mov_b32 m0, 126976
    s_nop 0
    buffer_load_dwordx4 v200, s[36:39], s93 offen lds
    buffer_load_dwordx4 v201, s[36:39], s93 offen offset:1024 lds
    buffer_load_dwordx4 v202, s[36:39], s93 offen offset:2048 lds
    buffer_load_dwordx4 v203, s[36:39], s93 offen offset:3072 lds
    s_add_u32 s93, s93, s63
    s_mov_b32 m0, 131072
    s_nop 0
    buffer_load_dwordx4 v200, s[36:39], s93 offen lds
    buffer_load_dwordx4 v201, s[36:39], s93 offen offset:1024 lds
    buffer_load_dwordx4 v202, s[36:39], s93 offen offset:2048 lds
    buffer_load_dwordx4 v203, s[36:39], s93 offen offset:3072 lds
    s_add_u32 s94, s94, 3
    s_and_b32 s94, s94, 15
    s_mul_i32 s93, s94, s65
    s_add_u32 s93, s93, s62
    s_waitcnt vmcnt(16)
    s_barrier
    v_cmp_ne_u32 vcc, 0x01010101, v251
    s_cbranch_vccz ap_32
    s_cmp_eq_u32 s46, 0
    s_cbranch_scc1 ap_32
    v_lshrrev_b32 v252, 2, v254
    v_min_u32 v252, 60, v252
    s_add_u32 s55, s54, 8192
    s_mov_b32 s56, 262144
poll_33:
    buffer_load_dword v253, v252, s[4:7], s55 offen sc0 sc1
    s_waitcnt vmcnt(0)
    v_cmp_ne_u32 vcc, 0x01010101, v253
    s_cbranch_vccz pd_34
    s_sleep 1
    s_sub_u32 s56, s56, 1
    s_cmp_lg_u32 s56, 0
    s_cbranch_scc1 poll_33
pd_34:
ap_32:
    s_mov_b32 m0, 137216
    s_nop 0
    buffer_load_dwordx4 v200, s[36:39], s93 offen lds
    buffer_load_dwordx4 v201, s[36:39], s93 offen offset:1024 lds
    buffer_load_dwordx4 v202, s[36:39], s93 offen offset:2048 lds
    buffer_load_dwordx4 v203, s[36:39], s93 offen offset:3072 lds
    s_add_u32 s93, s93, s63
    s_mov_b32 m0, 141312
    s_nop 0
    buffer_load_dwordx4 v200, s[36:39], s93 offen lds
    buffer_load_dwordx4 v201, s[36:39], s93 offen offset:1024 lds
    buffer_load_dwordx4 v202, s[36:39], s93 offen offset:2048 lds
    buffer_load_dwordx4 v203, s[36:39], s93 offen offset:3072 lds
    s_add_u32 s93, s93, s63
    s_barrier
    s_mov_b32 m0, 145408
    s_nop 0
    buffer_load_dwordx4 v200, s[36:39], s93 offen lds
    buffer_load_dwordx4 v201, s[36:39], s93 offen offset:1024 lds
    buffer_load_dwordx4 v202, s[36:39], s93 offen offset:2048 lds
    buffer_load_dwordx4 v203, s[36:39], s93 offen offset:3072 lds
    s_add_u32 s93, s93, s63
    s_mov_b32 m0, 149504
    s_nop 0
    buffer_load_dwordx4 v200, s[36:39], s93 offen lds
    buffer_load_dwordx4 v201, s[36:39], s93 offen offset:1024 lds
    buffer_load_dwordx4 v202, s[36:39], s93 offen offset:2048 lds
    buffer_load_dwordx4 v203, s[36:39], s93 offen offset:3072 lds
    s_add_u32 s94, s94, 2
    s_and_b32 s94, s94, 15
    s_mul_i32 s93, s94, s65
    s_add_u32 s93, s93, s62
    s_waitcnt vmcnt(16)
    s_barrier
    s_mov_b32 m0, 100352
    s_nop 0
    buffer_load_dwordx4 v200, s[36:39], s93 offen lds
    buffer_load_dwordx4 v201, s[36:39], s93 offen offset:1024 lds
    buffer_load_dwordx4 v202, s[36:39], s93 offen offset:2048 lds
    buffer_load_dwordx4 v203, s[36:39], s93 offen offset:3072 lds
    s_add_u32 s93, s93, s63
    s_mov_b32 m0, 104448
    s_nop 0
    buffer_load_dwordx4 v200, s[36:39], s93 offen lds
    buffer_load_dwordx4 v201, s[36:39], s93 offen offset:1024 lds
    buffer_load_dwordx4 v202, s[36:39], s93 offen offset:2048 lds
    buffer_load_dwordx4 v203, s[36:39], s93 offen offset:3072 lds
    s_add_u32 s93, s93, s63
    s_barrier
    s_mov_b32 m0, 108544
    s_nop 0
    buffer_load_dwordx4 v200, s[36:39], s93 offen lds
    buffer_load_dwordx4 v201, s[36:39], s93 offen offset:1024 lds
    buffer_load_dwordx4 v202, s[36:39], s93 offen offset:2048 lds
    buffer_load_dwordx4 v203, s[36:39], s93 offen offset:3072 lds
    s_add_u32 s93, s93, s63
    s_mov_b32 m0, 112640
    s_nop 0
    buffer_load_dwordx4 v200, s[36:39], s93 offen lds
    buffer_load_dwordx4 v201, s[36:39], s93 offen offset:1024 lds
    buffer_load_dwordx4 v202, s[36:39], s93 offen offset:2048 lds
    buffer_load_dwordx4 v203, s[36:39], s93 offen offset:3072 lds
    s_add_u32 s94, s94, 2
    s_and_b32 s94, s94, 15
    s_mul_i32 s93, s94, s65
    s_add_u32 s93, s93, s62
    s_waitcnt vmcnt(16)
    s_barrier
    s_mov_b32 m0, 118784
    s_nop 0
    buffer_load_dwordx4 v200, s[36:39], s93 offen lds
    buffer_load_dwordx4 v201, s[36:39], s93 offen offset:1024 lds
    buffer_load_dwordx4 v202, s[36:39], s93 offen offset:2048 lds
    buffer_load_dwordx4 v203, s[36:39], s93 offen offset:3072 lds
    s_add_u32 s93, s93, s63
    s_mov_b32 m0, 122880
    s_nop 0
    buffer_load_dwordx4 v200, s[36:39], s93 offen lds
    buffer_load_dwordx4 v201, s[36:39], s93 offen offset:1024 lds
    buffer_load_dwordx4 v202, s[36:39], s93 offen offset:2048 lds
    buffer_load_dwordx4 v203, s[36:39], s93 offen offset:3072 lds
    s_add_u32 s93, s93, s63
    s_barrier
    s_mov_b32 m0, 126976
    s_nop 0
    buffer_load_dwordx4 v200, s[36:39], s93 offen lds
    buffer_load_dwordx4 v201, s[36:39], s93 offen offset:1024 lds
    buffer_load_dwordx4 v202, s[36:39], s93 offen offset:2048 lds
    buffer_load_dwordx4 v203, s[36:39], s93 offen offset:3072 lds
    s_add_u32 s93, s93, s63
    s_mov_b32 m0, 131072
    s_nop 0
    buffer_load_dwordx4 v200, s[36:39], s93 offen lds
    buffer_load_dwordx4 v201, s[36:39], s93 offen offset:1024 lds
    buffer_load_dwordx4 v202, s[36:39], s93 offen offset:2048 lds
    buffer_load_dwordx4 v203, s[36:39], s93 offen offset:3072 lds
    s_add_u32 s94, s94, 2
    s_and_b32 s94, s94, 15
    s_mul_i32 s93, s94, s65
    s_add_u32 s93, s93, s62
    s_waitcnt vmcnt(16)
    s_barrier
    s_mov_b32 m0, 137216
    s_nop 0
    buffer_load_dwordx4 v200, s[36:39], s93 offen lds
    buffer_load_dwordx4 v201, s[36:39], s93 offen offset:1024 lds
    buffer_load_dwordx4 v202, s[36:39], s93 offen offset:2048 lds
    buffer_load_dwordx4 v203, s[36:39], s93 offen offset:3072 lds
    s_add_u32 s93, s93, s63
    s_mov_b32 m0, 141312
    s_nop 0
    buffer_load_dwordx4 v200, s[36:39], s93 offen lds
    buffer_load_dwordx4 v201, s[36:39], s93 offen offset:1024 lds
    buffer_load_dwordx4 v202, s[36:39], s93 offen offset:2048 lds
    buffer_load_dwordx4 v203, s[36:39], s93 offen offset:3072 lds
    s_add_u32 s93, s93, s63
    s_barrier
    s_mov_b32 m0, 145408
    s_nop 0
    buffer_load_dwordx4 v200, s[36:39], s93 offen lds
    buffer_load_dwordx4 v201, s[36:39], s93 offen offset:1024 lds
    buffer_load_dwordx4 v202, s[36:39], s93 offen offset:2048 lds
    buffer_load_dwordx4 v203, s[36:39], s93 offen offset:3072 lds
    s_add_u32 s93, s93, s63
    s_mov_b32 m0, 149504
    s_nop 0
    buffer_load_dwordx4 v200, s[36:39], s93 offen lds
    buffer_load_dwordx4 v201, s[36:39], s93 offen offset:1024 lds
    buffer_load_dwordx4 v202, s[36:39], s93 offen offset:2048 lds
    buffer_load_dwordx4 v203, s[36:39], s93 offen offset:3072 lds
    s_add_u32 s94, s94, 2
    s_and_b32 s94, s94, 15
    s_mul_i32 s93, s94, s65
    s_add_u32 s93, s93, s62
    s_waitcnt vmcnt(16)
    s_barrier
    s_mov_b32 m0, 100352
    s_nop 0
    buffer_load_dwordx4 v200, s[36:39], s93 offen lds
    buffer_load_dwordx4 v201, s[36:39], s93 offen offset:1024 lds
    buffer_load_dwordx4 v202, s[36:39], s93 offen offset:2048 lds
    buffer_load_dwordx4 v203, s[36:39], s93 offen offset:3072 lds
    s_add_u32 s93, s93, s63
    s_mov_b32 m0, 104448
    s_nop 0
    buffer_load_dwordx4 v200, s[36:39], s93 offen lds
    buffer_load_dwordx4 v201, s[36:39], s93 offen offset:1024 lds
    buffer_load_dwordx4 v202, s[36:39], s93 offen offset:2048 lds
    buffer_load_dwordx4 v203, s[36:39], s93 offen offset:3072 lds
    s_add_u32 s93, s93, s63
    s_barrier
    s_mov_b32 m0, 108544
    s_nop 0
    buffer_load_dwordx4 v200, s[36:39], s93 offen lds
    buffer_load_dwordx4 v201, s[36:39], s93 offen offset:1024 lds
    buffer_load_dwordx4 v202, s[36:39], s93 offen offset:2048 lds
    buffer_load_dwordx4 v203, s[36:39], s93 offen offset:3072 lds
    s_add_u32 s93, s93, s63
    s_mov_b32 m0, 112640
    s_nop 0
    buffer_load_dwordx4 v200, s[36:39], s93 offen lds
    buffer_load_dwordx4 v201, s[36:39], s93 offen offset:1024 lds
    buffer_load_dwordx4 v202, s[36:39], s93 offen offset:2048 lds
    buffer_load_dwordx4 v203, s[36:39], s93 offen offset:3072 lds
    s_add_u32 s94, s94, 2
    s_and_b32 s94, s94, 15
    s_mul_i32 s93, s94, s65
    s_add_u32 s93, s93, s62
    s_waitcnt vmcnt(16)
    s_barrier
    s_mov_b32 m0, 118784
    s_nop 0
    buffer_load_dwordx4 v200, s[36:39], s93 offen lds
    buffer_load_dwordx4 v201, s[36:39], s93 offen offset:1024 lds
    buffer_load_dwordx4 v202, s[36:39], s93 offen offset:2048 lds
    buffer_load_dwordx4 v203, s[36:39], s93 offen offset:3072 lds
    s_add_u32 s93, s93, s63
    s_mov_b32 m0, 122880
    s_nop 0
    buffer_load_dwordx4 v200, s[36:39], s93 offen lds
    buffer_load_dwordx4 v201, s[36:39], s93 offen offset:1024 lds
    buffer_load_dwordx4 v202, s[36:39], s93 offen offset:2048 lds
    buffer_load_dwordx4 v203, s[36:39], s93 offen offset:3072 lds
    s_add_u32 s93, s93, s63
    s_barrier
    s_mov_b32 m0, 126976
    s_nop 0
    buffer_load_dwordx4 v200, s[36:39], s93 offen lds
    buffer_load_dwordx4 v201, s[36:39], s93 offen offset:1024 lds
    buffer_load_dwordx4 v202, s[36:39], s93 offen offset:2048 lds
    buffer_load_dwordx4 v203, s[36:39], s93 offen offset:3072 lds
    s_add_u32 s93, s93, s63
    s_mov_b32 m0, 131072
    s_nop 0
    buffer_load_dwordx4 v200, s[36:39], s93 offen lds
    buffer_load_dwordx4 v201, s[36:39], s93 offen offset:1024 lds
    buffer_load_dwordx4 v202, s[36:39], s93 offen offset:2048 lds
    buffer_load_dwordx4 v203, s[36:39], s93 offen offset:3072 lds
    s_add_u32 s94, s94, 2
    s_and_b32 s94, s94, 15
    s_mul_i32 s93, s94, s65
    s_add_u32 s93, s93, s62
    s_waitcnt vmcnt(16)
    s_barrier
    s_mov_b32 m0, 137216
    s_nop 0
    buffer_load_dwordx4 v200, s[36:39], s93 offen lds
    buffer_load_dwordx4 v201, s[36:39], s93 offen offset:1024 lds
    buffer_load_dwordx4 v202, s[36:39], s93 offen offset:2048 lds
    buffer_load_dwordx4 v203, s[36:39], s93 offen offset:3072 lds
    s_add_u32 s93, s93, s63
    s_mov_b32 m0, 141312
    s_nop 0
    buffer_load_dwordx4 v200, s[36:39], s93 offen lds
    buffer_load_dwordx4 v201, s[36:39], s93 offen offset:1024 lds
    buffer_load_dwordx4 v202, s[36:39], s93 offen offset:2048 lds
    buffer_load_dwordx4 v203, s[36:39], s93 offen offset:3072 lds
    s_add_u32 s93, s93, s63
    s_barrier
    s_mov_b32 m0, 145408
    s_nop 0
    buffer_load_dwordx4 v200, s[36:39], s93 offen lds
    buffer_load_dwordx4 v201, s[36:39], s93 offen offset:1024 lds
    buffer_load_dwordx4 v202, s[36:39], s93 offen offset:2048 lds
    buffer_load_dwordx4 v203, s[36:39], s93 offen offset:3072 lds
    s_add_u32 s93, s93, s63
    s_mov_b32 m0, 149504
    s_nop 0
    buffer_load_dwordx4 v200, s[36:39], s93 offen lds
    buffer_load_dwordx4 v201, s[36:39], s93 offen offset:1024 lds
    buffer_load_dwordx4 v202, s[36:39], s93 offen offset:2048 lds
    buffer_load_dwordx4 v203, s[36:39], s93 offen offset:3072 lds
    s_add_u32 s94, s94, 2
    s_and_b32 s94, s94, 15
    s_mul_i32 s93, s94, s65
    s_add_u32 s93, s93, s62
    s_waitcnt vmcnt(16)
    s_barrier
    s_mov_b32 m0, 100352
    s_nop 0
    buffer_load_dwordx4 v200, s[36:39], s93 offen lds
    buffer_load_dwordx4 v201, s[36:39], s93 offen offset:1024 lds
    buffer_load_dwordx4 v202, s[36:39], s93 offen offset:2048 lds
    buffer_load_dwordx4 v203, s[36:39], s93 offen offset:3072 lds
    s_add_u32 s93, s93, s63
    s_mov_b32 m0, 104448
    s_nop 0
    buffer_load_dwordx4 v200, s[36:39], s93 offen lds
    buffer_load_dwordx4 v201, s[36:39], s93 offen offset:1024 lds
    buffer_load_dwordx4 v202, s[36:39], s93 offen offset:2048 lds
    buffer_load_dwordx4 v203, s[36:39], s93 offen offset:3072 lds
    s_add_u32 s93, s93, s63
    s_barrier
    s_mov_b32 m0, 108544
    s_nop 0
    buffer_load_dwordx4 v200, s[36:39], s93 offen lds
    buffer_load_dwordx4 v201, s[36:39], s93 offen offset:1024 lds
    buffer_load_dwordx4 v202, s[36:39], s93 offen offset:2048 lds
    buffer_load_dwordx4 v203, s[36:39], s93 offen offset:3072 lds
    s_add_u32 s93, s93, s63
    s_mov_b32 m0, 112640
    s_nop 0
    buffer_load_dwordx4 v200, s[36:39], s93 offen lds
    buffer_load_dwordx4 v201, s[36:39], s93 offen offset:1024 lds
    buffer_load_dwordx4 v202, s[36:39], s93 offen offset:2048 lds
    buffer_load_dwordx4 v203, s[36:39], s93 offen offset:3072 lds
    s_add_u32 s94, s94, 2
    s_and_b32 s94, s94, 15
    s_mul_i32 s93, s94, s65
    s_add_u32 s93, s93, s62
    s_waitcnt vmcnt(16)
    s_barrier
    s_barrier
    s_waitcnt vmcnt(0)
    s_barrier
    s_barrier
    s_barrier
    v_mov_b32 v224, 157568
    ds_read_b32 v224, v224
    s_waitcnt lgkmcnt(0)
    v_readfirstlane_b32 s45, v224
    s_branch YA_g2
YS_g1:
    s_add_u32 s93, s93, s63
    s_add_u32 s93, s93, s63
    s_mov_b32 m0, 108544
    s_nop 0
    buffer_load_dwordx4 v200, s[36:39], s93 offen lds
    buffer_load_dwordx4 v201, s[36:39], s93 offen offset:1024 lds
    buffer_load_dwordx4 v202, s[36:39], s93 offen offset:2048 lds
    buffer_load_dwordx4 v203, s[36:39], s93 offen offset:3072 lds
    s_add_u32 s93, s93, s63
    s_mov_b32 m0, 112640
    s_nop 0
    buffer_load_dwordx4 v200, s[36:39], s93 offen lds
    buffer_load_dwordx4 v201, s[36:39], s93 offen offset:1024 lds
    buffer_load_dwordx4 v202, s[36:39], s93 offen offset:2048 lds
    buffer_load_dwordx4 v203, s[36:39], s93 offen offset:3072 lds
    s_add_u32 s94, s94, 2
    s_and_b32 s94, s94, 15
    s_mul_i32 s93, s94, s65
    s_add_u32 s93, s93, s62
    s_add_u32 s93, s93, s63
    s_add_u32 s93, s93, s63
    s_mov_b32 m0, 126976
    s_nop 0
    buffer_load_dwordx4 v200, s[36:39], s93 offen lds
    buffer_load_dwordx4 v201, s[36:39], s93 offen offset:1024 lds
    buffer_load_dwordx4 v202, s[36:39], s93 offen offset:2048 lds
    buffer_load_dwordx4 v203, s[36:39], s93 offen offset:3072 lds
    s_add_u32 s93, s93, s63
    s_mov_b32 m0, 131072
    s_nop 0
    buffer_load_dwordx4 v200, s[36:39], s93 offen lds
    buffer_load_dwordx4 v201, s[36:39], s93 offen offset:1024 lds
    buffer_load_dwordx4 v202, s[36:39], s93 offen offset:2048 lds
    buffer_load_dwordx4 v203, s[36:39], s93 offen offset:3072 lds
    s_add_u32 s94, s94, 2
    s_and_b32 s94, s94, 15
    s_mul_i32 s93, s94, s65
    s_add_u32 s93, s93, s62
    s_setprio 1
    s_waitcnt vmcnt(8)
    s_barrier
    s_waitcnt lgkmcnt(0)
    s_barrier
    s_waitcnt vmcnt(0) lgkmcnt(0)
    s_barrier
    s_waitcnt lgkmcnt(0)
    s_barrier
    s_lshl_b32 s55, s51, 2
    s_add_u32 s55, s55, s54
    v_mov_b32 v252, 14336
    v_mov_b32 v250, 0x01010101
    s_mov_b64 exec, 1
    buffer_store_dword v250, v252, s[4:7], s55 offen sc0 sc1
    s_mov_b64 exec, -1
    s_waitcnt lgkmcnt(0)
    s_barrier
    s_waitcnt lgkmcnt(0)
    s_barrier
    s_waitcnt lgkmcnt(0)
    s_barrier
    s_waitcnt lgkmcnt(0)
    s_barrier
    v_lshrrev_b32 v252, 2, v254
    v_min_u32 v252, 60, v252
    s_add_u32 s55, s54, 14336
    buffer_load_dword v251, v252, s[4:7], s55 offen sc0 sc1
    s_waitcnt lgkmcnt(0)
    s_barrier
    s_waitcnt lgkmcnt(0)
    s_barrier
    s_waitcnt lgkmcnt(0)
    s_barrier
    s_waitcnt vmcnt(0)
    v_cmp_ne_u32 vcc, 0x01010101, v251
    s_cbranch_vccz ap_35
    v_lshrrev_b32 v252, 2, v254
    v_min_u32 v252, 60, v252
    s_add_u32 s55, s54, 14336
    s_mov_b32 s56, 262144
poll_36:
    buffer_load_dword v253, v252, s[4:7], s55 offen sc0 sc1
    s_waitcnt vmcnt(0)
    v_cmp_ne_u32 vcc, 0x01010101, v253
    s_cbranch_vccz pd_37
    s_sleep 1
    s_sub_u32 s56, s56, 1
    s_cmp_lg_u32 s56, 0
    s_cbranch_scc1 poll_36
pd_37:
ap_35:
    s_add_u32 s55, s53, 0
    buffer_load_dwordx4 v[0:3], v254, s[4:7], s55 offen offset:0
    buffer_load_dwordx4 v[4:7], v254, s[4:7], s55 offen offset:1024
    buffer_load_dwordx4 v[8:11], v254, s[4:7], s55 offen offset:2048
    buffer_load_dwordx4 v[12:15], v254, s[4:7], s55 offen offset:3072
    s_waitcnt lgkmcnt(0)
    s_barrier
    s_add_u32 s55, s53, 4096
    buffer_load_dwordx4 v[16:19], v254, s[4:7], s55 offen offset:0
    buffer_load_dwordx4 v[20:23], v254, s[4:7], s55 offen offset:1024
    buffer_load_dwordx4 v[24:27], v254, s[4:7], s55 offen offset:2048
    buffer_load_dwordx4 v[28:31], v254, s[4:7], s55 offen offset:3072
    s_waitcnt lgkmcnt(0)
    s_barrier
    s_add_u32 s55, s53, 8192
    buffer_load_dwordx4 v[32:35], v254, s[4:7], s55 offen offset:0
    buffer_load_dwordx4 v[36:39], v254, s[4:7], s55 offen offset:1024
    buffer_load_dwordx4 v[40:43], v254, s[4:7], s55 offen offset:2048
    buffer_load_dwordx4 v[44:47], v254, s[4:7], s55 offen offset:3072
    s_waitcnt lgkmcnt(0)
    s_barrier
    s_add_u32 s55, s53, 12288
    buffer_load_dwordx4 v[48:51], v254, s[4:7], s55 offen offset:0
    buffer_load_dwordx4 v[52:55], v254, s[4:7], s55 offen offset:1024
    buffer_load_dwordx4 v[56:59], v254, s[4:7], s55 offen offset:2048
    buffer_load_dwordx4 v[60:63], v254, s[4:7], s55 offen offset:3072
    s_waitcnt lgkmcnt(0)
    s_barrier
    s_add_u32 s55, s53, 16384
    buffer_load_dwordx4 v[64:67], v254, s[4:7], s55 offen offset:0
    buffer_load_dwordx4 v[68:71], v254, s[4:7], s55 offen offset:1024
    buffer_load_dwordx4 v[72:75], v254, s[4:7], s55 offen offset:2048
    buffer_load_dwordx4 v[76:79], v254, s[4:7], s55 offen offset:3072
    s_waitcnt vmcnt(19)
    v_mov_b32 v128, v0
    v_mov_b32 v129, v1
    v_mov_b32 v130, v2
    v_mov_b32 v131, v3
    s_waitcnt vmcnt(18)
    v_add_f32 v128, v128, v4
    v_add_f32 v129, v129, v5
    v_add_f32 v130, v130, v6
    v_add_f32 v131, v131, v7
    s_waitcnt vmcnt(17)
    v_add_f32 v128, v128, v8
    v_add_f32 v129, v129, v9
    v_add_f32 v130, v130, v10
    v_add_f32 v131, v131, v11
    s_waitcnt vmcnt(16)
    v_add_f32 v128, v128, v12
    v_add_f32 v129, v129, v13
    v_add_f32 v130, v130, v14
    v_add_f32 v131, v131, v15
    s_waitcnt lgkmcnt(0)
    s_barrier
    s_add_u32 s55, s53, 20480
    buffer_load_dwordx4 v[80:83], v254, s[4:7], s55 offen offset:0
    buffer_load_dwordx4 v[84:87], v254, s[4:7], s55 offen offset:1024
    buffer_load_dwordx4 v[88:91], v254, s[4:7], s55 offen offset:2048
    buffer_load_dwordx4 v[92:95], v254, s[4:7], s55 offen offset:3072
    s_waitcnt vmcnt(19)
    v_add_f32 v128, v128, v16
    v_add_f32 v129, v129, v17
    v_add_f32 v130, v130, v18
    v_add_f32 v131, v131, v19
    s_waitcnt vmcnt(18)
    v_add_f32 v128, v128, v20
    v_add_f32 v129, v129, v21
    v_add_f32 v130, v130, v22
    v_add_f32 v131, v131, v23
    s_waitcnt vmcnt(17)
    v_add_f32 v128, v128, v24
    v_add_f32 v129, v129, v25
    v_add_f32 v130, v130, v26
    v_add_f32 v131, v131, v27
    s_waitcnt vmcnt(16)
    v_add_f32 v128, v128, v28
    v_add_f32 v129, v129, v29
    v_add_f32 v130, v130, v30
    v_add_f32 v131, v131, v31
    s_waitcnt lgkmcnt(0)
    s_barrier
    s_add_u32 s55, s53, 24576
    buffer_load_dwordx4 v[96:99], v254, s[4:7], s55 offen offset:0
    buffer_load_dwordx4 v[100:103], v254, s[4:7], s55 offen offset:1024
    buffer_load_dwordx4 v[104:107], v254, s[4:7], s55 offen offset:2048
    buffer_load_dwordx4 v[108:111], v254, s[4:7], s55 offen offset:3072
    s_waitcnt vmcnt(19)
    v_add_f32 v128, v128, v32
    v_add_f32 v129, v129, v33
    v_add_f32 v130, v130, v34
    v_add_f32 v131, v131, v35
    s_waitcnt vmcnt(18)
    v_add_f32 v128, v128, v36
    v_add_f32 v129, v129, v37
    v_add_f32 v130, v130, v38
    v_add_f32 v131, v131, v39
    s_waitcnt vmcnt(17)
    v_add_f32 v128, v128, v40
    v_add_f32 v129, v129, v41
    v_add_f32 v130, v130, v42
    v_add_f32 v131, v131, v43
    s_waitcnt vmcnt(16)
    v_add_f32 v128, v128, v44
    v_add_f32 v129, v129, v45
    v_add_f32 v130, v130, v46
    v_add_f32 v131, v131, v47
    s_waitcnt lgkmcnt(0)
    s_barrier
    s_add_u32 s55, s53, 28672
    buffer_load_dwordx4 v[112:115], v254, s[4:7], s55 offen offset:0
    buffer_load_dwordx4 v[116:119], v254, s[4:7], s55 offen offset:1024
    buffer_load_dwordx4 v[120:123], v254, s[4:7], s55 offen offset:2048
    buffer_load_dwordx4 v[124:127], v254, s[4:7], s55 offen offset:3072
    s_waitcnt vmcnt(19)
    v_add_f32 v128, v128, v48
    v_add_f32 v129, v129, v49
    v_add_f32 v130, v130, v50
    v_add_f32 v131, v131, v51
    s_waitcnt vmcnt(18)
    v_add_f32 v128, v128, v52
    v_add_f32 v129, v129, v53
    v_add_f32 v130, v130, v54
    v_add_f32 v131, v131, v55
    s_waitcnt vmcnt(17)
    v_add_f32 v128, v128, v56
    v_add_f32 v129, v129, v57
    v_add_f32 v130, v130, v58
    v_add_f32 v131, v131, v59
    s_waitcnt vmcnt(16)
    v_add_f32 v128, v128, v60
    v_add_f32 v129, v129, v61
    v_add_f32 v130, v130, v62
    v_add_f32 v131, v131, v63
    s_waitcnt lgkmcnt(0)
    s_barrier
    v_lshrrev_b32 v252, 2, v254
    v_min_u32 v252, 60, v252
    s_add_u32 s55, s54, 14208
    buffer_load_dword v251, v252, s[4:7], s55 offen sc0 sc1
    s_waitcnt vmcnt(16)
    v_add_f32 v128, v128, v64
    v_add_f32 v129, v129, v65
    v_add_f32 v130, v130, v66
    v_add_f32 v131, v131, v67
    s_waitcnt vmcnt(15)
    v_add_f32 v128, v128, v68
    v_add_f32 v129, v129, v69
    v_add_f32 v130, v130, v70
    v_add_f32 v131, v131, v71
    s_waitcnt vmcnt(14)
    v_add_f32 v128, v128, v72
    v_add_f32 v129, v129, v73
    v_add_f32 v130, v130, v74
    v_add_f32 v131, v131, v75
    s_waitcnt vmcnt(13)
    v_add_f32 v128, v128, v76
    v_add_f32 v129, v129, v77
    v_add_f32 v130, v130, v78
    v_add_f32 v131, v131, v79
    s_waitcnt lgkmcnt(0)
    s_barrier
    s_waitcnt vmcnt(12)
    v_add_f32 v128, v128, v80
    v_add_f32 v129, v129, v81
    v_add_f32 v130, v130, v82
    v_add_f32 v131, v131, v83
    s_waitcnt vmcnt(11)
    v_add_f32 v128, v128, v84
    v_add_f32 v129, v129, v85
    v_add_f32 v130, v130, v86
    v_add_f32 v131, v131, v87
    s_waitcnt vmcnt(10)
    v_add_f32 v128, v128, v88
    v_add_f32 v129, v129, v89
    v_add_f32 v130, v130, v90
    v_add_f32 v131, v131, v91
    s_waitcnt vmcnt(9)
    v_add_f32 v128, v128, v92
    v_add_f32 v129, v129, v93
    v_add_f32 v130, v130, v94
    v_add_f32 v131, v131, v95
    s_waitcnt lgkmcnt(0)
    s_barrier
    s_waitcnt vmcnt(8)
    v_add_f32 v128, v128, v96
    v_add_f32 v129, v129, v97
    v_add_f32 v130, v130, v98
    v_add_f32 v131, v131, v99
    s_waitcnt vmcnt(7)
    v_add_f32 v128, v128, v100
    v_add_f32 v129, v129, v101
    v_add_f32 v130, v130, v102
    v_add_f32 v131, v131, v103
    s_waitcnt vmcnt(6)
    v_add_f32 v128, v128, v104
    v_add_f32 v129, v129, v105
    v_add_f32 v130, v130, v106
    v_add_f32 v131, v131, v107
    s_waitcnt vmcnt(5)
    v_add_f32 v128, v128, v108
    v_add_f32 v129, v129, v109
    v_add_f32 v130, v130, v110
    v_add_f32 v131, v131, v111
    s_waitcnt lgkmcnt(0)
    s_barrier
    s_waitcnt vmcnt(4)
    v_add_f32 v128, v128, v112
    v_add_f32 v129, v129, v113
    v_add_f32 v130, v130, v114
    v_add_f32 v131, v131, v115
    s_waitcnt vmcnt(3)
    v_add_f32 v128, v128, v116
    v_add_f32 v129, v129, v117
    v_add_f32 v130, v130, v118
    v_add_f32 v131, v131, v119
    s_waitcnt vmcnt(2)
    v_add_f32 v128, v128, v120
    v_add_f32 v129, v129, v121
    v_add_f32 v130, v130, v122
    v_add_f32 v131, v131, v123
    s_waitcnt vmcnt(1)
    v_add_f32 v128, v128, v124
    v_add_f32 v129, v129, v125
    v_add_f32 v130, v130, v126
    v_add_f32 v131, v131, v127
    s_waitcnt lgkmcnt(0)
    s_barrier
    s_waitcnt vmcnt(0)
    v_cmp_ne_u32 vcc, 0x01010101, v251
    s_cbranch_vccz ap_38
    s_cmp_eq_u32 s40, 0
    s_cbranch_scc1 ap_38
    v_lshrrev_b32 v252, 2, v254
    v_min_u32 v252, 60, v252
    s_add_u32 s55, s54, 14208
    s_mov_b32 s56, 262144
poll_39:
    buffer_load_dword v253, v252, s[4:7], s55 offen sc0 sc1
    s_waitcnt vmcnt(0)
    v_cmp_ne_u32 vcc, 0x01010101, v253
    s_cbranch_vccz pd_40
    s_sleep 1
    s_sub_u32 s56, s56, 1
    s_cmp_lg_u32 s56, 0
    s_cbranch_scc1 poll_39
pd_40:
ap_38:
    s_sub_u32 s55, s53, 4193408
    s_cmp_eq_u32 s40, 0
    s_cselect_b32 s55, 2130706432, s55
    v_lshrrev_b32 v224, 7, v254
    v_and_b32 v225, 0x70, v254
    v_lshl_add_u32 v224, v224, 10, v225
    buffer_load_dwordx4 v[0:3], v224, s[4:7], s55 offen
    s_add_u32 s55, s55, 8192
    buffer_load_dwordx4 v[4:7], v224, s[4:7], s55 offen
    s_add_u32 s55, s55, 8192
    buffer_load_dwordx4 v[8:11], v224, s[4:7], s55 offen
    s_add_u32 s55, s55, 8192
    buffer_load_dwordx4 v[12:15], v224, s[4:7], s55 offen
    s_add_u32 s55, s55, 8192
    s_waitcnt lgkmcnt(0)
    s_barrier
    v_mul_f32 v128, 0x3a800000, v128
    v_mul_f32 v129, 0x3a800000, v129
    v_fma_f32 v129, -v128, v128, v129
    v_max_f32 v129, 0, v129
    v_cvt_pk_bf16_f32 v128, v128, v128
    v_lshlrev_b32 v128, 16, v128
    v_cvt_pk_bf16_f32 v129, v129, v129
    v_lshlrev_b32 v129, 16, v129
    v_add_f32 v129, 0x3727c5ac, v129
    v_cvt_pk_bf16_f32 v129, v129, v129
    v_lshlrev_b32 v129, 16, v129
    v_sqrt_f32 v129, v129
    s_nop 0
    v_cvt_pk_bf16_f32 v129, v129, v129
    v_lshlrev_b32 v129, 16, v129
    v_rcp_f32 v129, v129
    s_nop 0
    v_mul_f32 v130, 0x3a800000, v130
    v_mul_f32 v131, 0x3a800000, v131
    v_fma_f32 v131, -v130, v130, v131
    v_max_f32 v131, 0, v131
    v_cvt_pk_bf16_f32 v130, v130, v130
    v_lshlrev_b32 v130, 16, v130
    v_cvt_pk_bf16_f32 v131, v131, v131
    v_lshlrev_b32 v131, 16, v131
    v_add_f32 v131, 0x3727c5ac, v131
    v_cvt_pk_bf16_f32 v131, v131, v131
    v_lshlrev_b32 v131, 16, v131
    v_sqrt_f32 v131, v131
    s_nop 0
    v_cvt_pk_bf16_f32 v131, v131, v131
    v_lshlrev_b32 v131, 16, v131
    v_rcp_f32 v131, v131
    s_nop 0
    v_lshrrev_b32 v224, 1, v254
    v_add_u32 v224, 153664, v224
    v_sub_f32 v128, 0, v128
    v_sub_f32 v130, 0, v130
    ds_write2_b32 v224, v128, v130 offset0:0 offset1:1
    ds_write2_b32 v224, v129, v131 offset0:144 offset1:145
    s_waitcnt lgkmcnt(0)
    s_barrier
    s_waitcnt lgkmcnt(0)
    s_barrier
    s_waitcnt lgkmcnt(0)
    s_barrier
    s_waitcnt lgkmcnt(0)
    s_barrier
    s_waitcnt vmcnt(0)
    v_add_f32 v0, v0, v4
    v_add_f32 v8, v8, v12
    v_add_f32 v1, v1, v5
    v_add_f32 v9, v9, v13
    v_add_f32 v2, v2, v6
    v_add_f32 v10, v10, v14
    v_add_f32 v3, v3, v7
    v_add_f32 v11, v11, v15
    v_add_f32 v0, v0, v8
    v_add_f32 v1, v1, v9
    v_add_f32 v2, v2, v10
    v_add_f32 v3, v3, v11
    s_nop 1
    v_add_f32_dpp v0, v0, v0 row_ror:8 row_mask:0xf bank_mask:0xf
    v_add_f32_dpp v1, v1, v1 row_ror:8 row_mask:0xf bank_mask:0xf
    v_add_f32_dpp v2, v2, v2 row_ror:8 row_mask:0xf bank_mask:0xf
    v_add_f32_dpp v3, v3, v3 row_ror:8 row_mask:0xf bank_mask:0xf
    v_mov_b32 v4, v0
    v_mov_b32 v5, v1
    v_mov_b32 v6, v2
    v_mov_b32 v7, v3
    s_nop 1
    v_permlane16_swap_b32 v0, v4
    v_permlane16_swap_b32 v1, v5
    v_permlane16_swap_b32 v2, v6
    v_permlane16_swap_b32 v3, v7
    v_add_f32 v0, v0, v4
    v_add_f32 v1, v1, v5
    v_add_f32 v2, v2, v6
    v_add_f32 v3, v3, v7
    v_mov_b32 v4, v0
    v_mov_b32 v5, v1
    v_mov_b32 v6, v2
    v_mov_b32 v7, v3
    s_nop 1
    v_permlane32_swap_b32 v0, v4
    v_permlane32_swap_b32 v1, v5
    v_permlane32_swap_b32 v2, v6
    v_permlane32_swap_b32 v3, v7
    v_add_f32 v0, v0, v4
    v_add_f32 v1, v1, v5
    v_add_f32 v2, v2, v6
    v_add_f32 v3, v3, v7
    s_waitcnt lgkmcnt(0)
    s_barrier
    v_mul_f32 v0, 0x3a800000, v0
    v_mul_f32 v1, 0x3a800000, v1
    v_fma_f32 v1, -v0, v0, v1
    v_max_f32 v1, 0, v1
    v_cvt_pk_bf16_f32 v0, v0, v0
    v_lshlrev_b32 v0, 16, v0
    v_cvt_pk_bf16_f32 v1, v1, v1
    v_lshlrev_b32 v1, 16, v1
    v_add_f32 v1, 0x3727c5ac, v1
    v_cvt_pk_bf16_f32 v1, v1, v1
    v_lshlrev_b32 v1, 16, v1
    v_sqrt_f32 v1, v1
    s_nop 0
    v_cvt_pk_bf16_f32 v1, v1, v1
    v_lshlrev_b32 v1, 16, v1
    v_rcp_f32 v1, v1
    s_nop 0
    v_mul_f32 v2, 0x3a800000, v2
    v_mul_f32 v3, 0x3a800000, v3
    v_fma_f32 v3, -v2, v2, v3
    v_max_f32 v3, 0, v3
    v_cvt_pk_bf16_f32 v2, v2, v2
    v_lshlrev_b32 v2, 16, v2
    v_cvt_pk_bf16_f32 v3, v3, v3
    v_lshlrev_b32 v3, 16, v3
    v_add_f32 v3, 0x3727c5ac, v3
    v_cvt_pk_bf16_f32 v3, v3, v3
    v_lshlrev_b32 v3, 16, v3
    v_sqrt_f32 v3, v3
    s_nop 0
    v_cvt_pk_bf16_f32 v3, v3, v3
    v_lshlrev_b32 v3, 16, v3
    v_rcp_f32 v3, v3
    s_nop 0
    v_lshrrev_b32 v224, 1, v254
    v_add_u32 v224, 153600, v224
    v_sub_f32 v0, 0, v0
    v_sub_f32 v2, 0, v2
    s_mov_b64 exec, 0xff
    ds_write2_b32 v224, v0, v2 offset0:0 offset1:1
    ds_write2_b32 v224, v1, v3 offset0:144 offset1:145
    s_mov_b64 exec, -1
    s_waitcnt lgkmcnt(0)
    s_barrier
    s_waitcnt lgkmcnt(0)
    s_barrier
    s_waitcnt lgkmcnt(0)
    s_barrier
    s_waitcnt lgkmcnt(0)
    s_barrier
    s_setprio 0
YA_g2:
    s_lshl_b32 s61, s43, 13
    s_add_u32 s62, s47, s61
    s_lshl_b32 s94, s51, 14
    s_barrier
    s_add_u32 m0, s61, 98304
    s_add_u32 s59, s62, s94
    buffer_load_dwordx4 v254, s[4:7], s59 offen lds
    buffer_load_dwordx4 v254, s[4:7], s59 offen offset:1024 lds
    buffer_load_dwordx4 v254, s[4:7], s59 offen offset:2048 lds
    buffer_load_dwordx4 v254, s[4:7], s59 offen offset:3072 lds
    s_add_u32 m0, s61, 102400
    s_add_u32 s60, s59, 4096
    buffer_load_dwordx4 v254, s[4:7], s60 offen lds
    buffer_load_dwordx4 v254, s[4:7], s60 offen offset:1024 lds
    s_add_u32 s94, s94, 32768
    s_and_b32 s94, s94, 0x3ffff
    buffer_load_dwordx4 v254, s[4:7], s60 offen offset:2048 lds
    buffer_load_dwordx4 v254, s[4:7], s60 offen offset:3072 lds
    s_waitcnt vmcnt(0)
    s_barrier
    v_lshrrev_b32 v252, 2, v254
    v_min_u32 v252, 28, v252
    s_add_u32 s55, s0, 0
    s_mov_b32 s56, 262144
poll_41:
    buffer_load_dword v253, v252, s[4:7], s55 offen sc0 sc1
    s_waitcnt vmcnt(0)
    v_cmp_ne_u32 vcc, 0x01010101, v253
    s_cbranch_vccz pd_42
    s_sleep 1
    s_sub_u32 s56, s56, 1
    s_cmp_lg_u32 s56, 0
    s_cbranch_scc1 poll_41
pd_42:
    s_add_u32 m0, s61, 114688
    s_add_u32 s59, s62, s94
    buffer_load_dwordx4 v254, s[4:7], s59 offen lds
    buffer_load_dwordx4 v254, s[4:7], s59 offen offset:1024 lds
    buffer_load_dwordx4 v254, s[4:7], s59 offen offset:2048 lds
    buffer_load_dwordx4 v254, s[4:7], s59 offen offset:3072 lds
    s_add_u32 m0, s61, 118784
    s_add_u32 s60, s59, 4096
    buffer_load_dwordx4 v254, s[4:7], s60 offen lds
    buffer_load_dwordx4 v254, s[4:7], s60 offen offset:1024 lds
    s_add_u32 s94, s94, 32768
    s_and_b32 s94, s94, 0x3ffff
    buffer_load_dwordx4 v254, s[4:7], s60 offen offset:2048 lds
    buffer_load_dwordx4 v254, s[4:7], s60 offen offset:3072 lds
    s_add_u32 m0, s61, 131072
    s_add_u32 s59, s62, s94
    buffer_load_dwordx4 v254, s[4:7], s59 offen lds
    buffer_load_dwordx4 v254, s[4:7], s59 offen offset:1024 lds
    buffer_load_dwordx4 v254, s[4:7], s59 offen offset:2048 lds
    buffer_load_dwordx4 v254, s[4:7], s59 offen offset:3072 lds
    s_add_u32 m0, s61, 135168
    s_add_u32 s60, s59, 4096
    buffer_load_dwordx4 v254, s[4:7], s60 offen lds
    buffer_load_dwordx4 v254, s[4:7], s60 offen offset:1024 lds
    s_add_u32 s94, s94, 32768
    s_and_b32 s94, s94, 0x3ffff
    buffer_load_dwordx4 v254, s[4:7], s60 offen offset:2048 lds
    buffer_load_dwordx4 v254, s[4:7], s60 offen offset:3072 lds
    s_waitcnt vmcnt(8)
    s_barrier
    s_add_u32 m0, s61, 98304
    s_add_u32 s59, s62, s94
    buffer_load_dwordx4 v254, s[4:7], s59 offen lds
    buffer_load_dwordx4 v254, s[4:7], s59 offen offset:1024 lds
    buffer_load_dwordx4 v254, s[4:7], s59 offen offset:2048 lds
    buffer_load_dwordx4 v254, s[4:7], s59 offen offset:3072 lds
    s_add_u32 m0, s61, 102400
    s_add_u32 s60, s59, 4096
    buffer_load_dwordx4 v254, s[4:7], s60 offen lds
    buffer_load_dwordx4 v254, s[4:7], s60 offen offset:1024 lds
    s_add_u32 s94, s94, 32768
    s_and_b32 s94, s94, 0x3ffff
    buffer_load_dwordx4 v254, s[4:7], s60 offen offset:2048 lds
    buffer_load_dwordx4 v254, s[4:7], s60 offen offset:3072 lds
    s_waitcnt vmcnt(8)
    s_barrier
    s_add_u32 m0, s61, 114688
    s_add_u32 s59, s62, s94
    buffer_load_dwordx4 v254, s[4:7], s59 offen lds
    buffer_load_dwordx4 v254, s[4:7], s59 offen offset:1024 lds
    buffer_load_dwordx4 v254, s[4:7], s59 offen offset:2048 lds
    buffer_load_dwordx4 v254, s[4:7], s59 offen offset:3072 lds
    s_add_u32 m0, s61, 118784
    s_add_u32 s60, s59, 4096
    buffer_load_dwordx4 v254, s[4:7], s60 offen lds
    buffer_load_dwordx4 v254, s[4:7], s60 offen offset:1024 lds
    s_add_u32 s94, s94, 32768
    s_and_b32 s94, s94, 0x3ffff
    buffer_load_dwordx4 v254, s[4:7], s60 offen offset:2048 lds
    buffer_load_dwordx4 v254, s[4:7], s60 offen offset:3072 lds
    s_waitcnt vmcnt(8)
    s_barrier
    s_add_u32 m0, s61, 131072
    s_add_u32 s59, s62, s94
    buffer_load_dwordx4 v254, s[4:7], s59 offen lds
    buffer_load_dwordx4 v254, s[4:7], s59 offen offset:1024 lds
    buffer_load_dwordx4 v254, s[4:7], s59 offen offset:2048 lds
    buffer_load_dwordx4 v254, s[4:7], s59 offen offset:3072 lds
    s_add_u32 m0, s61, 135168
    s_add_u32 s60, s59, 4096
    buffer_load_dwordx4 v254, s[4:7], s60 offen lds
    buffer_load_dwordx4 v254, s[4:7], s60 offen offset:1024 lds
    s_add_u32 s94, s94, 32768
    s_and_b32 s94, s94, 0x3ffff
    buffer_load_dwordx4 v254, s[4:7], s60 offen offset:2048 lds
    buffer_load_dwordx4 v254, s[4:7], s60 offen offset:3072 lds
    s_waitcnt vmcnt(8)
    s_barrier
    v_lshrrev_b32 v252, 2, v254
    v_min_u32 v252, 60, v252
    s_add_u32 s55, s54, 0
    buffer_load_dword v251, v252, s[4:7], s55 offen sc0 sc1
    s_add_u32 m0, s61, 98304
    s_add_u32 s59, s62, s94
    buffer_load_dwordx4 v254, s[4:7], s59 offen lds
    buffer_load_dwordx4 v254, s[4:7], s59 offen offset:1024 lds
    buffer_load_dwordx4 v254, s[4:7], s59 offen offset:2048 lds
    buffer_load_dwordx4 v254, s[4:7], s59 offen offset:3072 lds
    s_add_u32 m0, s61, 102400
    s_add_u32 s60, s59, 4096
    buffer_load_dwordx4 v254, s[4:7], s60 offen lds
    buffer_load_dwordx4 v254, s[4:7], s60 offen offset:1024 lds
    s_add_u32 s94, s94, 32768
    s_and_b32 s94, s94, 0x3ffff
    buffer_load_dwordx4 v254, s[4:7], s60 offen offset:2048 lds
    buffer_load_dwordx4 v254, s[4:7], s60 offen offset:3072 lds
    s_waitcnt vmcnt(9)
    s_barrier
    s_add_u32 m0, s61, 114688
    s_add_u32 s59, s62, s94
    buffer_load_dwordx4 v254, s[4:7], s59 offen lds
    buffer_load_dwordx4 v254, s[4:7], s59 offen offset:1024 lds
    buffer_load_dwordx4 v254, s[4:7], s59 offen offset:2048 lds
    buffer_load_dwordx4 v254, s[4:7], s59 offen offset:3072 lds
    s_add_u32 m0, s61, 118784
    s_add_u32 s60, s59, 4096
    buffer_load_dwordx4 v254, s[4:7], s60 offen lds
    buffer_load_dwordx4 v254, s[4:7], s60 offen offset:1024 lds
    s_add_u32 s94, s94, 49152
    s_and_b32 s94, s94, 0x3ffff
    buffer_load_dwordx4 v254, s[4:7], s60 offen offset:2048 lds
    buffer_load_dwordx4 v254, s[4:7], s60 offen offset:3072 lds
    s_waitcnt vmcnt(8)
    s_barrier
    v_cmp_ne_u32 vcc, 0x01010101, v251
    s_cbranch_vccz ap_43
    v_lshrrev_b32 v252, 2, v254
    v_min_u32 v252, 60, v252
    s_add_u32 s55, s54, 0
    s_mov_b32 s56, 262144
poll_44:
    buffer_load_dword v253, v252, s[4:7], s55 offen sc0 sc1
    s_waitcnt vmcnt(0)
    v_cmp_ne_u32 vcc, 0x01010101, v253
    s_cbranch_vccz pd_45
    s_sleep 1
    s_sub_u32 s56, s56, 1
    s_cmp_lg_u32 s56, 0
    s_cbranch_scc1 poll_44
pd_45:
ap_43:
    s_add_u32 m0, s61, 131072
    s_add_u32 s59, s62, s94
    buffer_load_dwordx4 v254, s[4:7], s59 offen lds
    buffer_load_dwordx4 v254, s[4:7], s59 offen offset:1024 lds
    buffer_load_dwordx4 v254, s[4:7], s59 offen offset:2048 lds
    buffer_load_dwordx4 v254, s[4:7], s59 offen offset:3072 lds
    s_add_u32 m0, s61, 135168
    s_add_u32 s60, s59, 4096
    buffer_load_dwordx4 v254, s[4:7], s60 offen lds
    buffer_load_dwordx4 v254, s[4:7], s60 offen offset:1024 lds
    s_add_u32 s94, s94, 32768
    s_and_b32 s94, s94, 0x3ffff
    buffer_load_dwordx4 v254, s[4:7], s60 offen offset:2048 lds
    buffer_load_dwordx4 v254, s[4:7], s60 offen offset:3072 lds
    s_waitcnt vmcnt(8)
    s_barrier
    s_add_u32 m0, s61, 98304
    s_add_u32 s59, s62, s94
    buffer_load_dwordx4 v254, s[4:7], s59 offen lds
    buffer_load_dwordx4 v254, s[4:7], s59 offen offset:1024 lds
    buffer_load_dwordx4 v254, s[4:7], s59 offen offset:2048 lds
    buffer_load_dwordx4 v254, s[4:7], s59 offen offset:3072 lds
    s_add_u32 m0, s61, 102400
    s_add_u32 s60, s59, 4096
    buffer_load_dwordx4 v254, s[4:7], s60 offen lds
    buffer_load_dwordx4 v254, s[4:7], s60 offen offset:1024 lds
    s_add_u32 s94, s94, 32768
    s_and_b32 s94, s94, 0x3ffff
    buffer_load_dwordx4 v254, s[4:7], s60 offen offset:2048 lds
    buffer_load_dwordx4 v254, s[4:7], s60 offen offset:3072 lds
    s_waitcnt vmcnt(8)
    s_barrier
    s_add_u32 m0, s61, 114688
    s_add_u32 s59, s62, s94
    buffer_load_dwordx4 v254, s[4:7], s59 offen lds
    buffer_load_dwordx4 v254, s[4:7], s59 offen offset:1024 lds
    buffer_load_dwordx4 v254, s[4:7], s59 offen offset:2048 lds
    buffer_load_dwordx4 v254, s[4:7], s59 offen offset:3072 lds
    s_add_u32 m0, s61, 118784
    s_add_u32 s60, s59, 4096
    buffer_load_dwordx4 v254, s[4:7], s60 offen lds
    buffer_load_dwordx4 v254, s[4:7], s60 offen offset:1024 lds
    s_add_u32 s94, s94, 32768
    s_and_b32 s94, s94, 0x3ffff
    buffer_load_dwordx4 v254, s[4:7], s60 offen offset:2048 lds
    buffer_load_dwordx4 v254, s[4:7], s60 offen offset:3072 lds
    s_waitcnt vmcnt(8)
    s_barrier
    s_add_u32 m0, s61, 131072
    s_add_u32 s59, s62, s94
    buffer_load_dwordx4 v254, s[4:7], s59 offen lds
    buffer_load_dwordx4 v254, s[4:7], s59 offen offset:1024 lds
    buffer_load_dwordx4 v254, s[4:7], s59 offen offset:2048 lds
    buffer_load_dwordx4 v254, s[4:7], s59 offen offset:3072 lds
    s_add_u32 m0, s61, 135168
    s_add_u32 s60, s59, 4096
    buffer_load_dwordx4 v254, s[4:7], s60 offen lds
    buffer_load_dwordx4 v254, s[4:7], s60 offen offset:1024 lds
    s_add_u32 s94, s94, 32768
    s_and_b32 s94, s94, 0x3ffff
    buffer_load_dwordx4 v254, s[4:7], s60 offen offset:2048 lds
    buffer_load_dwordx4 v254, s[4:7], s60 offen offset:3072 lds
    s_waitcnt vmcnt(8)
    s_barrier
    s_add_u32 m0, s61, 98304
    s_add_u32 s59, s62, s94
    buffer_load_dwordx4 v254, s[4:7], s59 offen lds
    buffer_load_dwordx4 v254, s[4:7], s59 offen offset:1024 lds
    buffer_load_dwordx4 v254, s[4:7], s59 offen offset:2048 lds
    buffer_load_dwordx4 v254, s[4:7], s59 offen offset:3072 lds
    s_add_u32 m0, s61, 102400
    s_add_u32 s60, s59, 4096
    buffer_load_dwordx4 v254, s[4:7], s60 offen lds
    buffer_load_dwordx4 v254, s[4:7], s60 offen offset:1024 lds
    s_add_u32 s94, s94, 32768
    s_and_b32 s94, s94, 0x3ffff
    buffer_load_dwordx4 v254, s[4:7], s60 offen offset:2048 lds
    buffer_load_dwordx4 v254, s[4:7], s60 offen offset:3072 lds
    s_waitcnt vmcnt(8)
    s_barrier
    s_add_u32 m0, s61, 114688
    s_add_u32 s59, s62, s94
    buffer_load_dwordx4 v254, s[4:7], s59 offen lds
    buffer_load_dwordx4 v254, s[4:7], s59 offen offset:1024 lds
    buffer_load_dwordx4 v254, s[4:7], s59 offen offset:2048 lds
    buffer_load_dwordx4 v254, s[4:7], s59 offen offset:3072 lds
    s_add_u32 m0, s61, 118784
    s_add_u32 s60, s59, 4096
    buffer_load_dwordx4 v254, s[4:7], s60 offen lds
    buffer_load_dwordx4 v254, s[4:7], s60 offen offset:1024 lds
    s_add_u32 s94, s94, 32768
    s_and_b32 s94, s94, 0x3ffff
    buffer_load_dwordx4 v254, s[4:7], s60 offen offset:2048 lds
    buffer_load_dwordx4 v254, s[4:7], s60 offen offset:3072 lds
    s_waitcnt vmcnt(8)
    s_barrier
    s_add_u32 m0, s61, 131072
    s_add_u32 s59, s62, s94
    buffer_load_dwordx4 v254, s[4:7], s59 offen lds
    buffer_load_dwordx4 v254, s[4:7], s59 offen offset:1024 lds
    buffer_load_dwordx4 v254, s[4:7], s59 offen offset:2048 lds
    buffer_load_dwordx4 v254, s[4:7], s59 offen offset:3072 lds
    s_add_u32 m0, s61, 135168
    s_add_u32 s60, s59, 4096
    buffer_load_dwordx4 v254, s[4:7], s60 offen lds
    buffer_load_dwordx4 v254, s[4:7], s60 offen offset:1024 lds
    s_add_u32 s94, s94, 32768
    s_and_b32 s94, s94, 0x3ffff
    buffer_load_dwordx4 v254, s[4:7], s60 offen offset:2048 lds
    buffer_load_dwordx4 v254, s[4:7], s60 offen offset:3072 lds
    s_waitcnt vmcnt(8)
    s_barrier
    s_add_u32 m0, s61, 98304
    s_add_u32 s59, s62, s94
    buffer_load_dwordx4 v254, s[4:7], s59 offen lds
    buffer_load_dwordx4 v254, s[4:7], s59 offen offset:1024 lds
    buffer_load_dwordx4 v254, s[4:7], s59 offen offset:2048 lds
    buffer_load_dwordx4 v254, s[4:7], s59 offen offset:3072 lds
    s_add_u32 m0, s61, 102400
    s_add_u32 s60, s59, 4096
    buffer_load_dwordx4 v254, s[4:7], s60 offen lds
    buffer_load_dwordx4 v254, s[4:7], s60 offen offset:1024 lds
    s_add_u32 s94, s94, 32768
    s_and_b32 s94, s94, 0x3ffff
    buffer_load_dwordx4 v254, s[4:7], s60 offen offset:2048 lds
    buffer_load_dwordx4 v254, s[4:7], s60 offen offset:3072 lds
    s_waitcnt vmcnt(8)
    s_barrier
    s_waitcnt vmcnt(0)
    s_barrier
    s_barrier
    s_setprio 1
    s_add_u32 s62, s49, s61
    s_lshl_b32 s94, s51, 14
    s_barrier
    s_add_u32 m0, s61, 98304
    s_add_u32 s59, s62, s94
    buffer_load_dwordx4 v254, s[4:7], s59 offen lds
    buffer_load_dwordx4 v254, s[4:7], s59 offen offset:1024 lds
    buffer_load_dwordx4 v254, s[4:7], s59 offen offset:2048 lds
    buffer_load_dwordx4 v254, s[4:7], s59 offen offset:3072 lds
    s_add_u32 m0, s61, 102400
    s_add_u32 s60, s59, 4096
    buffer_load_dwordx4 v254, s[4:7], s60 offen lds
    buffer_load_dwordx4 v254, s[4:7], s60 offen offset:1024 lds
    s_add_u32 s94, s94, 32768
    s_and_b32 s94, s94, 0x3ffff
    buffer_load_dwordx4 v254, s[4:7], s60 offen offset:2048 lds
    buffer_load_dwordx4 v254, s[4:7], s60 offen offset:3072 lds
    s_waitcnt vmcnt(0)
    s_barrier
    v_lshrrev_b32 v252, 2, v254
    v_min_u32 v252, 28, v252
    s_add_u32 s55, s0, 32
    buffer_load_dword v251, v252, s[4:7], s55 offen sc0 sc1
    s_waitcnt lgkmcnt(0)
    s_barrier
    s_waitcnt vmcnt(0)
    v_cmp_ne_u32 vcc, 0x01010101, v251
    s_cbranch_vccz ap_46
    v_lshrrev_b32 v252, 2, v254
    v_min_u32 v252, 28, v252
    s_add_u32 s55, s0, 32
    s_mov_b32 s56, 262144
poll_47:
    buffer_load_dword v253, v252, s[4:7], s55 offen sc0 sc1
    s_waitcnt vmcnt(0)
    v_cmp_ne_u32 vcc, 0x01010101, v253
    s_cbranch_vccz pd_48
    s_sleep 1
    s_sub_u32 s56, s56, 1
    s_cmp_lg_u32 s56, 0
    s_cbranch_scc1 poll_47
pd_48:
ap_46:
    s_add_u32 m0, s61, 114688
    s_add_u32 s59, s62, s94
    buffer_load_dwordx4 v254, s[4:7], s59 offen lds
    buffer_load_dwordx4 v254, s[4:7], s59 offen offset:1024 lds
    buffer_load_dwordx4 v254, s[4:7], s59 offen offset:2048 lds
    buffer_load_dwordx4 v254, s[4:7], s59 offen offset:3072 lds
    s_add_u32 m0, s61, 118784
    s_add_u32 s60, s59, 4096
    buffer_load_dwordx4 v254, s[4:7], s60 offen lds
    buffer_load_dwordx4 v254, s[4:7], s60 offen offset:1024 lds
    s_add_u32 s94, s94, 32768
    s_and_b32 s94, s94, 0x3ffff
    buffer_load_dwordx4 v254, s[4:7], s60 offen offset:2048 lds
    buffer_load_dwordx4 v254, s[4:7], s60 offen offset:3072 lds
    s_add_u32 m0, s61, 131072
    s_add_u32 s59, s62, s94
    buffer_load_dwordx4 v254, s[4:7], s59 offen lds
    buffer_load_dwordx4 v254, s[4:7], s59 offen offset:1024 lds
    buffer_load_dwordx4 v254, s[4:7], s59 offen offset:2048 lds
    buffer_load_dwordx4 v254, s[4:7], s59 offen offset:3072 lds
    s_add_u32 m0, s61, 135168
    s_add_u32 s60, s59, 4096
    buffer_load_dwordx4 v254, s[4:7], s60 offen lds
    buffer_load_dwordx4 v254, s[4:7], s60 offen offset:1024 lds
    s_add_u32 s94, s94, 32768
    s_and_b32 s94, s94, 0x3ffff
    buffer_load_dwordx4 v254, s[4:7], s60 offen offset:2048 lds
    buffer_load_dwordx4 v254, s[4:7], s60 offen offset:3072 lds
    s_waitcnt vmcnt(8) lgkmcnt(0)
    s_barrier
    s_add_u32 m0, s61, 98304
    s_add_u32 s59, s62, s94
    buffer_load_dwordx4 v254, s[4:7], s59 offen lds
    buffer_load_dwordx4 v254, s[4:7], s59 offen offset:1024 lds
    buffer_load_dwordx4 v254, s[4:7], s59 offen offset:2048 lds
    buffer_load_dwordx4 v254, s[4:7], s59 offen offset:3072 lds
    s_waitcnt lgkmcnt(0)
    s_barrier
    s_cmp_lg_u32 s42, 0
    s_cbranch_scc1 wf_49
    s_lshl_b32 s55, s51, 2
    s_add_u32 s55, s55, s54
    v_mov_b32 v252, 12288
    v_mov_b32 v250, 0x01010101
    s_mov_b64 exec, 1
    buffer_store_dword v250, v252, s[4:7], s55 offen sc0 sc1
    s_mov_b64 exec, -1
wf_49:
    s_add_u32 m0, s61, 102400
    s_add_u32 s60, s59, 4096
    buffer_load_dwordx4 v254, s[4:7], s60 offen lds
    buffer_load_dwordx4 v254, s[4:7], s60 offen offset:1024 lds
    s_add_u32 s94, s94, 32768
    s_and_b32 s94, s94, 0x3ffff
    buffer_load_dwordx4 v254, s[4:7], s60 offen offset:2048 lds
    buffer_load_dwordx4 v254, s[4:7], s60 offen offset:3072 lds
    s_waitcnt vmcnt(8) lgkmcnt(0)
    s_barrier
    s_add_u32 m0, s61, 114688
    s_add_u32 s59, s62, s94
    buffer_load_dwordx4 v254, s[4:7], s59 offen lds
    buffer_load_dwordx4 v254, s[4:7], s59 offen offset:1024 lds
    buffer_load_dwordx4 v254, s[4:7], s59 offen offset:2048 lds
    buffer_load_dwordx4 v254, s[4:7], s59 offen offset:3072 lds
    s_waitcnt lgkmcnt(0)
    s_barrier
    s_add_u32 m0, s61, 118784
    s_add_u32 s60, s59, 4096
    buffer_load_dwordx4 v254, s[4:7], s60 offen lds
    buffer_load_dwordx4 v254, s[4:7], s60 offen offset:1024 lds
    s_add_u32 s94, s94, 32768
    s_and_b32 s94, s94, 0x3ffff
    buffer_load_dwordx4 v254, s[4:7], s60 offen offset:2048 lds
    buffer_load_dwordx4 v254, s[4:7], s60 offen offset:3072 lds
    s_waitcnt vmcnt(8) lgkmcnt(0)
    s_barrier
    s_add_u32 m0, s61, 131072
    s_add_u32 s59, s62, s94
    buffer_load_dwordx4 v254, s[4:7], s59 offen lds
    buffer_load_dwordx4 v254, s[4:7], s59 offen offset:1024 lds
    buffer_load_dwordx4 v254, s[4:7], s59 offen offset:2048 lds
    buffer_load_dwordx4 v254, s[4:7], s59 offen offset:3072 lds
    s_waitcnt lgkmcnt(0)
    s_barrier
    v_lshrrev_b32 v252, 2, v254
    v_min_u32 v252, 60, v252
    s_add_u32 s55, s54, 12288
    buffer_load_dword v251, v252, s[4:7], s55 offen sc0 sc1
    s_add_u32 m0, s61, 135168
    s_add_u32 s60, s59, 4096
    buffer_load_dwordx4 v254, s[4:7], s60 offen lds
    buffer_load_dwordx4 v254, s[4:7], s60 offen offset:1024 lds
    s_add_u32 s94, s94, 32768
    s_and_b32 s94, s94, 0x3ffff
    buffer_load_dwordx4 v254, s[4:7], s60 offen offset:2048 lds
    buffer_load_dwordx4 v254, s[4:7], s60 offen offset:3072 lds
    s_waitcnt vmcnt(9) lgkmcnt(0)
    s_barrier
    s_add_u32 m0, s61, 98304
    s_add_u32 s59, s62, s94
    buffer_load_dwordx4 v254, s[4:7], s59 offen lds
    buffer_load_dwordx4 v254, s[4:7], s59 offen offset:1024 lds
    buffer_load_dwordx4 v254, s[4:7], s59 offen offset:2048 lds
    buffer_load_dwordx4 v254, s[4:7], s59 offen offset:3072 lds
    s_waitcnt lgkmcnt(0)
    s_barrier
    s_waitcnt vmcnt(8)
    v_cmp_ne_u32 vcc, 0x01010101, v251
    s_cbranch_vccz ap_50
    v_lshrrev_b32 v252, 2, v254
    v_min_u32 v252, 60, v252
    s_add_u32 s55, s54, 12288
    s_mov_b32 s56, 262144
poll_51:
    buffer_load_dword v253, v252, s[4:7], s55 offen sc0 sc1
    s_waitcnt vmcnt(0)
    v_cmp_ne_u32 vcc, 0x01010101, v253
    s_cbranch_vccz pd_52
    s_sleep 1
    s_sub_u32 s56, s56, 1
    s_cmp_lg_u32 s56, 0
    s_cbranch_scc1 poll_51
pd_52:
ap_50:
    v_and_b32 v226, 0x1f0, v254
    v_and_b32 v227, 0x200, v254
    v_lshl_add_u32 v227, v227, 1, v226
    s_lshl_b32 s68, s43, 9
    s_add_u32 s68, s68, s52
    s_add_u32 m0, s61, 102400
    s_add_u32 s60, s59, 4096
    buffer_load_dwordx4 v254, s[4:7], s60 offen lds
    s_add_u32 s55, s68, 0
    buffer_load_dwordx4 v[96:99], v227, s[4:7], s55 offen offset:0
    buffer_load_dwordx4 v254, s[4:7], s60 offen offset:1024 lds
    s_add_u32 s94, s94, 32768
    s_and_b32 s94, s94, 0x3ffff
    buffer_load_dwordx4 v[100:103], v227, s[4:7], s55 offen offset:2048
    buffer_load_dwordx4 v254, s[4:7], s60 offen offset:2048 lds
    s_add_u32 s55, s68, 4096
    buffer_load_dwordx4 v[104:107], v227, s[4:7], s55 offen offset:0
    buffer_load_dwordx4 v254, s[4:7], s60 offen offset:3072 lds
    buffer_load_dwordx4 v[108:111], v227, s[4:7], s55 offen offset:2048
    s_waitcnt vmcnt(12) lgkmcnt(0)
    s_barrier
    s_add_u32 m0, s61, 114688
    s_add_u32 s59, s62, s94
    buffer_load_dwordx4 v254, s[4:7], s59 offen lds
    s_add_u32 s55, s68, 8192
    buffer_load_dwordx4 v[112:115], v227, s[4:7], s55 offen offset:0
    buffer_load_dwordx4 v254, s[4:7], s59 offen offset:1024 lds
    buffer_load_dwordx4 v[116:119], v227, s[4:7], s55 offen offset:2048
    buffer_load_dwordx4 v254, s[4:7], s59 offen offset:2048 lds
    s_add_u32 s55, s68, 12288
    buffer_load_dwordx4 v[120:123], v227, s[4:7], s55 offen offset:0
    buffer_load_dwordx4 v254, s[4:7], s59 offen offset:3072 lds
    buffer_load_dwordx4 v[124:127], v227, s[4:7], s55 offen offset:2048
    s_waitcnt lgkmcnt(0)
    s_barrier
    s_add_u32 m0, s61, 118784
    s_add_u32 s60, s59, 4096
    buffer_load_dwordx4 v254, s[4:7], s60 offen lds
    s_add_u32 s55, s68, 16384
    buffer_load_dwordx4 v[128:131], v227, s[4:7], s55 offen offset:0
    buffer_load_dwordx4 v254, s[4:7], s60 offen offset:1024 lds
    s_add_u32 s94, s94, 49152
    s_and_b32 s94, s94, 0x3ffff
    buffer_load_dwordx4 v[132:135], v227, s[4:7], s55 offen offset:2048
    buffer_load_dwordx4 v254, s[4:7], s60 offen offset:2048 lds
    s_add_u32 s55, s68, 20480
    buffer_load_dwordx4 v[136:139], v227, s[4:7], s55 offen offset:0
    buffer_load_dwordx4 v254, s[4:7], s60 offen offset:3072 lds
    buffer_load_dwordx4 v[140:143], v227, s[4:7], s55 offen offset:2048
    s_waitcnt vmcnt(17) lgkmcnt(0)
    s_barrier
    s_add_u32 m0, s61, 131072
    s_add_u32 s59, s62, s94
    buffer_load_dwordx4 v254, s[4:7], s59 offen lds
    s_add_u32 s55, s68, 24576
    buffer_load_dwordx4 v[144:147], v227, s[4:7], s55 offen offset:0
    buffer_load_dwordx4 v254, s[4:7], s59 offen offset:1024 lds
    buffer_load_dwordx4 v[148:151], v227, s[4:7], s55 offen offset:2048
    buffer_load_dwordx4 v254, s[4:7], s59 offen offset:2048 lds
    s_add_u32 s55, s68, 28672
    buffer_load_dwordx4 v[152:155], v227, s[4:7], s55 offen offset:0
    buffer_load_dwordx4 v254, s[4:7], s59 offen offset:3072 lds
    buffer_load_dwordx4 v[156:159], v227, s[4:7], s55 offen offset:2048
    s_waitcnt lgkmcnt(0)
    s_barrier
    s_waitcnt vmcnt(24)
    s_add_u32 m0, s61, 135168
    s_add_u32 s60, s59, 4096
    buffer_load_dwordx4 v254, s[4:7], s60 offen lds
    v_mov_b32 v192, v96
    v_mov_b32 v193, v97
    v_mov_b32 v194, v98
    v_mov_b32 v195, v99
    buffer_load_dwordx4 v254, s[4:7], s60 offen offset:1024 lds
    s_add_u32 s94, s94, 32768
    s_and_b32 s94, s94, 0x3ffff
    v_add_f32 v192, v192, v100
    v_add_f32 v193, v193, v101
    v_add_f32 v194, v194, v102
    v_add_f32 v195, v195, v103
    buffer_load_dwordx4 v254, s[4:7], s60 offen offset:2048 lds
    v_add_f32 v192, v192, v104
    v_add_f32 v193, v193, v105
    v_add_f32 v194, v194, v106
    v_add_f32 v195, v195, v107
    buffer_load_dwordx4 v254, s[4:7], s60 offen offset:3072 lds
    v_add_f32 v192, v192, v108
    v_add_f32 v193, v193, v109
    v_add_f32 v194, v194, v110
    v_add_f32 v195, v195, v111
    s_waitcnt vmcnt(13) lgkmcnt(0)
    s_barrier
    s_mov_b32 s55, 71566336
    buffer_load_dwordx4 v[160:163], v254, s[4:7], s55 offen sc0 sc1
    s_add_u32 m0, s61, 98304
    s_add_u32 s59, s62, s94
    buffer_load_dwordx4 v254, s[4:7], s59 offen lds
    v_add_f32 v192, v192, v112
    v_add_f32 v193, v193, v113
    v_add_f32 v194, v194, v114
    v_add_f32 v195, v195, v115
    buffer_load_dwordx4 v254, s[4:7], s59 offen offset:1024 lds
    v_add_f32 v192, v192, v116
    v_add_f32 v193, v193, v117
    v_add_f32 v194, v194, v118
    v_add_f32 v195, v195, v119
    buffer_load_dwordx4 v254, s[4:7], s59 offen offset:2048 lds
    v_add_f32 v192, v192, v120
    v_add_f32 v193, v193, v121
    v_add_f32 v194, v194, v122
    v_add_f32 v195, v195, v123
    buffer_load_dwordx4 v254, s[4:7], s59 offen offset:3072 lds
    v_add_f32 v192, v192, v124
    v_add_f32 v193, v193, v125
    v_add_f32 v194, v194, v126
    v_add_f32 v195, v195, v127
    s_waitcnt lgkmcnt(0)
    s_barrier
    s_waitcnt vmcnt(17)
    s_add_u32 m0, s61, 102400
    s_add_u32 s60, s59, 4096
    buffer_load_dwordx4 v254, s[4:7], s60 offen lds
    v_add_f32 v192, v192, v128
    v_add_f32 v193, v193, v129
    v_add_f32 v194, v194, v130
    v_add_f32 v195, v195, v131
    buffer_load_dwordx4 v254, s[4:7], s60 offen offset:1024 lds
    s_add_u32 s94, s94, 32768
    s_and_b32 s94, s94, 0x3ffff
    v_add_f32 v192, v192, v132
    v_add_f32 v193, v193, v133
    v_add_f32 v194, v194, v134
    v_add_f32 v195, v195, v135
    buffer_load_dwordx4 v254, s[4:7], s60 offen offset:2048 lds
    v_add_f32 v192, v192, v136
    v_add_f32 v193, v193, v137
    v_add_f32 v194, v194, v138
    v_add_f32 v195, v195, v139
    buffer_load_dwordx4 v254, s[4:7], s60 offen offset:3072 lds
    v_add_f32 v192, v192, v140
    v_add_f32 v193, v193, v141
    v_add_f32 v194, v194, v142
    v_add_f32 v195, v195, v143
    s_waitcnt vmcnt(9) lgkmcnt(0)
    s_barrier
    s_waitcnt vmcnt(8)
    s_cmp_eq_u32 s46, 1
    s_cbranch_scc1 a4_53
    v_and_b32 v160, v160, v161
    v_and_b32 v162, v162, v163
    v_and_b32 v160, v160, v162
    v_cmp_ne_u32 vcc, 1, v160
    s_cbranch_vccz a4_53
    s_mov_b32 s55, 71566336
    s_mov_b32 s56, 262144
p4_54:
    buffer_load_dwordx4 v[160:163], v254, s[4:7], s55 offen sc0 sc1
    s_waitcnt vmcnt(0)
    v_and_b32 v160, v160, v161
    v_and_b32 v162, v162, v163
    v_and_b32 v160, v160, v162
    v_cmp_ne_u32 vcc, 1, v160
    s_cbranch_vccz p4_55
    s_sleep 1
    s_sub_u32 s56, s56, 1
    s_cmp_lg_u32 s56, 0
    s_cbranch_scc1 p4_54
p4_55:
a4_53:
    s_cmp_lg_u32 s46, 0
    s_cbranch_scc1 cs_56
    s_and_b32 s55, s41, 1
    s_mul_i32 s56, s55, 384
    s_xor_b32 s55, s55, 1
    s_lshl_b32 s55, s55, 9
    s_cmp_eq_u32 s43, 0
    s_cselect_b32 s55, s56, s55
    s_mul_i32 s56, s41, 896
    s_add_u32 s55, s55, s56
    s_add_u32 s55, s55, 70778880
    v_lshrrev_b32 v224, 9, v254
    v_mul_u32_u24 v224, 14336, v224
    v_and_b32 v225, 0x1f0, v254
    v_add_u32 v224, v224, v225
    buffer_load_dwordx4 v[160:163], v224, s[4:7], s55 offen sc1
    s_add_u32 s55, s55, 28672
    buffer_load_dwordx4 v[164:167], v224, s[4:7], s55 offen sc1
    s_add_u32 s55, s55, 28672
    buffer_load_dwordx4 v[168:171], v224, s[4:7], s55 offen sc1
    s_add_u32 s55, s55, 28672
    buffer_load_dwordx4 v[172:175], v224, s[4:7], s55 offen sc1
    s_add_u32 s55, s55, 28672
    buffer_load_dwordx4 v[176:179], v224, s[4:7], s55 offen sc1
    s_add_u32 s55, s55, 28672
    buffer_load_dwordx4 v[180:183], v224, s[4:7], s55 offen sc1
    s_add_u32 s55, s55, 28672
cs_56:
    s_add_u32 m0, s61, 114688
    s_add_u32 s59, s62, s94
    buffer_load_dwordx4 v254, s[4:7], s59 offen lds
    v_add_f32 v192, v192, v144
    v_add_f32 v193, v193, v145
    v_add_f32 v194, v194, v146
    v_add_f32 v195, v195, v147
    buffer_load_dwordx4 v254, s[4:7], s59 offen offset:1024 lds
    v_add_f32 v192, v192, v148
    v_add_f32 v193, v193, v149
    v_add_f32 v194, v194, v150
    v_add_f32 v195, v195, v151
    buffer_load_dwordx4 v254, s[4:7], s59 offen offset:2048 lds
    v_add_f32 v192, v192, v152
    v_add_f32 v193, v193, v153
    v_add_f32 v194, v194, v154
    v_add_f32 v195, v195, v155
    buffer_load_dwordx4 v254, s[4:7], s59 offen offset:3072 lds
    v_add_f32 v192, v192, v156
    v_add_f32 v193, v193, v157
    v_add_f32 v194, v194, v158
    v_add_f32 v195, v195, v159
    s_waitcnt lgkmcnt(0)
    s_barrier
    s_add_u32 m0, s61, 118784
    s_add_u32 s60, s59, 4096
    buffer_load_dwordx4 v254, s[4:7], s60 offen lds
    v_mov_b32 v96, v192
    v_mov_b32 v97, v193
    v_mov_b32 v98, v194
    buffer_load_dwordx4 v254, s[4:7], s60 offen offset:1024 lds
    s_add_u32 s94, s94, 32768
    s_and_b32 s94, s94, 0x3ffff
    v_mov_b32 v99, v195
    s_nop 1
    v_permlane32_swap_b32 v192, v96
    buffer_load_dwordx4 v254, s[4:7], s60 offen offset:2048 lds
    v_permlane32_swap_b32 v193, v97
    v_permlane32_swap_b32 v194, v98
    v_permlane32_swap_b32 v195, v99
    buffer_load_dwordx4 v254, s[4:7], s60 offen offset:3072 lds
    v_add_f32 v192, v192, v96
    v_add_f32 v193, v193, v97
    v_add_f32 v194, v194, v98
    v_add_f32 v195, v195, v99
    s_waitcnt vmcnt(8) lgkmcnt(0)
    s_barrier
    s_add_u32 m0, s61, 131072
    s_add_u32 s59, s62, s94
    buffer_load_dwordx4 v254, s[4:7], s59 offen lds
    v_mul_f32 v192, 0x3a800000, v192
    v_mul_f32 v193, 0x3a800000, v193
    v_fma_f32 v193, -v192, v192, v193
    v_max_f32 v193, 0, v193
    buffer_load_dwordx4 v254, s[4:7], s59 offen offset:1024 lds
    v_cvt_pk_bf16_f32 v192, v192, v192
    v_lshlrev_b32 v192, 16, v192
    v_cvt_pk_bf16_f32 v193, v193, v193
    v_lshlrev_b32 v193, 16, v193
    buffer_load_dwordx4 v254, s[4:7], s59 offen offset:2048 lds
    v_add_f32 v193, 0x3727c5ac, v193
    v_cvt_pk_bf16_f32 v193, v193, v193
    v_lshlrev_b32 v193, 16, v193
    v_sqrt_f32 v193, v193
    buffer_load_dwordx4 v254, s[4:7], s59 offen offset:3072 lds
    s_nop 0
    v_cvt_pk_bf16_f32 v193, v193, v193
    v_lshlrev_b32 v193, 16, v193
    v_rcp_f32 v193, v193
    s_nop 0
    s_waitcnt lgkmcnt(0)
    s_barrier
    s_add_u32 m0, s61, 135168
    s_add_u32 s60, s59, 4096
    buffer_load_dwordx4 v254, s[4:7], s60 offen lds
    v_mul_f32 v194, 0x3a800000, v194
    v_mul_f32 v195, 0x3a800000, v195
    v_fma_f32 v195, -v194, v194, v195
    v_max_f32 v195, 0, v195
    buffer_load_dwordx4 v254, s[4:7], s60 offen offset:1024 lds
    s_add_u32 s94, s94, 32768
    s_and_b32 s94, s94, 0x3ffff
    v_cvt_pk_bf16_f32 v194, v194, v194
    v_lshlrev_b32 v194, 16, v194
    v_cvt_pk_bf16_f32 v195, v195, v195
    v_lshlrev_b32 v195, 16, v195
    v_add_f32 v195, 0x3727c5ac, v195
    buffer_load_dwordx4 v254, s[4:7], s60 offen offset:2048 lds
    v_cvt_pk_bf16_f32 v195, v195, v195
    v_lshlrev_b32 v195, 16, v195
    v_sqrt_f32 v195, v195
    s_nop 0
    buffer_load_dwordx4 v254, s[4:7], s60 offen offset:3072 lds
    v_cvt_pk_bf16_f32 v195, v195, v195
    v_lshlrev_b32 v195, 16, v195
    v_rcp_f32 v195, v195
    s_nop 0
    s_lshl_b32 s55, s43, 9
    s_add_u32 s55, s55, 153600
    v_add_u32 v226, s55, v226
    ds_write_b128 v226, v[192:195]
    s_waitcnt vmcnt(8) lgkmcnt(0)
    s_barrier
    s_cmp_lg_u32 s46, 0
    s_cbranch_scc1 cs_57
    v_add_f32 v160, v160, v164
    v_add_f32 v161, v161, v165
    v_add_f32 v162, v162, v166
    v_add_f32 v163, v163, v167
    v_add_f32 v160, v160, v168
    v_add_f32 v161, v161, v169
    v_add_f32 v162, v162, v170
    v_add_f32 v163, v163, v171
    v_add_f32 v160, v160, v172
    v_add_f32 v161, v161, v173
    v_add_f32 v162, v162, v174
    v_add_f32 v163, v163, v175
    v_add_f32 v160, v160, v176
    v_add_f32 v161, v161, v177
    v_add_f32 v162, v162, v178
    v_add_f32 v163, v163, v179
    v_add_f32 v160, v160, v180
    v_add_f32 v161, v161, v181
    v_add_f32 v162, v162, v182
    v_add_f32 v163, v163, v183
    s_lshl_b32 s55, s43, 10
    s_add_u32 s55, s55, 155520
    v_add_u32 v224, s55, v254
    ds_write_b128 v224, v[160:163]
cs_57:
    s_add_u32 m0, s61, 98304
    s_add_u32 s59, s62, s94
    buffer_load_dwordx4 v254, s[4:7], s59 offen lds
    buffer_load_dwordx4 v254, s[4:7], s59 offen offset:1024 lds
    buffer_load_dwordx4 v254, s[4:7], s59 offen offset:2048 lds
    buffer_load_dwordx4 v254, s[4:7], s59 offen offset:3072 lds
    s_waitcnt lgkmcnt(0)
    s_barrier
    s_add_u32 m0, s61, 102400
    s_add_u32 s60, s59, 4096
    buffer_load_dwordx4 v254, s[4:7], s60 offen lds
    buffer_load_dwordx4 v254, s[4:7], s60 offen offset:1024 lds
    s_add_u32 s94, s94, 32768
    s_and_b32 s94, s94, 0x3ffff
    buffer_load_dwordx4 v254, s[4:7], s60 offen offset:2048 lds
    buffer_load_dwordx4 v254, s[4:7], s60 offen offset:3072 lds
    s_waitcnt vmcnt(8) lgkmcnt(0)
    s_barrier
    s_add_u32 m0, s61, 114688
    s_add_u32 s59, s62, s94
    buffer_load_dwordx4 v254, s[4:7], s59 offen lds
    buffer_load_dwordx4 v254, s[4:7], s59 offen offset:1024 lds
    buffer_load_dwordx4 v254, s[4:7], s59 offen offset:2048 lds
    buffer_load_dwordx4 v254, s[4:7], s59 offen offset:3072 lds
    s_waitcnt lgkmcnt(0)
    s_barrier
    s_add_u32 m0, s61, 118784
    s_add_u32 s60, s59, 4096
    buffer_load_dwordx4 v254, s[4:7], s60 offen lds
    s_lshl_b32 s55, s43, 9
    s_add_u32 s55, s55, 153600
    v_and_b32 v224, 0xf0, v254
    v_lshrrev_b32 v224, 1, v224
    v_add_u32 v224, s55, v224
    ds_read_b64 v[96:97], v224 offset:0
    ds_read_b64 v[98:99], v224 offset:128
    ds_read_b64 v[100:101], v224 offset:256
    buffer_load_dwordx4 v254, s[4:7], s60 offen offset:1024 lds
    s_add_u32 s94, s94, 32768
    s_and_b32 s94, s94, 0x3ffff
    ds_read_b64 v[102:103], v224 offset:384
    s_waitcnt lgkmcnt(0)
    v_sub_f32 v196, 0, v96
    v_mul_f32 v184, 0xbfb8aa3b, v97
    v_mul_f32 v188, v97, v97
    buffer_load_dwordx4 v254, s[4:7], s60 offen offset:2048 lds
    v_sub_f32 v197, 0, v98
    v_mul_f32 v185, 0xbfb8aa3b, v99
    v_mul_f32 v189, v99, v99
    v_sub_f32 v198, 0, v100
    buffer_load_dwordx4 v254, s[4:7], s60 offen offset:3072 lds
    v_mul_f32 v186, 0xbfb8aa3b, v101
    v_mul_f32 v190, v101, v101
    v_sub_f32 v199, 0, v102
    v_mul_f32 v187, 0xbfb8aa3b, v103
    v_mul_f32 v191, v103, v103
    s_waitcnt vmcnt(8) lgkmcnt(0)
    s_barrier
    s_add_u32 m0, s61, 131072
    s_add_u32 s59, s62, s94
    buffer_load_dwordx4 v254, s[4:7], s59 offen lds
    v_rcp_f32 v188, v188
    v_rcp_f32 v189, v189
    v_rcp_f32 v190, v190
    v_rcp_f32 v191, v191
    buffer_load_dwordx4 v254, s[4:7], s59 offen offset:1024 lds
    s_nop 0
    v_lshrrev_b32 v224, 8, v254
    v_lshlrev_b32 v224, 4, v224
    v_add_u32 v224, 156544, v224
    s_lshl_b32 s55, s44, 8
    v_add_u32 v225, s55, v224
    buffer_load_dwordx4 v254, s[4:7], s59 offen offset:2048 lds
    s_lshl_b32 s55, s44, 6
    v_add_u32 v224, s55, v224
    ds_read_b128 v[96:99], v225 offset:0
    ds_read_b128 v[100:103], v225 offset:64
    ds_read_b128 v[104:107], v224 offset:128
    ds_read_b128 v[108:111], v225 offset:512
    buffer_load_dwordx4 v254, s[4:7], s59 offen offset:3072 lds
    ds_read_b128 v[112:115], v225 offset:576
    ds_read_b128 v[116:119], v224 offset:640
    s_waitcnt lgkmcnt(0)
    v_mul_f32 v0, v196, v96
    v_mul_f32 v1, v196, v97
    s_waitcnt lgkmcnt(0)
    s_barrier
    s_add_u32 m0, s61, 135168
    s_add_u32 s60, s59, 4096
    buffer_load_dwordx4 v254, s[4:7], s60 offen lds
    v_mul_f32 v2, v196, v98
    v_mul_f32 v3, v196, v99
    v_mul_f32 v4, v197, v96
    v_mul_f32 v5, v197, v97
    v_mul_f32 v6, v197, v98
    buffer_load_dwordx4 v254, s[4:7], s60 offen offset:1024 lds
    s_add_u32 s94, s94, 32768
    s_and_b32 s94, s94, 0x3ffff
    v_mul_f32 v7, v197, v99
    v_mul_f32 v8, v198, v96
    v_mul_f32 v9, v198, v97
    v_mul_f32 v10, v198, v98
    v_mul_f32 v11, v198, v99
    buffer_load_dwordx4 v254, s[4:7], s60 offen offset:2048 lds
    v_mul_f32 v12, v199, v96
    v_mul_f32 v13, v199, v97
    v_mul_f32 v14, v199, v98
    v_mul_f32 v15, v199, v99
    v_mul_f32 v16, v196, v100
    buffer_load_dwordx4 v254, s[4:7], s60 offen offset:3072 lds
    v_mul_f32 v17, v196, v101
    v_mul_f32 v18, v196, v102
    v_mul_f32 v19, v196, v103
    v_mul_f32 v20, v197, v100
    v_mul_f32 v21, v197, v101
    s_waitcnt vmcnt(8) lgkmcnt(0)
    s_barrier
    s_add_u32 m0, s61, 98304
    s_add_u32 s59, s62, s94
    buffer_load_dwordx4 v254, s[4:7], s59 offen lds
    v_mul_f32 v22, v197, v102
    v_mul_f32 v23, v197, v103
    v_mul_f32 v24, v198, v100
    v_mul_f32 v25, v198, v101
    v_mul_f32 v26, v198, v102
    buffer_load_dwordx4 v254, s[4:7], s59 offen offset:1024 lds
    v_mul_f32 v27, v198, v103
    v_mul_f32 v28, v199, v100
    v_mul_f32 v29, v199, v101
    v_mul_f32 v30, v199, v102
    v_mul_f32 v31, v199, v103
    buffer_load_dwordx4 v254, s[4:7], s59 offen offset:2048 lds
    v_mul_f32 v32, v196, v104
    v_mul_f32 v33, v196, v105
    v_mul_f32 v34, v196, v106
    v_mul_f32 v35, v196, v107
    v_mul_f32 v36, v197, v104
    buffer_load_dwordx4 v254, s[4:7], s59 offen offset:3072 lds
    v_mul_f32 v37, v197, v105
    v_mul_f32 v38, v197, v106
    v_mul_f32 v39, v197, v107
    v_mul_f32 v40, v198, v104
    v_mul_f32 v41, v198, v105
    s_waitcnt lgkmcnt(0)
    s_barrier
    s_add_u32 m0, s61, 102400
    s_add_u32 s60, s59, 4096
    buffer_load_dwordx4 v254, s[4:7], s60 offen lds
    v_mul_f32 v42, v198, v106
    v_mul_f32 v43, v198, v107
    v_mul_f32 v44, v199, v104
    v_mul_f32 v45, v199, v105
    v_mul_f32 v46, v199, v106
    buffer_load_dwordx4 v254, s[4:7], s60 offen offset:1024 lds
    s_add_u32 s94, s94, 32768
    s_and_b32 s94, s94, 0x3ffff
    v_mul_f32 v47, v199, v107
    v_mul_f32 v48, v196, v108
    v_mul_f32 v49, v196, v109
    v_mul_f32 v50, v196, v110
    v_mul_f32 v51, v196, v111
    buffer_load_dwordx4 v254, s[4:7], s60 offen offset:2048 lds
    v_mul_f32 v52, v197, v108
    v_mul_f32 v53, v197, v109
    v_mul_f32 v54, v197, v110
    v_mul_f32 v55, v197, v111
    v_mul_f32 v56, v198, v108
    buffer_load_dwordx4 v254, s[4:7], s60 offen offset:3072 lds
    v_mul_f32 v57, v198, v109
    v_mul_f32 v58, v198, v110
    v_mul_f32 v59, v198, v111
    v_mul_f32 v60, v199, v108
    v_mul_f32 v61, v199, v109
    s_waitcnt vmcnt(8) lgkmcnt(0)
    s_barrier
    s_add_u32 m0, s61, 114688
    s_add_u32 s59, s62, 0
    buffer_load_dwordx4 v254, s[4:7], s59 offen lds
    v_mul_f32 v62, v199, v110
    v_mul_f32 v63, v199, v111
    v_mul_f32 v64, v196, v112
    v_mul_f32 v65, v196, v113
    v_mul_f32 v66, v196, v114
    buffer_load_dwordx4 v254, s[4:7], s59 offen offset:1024 lds
    v_mul_f32 v67, v196, v115
    v_mul_f32 v68, v197, v112
    v_mul_f32 v69, v197, v113
    v_mul_f32 v70, v197, v114
    v_mul_f32 v71, v197, v115
    buffer_load_dwordx4 v254, s[4:7], s59 offen offset:2048 lds
    v_mul_f32 v72, v198, v112
    v_mul_f32 v73, v198, v113
    v_mul_f32 v74, v198, v114
    v_mul_f32 v75, v198, v115
    v_mul_f32 v76, v199, v112
    buffer_load_dwordx4 v254, s[4:7], s59 offen offset:3072 lds
    v_mul_f32 v77, v199, v113
    v_mul_f32 v78, v199, v114
    v_mul_f32 v79, v199, v115
    v_mul_f32 v80, v196, v116
    v_mul_f32 v81, v196, v117
    s_waitcnt lgkmcnt(0)
    s_barrier
    s_add_u32 m0, s61, 118784
    s_add_u32 s60, s62, 4096
    buffer_load_dwordx4 v254, s[4:7], s60 offen lds
    v_mul_f32 v82, v196, v118
    v_mul_f32 v83, v196, v119
    v_mul_f32 v84, v197, v116
    v_mul_f32 v85, v197, v117
    buffer_load_dwordx4 v254, s[4:7], s60 offen offset:1024 lds
    v_mul_f32 v86, v197, v118
    v_mul_f32 v87, v197, v119
    v_mul_f32 v88, v198, v116
    v_mul_f32 v89, v198, v117
    v_mul_f32 v90, v198, v118
    buffer_load_dwordx4 v254, s[4:7], s60 offen offset:2048 lds
    v_mul_f32 v91, v198, v119
    v_mul_f32 v92, v199, v116
    v_mul_f32 v93, v199, v117
    v_mul_f32 v94, v199, v118
    v_mul_f32 v95, v199, v119
    buffer_load_dwordx4 v254, s[4:7], s60 offen offset:3072 lds
    s_lshl_b32 s55, s43, 13
    s_add_u32 s55, s55, 98304
    v_add_u32 v176, s55, v254
    v_lshrrev_b32 v224, 6, v254
    v_mul_u32_u24 v224, 192, v224
    v_and_b32 v225, 0x30, v254
    v_lshrrev_b32 v225, 1, v225
    s_waitcnt vmcnt(8) lgkmcnt(0)
    s_barrier
    s_add_u32 m0, s61, 131072
    s_add_u32 s59, s62, 16384
    buffer_load_dwordx4 v254, s[4:7], s59 offen lds
    v_add_u32 v224, v224, v225
    v_lshrrev_b32 v225, 8, v254
    v_and_b32 v225, 1, v225
    buffer_load_dwordx4 v254, s[4:7], s59 offen offset:1024 lds
    s_lshl_b32 s55, s44, 2
    v_xor_b32 v226, s55, v225
    v_lshl_add_u32 v177, v226, 5, v224
    v_xor_b32 v226, 1, v226
    buffer_load_dwordx4 v254, s[4:7], s59 offen offset:2048 lds
    v_lshl_add_u32 v178, v226, 5, v224
    s_add_u32 s55, s44, 2
    v_xor_b32 v226, s55, v225
    v_lshl_add_u32 v179, v226, 5, v224
    buffer_load_dwordx4 v254, s[4:7], s59 offen offset:3072 lds
    v_add_u32 v180, 49152, v177
    v_add_u32 v181, 49152, v178
    v_add_u32 v182, 49152, v179
    s_waitcnt lgkmcnt(0)
    s_barrier
    s_add_u32 m0, s61, 135168
    s_add_u32 s60, s62, 20480
    buffer_load_dwordx4 v254, s[4:7], s60 offen lds
    buffer_load_dwordx4 v254, s[4:7], s60 offen offset:1024 lds
    buffer_load_dwordx4 v254, s[4:7], s60 offen offset:2048 lds
    buffer_load_dwordx4 v254, s[4:7], s60 offen offset:3072 lds
    s_waitcnt vmcnt(8) lgkmcnt(0)
    s_barrier
    s_waitcnt vmcnt(0)
    s_setprio 0
    s_branch Y_g3b
YW_layer:
    s_mov_b32 s36, s4
    s_mov_b32 s37, s5
    s_mov_b32 s38, s6
    s_mov_b32 s39, s7
    v_mov_b32 v221, v254
    s_sub_u32 s64, s48, 4179968
    s_lshl_b32 s55, s43, 10
    s_add_u32 s64, s64, s55
    s_mov_b32 s66, 16384
    s_cmp_eq_u32 s40, 0
    s_cselect_b32 s64, 2130706432, s64
    s_lshl_b32 s65, s43, 10
    s_mov_b32 s95, s51
    s_barrier
    s_cmp_lg_u32 s42, 2
    s_cbranch_scc1 wf_59
    s_and_b32 s55, s51, 14
    s_lshl_b32 s55, s55, 1
    s_add_u32 s55, s55, s0
    v_mov_b32 v252, 64
    v_mov_b32 v250, 0x01010101
    s_mov_b64 exec, 1
    s_cmp_eq_u32 s45, 0
    s_cbranch_scc1 st_61
    buffer_store_dword v250, v252, s[4:7], s55 offen sc0 sc1
    s_branch st_62
st_61:
    buffer_store_dword v250, v252, s[4:7], s55 offen
st_62:
    s_mov_b64 exec, -1
    s_branch wf_60
wf_59:
    s_lshl_b32 s55, s51, 2
    s_add_u32 s55, s55, s54
    v_mov_b32 v252, 8192
    v_mov_b32 v250, 0x01010101
    s_mov_b64 exec, 1
    buffer_store_dword v250, v252, s[4:7], s55 offen sc0 sc1
    s_mov_b64 exec, -1
wf_60:
    s_cmp_eq_u32 s40, 0
    s_cbranch_scc1 gw_58
    s_add_u32 s59, s0, 4294967232
    s_add_u32 s60, s54, 8064
    s_and_b32 s55, s40, 3
    s_cselect_b32 s59, s59, s60
    s_cselect_b32 s60, 28, 60
    v_lshrrev_b32 v252, 2, v254
    v_min_u32 v252, s60, v252
    s_add_u32 s55, s59, 0
    s_mov_b32 s56, 262144
poll_63:
    buffer_load_dword v253, v252, s[4:7], s55 offen sc0 sc1
    s_waitcnt vmcnt(0)
    v_cmp_ne_u32 vcc, 0x01010101, v253
    s_cbranch_vccz pd_64
    s_sleep 1
    s_sub_u32 s56, s56, 1
    s_cmp_lg_u32 s56, 0
    s_cbranch_scc1 poll_63
pd_64:
gw_58:
    s_mul_i32 s93, s95, s66
    s_add_u32 m0, s65, 98304
    s_add_u32 s93, s93, s64
    buffer_load_dwordx4 v221, s[36:39], s93 offen lds
    s_add_u32 s95, s95, 2
    s_and_b32 s95, s95, 15
    s_mul_i32 s93, s95, s66
    s_add_u32 m0, s65, 116736
    s_add_u32 s93, s93, s64
    buffer_load_dwordx4 v221, s[36:39], s93 offen lds
    s_add_u32 s95, s95, 2
    s_and_b32 s95, s95, 15
    s_mul_i32 s93, s95, s66
    s_add_u32 m0, s65, 135168
    s_add_u32 s93, s93, s64
    buffer_load_dwordx4 v221, s[36:39], s93 offen lds
    s_add_u32 s95, s95, 2
    s_and_b32 s95, s95, 15
    s_waitcnt vmcnt(0)
YW_b:
    s_barrier
    s_setprio 1
    s_waitcnt vmcnt(26)
    s_barrier
    s_mul_i32 s59, s94, 196608
    s_add_u32 m0, s61, 0
    s_add_u32 s59, s59, s62
    buffer_load_dwordx4 v200, s[8:11], s59 offen lds
    buffer_load_dwordx4 v201, s[8:11], s59 offen offset:1024 lds
    s_add_u32 s94, s94, 1
    s_and_b32 s94, s94, 31
    buffer_load_dwordx4 v202, s[8:11], s59 offen offset:2048 lds
    s_add_u32 m0, s61, 3072
    s_add_u32 s60, s59, 0
    buffer_load_dwordx4 v203, s[8:11], s60 offen lds
    buffer_load_dwordx4 v204, s[8:11], s60 offen offset:1024 lds
    buffer_load_dwordx4 v205, s[8:11], s60 offen offset:2048 lds
    s_waitcnt vmcnt(25)
    s_barrier
    s_mul_i32 s93, s95, s66
    s_add_u32 m0, s65, 98304
    s_add_u32 s93, s93, s64
    buffer_load_dwordx4 v221, s[36:39], s93 offen lds
    s_add_u32 s95, s95, 2
    s_and_b32 s95, s95, 15
    s_mul_i32 s59, s94, 196608
    s_add_u32 m0, s61, 16384
    s_add_u32 s59, s59, s62
    buffer_load_dwordx4 v200, s[8:11], s59 offen lds
    buffer_load_dwordx4 v201, s[8:11], s59 offen offset:1024 lds
    s_add_u32 s94, s94, 3
    s_and_b32 s94, s94, 31
    buffer_load_dwordx4 v202, s[8:11], s59 offen offset:2048 lds
    s_add_u32 m0, s61, 19456
    s_add_u32 s60, s59, 0
    buffer_load_dwordx4 v203, s[8:11], s60 offen lds
    buffer_load_dwordx4 v204, s[8:11], s60 offen offset:1024 lds
    buffer_load_dwordx4 v205, s[8:11], s60 offen offset:2048 lds
    s_waitcnt vmcnt(25)
    s_barrier
    s_mul_i32 s59, s94, 196608
    s_add_u32 m0, s61, 32768
    s_add_u32 s59, s59, s62
    buffer_load_dwordx4 v200, s[8:11], s59 offen lds
    buffer_load_dwordx4 v201, s[8:11], s59 offen offset:1024 lds
    s_add_u32 s94, s94, 1
    s_and_b32 s94, s94, 31
    buffer_load_dwordx4 v202, s[8:11], s59 offen offset:2048 lds
    s_add_u32 m0, s61, 35840
    s_add_u32 s60, s59, 0
    buffer_load_dwordx4 v203, s[8:11], s60 offen lds
    buffer_load_dwordx4 v204, s[8:11], s60 offen offset:1024 lds
    buffer_load_dwordx4 v205, s[8:11], s60 offen offset:2048 lds
    s_waitcnt vmcnt(25)
    s_barrier
    s_mul_i32 s93, s95, s66
    s_add_u32 m0, s65, 116736
    s_add_u32 s93, s93, s64
    buffer_load_dwordx4 v221, s[36:39], s93 offen lds
    s_add_u32 s95, s95, 2
    s_and_b32 s95, s95, 15
    s_mul_i32 s59, s94, 196608
    s_add_u32 m0, s61, 49152
    s_add_u32 s59, s59, s62
    buffer_load_dwordx4 v200, s[8:11], s59 offen lds
    buffer_load_dwordx4 v201, s[8:11], s59 offen offset:1024 lds
    s_add_u32 s94, s94, 3
    s_and_b32 s94, s94, 31
    buffer_load_dwordx4 v202, s[8:11], s59 offen offset:2048 lds
    s_add_u32 m0, s61, 52224
    s_add_u32 s60, s59, 0
    buffer_load_dwordx4 v203, s[8:11], s60 offen lds
    buffer_load_dwordx4 v204, s[8:11], s60 offen offset:1024 lds
    buffer_load_dwordx4 v205, s[8:11], s60 offen offset:2048 lds
    s_waitcnt vmcnt(26)
    s_barrier
    s_mul_i32 s59, s94, 196608
    s_add_u32 m0, s61, 65536
    s_add_u32 s59, s59, s62
    buffer_load_dwordx4 v200, s[8:11], s59 offen lds
    buffer_load_dwordx4 v201, s[8:11], s59 offen offset:1024 lds
    s_add_u32 s94, s94, 1
    s_and_b32 s94, s94, 31
    buffer_load_dwordx4 v202, s[8:11], s59 offen offset:2048 lds
    s_add_u32 m0, s61, 68608
    s_add_u32 s60, s59, 0
    buffer_load_dwordx4 v203, s[8:11], s60 offen lds
    buffer_load_dwordx4 v204, s[8:11], s60 offen offset:1024 lds
    buffer_load_dwordx4 v205, s[8:11], s60 offen offset:2048 lds
    s_waitcnt vmcnt(25)
    s_barrier
    s_mul_i32 s93, s95, s66
    s_add_u32 m0, s65, 135168
    s_add_u32 s93, s93, s64
    buffer_load_dwordx4 v221, s[36:39], s93 offen lds
    s_add_u32 s95, s95, 2
    s_and_b32 s95, s95, 15
    s_mul_i32 s59, s94, 196608
    s_add_u32 m0, s61, 81920
    s_add_u32 s59, s59, s62
    buffer_load_dwordx4 v200, s[8:11], s59 offen lds
    buffer_load_dwordx4 v201, s[8:11], s59 offen offset:1024 lds
    s_add_u32 s94, s94, 3
    s_and_b32 s94, s94, 31
    buffer_load_dwordx4 v202, s[8:11], s59 offen offset:2048 lds
    s_add_u32 m0, s61, 84992
    s_add_u32 s60, s59, 0
    buffer_load_dwordx4 v203, s[8:11], s60 offen lds
    buffer_load_dwordx4 v204, s[8:11], s60 offen offset:1024 lds
    buffer_load_dwordx4 v205, s[8:11], s60 offen offset:2048 lds
    s_waitcnt vmcnt(26)
    s_barrier
    v_lshrrev_b32 v252, 2, v254
    v_min_u32 v252, 60, v252
    s_add_u32 s55, s54, 8064
    buffer_load_dword v251, v252, s[4:7], s55 offen sc0 sc1
    s_mul_i32 s59, s94, 196608
    s_add_u32 m0, s61, 0
    s_add_u32 s59, s59, s62
    buffer_load_dwordx4 v200, s[8:11], s59 offen lds
    buffer_load_dwordx4 v201, s[8:11], s59 offen offset:1024 lds
    s_add_u32 s94, s94, 1
    s_and_b32 s94, s94, 31
    buffer_load_dwordx4 v202, s[8:11], s59 offen offset:2048 lds
    s_add_u32 m0, s61, 3072
    s_add_u32 s60, s59, 0
    buffer_load_dwordx4 v203, s[8:11], s60 offen lds
    buffer_load_dwordx4 v204, s[8:11], s60 offen offset:1024 lds
    buffer_load_dwordx4 v205, s[8:11], s60 offen offset:2048 lds
    s_waitcnt vmcnt(26)
    s_barrier
    s_mul_i32 s93, s95, s66
    s_add_u32 m0, s65, 98304
    s_add_u32 s93, s93, s64
    buffer_load_dwordx4 v221, s[36:39], s93 offen lds
    s_add_u32 s95, s95, 2
    s_and_b32 s95, s95, 15
    s_mul_i32 s59, s94, 196608
    s_add_u32 m0, s61, 16384
    s_add_u32 s59, s59, s62
    buffer_load_dwordx4 v200, s[8:11], s59 offen lds
    buffer_load_dwordx4 v201, s[8:11], s59 offen offset:1024 lds
    s_add_u32 s94, s94, 3
    s_and_b32 s94, s94, 31
    buffer_load_dwordx4 v202, s[8:11], s59 offen offset:2048 lds
    s_add_u32 m0, s61, 19456
    s_add_u32 s60, s59, 0
    buffer_load_dwordx4 v203, s[8:11], s60 offen lds
    buffer_load_dwordx4 v204, s[8:11], s60 offen offset:1024 lds
    buffer_load_dwordx4 v205, s[8:11], s60 offen offset:2048 lds
    s_waitcnt vmcnt(27)
    s_barrier
    s_mul_i32 s59, s94, 196608
    s_add_u32 m0, s61, 32768
    s_add_u32 s59, s59, s62
    buffer_load_dwordx4 v200, s[8:11], s59 offen lds
    buffer_load_dwordx4 v201, s[8:11], s59 offen offset:1024 lds
    s_add_u32 s94, s94, 1
    s_and_b32 s94, s94, 31
    buffer_load_dwordx4 v202, s[8:11], s59 offen offset:2048 lds
    s_add_u32 m0, s61, 35840
    s_add_u32 s60, s59, 0
    buffer_load_dwordx4 v203, s[8:11], s60 offen lds
    buffer_load_dwordx4 v204, s[8:11], s60 offen offset:1024 lds
    buffer_load_dwordx4 v205, s[8:11], s60 offen offset:2048 lds
    v_lshrrev_b32 v224, 7, v254
    v_and_b32 v225, 0x70, v254
    v_and_b32 v226, 6, v224
    v_lshlrev_b32 v226, 4, v226
    v_xor_b32 v225, v225, v226
    v_lshl_add_u32 v206, v224, 11, v225
    v_add_u32 v207, 15360, v206
    v_add_u32 v208, 30720, v206
    v_add_u32 v209, 46080, v206
    s_lshl_b32 s67, s43, 13
    s_lshl_b32 s68, s51, 7
    s_waitcnt vmcnt(26)
    s_barrier
    s_mul_i32 s93, s95, s66
    s_add_u32 m0, s65, 116736
    s_add_u32 s93, s93, s64
    buffer_load_dwordx4 v221, s[36:39], s93 offen lds
    s_add_u32 s95, s95, 3
    s_and_b32 s95, s95, 15
    s_mul_i32 s59, s94, 196608
    s_add_u32 m0, s61, 49152
    s_add_u32 s59, s59, s62
    buffer_load_dwordx4 v200, s[8:11], s59 offen lds
    buffer_load_dwordx4 v201, s[8:11], s59 offen offset:1024 lds
    s_add_u32 s94, s94, 5
    s_and_b32 s94, s94, 31
    buffer_load_dwordx4 v202, s[8:11], s59 offen offset:2048 lds
    s_add_u32 m0, s61, 52224
    s_add_u32 s60, s59, 0
    buffer_load_dwordx4 v203, s[8:11], s60 offen lds
    buffer_load_dwordx4 v204, s[8:11], s60 offen offset:1024 lds
    buffer_load_dwordx4 v205, s[8:11], s60 offen offset:2048 lds
    s_waitcnt vmcnt(27)
    s_barrier
    s_mul_i32 s59, s94, 196608
    s_add_u32 m0, s61, 65536
    s_add_u32 s59, s59, s62
    buffer_load_dwordx4 v200, s[8:11], s59 offen lds
    buffer_load_dwordx4 v201, s[8:11], s59 offen offset:1024 lds
    s_add_u32 s94, s94, 1
    s_and_b32 s94, s94, 31
    buffer_load_dwordx4 v202, s[8:11], s59 offen offset:2048 lds
    s_add_u32 m0, s61, 68608
    s_add_u32 s60, s59, 0
    buffer_load_dwordx4 v203, s[8:11], s60 offen lds
    buffer_load_dwordx4 v204, s[8:11], s60 offen offset:1024 lds
    buffer_load_dwordx4 v205, s[8:11], s60 offen offset:2048 lds
    s_waitcnt vmcnt(25)
    s_barrier
    v_cmp_ne_u32 vcc, 0x01010101, v251
    s_cbranch_vccz ap_65
    s_cmp_eq_u32 s46, 0
    s_cbranch_scc1 ap_65
    s_cmp_eq_u32 s40, 0
    s_cbranch_scc1 ap_65
    v_lshrrev_b32 v252, 2, v254
    v_min_u32 v252, 60, v252
    s_add_u32 s55, s54, 8064
    s_mov_b32 s56, 262144
poll_66:
    buffer_load_dword v253, v252, s[4:7], s55 offen sc0 sc1
    s_waitcnt vmcnt(0)
    v_cmp_ne_u32 vcc, 0x01010101, v253
    s_cbranch_vccz pd_67
    s_sleep 1
    s_sub_u32 s56, s56, 1
    s_cmp_lg_u32 s56, 0
    s_cbranch_scc1 poll_66
pd_67:
ap_65:
    s_mul_i32 s93, s95, s66
    s_add_u32 m0, s65, 135168
    s_add_u32 s93, s93, s64
    buffer_load_dwordx4 v221, s[36:39], s93 offen lds
    s_add_u32 s95, s95, 2
    s_and_b32 s95, s95, 15
    s_mul_i32 s59, s94, 196608
    s_add_u32 m0, s61, 81920
    s_add_u32 s59, s59, s62
    buffer_load_dwordx4 v200, s[8:11], s59 offen lds
    buffer_load_dwordx4 v201, s[8:11], s59 offen offset:1024 lds
    s_add_u32 s94, s94, 3
    s_and_b32 s94, s94, 31
    buffer_load_dwordx4 v202, s[8:11], s59 offen offset:2048 lds
    s_add_u32 m0, s61, 84992
    s_add_u32 s60, s59, 0
    buffer_load_dwordx4 v203, s[8:11], s60 offen lds
    buffer_load_dwordx4 v204, s[8:11], s60 offen offset:1024 lds
    buffer_load_dwordx4 v205, s[8:11], s60 offen offset:2048 lds
    s_waitcnt vmcnt(26)
    s_barrier
    s_mul_i32 s59, s94, 196608
    s_add_u32 m0, s61, 0
    s_add_u32 s59, s59, s62
    buffer_load_dwordx4 v200, s[8:11], s59 offen lds
    buffer_load_dwordx4 v201, s[8:11], s59 offen offset:1024 lds
    s_add_u32 s94, s94, 1
    s_and_b32 s94, s94, 31
    buffer_load_dwordx4 v202, s[8:11], s59 offen offset:2048 lds
    s_add_u32 m0, s61, 3072
    s_add_u32 s60, s59, 0
    buffer_load_dwordx4 v203, s[8:11], s60 offen lds
    buffer_load_dwordx4 v204, s[8:11], s60 offen offset:1024 lds
    buffer_load_dwordx4 v205, s[8:11], s60 offen offset:2048 lds
    s_waitcnt vmcnt(25)
    s_barrier
    s_mul_i32 s93, s95, s66
    s_add_u32 m0, s65, 98304
    s_add_u32 s93, s93, s64
    buffer_load_dwordx4 v221, s[36:39], s93 offen lds
    s_add_u32 s95, s95, 2
    s_and_b32 s95, s95, 15
    s_mul_i32 s59, s94, 196608
    s_add_u32 m0, s61, 16384
    s_add_u32 s59, s59, s62
    buffer_load_dwordx4 v200, s[8:11], s59 offen lds
    buffer_load_dwordx4 v201, s[8:11], s59 offen offset:1024 lds
    s_add_u32 s94, s94, 3
    s_and_b32 s94, s94, 31
    buffer_load_dwordx4 v202, s[8:11], s59 offen offset:2048 lds
    s_add_u32 m0, s61, 19456
    s_add_u32 s60, s59, 0
    buffer_load_dwordx4 v203, s[8:11], s60 offen lds
    buffer_load_dwordx4 v204, s[8:11], s60 offen offset:1024 lds
    buffer_load_dwordx4 v205, s[8:11], s60 offen offset:2048 lds
    s_waitcnt vmcnt(26)
    s_barrier
    s_mul_i32 s59, s94, 196608
    s_add_u32 m0, s61, 32768
    s_add_u32 s59, s59, s62
    buffer_load_dwordx4 v200, s[8:11], s59 offen lds
    buffer_load_dwordx4 v201, s[8:11], s59 offen offset:1024 lds
    s_add_u32 s94, s94, 1
    s_and_b32 s94, s94, 31
    buffer_load_dwordx4 v202, s[8:11], s59 offen offset:2048 lds
    s_add_u32 m0, s61, 35840
    s_add_u32 s60, s59, 0
    buffer_load_dwordx4 v203, s[8:11], s60 offen lds
    buffer_load_dwordx4 v204, s[8:11], s60 offen offset:1024 lds
    buffer_load_dwordx4 v205, s[8:11], s60 offen offset:2048 lds
    s_waitcnt vmcnt(25)
    s_barrier
    s_mul_i32 s93, s95, s66
    s_add_u32 m0, s65, 116736
    s_add_u32 s93, s93, s64
    buffer_load_dwordx4 v221, s[36:39], s93 offen lds
    s_add_u32 s95, s95, 2
    s_and_b32 s95, s95, 15
    s_mul_i32 s59, s94, 196608
    s_add_u32 m0, s61, 49152
    s_add_u32 s59, s59, s62
    buffer_load_dwordx4 v200, s[8:11], s59 offen lds
    buffer_load_dwordx4 v201, s[8:11], s59 offen offset:1024 lds
    s_add_u32 s94, s94, 3
    s_and_b32 s94, s94, 31
    buffer_load_dwordx4 v202, s[8:11], s59 offen offset:2048 lds
    s_add_u32 m0, s61, 52224
    s_add_u32 s60, s59, 0
    buffer_load_dwordx4 v203, s[8:11], s60 offen lds
    buffer_load_dwordx4 v204, s[8:11], s60 offen offset:1024 lds
    buffer_load_dwordx4 v205, s[8:11], s60 offen offset:2048 lds
    s_waitcnt vmcnt(26)
    s_barrier
    s_mul_i32 s59, s94, 196608
    s_add_u32 m0, s61, 65536
    s_add_u32 s59, s59, s62
    buffer_load_dwordx4 v200, s[8:11], s59 offen lds
    buffer_load_dwordx4 v201, s[8:11], s59 offen offset:1024 lds
    s_add_u32 s94, s94, 1
    s_and_b32 s94, s94, 31
    buffer_load_dwordx4 v202, s[8:11], s59 offen offset:2048 lds
    s_add_u32 m0, s61, 68608
    s_add_u32 s60, s59, 0
    buffer_load_dwordx4 v203, s[8:11], s60 offen lds
    buffer_load_dwordx4 v204, s[8:11], s60 offen offset:1024 lds
    buffer_load_dwordx4 v205, s[8:11], s60 offen offset:2048 lds
    s_waitcnt vmcnt(25)
    s_barrier
    s_mul_i32 s93, s95, s66
    s_add_u32 m0, s65, 135168
    s_add_u32 s93, s93, s64
    buffer_load_dwordx4 v221, s[36:39], s93 offen lds
    s_add_u32 s95, s95, 2
    s_and_b32 s95, s95, 15
    s_mul_i32 s59, s94, 196608
    s_add_u32 m0, s61, 81920
    s_add_u32 s59, s59, s62
    buffer_load_dwordx4 v200, s[8:11], s59 offen lds
    buffer_load_dwordx4 v201, s[8:11], s59 offen offset:1024 lds
    s_add_u32 s94, s94, 3
    s_and_b32 s94, s94, 31
    buffer_load_dwordx4 v202, s[8:11], s59 offen offset:2048 lds
    s_add_u32 m0, s61, 84992
    s_add_u32 s60, s59, 0
    buffer_load_dwordx4 v203, s[8:11], s60 offen lds
    buffer_load_dwordx4 v204, s[8:11], s60 offen offset:1024 lds
    buffer_load_dwordx4 v205, s[8:11], s60 offen offset:2048 lds
    s_waitcnt vmcnt(26)
    s_barrier
    s_mul_i32 s59, s94, 196608
    s_add_u32 m0, s61, 0
    s_add_u32 s59, s59, s62
    buffer_load_dwordx4 v200, s[8:11], s59 offen lds
    buffer_load_dwordx4 v201, s[8:11], s59 offen offset:1024 lds
    s_add_u32 s94, s94, 1
    s_and_b32 s94, s94, 31
    buffer_load_dwordx4 v202, s[8:11], s59 offen offset:2048 lds
    s_add_u32 m0, s61, 3072
    s_add_u32 s60, s59, 0
    buffer_load_dwordx4 v203, s[8:11], s60 offen lds
    buffer_load_dwordx4 v204, s[8:11], s60 offen offset:1024 lds
    buffer_load_dwordx4 v205, s[8:11], s60 offen offset:2048 lds
    s_waitcnt vmcnt(25)
    s_barrier
    s_mul_i32 s93, s95, s66
    s_add_u32 m0, s65, 98304
    s_add_u32 s93, s93, s64
    buffer_load_dwordx4 v221, s[36:39], s93 offen lds
    s_add_u32 s95, s95, 2
    s_and_b32 s95, s95, 15
    s_mul_i32 s59, s94, 196608
    s_add_u32 m0, s61, 16384
    s_add_u32 s59, s59, s62
    buffer_load_dwordx4 v200, s[8:11], s59 offen lds
    buffer_load_dwordx4 v201, s[8:11], s59 offen offset:1024 lds
    s_add_u32 s94, s94, 3
    s_and_b32 s94, s94, 31
    buffer_load_dwordx4 v202, s[8:11], s59 offen offset:2048 lds
    s_add_u32 m0, s61, 19456
    s_add_u32 s60, s59, 0
    buffer_load_dwordx4 v203, s[8:11], s60 offen lds
    buffer_load_dwordx4 v204, s[8:11], s60 offen offset:1024 lds
    buffer_load_dwordx4 v205, s[8:11], s60 offen offset:2048 lds
    s_waitcnt vmcnt(26)
    s_barrier
    s_mul_i32 s59, s94, 196608
    s_add_u32 m0, s61, 32768
    s_add_u32 s59, s59, s62
    buffer_load_dwordx4 v200, s[8:11], s59 offen lds
    buffer_load_dwordx4 v201, s[8:11], s59 offen offset:1024 lds
    s_add_u32 s94, s94, 1
    s_and_b32 s94, s94, 31
    buffer_load_dwordx4 v202, s[8:11], s59 offen offset:2048 lds
    s_add_u32 m0, s61, 35840
    s_add_u32 s60, s59, 0
    buffer_load_dwordx4 v203, s[8:11], s60 offen lds
    buffer_load_dwordx4 v204, s[8:11], s60 offen offset:1024 lds
    buffer_load_dwordx4 v205, s[8:11], s60 offen offset:2048 lds
    s_waitcnt vmcnt(25)
    s_barrier
    s_mul_i32 s93, s95, s66
    s_add_u32 m0, s65, 116736
    s_add_u32 s93, s93, s64
    buffer_load_dwordx4 v221, s[36:39], s93 offen lds
    s_add_u32 s95, s95, 2
    s_and_b32 s95, s95, 15
    s_mul_i32 s59, s94, 196608
    s_add_u32 m0, s61, 49152
    s_add_u32 s59, s59, s62
    buffer_load_dwordx4 v200, s[8:11], s59 offen lds
    buffer_load_dwordx4 v201, s[8:11], s59 offen offset:1024 lds
    s_add_u32 s94, s94, 3
    s_and_b32 s94, s94, 31
    buffer_load_dwordx4 v202, s[8:11], s59 offen offset:2048 lds
    s_add_u32 m0, s61, 52224
    s_add_u32 s60, s59, 0
    buffer_load_dwordx4 v203, s[8:11], s60 offen lds
    buffer_load_dwordx4 v204, s[8:11], s60 offen offset:1024 lds
    buffer_load_dwordx4 v205, s[8:11], s60 offen offset:2048 lds
    s_waitcnt vmcnt(26)
    s_barrier
    s_mul_i32 s59, s94, 196608
    s_add_u32 m0, s61, 65536
    s_add_u32 s59, s59, s62
    buffer_load_dwordx4 v200, s[8:11], s59 offen lds
    buffer_load_dwordx4 v201, s[8:11], s59 offen offset:1024 lds
    s_add_u32 s94, s94, 1
    s_and_b32 s94, s94, 31
    buffer_load_dwordx4 v202, s[8:11], s59 offen offset:2048 lds
    s_add_u32 m0, s61, 68608
    s_add_u32 s60, s59, 0
    buffer_load_dwordx4 v203, s[8:11], s60 offen lds
    buffer_load_dwordx4 v204, s[8:11], s60 offen offset:1024 lds
    buffer_load_dwordx4 v205, s[8:11], s60 offen offset:2048 lds
    s_waitcnt vmcnt(25)
    s_barrier
    s_mul_i32 s93, s95, s66
    s_add_u32 m0, s65, 135168
    s_add_u32 s93, s93, s64
    buffer_load_dwordx4 v221, s[36:39], s93 offen lds
    s_add_u32 s95, s95, 2
    s_and_b32 s95, s95, 15
    s_mul_i32 s59, s94, 196608
    s_add_u32 m0, s61, 81920
    s_add_u32 s59, s59, s62
    buffer_load_dwordx4 v200, s[8:11], s59 offen lds
    buffer_load_dwordx4 v201, s[8:11], s59 offen offset:1024 lds
    s_add_u32 s94, s94, 3
    s_and_b32 s94, s94, 31
    buffer_load_dwordx4 v202, s[8:11], s59 offen offset:2048 lds
    s_add_u32 m0, s61, 84992
    s_add_u32 s60, s59, 0
    buffer_load_dwordx4 v203, s[8:11], s60 offen lds
    buffer_load_dwordx4 v204, s[8:11], s60 offen offset:1024 lds
    buffer_load_dwordx4 v205, s[8:11], s60 offen offset:2048 lds
    s_waitcnt vmcnt(26)
    s_barrier
    s_mul_i32 s59, s94, 196608
    s_add_u32 m0, s61, 0
    s_add_u32 s59, s59, s62
    buffer_load_dwordx4 v200, s[8:11], s59 offen lds
    buffer_load_dwordx4 v201, s[8:11], s59 offen offset:1024 lds
    s_add_u32 s94, s94, 1
    s_and_b32 s94, s94, 31
    buffer_load_dwordx4 v202, s[8:11], s59 offen offset:2048 lds
    s_add_u32 m0, s61, 3072
    s_add_u32 s60, s59, 0
    buffer_load_dwordx4 v203, s[8:11], s60 offen lds
    buffer_load_dwordx4 v204, s[8:11], s60 offen offset:1024 lds
    buffer_load_dwordx4 v205, s[8:11], s60 offen offset:2048 lds
    s_waitcnt vmcnt(25)
    s_barrier
    s_mul_i32 s93, s95, s66
    s_add_u32 m0, s65, 98304
    s_add_u32 s93, s93, s64
    buffer_load_dwordx4 v221, s[36:39], s93 offen lds
    s_add_u32 s95, s95, 2
    s_and_b32 s95, s95, 15
    s_mul_i32 s59, s94, 196608
    s_add_u32 m0, s61, 16384
    s_add_u32 s59, s59, s62
    buffer_load_dwordx4 v200, s[8:11], s59 offen lds
    buffer_load_dwordx4 v201, s[8:11], s59 offen offset:1024 lds
    s_add_u32 s94, s94, 3
    s_and_b32 s94, s94, 31
    buffer_load_dwordx4 v202, s[8:11], s59 offen offset:2048 lds
    s_add_u32 m0, s61, 19456
    s_add_u32 s60, s59, 0
    buffer_load_dwordx4 v203, s[8:11], s60 offen lds
    buffer_load_dwordx4 v204, s[8:11], s60 offen offset:1024 lds
    buffer_load_dwordx4 v205, s[8:11], s60 offen offset:2048 lds
    s_waitcnt vmcnt(26)
    s_barrier
    s_lshl_b32 s94, s43, 1
    s_add_u32 s94, s51, s94
    s_and_b32 s94, s94, 15
    s_mul_i32 s59, s94, 131072
    s_add_u32 m0, s67, 32768
    s_add_u32 s59, s59, s68
    buffer_load_dwordx4 v206, s[12:15], s59 offen lds
    buffer_load_dwordx4 v207, s[12:15], s59 offen offset:1024 lds
    s_add_u32 s94, s94, 4
    s_and_b32 s94, s94, 15
    buffer_load_dwordx4 v208, s[12:15], s59 offen offset:2048 lds
    buffer_load_dwordx4 v209, s[12:15], s59 offen offset:3072 lds
    s_add_u32 m0, s67, 36864
    s_add_u32 s60, s59, 65536
    buffer_load_dwordx4 v206, s[12:15], s60 offen lds
    buffer_load_dwordx4 v207, s[12:15], s60 offen offset:1024 lds
    buffer_load_dwordx4 v208, s[12:15], s60 offen offset:2048 lds
    buffer_load_dwordx4 v209, s[12:15], s60 offen offset:3072 lds
    s_waitcnt vmcnt(27)
    s_barrier
    s_mul_i32 s59, s94, 131072
    s_add_u32 m0, s67, 49152
    s_add_u32 s59, s59, s68
    buffer_load_dwordx4 v206, s[12:15], s59 offen lds
    buffer_load_dwordx4 v207, s[12:15], s59 offen offset:1024 lds
    s_add_u32 s94, s94, 4
    s_and_b32 s94, s94, 15
    buffer_load_dwordx4 v208, s[12:15], s59 offen offset:2048 lds
    buffer_load_dwordx4 v209, s[12:15], s59 offen offset:3072 lds
    s_add_u32 m0, s67, 53248
    s_add_u32 s60, s59, 65536
    buffer_load_dwordx4 v206, s[12:15], s60 offen lds
    buffer_load_dwordx4 v207, s[12:15], s60 offen offset:1024 lds
    buffer_load_dwordx4 v208, s[12:15], s60 offen offset:2048 lds
    buffer_load_dwordx4 v209, s[12:15], s60 offen offset:3072 lds
    s_waitcnt vmcnt(29)
    s_barrier
    s_mul_i32 s59, s94, 131072
    s_add_u32 m0, s67, 65536
    s_add_u32 s59, s59, s68
    buffer_load_dwordx4 v206, s[12:15], s59 offen lds
    buffer_load_dwordx4 v207, s[12:15], s59 offen offset:1024 lds
    s_add_u32 s94, s94, 4
    s_and_b32 s94, s94, 15
    buffer_load_dwordx4 v208, s[12:15], s59 offen offset:2048 lds
    buffer_load_dwordx4 v209, s[12:15], s59 offen offset:3072 lds
    s_add_u32 m0, s67, 69632
    s_add_u32 s60, s59, 65536
    buffer_load_dwordx4 v206, s[12:15], s60 offen lds
    buffer_load_dwordx4 v207, s[12:15], s60 offen offset:1024 lds
    buffer_load_dwordx4 v208, s[12:15], s60 offen offset:2048 lds
    buffer_load_dwordx4 v209, s[12:15], s60 offen offset:3072 lds
    s_cmp_lg_u32 s46, 0
    s_cbranch_scc1 jw_68
    buffer_load_dwordx4 v[16:19], v222, s[72:75], s76 offen
    s_add_u32 s76, s76, 57344
    buffer_load_dwordx4 v[20:23], v222, s[72:75], s76 offen
    s_add_u32 s76, s76, 57344
    buffer_load_dwordx4 v[24:27], v222, s[72:75], s76 offen
    s_add_u32 s76, s76, 57344
    buffer_load_dwordx4 v[28:31], v222, s[72:75], s76 offen
    s_add_u32 s76, s76, 57344
jw_68:
    s_waitcnt vmcnt(30)
    s_barrier
    s_mul_i32 s59, s94, 131072
    s_add_u32 m0, s67, 81920
    s_add_u32 s59, s59, s68
    buffer_load_dwordx4 v206, s[12:15], s59 offen lds
    buffer_load_dwordx4 v207, s[12:15], s59 offen offset:1024 lds
    s_add_u32 s94, s94, 5
    s_and_b32 s94, s94, 15
    buffer_load_dwordx4 v208, s[12:15], s59 offen offset:2048 lds
    buffer_load_dwordx4 v209, s[12:15], s59 offen offset:3072 lds
    s_add_u32 m0, s67, 86016
    s_add_u32 s60, s59, 65536
    buffer_load_dwordx4 v206, s[12:15], s60 offen lds
    buffer_load_dwordx4 v207, s[12:15], s60 offen offset:1024 lds
    buffer_load_dwordx4 v208, s[12:15], s60 offen offset:2048 lds
    buffer_load_dwordx4 v209, s[12:15], s60 offen offset:3072 lds
    s_cmp_lg_u32 s46, 0
    s_cbranch_scc1 jw_69
    buffer_load_dwordx4 v[32:35], v222, s[72:75], s76 offen
    s_add_u32 s76, s76, 57344
    buffer_load_dwordx4 v[36:39], v222, s[72:75], s76 offen
    s_add_u32 s76, s76, 57344
    buffer_load_dwordx4 v[40:43], v222, s[72:75], s76 offen
    s_add_u32 s76, s76, 57344
    buffer_load_dwordx4 v[44:47], v222, s[72:75], s76 offen
    s_add_u32 s76, s76, 57344
jw_69:
    s_waitcnt vmcnt(32)
    s_barrier
    s_mul_i32 s59, s94, 131072
    s_add_u32 m0, s67, 0
    s_add_u32 s59, s59, s68
    buffer_load_dwordx4 v206, s[12:15], s59 offen lds
    buffer_load_dwordx4 v207, s[12:15], s59 offen offset:1024 lds
    s_add_u32 s94, s94, 4
    s_and_b32 s94, s94, 15
    buffer_load_dwordx4 v208, s[12:15], s59 offen offset:2048 lds
    buffer_load_dwordx4 v209, s[12:15], s59 offen offset:3072 lds
    s_add_u32 m0, s67, 4096
    s_add_u32 s60, s59, 65536
    buffer_load_dwordx4 v206, s[12:15], s60 offen lds
    buffer_load_dwordx4 v207, s[12:15], s60 offen offset:1024 lds
    buffer_load_dwordx4 v208, s[12:15], s60 offen offset:2048 lds
    buffer_load_dwordx4 v209, s[12:15], s60 offen offset:3072 lds
    s_cmp_lg_u32 s46, 0
    s_cbranch_scc1 jw_70
    buffer_load_dwordx4 v[48:51], v222, s[72:75], s76 offen
    s_add_u32 s76, s76, 57344
    buffer_load_dwordx4 v[52:55], v222, s[72:75], s76 offen
    s_add_u32 s76, s76, 57344
    buffer_load_dwordx4 v[56:59], v222, s[72:75], s76 offen
    s_add_u32 s76, s76, 57344
    buffer_load_dwordx4 v[60:63], v222, s[72:75], s76 offen
    s_add_u32 s76, s76, 57344
jw_70:
    s_barrier
    s_mul_i32 s59, s94, 131072
    s_add_u32 m0, s67, 16384
    s_add_u32 s59, s59, s68
    buffer_load_dwordx4 v206, s[12:15], s59 offen lds
    buffer_load_dwordx4 v207, s[12:15], s59 offen offset:1024 lds
    s_add_u32 s94, s94, 4
    s_and_b32 s94, s94, 15
    buffer_load_dwordx4 v208, s[12:15], s59 offen offset:2048 lds
    buffer_load_dwordx4 v209, s[12:15], s59 offen offset:3072 lds
    s_add_u32 m0, s67, 20480
    s_add_u32 s60, s59, 65536
    buffer_load_dwordx4 v206, s[12:15], s60 offen lds
    buffer_load_dwordx4 v207, s[12:15], s60 offen offset:1024 lds
    buffer_load_dwordx4 v208, s[12:15], s60 offen offset:2048 lds
    buffer_load_dwordx4 v209, s[12:15], s60 offen offset:3072 lds
    s_cmp_lg_u32 s46, 0
    s_cbranch_scc1 jw_71
    buffer_load_dwordx4 v[64:67], v222, s[72:75], s76 offen
    s_add_u32 s76, s76, 57344
    buffer_load_dwordx4 v[68:71], v222, s[72:75], s76 offen
    s_add_u32 s76, s76, 57344
    buffer_load_dwordx4 v[72:75], v222, s[72:75], s76 offen
    s_add_u32 s76, s76, 57344
    buffer_load_dwordx4 v[76:79], v222, s[72:75], s76 offen
    s_add_u32 s76, s76, 57344
jw_71:
    v_lshlrev_b32 v224, 7, v254
    s_add_u32 s55, s94, 0
    s_and_b32 s55, s55, 15
    s_lshl_b32 s55, s55, 17
    s_add_u32 s55, s55, s68
    buffer_load_dword v251, v224, s[12:15], s55 offen
    s_add_u32 s55, s94, 4
    s_and_b32 s55, s55, 15
    s_lshl_b32 s55, s55, 17
    s_add_u32 s55, s55, s68
    buffer_load_dword v251, v224, s[12:15], s55 offen
    v_mov_b32 v224, 157568
    ds_read_b32 v224, v224
    s_waitcnt lgkmcnt(0)
    v_readfirstlane_b32 s45, v224
    v_mov_b32 v0, -1
    v_mov_b32 v1, -1
    v_mov_b32 v2, -1
    v_mov_b32 v3, -1
    s_lshl_b32 s55, s51, 14
    s_add_u32 s55, s55, s67
    s_add_u32 s55, s55, s47
    s_add_u32 s55, s55, 1310720
    buffer_store_dwordx4 v[0:3], v254, s[4:7], s55 offen offset:0 sc0 sc1
    buffer_store_dwordx4 v[0:3], v254, s[4:7], s55 offen offset:1024 sc0 sc1
    buffer_store_dwordx4 v[0:3], v254, s[4:7], s55 offen offset:2048 sc0 sc1
    buffer_store_dwordx4 v[0:3], v254, s[4:7], s55 offen offset:3072 sc0 sc1
    s_add_u32 s55, s55, 4096
    buffer_store_dwordx4 v[0:3], v254, s[4:7], s55 offen offset:0 sc0 sc1
    buffer_store_dwordx4 v[0:3], v254, s[4:7], s55 offen offset:1024 sc0 sc1
    buffer_store_dwordx4 v[0:3], v254, s[4:7], s55 offen offset:2048 sc0 sc1
    buffer_store_dwordx4 v[0:3], v254, s[4:7], s55 offen offset:3072 sc0 sc1
    v_and_b32 v225, 0xf0, v254
    v_lshrrev_b32 v224, 8, v254
    v_and_b32 v226, 7, v224
    v_lshlrev_b32 v226, 5, v226
    v_xor_b32 v226, v225, v226
    v_mul_u32_u24 v224, 7168, v224
    v_add_u32 v210, v224, v226
    v_lshrrev_b32 v224, 8, v254
    v_add_u32 v224, 4, v224
    v_and_b32 v226, 7, v224
    v_lshlrev_b32 v226, 5, v226
    v_xor_b32 v226, v225, v226
    v_mul_u32_u24 v224, 7168, v224
    v_add_u32 v211, v224, v226
    v_subrev_u32 v211, 1024, v211
    v_lshrrev_b32 v224, 8, v254
    v_add_u32 v224, 8, v224
    v_and_b32 v226, 7, v224
    v_lshlrev_b32 v226, 5, v226
    v_xor_b32 v226, v225, v226
    v_mul_u32_u24 v224, 7168, v224
    v_add_u32 v212, v224, v226
    v_subrev_u32 v212, 2048, v212
    v_lshrrev_b32 v224, 8, v254
    v_add_u32 v224, 12, v224
    v_and_b32 v226, 7, v224
    v_lshlrev_b32 v226, 5, v226
    v_xor_b32 v226, v225, v226
    v_mul_u32_u24 v224, 7168, v224
    v_add_u32 v213, v224, v226
    v_subrev_u32 v213, 3072, v213
    s_lshl_b32 s67, s43, 13
    s_mul_i32 s62, s41, 448
    s_and_b32 s55, s41, 1
    s_mul_i32 s55, s55, 192
    s_add_u32 s62, s62, s55
    s_mov_b32 s55, 5462
    v_lshrrev_b32 v224, 4, v254
    v_mul_lo_u32 v225, v224, s55
    v_lshrrev_b32 v225, 16, v225
    v_mul_u32_u24 v226, 12, v225
    v_sub_u32 v224, v224, v226
    v_lshrrev_b32 v226, 1, v225
    v_and_b32 v226, 2, v226
    v_xor_b32 v224, v224, v226
    v_mul_u32_u24 v225, 7168, v225
    v_lshl_add_u32 v214, v224, 4, v225
    v_lshrrev_b32 v224, 4, v254
    v_add_u32 v224, 64, v224
    v_mul_lo_u32 v225, v224, s55
    v_lshrrev_b32 v225, 16, v225
    v_mul_u32_u24 v226, 12, v225
    v_sub_u32 v224, v224, v226
    v_lshrrev_b32 v226, 1, v225
    v_and_b32 v226, 2, v226
    v_xor_b32 v224, v224, v226
    v_mul_u32_u24 v225, 7168, v225
    v_lshl_add_u32 v215, v224, 4, v225
    v_subrev_u32 v215, 1024, v215
    v_lshrrev_b32 v224, 4, v254
    v_add_u32 v224, 128, v224
    v_mul_lo_u32 v225, v224, s55
    v_lshrrev_b32 v225, 16, v225
    v_mul_u32_u24 v226, 12, v225
    v_sub_u32 v224, v224, v226
    v_lshrrev_b32 v226, 1, v225
    v_and_b32 v226, 2, v226
    v_xor_b32 v224, v224, v226
    v_mul_u32_u24 v225, 7168, v225
    v_lshl_add_u32 v216, v224, 4, v225
    v_subrev_u32 v216, 2048, v216
    s_mul_i32 s61, s43, 6144
    s_mul_i32 s63, s41, 448
    s_and_b32 s55, s41, 1
    s_xor_b32 s55, s55, 1
    s_lshl_b32 s55, s55, 8
    s_add_u32 s63, s63, s55
    s_barrier
    s_cmp_lg_u32 s42, 2
    s_cbranch_scc1 wf_72
    s_and_b32 s55, s51, 14
    s_lshl_b32 s55, s55, 1
    s_add_u32 s55, s55, s0
    v_mov_b32 v252, 0
    v_mov_b32 v250, 0x01010101
    s_mov_b64 exec, 1
    s_cmp_eq_u32 s45, 0
    s_cbranch_scc1 st_74
    buffer_store_dword v250, v252, s[4:7], s55 offen sc0 sc1
    s_branch st_75
st_74:
    buffer_store_dword v250, v252, s[4:7], s55 offen
st_75:
    s_mov_b64 exec, -1
    s_branch wf_73
wf_72:
    s_lshl_b32 s55, s51, 2
    s_add_u32 s55, s55, s54
    v_mov_b32 v252, 0
    v_mov_b32 v250, 0x01010101
    s_mov_b64 exec, 1
    buffer_store_dword v250, v252, s[4:7], s55 offen sc0 sc1
    s_mov_b64 exec, -1
wf_73:
    s_waitcnt vmcnt(50)
    s_barrier
    s_barrier
    s_waitcnt vmcnt(42)
    s_barrier
    s_mul_i32 s59, s94, 131072
    s_add_u32 m0, s67, 32768
    s_add_u32 s59, s59, s68
    buffer_load_dwordx4 v206, s[12:15], s59 offen lds
    buffer_load_dwordx4 v207, s[12:15], s59 offen offset:1024 lds
    s_add_u32 s94, s94, 4
    s_and_b32 s94, s94, 15
    buffer_load_dwordx4 v208, s[12:15], s59 offen offset:2048 lds
    buffer_load_dwordx4 v209, s[12:15], s59 offen offset:3072 lds
    s_add_u32 m0, s67, 36864
    s_add_u32 s60, s59, 65536
    buffer_load_dwordx4 v206, s[12:15], s60 offen lds
    buffer_load_dwordx4 v207, s[12:15], s60 offen offset:1024 lds
    buffer_load_dwordx4 v208, s[12:15], s60 offen offset:2048 lds
    buffer_load_dwordx4 v209, s[12:15], s60 offen offset:3072 lds
    s_barrier
    s_waitcnt vmcnt(42)
    s_barrier
    s_mul_i32 s59, s94, 131072
    s_add_u32 m0, s67, 49152
    s_add_u32 s59, s59, s68
    buffer_load_dwordx4 v206, s[12:15], s59 offen lds
    buffer_load_dwordx4 v207, s[12:15], s59 offen offset:1024 lds
    s_add_u32 s94, s94, 4
    s_and_b32 s94, s94, 15
    buffer_load_dwordx4 v208, s[12:15], s59 offen offset:2048 lds
    buffer_load_dwordx4 v209, s[12:15], s59 offen offset:3072 lds
    s_add_u32 m0, s67, 53248
    s_add_u32 s60, s59, 65536
    buffer_load_dwordx4 v206, s[12:15], s60 offen lds
    buffer_load_dwordx4 v207, s[12:15], s60 offen offset:1024 lds
    buffer_load_dwordx4 v208, s[12:15], s60 offen offset:2048 lds
    buffer_load_dwordx4 v209, s[12:15], s60 offen offset:3072 lds
    s_barrier
    s_waitcnt vmcnt(42)
    s_barrier
    s_barrier
    s_waitcnt vmcnt(34)
    s_barrier
    s_barrier
    s_waitcnt vmcnt(26)
    s_barrier
    s_barrier
    s_waitcnt vmcnt(8)
    s_barrier
    s_barrier
    s_waitcnt vmcnt(0)
    s_barrier
    s_lshl_b32 s94, s51, 1
    s_mul_i32 s59, s94, 229376
    s_add_u32 m0, s67, 65536
    s_add_u32 s59, s59, s62
    buffer_load_dwordx4 v210, s[16:19], s59 offen lds
    buffer_load_dwordx4 v211, s[16:19], s59 offen offset:1024 lds
    s_add_u32 s94, s94, 1
    s_and_b32 s94, s94, 31
    buffer_load_dwordx4 v212, s[16:19], s59 offen offset:2048 lds
    buffer_load_dwordx4 v213, s[16:19], s59 offen offset:3072 lds
    s_add_u32 m0, s67, 69632
    s_add_u32 s60, s59, 114688
    buffer_load_dwordx4 v210, s[16:19], s60 offen lds
    buffer_load_dwordx4 v211, s[16:19], s60 offen offset:1024 lds
    buffer_load_dwordx4 v212, s[16:19], s60 offen offset:2048 lds
    buffer_load_dwordx4 v213, s[16:19], s60 offen offset:3072 lds
    s_barrier
    s_mul_i32 s59, s94, 229376
    s_add_u32 m0, s67, 81920
    s_add_u32 s59, s59, s62
    buffer_load_dwordx4 v210, s[16:19], s59 offen lds
    buffer_load_dwordx4 v211, s[16:19], s59 offen offset:1024 lds
    s_add_u32 s94, s94, 3
    s_and_b32 s94, s94, 31
    buffer_load_dwordx4 v212, s[16:19], s59 offen offset:2048 lds
    buffer_load_dwordx4 v213, s[16:19], s59 offen offset:3072 lds
    s_add_u32 m0, s67, 86016
    s_add_u32 s60, s59, 114688
    buffer_load_dwordx4 v210, s[16:19], s60 offen lds
    buffer_load_dwordx4 v211, s[16:19], s60 offen offset:1024 lds
    buffer_load_dwordx4 v212, s[16:19], s60 offen offset:2048 lds
    buffer_load_dwordx4 v213, s[16:19], s60 offen offset:3072 lds
    s_barrier
    s_mul_i32 s59, s94, 229376
    s_add_u32 m0, s67, 0
    s_add_u32 s59, s59, s62
    buffer_load_dwordx4 v210, s[16:19], s59 offen lds
    buffer_load_dwordx4 v211, s[16:19], s59 offen offset:1024 lds
    s_add_u32 s94, s94, 1
    s_and_b32 s94, s94, 31
    buffer_load_dwordx4 v212, s[16:19], s59 offen offset:2048 lds
    buffer_load_dwordx4 v213, s[16:19], s59 offen offset:3072 lds
    s_add_u32 m0, s67, 4096
    s_add_u32 s60, s59, 114688
    buffer_load_dwordx4 v210, s[16:19], s60 offen lds
    buffer_load_dwordx4 v211, s[16:19], s60 offen offset:1024 lds
    buffer_load_dwordx4 v212, s[16:19], s60 offen offset:2048 lds
    buffer_load_dwordx4 v213, s[16:19], s60 offen offset:3072 lds
    s_cmp_lg_u32 s46, 0
    s_cbranch_scc1 jw_76
    v_mov_b32 v12, 0x3f80
    v_lshrrev_b32 v224, 4, v254
    v_and_b32 v225, 1, v224
    v_lshlrev_b32 v225, 4, v225
    v_lshlrev_b32 v225, v225, v12
    v_bfe_u32 v224, v224, 1, 3
    v_cmp_eq_u32 vcc, 0, v224
    s_nop 1
    v_cndmask_b32 v12, 0, v225, vcc
    v_cmp_eq_u32 vcc, 1, v224
    s_nop 1
    v_cndmask_b32 v13, 0, v225, vcc
    v_cmp_eq_u32 vcc, 2, v224
    s_nop 1
    v_cndmask_b32 v14, 0, v225, vcc
    v_cmp_eq_u32 vcc, 3, v224
    s_nop 1
    v_cndmask_b32 v15, 0, v225, vcc
    s_nop 1
    v_mfma_f32_16x16x32_bf16 v[8:11], v[12:15], v[16:19], 0
    v_mfma_f32_16x16x32_bf16 v[8:11], v[12:15], v[20:23], v[8:11]
    v_mfma_f32_16x16x32_bf16 v[8:11], v[12:15], v[24:27], v[8:11]
    v_mfma_f32_16x16x32_bf16 v[8:11], v[12:15], v[28:31], v[8:11]
    v_mfma_f32_16x16x32_bf16 v[8:11], v[12:15], v[32:35], v[8:11]
    v_mfma_f32_16x16x32_bf16 v[8:11], v[12:15], v[36:39], v[8:11]
    v_mfma_f32_16x16x32_bf16 v[8:11], v[12:15], v[40:43], v[8:11]
    v_mfma_f32_16x16x32_bf16 v[8:11], v[12:15], v[44:47], v[8:11]
    v_mfma_f32_16x16x32_bf16 v[8:11], v[12:15], v[48:51], v[8:11]
    v_mfma_f32_16x16x32_bf16 v[8:11], v[12:15], v[52:55], v[8:11]
    v_mfma_f32_16x16x32_bf16 v[8:11], v[12:15], v[56:59], v[8:11]
    v_mfma_f32_16x16x32_bf16 v[8:11], v[12:15], v[60:63], v[8:11]
    v_mfma_f32_16x16x32_bf16 v[8:11], v[12:15], v[64:67], v[8:11]
    v_mfma_f32_16x16x32_bf16 v[8:11], v[12:15], v[68:71], v[8:11]
    v_mfma_f32_16x16x32_bf16 v[8:11], v[12:15], v[72:75], v[8:11]
    v_mfma_f32_16x16x32_bf16 v[8:11], v[12:15], v[76:79], v[8:11]
    s_and_b32 s56, s2, 1
    s_mul_i32 s56, s56, 3
    s_add_u32 s56, s56, s42
    s_mul_i32 s56, s56, 28672
    s_lshr_b32 s55, s2, 1
    s_lshl_b32 s55, s55, 8
    s_add_u32 s55, s55, s56
    s_add_u32 s55, s55, 70750208
    s_cmp_lt_u32 s2, 224
    s_cselect_b32 s55, s55, 2130706432
    v_and_b32 v224, 0x70, v254
    v_lshrrev_b32 v225, 4, v254
    v_and_b32 v225, 16, v225
    v_lshl_add_u32 v224, v224, 1, v225
    s_nop 2
    v_add_f32_dpp v8, v8, v8 row_ror:8 row_mask:0xf bank_mask:0xf
    v_add_f32_dpp v9, v9, v9 row_ror:8 row_mask:0xf bank_mask:0xf
    v_add_f32_dpp v10, v10, v10 row_ror:8 row_mask:0xf bank_mask:0xf
    v_add_f32_dpp v11, v11, v11 row_ror:8 row_mask:0xf bank_mask:0xf
    s_mov_b64 exec, 0x00ff00ff
    buffer_store_dwordx4 v[8:11], v224, s[4:7], s55 offen sc0 sc1
    s_mov_b64 exec, -1
jw_76:
    s_setprio 1
    s_barrier
    s_cmp_lg_u32 s42, 2
    s_cbranch_scc1 wf_77
    s_and_b32 s55, s51, 14
    s_lshl_b32 s55, s55, 1
    s_add_u32 s55, s55, s0
    v_mov_b32 v252, 32
    v_mov_b32 v250, 0x01010101
    s_mov_b64 exec, 1
    s_cmp_eq_u32 s45, 0
    s_cbranch_scc1 st_79
    buffer_store_dword v250, v252, s[4:7], s55 offen sc0 sc1
    s_branch st_80
st_79:
    buffer_store_dword v250, v252, s[4:7], s55 offen
st_80:
    s_mov_b64 exec, -1
    s_branch wf_78
wf_77:
    s_lshl_b32 s55, s51, 2
    s_add_u32 s55, s55, s54
    v_mov_b32 v252, 2048
    v_mov_b32 v250, 0x01010101
    s_mov_b64 exec, 1
    buffer_store_dword v250, v252, s[4:7], s55 offen sc0 sc1
    s_mov_b64 exec, -1
wf_78:
    s_waitcnt vmcnt(16)
    s_barrier
    s_waitcnt vmcnt(8) lgkmcnt(0)
    s_barrier
    s_mul_i32 s59, s94, 229376
    s_add_u32 m0, s67, 16384
    s_add_u32 s59, s59, s62
    buffer_load_dwordx4 v210, s[16:19], s59 offen lds
    buffer_load_dwordx4 v211, s[16:19], s59 offen offset:1024 lds
    s_add_u32 s94, s94, 3
    s_and_b32 s94, s94, 31
    buffer_load_dwordx4 v212, s[16:19], s59 offen offset:2048 lds
    buffer_load_dwordx4 v213, s[16:19], s59 offen offset:3072 lds
    s_add_u32 m0, s67, 20480
    s_add_u32 s60, s59, 114688
    buffer_load_dwordx4 v210, s[16:19], s60 offen lds
    buffer_load_dwordx4 v211, s[16:19], s60 offen offset:1024 lds
    buffer_load_dwordx4 v212, s[16:19], s60 offen offset:2048 lds
    buffer_load_dwordx4 v213, s[16:19], s60 offen offset:3072 lds
    s_waitcnt vmcnt(8) lgkmcnt(0)
    s_barrier
    s_mul_i32 s59, s94, 229376
    s_add_u32 m0, s67, 32768
    s_add_u32 s59, s59, s62
    buffer_load_dwordx4 v210, s[16:19], s59 offen lds
    buffer_load_dwordx4 v211, s[16:19], s59 offen offset:1024 lds
    s_add_u32 s94, s94, 1
    s_and_b32 s94, s94, 31
    buffer_load_dwordx4 v212, s[16:19], s59 offen offset:2048 lds
    buffer_load_dwordx4 v213, s[16:19], s59 offen offset:3072 lds
    s_add_u32 m0, s67, 36864
    s_add_u32 s60, s59, 114688
    buffer_load_dwordx4 v210, s[16:19], s60 offen lds
    buffer_load_dwordx4 v211, s[16:19], s60 offen offset:1024 lds
    buffer_load_dwordx4 v212, s[16:19], s60 offen offset:2048 lds
    buffer_load_dwordx4 v213, s[16:19], s60 offen offset:3072 lds
    s_waitcnt vmcnt(8) lgkmcnt(0)
    s_barrier
    s_mul_i32 s59, s94, 229376
    s_add_u32 m0, s67, 49152
    s_add_u32 s59, s59, s62
    buffer_load_dwordx4 v210, s[16:19], s59 offen lds
    buffer_load_dwordx4 v211, s[16:19], s59 offen offset:1024 lds
    s_add_u32 s94, s94, 3
    s_and_b32 s94, s94, 31
    buffer_load_dwordx4 v212, s[16:19], s59 offen offset:2048 lds
    buffer_load_dwordx4 v213, s[16:19], s59 offen offset:3072 lds
    s_add_u32 m0, s67, 53248
    s_add_u32 s60, s59, 114688
    buffer_load_dwordx4 v210, s[16:19], s60 offen lds
    buffer_load_dwordx4 v211, s[16:19], s60 offen offset:1024 lds
    buffer_load_dwordx4 v212, s[16:19], s60 offen offset:2048 lds
    buffer_load_dwordx4 v213, s[16:19], s60 offen offset:3072 lds
    s_mul_i32 s59, s94, 229376
    s_add_u32 m0, s67, 65536
    s_add_u32 s59, s59, s62
    buffer_load_dwordx4 v210, s[16:19], s59 offen lds
    buffer_load_dwordx4 v211, s[16:19], s59 offen offset:1024 lds
    s_add_u32 s94, s94, 1
    s_and_b32 s94, s94, 31
    buffer_load_dwordx4 v212, s[16:19], s59 offen offset:2048 lds
    buffer_load_dwordx4 v213, s[16:19], s59 offen offset:3072 lds
    s_waitcnt vmcnt(12) lgkmcnt(0)
    s_barrier
    s_add_u32 m0, s67, 69632
    s_add_u32 s60, s59, 114688
    buffer_load_dwordx4 v210, s[16:19], s60 offen lds
    buffer_load_dwordx4 v211, s[16:19], s60 offen offset:1024 lds
    buffer_load_dwordx4 v212, s[16:19], s60 offen offset:2048 lds
    buffer_load_dwordx4 v213, s[16:19], s60 offen offset:3072 lds
    s_mul_i32 s59, s94, 229376
    s_add_u32 m0, s67, 81920
    s_add_u32 s59, s59, s62
    buffer_load_dwordx4 v210, s[16:19], s59 offen lds
    buffer_load_dwordx4 v211, s[16:19], s59 offen offset:1024 lds
    s_add_u32 s94, s94, 3
    s_and_b32 s94, s94, 31
    buffer_load_dwordx4 v212, s[16:19], s59 offen offset:2048 lds
    buffer_load_dwordx4 v213, s[16:19], s59 offen offset:3072 lds
    s_waitcnt vmcnt(12) lgkmcnt(0)
    s_barrier
    s_add_u32 m0, s67, 86016
    s_add_u32 s60, s59, 114688
    buffer_load_dwordx4 v210, s[16:19], s60 offen lds
    buffer_load_dwordx4 v211, s[16:19], s60 offen offset:1024 lds
    buffer_load_dwordx4 v212, s[16:19], s60 offen offset:2048 lds
    buffer_load_dwordx4 v213, s[16:19], s60 offen offset:3072 lds
    s_mul_i32 s59, s94, 229376
    s_add_u32 m0, s67, 0
    s_add_u32 s59, s59, s62
    buffer_load_dwordx4 v210, s[16:19], s59 offen lds
    buffer_load_dwordx4 v211, s[16:19], s59 offen offset:1024 lds
    s_add_u32 s94, s94, 1
    s_and_b32 s94, s94, 31
    buffer_load_dwordx4 v212, s[16:19], s59 offen offset:2048 lds
    buffer_load_dwordx4 v213, s[16:19], s59 offen offset:3072 lds
    s_waitcnt vmcnt(12) lgkmcnt(0)
    s_barrier
    s_cmp_lg_u32 s46, 0
    s_cbranch_scc1 cf_81
    s_cmp_lg_u32 s42, 2
    s_cbranch_scc1 cf_81
    v_mov_b32 v252, 0
    v_mov_b32 v250, 1
    s_lshl_b32 s55, s2, 2
    s_add_u32 s55, s55, 71566336
    s_mov_b64 exec, 1
    buffer_store_dword v250, v252, s[4:7], s55 offen sc0 sc1
    s_mov_b64 exec, -1
cf_81:
    s_add_u32 m0, s67, 4096
    s_add_u32 s60, s59, 114688
    buffer_load_dwordx4 v210, s[16:19], s60 offen lds
    buffer_load_dwordx4 v211, s[16:19], s60 offen offset:1024 lds
    buffer_load_dwordx4 v212, s[16:19], s60 offen offset:2048 lds
    buffer_load_dwordx4 v213, s[16:19], s60 offen offset:3072 lds
    s_mul_i32 s59, s94, 229376
    s_add_u32 m0, s67, 16384
    s_add_u32 s59, s59, s62
    buffer_load_dwordx4 v210, s[16:19], s59 offen lds
    buffer_load_dwordx4 v211, s[16:19], s59 offen offset:1024 lds
    s_add_u32 s94, s94, 3
    s_and_b32 s94, s94, 31
    buffer_load_dwordx4 v212, s[16:19], s59 offen offset:2048 lds
    buffer_load_dwordx4 v213, s[16:19], s59 offen offset:3072 lds
    s_add_u32 m0, s67, 20480
    s_add_u32 s60, s59, 114688
    buffer_load_dwordx4 v210, s[16:19], s60 offen lds
    buffer_load_dwordx4 v211, s[16:19], s60 offen offset:1024 lds
    buffer_load_dwordx4 v212, s[16:19], s60 offen offset:2048 lds
    buffer_load_dwordx4 v213, s[16:19], s60 offen offset:3072 lds
    s_waitcnt vmcnt(16) lgkmcnt(0)
    s_barrier
    s_lshl_b32 s55, s46, 4
    s_lshr_b32 s56, s40, 1
    s_add_u32 s55, s55, s56
    s_cmp_lg_u32 s55, 0
    s_cbranch_scc1 w2_82
    v_lshlrev_b32 v224, 3, v254
    s_lshl_b32 s55, s2, 1
    s_add_u32 s55, s55, s43
    s_lshl_b32 s55, s55, 14
    buffer_load_dword v251, v224, s[20:23], s55 offen
    s_add_u32 s55, s55, 8192
    buffer_load_dword v251, v224, s[20:23], s55 offen
w2_82:
    s_mul_i32 s59, s94, 229376
    s_add_u32 m0, s67, 32768
    s_add_u32 s59, s59, s62
    buffer_load_dwordx4 v210, s[16:19], s59 offen lds
    buffer_load_dwordx4 v211, s[16:19], s59 offen offset:1024 lds
    s_add_u32 s94, s94, 1
    s_and_b32 s94, s94, 31
    buffer_load_dwordx4 v212, s[16:19], s59 offen offset:2048 lds
    buffer_load_dwordx4 v213, s[16:19], s59 offen offset:3072 lds
    s_add_u32 m0, s67, 36864
    s_add_u32 s60, s59, 114688
    buffer_load_dwordx4 v210, s[16:19], s60 offen lds
    buffer_load_dwordx4 v211, s[16:19], s60 offen offset:1024 lds
    buffer_load_dwordx4 v212, s[16:19], s60 offen offset:2048 lds
    buffer_load_dwordx4 v213, s[16:19], s60 offen offset:3072 lds
    s_waitcnt vmcnt(16) lgkmcnt(0)
    s_barrier
    s_mul_i32 s59, s94, 229376
    s_add_u32 m0, s67, 49152
    s_add_u32 s59, s59, s62
    buffer_load_dwordx4 v210, s[16:19], s59 offen lds
    buffer_load_dwordx4 v211, s[16:19], s59 offen offset:1024 lds
    s_add_u32 s94, s94, 3
    s_and_b32 s94, s94, 31
    buffer_load_dwordx4 v212, s[16:19], s59 offen offset:2048 lds
    buffer_load_dwordx4 v213, s[16:19], s59 offen offset:3072 lds
    s_add_u32 m0, s67, 53248
    s_add_u32 s60, s59, 114688
    buffer_load_dwordx4 v210, s[16:19], s60 offen lds
    buffer_load_dwordx4 v211, s[16:19], s60 offen offset:1024 lds
    buffer_load_dwordx4 v212, s[16:19], s60 offen offset:2048 lds
    buffer_load_dwordx4 v213, s[16:19], s60 offen offset:3072 lds
    s_mul_i32 s59, s94, 229376
    s_add_u32 m0, s67, 65536
    s_add_u32 s59, s59, s62
    buffer_load_dwordx4 v210, s[16:19], s59 offen lds
    buffer_load_dwordx4 v211, s[16:19], s59 offen offset:1024 lds
    s_add_u32 s94, s94, 1
    s_and_b32 s94, s94, 31
    buffer_load_dwordx4 v212, s[16:19], s59 offen offset:2048 lds
    buffer_load_dwordx4 v213, s[16:19], s59 offen offset:3072 lds
    s_waitcnt vmcnt(20) lgkmcnt(0)
    s_barrier
    s_lshl_b32 s55, s46, 4
    s_lshr_b32 s56, s40, 1
    s_add_u32 s55, s55, s56
    s_cmp_lg_u32 s55, 1
    s_cbranch_scc1 w2_83
    v_lshlrev_b32 v224, 3, v254
    s_lshl_b32 s55, s2, 1
    s_add_u32 s55, s55, s43
    s_lshl_b32 s55, s55, 14
    buffer_load_dword v251, v224, s[20:23], s55 offen
    s_add_u32 s55, s55, 8192
    buffer_load_dword v251, v224, s[20:23], s55 offen
w2_83:
    s_add_u32 m0, s67, 69632
    s_add_u32 s60, s59, 114688
    buffer_load_dwordx4 v210, s[16:19], s60 offen lds
    buffer_load_dwordx4 v211, s[16:19], s60 offen offset:1024 lds
    buffer_load_dwordx4 v212, s[16:19], s60 offen offset:2048 lds
    buffer_load_dwordx4 v213, s[16:19], s60 offen offset:3072 lds
    s_mul_i32 s59, s94, 229376
    s_add_u32 m0, s67, 81920
    s_add_u32 s59, s59, s62
    buffer_load_dwordx4 v210, s[16:19], s59 offen lds
    buffer_load_dwordx4 v211, s[16:19], s59 offen offset:1024 lds
    s_add_u32 s94, s94, 3
    s_and_b32 s94, s94, 31
    buffer_load_dwordx4 v212, s[16:19], s59 offen offset:2048 lds
    buffer_load_dwordx4 v213, s[16:19], s59 offen offset:3072 lds
    s_waitcnt vmcnt(20) lgkmcnt(0)
    s_barrier
    s_add_u32 m0, s67, 86016
    s_add_u32 s60, s59, 114688
    buffer_load_dwordx4 v210, s[16:19], s60 offen lds
    buffer_load_dwordx4 v211, s[16:19], s60 offen offset:1024 lds
    buffer_load_dwordx4 v212, s[16:19], s60 offen offset:2048 lds
    buffer_load_dwordx4 v213, s[16:19], s60 offen offset:3072 lds
    s_mul_i32 s59, s94, 229376
    s_add_u32 m0, s67, 0
    s_add_u32 s59, s59, s62
    buffer_load_dwordx4 v210, s[16:19], s59 offen lds
    buffer_load_dwordx4 v211, s[16:19], s59 offen offset:1024 lds
    s_add_u32 s94, s94, 1
    s_and_b32 s94, s94, 31
    buffer_load_dwordx4 v212, s[16:19], s59 offen offset:2048 lds
    buffer_load_dwordx4 v213, s[16:19], s59 offen offset:3072 lds
    s_waitcnt vmcnt(20) lgkmcnt(0)
    s_barrier
    s_lshl_b32 s55, s46, 4
    s_lshr_b32 s56, s40, 1
    s_add_u32 s55, s55, s56
    s_cmp_lg_u32 s55, 2
    s_cbranch_scc1 w2_84
    v_lshlrev_b32 v224, 3, v254
    s_lshl_b32 s55, s2, 1
    s_add_u32 s55, s55, s43
    s_lshl_b32 s55, s55, 14
    buffer_load_dword v251, v224, s[20:23], s55 offen
    s_add_u32 s55, s55, 8192
    buffer_load_dword v251, v224, s[20:23], s55 offen
w2_84:
    s_add_u32 m0, s67, 4096
    s_add_u32 s60, s59, 114688
    buffer_load_dwordx4 v210, s[16:19], s60 offen lds
    buffer_load_dwordx4 v211, s[16:19], s60 offen offset:1024 lds
    buffer_load_dwordx4 v212, s[16:19], s60 offen offset:2048 lds
    buffer_load_dwordx4 v213, s[16:19], s60 offen offset:3072 lds
    s_mul_i32 s59, s94, 229376
    s_add_u32 m0, s67, 16384
    s_add_u32 s59, s59, s62
    buffer_load_dwordx4 v210, s[16:19], s59 offen lds
    buffer_load_dwordx4 v211, s[16:19], s59 offen offset:1024 lds
    s_add_u32 s94, s94, 5
    s_and_b32 s94, s94, 31
    buffer_load_dwordx4 v212, s[16:19], s59 offen offset:2048 lds
    buffer_load_dwordx4 v213, s[16:19], s59 offen offset:3072 lds
    s_waitcnt vmcnt(20) lgkmcnt(0)
    s_barrier
    s_add_u32 m0, s67, 20480
    s_add_u32 s60, s59, 114688
    buffer_load_dwordx4 v210, s[16:19], s60 offen lds
    buffer_load_dwordx4 v211, s[16:19], s60 offen offset:1024 lds
    buffer_load_dwordx4 v212, s[16:19], s60 offen offset:2048 lds
    buffer_load_dwordx4 v213, s[16:19], s60 offen offset:3072 lds
    s_mul_i32 s59, s94, 229376
    s_add_u32 m0, s67, 32768
    s_add_u32 s59, s59, s62
    buffer_load_dwordx4 v210, s[16:19], s59 offen lds
    buffer_load_dwordx4 v211, s[16:19], s59 offen offset:1024 lds
    s_add_u32 s94, s94, 1
    s_and_b32 s94, s94, 31
    buffer_load_dwordx4 v212, s[16:19], s59 offen offset:2048 lds
    buffer_load_dwordx4 v213, s[16:19], s59 offen offset:3072 lds
    s_waitcnt vmcnt(20) lgkmcnt(0)
    s_barrier
    s_lshl_b32 s55, s46, 4
    s_lshr_b32 s56, s40, 1
    s_add_u32 s55, s55, s56
    s_cmp_lg_u32 s55, 3
    s_cbranch_scc1 w2_85
    v_lshlrev_b32 v224, 3, v254
    s_lshl_b32 s55, s2, 1
    s_add_u32 s55, s55, s43
    s_lshl_b32 s55, s55, 14
    buffer_load_dword v251, v224, s[20:23], s55 offen
    s_add_u32 s55, s55, 8192
    buffer_load_dword v251, v224, s[20:23], s55 offen
w2_85:
    s_add_u32 m0, s67, 36864
    s_add_u32 s60, s59, 114688
    buffer_load_dwordx4 v210, s[16:19], s60 offen lds
    buffer_load_dwordx4 v211, s[16:19], s60 offen offset:1024 lds
    buffer_load_dwordx4 v212, s[16:19], s60 offen offset:2048 lds
    buffer_load_dwordx4 v213, s[16:19], s60 offen offset:3072 lds
    s_mul_i32 s59, s94, 229376
    s_add_u32 m0, s67, 49152
    s_add_u32 s59, s59, s62
    buffer_load_dwordx4 v210, s[16:19], s59 offen lds
    buffer_load_dwordx4 v211, s[16:19], s59 offen offset:1024 lds
    s_add_u32 s94, s94, 3
    s_and_b32 s94, s94, 31
    buffer_load_dwordx4 v212, s[16:19], s59 offen offset:2048 lds
    buffer_load_dwordx4 v213, s[16:19], s59 offen offset:3072 lds
    s_waitcnt vmcnt(20) lgkmcnt(0)
    s_barrier
    s_add_u32 m0, s67, 53248
    s_add_u32 s60, s59, 114688
    buffer_load_dwordx4 v210, s[16:19], s60 offen lds
    buffer_load_dwordx4 v211, s[16:19], s60 offen offset:1024 lds
    buffer_load_dwordx4 v212, s[16:19], s60 offen offset:2048 lds
    buffer_load_dwordx4 v213, s[16:19], s60 offen offset:3072 lds
    s_mul_i32 s59, s94, 229376
    s_add_u32 m0, s67, 65536
    s_add_u32 s59, s59, s62
    buffer_load_dwordx4 v210, s[16:19], s59 offen lds
    buffer_load_dwordx4 v211, s[16:19], s59 offen offset:1024 lds
    s_add_u32 s94, s94, 1
    s_and_b32 s94, s94, 31
    buffer_load_dwordx4 v212, s[16:19], s59 offen offset:2048 lds
    buffer_load_dwordx4 v213, s[16:19], s59 offen offset:3072 lds
    s_waitcnt vmcnt(20) lgkmcnt(0)
    s_barrier
    s_lshl_b32 s55, s46, 4
    s_lshr_b32 s56, s40, 1
    s_add_u32 s55, s55, s56
    s_cmp_lg_u32 s55, 4
    s_cbranch_scc1 w2_86
    v_lshlrev_b32 v224, 3, v254
    s_lshl_b32 s55, s2, 1
    s_add_u32 s55, s55, s43
    s_lshl_b32 s55, s55, 14
    buffer_load_dword v251, v224, s[20:23], s55 offen
    s_add_u32 s55, s55, 8192
    buffer_load_dword v251, v224, s[20:23], s55 offen
w2_86:
    s_add_u32 m0, s67, 69632
    s_add_u32 s60, s59, 114688
    buffer_load_dwordx4 v210, s[16:19], s60 offen lds
    buffer_load_dwordx4 v211, s[16:19], s60 offen offset:1024 lds
    buffer_load_dwordx4 v212, s[16:19], s60 offen offset:2048 lds
    buffer_load_dwordx4 v213, s[16:19], s60 offen offset:3072 lds
    s_mul_i32 s59, s94, 229376
    s_add_u32 m0, s67, 81920
    s_add_u32 s59, s59, s62
    buffer_load_dwordx4 v210, s[16:19], s59 offen lds
    buffer_load_dwordx4 v211, s[16:19], s59 offen offset:1024 lds
    s_add_u32 s94, s94, 3
    s_and_b32 s94, s94, 31
    buffer_load_dwordx4 v212, s[16:19], s59 offen offset:2048 lds
    buffer_load_dwordx4 v213, s[16:19], s59 offen offset:3072 lds
    s_add_u32 m0, s67, 86016
    s_add_u32 s60, s59, 114688
    buffer_load_dwordx4 v210, s[16:19], s60 offen lds
    buffer_load_dwordx4 v211, s[16:19], s60 offen offset:1024 lds
    buffer_load_dwordx4 v212, s[16:19], s60 offen offset:2048 lds
    buffer_load_dwordx4 v213, s[16:19], s60 offen offset:3072 lds
    s_waitcnt vmcnt(24) lgkmcnt(0)
    s_barrier
    s_mul_i32 s59, s94, 229376
    s_add_u32 m0, s67, 0
    s_add_u32 s59, s59, s62
    buffer_load_dwordx4 v210, s[16:19], s59 offen lds
    buffer_load_dwordx4 v211, s[16:19], s59 offen offset:1024 lds
    s_add_u32 s94, s94, 1
    s_and_b32 s94, s94, 31
    buffer_load_dwordx4 v212, s[16:19], s59 offen offset:2048 lds
    buffer_load_dwordx4 v213, s[16:19], s59 offen offset:3072 lds
    s_add_u32 m0, s67, 4096
    s_add_u32 s60, s59, 114688
    buffer_load_dwordx4 v210, s[16:19], s60 offen lds
    buffer_load_dwordx4 v211, s[16:19], s60 offen offset:1024 lds
    buffer_load_dwordx4 v212, s[16:19], s60 offen offset:2048 lds
    buffer_load_dwordx4 v213, s[16:19], s60 offen offset:3072 lds
    s_waitcnt vmcnt(24) lgkmcnt(0)
    s_barrier
    s_lshl_b32 s55, s46, 4
    s_lshr_b32 s56, s40, 1
    s_add_u32 s55, s55, s56
    s_cmp_lg_u32 s55, 5
    s_cbranch_scc1 w2_87
    v_lshlrev_b32 v224, 3, v254
    s_lshl_b32 s55, s2, 1
    s_add_u32 s55, s55, s43
    s_lshl_b32 s55, s55, 14
    buffer_load_dword v251, v224, s[20:23], s55 offen
    s_add_u32 s55, s55, 8192
    buffer_load_dword v251, v224, s[20:23], s55 offen
w2_87:
    s_mul_i32 s59, s94, 229376
    s_add_u32 m0, s67, 16384
    s_add_u32 s59, s59, s62
    buffer_load_dwordx4 v210, s[16:19], s59 offen lds
    buffer_load_dwordx4 v211, s[16:19], s59 offen offset:1024 lds
    s_add_u32 s94, s94, 3
    s_and_b32 s94, s94, 31
    buffer_load_dwordx4 v212, s[16:19], s59 offen offset:2048 lds
    buffer_load_dwordx4 v213, s[16:19], s59 offen offset:3072 lds
    s_add_u32 m0, s67, 20480
    s_add_u32 s60, s59, 114688
    buffer_load_dwordx4 v210, s[16:19], s60 offen lds
    buffer_load_dwordx4 v211, s[16:19], s60 offen offset:1024 lds
    buffer_load_dwordx4 v212, s[16:19], s60 offen offset:2048 lds
    buffer_load_dwordx4 v213, s[16:19], s60 offen offset:3072 lds
    s_mul_i32 s59, s94, 229376
    s_add_u32 m0, s67, 32768
    s_add_u32 s59, s59, s62
    buffer_load_dwordx4 v210, s[16:19], s59 offen lds
    buffer_load_dwordx4 v211, s[16:19], s59 offen offset:1024 lds
    s_add_u32 s94, s94, 1
    s_and_b32 s94, s94, 31
    buffer_load_dwordx4 v212, s[16:19], s59 offen offset:2048 lds
    buffer_load_dwordx4 v213, s[16:19], s59 offen offset:3072 lds
    s_waitcnt vmcnt(28) lgkmcnt(0)
    s_barrier
    s_add_u32 m0, s67, 36864
    s_add_u32 s60, s59, 114688
    buffer_load_dwordx4 v210, s[16:19], s60 offen lds
    buffer_load_dwordx4 v211, s[16:19], s60 offen offset:1024 lds
    buffer_load_dwordx4 v212, s[16:19], s60 offen offset:2048 lds
    buffer_load_dwordx4 v213, s[16:19], s60 offen offset:3072 lds
    s_mul_i32 s59, s94, 229376
    s_add_u32 m0, s67, 49152
    s_add_u32 s59, s59, s62
    buffer_load_dwordx4 v210, s[16:19], s59 offen lds
    buffer_load_dwordx4 v211, s[16:19], s59 offen offset:1024 lds
    s_add_u32 s94, s94, 3
    s_and_b32 s94, s94, 31
    buffer_load_dwordx4 v212, s[16:19], s59 offen offset:2048 lds
    buffer_load_dwordx4 v213, s[16:19], s59 offen offset:3072 lds
    s_waitcnt vmcnt(28) lgkmcnt(0)
    s_barrier
    s_lshl_b32 s55, s46, 4
    s_lshr_b32 s56, s40, 1
    s_add_u32 s55, s55, s56
    s_cmp_lg_u32 s55, 6
    s_cbranch_scc1 w2_88
    v_lshlrev_b32 v224, 3, v254
    s_lshl_b32 s55, s2, 1
    s_add_u32 s55, s55, s43
    s_lshl_b32 s55, s55, 14
    buffer_load_dword v251, v224, s[20:23], s55 offen
    s_add_u32 s55, s55, 8192
    buffer_load_dword v251, v224, s[20:23], s55 offen
w2_88:
    s_add_u32 m0, s67, 53248
    s_add_u32 s60, s59, 114688
    buffer_load_dwordx4 v210, s[16:19], s60 offen lds
    buffer_load_dwordx4 v211, s[16:19], s60 offen offset:1024 lds
    buffer_load_dwordx4 v212, s[16:19], s60 offen offset:2048 lds
    buffer_load_dwordx4 v213, s[16:19], s60 offen offset:3072 lds
    s_mul_i32 s59, s94, 229376
    s_add_u32 m0, s67, 65536
    s_add_u32 s59, s59, s62
    buffer_load_dwordx4 v210, s[16:19], s59 offen lds
    buffer_load_dwordx4 v211, s[16:19], s59 offen offset:1024 lds
    s_add_u32 s94, s94, 1
    s_and_b32 s94, s94, 31
    buffer_load_dwordx4 v212, s[16:19], s59 offen offset:2048 lds
    buffer_load_dwordx4 v213, s[16:19], s59 offen offset:3072 lds
    s_add_u32 m0, s67, 69632
    s_add_u32 s60, s59, 114688
    buffer_load_dwordx4 v210, s[16:19], s60 offen lds
    buffer_load_dwordx4 v211, s[16:19], s60 offen offset:1024 lds
    buffer_load_dwordx4 v212, s[16:19], s60 offen offset:2048 lds
    buffer_load_dwordx4 v213, s[16:19], s60 offen offset:3072 lds
    s_waitcnt vmcnt(32) lgkmcnt(0)
    s_barrier
    s_mul_i32 s59, s94, 229376
    s_add_u32 m0, s67, 81920
    s_add_u32 s59, s59, s62
    buffer_load_dwordx4 v210, s[16:19], s59 offen lds
    buffer_load_dwordx4 v211, s[16:19], s59 offen offset:1024 lds
    s_add_u32 s94, s94, 3
    s_and_b32 s94, s94, 31
    buffer_load_dwordx4 v212, s[16:19], s59 offen offset:2048 lds
    buffer_load_dwordx4 v213, s[16:19], s59 offen offset:3072 lds
    s_add_u32 m0, s67, 86016
    s_add_u32 s60, s59, 114688
    buffer_load_dwordx4 v210, s[16:19], s60 offen lds
    buffer_load_dwordx4 v211, s[16:19], s60 offen offset:1024 lds
    buffer_load_dwordx4 v212, s[16:19], s60 offen offset:2048 lds
    buffer_load_dwordx4 v213, s[16:19], s60 offen offset:3072 lds
    s_waitcnt vmcnt(32) lgkmcnt(0)
    s_barrier
    s_lshl_b32 s55, s46, 4
    s_lshr_b32 s56, s40, 1
    s_add_u32 s55, s55, s56
    s_cmp_lg_u32 s55, 7
    s_cbranch_scc1 w2_89
    v_lshlrev_b32 v224, 3, v254
    s_lshl_b32 s55, s2, 1
    s_add_u32 s55, s55, s43
    s_lshl_b32 s55, s55, 14
    buffer_load_dword v251, v224, s[20:23], s55 offen
    s_add_u32 s55, s55, 8192
    buffer_load_dword v251, v224, s[20:23], s55 offen
w2_89:
    s_mul_i32 s59, s94, 229376
    s_add_u32 m0, s67, 0
    s_add_u32 s59, s59, s62
    buffer_load_dwordx4 v210, s[16:19], s59 offen lds
    buffer_load_dwordx4 v211, s[16:19], s59 offen offset:1024 lds
    s_add_u32 s94, s94, 1
    s_and_b32 s94, s94, 31
    buffer_load_dwordx4 v212, s[16:19], s59 offen offset:2048 lds
    buffer_load_dwordx4 v213, s[16:19], s59 offen offset:3072 lds
    s_add_u32 m0, s67, 4096
    s_add_u32 s60, s59, 114688
    buffer_load_dwordx4 v210, s[16:19], s60 offen lds
    buffer_load_dwordx4 v211, s[16:19], s60 offen offset:1024 lds
    buffer_load_dwordx4 v212, s[16:19], s60 offen offset:2048 lds
    buffer_load_dwordx4 v213, s[16:19], s60 offen offset:3072 lds
    s_waitcnt vmcnt(32) lgkmcnt(0)
    s_barrier
    s_mul_i32 s59, s94, 229376
    s_add_u32 m0, s67, 16384
    s_add_u32 s59, s59, s62
    buffer_load_dwordx4 v210, s[16:19], s59 offen lds
    buffer_load_dwordx4 v211, s[16:19], s59 offen offset:1024 lds
    s_add_u32 s94, s94, 3
    s_and_b32 s94, s94, 31
    buffer_load_dwordx4 v212, s[16:19], s59 offen offset:2048 lds
    buffer_load_dwordx4 v213, s[16:19], s59 offen offset:3072 lds
    s_add_u32 m0, s67, 20480
    s_add_u32 s60, s59, 114688
    buffer_load_dwordx4 v210, s[16:19], s60 offen lds
    buffer_load_dwordx4 v211, s[16:19], s60 offen offset:1024 lds
    buffer_load_dwordx4 v212, s[16:19], s60 offen offset:2048 lds
    buffer_load_dwordx4 v213, s[16:19], s60 offen offset:3072 lds
    s_waitcnt vmcnt(32) lgkmcnt(0)
    s_barrier
    s_mul_i32 s59, s94, 229376
    s_add_u32 m0, s67, 32768
    s_add_u32 s59, s59, s62
    buffer_load_dwordx4 v210, s[16:19], s59 offen lds
    s_lshl_b32 s55, s43, 9
    s_add_u32 s55, s55, 153600
    v_and_b32 v224, 0xf0, v254
    v_lshrrev_b32 v224, 1, v224
    v_add_u32 v224, s55, v224
    ds_read_b64 v[96:97], v224 offset:0
    buffer_load_dwordx4 v211, s[16:19], s59 offen offset:1024 lds
    s_add_u32 s94, s94, 1
    s_and_b32 s94, s94, 31
    ds_read_b64 v[98:99], v224 offset:128
    ds_read_b64 v[100:101], v224 offset:256
    buffer_load_dwordx4 v212, s[16:19], s59 offen offset:2048 lds
    ds_read_b64 v[102:103], v224 offset:384
    s_waitcnt lgkmcnt(0)
    buffer_load_dwordx4 v213, s[16:19], s59 offen offset:3072 lds
    v_sub_f32 v196, 0, v96
    v_mul_f32 v184, 0xbfb8aa3b, v97
    v_mul_f32 v188, v97, v97
    s_add_u32 m0, s67, 36864
    s_add_u32 s60, s59, 114688
    buffer_load_dwordx4 v210, s[16:19], s60 offen lds
    v_sub_f32 v197, 0, v98
    v_mul_f32 v185, 0xbfb8aa3b, v99
    buffer_load_dwordx4 v211, s[16:19], s60 offen offset:1024 lds
    v_mul_f32 v189, v99, v99
    v_sub_f32 v198, 0, v100
    buffer_load_dwordx4 v212, s[16:19], s60 offen offset:2048 lds
    v_mul_f32 v186, 0xbfb8aa3b, v101
    v_mul_f32 v190, v101, v101
    buffer_load_dwordx4 v213, s[16:19], s60 offen offset:3072 lds
    v_sub_f32 v199, 0, v102
    v_mul_f32 v187, 0xbfb8aa3b, v103
    v_mul_f32 v191, v103, v103
    s_waitcnt vmcnt(32) lgkmcnt(0)
    s_barrier
    s_mul_i32 s59, s94, 229376
    s_add_u32 m0, s67, 49152
    s_add_u32 s59, s59, s62
    buffer_load_dwordx4 v210, s[16:19], s59 offen lds
    v_rcp_f32 v188, v188
    v_rcp_f32 v189, v189
    buffer_load_dwordx4 v211, s[16:19], s59 offen offset:1024 lds
    s_add_u32 s94, s94, 3
    s_and_b32 s94, s94, 31
    v_rcp_f32 v190, v190
    v_rcp_f32 v191, v191
    buffer_load_dwordx4 v212, s[16:19], s59 offen offset:2048 lds
    s_nop 0
    v_lshrrev_b32 v224, 8, v254
    v_lshlrev_b32 v224, 4, v224
    buffer_load_dwordx4 v213, s[16:19], s59 offen offset:3072 lds
    v_add_u32 v224, 156544, v224
    s_lshl_b32 s55, s44, 8
    v_add_u32 v225, s55, v224
    s_add_u32 m0, s67, 53248
    s_add_u32 s60, s59, 114688
    buffer_load_dwordx4 v210, s[16:19], s60 offen lds
    s_lshl_b32 s55, s44, 6
    v_add_u32 v224, s55, v224
    ds_read_b128 v[96:99], v225 offset:0
    buffer_load_dwordx4 v211, s[16:19], s60 offen offset:1024 lds
    ds_read_b128 v[100:103], v225 offset:64
    ds_read_b128 v[104:107], v224 offset:128
    ds_read_b128 v[108:111], v225 offset:512
    buffer_load_dwordx4 v212, s[16:19], s60 offen offset:2048 lds
    ds_read_b128 v[112:115], v225 offset:576
    ds_read_b128 v[116:119], v224 offset:640
    buffer_load_dwordx4 v213, s[16:19], s60 offen offset:3072 lds
    s_waitcnt lgkmcnt(0)
    v_mul_f32 v0, v196, v96
    v_mul_f32 v1, v196, v97
    s_waitcnt vmcnt(32) lgkmcnt(0)
    s_barrier
    s_mul_i32 s59, s94, 229376
    s_add_u32 m0, s67, 65536
    s_add_u32 s59, s59, s62
    buffer_load_dwordx4 v210, s[16:19], s59 offen lds
    v_mul_f32 v2, v196, v98
    v_mul_f32 v3, v196, v99
    buffer_load_dwordx4 v211, s[16:19], s59 offen offset:1024 lds
    s_add_u32 s94, s94, 1
    s_and_b32 s94, s94, 31
    v_mul_f32 v4, v197, v96
    v_mul_f32 v5, v197, v97
    v_mul_f32 v6, v197, v98
    buffer_load_dwordx4 v212, s[16:19], s59 offen offset:2048 lds
    v_mul_f32 v7, v197, v99
    v_mul_f32 v8, v198, v96
    buffer_load_dwordx4 v213, s[16:19], s59 offen offset:3072 lds
    v_mul_f32 v9, v198, v97
    v_mul_f32 v10, v198, v98
    v_mul_f32 v11, v198, v99
    s_add_u32 m0, s67, 69632
    s_add_u32 s60, s59, 114688
    buffer_load_dwordx4 v210, s[16:19], s60 offen lds
    v_mul_f32 v12, v199, v96
    v_mul_f32 v13, v199, v97
    buffer_load_dwordx4 v211, s[16:19], s60 offen offset:1024 lds
    v_mul_f32 v14, v199, v98
    v_mul_f32 v15, v199, v99
    v_mul_f32 v16, v196, v100
    buffer_load_dwordx4 v212, s[16:19], s60 offen offset:2048 lds
    v_mul_f32 v17, v196, v101
    v_mul_f32 v18, v196, v102
    buffer_load_dwordx4 v213, s[16:19], s60 offen offset:3072 lds
    v_mul_f32 v19, v196, v103
    v_mul_f32 v20, v197, v100
    v_mul_f32 v21, v197, v101
    s_waitcnt vmcnt(32) lgkmcnt(0)
    s_barrier
    s_mul_i32 s59, s94, 229376
    s_add_u32 m0, s67, 81920
    s_add_u32 s59, s59, s62
    buffer_load_dwordx4 v210, s[16:19], s59 offen lds
    v_mul_f32 v22, v197, v102
    v_mul_f32 v23, v197, v103
    buffer_load_dwordx4 v211, s[16:19], s59 offen offset:1024 lds
    s_add_u32 s94, s94, 3
    s_and_b32 s94, s94, 31
    v_mul_f32 v24, v198, v100
    v_mul_f32 v25, v198, v101
    v_mul_f32 v26, v198, v102
    buffer_load_dwordx4 v212, s[16:19], s59 offen offset:2048 lds
    v_mul_f32 v27, v198, v103
    v_mul_f32 v28, v199, v100
    buffer_load_dwordx4 v213, s[16:19], s59 offen offset:3072 lds
    v_mul_f32 v29, v199, v101
    v_mul_f32 v30, v199, v102
    v_mul_f32 v31, v199, v103
    s_add_u32 m0, s67, 86016
    s_add_u32 s60, s59, 114688
    buffer_load_dwordx4 v210, s[16:19], s60 offen lds
    v_mul_f32 v32, v196, v104
    v_mul_f32 v33, v196, v105
    buffer_load_dwordx4 v211, s[16:19], s60 offen offset:1024 lds
    v_mul_f32 v34, v196, v106
    v_mul_f32 v35, v196, v107
    v_mul_f32 v36, v197, v104
    buffer_load_dwordx4 v212, s[16:19], s60 offen offset:2048 lds
    v_mul_f32 v37, v197, v105
    v_mul_f32 v38, v197, v106
    buffer_load_dwordx4 v213, s[16:19], s60 offen offset:3072 lds
    v_mul_f32 v39, v197, v107
    v_mul_f32 v40, v198, v104
    v_mul_f32 v41, v198, v105
    s_waitcnt vmcnt(32) lgkmcnt(0)
    s_barrier
    s_add_u32 m0, s61, 0
    s_add_u32 s59, s63, 0
    buffer_load_dwordx4 v214, s[16:19], s59 offen lds
    v_mul_f32 v42, v198, v106
    v_mul_f32 v43, v198, v107
    v_mul_f32 v44, v199, v104
    buffer_load_dwordx4 v215, s[16:19], s59 offen offset:1024 lds
    v_mul_f32 v45, v199, v105
    v_mul_f32 v46, v199, v106
    v_mul_f32 v47, v199, v107
    buffer_load_dwordx4 v216, s[16:19], s59 offen offset:2048 lds
    v_mul_f32 v48, v196, v108
    v_mul_f32 v49, v196, v109
    v_mul_f32 v50, v196, v110
    v_mul_f32 v51, v196, v111
    s_add_u32 m0, s61, 3072
    s_add_u32 s60, s63, 114688
    buffer_load_dwordx4 v214, s[16:19], s60 offen lds
    v_mul_f32 v52, v197, v108
    v_mul_f32 v53, v197, v109
    v_mul_f32 v54, v197, v110
    buffer_load_dwordx4 v215, s[16:19], s60 offen offset:1024 lds
    v_mul_f32 v55, v197, v111
    v_mul_f32 v56, v198, v108
    v_mul_f32 v57, v198, v109
    buffer_load_dwordx4 v216, s[16:19], s60 offen offset:2048 lds
    v_mul_f32 v58, v198, v110
    v_mul_f32 v59, v198, v111
    v_mul_f32 v60, v199, v108
    v_mul_f32 v61, v199, v109
    s_waitcnt vmcnt(30) lgkmcnt(0)
    s_barrier
    s_add_u32 m0, s61, 16384
    s_add_u32 s59, s63, 229376
    buffer_load_dwordx4 v214, s[16:19], s59 offen lds
    v_mul_f32 v62, v199, v110
    v_mul_f32 v63, v199, v111
    v_mul_f32 v64, v196, v112
    buffer_load_dwordx4 v215, s[16:19], s59 offen offset:1024 lds
    v_mul_f32 v65, v196, v113
    v_mul_f32 v66, v196, v114
    v_mul_f32 v67, v196, v115
    buffer_load_dwordx4 v216, s[16:19], s59 offen offset:2048 lds
    v_mul_f32 v68, v197, v112
    v_mul_f32 v69, v197, v113
    v_mul_f32 v70, v197, v114
    v_mul_f32 v71, v197, v115
    s_add_u32 m0, s61, 19456
    s_add_u32 s60, s63, 344064
    buffer_load_dwordx4 v214, s[16:19], s60 offen lds
    v_mul_f32 v72, v198, v112
    v_mul_f32 v73, v198, v113
    v_mul_f32 v74, v198, v114
    buffer_load_dwordx4 v215, s[16:19], s60 offen offset:1024 lds
    v_mul_f32 v75, v198, v115
    v_mul_f32 v76, v199, v112
    v_mul_f32 v77, v199, v113
    buffer_load_dwordx4 v216, s[16:19], s60 offen offset:2048 lds
    v_mul_f32 v78, v199, v114
    v_mul_f32 v79, v199, v115
    v_mul_f32 v80, v196, v116
    v_mul_f32 v81, v196, v117
    s_waitcnt vmcnt(28) lgkmcnt(0)
    s_barrier
    s_add_u32 m0, s61, 32768
    s_add_u32 s59, s63, 458752
    buffer_load_dwordx4 v214, s[16:19], s59 offen lds
    v_mul_f32 v82, v196, v118
    v_mul_f32 v83, v196, v119
    v_mul_f32 v84, v197, v116
    buffer_load_dwordx4 v215, s[16:19], s59 offen offset:1024 lds
    v_mul_f32 v85, v197, v117
    v_mul_f32 v86, v197, v118
    v_mul_f32 v87, v197, v119
    buffer_load_dwordx4 v216, s[16:19], s59 offen offset:2048 lds
    v_mul_f32 v88, v198, v116
    v_mul_f32 v89, v198, v117
    v_mul_f32 v90, v198, v118
    s_add_u32 m0, s61, 35840
    s_add_u32 s60, s63, 573440
    buffer_load_dwordx4 v214, s[16:19], s60 offen lds
    v_mul_f32 v91, v198, v119
    v_mul_f32 v92, v199, v116
    v_mul_f32 v93, v199, v117
    buffer_load_dwordx4 v215, s[16:19], s60 offen offset:1024 lds
    v_mul_f32 v94, v199, v118
    v_mul_f32 v95, v199, v119
    s_lshl_b32 s55, s43, 13
    s_add_u32 s55, s55, 98304
    v_add_u32 v176, s55, v254
    buffer_load_dwordx4 v216, s[16:19], s60 offen offset:2048 lds
    v_lshrrev_b32 v224, 6, v254
    v_mul_u32_u24 v224, 192, v224
    v_and_b32 v225, 0x30, v254
    v_lshrrev_b32 v225, 1, v225
    s_waitcnt vmcnt(26) lgkmcnt(0)
    s_barrier
    s_add_u32 m0, s61, 49152
    s_add_u32 s59, s63, 688128
    buffer_load_dwordx4 v214, s[16:19], s59 offen lds
    v_add_u32 v224, v224, v225
    v_lshrrev_b32 v225, 8, v254
    buffer_load_dwordx4 v215, s[16:19], s59 offen offset:1024 lds
    v_and_b32 v225, 1, v225
    s_lshl_b32 s55, s44, 2
    v_xor_b32 v226, s55, v225
    buffer_load_dwordx4 v216, s[16:19], s59 offen offset:2048 lds
    v_lshl_add_u32 v177, v226, 5, v224
    v_xor_b32 v226, 1, v226
    s_add_u32 m0, s61, 52224
    s_add_u32 s60, s63, 802816
    buffer_load_dwordx4 v214, s[16:19], s60 offen lds
    v_lshl_add_u32 v178, v226, 5, v224
    s_add_u32 s55, s44, 2
    v_xor_b32 v226, s55, v225
    buffer_load_dwordx4 v215, s[16:19], s60 offen offset:1024 lds
    v_lshl_add_u32 v179, v226, 5, v224
    v_add_u32 v180, 49152, v177
    buffer_load_dwordx4 v216, s[16:19], s60 offen offset:2048 lds
    v_add_u32 v181, 49152, v178
    v_add_u32 v182, 49152, v179
    s_waitcnt vmcnt(24) lgkmcnt(0)
    s_barrier
    s_add_u32 m0, s61, 65536
    s_add_u32 s59, s63, 917504
    buffer_load_dwordx4 v214, s[16:19], s59 offen lds
    buffer_load_dwordx4 v215, s[16:19], s59 offen offset:1024 lds
    buffer_load_dwordx4 v216, s[16:19], s59 offen offset:2048 lds
    s_add_u32 m0, s61, 68608
    s_add_u32 s60, s63, 1032192
    buffer_load_dwordx4 v214, s[16:19], s60 offen lds
    buffer_load_dwordx4 v215, s[16:19], s60 offen offset:1024 lds
    buffer_load_dwordx4 v216, s[16:19], s60 offen offset:2048 lds
    s_waitcnt vmcnt(24) lgkmcnt(0)
    s_barrier
    s_add_u32 m0, s61, 81920
    s_add_u32 s59, s63, 1146880
    buffer_load_dwordx4 v214, s[16:19], s59 offen lds
    buffer_load_dwordx4 v215, s[16:19], s59 offen offset:1024 lds
    buffer_load_dwordx4 v216, s[16:19], s59 offen offset:2048 lds
    s_add_u32 m0, s61, 84992
    s_add_u32 s60, s63, 1261568
    buffer_load_dwordx4 v214, s[16:19], s60 offen lds
    buffer_load_dwordx4 v215, s[16:19], s60 offen offset:1024 lds
    buffer_load_dwordx4 v216, s[16:19], s60 offen offset:2048 lds
    s_setprio 0
Y_g3b:
    ds_read_b64_tr_b16 v[128:129], v177 offset:0
    ds_read_b64_tr_b16 v[130:131], v177 offset:3072
    ds_read_b128 v[96:99], v176 offset:16384
    ds_read_b128 v[100:103], v176 offset:18432
    ds_read_b128 v[104:107], v176 offset:20480
    ds_read_b128 v[108:111], v176 offset:22528
    ds_read_b64_tr_b16 v[140:141], v177 offset:6144
    ds_read_b64_tr_b16 v[142:143], v177 offset:9216
    ds_read_b64_tr_b16 v[132:133], v178 offset:0
    ds_read_b64_tr_b16 v[134:135], v178 offset:3072
    ds_read_b64_tr_b16 v[144:145], v178 offset:6144
    ds_read_b64_tr_b16 v[146:147], v178 offset:9216
    ds_read_b64_tr_b16 v[136:137], v179 offset:0
    ds_read_b64_tr_b16 v[138:139], v179 offset:3072
    ds_read_b64_tr_b16 v[148:149], v179 offset:6144
    ds_read_b64_tr_b16 v[150:151], v179 offset:9216
    s_lshr_b32 s55, s41, 3
    s_mul_i32 s55, s55, 458752
    s_add_u32 s55, s55, s50
    s_lshl_b32 s56, s43, 13
    s_add_u32 s55, s55, s56
    s_and_b32 s56, s41, 7
    s_add_u32 s56, s56, 16
    s_lshl_b32 s56, s56, 14
    s_add_u32 s64, s55, s56
    s_lshl_b32 s56, s44, 10
    s_add_u32 s64, s64, s56
    s_and_b32 s56, s41, 6
    s_add_u32 s56, s56, 48
    s_lshl_b32 s56, s56, 13
    s_add_u32 s65, s55, s56
    s_and_b32 s56, s41, 1
    s_lshl_b32 s56, s56, 10
    s_add_u32 s65, s65, s56
    s_mov_b32 s58, 5
    .p2align 3
loop_90:
    s_waitcnt vmcnt(24) lgkmcnt(0)
    s_barrier
    .p2align 3
    v_mfma_f32_16x16x32_bf16 v[0:3], v[128:131], v[96:99], v[0:3]
    ds_read_b64_tr_b16 v[152:153], v177 offset:16384
    v_mfma_f32_16x16x32_bf16 v[4:7], v[128:131], v[100:103], v[4:7]
    ds_read_b64_tr_b16 v[154:155], v177 offset:19456
    v_mfma_f32_16x16x32_bf16 v[8:11], v[128:131], v[104:107], v[8:11]
    ds_read_b128 v[112:115], v176 offset:17408
    v_mfma_f32_16x16x32_bf16 v[12:15], v[128:131], v[108:111], v[12:15]
    ds_read_b128 v[116:119], v176 offset:19456
    v_mfma_f32_16x16x32_bf16 v[48:51], v[140:143], v[96:99], v[48:51]
    ds_read_b128 v[120:123], v176 offset:21504
    v_mfma_f32_16x16x32_bf16 v[52:55], v[140:143], v[100:103], v[52:55]
    ds_read_b128 v[124:127], v176 offset:23552
    v_mfma_f32_16x16x32_bf16 v[56:59], v[140:143], v[104:107], v[56:59]
    ds_read_b64_tr_b16 v[164:165], v177 offset:22528
    v_mfma_f32_16x16x32_bf16 v[60:63], v[140:143], v[108:111], v[60:63]
    ds_read_b64_tr_b16 v[166:167], v177 offset:25600
    v_mfma_f32_16x16x32_bf16 v[16:19], v[132:135], v[96:99], v[16:19]
    v_mfma_f32_16x16x32_bf16 v[20:23], v[132:135], v[100:103], v[20:23]
    ds_read_b64_tr_b16 v[156:157], v178 offset:16384
    v_mfma_f32_16x16x32_bf16 v[24:27], v[132:135], v[104:107], v[24:27]
    ds_read_b64_tr_b16 v[158:159], v178 offset:19456
    v_mfma_f32_16x16x32_bf16 v[28:31], v[132:135], v[108:111], v[28:31]
    ds_read_b64_tr_b16 v[168:169], v178 offset:22528
    v_mfma_f32_16x16x32_bf16 v[64:67], v[144:147], v[96:99], v[64:67]
    ds_read_b64_tr_b16 v[170:171], v178 offset:25600
    v_mfma_f32_16x16x32_bf16 v[68:71], v[144:147], v[100:103], v[68:71]
    ds_read_b64_tr_b16 v[160:161], v179 offset:16384
    v_mfma_f32_16x16x32_bf16 v[72:75], v[144:147], v[104:107], v[72:75]
    ds_read_b64_tr_b16 v[162:163], v179 offset:19456
    v_mfma_f32_16x16x32_bf16 v[76:79], v[144:147], v[108:111], v[76:79]
    ds_read_b64_tr_b16 v[172:173], v179 offset:22528
    v_mfma_f32_16x16x32_bf16 v[32:35], v[136:139], v[96:99], v[32:35]
    ds_read_b64_tr_b16 v[174:175], v179 offset:25600
    v_mfma_f32_16x16x32_bf16 v[36:39], v[136:139], v[100:103], v[36:39]
    v_mfma_f32_16x16x32_bf16 v[40:43], v[136:139], v[104:107], v[40:43]
    v_mfma_f32_16x16x32_bf16 v[44:47], v[136:139], v[108:111], v[44:47]
    v_mfma_f32_16x16x32_bf16 v[80:83], v[148:151], v[96:99], v[80:83]
    v_mfma_f32_16x16x32_bf16 v[84:87], v[148:151], v[100:103], v[84:87]
    v_mfma_f32_16x16x32_bf16 v[88:91], v[148:151], v[104:107], v[88:91]
    v_mfma_f32_16x16x32_bf16 v[92:95], v[148:151], v[108:111], v[92:95]
    s_waitcnt vmcnt(18) lgkmcnt(0)
    s_barrier
    .p2align 3
    v_mfma_f32_16x16x32_bf16 v[0:3], v[152:155], v[112:115], v[0:3]
    ds_read_b64_tr_b16 v[128:129], v177 offset:32768
    v_mfma_f32_16x16x32_bf16 v[4:7], v[152:155], v[116:119], v[4:7]
    ds_read_b64_tr_b16 v[130:131], v177 offset:35840
    v_mfma_f32_16x16x32_bf16 v[8:11], v[152:155], v[120:123], v[8:11]
    ds_read_b128 v[96:99], v176 offset:32768
    v_mfma_f32_16x16x32_bf16 v[12:15], v[152:155], v[124:127], v[12:15]
    ds_read_b128 v[100:103], v176 offset:34816
    v_mfma_f32_16x16x32_bf16 v[48:51], v[164:167], v[112:115], v[48:51]
    ds_read_b128 v[104:107], v176 offset:36864
    v_mfma_f32_16x16x32_bf16 v[52:55], v[164:167], v[116:119], v[52:55]
    ds_read_b128 v[108:111], v176 offset:38912
    v_mfma_f32_16x16x32_bf16 v[56:59], v[164:167], v[120:123], v[56:59]
    ds_read_b64_tr_b16 v[140:141], v177 offset:38912
    v_mfma_f32_16x16x32_bf16 v[60:63], v[164:167], v[124:127], v[60:63]
    ds_read_b64_tr_b16 v[142:143], v177 offset:41984
    v_mfma_f32_16x16x32_bf16 v[16:19], v[156:159], v[112:115], v[16:19]
    v_mfma_f32_16x16x32_bf16 v[20:23], v[156:159], v[116:119], v[20:23]
    ds_read_b64_tr_b16 v[132:133], v178 offset:32768
    v_mfma_f32_16x16x32_bf16 v[24:27], v[156:159], v[120:123], v[24:27]
    ds_read_b64_tr_b16 v[134:135], v178 offset:35840
    v_mfma_f32_16x16x32_bf16 v[28:31], v[156:159], v[124:127], v[28:31]
    ds_read_b64_tr_b16 v[144:145], v178 offset:38912
    v_mfma_f32_16x16x32_bf16 v[64:67], v[168:171], v[112:115], v[64:67]
    ds_read_b64_tr_b16 v[146:147], v178 offset:41984
    v_mfma_f32_16x16x32_bf16 v[68:71], v[168:171], v[116:119], v[68:71]
    ds_read_b64_tr_b16 v[136:137], v179 offset:32768
    v_mfma_f32_16x16x32_bf16 v[72:75], v[168:171], v[120:123], v[72:75]
    ds_read_b64_tr_b16 v[138:139], v179 offset:35840
    v_mfma_f32_16x16x32_bf16 v[76:79], v[168:171], v[124:127], v[76:79]
    ds_read_b64_tr_b16 v[148:149], v179 offset:38912
    v_mfma_f32_16x16x32_bf16 v[32:35], v[160:163], v[112:115], v[32:35]
    ds_read_b64_tr_b16 v[150:151], v179 offset:41984
    v_mfma_f32_16x16x32_bf16 v[36:39], v[160:163], v[116:119], v[36:39]
    v_mfma_f32_16x16x32_bf16 v[40:43], v[160:163], v[120:123], v[40:43]
    v_mfma_f32_16x16x32_bf16 v[44:47], v[160:163], v[124:127], v[44:47]
    v_mfma_f32_16x16x32_bf16 v[80:83], v[172:175], v[112:115], v[80:83]
    v_mfma_f32_16x16x32_bf16 v[84:87], v[172:175], v[116:119], v[84:87]
    v_mfma_f32_16x16x32_bf16 v[88:91], v[172:175], v[120:123], v[88:91]
    v_mfma_f32_16x16x32_bf16 v[92:95], v[172:175], v[124:127], v[92:95]
    s_waitcnt vmcnt(12) lgkmcnt(0)
    s_barrier
    .p2align 3
    v_mfma_f32_16x16x32_bf16 v[0:3], v[128:131], v[96:99], v[0:3]
    ds_read_b64_tr_b16 v[152:153], v180 offset:0
    v_mfma_f32_16x16x32_bf16 v[4:7], v[128:131], v[100:103], v[4:7]
    ds_read_b64_tr_b16 v[154:155], v180 offset:3072
    v_mfma_f32_16x16x32_bf16 v[8:11], v[128:131], v[104:107], v[8:11]
    ds_read_b128 v[112:115], v176 offset:33792
    v_mfma_f32_16x16x32_bf16 v[12:15], v[128:131], v[108:111], v[12:15]
    ds_read_b128 v[116:119], v176 offset:35840
    v_mfma_f32_16x16x32_bf16 v[48:51], v[140:143], v[96:99], v[48:51]
    ds_read_b128 v[120:123], v176 offset:37888
    v_mfma_f32_16x16x32_bf16 v[52:55], v[140:143], v[100:103], v[52:55]
    ds_read_b128 v[124:127], v176 offset:39936
    v_mfma_f32_16x16x32_bf16 v[56:59], v[140:143], v[104:107], v[56:59]
    ds_read_b64_tr_b16 v[164:165], v180 offset:6144
    v_mfma_f32_16x16x32_bf16 v[60:63], v[140:143], v[108:111], v[60:63]
    ds_read_b64_tr_b16 v[166:167], v180 offset:9216
    v_mfma_f32_16x16x32_bf16 v[16:19], v[132:135], v[96:99], v[16:19]
    v_mfma_f32_16x16x32_bf16 v[20:23], v[132:135], v[100:103], v[20:23]
    ds_read_b64_tr_b16 v[156:157], v181 offset:0
    v_mfma_f32_16x16x32_bf16 v[24:27], v[132:135], v[104:107], v[24:27]
    ds_read_b64_tr_b16 v[158:159], v181 offset:3072
    v_mfma_f32_16x16x32_bf16 v[28:31], v[132:135], v[108:111], v[28:31]
    ds_read_b64_tr_b16 v[168:169], v181 offset:6144
    v_mfma_f32_16x16x32_bf16 v[64:67], v[144:147], v[96:99], v[64:67]
    ds_read_b64_tr_b16 v[170:171], v181 offset:9216
    v_mfma_f32_16x16x32_bf16 v[68:71], v[144:147], v[100:103], v[68:71]
    ds_read_b64_tr_b16 v[160:161], v182 offset:0
    v_mfma_f32_16x16x32_bf16 v[72:75], v[144:147], v[104:107], v[72:75]
    ds_read_b64_tr_b16 v[162:163], v182 offset:3072
    v_mfma_f32_16x16x32_bf16 v[76:79], v[144:147], v[108:111], v[76:79]
    ds_read_b64_tr_b16 v[172:173], v182 offset:6144
    v_mfma_f32_16x16x32_bf16 v[32:35], v[136:139], v[96:99], v[32:35]
    ds_read_b64_tr_b16 v[174:175], v182 offset:9216
    v_mfma_f32_16x16x32_bf16 v[36:39], v[136:139], v[100:103], v[36:39]
    v_mfma_f32_16x16x32_bf16 v[40:43], v[136:139], v[104:107], v[40:43]
    v_mfma_f32_16x16x32_bf16 v[44:47], v[136:139], v[108:111], v[44:47]
    v_mfma_f32_16x16x32_bf16 v[80:83], v[148:151], v[96:99], v[80:83]
    v_mfma_f32_16x16x32_bf16 v[84:87], v[148:151], v[100:103], v[84:87]
    v_mfma_f32_16x16x32_bf16 v[88:91], v[148:151], v[104:107], v[88:91]
    v_mfma_f32_16x16x32_bf16 v[92:95], v[148:151], v[108:111], v[92:95]
    s_waitcnt vmcnt(6) lgkmcnt(0)
    s_barrier
    .p2align 3
    v_mfma_f32_16x16x32_bf16 v[0:3], v[152:155], v[112:115], v[0:3]
    ds_read_b64_tr_b16 v[128:129], v180 offset:16384
    v_mfma_f32_16x16x32_bf16 v[4:7], v[152:155], v[116:119], v[4:7]
    ds_read_b64_tr_b16 v[130:131], v180 offset:19456
    v_mfma_f32_16x16x32_bf16 v[8:11], v[152:155], v[120:123], v[8:11]
    ds_read_b128 v[96:99], v176 offset:0
    v_mfma_f32_16x16x32_bf16 v[12:15], v[152:155], v[124:127], v[12:15]
    ds_read_b128 v[100:103], v176 offset:2048
    v_mfma_f32_16x16x32_bf16 v[48:51], v[164:167], v[112:115], v[48:51]
    ds_read_b128 v[104:107], v176 offset:4096
    v_mfma_f32_16x16x32_bf16 v[52:55], v[164:167], v[116:119], v[52:55]
    ds_read_b128 v[108:111], v176 offset:6144
    v_mfma_f32_16x16x32_bf16 v[56:59], v[164:167], v[120:123], v[56:59]
    ds_read_b64_tr_b16 v[140:141], v180 offset:22528
    v_mfma_f32_16x16x32_bf16 v[60:63], v[164:167], v[124:127], v[60:63]
    ds_read_b64_tr_b16 v[142:143], v180 offset:25600
    v_mfma_f32_16x16x32_bf16 v[16:19], v[156:159], v[112:115], v[16:19]
    v_mfma_f32_16x16x32_bf16 v[20:23], v[156:159], v[116:119], v[20:23]
    ds_read_b64_tr_b16 v[132:133], v181 offset:16384
    v_mfma_f32_16x16x32_bf16 v[24:27], v[156:159], v[120:123], v[24:27]
    ds_read_b64_tr_b16 v[134:135], v181 offset:19456
    v_mfma_f32_16x16x32_bf16 v[28:31], v[156:159], v[124:127], v[28:31]
    ds_read_b64_tr_b16 v[144:145], v181 offset:22528
    v_mfma_f32_16x16x32_bf16 v[64:67], v[168:171], v[112:115], v[64:67]
    ds_read_b64_tr_b16 v[146:147], v181 offset:25600
    v_mfma_f32_16x16x32_bf16 v[68:71], v[168:171], v[116:119], v[68:71]
    ds_read_b64_tr_b16 v[136:137], v182 offset:16384
    v_mfma_f32_16x16x32_bf16 v[72:75], v[168:171], v[120:123], v[72:75]
    ds_read_b64_tr_b16 v[138:139], v182 offset:19456
    v_mfma_f32_16x16x32_bf16 v[76:79], v[168:171], v[124:127], v[76:79]
    ds_read_b64_tr_b16 v[148:149], v182 offset:22528
    v_mfma_f32_16x16x32_bf16 v[32:35], v[160:163], v[112:115], v[32:35]
    ds_read_b64_tr_b16 v[150:151], v182 offset:25600
    v_mfma_f32_16x16x32_bf16 v[36:39], v[160:163], v[116:119], v[36:39]
    v_mfma_f32_16x16x32_bf16 v[40:43], v[160:163], v[120:123], v[40:43]
    v_mfma_f32_16x16x32_bf16 v[44:47], v[160:163], v[124:127], v[44:47]
    v_mfma_f32_16x16x32_bf16 v[80:83], v[172:175], v[112:115], v[80:83]
    v_mfma_f32_16x16x32_bf16 v[84:87], v[172:175], v[116:119], v[84:87]
    v_mfma_f32_16x16x32_bf16 v[88:91], v[172:175], v[120:123], v[88:91]
    v_mfma_f32_16x16x32_bf16 v[92:95], v[172:175], v[124:127], v[92:95]
    s_waitcnt vmcnt(0) lgkmcnt(0)
    s_barrier
    .p2align 3
    v_mfma_f32_16x16x32_bf16 v[0:3], v[128:131], v[96:99], v[0:3]
    ds_read_b64_tr_b16 v[152:153], v180 offset:32768
    v_mfma_f32_16x16x32_bf16 v[4:7], v[128:131], v[100:103], v[4:7]
    ds_read_b64_tr_b16 v[154:155], v180 offset:35840
    v_mfma_f32_16x16x32_bf16 v[8:11], v[128:131], v[104:107], v[8:11]
    ds_read_b128 v[112:115], v176 offset:1024
    v_mfma_f32_16x16x32_bf16 v[12:15], v[128:131], v[108:111], v[12:15]
    ds_read_b128 v[116:119], v176 offset:3072
    v_mfma_f32_16x16x32_bf16 v[48:51], v[140:143], v[96:99], v[48:51]
    ds_read_b128 v[120:123], v176 offset:5120
    v_mfma_f32_16x16x32_bf16 v[52:55], v[140:143], v[100:103], v[52:55]
    ds_read_b128 v[124:127], v176 offset:7168
    v_mfma_f32_16x16x32_bf16 v[56:59], v[140:143], v[104:107], v[56:59]
    ds_read_b64_tr_b16 v[164:165], v180 offset:38912
    v_mfma_f32_16x16x32_bf16 v[60:63], v[140:143], v[108:111], v[60:63]
    ds_read_b64_tr_b16 v[166:167], v180 offset:41984
    v_mfma_f32_16x16x32_bf16 v[16:19], v[132:135], v[96:99], v[16:19]
    v_mfma_f32_16x16x32_bf16 v[20:23], v[132:135], v[100:103], v[20:23]
    ds_read_b64_tr_b16 v[156:157], v181 offset:32768
    v_mfma_f32_16x16x32_bf16 v[24:27], v[132:135], v[104:107], v[24:27]
    ds_read_b64_tr_b16 v[158:159], v181 offset:35840
    v_mfma_f32_16x16x32_bf16 v[28:31], v[132:135], v[108:111], v[28:31]
    ds_read_b64_tr_b16 v[168:169], v181 offset:38912
    v_mfma_f32_16x16x32_bf16 v[64:67], v[144:147], v[96:99], v[64:67]
    ds_read_b64_tr_b16 v[170:171], v181 offset:41984
    v_mfma_f32_16x16x32_bf16 v[68:71], v[144:147], v[100:103], v[68:71]
    ds_read_b64_tr_b16 v[160:161], v182 offset:32768
    v_mfma_f32_16x16x32_bf16 v[72:75], v[144:147], v[104:107], v[72:75]
    ds_read_b64_tr_b16 v[162:163], v182 offset:35840
    v_mfma_f32_16x16x32_bf16 v[76:79], v[144:147], v[108:111], v[76:79]
    ds_read_b64_tr_b16 v[172:173], v182 offset:38912
    v_mfma_f32_16x16x32_bf16 v[32:35], v[136:139], v[96:99], v[32:35]
    ds_read_b64_tr_b16 v[174:175], v182 offset:41984
    v_mfma_f32_16x16x32_bf16 v[36:39], v[136:139], v[100:103], v[36:39]
    v_mfma_f32_16x16x32_bf16 v[40:43], v[136:139], v[104:107], v[40:43]
    v_mfma_f32_16x16x32_bf16 v[44:47], v[136:139], v[108:111], v[44:47]
    v_mfma_f32_16x16x32_bf16 v[80:83], v[148:151], v[96:99], v[80:83]
    v_mfma_f32_16x16x32_bf16 v[84:87], v[148:151], v[100:103], v[84:87]
    v_mfma_f32_16x16x32_bf16 v[88:91], v[148:151], v[104:107], v[88:91]
    v_mfma_f32_16x16x32_bf16 v[92:95], v[148:151], v[108:111], v[92:95]
    s_waitcnt lgkmcnt(0)
    s_barrier
    .p2align 3
    v_mfma_f32_16x16x32_bf16 v[0:3], v[152:155], v[112:115], v[0:3]
    ds_read_b64_tr_b16 v[128:129], v177 offset:0
    v_mfma_f32_16x16x32_bf16 v[4:7], v[152:155], v[116:119], v[4:7]
    ds_read_b64_tr_b16 v[130:131], v177 offset:3072
    v_mfma_f32_16x16x32_bf16 v[8:11], v[152:155], v[120:123], v[8:11]
    ds_read_b128 v[96:99], v176 offset:16384
    v_mfma_f32_16x16x32_bf16 v[12:15], v[152:155], v[124:127], v[12:15]
    ds_read_b128 v[100:103], v176 offset:18432
    v_mfma_f32_16x16x32_bf16 v[48:51], v[164:167], v[112:115], v[48:51]
    ds_read_b128 v[104:107], v176 offset:20480
    v_mfma_f32_16x16x32_bf16 v[52:55], v[164:167], v[116:119], v[52:55]
    ds_read_b128 v[108:111], v176 offset:22528
    v_mfma_f32_16x16x32_bf16 v[56:59], v[164:167], v[120:123], v[56:59]
    ds_read_b64_tr_b16 v[140:141], v177 offset:6144
    v_mfma_f32_16x16x32_bf16 v[60:63], v[164:167], v[124:127], v[60:63]
    ds_read_b64_tr_b16 v[142:143], v177 offset:9216
    v_mfma_f32_16x16x32_bf16 v[16:19], v[156:159], v[112:115], v[16:19]
    v_mfma_f32_16x16x32_bf16 v[20:23], v[156:159], v[116:119], v[20:23]
    ds_read_b64_tr_b16 v[132:133], v178 offset:0
    v_mfma_f32_16x16x32_bf16 v[24:27], v[156:159], v[120:123], v[24:27]
    ds_read_b64_tr_b16 v[134:135], v178 offset:3072
    v_mfma_f32_16x16x32_bf16 v[28:31], v[156:159], v[124:127], v[28:31]
    ds_read_b64_tr_b16 v[144:145], v178 offset:6144
    v_mfma_f32_16x16x32_bf16 v[64:67], v[168:171], v[112:115], v[64:67]
    ds_read_b64_tr_b16 v[146:147], v178 offset:9216
    v_mfma_f32_16x16x32_bf16 v[68:71], v[168:171], v[116:119], v[68:71]
    ds_read_b64_tr_b16 v[136:137], v179 offset:0
    v_mfma_f32_16x16x32_bf16 v[72:75], v[168:171], v[120:123], v[72:75]
    ds_read_b64_tr_b16 v[138:139], v179 offset:3072
    v_mfma_f32_16x16x32_bf16 v[76:79], v[168:171], v[124:127], v[76:79]
    ds_read_b64_tr_b16 v[148:149], v179 offset:6144
    v_mfma_f32_16x16x32_bf16 v[32:35], v[160:163], v[112:115], v[32:35]
    ds_read_b64_tr_b16 v[150:151], v179 offset:9216
    v_mfma_f32_16x16x32_bf16 v[36:39], v[160:163], v[116:119], v[36:39]
    v_mfma_f32_16x16x32_bf16 v[40:43], v[160:163], v[120:123], v[40:43]
    v_mfma_f32_16x16x32_bf16 v[44:47], v[160:163], v[124:127], v[44:47]
    v_mfma_f32_16x16x32_bf16 v[80:83], v[172:175], v[112:115], v[80:83]
    s_sub_u32 s58, s58, 1
    s_cmp_lg_u32 s58, 0
    .p2align 3
    v_mfma_f32_16x16x32_bf16 v[84:87], v[172:175], v[116:119], v[84:87]
    v_mfma_f32_16x16x32_bf16 v[88:91], v[172:175], v[120:123], v[88:91]
    v_mfma_f32_16x16x32_bf16 v[92:95], v[172:175], v[124:127], v[92:95]
    s_cbranch_scc1 loop_90
    s_waitcnt lgkmcnt(0)
    s_barrier
    .p2align 3
    v_mfma_f32_16x16x32_bf16 v[0:3], v[128:131], v[96:99], v[0:3]
    ds_read_b64_tr_b16 v[152:153], v177 offset:16384
    v_mfma_f32_16x16x32_bf16 v[4:7], v[128:131], v[100:103], v[4:7]
    ds_read_b64_tr_b16 v[154:155], v177 offset:19456
    v_mfma_f32_16x16x32_bf16 v[8:11], v[128:131], v[104:107], v[8:11]
    ds_read_b128 v[112:115], v176 offset:17408
    v_mfma_f32_16x16x32_bf16 v[12:15], v[128:131], v[108:111], v[12:15]
    ds_read_b128 v[116:119], v176 offset:19456
    v_mfma_f32_16x16x32_bf16 v[48:51], v[140:143], v[96:99], v[48:51]
    ds_read_b128 v[120:123], v176 offset:21504
    v_mfma_f32_16x16x32_bf16 v[52:55], v[140:143], v[100:103], v[52:55]
    ds_read_b128 v[124:127], v176 offset:23552
    v_mfma_f32_16x16x32_bf16 v[56:59], v[140:143], v[104:107], v[56:59]
    ds_read_b64_tr_b16 v[164:165], v177 offset:22528
    v_mfma_f32_16x16x32_bf16 v[60:63], v[140:143], v[108:111], v[60:63]
    ds_read_b64_tr_b16 v[166:167], v177 offset:25600
    v_mfma_f32_16x16x32_bf16 v[16:19], v[132:135], v[96:99], v[16:19]
    v_mfma_f32_16x16x32_bf16 v[20:23], v[132:135], v[100:103], v[20:23]
    ds_read_b64_tr_b16 v[156:157], v178 offset:16384
    v_mfma_f32_16x16x32_bf16 v[24:27], v[132:135], v[104:107], v[24:27]
    ds_read_b64_tr_b16 v[158:159], v178 offset:19456
    v_mfma_f32_16x16x32_bf16 v[28:31], v[132:135], v[108:111], v[28:31]
    ds_read_b64_tr_b16 v[168:169], v178 offset:22528
    v_mfma_f32_16x16x32_bf16 v[64:67], v[144:147], v[96:99], v[64:67]
    ds_read_b64_tr_b16 v[170:171], v178 offset:25600
    v_mfma_f32_16x16x32_bf16 v[68:71], v[144:147], v[100:103], v[68:71]
    ds_read_b64_tr_b16 v[160:161], v179 offset:16384
    v_mfma_f32_16x16x32_bf16 v[72:75], v[144:147], v[104:107], v[72:75]
    ds_read_b64_tr_b16 v[162:163], v179 offset:19456
    v_mfma_f32_16x16x32_bf16 v[76:79], v[144:147], v[108:111], v[76:79]
    ds_read_b64_tr_b16 v[172:173], v179 offset:22528
    v_mfma_f32_16x16x32_bf16 v[32:35], v[136:139], v[96:99], v[32:35]
    ds_read_b64_tr_b16 v[174:175], v179 offset:25600
    v_mfma_f32_16x16x32_bf16 v[36:39], v[136:139], v[100:103], v[36:39]
    v_mfma_f32_16x16x32_bf16 v[40:43], v[136:139], v[104:107], v[40:43]
    v_mfma_f32_16x16x32_bf16 v[44:47], v[136:139], v[108:111], v[44:47]
    v_mfma_f32_16x16x32_bf16 v[80:83], v[148:151], v[96:99], v[80:83]
    v_mfma_f32_16x16x32_bf16 v[84:87], v[148:151], v[100:103], v[84:87]
    v_mfma_f32_16x16x32_bf16 v[88:91], v[148:151], v[104:107], v[88:91]
    v_mfma_f32_16x16x32_bf16 v[92:95], v[148:151], v[108:111], v[92:95]
    s_waitcnt lgkmcnt(0)
    s_barrier
    .p2align 3
    v_mfma_f32_16x16x32_bf16 v[0:3], v[152:155], v[112:115], v[0:3]
    v_mfma_f32_16x16x32_bf16 v[4:7], v[152:155], v[116:119], v[4:7]
    v_mfma_f32_16x16x32_bf16 v[8:11], v[152:155], v[120:123], v[8:11]
    v_mfma_f32_16x16x32_bf16 v[12:15], v[152:155], v[124:127], v[12:15]
    v_mfma_f32_16x16x32_bf16 v[48:51], v[164:167], v[112:115], v[48:51]
    v_mfma_f32_16x16x32_bf16 v[52:55], v[164:167], v[116:119], v[52:55]
    v_mfma_f32_16x16x32_bf16 v[56:59], v[164:167], v[120:123], v[56:59]
    v_mfma_f32_16x16x32_bf16 v[60:63], v[164:167], v[124:127], v[60:63]
    v_mfma_f32_16x16x32_bf16 v[16:19], v[156:159], v[112:115], v[16:19]
    v_mfma_f32_16x16x32_bf16 v[20:23], v[156:159], v[116:119], v[20:23]
    v_mfma_f32_16x16x32_bf16 v[24:27], v[156:159], v[120:123], v[24:27]
    v_mfma_f32_16x16x32_bf16 v[28:31], v[156:159], v[124:127], v[28:31]
    v_mfma_f32_16x16x32_bf16 v[64:67], v[168:171], v[112:115], v[64:67]
    v_mfma_f32_16x16x32_bf16 v[68:71], v[168:171], v[116:119], v[68:71]
    v_mfma_f32_16x16x32_bf16 v[72:75], v[168:171], v[120:123], v[72:75]
    v_mfma_f32_16x16x32_bf16 v[76:79], v[168:171], v[124:127], v[76:79]
    v_mfma_f32_16x16x32_bf16 v[32:35], v[160:163], v[112:115], v[32:35]
    v_mfma_f32_16x16x32_bf16 v[36:39], v[160:163], v[116:119], v[36:39]
    v_mfma_f32_16x16x32_bf16 v[40:43], v[160:163], v[120:123], v[40:43]
    v_mfma_f32_16x16x32_bf16 v[44:47], v[160:163], v[124:127], v[44:47]
    v_mfma_f32_16x16x32_bf16 v[80:83], v[172:175], v[112:115], v[80:83]
    v_mfma_f32_16x16x32_bf16 v[84:87], v[172:175], v[116:119], v[84:87]
    v_mfma_f32_16x16x32_bf16 v[88:91], v[172:175], v[120:123], v[88:91]
    v_mfma_f32_16x16x32_bf16 v[92:95], v[172:175], v[124:127], v[92:95]
    s_cmp_ge_u32 s42, 2
    s_cbranch_scc1 YW_g4
    s_setprio 1
    s_and_b32 s55, s51, 1
    s_mul_i32 s55, s55, 458752
    s_add_u32 s63, s50, s55
    s_add_u32 s63, s63, s61
    s_add_u32 m0, s61, 114688
    s_add_u32 s59, s63, 32768
    buffer_load_dwordx4 v254, s[4:7], s59 offen lds
    buffer_load_dwordx4 v254, s[4:7], s59 offen offset:1024 lds
    buffer_load_dwordx4 v254, s[4:7], s59 offen offset:2048 lds
    buffer_load_dwordx4 v254, s[4:7], s59 offen offset:3072 lds
    s_add_u32 m0, s61, 118784
    s_add_u32 s60, s63, 36864
    buffer_load_dwordx4 v254, s[4:7], s60 offen lds
    buffer_load_dwordx4 v254, s[4:7], s60 offen offset:1024 lds
    buffer_load_dwordx4 v254, s[4:7], s60 offen offset:2048 lds
    buffer_load_dwordx4 v254, s[4:7], s60 offen offset:3072 lds
    s_nop 7
    v_mul_f32 v96, v184, v0
    v_mul_f32 v97, v184, v1
    v_mul_f32 v98, v184, v2
    v_mul_f32 v99, v184, v3
    v_exp_f32 v96, v96
    v_exp_f32 v97, v97
    v_exp_f32 v98, v98
    v_exp_f32 v99, v99
    v_mul_f32 v0, v0, v48
    v_mul_f32 v1, v1, v49
    v_mul_f32 v2, v2, v50
    v_mul_f32 v3, v3, v51
    s_barrier
    s_add_u32 m0, s61, 131072
    s_add_u32 s59, s63, 49152
    buffer_load_dwordx4 v254, s[4:7], s59 offen lds
    v_fma_f32 v96, v96, v188, v188
    v_fma_f32 v97, v97, v188, v188
    v_fma_f32 v98, v98, v188, v188
    buffer_load_dwordx4 v254, s[4:7], s59 offen offset:1024 lds
    v_fma_f32 v99, v99, v188, v188
    v_rcp_f32 v96, v96
    v_rcp_f32 v97, v97
    buffer_load_dwordx4 v254, s[4:7], s59 offen offset:2048 lds
    v_rcp_f32 v98, v98
    v_rcp_f32 v99, v99
    v_mul_f32 v0, v0, v96
    buffer_load_dwordx4 v254, s[4:7], s59 offen offset:3072 lds
    v_mul_f32 v1, v1, v97
    v_mul_f32 v2, v2, v98
    v_mul_f32 v3, v3, v99
    v_cvt_pk_bf16_f32 v100, v0, v1
    s_add_u32 m0, s61, 135168
    s_add_u32 s60, s63, 53248
    buffer_load_dwordx4 v254, s[4:7], s60 offen lds
    v_cvt_pk_bf16_f32 v101, v2, v3
    v_mul_f32 v96, v184, v16
    v_mul_f32 v97, v184, v17
    buffer_load_dwordx4 v254, s[4:7], s60 offen offset:1024 lds
    v_mul_f32 v98, v184, v18
    v_mul_f32 v99, v184, v19
    v_exp_f32 v96, v96
    buffer_load_dwordx4 v254, s[4:7], s60 offen offset:2048 lds
    v_exp_f32 v97, v97
    v_exp_f32 v98, v98
    v_exp_f32 v99, v99
    buffer_load_dwordx4 v254, s[4:7], s60 offen offset:3072 lds
    v_mul_f32 v16, v16, v64
    v_mul_f32 v17, v17, v65
    v_mul_f32 v18, v18, v66
    v_mul_f32 v19, v19, v67
    s_waitcnt vmcnt(8)
    s_barrier
    s_add_u32 m0, s61, 98304
    s_add_u32 s59, s63, 65536
    buffer_load_dwordx4 v254, s[4:7], s59 offen lds
    v_fma_f32 v96, v96, v188, v188
    v_fma_f32 v97, v97, v188, v188
    buffer_load_dwordx4 v254, s[4:7], s59 offen offset:1024 lds
    v_fma_f32 v98, v98, v188, v188
    v_fma_f32 v99, v99, v188, v188
    v_rcp_f32 v96, v96
    buffer_load_dwordx4 v254, s[4:7], s59 offen offset:2048 lds
    v_rcp_f32 v97, v97
    v_rcp_f32 v98, v98
    v_rcp_f32 v99, v99
    buffer_load_dwordx4 v254, s[4:7], s59 offen offset:3072 lds
    v_mul_f32 v16, v16, v96
    v_mul_f32 v17, v17, v97
    v_mul_f32 v18, v18, v98
    s_add_u32 m0, s61, 102400
    s_add_u32 s60, s63, 69632
    buffer_load_dwordx4 v254, s[4:7], s60 offen lds
    v_mul_f32 v19, v19, v99
    v_cvt_pk_bf16_f32 v102, v16, v17
    v_cvt_pk_bf16_f32 v103, v18, v19
    buffer_load_dwordx4 v254, s[4:7], s60 offen offset:1024 lds
    s_add_u32 s55, s64, 0
    buffer_store_dwordx4 v[100:103], v254, s[4:7], s55 offen sc0 sc1
    v_mul_f32 v96, v185, v4
    v_mul_f32 v97, v185, v5
    buffer_load_dwordx4 v254, s[4:7], s60 offen offset:2048 lds
    v_mul_f32 v98, v185, v6
    v_mul_f32 v99, v185, v7
    v_exp_f32 v96, v96
    buffer_load_dwordx4 v254, s[4:7], s60 offen offset:3072 lds
    v_exp_f32 v97, v97
    v_exp_f32 v98, v98
    v_exp_f32 v99, v99
    s_waitcnt vmcnt(9)
    s_barrier
    s_add_u32 m0, s61, 114688
    s_add_u32 s59, s63, 81920
    buffer_load_dwordx4 v254, s[4:7], s59 offen lds
    v_mul_f32 v4, v4, v52
    v_mul_f32 v5, v5, v53
    v_mul_f32 v6, v6, v54
    buffer_load_dwordx4 v254, s[4:7], s59 offen offset:1024 lds
    v_mul_f32 v7, v7, v55
    v_fma_f32 v96, v96, v189, v189
    v_fma_f32 v97, v97, v189, v189
    buffer_load_dwordx4 v254, s[4:7], s59 offen offset:2048 lds
    v_fma_f32 v98, v98, v189, v189
    v_fma_f32 v99, v99, v189, v189
    v_rcp_f32 v96, v96
    buffer_load_dwordx4 v254, s[4:7], s59 offen offset:3072 lds
    v_rcp_f32 v97, v97
    v_rcp_f32 v98, v98
    v_rcp_f32 v99, v99
    v_mul_f32 v4, v4, v96
    s_add_u32 m0, s61, 118784
    s_add_u32 s60, s63, 86016
    buffer_load_dwordx4 v254, s[4:7], s60 offen lds
    v_mul_f32 v5, v5, v97
    v_mul_f32 v6, v6, v98
    v_mul_f32 v7, v7, v99
    buffer_load_dwordx4 v254, s[4:7], s60 offen offset:1024 lds
    v_cvt_pk_bf16_f32 v104, v4, v5
    v_cvt_pk_bf16_f32 v105, v6, v7
    v_mul_f32 v96, v185, v20
    buffer_load_dwordx4 v254, s[4:7], s60 offen offset:2048 lds
    v_mul_f32 v97, v185, v21
    v_mul_f32 v98, v185, v22
    v_mul_f32 v99, v185, v23
    buffer_load_dwordx4 v254, s[4:7], s60 offen offset:3072 lds
    v_exp_f32 v96, v96
    v_exp_f32 v97, v97
    v_exp_f32 v98, v98
    v_exp_f32 v99, v99
    s_waitcnt vmcnt(8)
    s_barrier
    s_add_u32 m0, s61, 131072
    s_add_u32 s59, s63, 98304
    buffer_load_dwordx4 v254, s[4:7], s59 offen lds
    v_mul_f32 v20, v20, v68
    v_mul_f32 v21, v21, v69
    v_mul_f32 v22, v22, v70
    buffer_load_dwordx4 v254, s[4:7], s59 offen offset:1024 lds
    v_mul_f32 v23, v23, v71
    v_fma_f32 v96, v96, v189, v189
    v_fma_f32 v97, v97, v189, v189
    buffer_load_dwordx4 v254, s[4:7], s59 offen offset:2048 lds
    v_fma_f32 v98, v98, v189, v189
    v_fma_f32 v99, v99, v189, v189
    v_rcp_f32 v96, v96
    buffer_load_dwordx4 v254, s[4:7], s59 offen offset:3072 lds
    v_rcp_f32 v97, v97
    v_rcp_f32 v98, v98
    v_rcp_f32 v99, v99
    s_add_u32 m0, s61, 135168
    s_add_u32 s60, s63, 102400
    buffer_load_dwordx4 v254, s[4:7], s60 offen lds
    v_mul_f32 v20, v20, v96
    v_mul_f32 v21, v21, v97
    v_mul_f32 v22, v22, v98
    buffer_load_dwordx4 v254, s[4:7], s60 offen offset:1024 lds
    v_mul_f32 v23, v23, v99
    v_cvt_pk_bf16_f32 v106, v20, v21
    v_cvt_pk_bf16_f32 v107, v22, v23
    buffer_load_dwordx4 v254, s[4:7], s60 offen offset:2048 lds
    s_add_u32 s55, s64, 2048
    buffer_store_dwordx4 v[104:107], v254, s[4:7], s55 offen sc0 sc1
    v_mul_f32 v96, v186, v8
    v_mul_f32 v97, v186, v9
    buffer_load_dwordx4 v254, s[4:7], s60 offen offset:3072 lds
    v_mul_f32 v98, v186, v10
    v_mul_f32 v99, v186, v11
    v_exp_f32 v96, v96
    v_exp_f32 v97, v97
    s_waitcnt vmcnt(9)
    s_barrier
    v_lshrrev_b32 v252, 2, v254
    v_min_u32 v252, 28, v252
    s_add_u32 s55, s0, 2080
    buffer_load_dword v251, v252, s[4:7], s55 offen sc0 sc1
    s_add_u32 m0, s61, 98304
    s_add_u32 s59, s63, 114688
    buffer_load_dwordx4 v254, s[4:7], s59 offen lds
    v_exp_f32 v98, v98
    v_exp_f32 v99, v99
    v_mul_f32 v8, v8, v56
    buffer_load_dwordx4 v254, s[4:7], s59 offen offset:1024 lds
    v_mul_f32 v9, v9, v57
    v_mul_f32 v10, v10, v58
    v_mul_f32 v11, v11, v59
    buffer_load_dwordx4 v254, s[4:7], s59 offen offset:2048 lds
    v_fma_f32 v96, v96, v190, v190
    v_fma_f32 v97, v97, v190, v190
    v_fma_f32 v98, v98, v190, v190
    buffer_load_dwordx4 v254, s[4:7], s59 offen offset:3072 lds
    v_fma_f32 v99, v99, v190, v190
    v_rcp_f32 v96, v96
    v_rcp_f32 v97, v97
    v_rcp_f32 v98, v98
    s_add_u32 m0, s61, 102400
    s_add_u32 s60, s63, 118784
    buffer_load_dwordx4 v254, s[4:7], s60 offen lds
    v_rcp_f32 v99, v99
    v_mul_f32 v8, v8, v96
    v_mul_f32 v9, v9, v97
    buffer_load_dwordx4 v254, s[4:7], s60 offen offset:1024 lds
    v_mul_f32 v10, v10, v98
    v_mul_f32 v11, v11, v99
    v_cvt_pk_bf16_f32 v100, v8, v9
    buffer_load_dwordx4 v254, s[4:7], s60 offen offset:2048 lds
    v_cvt_pk_bf16_f32 v101, v10, v11
    v_mul_f32 v96, v186, v24
    v_mul_f32 v97, v186, v25
    buffer_load_dwordx4 v254, s[4:7], s60 offen offset:3072 lds
    v_mul_f32 v98, v186, v26
    v_mul_f32 v99, v186, v27
    v_exp_f32 v96, v96
    v_exp_f32 v97, v97
    s_waitcnt vmcnt(9)
    s_barrier
    s_waitcnt vmcnt(8)
    v_cmp_ne_u32 vcc, 0x01010101, v251
    s_cbranch_vccz ap_91
    v_lshrrev_b32 v252, 2, v254
    v_min_u32 v252, 28, v252
    s_add_u32 s55, s0, 2080
    s_mov_b32 s56, 262144
poll_92:
    buffer_load_dword v253, v252, s[4:7], s55 offen sc0 sc1
    s_waitcnt vmcnt(0)
    v_cmp_ne_u32 vcc, 0x01010101, v253
    s_cbranch_vccz pd_93
    s_sleep 1
    s_sub_u32 s56, s56, 1
    s_cmp_lg_u32 s56, 0
    s_cbranch_scc1 poll_92
pd_93:
ap_91:
    s_add_u32 m0, s61, 114688
    s_add_u32 s59, s63, 131072
    buffer_load_dwordx4 v254, s[4:7], s59 offen lds
    v_exp_f32 v98, v98
    v_exp_f32 v99, v99
    v_mul_f32 v24, v24, v72
    buffer_load_dwordx4 v254, s[4:7], s59 offen offset:1024 lds
    v_mul_f32 v25, v25, v73
    v_mul_f32 v26, v26, v74
    v_mul_f32 v27, v27, v75
    buffer_load_dwordx4 v254, s[4:7], s59 offen offset:2048 lds
    v_fma_f32 v96, v96, v190, v190
    v_fma_f32 v97, v97, v190, v190
    v_fma_f32 v98, v98, v190, v190
    buffer_load_dwordx4 v254, s[4:7], s59 offen offset:3072 lds
    v_fma_f32 v99, v99, v190, v190
    v_rcp_f32 v96, v96
    v_rcp_f32 v97, v97
    s_add_u32 m0, s61, 118784
    s_add_u32 s60, s63, 135168
    buffer_load_dwordx4 v254, s[4:7], s60 offen lds
    v_rcp_f32 v98, v98
    v_rcp_f32 v99, v99
    v_mul_f32 v24, v24, v96
    buffer_load_dwordx4 v254, s[4:7], s60 offen offset:1024 lds
    v_mul_f32 v25, v25, v97
    v_mul_f32 v26, v26, v98
    v_mul_f32 v27, v27, v99
    buffer_load_dwordx4 v254, s[4:7], s60 offen offset:2048 lds
    v_cvt_pk_bf16_f32 v102, v24, v25
    v_cvt_pk_bf16_f32 v103, v26, v27
    s_add_u32 s55, s64, 4096
    buffer_store_dwordx4 v[100:103], v254, s[4:7], s55 offen sc0 sc1
    buffer_load_dwordx4 v254, s[4:7], s60 offen offset:3072 lds
    v_mul_f32 v96, v187, v12
    v_mul_f32 v97, v187, v13
    v_mul_f32 v98, v187, v14
    v_mul_f32 v99, v187, v15
    s_waitcnt vmcnt(9)
    s_barrier
    s_add_u32 m0, s61, 131072
    s_add_u32 s59, s63, 147456
    buffer_load_dwordx4 v254, s[4:7], s59 offen lds
    v_exp_f32 v96, v96
    v_exp_f32 v97, v97
    v_exp_f32 v98, v98
    buffer_load_dwordx4 v254, s[4:7], s59 offen offset:1024 lds
    v_exp_f32 v99, v99
    v_mul_f32 v12, v12, v60
    v_mul_f32 v13, v13, v61
    buffer_load_dwordx4 v254, s[4:7], s59 offen offset:2048 lds
    v_mul_f32 v14, v14, v62
    v_mul_f32 v15, v15, v63
    v_fma_f32 v96, v96, v191, v191
    buffer_load_dwordx4 v254, s[4:7], s59 offen offset:3072 lds
    v_fma_f32 v97, v97, v191, v191
    v_fma_f32 v98, v98, v191, v191
    v_fma_f32 v99, v99, v191, v191
    v_rcp_f32 v96, v96
    s_add_u32 m0, s61, 135168
    s_add_u32 s60, s63, 151552
    buffer_load_dwordx4 v254, s[4:7], s60 offen lds
    v_rcp_f32 v97, v97
    v_rcp_f32 v98, v98
    v_rcp_f32 v99, v99
    buffer_load_dwordx4 v254, s[4:7], s60 offen offset:1024 lds
    v_mul_f32 v12, v12, v96
    v_mul_f32 v13, v13, v97
    v_mul_f32 v14, v14, v98
    buffer_load_dwordx4 v254, s[4:7], s60 offen offset:2048 lds
    v_mul_f32 v15, v15, v99
    v_cvt_pk_bf16_f32 v104, v12, v13
    v_cvt_pk_bf16_f32 v105, v14, v15
    buffer_load_dwordx4 v254, s[4:7], s60 offen offset:3072 lds
    v_mul_f32 v96, v187, v28
    v_mul_f32 v97, v187, v29
    v_mul_f32 v98, v187, v30
    v_mul_f32 v99, v187, v31
    s_waitcnt vmcnt(8)
    s_barrier
    s_add_u32 m0, s61, 98304
    s_add_u32 s59, s63, 163840
    buffer_load_dwordx4 v254, s[4:7], s59 offen lds
    v_exp_f32 v96, v96
    v_exp_f32 v97, v97
    buffer_load_dwordx4 v254, s[4:7], s59 offen offset:1024 lds
    v_exp_f32 v98, v98
    v_exp_f32 v99, v99
    v_mul_f32 v28, v28, v76
    buffer_load_dwordx4 v254, s[4:7], s59 offen offset:2048 lds
    v_mul_f32 v29, v29, v77
    v_mul_f32 v30, v30, v78
    v_mul_f32 v31, v31, v79
    buffer_load_dwordx4 v254, s[4:7], s59 offen offset:3072 lds
    v_fma_f32 v96, v96, v191, v191
    v_fma_f32 v97, v97, v191, v191
    v_fma_f32 v98, v98, v191, v191
    s_add_u32 m0, s61, 102400
    s_add_u32 s60, s63, 167936
    buffer_load_dwordx4 v254, s[4:7], s60 offen lds
    v_fma_f32 v99, v99, v191, v191
    v_rcp_f32 v96, v96
    v_rcp_f32 v97, v97
    buffer_load_dwordx4 v254, s[4:7], s60 offen offset:1024 lds
    v_rcp_f32 v98, v98
    v_rcp_f32 v99, v99
    v_mul_f32 v28, v28, v96
    buffer_load_dwordx4 v254, s[4:7], s60 offen offset:2048 lds
    v_mul_f32 v29, v29, v97
    v_mul_f32 v30, v30, v98
    v_mul_f32 v31, v31, v99
    buffer_load_dwordx4 v254, s[4:7], s60 offen offset:3072 lds
    v_cvt_pk_bf16_f32 v106, v28, v29
    v_cvt_pk_bf16_f32 v107, v30, v31
    s_add_u32 s55, s64, 6144
    buffer_store_dwordx4 v[104:107], v254, s[4:7], s55 offen sc0 sc1
    s_waitcnt vmcnt(9)
    s_barrier
    s_add_u32 m0, s61, 114688
    s_add_u32 s59, s63, 180224
    buffer_load_dwordx4 v254, s[4:7], s59 offen lds
    v_lshrrev_b32 v120, 1, v254
    s_lshl_b32 s55, s43, 11
    s_add_u32 s55, s55, 157632
    v_add_u32 v120, s55, v120
    buffer_load_dwordx4 v254, s[4:7], s59 offen offset:1024 lds
    v_mul_f32 v96, v186, v40
    v_mul_f32 v97, v186, v41
    v_mul_f32 v98, v186, v42
    buffer_load_dwordx4 v254, s[4:7], s59 offen offset:2048 lds
    v_mul_f32 v99, v186, v43
    v_exp_f32 v96, v96
    buffer_load_dwordx4 v254, s[4:7], s59 offen offset:3072 lds
    v_exp_f32 v97, v97
    v_exp_f32 v98, v98
    v_exp_f32 v99, v99
    s_add_u32 m0, s61, 118784
    s_add_u32 s60, s63, 184320
    buffer_load_dwordx4 v254, s[4:7], s60 offen lds
    v_mul_f32 v40, v40, v88
    v_mul_f32 v41, v41, v89
    v_mul_f32 v42, v42, v90
    buffer_load_dwordx4 v254, s[4:7], s60 offen offset:1024 lds
    v_mul_f32 v43, v43, v91
    v_fma_f32 v96, v96, v190, v190
    buffer_load_dwordx4 v254, s[4:7], s60 offen offset:2048 lds
    v_fma_f32 v97, v97, v190, v190
    v_fma_f32 v98, v98, v190, v190
    v_fma_f32 v99, v99, v190, v190
    buffer_load_dwordx4 v254, s[4:7], s60 offen offset:3072 lds
    v_rcp_f32 v96, v96
    v_rcp_f32 v97, v97
    v_rcp_f32 v98, v98
    s_waitcnt vmcnt(9)
    s_barrier
    s_add_u32 m0, s61, 131072
    s_add_u32 s59, s63, 196608
    buffer_load_dwordx4 v254, s[4:7], s59 offen lds
    v_rcp_f32 v99, v99
    v_mul_f32 v40, v40, v96
    v_mul_f32 v41, v41, v97
    buffer_load_dwordx4 v254, s[4:7], s59 offen offset:1024 lds
    v_mul_f32 v42, v42, v98
    v_mul_f32 v43, v43, v99
    v_cvt_pk_bf16_f32 v108, v40, v41
    buffer_load_dwordx4 v254, s[4:7], s59 offen offset:2048 lds
    v_cvt_pk_bf16_f32 v109, v42, v43
    ds_write_b64 v120, v[108:109] offset:1024
    v_mul_f32 v96, v187, v44
    buffer_load_dwordx4 v254, s[4:7], s59 offen offset:3072 lds
    v_mul_f32 v97, v187, v45
    v_mul_f32 v98, v187, v46
    v_mul_f32 v99, v187, v47
    v_exp_f32 v96, v96
    s_add_u32 m0, s61, 135168
    s_add_u32 s60, s63, 200704
    buffer_load_dwordx4 v254, s[4:7], s60 offen lds
    v_exp_f32 v97, v97
    v_exp_f32 v98, v98
    v_exp_f32 v99, v99
    buffer_load_dwordx4 v254, s[4:7], s60 offen offset:1024 lds
    v_mul_f32 v44, v44, v92
    v_mul_f32 v45, v45, v93
    v_mul_f32 v46, v46, v94
    buffer_load_dwordx4 v254, s[4:7], s60 offen offset:2048 lds
    v_mul_f32 v47, v47, v95
    v_fma_f32 v96, v96, v191, v191
    v_fma_f32 v97, v97, v191, v191
    buffer_load_dwordx4 v254, s[4:7], s60 offen offset:3072 lds
    v_fma_f32 v98, v98, v191, v191
    v_fma_f32 v99, v99, v191, v191
    v_rcp_f32 v96, v96
    v_rcp_f32 v97, v97
    s_waitcnt vmcnt(8)
    s_barrier
    s_add_u32 m0, s61, 98304
    s_add_u32 s59, s63, 212992
    buffer_load_dwordx4 v254, s[4:7], s59 offen lds
    v_rcp_f32 v98, v98
    v_rcp_f32 v99, v99
    v_mul_f32 v44, v44, v96
    buffer_load_dwordx4 v254, s[4:7], s59 offen offset:1024 lds
    v_mul_f32 v45, v45, v97
    v_mul_f32 v46, v46, v98
    v_mul_f32 v47, v47, v99
    buffer_load_dwordx4 v254, s[4:7], s59 offen offset:2048 lds
    v_cvt_pk_bf16_f32 v110, v44, v45
    v_cvt_pk_bf16_f32 v111, v46, v47
    ds_write_b64 v120, v[110:111] offset:1536
    buffer_load_dwordx4 v254, s[4:7], s59 offen offset:3072 lds
    s_waitcnt lgkmcnt(0)
    v_mul_f32 v96, v184, v32
    v_mul_f32 v97, v184, v33
    s_add_u32 m0, s61, 102400
    s_add_u32 s60, s63, 217088
    buffer_load_dwordx4 v254, s[4:7], s60 offen lds
    v_mul_f32 v98, v184, v34
    v_mul_f32 v99, v184, v35
    v_exp_f32 v96, v96
    buffer_load_dwordx4 v254, s[4:7], s60 offen offset:1024 lds
    v_exp_f32 v97, v97
    v_exp_f32 v98, v98
    v_exp_f32 v99, v99
    buffer_load_dwordx4 v254, s[4:7], s60 offen offset:2048 lds
    v_mul_f32 v32, v32, v80
    v_mul_f32 v33, v33, v81
    v_mul_f32 v34, v34, v82
    buffer_load_dwordx4 v254, s[4:7], s60 offen offset:3072 lds
    v_mul_f32 v35, v35, v83
    v_fma_f32 v96, v96, v188, v188
    v_fma_f32 v97, v97, v188, v188
    v_fma_f32 v98, v98, v188, v188
    s_waitcnt vmcnt(8)
    s_barrier
    s_and_b32 s55, s41, 7
    s_lshl_b32 s55, s55, 2
    s_add_u32 s55, s55, s42
    s_add_u32 s55, s55, s0
    s_add_u32 s55, s55, 2112
    v_mov_b32 v252, 0
    v_mov_b32 v253, 1
    s_mov_b64 exec, 1
    s_cmp_eq_u32 s45, 0
    s_cbranch_scc1 st_94
    buffer_store_byte v253, v252, s[4:7], s55 offen sc0 sc1
    s_branch st_95
st_94:
    buffer_store_byte v253, v252, s[4:7], s55 offen
st_95:
    s_mov_b64 exec, -1
    s_add_u32 m0, s61, 114688
    s_add_u32 s59, s63, 229376
    buffer_load_dwordx4 v254, s[4:7], s59 offen lds
    v_fma_f32 v99, v99, v188, v188
    v_rcp_f32 v96, v96
    v_rcp_f32 v97, v97
    buffer_load_dwordx4 v254, s[4:7], s59 offen offset:1024 lds
    v_rcp_f32 v98, v98
    v_rcp_f32 v99, v99
    v_mul_f32 v32, v32, v96
    buffer_load_dwordx4 v254, s[4:7], s59 offen offset:2048 lds
    v_mul_f32 v33, v33, v97
    v_mul_f32 v34, v34, v98
    v_mul_f32 v35, v35, v99
    buffer_load_dwordx4 v254, s[4:7], s59 offen offset:3072 lds
    v_cvt_pk_bf16_f32 v112, v32, v33
    v_cvt_pk_bf16_f32 v113, v34, v35
    v_mul_f32 v96, v185, v36
    v_mul_f32 v97, v185, v37
    s_add_u32 m0, s61, 118784
    s_add_u32 s60, s63, 233472
    buffer_load_dwordx4 v254, s[4:7], s60 offen lds
    v_mul_f32 v98, v185, v38
    v_mul_f32 v99, v185, v39
    v_exp_f32 v96, v96
    buffer_load_dwordx4 v254, s[4:7], s60 offen offset:1024 lds
    v_exp_f32 v97, v97
    v_exp_f32 v98, v98
    v_exp_f32 v99, v99
    buffer_load_dwordx4 v254, s[4:7], s60 offen offset:2048 lds
    v_mul_f32 v36, v36, v84
    v_mul_f32 v37, v37, v85
    v_mul_f32 v38, v38, v86
    buffer_load_dwordx4 v254, s[4:7], s60 offen offset:3072 lds
    v_mul_f32 v39, v39, v87
    v_fma_f32 v96, v96, v189, v189
    v_fma_f32 v97, v97, v189, v189
    v_fma_f32 v98, v98, v189, v189
    s_waitcnt vmcnt(9)
    s_barrier
    v_lshrrev_b32 v252, 2, v254
    v_min_u32 v252, 28, v252
    s_add_u32 s55, s0, 2112
    buffer_load_dword v251, v252, s[4:7], s55 offen sc0 sc1
    s_add_u32 m0, s61, 131072
    s_add_u32 s59, s63, 245760
    buffer_load_dwordx4 v254, s[4:7], s59 offen lds
    v_fma_f32 v99, v99, v189, v189
    buffer_load_dwordx4 v254, s[4:7], s59 offen offset:1024 lds
    v_rcp_f32 v96, v96
    buffer_load_dwordx4 v254, s[4:7], s59 offen offset:2048 lds
    v_rcp_f32 v97, v97
    v_rcp_f32 v98, v98
    buffer_load_dwordx4 v254, s[4:7], s59 offen offset:3072 lds
    v_rcp_f32 v99, v99
    s_add_u32 m0, s61, 135168
    s_add_u32 s60, s63, 249856
    buffer_load_dwordx4 v254, s[4:7], s60 offen lds
    v_mul_f32 v36, v36, v96
    buffer_load_dwordx4 v254, s[4:7], s60 offen offset:1024 lds
    v_mul_f32 v37, v37, v97
    v_mul_f32 v38, v38, v98
    buffer_load_dwordx4 v254, s[4:7], s60 offen offset:2048 lds
    v_mul_f32 v39, v39, v99
    buffer_load_dwordx4 v254, s[4:7], s60 offen offset:3072 lds
    v_cvt_pk_bf16_f32 v116, v36, v37
    v_cvt_pk_bf16_f32 v117, v38, v39
    s_waitcnt vmcnt(9)
    s_barrier
    s_waitcnt vmcnt(8)
    v_cmp_ne_u32 vcc, 0x01010101, v251
    s_cbranch_vccz ap_96
    v_lshrrev_b32 v252, 2, v254
    v_min_u32 v252, 28, v252
    s_add_u32 s55, s0, 2112
    s_mov_b32 s56, 262144
poll_97:
    buffer_load_dword v253, v252, s[4:7], s55 offen sc0 sc1
    s_waitcnt vmcnt(0)
    v_cmp_ne_u32 vcc, 0x01010101, v253
    s_cbranch_vccz pd_98
    s_sleep 1
    s_sub_u32 s56, s56, 1
    s_cmp_lg_u32 s56, 0
    s_cbranch_scc1 poll_97
pd_98:
ap_96:
    s_add_u32 m0, s61, 98304
    s_add_u32 s59, s63, 262144
    buffer_load_dwordx4 v254, s[4:7], s59 offen lds
    buffer_load_dwordx4 v254, s[4:7], s59 offen offset:1024 lds
    ds_read_b64 v[114:115], v120 offset:0
    buffer_load_dwordx4 v254, s[4:7], s59 offen offset:2048 lds
    buffer_load_dwordx4 v254, s[4:7], s59 offen offset:3072 lds
    ds_read_b64 v[118:119], v120 offset:512
    s_add_u32 m0, s61, 102400
    s_add_u32 s60, s63, 266240
    buffer_load_dwordx4 v254, s[4:7], s60 offen lds
    s_waitcnt lgkmcnt(0)
    buffer_load_dwordx4 v254, s[4:7], s60 offen offset:1024 lds
    buffer_load_dwordx4 v254, s[4:7], s60 offen offset:2048 lds
    s_add_u32 s55, s65, 0
    buffer_store_dwordx4 v[112:115], v254, s[4:7], s55 offen sc0 sc1
    buffer_load_dwordx4 v254, s[4:7], s60 offen offset:3072 lds
    s_add_u32 s55, s65, 2048
    buffer_store_dwordx4 v[116:119], v254, s[4:7], s55 offen sc0 sc1
    s_waitcnt vmcnt(10)
    s_barrier
    s_add_u32 m0, s61, 114688
    s_add_u32 s59, s63, 278528
    buffer_load_dwordx4 v254, s[4:7], s59 offen lds
    buffer_load_dwordx4 v254, s[4:7], s59 offen offset:1024 lds
    buffer_load_dwordx4 v254, s[4:7], s59 offen offset:2048 lds
    buffer_load_dwordx4 v254, s[4:7], s59 offen offset:3072 lds
    s_add_u32 m0, s61, 118784
    s_add_u32 s60, s63, 282624
    buffer_load_dwordx4 v254, s[4:7], s60 offen lds
    buffer_load_dwordx4 v254, s[4:7], s60 offen offset:1024 lds
    buffer_load_dwordx4 v254, s[4:7], s60 offen offset:2048 lds
    buffer_load_dwordx4 v254, s[4:7], s60 offen offset:3072 lds
    s_waitcnt vmcnt(9)
    s_barrier
    s_add_u32 m0, s61, 131072
    s_add_u32 s59, s63, 294912
    buffer_load_dwordx4 v254, s[4:7], s59 offen lds
    buffer_load_dwordx4 v254, s[4:7], s59 offen offset:1024 lds
    buffer_load_dwordx4 v254, s[4:7], s59 offen offset:2048 lds
    buffer_load_dwordx4 v254, s[4:7], s59 offen offset:3072 lds
    s_add_u32 m0, s61, 135168
    s_add_u32 s60, s63, 299008
    buffer_load_dwordx4 v254, s[4:7], s60 offen lds
    buffer_load_dwordx4 v254, s[4:7], s60 offen offset:1024 lds
    buffer_load_dwordx4 v254, s[4:7], s60 offen offset:2048 lds
    buffer_load_dwordx4 v254, s[4:7], s60 offen offset:3072 lds
    s_waitcnt vmcnt(8)
    s_barrier
    s_and_b32 s55, s41, 7
    s_lshl_b32 s55, s55, 2
    s_add_u32 s55, s55, s42
    s_add_u32 s55, s55, s0
    s_add_u32 s55, s55, 2144
    v_mov_b32 v252, 0
    v_mov_b32 v253, 1
    s_mov_b64 exec, 1
    s_cmp_eq_u32 s45, 0
    s_cbranch_scc1 st_99
    buffer_store_byte v253, v252, s[4:7], s55 offen sc0 sc1
    s_branch st_100
st_99:
    buffer_store_byte v253, v252, s[4:7], s55 offen
st_100:
    s_mov_b64 exec, -1
    s_add_u32 m0, s61, 98304
    s_add_u32 s59, s63, 311296
    buffer_load_dwordx4 v254, s[4:7], s59 offen lds
    buffer_load_dwordx4 v254, s[4:7], s59 offen offset:1024 lds
    buffer_load_dwordx4 v254, s[4:7], s59 offen offset:2048 lds
    buffer_load_dwordx4 v254, s[4:7], s59 offen offset:3072 lds
    s_add_u32 m0, s61, 102400
    s_add_u32 s60, s63, 315392
    buffer_load_dwordx4 v254, s[4:7], s60 offen lds
    buffer_load_dwordx4 v254, s[4:7], s60 offen offset:1024 lds
    buffer_load_dwordx4 v254, s[4:7], s60 offen offset:2048 lds
    buffer_load_dwordx4 v254, s[4:7], s60 offen offset:3072 lds
    s_waitcnt vmcnt(9)
    s_barrier
    s_add_u32 m0, s61, 114688
    s_add_u32 s59, s63, 327680
    buffer_load_dwordx4 v254, s[4:7], s59 offen lds
    buffer_load_dwordx4 v254, s[4:7], s59 offen offset:1024 lds
    buffer_load_dwordx4 v254, s[4:7], s59 offen offset:2048 lds
    buffer_load_dwordx4 v254, s[4:7], s59 offen offset:3072 lds
    s_add_u32 m0, s61, 118784
    s_add_u32 s60, s63, 331776
    buffer_load_dwordx4 v254, s[4:7], s60 offen lds
    buffer_load_dwordx4 v254, s[4:7], s60 offen offset:1024 lds
    buffer_load_dwordx4 v254, s[4:7], s60 offen offset:2048 lds
    buffer_load_dwordx4 v254, s[4:7], s60 offen offset:3072 lds
    s_waitcnt vmcnt(8)
    s_barrier
    s_add_u32 m0, s61, 131072
    s_add_u32 s59, s63, 344064
    buffer_load_dwordx4 v254, s[4:7], s59 offen lds
    buffer_load_dwordx4 v254, s[4:7], s59 offen offset:1024 lds
    buffer_load_dwordx4 v254, s[4:7], s59 offen offset:2048 lds
    buffer_load_dwordx4 v254, s[4:7], s59 offen offset:3072 lds
    s_add_u32 m0, s61, 135168
    s_add_u32 s60, s63, 348160
    buffer_load_dwordx4 v254, s[4:7], s60 offen lds
    buffer_load_dwordx4 v254, s[4:7], s60 offen offset:1024 lds
    buffer_load_dwordx4 v254, s[4:7], s60 offen offset:2048 lds
    buffer_load_dwordx4 v254, s[4:7], s60 offen offset:3072 lds
    s_waitcnt vmcnt(8)
    s_barrier
    s_add_u32 m0, s61, 98304
    s_add_u32 s59, s63, 360448
    buffer_load_dwordx4 v254, s[4:7], s59 offen lds
    buffer_load_dwordx4 v254, s[4:7], s59 offen offset:1024 lds
    buffer_load_dwordx4 v254, s[4:7], s59 offen offset:2048 lds
    buffer_load_dwordx4 v254, s[4:7], s59 offen offset:3072 lds
    s_add_u32 m0, s61, 102400
    s_add_u32 s60, s63, 364544
    buffer_load_dwordx4 v254, s[4:7], s60 offen lds
    buffer_load_dwordx4 v254, s[4:7], s60 offen offset:1024 lds
    buffer_load_dwordx4 v254, s[4:7], s60 offen offset:2048 lds
    buffer_load_dwordx4 v254, s[4:7], s60 offen offset:3072 lds
    s_waitcnt vmcnt(8)
    s_barrier
    v_lshrrev_b32 v252, 2, v254
    v_min_u32 v252, 28, v252
    s_add_u32 s55, s0, 2144
    buffer_load_dword v251, v252, s[4:7], s55 offen sc0 sc1
    s_add_u32 m0, s61, 114688
    s_add_u32 s59, s63, 376832
    buffer_load_dwordx4 v254, s[4:7], s59 offen lds
    buffer_load_dwordx4 v254, s[4:7], s59 offen offset:1024 lds
    buffer_load_dwordx4 v254, s[4:7], s59 offen offset:2048 lds
    buffer_load_dwordx4 v254, s[4:7], s59 offen offset:3072 lds
    s_add_u32 m0, s61, 118784
    s_add_u32 s60, s63, 380928
    buffer_load_dwordx4 v254, s[4:7], s60 offen lds
    buffer_load_dwordx4 v254, s[4:7], s60 offen offset:1024 lds
    buffer_load_dwordx4 v254, s[4:7], s60 offen offset:2048 lds
    buffer_load_dwordx4 v254, s[4:7], s60 offen offset:3072 lds
    s_waitcnt vmcnt(9)
    s_barrier
    s_waitcnt vmcnt(8)
    v_cmp_ne_u32 vcc, 0x01010101, v251
    s_cbranch_vccz ap_101
    v_lshrrev_b32 v252, 2, v254
    v_min_u32 v252, 28, v252
    s_add_u32 s55, s0, 2144
    s_mov_b32 s56, 262144
poll_102:
    buffer_load_dword v253, v252, s[4:7], s55 offen sc0 sc1
    s_waitcnt vmcnt(0)
    v_cmp_ne_u32 vcc, 0x01010101, v253
    s_cbranch_vccz pd_103
    s_sleep 1
    s_sub_u32 s56, s56, 1
    s_cmp_lg_u32 s56, 0
    s_cbranch_scc1 poll_102
pd_103:
ap_101:
    s_add_u32 m0, s61, 131072
    s_add_u32 s59, s63, 393216
    buffer_load_dwordx4 v254, s[4:7], s59 offen lds
    buffer_load_dwordx4 v254, s[4:7], s59 offen offset:1024 lds
    buffer_load_dwordx4 v254, s[4:7], s59 offen offset:2048 lds
    buffer_load_dwordx4 v254, s[4:7], s59 offen offset:3072 lds
    s_add_u32 m0, s61, 135168
    s_add_u32 s60, s63, 397312
    buffer_load_dwordx4 v254, s[4:7], s60 offen lds
    buffer_load_dwordx4 v254, s[4:7], s60 offen offset:1024 lds
    buffer_load_dwordx4 v254, s[4:7], s60 offen offset:2048 lds
    buffer_load_dwordx4 v254, s[4:7], s60 offen offset:3072 lds
    s_waitcnt vmcnt(8)
    s_barrier
    s_add_u32 m0, s61, 98304
    s_add_u32 s59, s63, 409600
    buffer_load_dwordx4 v254, s[4:7], s59 offen lds
    buffer_load_dwordx4 v254, s[4:7], s59 offen offset:1024 lds
    buffer_load_dwordx4 v254, s[4:7], s59 offen offset:2048 lds
    buffer_load_dwordx4 v254, s[4:7], s59 offen offset:3072 lds
    s_add_u32 m0, s61, 102400
    s_add_u32 s60, s63, 413696
    buffer_load_dwordx4 v254, s[4:7], s60 offen lds
    buffer_load_dwordx4 v254, s[4:7], s60 offen offset:1024 lds
    buffer_load_dwordx4 v254, s[4:7], s60 offen offset:2048 lds
    buffer_load_dwordx4 v254, s[4:7], s60 offen offset:3072 lds
    s_waitcnt vmcnt(8)
    s_barrier
    s_add_u32 m0, s61, 114688
    s_add_u32 s59, s63, 425984
    buffer_load_dwordx4 v254, s[4:7], s59 offen lds
    buffer_load_dwordx4 v254, s[4:7], s59 offen offset:1024 lds
    buffer_load_dwordx4 v254, s[4:7], s59 offen offset:2048 lds
    buffer_load_dwordx4 v254, s[4:7], s59 offen offset:3072 lds
    s_add_u32 m0, s61, 118784
    s_add_u32 s60, s63, 430080
    buffer_load_dwordx4 v254, s[4:7], s60 offen lds
    buffer_load_dwordx4 v254, s[4:7], s60 offen offset:1024 lds
    buffer_load_dwordx4 v254, s[4:7], s60 offen offset:2048 lds
    buffer_load_dwordx4 v254, s[4:7], s60 offen offset:3072 lds
    s_waitcnt vmcnt(8)
    s_barrier
    s_add_u32 m0, s61, 131072
    s_add_u32 s59, s63, 442368
    buffer_load_dwordx4 v254, s[4:7], s59 offen lds
    buffer_load_dwordx4 v254, s[4:7], s59 offen offset:1024 lds
    buffer_load_dwordx4 v254, s[4:7], s59 offen offset:2048 lds
    buffer_load_dwordx4 v254, s[4:7], s59 offen offset:3072 lds
    s_add_u32 m0, s61, 135168
    s_add_u32 s60, s63, 446464
    buffer_load_dwordx4 v254, s[4:7], s60 offen lds
    buffer_load_dwordx4 v254, s[4:7], s60 offen offset:1024 lds
    buffer_load_dwordx4 v254, s[4:7], s60 offen offset:2048 lds
    buffer_load_dwordx4 v254, s[4:7], s60 offen offset:3072 lds
    s_waitcnt vmcnt(8)
    s_barrier
    s_waitcnt vmcnt(0)
    s_barrier
    s_barrier
    s_setprio 0
    s_cmp_lg_u32 s46, 0
    s_cbranch_scc1 K_end
    s_mov_b32 s46, 1
    s_add_u32 s47, s47, 262144
    s_add_u32 s49, s49, 524288
    s_add_u32 s50, s50, 917504
    s_add_u32 s52, s52, 65536
    s_add_u32 s54, s54, 32768
    s_add_u32 s0, s0, 32768
    s_branch YA_layer
YW_g4:
    s_setprio 1
    v_and_b32 v225, 0xf0, v254
    v_lshrrev_b32 v224, 8, v254
    v_and_b32 v226, 7, v224
    v_lshlrev_b32 v226, 5, v226
    v_xor_b32 v226, v225, v226
    v_mul_u32_u24 v224, 2048, v224
    v_add_u32 v217, v224, v226
    v_lshrrev_b32 v224, 8, v254
    v_add_u32 v224, 4, v224
    v_and_b32 v226, 7, v224
    v_lshlrev_b32 v226, 5, v226
    v_xor_b32 v226, v225, v226
    v_mul_u32_u24 v224, 2048, v224
    v_add_u32 v218, v224, v226
    v_subrev_u32 v218, 1024, v218
    v_lshrrev_b32 v224, 8, v254
    v_add_u32 v224, 8, v224
    v_and_b32 v226, 7, v224
    v_lshlrev_b32 v226, 5, v226
    v_xor_b32 v226, v225, v226
    v_mul_u32_u24 v224, 2048, v224
    v_add_u32 v219, v224, v226
    v_subrev_u32 v219, 2048, v219
    v_lshrrev_b32 v224, 8, v254
    v_add_u32 v224, 12, v224
    v_and_b32 v226, 7, v224
    v_lshlrev_b32 v226, 5, v226
    v_xor_b32 v226, v225, v226
    v_mul_u32_u24 v224, 2048, v224
    v_add_u32 v220, v224, v226
    v_subrev_u32 v220, 3072, v220
    s_lshl_b32 s67, s43, 13
    s_and_b32 s55, s51, 1
    s_mul_i32 s68, s55, 3670016
    s_lshr_b32 s55, s51, 1
    s_lshl_b32 s55, s55, 8
    s_add_u32 s68, s68, s55
    s_mul_i32 s55, s43, 196608
    s_add_u32 s69, s68, s55
    s_lshl_b32 s55, s43, 17
    s_add_u32 s68, s68, s55
    s_nop 7
    v_mul_f32 v96, v184, v0
    v_mul_f32 v97, v184, v1
    v_mul_f32 v98, v184, v2
    v_mul_f32 v99, v184, v3
    v_exp_f32 v96, v96
    v_exp_f32 v97, v97
    v_exp_f32 v98, v98
    v_exp_f32 v99, v99
    v_mul_f32 v0, v0, v48
    v_mul_f32 v1, v1, v49
    v_mul_f32 v2, v2, v50
    v_mul_f32 v3, v3, v51
    s_barrier
    s_add_u32 m0, s67, 32768
    s_add_u32 s59, s68, 2752512
    buffer_load_dwordx4 v217, s[20:23], s59 offen lds
    v_fma_f32 v96, v96, v188, v188
    v_fma_f32 v97, v97, v188, v188
    v_fma_f32 v98, v98, v188, v188
    buffer_load_dwordx4 v218, s[20:23], s59 offen offset:1024 lds
    v_fma_f32 v99, v99, v188, v188
    v_rcp_f32 v96, v96
    v_rcp_f32 v97, v97
    buffer_load_dwordx4 v219, s[20:23], s59 offen offset:2048 lds
    v_rcp_f32 v98, v98
    v_rcp_f32 v99, v99
    v_mul_f32 v0, v0, v96
    buffer_load_dwordx4 v220, s[20:23], s59 offen offset:3072 lds
    v_mul_f32 v1, v1, v97
    v_mul_f32 v2, v2, v98
    v_mul_f32 v3, v3, v99
    v_cvt_pk_bf16_f32 v100, v0, v1
    s_add_u32 m0, s67, 36864
    s_add_u32 s60, s68, 2785280
    buffer_load_dwordx4 v217, s[20:23], s60 offen lds
    v_cvt_pk_bf16_f32 v101, v2, v3
    v_mul_f32 v96, v184, v16
    v_mul_f32 v97, v184, v17
    buffer_load_dwordx4 v218, s[20:23], s60 offen offset:1024 lds
    v_mul_f32 v98, v184, v18
    v_mul_f32 v99, v184, v19
    v_exp_f32 v96, v96
    buffer_load_dwordx4 v219, s[20:23], s60 offen offset:2048 lds
    v_exp_f32 v97, v97
    v_exp_f32 v98, v98
    v_exp_f32 v99, v99
    buffer_load_dwordx4 v220, s[20:23], s60 offen offset:3072 lds
    v_mul_f32 v16, v16, v64
    v_mul_f32 v17, v17, v65
    v_mul_f32 v18, v18, v66
    v_mul_f32 v19, v19, v67
    s_barrier
    s_add_u32 m0, s67, 49152
    s_add_u32 s59, s68, 3407872
    buffer_load_dwordx4 v217, s[20:23], s59 offen lds
    v_fma_f32 v96, v96, v188, v188
    v_fma_f32 v97, v97, v188, v188
    buffer_load_dwordx4 v218, s[20:23], s59 offen offset:1024 lds
    v_fma_f32 v98, v98, v188, v188
    v_fma_f32 v99, v99, v188, v188
    v_rcp_f32 v96, v96
    buffer_load_dwordx4 v219, s[20:23], s59 offen offset:2048 lds
    v_rcp_f32 v97, v97
    v_rcp_f32 v98, v98
    v_rcp_f32 v99, v99
    buffer_load_dwordx4 v220, s[20:23], s59 offen offset:3072 lds
    v_mul_f32 v16, v16, v96
    v_mul_f32 v17, v17, v97
    v_mul_f32 v18, v18, v98
    s_add_u32 m0, s67, 53248
    s_add_u32 s60, s68, 3440640
    buffer_load_dwordx4 v217, s[20:23], s60 offen lds
    v_mul_f32 v19, v19, v99
    v_cvt_pk_bf16_f32 v102, v16, v17
    v_cvt_pk_bf16_f32 v103, v18, v19
    buffer_load_dwordx4 v218, s[20:23], s60 offen offset:1024 lds
    s_add_u32 s55, s64, 0
    buffer_store_dwordx4 v[100:103], v254, s[4:7], s55 offen sc0 sc1
    v_mul_f32 v96, v185, v4
    v_mul_f32 v97, v185, v5
    buffer_load_dwordx4 v219, s[20:23], s60 offen offset:2048 lds
    v_mul_f32 v98, v185, v6
    v_mul_f32 v99, v185, v7
    v_exp_f32 v96, v96
    buffer_load_dwordx4 v220, s[20:23], s60 offen offset:3072 lds
    v_exp_f32 v97, v97
    v_exp_f32 v98, v98
    v_exp_f32 v99, v99
    s_barrier
    s_add_u32 m0, s67, 65536
    s_add_u32 s59, s68, 65536
    buffer_load_dwordx4 v217, s[20:23], s59 offen lds
    v_mul_f32 v4, v4, v52
    v_mul_f32 v5, v5, v53
    v_mul_f32 v6, v6, v54
    buffer_load_dwordx4 v218, s[20:23], s59 offen offset:1024 lds
    v_mul_f32 v7, v7, v55
    v_fma_f32 v96, v96, v189, v189
    v_fma_f32 v97, v97, v189, v189
    buffer_load_dwordx4 v219, s[20:23], s59 offen offset:2048 lds
    v_fma_f32 v98, v98, v189, v189
    v_fma_f32 v99, v99, v189, v189
    v_rcp_f32 v96, v96
    buffer_load_dwordx4 v220, s[20:23], s59 offen offset:3072 lds
    v_rcp_f32 v97, v97
    v_rcp_f32 v98, v98
    v_rcp_f32 v99, v99
    v_mul_f32 v4, v4, v96
    s_add_u32 m0, s67, 69632
    s_add_u32 s60, s68, 98304
    buffer_load_dwordx4 v217, s[20:23], s60 offen lds
    v_mul_f32 v5, v5, v97
    v_mul_f32 v6, v6, v98
    v_mul_f32 v7, v7, v99
    buffer_load_dwordx4 v218, s[20:23], s60 offen offset:1024 lds
    v_cvt_pk_bf16_f32 v104, v4, v5
    v_cvt_pk_bf16_f32 v105, v6, v7
    v_mul_f32 v96, v185, v20
    buffer_load_dwordx4 v219, s[20:23], s60 offen offset:2048 lds
    v_mul_f32 v97, v185, v21
    v_mul_f32 v98, v185, v22
    v_mul_f32 v99, v185, v23
    buffer_load_dwordx4 v220, s[20:23], s60 offen offset:3072 lds
    v_exp_f32 v96, v96
    v_exp_f32 v97, v97
    v_exp_f32 v98, v98
    v_exp_f32 v99, v99
    s_barrier
    s_add_u32 m0, s67, 81920
    s_add_u32 s59, s68, 720896
    buffer_load_dwordx4 v217, s[20:23], s59 offen lds
    v_mul_f32 v20, v20, v68
    v_mul_f32 v21, v21, v69
    v_mul_f32 v22, v22, v70
    buffer_load_dwordx4 v218, s[20:23], s59 offen offset:1024 lds
    v_mul_f32 v23, v23, v71
    v_fma_f32 v96, v96, v189, v189
    v_fma_f32 v97, v97, v189, v189
    buffer_load_dwordx4 v219, s[20:23], s59 offen offset:2048 lds
    v_fma_f32 v98, v98, v189, v189
    v_fma_f32 v99, v99, v189, v189
    v_rcp_f32 v96, v96
    buffer_load_dwordx4 v220, s[20:23], s59 offen offset:3072 lds
    v_rcp_f32 v97, v97
    v_rcp_f32 v98, v98
    v_rcp_f32 v99, v99
    s_add_u32 m0, s67, 86016
    s_add_u32 s60, s68, 753664
    buffer_load_dwordx4 v217, s[20:23], s60 offen lds
    v_mul_f32 v20, v20, v96
    v_mul_f32 v21, v21, v97
    v_mul_f32 v22, v22, v98
    buffer_load_dwordx4 v218, s[20:23], s60 offen offset:1024 lds
    v_mul_f32 v23, v23, v99
    v_cvt_pk_bf16_f32 v106, v20, v21
    v_cvt_pk_bf16_f32 v107, v22, v23
    buffer_load_dwordx4 v219, s[20:23], s60 offen offset:2048 lds
    s_add_u32 s55, s64, 2048
    buffer_store_dwordx4 v[104:107], v254, s[4:7], s55 offen sc0 sc1
    v_mul_f32 v96, v186, v8
    v_mul_f32 v97, v186, v9
    buffer_load_dwordx4 v220, s[20:23], s60 offen offset:3072 lds
    v_mul_f32 v98, v186, v10
    v_mul_f32 v99, v186, v11
    v_exp_f32 v96, v96
    v_exp_f32 v97, v97
    s_barrier
    s_add_u32 m0, s67, 0
    s_add_u32 s59, s68, 983040
    buffer_load_dwordx4 v217, s[20:23], s59 offen lds
    v_exp_f32 v98, v98
    v_exp_f32 v99, v99
    v_mul_f32 v8, v8, v56
    buffer_load_dwordx4 v218, s[20:23], s59 offen offset:1024 lds
    v_mul_f32 v9, v9, v57
    v_mul_f32 v10, v10, v58
    v_mul_f32 v11, v11, v59
    buffer_load_dwordx4 v219, s[20:23], s59 offen offset:2048 lds
    v_fma_f32 v96, v96, v190, v190
    v_fma_f32 v97, v97, v190, v190
    v_fma_f32 v98, v98, v190, v190
    buffer_load_dwordx4 v220, s[20:23], s59 offen offset:3072 lds
    v_fma_f32 v99, v99, v190, v190
    v_rcp_f32 v96, v96
    v_rcp_f32 v97, v97
    v_rcp_f32 v98, v98
    s_add_u32 m0, s67, 4096
    s_add_u32 s60, s68, 1015808
    buffer_load_dwordx4 v217, s[20:23], s60 offen lds
    v_rcp_f32 v99, v99
    v_mul_f32 v8, v8, v96
    v_mul_f32 v9, v9, v97
    buffer_load_dwordx4 v218, s[20:23], s60 offen offset:1024 lds
    v_mul_f32 v10, v10, v98
    v_mul_f32 v11, v11, v99
    v_cvt_pk_bf16_f32 v100, v8, v9
    buffer_load_dwordx4 v219, s[20:23], s60 offen offset:2048 lds
    v_cvt_pk_bf16_f32 v101, v10, v11
    v_mul_f32 v96, v186, v24
    v_mul_f32 v97, v186, v25
    buffer_load_dwordx4 v220, s[20:23], s60 offen offset:3072 lds
    v_mul_f32 v98, v186, v26
    v_mul_f32 v99, v186, v27
    v_exp_f32 v96, v96
    v_exp_f32 v97, v97
    s_waitcnt vmcnt(34)
    s_barrier
    s_add_u32 m0, s67, 16384
    s_add_u32 s59, s68, 1638400
    buffer_load_dwordx4 v217, s[20:23], s59 offen lds
    v_exp_f32 v98, v98
    v_exp_f32 v99, v99
    v_mul_f32 v24, v24, v72
    buffer_load_dwordx4 v218, s[20:23], s59 offen offset:1024 lds
    v_mul_f32 v25, v25, v73
    v_mul_f32 v26, v26, v74
    v_mul_f32 v27, v27, v75
    buffer_load_dwordx4 v219, s[20:23], s59 offen offset:2048 lds
    v_fma_f32 v96, v96, v190, v190
    v_fma_f32 v97, v97, v190, v190
    v_fma_f32 v98, v98, v190, v190
    buffer_load_dwordx4 v220, s[20:23], s59 offen offset:3072 lds
    v_fma_f32 v99, v99, v190, v190
    v_rcp_f32 v96, v96
    v_rcp_f32 v97, v97
    s_add_u32 m0, s67, 20480
    s_add_u32 s60, s68, 1671168
    buffer_load_dwordx4 v217, s[20:23], s60 offen lds
    v_rcp_f32 v98, v98
    v_rcp_f32 v99, v99
    v_mul_f32 v24, v24, v96
    buffer_load_dwordx4 v218, s[20:23], s60 offen offset:1024 lds
    v_mul_f32 v25, v25, v97
    v_mul_f32 v26, v26, v98
    v_mul_f32 v27, v27, v99
    buffer_load_dwordx4 v219, s[20:23], s60 offen offset:2048 lds
    v_cvt_pk_bf16_f32 v102, v24, v25
    v_cvt_pk_bf16_f32 v103, v26, v27
    s_add_u32 s55, s64, 4096
    buffer_store_dwordx4 v[100:103], v254, s[4:7], s55 offen sc0 sc1
    buffer_load_dwordx4 v220, s[20:23], s60 offen offset:3072 lds
    v_mul_f32 v96, v187, v12
    v_mul_f32 v97, v187, v13
    v_mul_f32 v98, v187, v14
    v_mul_f32 v99, v187, v15
    s_waitcnt vmcnt(34)
    s_barrier
    s_add_u32 m0, s67, 32768
    s_add_u32 s59, s68, 1900544
    buffer_load_dwordx4 v217, s[20:23], s59 offen lds
    v_exp_f32 v96, v96
    v_exp_f32 v97, v97
    v_exp_f32 v98, v98
    buffer_load_dwordx4 v218, s[20:23], s59 offen offset:1024 lds
    v_exp_f32 v99, v99
    v_mul_f32 v12, v12, v60
    v_mul_f32 v13, v13, v61
    buffer_load_dwordx4 v219, s[20:23], s59 offen offset:2048 lds
    v_mul_f32 v14, v14, v62
    v_mul_f32 v15, v15, v63
    v_fma_f32 v96, v96, v191, v191
    buffer_load_dwordx4 v220, s[20:23], s59 offen offset:3072 lds
    v_fma_f32 v97, v97, v191, v191
    v_fma_f32 v98, v98, v191, v191
    v_fma_f32 v99, v99, v191, v191
    v_rcp_f32 v96, v96
    s_add_u32 m0, s67, 36864
    s_add_u32 s60, s68, 1933312
    buffer_load_dwordx4 v217, s[20:23], s60 offen lds
    v_rcp_f32 v97, v97
    v_rcp_f32 v98, v98
    v_rcp_f32 v99, v99
    buffer_load_dwordx4 v218, s[20:23], s60 offen offset:1024 lds
    v_mul_f32 v12, v12, v96
    v_mul_f32 v13, v13, v97
    v_mul_f32 v14, v14, v98
    buffer_load_dwordx4 v219, s[20:23], s60 offen offset:2048 lds
    v_mul_f32 v15, v15, v99
    v_cvt_pk_bf16_f32 v104, v12, v13
    v_cvt_pk_bf16_f32 v105, v14, v15
    buffer_load_dwordx4 v220, s[20:23], s60 offen offset:3072 lds
    v_mul_f32 v96, v187, v28
    v_mul_f32 v97, v187, v29
    v_mul_f32 v98, v187, v30
    v_mul_f32 v99, v187, v31
    s_waitcnt vmcnt(34)
    s_barrier
    s_add_u32 m0, s67, 49152
    s_add_u32 s59, s68, 2555904
    buffer_load_dwordx4 v217, s[20:23], s59 offen lds
    v_exp_f32 v96, v96
    v_exp_f32 v97, v97
    buffer_load_dwordx4 v218, s[20:23], s59 offen offset:1024 lds
    v_exp_f32 v98, v98
    v_exp_f32 v99, v99
    v_mul_f32 v28, v28, v76
    buffer_load_dwordx4 v219, s[20:23], s59 offen offset:2048 lds
    v_mul_f32 v29, v29, v77
    v_mul_f32 v30, v30, v78
    v_mul_f32 v31, v31, v79
    buffer_load_dwordx4 v220, s[20:23], s59 offen offset:3072 lds
    v_fma_f32 v96, v96, v191, v191
    v_fma_f32 v97, v97, v191, v191
    v_fma_f32 v98, v98, v191, v191
    s_add_u32 m0, s67, 53248
    s_add_u32 s60, s68, 2588672
    buffer_load_dwordx4 v217, s[20:23], s60 offen lds
    v_fma_f32 v99, v99, v191, v191
    v_rcp_f32 v96, v96
    v_rcp_f32 v97, v97
    buffer_load_dwordx4 v218, s[20:23], s60 offen offset:1024 lds
    v_rcp_f32 v98, v98
    v_rcp_f32 v99, v99
    v_mul_f32 v28, v28, v96
    buffer_load_dwordx4 v219, s[20:23], s60 offen offset:2048 lds
    v_mul_f32 v29, v29, v97
    v_mul_f32 v30, v30, v98
    v_mul_f32 v31, v31, v99
    buffer_load_dwordx4 v220, s[20:23], s60 offen offset:3072 lds
    v_cvt_pk_bf16_f32 v106, v28, v29
    v_cvt_pk_bf16_f32 v107, v30, v31
    s_add_u32 s55, s64, 6144
    buffer_store_dwordx4 v[104:107], v254, s[4:7], s55 offen sc0 sc1
    s_waitcnt vmcnt(34)
    s_barrier
    s_add_u32 m0, s67, 65536
    s_add_u32 s59, s68, 2818048
    buffer_load_dwordx4 v217, s[20:23], s59 offen lds
    v_lshrrev_b32 v120, 1, v254
    s_lshl_b32 s55, s43, 11
    s_add_u32 s55, s55, 157632
    v_add_u32 v120, s55, v120
    buffer_load_dwordx4 v218, s[20:23], s59 offen offset:1024 lds
    v_mul_f32 v96, v184, v32
    v_mul_f32 v97, v184, v33
    v_mul_f32 v98, v184, v34
    buffer_load_dwordx4 v219, s[20:23], s59 offen offset:2048 lds
    v_mul_f32 v99, v184, v35
    v_exp_f32 v96, v96
    buffer_load_dwordx4 v220, s[20:23], s59 offen offset:3072 lds
    v_exp_f32 v97, v97
    v_exp_f32 v98, v98
    v_exp_f32 v99, v99
    s_add_u32 m0, s67, 69632
    s_add_u32 s60, s68, 2850816
    buffer_load_dwordx4 v217, s[20:23], s60 offen lds
    v_mul_f32 v32, v32, v80
    v_mul_f32 v33, v33, v81
    v_mul_f32 v34, v34, v82
    buffer_load_dwordx4 v218, s[20:23], s60 offen offset:1024 lds
    v_mul_f32 v35, v35, v83
    v_fma_f32 v96, v96, v188, v188
    buffer_load_dwordx4 v219, s[20:23], s60 offen offset:2048 lds
    v_fma_f32 v97, v97, v188, v188
    v_fma_f32 v98, v98, v188, v188
    v_fma_f32 v99, v99, v188, v188
    buffer_load_dwordx4 v220, s[20:23], s60 offen offset:3072 lds
    v_rcp_f32 v96, v96
    v_rcp_f32 v97, v97
    v_rcp_f32 v98, v98
    s_waitcnt vmcnt(34)
    s_barrier
    s_add_u32 m0, s67, 81920
    s_add_u32 s59, s68, 3473408
    buffer_load_dwordx4 v217, s[20:23], s59 offen lds
    v_rcp_f32 v99, v99
    v_mul_f32 v32, v32, v96
    v_mul_f32 v33, v33, v97
    buffer_load_dwordx4 v218, s[20:23], s59 offen offset:1024 lds
    v_mul_f32 v34, v34, v98
    v_mul_f32 v35, v35, v99
    v_cvt_pk_bf16_f32 v108, v32, v33
    buffer_load_dwordx4 v219, s[20:23], s59 offen offset:2048 lds
    v_cvt_pk_bf16_f32 v109, v34, v35
    ds_write_b64 v120, v[108:109] offset:0
    v_mul_f32 v96, v185, v36
    buffer_load_dwordx4 v220, s[20:23], s59 offen offset:3072 lds
    v_mul_f32 v97, v185, v37
    v_mul_f32 v98, v185, v38
    v_mul_f32 v99, v185, v39
    v_exp_f32 v96, v96
    s_add_u32 m0, s67, 86016
    s_add_u32 s60, s68, 3506176
    buffer_load_dwordx4 v217, s[20:23], s60 offen lds
    v_exp_f32 v97, v97
    v_exp_f32 v98, v98
    v_exp_f32 v99, v99
    buffer_load_dwordx4 v218, s[20:23], s60 offen offset:1024 lds
    v_mul_f32 v36, v36, v84
    v_mul_f32 v37, v37, v85
    v_mul_f32 v38, v38, v86
    buffer_load_dwordx4 v219, s[20:23], s60 offen offset:2048 lds
    v_mul_f32 v39, v39, v87
    v_fma_f32 v96, v96, v189, v189
    v_fma_f32 v97, v97, v189, v189
    buffer_load_dwordx4 v220, s[20:23], s60 offen offset:3072 lds
    v_fma_f32 v98, v98, v189, v189
    v_fma_f32 v99, v99, v189, v189
    v_rcp_f32 v96, v96
    v_rcp_f32 v97, v97
    s_waitcnt vmcnt(33)
    s_barrier
    s_add_u32 m0, s67, 0
    s_add_u32 s59, s68, 262144
    buffer_load_dwordx4 v217, s[20:23], s59 offen lds
    v_rcp_f32 v98, v98
    v_rcp_f32 v99, v99
    v_mul_f32 v36, v36, v96
    buffer_load_dwordx4 v218, s[20:23], s59 offen offset:1024 lds
    v_mul_f32 v37, v37, v97
    v_mul_f32 v38, v38, v98
    v_mul_f32 v39, v39, v99
    buffer_load_dwordx4 v219, s[20:23], s59 offen offset:2048 lds
    v_cvt_pk_bf16_f32 v110, v36, v37
    v_cvt_pk_bf16_f32 v111, v38, v39
    ds_write_b64 v120, v[110:111] offset:512
    buffer_load_dwordx4 v220, s[20:23], s59 offen offset:3072 lds
    s_waitcnt lgkmcnt(0)
    v_mul_f32 v96, v186, v40
    v_mul_f32 v97, v186, v41
    s_add_u32 m0, s67, 4096
    s_add_u32 s60, s68, 294912
    buffer_load_dwordx4 v217, s[20:23], s60 offen lds
    v_mul_f32 v98, v186, v42
    v_mul_f32 v99, v186, v43
    v_exp_f32 v96, v96
    buffer_load_dwordx4 v218, s[20:23], s60 offen offset:1024 lds
    v_exp_f32 v97, v97
    v_exp_f32 v98, v98
    v_exp_f32 v99, v99
    buffer_load_dwordx4 v219, s[20:23], s60 offen offset:2048 lds
    v_mul_f32 v40, v40, v88
    v_mul_f32 v41, v41, v89
    v_mul_f32 v42, v42, v90
    buffer_load_dwordx4 v220, s[20:23], s60 offen offset:3072 lds
    v_mul_f32 v43, v43, v91
    v_fma_f32 v96, v96, v190, v190
    v_fma_f32 v97, v97, v190, v190
    v_fma_f32 v98, v98, v190, v190
    s_waitcnt vmcnt(24)
    s_barrier
    s_and_b32 s55, s41, 7
    s_lshl_b32 s55, s55, 2
    s_add_u32 s55, s55, s42
    s_add_u32 s55, s55, s0
    s_add_u32 s55, s55, 2112
    v_mov_b32 v252, 0
    v_mov_b32 v253, 1
    s_mov_b64 exec, 1
    s_cmp_eq_u32 s45, 0
    s_cbranch_scc1 st_104
    buffer_store_byte v253, v252, s[4:7], s55 offen sc0 sc1
    s_branch st_105
st_104:
    buffer_store_byte v253, v252, s[4:7], s55 offen
st_105:
    s_mov_b64 exec, -1
    s_add_u32 m0, s67, 16384
    s_add_u32 s59, s68, 458752
    buffer_load_dwordx4 v217, s[20:23], s59 offen lds
    v_fma_f32 v99, v99, v190, v190
    v_rcp_f32 v96, v96
    v_rcp_f32 v97, v97
    buffer_load_dwordx4 v218, s[20:23], s59 offen offset:1024 lds
    v_rcp_f32 v98, v98
    v_rcp_f32 v99, v99
    v_mul_f32 v40, v40, v96
    buffer_load_dwordx4 v219, s[20:23], s59 offen offset:2048 lds
    v_mul_f32 v41, v41, v97
    v_mul_f32 v42, v42, v98
    v_mul_f32 v43, v43, v99
    buffer_load_dwordx4 v220, s[20:23], s59 offen offset:3072 lds
    v_cvt_pk_bf16_f32 v114, v40, v41
    v_cvt_pk_bf16_f32 v115, v42, v43
    v_mul_f32 v96, v187, v44
    v_mul_f32 v97, v187, v45
    s_add_u32 m0, s67, 20480
    s_add_u32 s60, s68, 491520
    buffer_load_dwordx4 v217, s[20:23], s60 offen lds
    v_mul_f32 v98, v187, v46
    v_mul_f32 v99, v187, v47
    v_exp_f32 v96, v96
    buffer_load_dwordx4 v218, s[20:23], s60 offen offset:1024 lds
    v_exp_f32 v97, v97
    v_exp_f32 v98, v98
    v_exp_f32 v99, v99
    buffer_load_dwordx4 v219, s[20:23], s60 offen offset:2048 lds
    v_mul_f32 v44, v44, v92
    v_mul_f32 v45, v45, v93
    v_mul_f32 v46, v46, v94
    buffer_load_dwordx4 v220, s[20:23], s60 offen offset:3072 lds
    v_mul_f32 v47, v47, v95
    v_fma_f32 v96, v96, v191, v191
    v_fma_f32 v97, v97, v191, v191
    v_fma_f32 v98, v98, v191, v191
    s_barrier
    s_add_u32 m0, s67, 32768
    s_add_u32 s59, s68, 1179648
    buffer_load_dwordx4 v217, s[20:23], s59 offen lds
    v_fma_f32 v99, v99, v191, v191
    buffer_load_dwordx4 v218, s[20:23], s59 offen offset:1024 lds
    v_rcp_f32 v96, v96
    buffer_load_dwordx4 v219, s[20:23], s59 offen offset:2048 lds
    v_rcp_f32 v97, v97
    v_rcp_f32 v98, v98
    buffer_load_dwordx4 v220, s[20:23], s59 offen offset:3072 lds
    v_rcp_f32 v99, v99
    s_add_u32 m0, s67, 36864
    s_add_u32 s60, s68, 1212416
    buffer_load_dwordx4 v217, s[20:23], s60 offen lds
    v_mul_f32 v44, v44, v96
    buffer_load_dwordx4 v218, s[20:23], s60 offen offset:1024 lds
    v_mul_f32 v45, v45, v97
    v_mul_f32 v46, v46, v98
    buffer_load_dwordx4 v219, s[20:23], s60 offen offset:2048 lds
    v_mul_f32 v47, v47, v99
    buffer_load_dwordx4 v220, s[20:23], s60 offen offset:3072 lds
    v_cvt_pk_bf16_f32 v118, v44, v45
    v_cvt_pk_bf16_f32 v119, v46, v47
    s_waitcnt vmcnt(33)
    s_barrier
    s_add_u32 m0, s67, 49152
    s_add_u32 s59, s68, 1376256
    buffer_load_dwordx4 v217, s[20:23], s59 offen lds
    ds_read_b64 v[112:113], v120 offset:1024
    ds_read_b64 v[116:117], v120 offset:1536
    buffer_load_dwordx4 v218, s[20:23], s59 offen offset:1024 lds
    s_waitcnt lgkmcnt(0)
    s_add_u32 s55, s65, 4096
    buffer_store_dwordx4 v[112:115], v254, s[4:7], s55 offen sc0 sc1
    buffer_load_dwordx4 v219, s[20:23], s59 offen offset:2048 lds
    s_add_u32 s55, s65, 6144
    buffer_store_dwordx4 v[116:119], v254, s[4:7], s55 offen sc0 sc1
    v_lshrrev_b32 v224, 7, v254
    buffer_load_dwordx4 v220, s[20:23], s59 offen offset:3072 lds
    v_and_b32 v225, 0x70, v254
    v_and_b32 v226, 6, v224
    s_add_u32 m0, s67, 53248
    s_add_u32 s60, s68, 1409024
    buffer_load_dwordx4 v217, s[20:23], s60 offen lds
    v_lshlrev_b32 v226, 4, v226
    v_xor_b32 v225, v225, v226
    buffer_load_dwordx4 v218, s[20:23], s60 offen offset:1024 lds
    v_mul_u32_u24 v224, 6144, v224
    v_add_u32 v224, v224, v225
    buffer_load_dwordx4 v219, s[20:23], s60 offen offset:2048 lds
    s_cmp_eq_u32 s43, 0
    s_mov_b32 s55, 4096
    s_cselect_b32 s55, s55, 104448
    v_add_u32 v200, s55, v224
    v_subrev_u32 v200, 4096, v200
    buffer_load_dwordx4 v220, s[20:23], s60 offen offset:3072 lds
    s_cmp_eq_u32 s43, 0
    s_mov_b32 s55, 52224
    s_cselect_b32 s55, s55, 152576
    v_add_u32 v201, s55, v224
    v_subrev_u32 v201, 4096, v201
    s_cmp_eq_u32 s43, 0
    s_mov_b32 s55, 100352
    s_cselect_b32 s55, s55, 6144
    v_add_u32 v202, s55, v224
    s_waitcnt vmcnt(35)
    s_barrier
    s_add_u32 m0, s67, 65536
    s_add_u32 s59, s68, 2097152
    buffer_load_dwordx4 v217, s[20:23], s59 offen lds
    v_subrev_u32 v202, 4096, v202
    buffer_load_dwordx4 v218, s[20:23], s59 offen offset:1024 lds
    s_cmp_eq_u32 s43, 0
    s_mov_b32 s55, 151552
    s_cselect_b32 s55, s55, 57344
    v_add_u32 v203, s55, v224
    buffer_load_dwordx4 v219, s[20:23], s59 offen offset:2048 lds
    v_subrev_u32 v203, 4096, v203
    buffer_load_dwordx4 v220, s[20:23], s59 offen offset:3072 lds
    s_cmp_eq_u32 s43, 0
    s_mov_b32 s55, 5120
    s_cselect_b32 s55, s55, 105472
    v_add_u32 v204, s55, v224
    v_subrev_u32 v204, 4096, v204
    s_add_u32 m0, s67, 69632
    s_add_u32 s60, s68, 2129920
    buffer_load_dwordx4 v217, s[20:23], s60 offen lds
    s_cmp_eq_u32 s43, 0
    s_mov_b32 s55, 53248
    s_cselect_b32 s55, s55, 153600
    v_add_u32 v205, s55, v224
    buffer_load_dwordx4 v218, s[20:23], s60 offen offset:1024 lds
    v_subrev_u32 v205, 4096, v205
    buffer_load_dwordx4 v219, s[20:23], s60 offen offset:2048 lds
    s_mul_i32 s61, s43, 6144
    buffer_load_dwordx4 v220, s[20:23], s60 offen offset:3072 lds
    s_lshl_b32 s62, s51, 7
    s_cmp_eq_u32 s46, 0
    s_cselect_b32 s62, s62, 2130706432
    s_waitcnt vmcnt(35)
    s_barrier
    s_add_u32 m0, s67, 81920
    s_add_u32 s59, s68, 2293760
    buffer_load_dwordx4 v217, s[20:23], s59 offen lds
    buffer_load_dwordx4 v218, s[20:23], s59 offen offset:1024 lds
    buffer_load_dwordx4 v219, s[20:23], s59 offen offset:2048 lds
    buffer_load_dwordx4 v220, s[20:23], s59 offen offset:3072 lds
    s_add_u32 m0, s67, 86016
    s_add_u32 s60, s68, 2326528
    buffer_load_dwordx4 v217, s[20:23], s60 offen lds
    buffer_load_dwordx4 v218, s[20:23], s60 offen offset:1024 lds
    buffer_load_dwordx4 v219, s[20:23], s60 offen offset:2048 lds
    buffer_load_dwordx4 v220, s[20:23], s60 offen offset:3072 lds
    s_waitcnt vmcnt(21)
    s_barrier
    s_and_b32 s55, s41, 7
    s_lshl_b32 s55, s55, 2
    s_add_u32 s55, s55, s42
    s_add_u32 s55, s55, s0
    s_add_u32 s55, s55, 2144
    v_mov_b32 v252, 0
    v_mov_b32 v253, 1
    s_mov_b64 exec, 1
    s_cmp_eq_u32 s45, 0
    s_cbranch_scc1 st_106
    buffer_store_byte v253, v252, s[4:7], s55 offen sc0 sc1
    s_branch st_107
st_106:
    buffer_store_byte v253, v252, s[4:7], s55 offen
st_107:
    s_mov_b64 exec, -1
    s_add_u32 m0, s67, 0
    s_add_u32 s59, s68, 3014656
    buffer_load_dwordx4 v217, s[20:23], s59 offen lds
    buffer_load_dwordx4 v218, s[20:23], s59 offen offset:1024 lds
    buffer_load_dwordx4 v219, s[20:23], s59 offen offset:2048 lds
    buffer_load_dwordx4 v220, s[20:23], s59 offen offset:3072 lds
    s_add_u32 m0, s67, 4096
    s_add_u32 s60, s68, 3047424
    buffer_load_dwordx4 v217, s[20:23], s60 offen lds
    buffer_load_dwordx4 v218, s[20:23], s60 offen offset:1024 lds
    buffer_load_dwordx4 v219, s[20:23], s60 offen offset:2048 lds
    buffer_load_dwordx4 v220, s[20:23], s60 offen offset:3072 lds
    s_barrier
    s_add_u32 m0, s67, 16384
    s_add_u32 s59, s68, 3211264
    buffer_load_dwordx4 v217, s[20:23], s59 offen lds
    buffer_load_dwordx4 v218, s[20:23], s59 offen offset:1024 lds
    buffer_load_dwordx4 v219, s[20:23], s59 offen offset:2048 lds
    buffer_load_dwordx4 v220, s[20:23], s59 offen offset:3072 lds
    s_add_u32 m0, s67, 20480
    s_add_u32 s60, s68, 3244032
    buffer_load_dwordx4 v217, s[20:23], s60 offen lds
    buffer_load_dwordx4 v218, s[20:23], s60 offen offset:1024 lds
    buffer_load_dwordx4 v219, s[20:23], s60 offen offset:2048 lds
    buffer_load_dwordx4 v220, s[20:23], s60 offen offset:3072 lds
    s_waitcnt vmcnt(33)
    s_barrier
    s_add_u32 m0, s67, 32768
    s_add_u32 s59, s69, 327680
    buffer_load_dwordx4 v217, s[20:23], s59 offen lds
    buffer_load_dwordx4 v218, s[20:23], s59 offen offset:1024 lds
    buffer_load_dwordx4 v219, s[20:23], s59 offen offset:2048 lds
    buffer_load_dwordx4 v220, s[20:23], s59 offen offset:3072 lds
    s_add_u32 m0, s67, 36864
    s_add_u32 s60, s69, 360448
    buffer_load_dwordx4 v217, s[20:23], s60 offen lds
    buffer_load_dwordx4 v218, s[20:23], s60 offen offset:1024 lds
    buffer_load_dwordx4 v219, s[20:23], s60 offen offset:2048 lds
    buffer_load_dwordx4 v220, s[20:23], s60 offen offset:3072 lds
    s_waitcnt vmcnt(33)
    s_barrier
    s_add_u32 m0, s67, 49152
    s_add_u32 s59, s69, 1245184
    buffer_load_dwordx4 v217, s[20:23], s59 offen lds
    buffer_load_dwordx4 v218, s[20:23], s59 offen offset:1024 lds
    buffer_load_dwordx4 v219, s[20:23], s59 offen offset:2048 lds
    buffer_load_dwordx4 v220, s[20:23], s59 offen offset:3072 lds
    s_add_u32 m0, s67, 53248
    s_add_u32 s60, s69, 1277952
    buffer_load_dwordx4 v217, s[20:23], s60 offen lds
    buffer_load_dwordx4 v218, s[20:23], s60 offen offset:1024 lds
    buffer_load_dwordx4 v219, s[20:23], s60 offen offset:2048 lds
    buffer_load_dwordx4 v220, s[20:23], s60 offen offset:3072 lds
    s_waitcnt vmcnt(33)
    s_barrier
    s_add_u32 m0, s67, 65536
    s_add_u32 s59, s69, 2162688
    buffer_load_dwordx4 v217, s[20:23], s59 offen lds
    buffer_load_dwordx4 v218, s[20:23], s59 offen offset:1024 lds
    buffer_load_dwordx4 v219, s[20:23], s59 offen offset:2048 lds
    buffer_load_dwordx4 v220, s[20:23], s59 offen offset:3072 lds
    s_add_u32 m0, s67, 69632
    s_add_u32 s60, s69, 2195456
    buffer_load_dwordx4 v217, s[20:23], s60 offen lds
    buffer_load_dwordx4 v218, s[20:23], s60 offen offset:1024 lds
    buffer_load_dwordx4 v219, s[20:23], s60 offen offset:2048 lds
    buffer_load_dwordx4 v220, s[20:23], s60 offen offset:3072 lds
    s_waitcnt vmcnt(32)
    s_barrier
    s_add_u32 m0, s67, 81920
    s_add_u32 s59, s69, 3080192
    buffer_load_dwordx4 v217, s[20:23], s59 offen lds
    buffer_load_dwordx4 v218, s[20:23], s59 offen offset:1024 lds
    buffer_load_dwordx4 v219, s[20:23], s59 offen offset:2048 lds
    buffer_load_dwordx4 v220, s[20:23], s59 offen offset:3072 lds
    s_add_u32 m0, s67, 86016
    s_add_u32 s60, s69, 3112960
    buffer_load_dwordx4 v217, s[20:23], s60 offen lds
    buffer_load_dwordx4 v218, s[20:23], s60 offen offset:1024 lds
    buffer_load_dwordx4 v219, s[20:23], s60 offen offset:2048 lds
    buffer_load_dwordx4 v220, s[20:23], s60 offen offset:3072 lds
    s_waitcnt vmcnt(32)
    s_barrier
    s_lshl_b32 s94, s51, 1
    s_mul_i32 s59, s94, 196608
    s_add_u32 m0, s61, 0
    s_add_u32 s59, s59, s62
    buffer_load_dwordx4 v200, s[8:11], s59 offen lds
    buffer_load_dwordx4 v201, s[8:11], s59 offen offset:1024 lds
    s_add_u32 s94, s94, 1
    s_and_b32 s94, s94, 31
    buffer_load_dwordx4 v202, s[8:11], s59 offen offset:2048 lds
    s_add_u32 m0, s61, 3072
    s_add_u32 s60, s59, 0
    buffer_load_dwordx4 v203, s[8:11], s60 offen lds
    buffer_load_dwordx4 v204, s[8:11], s60 offen offset:1024 lds
    buffer_load_dwordx4 v205, s[8:11], s60 offen offset:2048 lds
    s_waitcnt vmcnt(30)
    s_barrier
    s_mul_i32 s59, s94, 196608
    s_add_u32 m0, s61, 16384
    s_add_u32 s59, s59, s62
    buffer_load_dwordx4 v200, s[8:11], s59 offen lds
    buffer_load_dwordx4 v201, s[8:11], s59 offen offset:1024 lds
    s_add_u32 s94, s94, 3
    s_and_b32 s94, s94, 31
    buffer_load_dwordx4 v202, s[8:11], s59 offen offset:2048 lds
    s_add_u32 m0, s61, 19456
    s_add_u32 s60, s59, 0
    buffer_load_dwordx4 v203, s[8:11], s60 offen lds
    buffer_load_dwordx4 v204, s[8:11], s60 offen offset:1024 lds
    buffer_load_dwordx4 v205, s[8:11], s60 offen offset:2048 lds
    s_waitcnt vmcnt(28)
    s_barrier
    s_mul_i32 s59, s94, 196608
    s_add_u32 m0, s61, 32768
    s_add_u32 s59, s59, s62
    buffer_load_dwordx4 v200, s[8:11], s59 offen lds
    buffer_load_dwordx4 v201, s[8:11], s59 offen offset:1024 lds
    s_add_u32 s94, s94, 1
    s_and_b32 s94, s94, 31
    buffer_load_dwordx4 v202, s[8:11], s59 offen offset:2048 lds
    s_add_u32 m0, s61, 35840
    s_add_u32 s60, s59, 0
    buffer_load_dwordx4 v203, s[8:11], s60 offen lds
    buffer_load_dwordx4 v204, s[8:11], s60 offen offset:1024 lds
    buffer_load_dwordx4 v205, s[8:11], s60 offen offset:2048 lds
    s_waitcnt vmcnt(26)
    s_barrier
    s_mul_i32 s59, s94, 196608
    s_add_u32 m0, s61, 49152
    s_add_u32 s59, s59, s62
    buffer_load_dwordx4 v200, s[8:11], s59 offen lds
    buffer_load_dwordx4 v201, s[8:11], s59 offen offset:1024 lds
    s_add_u32 s94, s94, 3
    s_and_b32 s94, s94, 31
    buffer_load_dwordx4 v202, s[8:11], s59 offen offset:2048 lds
    s_add_u32 m0, s61, 52224
    s_add_u32 s60, s59, 0
    buffer_load_dwordx4 v203, s[8:11], s60 offen lds
    buffer_load_dwordx4 v204, s[8:11], s60 offen offset:1024 lds
    buffer_load_dwordx4 v205, s[8:11], s60 offen offset:2048 lds
    s_waitcnt vmcnt(24)
    s_barrier
    s_mul_i32 s59, s94, 196608
    s_add_u32 m0, s61, 65536
    s_add_u32 s59, s59, s62
    buffer_load_dwordx4 v200, s[8:11], s59 offen lds
    buffer_load_dwordx4 v201, s[8:11], s59 offen offset:1024 lds
    s_add_u32 s94, s94, 1
    s_and_b32 s94, s94, 31
    buffer_load_dwordx4 v202, s[8:11], s59 offen offset:2048 lds
    s_add_u32 m0, s61, 68608
    s_add_u32 s60, s59, 0
    buffer_load_dwordx4 v203, s[8:11], s60 offen lds
    buffer_load_dwordx4 v204, s[8:11], s60 offen offset:1024 lds
    buffer_load_dwordx4 v205, s[8:11], s60 offen offset:2048 lds
    s_barrier
    s_mul_i32 s59, s94, 196608
    s_add_u32 m0, s61, 81920
    s_add_u32 s59, s59, s62
    buffer_load_dwordx4 v200, s[8:11], s59 offen lds
    buffer_load_dwordx4 v201, s[8:11], s59 offen offset:1024 lds
    s_add_u32 s94, s94, 3
    s_and_b32 s94, s94, 31
    buffer_load_dwordx4 v202, s[8:11], s59 offen offset:2048 lds
    s_add_u32 m0, s61, 84992
    s_add_u32 s60, s59, 0
    buffer_load_dwordx4 v203, s[8:11], s60 offen lds
    buffer_load_dwordx4 v204, s[8:11], s60 offen offset:1024 lds
    buffer_load_dwordx4 v205, s[8:11], s60 offen offset:2048 lds
    s_setprio 0
    s_cmp_lg_u32 s46, 0
    s_cbranch_scc1 K_end
    s_mov_b32 s46, 1
    s_add_u32 s47, s47, 262144
    s_add_u32 s49, s49, 524288
    s_add_u32 s50, s50, 917504
    s_add_u32 s52, s52, 65536
    s_add_u32 s54, s54, 32768
    s_add_u32 s0, s0, 32768
    s_branch YW_layer
K_end:
    s_endpgm
.section .rodata,"a"
.p2align 6
.amdhsa_kernel interleave_layers__sliding_local_dilated__glu_gated_swiglu__prompt_kernel
  .amdhsa_next_free_vgpr 256
  .amdhsa_next_free_sgpr 102
  .amdhsa_accum_offset 256
  .amdhsa_group_segment_fixed_size 0
  .amdhsa_kernarg_size 80
  .amdhsa_user_sgpr_count 2
  .amdhsa_user_sgpr_kernarg_segment_ptr 1
  .amdhsa_system_sgpr_workgroup_id_x 1
.end_amdhsa_kernel
```

```asm
; @launch grid=(256,1,1) block=(512,1,1) lds=163840
.amdgcn_target "amdgcn-amd-amdhsa--gfx950"
.text
.globl interleave_layers__sliding_local_dilated__glu_gated_swiglu__prompt_kernel
.p2align 8
.type interleave_layers__sliding_local_dilated__glu_gated_swiglu__prompt_kernel,@function
interleave_layers__sliding_local_dilated__glu_gated_swiglu__prompt_kernel:
    s_cmp_ge_u32 s2, 256
    s_cbranch_scc0 K_go
    s_endpgm
K_go:
    s_load_dwordx4 s[72:75], s[0:1], 0
    s_load_dwordx2 s[76:77], s[0:1], 16
    s_load_dwordx8 s[80:87], s[0:1], 32
    s_load_dwordx4 s[88:91], s[0:1], 64
    v_lshrrev_b32 v1, 6, v0
    v_and_b32 v254, 63, v0
    v_readfirstlane_b32 s3, v1
    v_lshlrev_b32 v254, 4, v254
    s_and_b32 s55, s2, 6
    s_lshl_b32 s55, s55, 1
    s_lshr_b32 s56, s2, 3
    s_and_b32 s56, s56, 3
    s_add_u32 s40, s55, s56
    s_and_b32 s55, s2, 1
    s_lshr_b32 s56, s2, 5
    s_lshl_b32 s41, s55, 3
    s_add_u32 s41, s41, s56
    s_lshl_b32 s51, s56, 1
    s_add_u32 s51, s51, s55
    s_and_b32 s42, s3, 3
    s_and_b32 s43, s3, 1
    s_lshr_b32 s44, s42, 1
    s_lshl_b32 s55, s43, 1
    s_add_u32 s55, s55, s44
    s_mul_i32 s61, s55, 3072
    s_lshl_b32 s62, s55, 12
    s_mov_b32 s45, 1
    s_mov_b32 s46, 0
    s_lshl_b32 s47, s40, 22
    s_add_u32 s49, s47, 524288
    s_add_u32 s48, s47, 786432
    s_add_u32 s50, s47, 2097152
    s_add_u32 s52, s47, 1835008
    s_add_u32 s53, s52, 32768
    s_lshl_b32 s54, s40, 7
    s_add_u32 s54, s54, 71303168
    s_lshl_b32 s63, s51, 7
    s_lshl_b32 s55, s44, 16
    s_add_u32 s64, s63, s55
    s_mul_i32 s55, s44, 114688
    s_mul_i32 s56, s41, 448
    s_add_u32 s55, s55, s56
    s_and_b32 s56, s41, 1
    s_mul_i32 s56, s56, 192
    s_add_u32 s65, s55, s56
    s_sub_u32 s66, s55, s56
    s_add_u32 s66, s66, 256
    s_lshl_b32 s55, s43, 4
    s_add_u32 s55, s55, s41
    s_lshl_b32 s55, s55, 6
    s_add_u32 s55, s55, s44
    s_lshl_b32 s55, s55, 10
    s_add_u32 s67, s55, 67106816
    s_and_b32 s55, s51, 1
    s_mul_i32 s55, s55, 3670016
    s_lshr_b32 s56, s51, 1
    s_lshl_b32 s56, s56, 8
    s_add_u32 s55, s55, s56
    s_lshl_b32 s56, s44, 15
    s_add_u32 s55, s55, s56
    s_lshl_b32 s56, s43, 16
    s_add_u32 s69, s55, s56
    s_add_u32 s68, s69, s56
    s_waitcnt lgkmcnt(0)
    s_mov_b32 s8, s74
    s_mov_b32 s9, s75
    s_mov_b32 s10, 6291456
    s_mov_b32 s11, 0x00020000
    s_mov_b32 s36, s72
    s_mov_b32 s37, s73
    s_mov_b32 s38, 4194304
    s_mov_b32 s39, 0x00020000
    s_mov_b32 s4, s90
    s_mov_b32 s5, s91
    s_mov_b32 s6, 268435456
    s_mov_b32 s7, 0x00020000
    s_mov_b32 s24, s72
    s_mov_b32 s25, s73
    s_mov_b32 s26, 4194304
    s_mov_b32 s27, 0x00020000
    s_mov_b32 s12, s76
    s_mov_b32 s13, s77
    s_mov_b32 s14, 2097152
    s_mov_b32 s15, 0x00020000
    s_cmp_eq_u32 s43, 0
    s_cselect_b32 s16, s80, s82
    s_cselect_b32 s17, s81, s83
    s_mov_b32 s18, 7340032
    s_mov_b32 s19, 0x00020000
    s_mov_b32 s20, s84
    s_mov_b32 s21, s85
    s_mov_b32 s22, 7340032
    s_mov_b32 s23, 0x00020000
    s_mov_b32 s28, s86
    s_mov_b32 s29, s87
    s_mov_b32 s30, 4194304
    s_mov_b32 s31, 0x00020000
    s_mov_b32 s32, s88
    s_mov_b32 s33, s89
    s_mov_b32 s34, 256
    s_mov_b32 s35, 0x00020000
    s_and_b32 s55, s2, 1
    s_lshl_b32 s55, s55, 13
    s_add_u32 s55, s55, 16384
    s_add_u32 s0, s54, s55
    s_lshl_b32 s55, s51, 14
    s_lshl_b32 s56, s43, 13
    s_add_u32 s55, s55, s56
    s_lshl_b32 s56, s44, 10
    s_add_u32 s1, s55, s56
    s_cmp_lt_u32 s3, 4
    s_cbranch_scc1 X_start
    v_lshrrev_b32 v224, 7, v254
    v_and_b32 v225, 0x70, v254
    v_and_b32 v226, 6, v224
    v_lshlrev_b32 v226, 4, v226
    v_xor_b32 v225, v225, v226
    v_and_b32 v226, 4, v224
    v_add_u32 v224, v224, v226
    v_mul_u32_u24 v224, 6144, v224
    v_add3_u32 v224, v224, v225, s63
    s_lshr_b32 s55, s61, 10
    s_add_u32 s55, s55, 0
    s_and_b32 s56, s55, 3
    s_and_b32 s57, s56, 1
    s_lshl_b32 s57, s57, 4
    s_and_b32 s56, s56, 2
    s_lshl_b32 s56, s56, 1
    s_add_u32 s56, s56, s57
    s_mul_i32 s56, s56, 6144
    s_lshr_b32 s55, s55, 2
    s_lshl_b32 s55, s55, 11
    s_add_u32 s55, s55, s56
    s_sub_u32 s55, s55, 0
    v_add_u32 v200, s55, v224
    s_lshr_b32 s55, s61, 10
    s_add_u32 s55, s55, 1
    s_and_b32 s56, s55, 3
    s_and_b32 s57, s56, 1
    s_lshl_b32 s57, s57, 4
    s_and_b32 s56, s56, 2
    s_lshl_b32 s56, s56, 1
    s_add_u32 s56, s56, s57
    s_mul_i32 s56, s56, 6144
    s_lshr_b32 s55, s55, 2
    s_lshl_b32 s55, s55, 11
    s_add_u32 s55, s55, s56
    s_sub_u32 s55, s55, 1024
    v_add_u32 v201, s55, v224
    s_lshr_b32 s55, s61, 10
    s_add_u32 s55, s55, 2
    s_and_b32 s56, s55, 3
    s_and_b32 s57, s56, 1
    s_lshl_b32 s57, s57, 4
    s_and_b32 s56, s56, 2
    s_lshl_b32 s56, s56, 1
    s_add_u32 s56, s56, s57
    s_mul_i32 s56, s56, 6144
    s_lshr_b32 s55, s55, 2
    s_lshl_b32 s55, s55, 11
    s_add_u32 s55, s55, s56
    s_sub_u32 s55, s55, 2048
    v_add_u32 v202, s55, v224
    s_lshl_b32 s93, s51, 12
    s_add_u32 m0, s61, 0
    s_mul_i32 s59, s93, 96
    buffer_load_dwordx4 v200, s[8:11], s59 offen lds
    buffer_load_dwordx4 v201, s[8:11], s59 offen offset:1024 lds
    buffer_load_dwordx4 v202, s[8:11], s59 offen offset:2048 lds
    s_add_u32 s93, s93, 2048
    s_and_b32 s93, s93, 65535
    s_lshl_b32 s55, s40, 18
    s_lshl_b32 s56, s62, 4
    s_add_u32 s88, s55, s56
    s_lshl_b32 s56, s43, 14
    s_add_u32 s89, s55, s56
    s_sub_u32 s89, s89, 32768
    v_lshrrev_b32 v224, 7, v254
    v_and_b32 v225, 0x70, v254
    v_and_b32 v226, 6, v224
    v_lshlrev_b32 v226, 4, v226
    v_xor_b32 v225, v225, v226
    v_mul_u32_u24 v224, 2048, v224
    v_add3_u32 v217, v224, v225, s88
    v_add_u32 v218, 15360, v217
    v_add_u32 v219, 30720, v217
    v_add_u32 v220, 46080, v217
    s_lshl_b32 s94, s51, 7
    s_cmp_eq_u32 s40, 0
    s_cselect_b32 s89, 2130706432, s89
    s_sub_u32 s89, s89, s88
    v_add_u32 v221, s89, v217
    s_lshl_b32 s91, s43, 10
    s_cmp_eq_u32 s44, 0
    s_cselect_b32 s84, -1, 0
    s_not_b32 s85, s84
    s_add_u32 m0, s91, 98304
    s_mov_b64 exec, s[84:85]
    buffer_load_dwordx4 v221, s[36:39], s94 offen lds
    s_mov_b64 exec, -1
    s_add_u32 m0, s62, 100352
    s_nop 0
    buffer_load_dwordx4 v217, s[36:39], s94 offen lds
    buffer_load_dwordx4 v218, s[36:39], s94 offen offset:1024 lds
    buffer_load_dwordx4 v219, s[36:39], s94 offen offset:2048 lds
    buffer_load_dwordx4 v220, s[36:39], s94 offen offset:3072 lds
    s_add_u32 s94, s94, 256
    s_and_b32 s94, s94, 2047
    s_add_u32 m0, s61, 16384
    s_mul_i32 s59, s93, 96
    buffer_load_dwordx4 v200, s[8:11], s59 offen lds
    buffer_load_dwordx4 v201, s[8:11], s59 offen offset:1024 lds
    buffer_load_dwordx4 v202, s[8:11], s59 offen offset:2048 lds
    s_add_u32 s93, s93, 6144
    s_and_b32 s93, s93, 65535
    s_cmp_lt_u32 s2, 128
    s_cselect_b32 s72, s80, s82
    s_cselect_b32 s73, s81, s83
    s_mov_b32 s74, 7340032
    s_mov_b32 s75, 0x00020000
    s_and_b32 s55, s2, 127
    s_mul_i32 s55, s55, 57344
    s_lshl_b32 s56, s42, 14
    s_add_u32 s55, s55, s56
    v_lshlrev_b32 v227, 3, v254
    buffer_load_dword v251, v227, s[72:75], s55 offen
    s_cmp_eq_u32 s42, 3
    s_cbranch_scc1 t_1
    s_add_u32 s55, s55, 8192
    buffer_load_dword v251, v227, s[72:75], s55 offen
    s_branch t_2
t_1:
    s_lshl_b32 s55, s2, 13
    buffer_load_dword v251, v227, s[12:15], s55 offen
t_2:
    s_add_u32 m0, s91, 116736
    s_mov_b64 exec, s[84:85]
    buffer_load_dwordx4 v221, s[36:39], s94 offen lds
    s_mov_b64 exec, -1
    s_add_u32 m0, s62, 118784
    s_nop 0
    buffer_load_dwordx4 v217, s[36:39], s94 offen lds
    buffer_load_dwordx4 v218, s[36:39], s94 offen offset:1024 lds
    buffer_load_dwordx4 v219, s[36:39], s94 offen offset:2048 lds
    buffer_load_dwordx4 v220, s[36:39], s94 offen offset:3072 lds
    s_add_u32 s94, s94, 256
    s_and_b32 s94, s94, 2047
    s_add_u32 m0, s61, 32768
    s_mul_i32 s59, s93, 96
    buffer_load_dwordx4 v200, s[8:11], s59 offen lds
    buffer_load_dwordx4 v201, s[8:11], s59 offen offset:1024 lds
    buffer_load_dwordx4 v202, s[8:11], s59 offen offset:2048 lds
    s_add_u32 s93, s93, 2048
    s_and_b32 s93, s93, 65535
    s_add_u32 m0, s91, 135168
    s_mov_b64 exec, s[84:85]
    buffer_load_dwordx4 v221, s[36:39], s94 offen lds
    s_mov_b64 exec, -1
    s_add_u32 m0, s62, 137216
    s_nop 0
    buffer_load_dwordx4 v217, s[36:39], s94 offen lds
    buffer_load_dwordx4 v218, s[36:39], s94 offen offset:1024 lds
    buffer_load_dwordx4 v219, s[36:39], s94 offen offset:2048 lds
    buffer_load_dwordx4 v220, s[36:39], s94 offen offset:3072 lds
    s_add_u32 s94, s94, 256
    s_and_b32 s94, s94, 2047
    s_add_u32 m0, s61, 49152
    s_mul_i32 s59, s93, 96
    buffer_load_dwordx4 v200, s[8:11], s59 offen lds
    buffer_load_dwordx4 v201, s[8:11], s59 offen offset:1024 lds
    buffer_load_dwordx4 v202, s[8:11], s59 offen offset:2048 lds
    s_add_u32 s93, s93, 6144
    s_and_b32 s93, s93, 65535
    s_add_u32 m0, s61, 65536
    s_mul_i32 s59, s93, 96
    buffer_load_dwordx4 v200, s[8:11], s59 offen lds
    buffer_load_dwordx4 v201, s[8:11], s59 offen offset:1024 lds
    buffer_load_dwordx4 v202, s[8:11], s59 offen offset:2048 lds
    s_add_u32 s93, s93, 2048
    s_and_b32 s93, s93, 65535
    s_add_u32 m0, s61, 81920
    s_mul_i32 s59, s93, 96
    buffer_load_dwordx4 v200, s[8:11], s59 offen lds
    buffer_load_dwordx4 v201, s[8:11], s59 offen offset:1024 lds
    buffer_load_dwordx4 v202, s[8:11], s59 offen offset:2048 lds
    s_add_u32 s93, s93, 6144
    s_and_b32 s93, s93, 65535
    s_branch Y_first
X_start:
    s_cmp_lg_u32 s42, 0
    s_cbranch_scc1 xz_5
    v_mov_b32 v103, 0
    v_lshrrev_b32 v100, 2, v254
    s_lshl_b32 s55, s2, 8
    s_add_u32 s55, s55, 71303168
    buffer_store_dword v103, v100, s[4:7], s55 offen sc0 sc1
    v_lshlrev_b32 v100, 6, v254
    s_lshl_b32 s55, s2, 2
    s_add_u32 s55, s55, 71565312
    s_mov_b64 exec, 3
    buffer_store_dword v103, v100, s[4:7], s55 offen sc0 sc1
    s_mov_b64 exec, -1
xz_5:
    s_getpc_b64 s[72:73]
K_pc:
    s_mov_b32 s74, K_end-K_pc
    s_mov_b32 s75, 0x00020000
    s_lshr_b32 s55, s2, 3
    s_lshl_b32 s55, s55, 2
    s_add_u32 s55, s55, s42
    s_lshl_b32 s55, s55, 10
    v_lshlrev_b32 v100, 3, v254
    s_mov_b64 exec, 0xff
    buffer_load_dword v101, v100, s[72:75], s55 offen
    s_mov_b64 exec, -1
    v_lshrrev_b32 v100, 7, v254
    v_and_b32 v102, 0x70, v254
    s_cmp_eq_u32 s42, 3
    s_cbranch_scc1 xp_3
    v_mul_u32_u24 v100, 6144, v100
    v_add_u32 v100, v100, v102
    s_mul_i32 s56, s2, 3
    s_add_u32 s56, s56, s42
    s_and_b32 s55, s56, 15
    s_mul_i32 s55, s55, 393216
    s_lshr_b32 s57, s56, 4
    s_lshl_b32 s57, s57, 7
    s_add_u32 s55, s55, s57
    buffer_load_dwordx4 v[0:3], v100, s[8:11], s55 offen
    s_add_u32 s55, s55, 49152
    buffer_load_dwordx4 v[4:7], v100, s[8:11], s55 offen
    s_add_u32 s55, s55, 49152
    buffer_load_dwordx4 v[8:11], v100, s[8:11], s55 offen
    s_add_u32 s55, s55, 49152
    buffer_load_dwordx4 v[12:15], v100, s[8:11], s55 offen
    s_add_u32 s55, s55, 49152
    buffer_load_dwordx4 v[16:19], v100, s[8:11], s55 offen
    s_add_u32 s55, s55, 49152
    buffer_load_dwordx4 v[20:23], v100, s[8:11], s55 offen
    s_add_u32 s55, s55, 49152
    buffer_load_dwordx4 v[24:27], v100, s[8:11], s55 offen
    s_add_u32 s55, s55, 49152
    buffer_load_dwordx4 v[28:31], v100, s[8:11], s55 offen
    s_add_u32 s55, s55, 49152
    v_mov_b32 v64, 0
    v_mov_b32 v65, 0
    v_mov_b32 v66, 0
    v_mov_b32 v67, 0
    v_mov_b32 v68, 0
    v_mov_b32 v69, 0
    v_mov_b32 v70, 0
    v_mov_b32 v71, 0
    v_mov_b32 v102, 0x00003f80
    v_mov_b32 v103, 0x3f800000
    s_waitcnt vmcnt(7)
    v_dot2_f32_bf16 v64, v0, v102, v64
    v_dot2_f32_bf16 v65, v0, v103, v65
    v_dot2_f32_bf16 v66, v1, v102, v66
    v_dot2_f32_bf16 v67, v1, v103, v67
    v_dot2_f32_bf16 v68, v2, v102, v68
    v_dot2_f32_bf16 v69, v2, v103, v69
    v_dot2_f32_bf16 v70, v3, v102, v70
    v_dot2_f32_bf16 v71, v3, v103, v71
    s_waitcnt vmcnt(6)
    v_dot2_f32_bf16 v64, v4, v102, v64
    v_dot2_f32_bf16 v65, v4, v103, v65
    v_dot2_f32_bf16 v66, v5, v102, v66
    v_dot2_f32_bf16 v67, v5, v103, v67
    v_dot2_f32_bf16 v68, v6, v102, v68
    v_dot2_f32_bf16 v69, v6, v103, v69
    v_dot2_f32_bf16 v70, v7, v102, v70
    v_dot2_f32_bf16 v71, v7, v103, v71
    s_waitcnt vmcnt(5)
    v_dot2_f32_bf16 v64, v8, v102, v64
    v_dot2_f32_bf16 v65, v8, v103, v65
    v_dot2_f32_bf16 v66, v9, v102, v66
    v_dot2_f32_bf16 v67, v9, v103, v67
    v_dot2_f32_bf16 v68, v10, v102, v68
    v_dot2_f32_bf16 v69, v10, v103, v69
    v_dot2_f32_bf16 v70, v11, v102, v70
    v_dot2_f32_bf16 v71, v11, v103, v71
    s_waitcnt vmcnt(4)
    v_dot2_f32_bf16 v64, v12, v102, v64
    v_dot2_f32_bf16 v65, v12, v103, v65
    v_dot2_f32_bf16 v66, v13, v102, v66
    v_dot2_f32_bf16 v67, v13, v103, v67
    v_dot2_f32_bf16 v68, v14, v102, v68
    v_dot2_f32_bf16 v69, v14, v103, v69
    v_dot2_f32_bf16 v70, v15, v102, v70
    v_dot2_f32_bf16 v71, v15, v103, v71
    s_waitcnt vmcnt(3)
    v_dot2_f32_bf16 v64, v16, v102, v64
    v_dot2_f32_bf16 v65, v16, v103, v65
    v_dot2_f32_bf16 v66, v17, v102, v66
    v_dot2_f32_bf16 v67, v17, v103, v67
    v_dot2_f32_bf16 v68, v18, v102, v68
    v_dot2_f32_bf16 v69, v18, v103, v69
    v_dot2_f32_bf16 v70, v19, v102, v70
    v_dot2_f32_bf16 v71, v19, v103, v71
    s_waitcnt vmcnt(2)
    v_dot2_f32_bf16 v64, v20, v102, v64
    v_dot2_f32_bf16 v65, v20, v103, v65
    v_dot2_f32_bf16 v66, v21, v102, v66
    v_dot2_f32_bf16 v67, v21, v103, v67
    v_dot2_f32_bf16 v68, v22, v102, v68
    v_dot2_f32_bf16 v69, v22, v103, v69
    v_dot2_f32_bf16 v70, v23, v102, v70
    v_dot2_f32_bf16 v71, v23, v103, v71
    s_waitcnt vmcnt(1)
    v_dot2_f32_bf16 v64, v24, v102, v64
    v_dot2_f32_bf16 v65, v24, v103, v65
    v_dot2_f32_bf16 v66, v25, v102, v66
    v_dot2_f32_bf16 v67, v25, v103, v67
    v_dot2_f32_bf16 v68, v26, v102, v68
    v_dot2_f32_bf16 v69, v26, v103, v69
    v_dot2_f32_bf16 v70, v27, v102, v70
    v_dot2_f32_bf16 v71, v27, v103, v71
    s_waitcnt vmcnt(0)
    v_dot2_f32_bf16 v64, v28, v102, v64
    v_dot2_f32_bf16 v65, v28, v103, v65
    v_dot2_f32_bf16 v66, v29, v102, v66
    v_dot2_f32_bf16 v67, v29, v103, v67
    v_dot2_f32_bf16 v68, v30, v102, v68
    v_dot2_f32_bf16 v69, v30, v103, v69
    v_dot2_f32_bf16 v70, v31, v102, v70
    v_dot2_f32_bf16 v71, v31, v103, v71
    s_cmp_lg_u32 s42, 0
    s_cbranch_scc1 xz_6
    s_getreg_b32 s59, hwreg(HW_REG_XCC_ID, 0, 4)
    s_mul_i32 s55, s59, s59
    s_lshl_b32 s55, s55, 15
    s_lshl_b32 s59, s59, 6
    s_add_u32 s59, s59, s55
    s_add_u32 s59, s59, 1
    v_mov_b32 v253, s59
    s_and_b32 s55, s2, 7
    s_lshl_b32 s55, s55, 5
    v_mov_b32 v252, 0
    s_mov_b64 exec, 1
    buffer_atomic_add v253, v252, s[32:35], s55 offen sc1
    s_mov_b64 exec, -1
xz_6:
    s_nop 3
    v_add_f32_dpp v64, v64, v64 row_ror:8 row_mask:0xf bank_mask:0xf
    v_add_f32_dpp v65, v65, v65 row_ror:8 row_mask:0xf bank_mask:0xf
    v_add_f32_dpp v66, v66, v66 row_ror:8 row_mask:0xf bank_mask:0xf
    v_add_f32_dpp v67, v67, v67 row_ror:8 row_mask:0xf bank_mask:0xf
    v_add_f32_dpp v68, v68, v68 row_ror:8 row_mask:0xf bank_mask:0xf
    v_add_f32_dpp v69, v69, v69 row_ror:8 row_mask:0xf bank_mask:0xf
    v_add_f32_dpp v70, v70, v70 row_ror:8 row_mask:0xf bank_mask:0xf
    v_add_f32_dpp v71, v71, v71 row_ror:8 row_mask:0xf bank_mask:0xf
    v_mov_b32 v80, v64
    v_mov_b32 v81, v65
    v_mov_b32 v82, v66
    v_mov_b32 v83, v67
    v_mov_b32 v84, v68
    v_mov_b32 v85, v69
    v_mov_b32 v86, v70
    v_mov_b32 v87, v71
    s_nop 1
    v_permlane16_swap_b32 v64, v80
    v_permlane16_swap_b32 v65, v81
    v_permlane16_swap_b32 v66, v82
    v_permlane16_swap_b32 v67, v83
    v_permlane16_swap_b32 v68, v84
    v_permlane16_swap_b32 v69, v85
    v_permlane16_swap_b32 v70, v86
    v_permlane16_swap_b32 v71, v87
    v_add_f32 v64, v64, v80
    v_add_f32 v65, v65, v81
    v_add_f32 v66, v66, v82
    v_add_f32 v67, v67, v83
    v_add_f32 v68, v68, v84
    v_add_f32 v69, v69, v85
    v_add_f32 v70, v70, v86
    v_add_f32 v71, v71, v87
    v_mov_b32 v80, v64
    v_mov_b32 v81, v65
    v_mov_b32 v82, v66
    v_mov_b32 v83, v67
    v_mov_b32 v84, v68
    v_mov_b32 v85, v69
    v_mov_b32 v86, v70
    v_mov_b32 v87, v71
    s_nop 1
    v_permlane32_swap_b32 v64, v80
    v_permlane32_swap_b32 v65, v81
    v_permlane32_swap_b32 v66, v82
    v_permlane32_swap_b32 v67, v83
    v_permlane32_swap_b32 v68, v84
    v_permlane32_swap_b32 v69, v85
    v_permlane32_swap_b32 v70, v86
    v_permlane32_swap_b32 v71, v87
    v_add_f32 v64, v64, v80
    v_add_f32 v65, v65, v81
    v_add_f32 v66, v66, v82
    v_add_f32 v67, v67, v83
    v_add_f32 v68, v68, v84
    v_add_f32 v69, v69, v85
    v_add_f32 v70, v70, v86
    v_add_f32 v71, v71, v87
    s_and_b32 s55, s56, 15
    s_mul_i32 s55, s55, 12288
    s_lshl_b32 s57, s57, 1
    s_add_u32 s55, s55, s57
    s_add_u32 s55, s55, 70516736
    v_lshlrev_b32 v100, 1, v254
    s_mov_b64 exec, 0xff
    buffer_store_dwordx4 v[64:67], v100, s[4:7], s55 offen sc0 sc1
    buffer_store_dwordx4 v[68:71], v100, s[4:7], s55 offen offset:16 sc0 sc1
    s_mov_b64 exec, -1
    s_branch xp_4
xp_3:
    v_lshl_add_u32 v100, v100, 11, v102
    s_lshl_b32 s55, s2, 14
    buffer_load_dwordx4 v[0:3], v100, s[24:27], s55 offen offset:0
    buffer_load_dwordx4 v[4:7], v100, s[24:27], s55 offen offset:128
    buffer_load_dwordx4 v[8:11], v100, s[24:27], s55 offen offset:256
    buffer_load_dwordx4 v[12:15], v100, s[24:27], s55 offen offset:384
    buffer_load_dwordx4 v[16:19], v100, s[24:27], s55 offen offset:512
    buffer_load_dwordx4 v[20:23], v100, s[24:27], s55 offen offset:640
    buffer_load_dwordx4 v[24:27], v100, s[24:27], s55 offen offset:768
    buffer_load_dwordx4 v[28:31], v100, s[24:27], s55 offen offset:896
    buffer_load_dwordx4 v[32:35], v100, s[24:27], s55 offen offset:1024
    buffer_load_dwordx4 v[36:39], v100, s[24:27], s55 offen offset:1152
    buffer_load_dwordx4 v[40:43], v100, s[24:27], s55 offen offset:1280
    buffer_load_dwordx4 v[44:47], v100, s[24:27], s55 offen offset:1408
    buffer_load_dwordx4 v[48:51], v100, s[24:27], s55 offen offset:1536
    buffer_load_dwordx4 v[52:55], v100, s[24:27], s55 offen offset:1664
    buffer_load_dwordx4 v[56:59], v100, s[24:27], s55 offen offset:1792
    buffer_load_dwordx4 v[60:63], v100, s[24:27], s55 offen offset:1920
    v_mov_b32 v64, 0
    v_mov_b32 v65, 0
    v_mov_b32 v66, 0
    v_mov_b32 v67, 0
    v_mov_b32 v102, 0x3f803f80
    s_waitcnt vmcnt(15)
    v_dot2_f32_bf16 v64, v0, v102, v64
    v_dot2_f32_bf16 v65, v0, v0, v65
    v_dot2_f32_bf16 v66, v1, v102, v66
    v_dot2_f32_bf16 v67, v1, v1, v67
    v_dot2_f32_bf16 v64, v2, v102, v64
    v_dot2_f32_bf16 v65, v2, v2, v65
    v_dot2_f32_bf16 v66, v3, v102, v66
    v_dot2_f32_bf16 v67, v3, v3, v67
    s_waitcnt vmcnt(14)
    v_dot2_f32_bf16 v64, v4, v102, v64
    v_dot2_f32_bf16 v65, v4, v4, v65
    v_dot2_f32_bf16 v66, v5, v102, v66
    v_dot2_f32_bf16 v67, v5, v5, v67
    v_dot2_f32_bf16 v64, v6, v102, v64
    v_dot2_f32_bf16 v65, v6, v6, v65
    v_dot2_f32_bf16 v66, v7, v102, v66
    v_dot2_f32_bf16 v67, v7, v7, v67
    s_waitcnt vmcnt(13)
    v_dot2_f32_bf16 v64, v8, v102, v64
    v_dot2_f32_bf16 v65, v8, v8, v65
    v_dot2_f32_bf16 v66, v9, v102, v66
    v_dot2_f32_bf16 v67, v9, v9, v67
    v_dot2_f32_bf16 v64, v10, v102, v64
    v_dot2_f32_bf16 v65, v10, v10, v65
    v_dot2_f32_bf16 v66, v11, v102, v66
    v_dot2_f32_bf16 v67, v11, v11, v67
    s_waitcnt vmcnt(12)
    v_dot2_f32_bf16 v64, v12, v102, v64
    v_dot2_f32_bf16 v65, v12, v12, v65
    v_dot2_f32_bf16 v66, v13, v102, v66
    v_dot2_f32_bf16 v67, v13, v13, v67
    v_dot2_f32_bf16 v64, v14, v102, v64
    v_dot2_f32_bf16 v65, v14, v14, v65
    v_dot2_f32_bf16 v66, v15, v102, v66
    v_dot2_f32_bf16 v67, v15, v15, v67
    s_waitcnt vmcnt(11)
    v_dot2_f32_bf16 v64, v16, v102, v64
    v_dot2_f32_bf16 v65, v16, v16, v65
    v_dot2_f32_bf16 v66, v17, v102, v66
    v_dot2_f32_bf16 v67, v17, v17, v67
    v_dot2_f32_bf16 v64, v18, v102, v64
    v_dot2_f32_bf16 v65, v18, v18, v65
    v_dot2_f32_bf16 v66, v19, v102, v66
    v_dot2_f32_bf16 v67, v19, v19, v67
    s_waitcnt vmcnt(10)
    v_dot2_f32_bf16 v64, v20, v102, v64
    v_dot2_f32_bf16 v65, v20, v20, v65
    v_dot2_f32_bf16 v66, v21, v102, v66
    v_dot2_f32_bf16 v67, v21, v21, v67
    v_dot2_f32_bf16 v64, v22, v102, v64
    v_dot2_f32_bf16 v65, v22, v22, v65
    v_dot2_f32_bf16 v66, v23, v102, v66
    v_dot2_f32_bf16 v67, v23, v23, v67
    s_waitcnt vmcnt(9)
    v_dot2_f32_bf16 v64, v24, v102, v64
    v_dot2_f32_bf16 v65, v24, v24, v65
    v_dot2_f32_bf16 v66, v25, v102, v66
    v_dot2_f32_bf16 v67, v25, v25, v67
    v_dot2_f32_bf16 v64, v26, v102, v64
    v_dot2_f32_bf16 v65, v26, v26, v65
    v_dot2_f32_bf16 v66, v27, v102, v66
    v_dot2_f32_bf16 v67, v27, v27, v67
    s_waitcnt vmcnt(8)
    v_dot2_f32_bf16 v64, v28, v102, v64
    v_dot2_f32_bf16 v65, v28, v28, v65
    v_dot2_f32_bf16 v66, v29, v102, v66
    v_dot2_f32_bf16 v67, v29, v29, v67
    v_dot2_f32_bf16 v64, v30, v102, v64
    v_dot2_f32_bf16 v65, v30, v30, v65
    v_dot2_f32_bf16 v66, v31, v102, v66
    v_dot2_f32_bf16 v67, v31, v31, v67
    s_waitcnt vmcnt(7)
    v_dot2_f32_bf16 v64, v32, v102, v64
    v_dot2_f32_bf16 v65, v32, v32, v65
    v_dot2_f32_bf16 v66, v33, v102, v66
    v_dot2_f32_bf16 v67, v33, v33, v67
    v_dot2_f32_bf16 v64, v34, v102, v64
    v_dot2_f32_bf16 v65, v34, v34, v65
    v_dot2_f32_bf16 v66, v35, v102, v66
    v_dot2_f32_bf16 v67, v35, v35, v67
    s_waitcnt vmcnt(6)
    v_dot2_f32_bf16 v64, v36, v102, v64
    v_dot2_f32_bf16 v65, v36, v36, v65
    v_dot2_f32_bf16 v66, v37, v102, v66
    v_dot2_f32_bf16 v67, v37, v37, v67
    v_dot2_f32_bf16 v64, v38, v102, v64
    v_dot2_f32_bf16 v65, v38, v38, v65
    v_dot2_f32_bf16 v66, v39, v102, v66
    v_dot2_f32_bf16 v67, v39, v39, v67
    s_waitcnt vmcnt(5)
    v_dot2_f32_bf16 v64, v40, v102, v64
    v_dot2_f32_bf16 v65, v40, v40, v65
    v_dot2_f32_bf16 v66, v41, v102, v66
    v_dot2_f32_bf16 v67, v41, v41, v67
    v_dot2_f32_bf16 v64, v42, v102, v64
    v_dot2_f32_bf16 v65, v42, v42, v65
    v_dot2_f32_bf16 v66, v43, v102, v66
    v_dot2_f32_bf16 v67, v43, v43, v67
    s_waitcnt vmcnt(4)
    v_dot2_f32_bf16 v64, v44, v102, v64
    v_dot2_f32_bf16 v65, v44, v44, v65
    v_dot2_f32_bf16 v66, v45, v102, v66
    v_dot2_f32_bf16 v67, v45, v45, v67
    v_dot2_f32_bf16 v64, v46, v102, v64
    v_dot2_f32_bf16 v65, v46, v46, v65
    v_dot2_f32_bf16 v66, v47, v102, v66
    v_dot2_f32_bf16 v67, v47, v47, v67
    s_waitcnt vmcnt(3)
    v_dot2_f32_bf16 v64, v48, v102, v64
    v_dot2_f32_bf16 v65, v48, v48, v65
    v_dot2_f32_bf16 v66, v49, v102, v66
    v_dot2_f32_bf16 v67, v49, v49, v67
    v_dot2_f32_bf16 v64, v50, v102, v64
    v_dot2_f32_bf16 v65, v50, v50, v65
    v_dot2_f32_bf16 v66, v51, v102, v66
    v_dot2_f32_bf16 v67, v51, v51, v67
    s_waitcnt vmcnt(2)
    v_dot2_f32_bf16 v64, v52, v102, v64
    v_dot2_f32_bf16 v65, v52, v52, v65
    v_dot2_f32_bf16 v66, v53, v102, v66
    v_dot2_f32_bf16 v67, v53, v53, v67
    v_dot2_f32_bf16 v64, v54, v102, v64
    v_dot2_f32_bf16 v65, v54, v54, v65
    v_dot2_f32_bf16 v66, v55, v102, v66
    v_dot2_f32_bf16 v67, v55, v55, v67
    s_waitcnt vmcnt(1)
    v_dot2_f32_bf16 v64, v56, v102, v64
    v_dot2_f32_bf16 v65, v56, v56, v65
    v_dot2_f32_bf16 v66, v57, v102, v66
    v_dot2_f32_bf16 v67, v57, v57, v67
    v_dot2_f32_bf16 v64, v58, v102, v64
    v_dot2_f32_bf16 v65, v58, v58, v65
    v_dot2_f32_bf16 v66, v59, v102, v66
    v_dot2_f32_bf16 v67, v59, v59, v67
    s_waitcnt vmcnt(0)
    v_dot2_f32_bf16 v64, v60, v102, v64
    v_dot2_f32_bf16 v65, v60, v60, v65
    v_dot2_f32_bf16 v66, v61, v102, v66
    v_dot2_f32_bf16 v67, v61, v61, v67
    v_dot2_f32_bf16 v64, v62, v102, v64
    v_dot2_f32_bf16 v65, v62, v62, v65
    v_dot2_f32_bf16 v66, v63, v102, v66
    v_dot2_f32_bf16 v67, v63, v63, v67
    s_nop 3
    v_add_f32 v64, v64, v66
    v_add_f32 v65, v65, v67
    s_nop 1
    v_add_f32_dpp v64, v64, v64 quad_perm:[1,0,3,2] row_mask:0xf bank_mask:0xf
    v_add_f32_dpp v65, v65, v65 quad_perm:[1,0,3,2] row_mask:0xf bank_mask:0xf
    s_nop 1
    v_add_f32_dpp v64, v64, v64 quad_perm:[2,3,0,1] row_mask:0xf bank_mask:0xf
    v_add_f32_dpp v65, v65, v65 quad_perm:[2,3,0,1] row_mask:0xf bank_mask:0xf
    s_nop 1
    v_add_f32_dpp v64, v64, v64 row_half_mirror row_mask:0xf bank_mask:0xf
    v_add_f32_dpp v65, v65, v65 row_half_mirror row_mask:0xf bank_mask:0xf
    v_lshrrev_b32 v100, 4, v254
    s_lshl_b32 s55, s2, 6
    s_add_u32 s55, s55, 70254592
    s_mov_b32 s70, 0x01010101
    s_mov_b32 s71, 0x01010101
    s_mov_b64 exec, s[70:71]
    buffer_store_dwordx2 v[64:65], v100, s[4:7], s55 offen sc0 sc1
    s_mov_b64 exec, -1
xp_4:
    v_and_b32 v100, 0xf0, v254
    v_lshlrev_b32 v100, 7, v100
    v_lshrrev_b32 v102, 8, v254
    v_lshl_add_u32 v100, v102, 3, v100
    s_lshl_b32 s55, s40, 18
    s_lshl_b32 s56, s43, 17
    s_add_u32 s55, s55, s56
    s_lshl_b32 s56, s51, 7
    s_add_u32 s55, s55, s56
    s_lshl_b32 s56, s44, 6
    s_add_u32 s55, s55, s56
    buffer_load_dwordx2 v[236:237], v100, s[24:27], s55 offen offset:0
    buffer_load_dwordx2 v[238:239], v100, s[24:27], s55 offen offset:32
    s_add_u32 s55, s55, 32768
    buffer_load_dwordx2 v[240:241], v100, s[24:27], s55 offen offset:0
    buffer_load_dwordx2 v[242:243], v100, s[24:27], s55 offen offset:32
    s_add_u32 s55, s55, 32768
    buffer_load_dwordx2 v[244:245], v100, s[24:27], s55 offen offset:0
    buffer_load_dwordx2 v[246:247], v100, s[24:27], s55 offen offset:32
    s_add_u32 s55, s55, 32768
    buffer_load_dwordx2 v[248:249], v100, s[24:27], s55 offen offset:0
    buffer_load_dwordx2 v[250:251], v100, s[24:27], s55 offen offset:32
    s_add_u32 s55, s55, 32768
X_layer:
    v_lshrrev_b32 v206, 4, v254
    v_lshrrev_b32 v207, 8, v254
    v_and_b32 v208, 15, v206
    s_lshl_b32 s55, s43, 13
    s_add_u32 s55, s55, 98304
    s_cmp_lg_u32 s46, 0
    s_cbranch_scc1 g1_7
    v_and_b32 v210, 6, v208
    v_xor_b32 v210, v210, v207
    v_lshlrev_b32 v210, 4, v210
    v_lshl_add_u32 v200, v208, 7, v210
    v_xor_b32 v201, 64, v200
    s_branch g1_8
g1_7:
    v_mov_b32 v200, v254
    v_add_u32 v201, 1024, v254
g1_8:
    v_add_u32 v200, s55, v200
    v_add_u32 v201, s55, v201
    v_lshrrev_b32 v209, 6, v254
    v_lshrrev_b32 v210, 1, v209
    v_and_b32 v210, 3, v210
    s_lshl_b32 s55, s44, 1
    v_xor_b32 v210, s55, v210
    v_lshlrev_b32 v209, 7, v209
    v_lshl_add_u32 v209, v210, 5, v209
    v_and_b32 v210, 0x30, v254
    v_lshrrev_b32 v210, 1, v210
    v_add_u32 v202, v209, v210
    v_xor_b32 v203, 32, v202
    v_add_u32 v204, 49152, v202
    v_add_u32 v205, 49152, v203
    s_add_u32 s88, s1, s47
    v_lshlrev_b32 v209, 2, v207
    v_sub_u32 v209, v208, v209
    v_cmp_le_i32 s[72:73], 0, v209
    v_cmp_le_i32 s[74:75], 1, v209
    v_cmp_le_i32 s[76:77], 2, v209
    v_cmp_le_i32 s[78:79], 3, v209
    v_and_b32 v210, 1, v208
    v_cmp_eq_u32 s[80:81], 1, v210
    v_sub_u32 v209, v209, v210
    v_mov_b32 v212, 0x0c0c0c0c
    v_mov_b32 v210, 0xc0c0100
    v_mov_b32 v211, 0x1000c0c
    v_cmp_le_i32 vcc, 0, v209
    v_cndmask_b32 v210, v210, v211, s[80:81]
    s_not_b64 s[82:83], vcc
    v_cndmask_b32 v214, v210, v212, vcc
    v_cndmask_b32 v216, v212, v210, vcc
    v_mov_b32 v210, 0xc0c0302
    v_mov_b32 v211, 0x3020c0c
    v_cmp_le_i32 vcc, 2, v209
    v_cndmask_b32 v210, v210, v211, s[80:81]
    s_not_b64 s[84:85], vcc
    v_cndmask_b32 v215, v210, v212, vcc
    v_cndmask_b32 v217, v212, v210, vcc
    s_or_b32 s55, s40, s43
    s_cmp_eq_u32 s55, 0
    s_cselect_b64 s[82:83], s[82:83], 0
    s_cselect_b64 s[84:85], s[84:85], 0
    s_lshl_b32 s55, s43, 8
    s_add_u32 s55, s55, 159744
    v_lshlrev_b32 v218, 2, v208
    v_add_u32 v218, s55, v218
    v_lshlrev_b32 v219, 4, v207
    v_add_u32 v219, s55, v219
    s_lshl_b32 s55, s44, 7
    s_add_u32 s55, s55, 160896
    v_lshlrev_b32 v220, 4, v207
    v_add_u32 v220, s55, v220
    v_lshlrev_b32 v221, 2, v208
    v_add_u32 v221, s55, v221
    v_mov_b32 v222, 0x3f803f80
    v_mov_b32 v223, 0x3f803f80
    v_mov_b32 v224, 0x3f803f80
    v_mov_b32 v225, 0x3f803f80
    v_mov_b32 v213, 163712
    s_cmp_eq_u32 s46, 0
    s_cbranch_scc1 g1_9
    s_waitcnt vmcnt(0) lgkmcnt(0)
    s_barrier
    s_cmp_lg_u32 s42, 2
    s_cbranch_scc1 wf_10
    s_lshr_b32 s55, s2, 5
    s_lshl_b32 s55, s55, 2
    s_add_u32 s55, s55, s0
    v_mov_b32 v252, 64
    v_mov_b32 v253, 0x01010101
    s_mov_b64 exec, 1
    s_cmp_eq_u32 s45, 0
    s_cbranch_scc1 st_11
    buffer_store_dword v253, v252, s[4:7], s55 offen sc0 sc1
    s_branch st_12
st_11:
    buffer_store_dword v253, v252, s[4:7], s55 offen
st_12:
    s_mov_b64 exec, -1
wf_10:
    s_cmp_lg_u32 s42, 3
    s_cbranch_scc1 wf_13
    s_lshl_b32 s55, s51, 2
    s_add_u32 s55, s55, s54
    v_mov_b32 v252, 8192
    v_mov_b32 v253, 0x01010101
    s_mov_b64 exec, 1
    buffer_store_dword v253, v252, s[4:7], s55 offen sc0 sc1
    s_mov_b64 exec, -1
wf_13:
    s_cmp_lg_u32 s42, 0
    s_cbranch_scc1 so_14
    v_add_u32 v234, 155648, v254
    ds_read_b128 v[226:229], v234
    ds_read_b128 v[230:233], v234 offset:1024
    s_lshl_b32 s55, s51, 10
    s_add_u32 s55, s55, s53
    s_waitcnt lgkmcnt(0)
    v_add_f32 v226, v226, v230
    v_add_f32 v227, v227, v231
    v_add_f32 v228, v228, v232
    v_add_f32 v229, v229, v233
    buffer_store_dwordx4 v[226:229], v254, s[4:7], s55 offen sc0 sc1
so_14:
g1_9:
    s_barrier
    ds_read_b64_tr_b16 v[152:153], v202 offset:0
    ds_read_b64_tr_b16 v[154:155], v202 offset:2048
    ds_read_b128 v[116:119], v200 offset:2048
    ds_read_b128 v[120:123], v200 offset:4096
    ds_read_b128 v[124:127], v200 offset:6144
    ds_read_b128 v[128:131], v200 offset:8192
    ds_read_b64_tr_b16 v[156:157], v203 offset:0
    ds_read_b64_tr_b16 v[158:159], v203 offset:2048
    ds_read_b64_tr_b16 v[160:161], v202 offset:4096
    ds_read_b64_tr_b16 v[162:163], v202 offset:6144
    ds_read_b128 v[112:115], v200 offset:0
    ds_read_b64_tr_b16 v[164:165], v203 offset:4096
    ds_read_b64_tr_b16 v[166:167], v203 offset:6144
    ds_read_b64_tr_b16 v[168:169], v202 offset:8192
    ds_read_b64_tr_b16 v[170:171], v202 offset:10240
    ds_read_b64_tr_b16 v[172:173], v203 offset:8192
    ds_read_b64_tr_b16 v[174:175], v203 offset:10240
    s_mov_b32 s58, 5
    s_waitcnt lgkmcnt(0)
    s_barrier
    .p2align 3
    v_mfma_f32_16x16x32_bf16 v[0:3], v[152:155], v[116:119], 0
    ds_read_b64_tr_b16 v[176:177], v202 offset:16384
    v_mfma_f32_16x16x32_bf16 v[8:11], v[152:155], v[120:123], 0
    ds_read_b64_tr_b16 v[178:179], v202 offset:18432
    v_mfma_f32_16x16x32_bf16 v[16:19], v[152:155], v[124:127], 0
    ds_read_b128 v[136:139], v201 offset:2048
    v_mfma_f32_16x16x32_bf16 v[24:27], v[152:155], v[128:131], 0
    ds_read_b128 v[140:143], v201 offset:4096
    v_mfma_f32_16x16x32_bf16 v[4:7], v[156:159], v[116:119], 0
    ds_read_b128 v[144:147], v201 offset:6144
    v_mfma_f32_16x16x32_bf16 v[12:15], v[156:159], v[120:123], 0
    v_mfma_f32_16x16x32_bf16 v[20:23], v[156:159], v[124:127], 0
    ds_read_b128 v[148:151], v201 offset:8192
    v_mfma_f32_16x16x32_bf16 v[28:31], v[156:159], v[128:131], 0
    ds_read_b64_tr_b16 v[180:181], v203 offset:16384
    v_mfma_f32_16x16x32_bf16 v[32:35], v[160:163], v[112:115], 0
    ds_read_b64_tr_b16 v[182:183], v203 offset:18432
    v_mfma_f32_16x16x32_bf16 v[40:43], v[160:163], v[116:119], 0
    ds_read_b64_tr_b16 v[184:185], v202 offset:20480
    v_mfma_f32_16x16x32_bf16 v[48:51], v[160:163], v[120:123], 0
    v_mfma_f32_16x16x32_bf16 v[56:59], v[160:163], v[124:127], 0
    ds_read_b64_tr_b16 v[186:187], v202 offset:22528
    v_mfma_f32_16x16x32_bf16 v[64:67], v[160:163], v[128:131], 0
    ds_read_b128 v[132:135], v201 offset:0
    v_mfma_f32_16x16x32_bf16 v[36:39], v[164:167], v[112:115], 0
    ds_read_b64_tr_b16 v[188:189], v203 offset:20480
    v_mfma_f32_16x16x32_bf16 v[44:47], v[164:167], v[116:119], 0
    ds_read_b64_tr_b16 v[190:191], v203 offset:22528
    v_mfma_f32_16x16x32_bf16 v[52:55], v[164:167], v[120:123], 0
    v_mfma_f32_16x16x32_bf16 v[60:63], v[164:167], v[124:127], 0
    ds_read_b64_tr_b16 v[192:193], v202 offset:24576
    v_mfma_f32_16x16x32_bf16 v[68:71], v[164:167], v[128:131], 0
    ds_read_b64_tr_b16 v[194:195], v202 offset:26624
    v_mfma_f32_16x16x32_bf16 v[72:75], v[112:115], v[168:171], 0
    ds_read_b64_tr_b16 v[196:197], v203 offset:24576
    v_mfma_f32_16x16x32_bf16 v[80:83], v[116:119], v[168:171], 0
    ds_read_b64_tr_b16 v[198:199], v203 offset:26624
    v_mfma_f32_16x16x32_bf16 v[88:91], v[120:123], v[168:171], 0
    v_mfma_f32_16x16x32_bf16 v[96:99], v[124:127], v[168:171], 0
    v_mfma_f32_16x16x32_bf16 v[104:107], v[128:131], v[168:171], 0
    v_mfma_f32_16x16x32_bf16 v[76:79], v[112:115], v[172:175], 0
    v_mfma_f32_16x16x32_bf16 v[84:87], v[116:119], v[172:175], 0
    v_mfma_f32_16x16x32_bf16 v[92:95], v[120:123], v[172:175], 0
    v_mfma_f32_16x16x32_bf16 v[100:103], v[124:127], v[172:175], 0
    v_mfma_f32_16x16x32_bf16 v[108:111], v[128:131], v[172:175], 0
    .p2align 3
loop_15:
    s_waitcnt lgkmcnt(0)
    s_barrier
    .p2align 3
    v_mfma_f32_16x16x32_bf16 v[0:3], v[176:179], v[136:139], v[0:3]
    ds_read_b64_tr_b16 v[152:153], v202 offset:32768
    v_mfma_f32_16x16x32_bf16 v[8:11], v[176:179], v[140:143], v[8:11]
    ds_read_b64_tr_b16 v[154:155], v202 offset:34816
    v_mfma_f32_16x16x32_bf16 v[16:19], v[176:179], v[144:147], v[16:19]
    ds_read_b128 v[116:119], v200 offset:20480
    v_mfma_f32_16x16x32_bf16 v[24:27], v[176:179], v[148:151], v[24:27]
    ds_read_b128 v[120:123], v200 offset:22528
    v_mfma_f32_16x16x32_bf16 v[4:7], v[180:183], v[136:139], v[4:7]
    ds_read_b128 v[124:127], v200 offset:24576
    v_mfma_f32_16x16x32_bf16 v[12:15], v[180:183], v[140:143], v[12:15]
    v_mfma_f32_16x16x32_bf16 v[20:23], v[180:183], v[144:147], v[20:23]
    ds_read_b128 v[128:131], v200 offset:26624
    v_mfma_f32_16x16x32_bf16 v[28:31], v[180:183], v[148:151], v[28:31]
    ds_read_b64_tr_b16 v[156:157], v203 offset:32768
    v_mfma_f32_16x16x32_bf16 v[32:35], v[184:187], v[132:135], v[32:35]
    ds_read_b64_tr_b16 v[158:159], v203 offset:34816
    v_mfma_f32_16x16x32_bf16 v[40:43], v[184:187], v[136:139], v[40:43]
    ds_read_b64_tr_b16 v[160:161], v202 offset:36864
    v_mfma_f32_16x16x32_bf16 v[48:51], v[184:187], v[140:143], v[48:51]
    v_mfma_f32_16x16x32_bf16 v[56:59], v[184:187], v[144:147], v[56:59]
    ds_read_b64_tr_b16 v[162:163], v202 offset:38912
    v_mfma_f32_16x16x32_bf16 v[64:67], v[184:187], v[148:151], v[64:67]
    ds_read_b128 v[112:115], v200 offset:18432
    v_mfma_f32_16x16x32_bf16 v[36:39], v[188:191], v[132:135], v[36:39]
    ds_read_b64_tr_b16 v[164:165], v203 offset:36864
    v_mfma_f32_16x16x32_bf16 v[44:47], v[188:191], v[136:139], v[44:47]
    ds_read_b64_tr_b16 v[166:167], v203 offset:38912
    v_mfma_f32_16x16x32_bf16 v[52:55], v[188:191], v[140:143], v[52:55]
    v_mfma_f32_16x16x32_bf16 v[60:63], v[188:191], v[144:147], v[60:63]
    ds_read_b64_tr_b16 v[168:169], v202 offset:40960
    v_mfma_f32_16x16x32_bf16 v[68:71], v[188:191], v[148:151], v[68:71]
    ds_read_b64_tr_b16 v[170:171], v202 offset:43008
    v_mfma_f32_16x16x32_bf16 v[72:75], v[132:135], v[192:195], v[72:75]
    ds_read_b64_tr_b16 v[172:173], v203 offset:40960
    v_mfma_f32_16x16x32_bf16 v[80:83], v[136:139], v[192:195], v[80:83]
    ds_read_b64_tr_b16 v[174:175], v203 offset:43008
    v_mfma_f32_16x16x32_bf16 v[88:91], v[140:143], v[192:195], v[88:91]
    v_mfma_f32_16x16x32_bf16 v[96:99], v[144:147], v[192:195], v[96:99]
    v_mfma_f32_16x16x32_bf16 v[104:107], v[148:151], v[192:195], v[104:107]
    v_mfma_f32_16x16x32_bf16 v[76:79], v[132:135], v[196:199], v[76:79]
    v_mfma_f32_16x16x32_bf16 v[84:87], v[136:139], v[196:199], v[84:87]
    v_mfma_f32_16x16x32_bf16 v[92:95], v[140:143], v[196:199], v[92:95]
    v_mfma_f32_16x16x32_bf16 v[100:103], v[144:147], v[196:199], v[100:103]
    v_mfma_f32_16x16x32_bf16 v[108:111], v[148:151], v[196:199], v[108:111]
    s_waitcnt vmcnt(0) lgkmcnt(0)
    s_barrier
    .p2align 3
    v_mfma_f32_16x16x32_bf16 v[0:3], v[152:155], v[116:119], v[0:3]
    ds_read_b64_tr_b16 v[176:177], v204 offset:0
    v_mfma_f32_16x16x32_bf16 v[8:11], v[152:155], v[120:123], v[8:11]
    ds_read_b64_tr_b16 v[178:179], v204 offset:2048
    v_mfma_f32_16x16x32_bf16 v[16:19], v[152:155], v[124:127], v[16:19]
    ds_read_b128 v[136:139], v201 offset:20480
    v_mfma_f32_16x16x32_bf16 v[24:27], v[152:155], v[128:131], v[24:27]
    ds_read_b128 v[140:143], v201 offset:22528
    v_mfma_f32_16x16x32_bf16 v[4:7], v[156:159], v[116:119], v[4:7]
    ds_read_b128 v[144:147], v201 offset:24576
    v_mfma_f32_16x16x32_bf16 v[12:15], v[156:159], v[120:123], v[12:15]
    v_mfma_f32_16x16x32_bf16 v[20:23], v[156:159], v[124:127], v[20:23]
    ds_read_b128 v[148:151], v201 offset:26624
    v_mfma_f32_16x16x32_bf16 v[28:31], v[156:159], v[128:131], v[28:31]
    ds_read_b64_tr_b16 v[180:181], v205 offset:0
    v_mfma_f32_16x16x32_bf16 v[32:35], v[160:163], v[112:115], v[32:35]
    ds_read_b64_tr_b16 v[182:183], v205 offset:2048
    v_mfma_f32_16x16x32_bf16 v[40:43], v[160:163], v[116:119], v[40:43]
    ds_read_b64_tr_b16 v[184:185], v204 offset:4096
    v_mfma_f32_16x16x32_bf16 v[48:51], v[160:163], v[120:123], v[48:51]
    v_mfma_f32_16x16x32_bf16 v[56:59], v[160:163], v[124:127], v[56:59]
    ds_read_b64_tr_b16 v[186:187], v204 offset:6144
    v_mfma_f32_16x16x32_bf16 v[64:67], v[160:163], v[128:131], v[64:67]
    ds_read_b128 v[132:135], v201 offset:18432
    v_mfma_f32_16x16x32_bf16 v[36:39], v[164:167], v[112:115], v[36:39]
    ds_read_b64_tr_b16 v[188:189], v205 offset:4096
    v_mfma_f32_16x16x32_bf16 v[44:47], v[164:167], v[116:119], v[44:47]
    ds_read_b64_tr_b16 v[190:191], v205 offset:6144
    v_mfma_f32_16x16x32_bf16 v[52:55], v[164:167], v[120:123], v[52:55]
    v_mfma_f32_16x16x32_bf16 v[60:63], v[164:167], v[124:127], v[60:63]
    ds_read_b64_tr_b16 v[192:193], v204 offset:8192
    v_mfma_f32_16x16x32_bf16 v[68:71], v[164:167], v[128:131], v[68:71]
    ds_read_b64_tr_b16 v[194:195], v204 offset:10240
    v_mfma_f32_16x16x32_bf16 v[72:75], v[112:115], v[168:171], v[72:75]
    ds_read_b64_tr_b16 v[196:197], v205 offset:8192
    v_mfma_f32_16x16x32_bf16 v[80:83], v[116:119], v[168:171], v[80:83]
    ds_read_b64_tr_b16 v[198:199], v205 offset:10240
    v_mfma_f32_16x16x32_bf16 v[88:91], v[120:123], v[168:171], v[88:91]
    v_mfma_f32_16x16x32_bf16 v[96:99], v[124:127], v[168:171], v[96:99]
    v_mfma_f32_16x16x32_bf16 v[104:107], v[128:131], v[168:171], v[104:107]
    v_mfma_f32_16x16x32_bf16 v[76:79], v[112:115], v[172:175], v[76:79]
    v_mfma_f32_16x16x32_bf16 v[84:87], v[116:119], v[172:175], v[84:87]
    v_mfma_f32_16x16x32_bf16 v[92:95], v[120:123], v[172:175], v[92:95]
    v_mfma_f32_16x16x32_bf16 v[100:103], v[124:127], v[172:175], v[100:103]
    v_mfma_f32_16x16x32_bf16 v[108:111], v[128:131], v[172:175], v[108:111]
    s_waitcnt lgkmcnt(0)
    s_barrier
    .p2align 3
    v_mfma_f32_16x16x32_bf16 v[0:3], v[176:179], v[136:139], v[0:3]
    ds_read_b64_tr_b16 v[152:153], v204 offset:16384
    v_mfma_f32_16x16x32_bf16 v[8:11], v[176:179], v[140:143], v[8:11]
    ds_read_b64_tr_b16 v[154:155], v204 offset:18432
    v_mfma_f32_16x16x32_bf16 v[16:19], v[176:179], v[144:147], v[16:19]
    ds_read_b128 v[116:119], v200 offset:38912
    v_mfma_f32_16x16x32_bf16 v[24:27], v[176:179], v[148:151], v[24:27]
    ds_read_b128 v[120:123], v200 offset:40960
    v_mfma_f32_16x16x32_bf16 v[4:7], v[180:183], v[136:139], v[4:7]
    ds_read_b128 v[124:127], v200 offset:43008
    v_mfma_f32_16x16x32_bf16 v[12:15], v[180:183], v[140:143], v[12:15]
    v_mfma_f32_16x16x32_bf16 v[20:23], v[180:183], v[144:147], v[20:23]
    ds_read_b128 v[128:131], v200 offset:45056
    v_mfma_f32_16x16x32_bf16 v[28:31], v[180:183], v[148:151], v[28:31]
    ds_read_b64_tr_b16 v[156:157], v205 offset:16384
    v_mfma_f32_16x16x32_bf16 v[32:35], v[184:187], v[132:135], v[32:35]
    ds_read_b64_tr_b16 v[158:159], v205 offset:18432
    v_mfma_f32_16x16x32_bf16 v[40:43], v[184:187], v[136:139], v[40:43]
    ds_read_b64_tr_b16 v[160:161], v204 offset:20480
    v_mfma_f32_16x16x32_bf16 v[48:51], v[184:187], v[140:143], v[48:51]
    v_mfma_f32_16x16x32_bf16 v[56:59], v[184:187], v[144:147], v[56:59]
    ds_read_b64_tr_b16 v[162:163], v204 offset:22528
    v_mfma_f32_16x16x32_bf16 v[64:67], v[184:187], v[148:151], v[64:67]
    ds_read_b128 v[112:115], v200 offset:36864
    v_mfma_f32_16x16x32_bf16 v[36:39], v[188:191], v[132:135], v[36:39]
    ds_read_b64_tr_b16 v[164:165], v205 offset:20480
    v_mfma_f32_16x16x32_bf16 v[44:47], v[188:191], v[136:139], v[44:47]
    ds_read_b64_tr_b16 v[166:167], v205 offset:22528
    v_mfma_f32_16x16x32_bf16 v[52:55], v[188:191], v[140:143], v[52:55]
    v_mfma_f32_16x16x32_bf16 v[60:63], v[188:191], v[144:147], v[60:63]
    ds_read_b64_tr_b16 v[168:169], v204 offset:24576
    v_mfma_f32_16x16x32_bf16 v[68:71], v[188:191], v[148:151], v[68:71]
    ds_read_b64_tr_b16 v[170:171], v204 offset:26624
    v_mfma_f32_16x16x32_bf16 v[72:75], v[132:135], v[192:195], v[72:75]
    ds_read_b64_tr_b16 v[172:173], v205 offset:24576
    v_mfma_f32_16x16x32_bf16 v[80:83], v[136:139], v[192:195], v[80:83]
    ds_read_b64_tr_b16 v[174:175], v205 offset:26624
    v_mfma_f32_16x16x32_bf16 v[88:91], v[140:143], v[192:195], v[88:91]
    v_mfma_f32_16x16x32_bf16 v[96:99], v[144:147], v[192:195], v[96:99]
    v_mfma_f32_16x16x32_bf16 v[104:107], v[148:151], v[192:195], v[104:107]
    v_mfma_f32_16x16x32_bf16 v[76:79], v[132:135], v[196:199], v[76:79]
    v_mfma_f32_16x16x32_bf16 v[84:87], v[136:139], v[196:199], v[84:87]
    v_mfma_f32_16x16x32_bf16 v[92:95], v[140:143], v[196:199], v[92:95]
    v_mfma_f32_16x16x32_bf16 v[100:103], v[144:147], v[196:199], v[100:103]
    v_mfma_f32_16x16x32_bf16 v[108:111], v[148:151], v[196:199], v[108:111]
    s_waitcnt lgkmcnt(0)
    s_barrier
    .p2align 3
    v_mfma_f32_16x16x32_bf16 v[0:3], v[152:155], v[116:119], v[0:3]
    ds_read_b64_tr_b16 v[176:177], v204 offset:32768
    v_mfma_f32_16x16x32_bf16 v[8:11], v[152:155], v[120:123], v[8:11]
    ds_read_b64_tr_b16 v[178:179], v204 offset:34816
    v_mfma_f32_16x16x32_bf16 v[16:19], v[152:155], v[124:127], v[16:19]
    ds_read_b128 v[136:139], v201 offset:38912
    v_mfma_f32_16x16x32_bf16 v[24:27], v[152:155], v[128:131], v[24:27]
    ds_read_b128 v[140:143], v201 offset:40960
    v_mfma_f32_16x16x32_bf16 v[4:7], v[156:159], v[116:119], v[4:7]
    ds_read_b128 v[144:147], v201 offset:43008
    v_mfma_f32_16x16x32_bf16 v[12:15], v[156:159], v[120:123], v[12:15]
    v_mfma_f32_16x16x32_bf16 v[20:23], v[156:159], v[124:127], v[20:23]
    ds_read_b128 v[148:151], v201 offset:45056
    v_mfma_f32_16x16x32_bf16 v[28:31], v[156:159], v[128:131], v[28:31]
    ds_read_b64_tr_b16 v[180:181], v205 offset:32768
    v_mfma_f32_16x16x32_bf16 v[32:35], v[160:163], v[112:115], v[32:35]
    ds_read_b64_tr_b16 v[182:183], v205 offset:34816
    v_mfma_f32_16x16x32_bf16 v[40:43], v[160:163], v[116:119], v[40:43]
    ds_read_b64_tr_b16 v[184:185], v204 offset:36864
    v_mfma_f32_16x16x32_bf16 v[48:51], v[160:163], v[120:123], v[48:51]
    v_mfma_f32_16x16x32_bf16 v[56:59], v[160:163], v[124:127], v[56:59]
    ds_read_b64_tr_b16 v[186:187], v204 offset:38912
    v_mfma_f32_16x16x32_bf16 v[64:67], v[160:163], v[128:131], v[64:67]
    ds_read_b128 v[132:135], v201 offset:36864
    v_mfma_f32_16x16x32_bf16 v[36:39], v[164:167], v[112:115], v[36:39]
    ds_read_b64_tr_b16 v[188:189], v205 offset:36864
    v_mfma_f32_16x16x32_bf16 v[44:47], v[164:167], v[116:119], v[44:47]
    ds_read_b64_tr_b16 v[190:191], v205 offset:38912
    v_mfma_f32_16x16x32_bf16 v[52:55], v[164:167], v[120:123], v[52:55]
    v_mfma_f32_16x16x32_bf16 v[60:63], v[164:167], v[124:127], v[60:63]
    ds_read_b64_tr_b16 v[192:193], v204 offset:40960
    v_mfma_f32_16x16x32_bf16 v[68:71], v[164:167], v[128:131], v[68:71]
    ds_read_b64_tr_b16 v[194:195], v204 offset:43008
    v_mfma_f32_16x16x32_bf16 v[72:75], v[112:115], v[168:171], v[72:75]
    ds_read_b64_tr_b16 v[196:197], v205 offset:40960
    v_mfma_f32_16x16x32_bf16 v[80:83], v[116:119], v[168:171], v[80:83]
    ds_read_b64_tr_b16 v[198:199], v205 offset:43008
    v_mfma_f32_16x16x32_bf16 v[88:91], v[120:123], v[168:171], v[88:91]
    v_mfma_f32_16x16x32_bf16 v[96:99], v[124:127], v[168:171], v[96:99]
    v_mfma_f32_16x16x32_bf16 v[104:107], v[128:131], v[168:171], v[104:107]
    v_mfma_f32_16x16x32_bf16 v[76:79], v[112:115], v[172:175], v[76:79]
    v_mfma_f32_16x16x32_bf16 v[84:87], v[116:119], v[172:175], v[84:87]
    v_mfma_f32_16x16x32_bf16 v[92:95], v[120:123], v[172:175], v[92:95]
    v_mfma_f32_16x16x32_bf16 v[100:103], v[124:127], v[172:175], v[100:103]
    v_mfma_f32_16x16x32_bf16 v[108:111], v[128:131], v[172:175], v[108:111]
    s_waitcnt lgkmcnt(0)
    s_barrier
    .p2align 3
    v_mfma_f32_16x16x32_bf16 v[0:3], v[176:179], v[136:139], v[0:3]
    ds_read_b64_tr_b16 v[152:153], v202 offset:0
    v_mfma_f32_16x16x32_bf16 v[8:11], v[176:179], v[140:143], v[8:11]
    ds_read_b64_tr_b16 v[154:155], v202 offset:2048
    v_mfma_f32_16x16x32_bf16 v[16:19], v[176:179], v[144:147], v[16:19]
    ds_read_b128 v[116:119], v200 offset:2048
    v_mfma_f32_16x16x32_bf16 v[24:27], v[176:179], v[148:151], v[24:27]
    ds_read_b128 v[120:123], v200 offset:4096
    v_mfma_f32_16x16x32_bf16 v[4:7], v[180:183], v[136:139], v[4:7]
    ds_read_b128 v[124:127], v200 offset:6144
    v_mfma_f32_16x16x32_bf16 v[12:15], v[180:183], v[140:143], v[12:15]
    v_mfma_f32_16x16x32_bf16 v[20:23], v[180:183], v[144:147], v[20:23]
    ds_read_b128 v[128:131], v200 offset:8192
    v_mfma_f32_16x16x32_bf16 v[28:31], v[180:183], v[148:151], v[28:31]
    ds_read_b64_tr_b16 v[156:157], v203 offset:0
    v_mfma_f32_16x16x32_bf16 v[32:35], v[184:187], v[132:135], v[32:35]
    ds_read_b64_tr_b16 v[158:159], v203 offset:2048
    v_mfma_f32_16x16x32_bf16 v[40:43], v[184:187], v[136:139], v[40:43]
    ds_read_b64_tr_b16 v[160:161], v202 offset:4096
    v_mfma_f32_16x16x32_bf16 v[48:51], v[184:187], v[140:143], v[48:51]
    v_mfma_f32_16x16x32_bf16 v[56:59], v[184:187], v[144:147], v[56:59]
    ds_read_b64_tr_b16 v[162:163], v202 offset:6144
    v_mfma_f32_16x16x32_bf16 v[64:67], v[184:187], v[148:151], v[64:67]
    ds_read_b128 v[112:115], v200 offset:0
    v_mfma_f32_16x16x32_bf16 v[36:39], v[188:191], v[132:135], v[36:39]
    ds_read_b64_tr_b16 v[164:165], v203 offset:4096
    v_mfma_f32_16x16x32_bf16 v[44:47], v[188:191], v[136:139], v[44:47]
    ds_read_b64_tr_b16 v[166:167], v203 offset:6144
    v_mfma_f32_16x16x32_bf16 v[52:55], v[188:191], v[140:143], v[52:55]
    v_mfma_f32_16x16x32_bf16 v[60:63], v[188:191], v[144:147], v[60:63]
    ds_read_b64_tr_b16 v[168:169], v202 offset:8192
    v_mfma_f32_16x16x32_bf16 v[68:71], v[188:191], v[148:151], v[68:71]
    ds_read_b64_tr_b16 v[170:171], v202 offset:10240
    v_mfma_f32_16x16x32_bf16 v[72:75], v[132:135], v[192:195], v[72:75]
    ds_read_b64_tr_b16 v[172:173], v203 offset:8192
    v_mfma_f32_16x16x32_bf16 v[80:83], v[136:139], v[192:195], v[80:83]
    ds_read_b64_tr_b16 v[174:175], v203 offset:10240
    v_mfma_f32_16x16x32_bf16 v[88:91], v[140:143], v[192:195], v[88:91]
    v_mfma_f32_16x16x32_bf16 v[96:99], v[144:147], v[192:195], v[96:99]
    v_mfma_f32_16x16x32_bf16 v[104:107], v[148:151], v[192:195], v[104:107]
    v_mfma_f32_16x16x32_bf16 v[76:79], v[132:135], v[196:199], v[76:79]
    v_mfma_f32_16x16x32_bf16 v[84:87], v[136:139], v[196:199], v[84:87]
    v_mfma_f32_16x16x32_bf16 v[92:95], v[140:143], v[196:199], v[92:95]
    v_mfma_f32_16x16x32_bf16 v[100:103], v[144:147], v[196:199], v[100:103]
    v_mfma_f32_16x16x32_bf16 v[108:111], v[148:151], v[196:199], v[108:111]
    s_waitcnt lgkmcnt(0)
    s_barrier
    .p2align 3
    v_mfma_f32_16x16x32_bf16 v[0:3], v[152:155], v[116:119], v[0:3]
    ds_read_b64_tr_b16 v[176:177], v202 offset:16384
    v_mfma_f32_16x16x32_bf16 v[8:11], v[152:155], v[120:123], v[8:11]
    ds_read_b64_tr_b16 v[178:179], v202 offset:18432
    v_mfma_f32_16x16x32_bf16 v[16:19], v[152:155], v[124:127], v[16:19]
    ds_read_b128 v[136:139], v201 offset:2048
    v_mfma_f32_16x16x32_bf16 v[24:27], v[152:155], v[128:131], v[24:27]
    ds_read_b128 v[140:143], v201 offset:4096
    v_mfma_f32_16x16x32_bf16 v[4:7], v[156:159], v[116:119], v[4:7]
    ds_read_b128 v[144:147], v201 offset:6144
    v_mfma_f32_16x16x32_bf16 v[12:15], v[156:159], v[120:123], v[12:15]
    v_mfma_f32_16x16x32_bf16 v[20:23], v[156:159], v[124:127], v[20:23]
    ds_read_b128 v[148:151], v201 offset:8192
    v_mfma_f32_16x16x32_bf16 v[28:31], v[156:159], v[128:131], v[28:31]
    ds_read_b64_tr_b16 v[180:181], v203 offset:16384
    v_mfma_f32_16x16x32_bf16 v[32:35], v[160:163], v[112:115], v[32:35]
    ds_read_b64_tr_b16 v[182:183], v203 offset:18432
    v_mfma_f32_16x16x32_bf16 v[40:43], v[160:163], v[116:119], v[40:43]
    ds_read_b64_tr_b16 v[184:185], v202 offset:20480
    v_mfma_f32_16x16x32_bf16 v[48:51], v[160:163], v[120:123], v[48:51]
    v_mfma_f32_16x16x32_bf16 v[56:59], v[160:163], v[124:127], v[56:59]
    ds_read_b64_tr_b16 v[186:187], v202 offset:22528
    v_mfma_f32_16x16x32_bf16 v[64:67], v[160:163], v[128:131], v[64:67]
    ds_read_b128 v[132:135], v201 offset:0
    v_mfma_f32_16x16x32_bf16 v[36:39], v[164:167], v[112:115], v[36:39]
    ds_read_b64_tr_b16 v[188:189], v203 offset:20480
    v_mfma_f32_16x16x32_bf16 v[44:47], v[164:167], v[116:119], v[44:47]
    ds_read_b64_tr_b16 v[190:191], v203 offset:22528
    v_mfma_f32_16x16x32_bf16 v[52:55], v[164:167], v[120:123], v[52:55]
    v_mfma_f32_16x16x32_bf16 v[60:63], v[164:167], v[124:127], v[60:63]
    ds_read_b64_tr_b16 v[192:193], v202 offset:24576
    v_mfma_f32_16x16x32_bf16 v[68:71], v[164:167], v[128:131], v[68:71]
    ds_read_b64_tr_b16 v[194:195], v202 offset:26624
    v_mfma_f32_16x16x32_bf16 v[72:75], v[112:115], v[168:171], v[72:75]
    ds_read_b64_tr_b16 v[196:197], v203 offset:24576
    v_mfma_f32_16x16x32_bf16 v[80:83], v[116:119], v[168:171], v[80:83]
    ds_read_b64_tr_b16 v[198:199], v203 offset:26624
    v_mfma_f32_16x16x32_bf16 v[88:91], v[120:123], v[168:171], v[88:91]
    v_mfma_f32_16x16x32_bf16 v[96:99], v[124:127], v[168:171], v[96:99]
    v_mfma_f32_16x16x32_bf16 v[104:107], v[128:131], v[168:171], v[104:107]
    v_mfma_f32_16x16x32_bf16 v[76:79], v[112:115], v[172:175], v[76:79]
    v_mfma_f32_16x16x32_bf16 v[84:87], v[116:119], v[172:175], v[84:87]
    s_sub_u32 s58, s58, 1
    s_cmp_lg_u32 s58, 0
    .p2align 3
    v_mfma_f32_16x16x32_bf16 v[92:95], v[120:123], v[172:175], v[92:95]
    v_mfma_f32_16x16x32_bf16 v[100:103], v[124:127], v[172:175], v[100:103]
    v_mfma_f32_16x16x32_bf16 v[108:111], v[128:131], v[172:175], v[108:111]
    s_cbranch_scc1 loop_15
    s_waitcnt lgkmcnt(0)
    s_barrier
    .p2align 3
    v_mfma_f32_16x16x32_bf16 v[0:3], v[176:179], v[136:139], v[0:3]
    ds_read_b128 v[152:155], v220 offset:0
    v_mfma_f32_16x16x32_bf16 v[8:11], v[176:179], v[140:143], v[8:11]
    ds_read_b128 v[156:159], v220 offset:64
    v_mfma_f32_16x16x32_bf16 v[16:19], v[176:179], v[144:147], v[16:19]
    ds_read_b128 v[160:163], v220 offset:256
    v_mfma_f32_16x16x32_bf16 v[24:27], v[176:179], v[148:151], v[24:27]
    ds_read_b128 v[164:167], v220 offset:320
    v_mfma_f32_16x16x32_bf16 v[4:7], v[180:183], v[136:139], v[4:7]
    ds_read_b32 v112, v218 offset:0
    v_mfma_f32_16x16x32_bf16 v[12:15], v[180:183], v[140:143], v[12:15]
    v_mfma_f32_16x16x32_bf16 v[20:23], v[180:183], v[144:147], v[20:23]
    ds_read_b32 v113, v218 offset:64
    v_mfma_f32_16x16x32_bf16 v[28:31], v[180:183], v[148:151], v[28:31]
    ds_read_b32 v114, v218 offset:128
    v_mfma_f32_16x16x32_bf16 v[32:35], v[184:187], v[132:135], v[32:35]
    ds_read_b32 v115, v218 offset:192
    v_mfma_f32_16x16x32_bf16 v[40:43], v[184:187], v[136:139], v[40:43]
    ds_read_b32 v116, v218 offset:256
    v_mfma_f32_16x16x32_bf16 v[48:51], v[184:187], v[140:143], v[48:51]
    v_mfma_f32_16x16x32_bf16 v[56:59], v[184:187], v[144:147], v[56:59]
    ds_read_b32 v118, v218 offset:576
    v_mfma_f32_16x16x32_bf16 v[64:67], v[184:187], v[148:151], v[64:67]
    ds_read_b32 v119, v218 offset:640
    v_mfma_f32_16x16x32_bf16 v[36:39], v[188:191], v[132:135], v[36:39]
    ds_read_b32 v120, v218 offset:704
    v_mfma_f32_16x16x32_bf16 v[44:47], v[188:191], v[136:139], v[44:47]
    ds_read_b32 v121, v218 offset:768
    v_mfma_f32_16x16x32_bf16 v[52:55], v[188:191], v[140:143], v[52:55]
    v_mfma_f32_16x16x32_bf16 v[60:63], v[188:191], v[144:147], v[60:63]
    ds_read_b32 v122, v218 offset:832
    v_mfma_f32_16x16x32_bf16 v[68:71], v[188:191], v[148:151], v[68:71]
    ds_read_b32 v168, v221 offset:512
    v_mfma_f32_16x16x32_bf16 v[72:75], v[132:135], v[192:195], v[72:75]
    ds_read_b32 v169, v221 offset:576
    v_mfma_f32_16x16x32_bf16 v[80:83], v[136:139], v[192:195], v[80:83]
    ds_read_b32 v170, v213
    v_mfma_f32_16x16x32_bf16 v[88:91], v[140:143], v[192:195], v[88:91]
    v_mfma_f32_16x16x32_bf16 v[96:99], v[144:147], v[192:195], v[96:99]
    v_mfma_f32_16x16x32_bf16 v[104:107], v[148:151], v[192:195], v[104:107]
    v_mfma_f32_16x16x32_bf16 v[76:79], v[132:135], v[196:199], v[76:79]
    v_mfma_f32_16x16x32_bf16 v[84:87], v[136:139], v[196:199], v[84:87]
    v_mfma_f32_16x16x32_bf16 v[92:95], v[140:143], v[196:199], v[92:95]
    v_mfma_f32_16x16x32_bf16 v[100:103], v[144:147], v[196:199], v[100:103]
    v_mfma_f32_16x16x32_bf16 v[108:111], v[148:151], v[196:199], v[108:111]
    s_waitcnt lgkmcnt(0)
    .p2align 3
    ds_read_b128 v[132:135], v219 offset:0
    ds_read_b128 v[176:179], v219 offset:576
    ds_read_b128 v[136:139], v219 offset:64
    ds_read_b128 v[180:183], v219 offset:640
    ds_read_b128 v[140:143], v219 offset:128
    ds_read_b128 v[184:187], v219 offset:704
    ds_read_b128 v[144:147], v219 offset:192
    ds_read_b128 v[188:191], v219 offset:768
    ds_read_b128 v[148:151], v219 offset:256
    ds_read_b128 v[192:195], v219 offset:832
    v_pk_fma_f32 v[0:1], v[112:113], v[152:153], v[0:1] op_sel:[1,0,0] op_sel_hi:[1,1,1]
    v_pk_fma_f32 v[2:3], v[112:113], v[154:155], v[2:3] op_sel:[1,0,0] op_sel_hi:[1,1,1]
    v_pk_fma_f32 v[4:5], v[112:113], v[156:157], v[4:5] op_sel:[1,0,0] op_sel_hi:[1,1,1]
    v_pk_fma_f32 v[6:7], v[112:113], v[158:159], v[6:7] op_sel:[1,0,0] op_sel_hi:[1,1,1]
    v_pk_fma_f32 v[8:9], v[114:115], v[152:153], v[8:9] op_sel:[0,0,0] op_sel_hi:[0,1,1]
    v_pk_fma_f32 v[10:11], v[114:115], v[154:155], v[10:11] op_sel:[0,0,0] op_sel_hi:[0,1,1]
    v_pk_fma_f32 v[12:13], v[114:115], v[156:157], v[12:13] op_sel:[0,0,0] op_sel_hi:[0,1,1]
    v_pk_fma_f32 v[14:15], v[114:115], v[158:159], v[14:15] op_sel:[0,0,0] op_sel_hi:[0,1,1]
    v_pk_fma_f32 v[16:17], v[114:115], v[152:153], v[16:17] op_sel:[1,0,0] op_sel_hi:[1,1,1]
    v_pk_fma_f32 v[18:19], v[114:115], v[154:155], v[18:19] op_sel:[1,0,0] op_sel_hi:[1,1,1]
    v_pk_fma_f32 v[20:21], v[114:115], v[156:157], v[20:21] op_sel:[1,0,0] op_sel_hi:[1,1,1]
    v_pk_fma_f32 v[22:23], v[114:115], v[158:159], v[22:23] op_sel:[1,0,0] op_sel_hi:[1,1,1]
    v_pk_fma_f32 v[24:25], v[116:117], v[152:153], v[24:25] op_sel:[0,0,0] op_sel_hi:[0,1,1]
    v_pk_fma_f32 v[26:27], v[116:117], v[154:155], v[26:27] op_sel:[0,0,0] op_sel_hi:[0,1,1]
    v_pk_fma_f32 v[28:29], v[116:117], v[156:157], v[28:29] op_sel:[0,0,0] op_sel_hi:[0,1,1]
    v_pk_fma_f32 v[30:31], v[116:117], v[158:159], v[30:31] op_sel:[0,0,0] op_sel_hi:[0,1,1]
    v_pk_fma_f32 v[32:33], v[112:113], v[160:161], v[32:33] op_sel:[0,0,0] op_sel_hi:[0,1,1]
    v_pk_fma_f32 v[34:35], v[112:113], v[162:163], v[34:35] op_sel:[0,0,0] op_sel_hi:[0,1,1]
    v_pk_fma_f32 v[36:37], v[112:113], v[164:165], v[36:37] op_sel:[0,0,0] op_sel_hi:[0,1,1]
    v_pk_fma_f32 v[38:39], v[112:113], v[166:167], v[38:39] op_sel:[0,0,0] op_sel_hi:[0,1,1]
    v_pk_fma_f32 v[40:41], v[112:113], v[160:161], v[40:41] op_sel:[1,0,0] op_sel_hi:[1,1,1]
    v_pk_fma_f32 v[42:43], v[112:113], v[162:163], v[42:43] op_sel:[1,0,0] op_sel_hi:[1,1,1]
    v_pk_fma_f32 v[44:45], v[112:113], v[164:165], v[44:45] op_sel:[1,0,0] op_sel_hi:[1,1,1]
    v_pk_fma_f32 v[46:47], v[112:113], v[166:167], v[46:47] op_sel:[1,0,0] op_sel_hi:[1,1,1]
    v_pk_fma_f32 v[48:49], v[114:115], v[160:161], v[48:49] op_sel:[0,0,0] op_sel_hi:[0,1,1]
    v_pk_fma_f32 v[50:51], v[114:115], v[162:163], v[50:51] op_sel:[0,0,0] op_sel_hi:[0,1,1]
    v_pk_fma_f32 v[52:53], v[114:115], v[164:165], v[52:53] op_sel:[0,0,0] op_sel_hi:[0,1,1]
    v_pk_fma_f32 v[54:55], v[114:115], v[166:167], v[54:55] op_sel:[0,0,0] op_sel_hi:[0,1,1]
    v_pk_fma_f32 v[56:57], v[114:115], v[160:161], v[56:57] op_sel:[1,0,0] op_sel_hi:[1,1,1]
    v_pk_fma_f32 v[58:59], v[114:115], v[162:163], v[58:59] op_sel:[1,0,0] op_sel_hi:[1,1,1]
    v_pk_fma_f32 v[60:61], v[114:115], v[164:165], v[60:61] op_sel:[1,0,0] op_sel_hi:[1,1,1]
    v_pk_fma_f32 v[62:63], v[114:115], v[166:167], v[62:63] op_sel:[1,0,0] op_sel_hi:[1,1,1]
    v_pk_fma_f32 v[64:65], v[116:117], v[160:161], v[64:65] op_sel:[0,0,0] op_sel_hi:[0,1,1]
    v_pk_fma_f32 v[66:67], v[116:117], v[162:163], v[66:67] op_sel:[0,0,0] op_sel_hi:[0,1,1]
    v_pk_fma_f32 v[68:69], v[116:117], v[164:165], v[68:69] op_sel:[0,0,0] op_sel_hi:[0,1,1]
    v_pk_fma_f32 v[70:71], v[116:117], v[166:167], v[70:71] op_sel:[0,0,0] op_sel_hi:[0,1,1]
    v_cvt_pk_bf16_f32 v0, v0, v1
    v_cvt_pk_bf16_f32 v1, v2, v3
    v_cvt_pk_bf16_f32 v2, v4, v5
    v_cvt_pk_bf16_f32 v3, v6, v7
    v_cvt_pk_bf16_f32 v8, v8, v9
    v_cvt_pk_bf16_f32 v9, v10, v11
    v_cvt_pk_bf16_f32 v10, v12, v13
    v_cvt_pk_bf16_f32 v11, v14, v15
    v_cvt_pk_bf16_f32 v16, v16, v17
    v_cvt_pk_bf16_f32 v17, v18, v19
    v_cvt_pk_bf16_f32 v18, v20, v21
    v_cvt_pk_bf16_f32 v19, v22, v23
    v_cvt_pk_bf16_f32 v24, v24, v25
    v_cvt_pk_bf16_f32 v25, v26, v27
    v_cvt_pk_bf16_f32 v26, v28, v29
    v_cvt_pk_bf16_f32 v27, v30, v31
    v_pk_mul_f32 v[32:33], v[118:119], v[32:33] op_sel:[0,0] op_sel_hi:[0,1]
    v_pk_mul_f32 v[34:35], v[118:119], v[34:35] op_sel:[0,0] op_sel_hi:[0,1]
    v_pk_mul_f32 v[36:37], v[118:119], v[36:37] op_sel:[0,0] op_sel_hi:[0,1]
    v_pk_mul_f32 v[38:39], v[118:119], v[38:39] op_sel:[0,0] op_sel_hi:[0,1]
    v_pk_mul_f32 v[40:41], v[118:119], v[40:41] op_sel:[1,0] op_sel_hi:[1,1]
    v_pk_mul_f32 v[42:43], v[118:119], v[42:43] op_sel:[1,0] op_sel_hi:[1,1]
    v_pk_mul_f32 v[44:45], v[118:119], v[44:45] op_sel:[1,0] op_sel_hi:[1,1]
    v_pk_mul_f32 v[46:47], v[118:119], v[46:47] op_sel:[1,0] op_sel_hi:[1,1]
    v_pk_mul_f32 v[48:49], v[120:121], v[48:49] op_sel:[0,0] op_sel_hi:[0,1]
    v_pk_mul_f32 v[50:51], v[120:121], v[50:51] op_sel:[0,0] op_sel_hi:[0,1]
    v_pk_mul_f32 v[52:53], v[120:121], v[52:53] op_sel:[0,0] op_sel_hi:[0,1]
    v_pk_mul_f32 v[54:55], v[120:121], v[54:55] op_sel:[0,0] op_sel_hi:[0,1]
    v_pk_mul_f32 v[56:57], v[120:121], v[56:57] op_sel:[1,0] op_sel_hi:[1,1]
    v_pk_mul_f32 v[58:59], v[120:121], v[58:59] op_sel:[1,0] op_sel_hi:[1,1]
    v_pk_mul_f32 v[60:61], v[120:121], v[60:61] op_sel:[1,0] op_sel_hi:[1,1]
    v_pk_mul_f32 v[62:63], v[120:121], v[62:63] op_sel:[1,0] op_sel_hi:[1,1]
    v_pk_mul_f32 v[64:65], v[122:123], v[64:65] op_sel:[0,0] op_sel_hi:[0,1]
    v_pk_mul_f32 v[66:67], v[122:123], v[66:67] op_sel:[0,0] op_sel_hi:[0,1]
    v_pk_mul_f32 v[68:69], v[122:123], v[68:69] op_sel:[0,0] op_sel_hi:[0,1]
    v_pk_mul_f32 v[70:71], v[122:123], v[70:71] op_sel:[0,0] op_sel_hi:[0,1]
    v_cvt_pk_bf16_f32 v32, v32, v33
    v_cvt_pk_bf16_f32 v33, v34, v35
    v_cvt_pk_bf16_f32 v34, v36, v37
    v_cvt_pk_bf16_f32 v35, v38, v39
    v_cvt_pk_bf16_f32 v40, v40, v41
    v_cvt_pk_bf16_f32 v41, v42, v43
    v_cvt_pk_bf16_f32 v42, v44, v45
    v_cvt_pk_bf16_f32 v43, v46, v47
    v_cvt_pk_bf16_f32 v48, v48, v49
    v_cvt_pk_bf16_f32 v49, v50, v51
    v_cvt_pk_bf16_f32 v50, v52, v53
    v_cvt_pk_bf16_f32 v51, v54, v55
    v_cvt_pk_bf16_f32 v56, v56, v57
    v_cvt_pk_bf16_f32 v57, v58, v59
    v_cvt_pk_bf16_f32 v58, v60, v61
    v_cvt_pk_bf16_f32 v59, v62, v63
    v_cvt_pk_bf16_f32 v64, v64, v65
    v_cvt_pk_bf16_f32 v65, v66, v67
    v_cvt_pk_bf16_f32 v66, v68, v69
    v_cvt_pk_bf16_f32 v67, v70, v71
    v_readfirstlane_b32 s45, v170
    s_waitcnt lgkmcnt(0)
    v_mfma_f32_16x16x32_bf16 v[4:7], v[40:43], v[0:3], 0
    v_mfma_f32_16x16x32_bf16 v[44:47], v[32:35], v[0:3], 0
    v_mfma_f32_16x16x32_bf16 v[12:15], v[48:51], v[8:11], 0
    v_mfma_f32_16x16x32_bf16 v[52:55], v[40:43], v[8:11], 0
    v_mfma_f32_16x16x32_bf16 v[20:23], v[56:59], v[16:19], 0
    v_mfma_f32_16x16x32_bf16 v[60:63], v[48:51], v[16:19], 0
    v_mfma_f32_16x16x32_bf16 v[28:31], v[64:67], v[24:27], 0
    v_mfma_f32_16x16x32_bf16 v[68:71], v[56:59], v[24:27], 0
    v_pk_fma_f32 v[72:73], v[132:133], v[168:169], v[72:73] op_sel:[0,0,0] op_sel_hi:[1,0,1]
    v_pk_fma_f32 v[74:75], v[134:135], v[168:169], v[74:75] op_sel:[0,0,0] op_sel_hi:[1,0,1]
    v_pk_fma_f32 v[76:77], v[132:133], v[168:169], v[76:77] op_sel:[0,1,0] op_sel_hi:[1,1,1]
    v_pk_fma_f32 v[78:79], v[134:135], v[168:169], v[78:79] op_sel:[0,1,0] op_sel_hi:[1,1,1]
    v_pk_fma_f32 v[80:81], v[136:137], v[168:169], v[80:81] op_sel:[0,0,0] op_sel_hi:[1,0,1]
    v_pk_fma_f32 v[82:83], v[138:139], v[168:169], v[82:83] op_sel:[0,0,0] op_sel_hi:[1,0,1]
    v_pk_fma_f32 v[84:85], v[136:137], v[168:169], v[84:85] op_sel:[0,1,0] op_sel_hi:[1,1,1]
    v_pk_fma_f32 v[86:87], v[138:139], v[168:169], v[86:87] op_sel:[0,1,0] op_sel_hi:[1,1,1]
    v_pk_fma_f32 v[88:89], v[140:141], v[168:169], v[88:89] op_sel:[0,0,0] op_sel_hi:[1,0,1]
    v_pk_fma_f32 v[90:91], v[142:143], v[168:169], v[90:91] op_sel:[0,0,0] op_sel_hi:[1,0,1]
    v_pk_fma_f32 v[92:93], v[140:141], v[168:169], v[92:93] op_sel:[0,1,0] op_sel_hi:[1,1,1]
    v_pk_fma_f32 v[94:95], v[142:143], v[168:169], v[94:95] op_sel:[0,1,0] op_sel_hi:[1,1,1]
    v_pk_fma_f32 v[96:97], v[144:145], v[168:169], v[96:97] op_sel:[0,0,0] op_sel_hi:[1,0,1]
    v_pk_fma_f32 v[98:99], v[146:147], v[168:169], v[98:99] op_sel:[0,0,0] op_sel_hi:[1,0,1]
    v_pk_fma_f32 v[100:101], v[144:145], v[168:169], v[100:101] op_sel:[0,1,0] op_sel_hi:[1,1,1]
    v_pk_fma_f32 v[102:103], v[146:147], v[168:169], v[102:103] op_sel:[0,1,0] op_sel_hi:[1,1,1]
    v_pk_fma_f32 v[104:105], v[148:149], v[168:169], v[104:105] op_sel:[0,0,0] op_sel_hi:[1,0,1]
    v_pk_fma_f32 v[106:107], v[150:151], v[168:169], v[106:107] op_sel:[0,0,0] op_sel_hi:[1,0,1]
    v_pk_fma_f32 v[108:109], v[148:149], v[168:169], v[108:109] op_sel:[0,1,0] op_sel_hi:[1,1,1]
    v_pk_fma_f32 v[110:111], v[150:151], v[168:169], v[110:111] op_sel:[0,1,0] op_sel_hi:[1,1,1]
    v_cndmask_b32 v44, v44, v4, s[72:73]
    v_cndmask_b32 v45, v45, v5, s[74:75]
    v_cndmask_b32 v46, v46, v6, s[76:77]
    v_cndmask_b32 v47, v47, v7, s[78:79]
    v_cndmask_b32 v52, v52, v12, s[72:73]
    v_cndmask_b32 v53, v53, v13, s[74:75]
    v_cndmask_b32 v54, v54, v14, s[76:77]
    v_cndmask_b32 v55, v55, v15, s[78:79]
    v_cndmask_b32 v60, v60, v20, s[72:73]
    v_cndmask_b32 v61, v61, v21, s[74:75]
    v_cndmask_b32 v62, v62, v22, s[76:77]
    v_cndmask_b32 v63, v63, v23, s[78:79]
    v_cndmask_b32 v68, v68, v28, s[72:73]
    v_cndmask_b32 v69, v69, v29, s[74:75]
    v_cndmask_b32 v70, v70, v30, s[76:77]
    v_cndmask_b32 v71, v71, v31, s[78:79]
    v_cndmask_b32 v44, v44, v45, s[80:81]
    v_cndmask_b32 v45, v46, v47, s[80:81]
    v_cndmask_b32 v52, v52, v53, s[80:81]
    v_cndmask_b32 v53, v54, v55, s[80:81]
    v_cndmask_b32 v60, v60, v61, s[80:81]
    v_cndmask_b32 v61, v62, v63, s[80:81]
    v_cndmask_b32 v68, v68, v69, s[80:81]
    v_cndmask_b32 v69, v70, v71, s[80:81]
    v_mov_b32 v209, 0xf149f2ca
    v_cndmask_b32 v44, v44, v209, s[82:83]
    v_cndmask_b32 v45, v45, v209, s[84:85]
    v_max_f32 v46, v44, v45
    v_max_f32 v54, v52, v53
    v_max_f32 v62, v60, v61
    v_max_f32 v70, v68, v69
    v_pk_mul_f32 v[72:73], v[176:177], v[72:73] op_sel:[0,0] op_sel_hi:[1,1]
    v_pk_mul_f32 v[74:75], v[178:179], v[74:75] op_sel:[0,0] op_sel_hi:[1,1]
    v_permlane32_swap_b32 v46, v62
    v_permlane32_swap_b32 v54, v70
    v_max_f32 v46, v46, v62
    v_max_f32 v54, v54, v70
    v_pk_mul_f32 v[76:77], v[176:177], v[76:77] op_sel:[0,0] op_sel_hi:[1,1]
    v_pk_mul_f32 v[78:79], v[178:179], v[78:79] op_sel:[0,0] op_sel_hi:[1,1]
    v_permlane16_swap_b32 v46, v54
    v_max_f32 v46, v46, v54
    v_mov_b32 v54, v46
    v_pk_mul_f32 v[80:81], v[180:181], v[80:81] op_sel:[0,0] op_sel_hi:[1,1]
    v_pk_mul_f32 v[82:83], v[182:183], v[82:83] op_sel:[0,0] op_sel_hi:[1,1]
    v_permlane16_swap_b32 v46, v54
    v_mov_b32 v62, v46
    v_mov_b32 v70, v54
    v_pk_mul_f32 v[84:85], v[180:181], v[84:85] op_sel:[0,0] op_sel_hi:[1,1]
    v_pk_mul_f32 v[86:87], v[182:183], v[86:87] op_sel:[0,0] op_sel_hi:[1,1]
    v_permlane32_swap_b32 v46, v62
    v_permlane32_swap_b32 v54, v70
    v_mul_f32 v119, 0x3e8293ee, v119
    v_mul_f32 v120, 0x3e8293ee, v120
    v_mul_f32 v121, 0x3e8293ee, v121
    v_mul_f32 v122, 0x3e8293ee, v122
    v_sub_f32 v44, v44, v46
    v_sub_f32 v45, v45, v46
    v_sub_f32 v52, v52, v54
    v_sub_f32 v53, v53, v54
    v_sub_f32 v60, v60, v62
    v_sub_f32 v61, v61, v62
    v_sub_f32 v68, v68, v70
    v_sub_f32 v69, v69, v70
    v_mul_f32 v44, v119, v44
    v_mul_f32 v45, v119, v45
    v_mul_f32 v52, v120, v52
    v_mul_f32 v53, v120, v53
    v_mul_f32 v60, v121, v60
    v_mul_f32 v61, v121, v61
    v_mul_f32 v68, v122, v68
    v_mul_f32 v69, v122, v69
    v_exp_f32 v44, v44
    v_exp_f32 v45, v45
    v_exp_f32 v52, v52
    v_exp_f32 v53, v53
    v_exp_f32 v60, v60
    v_exp_f32 v61, v61
    v_exp_f32 v68, v68
    v_exp_f32 v69, v69
    .p2align 3
    v_pk_mul_f32 v[88:89], v[184:185], v[88:89] op_sel:[0,0] op_sel_hi:[1,1]
    v_pk_mul_f32 v[90:91], v[186:187], v[90:91] op_sel:[0,0] op_sel_hi:[1,1]
    v_pk_mul_f32 v[92:93], v[184:185], v[92:93] op_sel:[0,0] op_sel_hi:[1,1]
    v_pk_mul_f32 v[94:95], v[186:187], v[94:95] op_sel:[0,0] op_sel_hi:[1,1]
    v_pk_mul_f32 v[96:97], v[188:189], v[96:97] op_sel:[0,0] op_sel_hi:[1,1]
    v_pk_mul_f32 v[98:99], v[190:191], v[98:99] op_sel:[0,0] op_sel_hi:[1,1]
    v_pk_mul_f32 v[100:101], v[188:189], v[100:101] op_sel:[0,0] op_sel_hi:[1,1]
    v_pk_mul_f32 v[102:103], v[190:191], v[102:103] op_sel:[0,0] op_sel_hi:[1,1]
    v_pk_mul_f32 v[104:105], v[192:193], v[104:105] op_sel:[0,0] op_sel_hi:[1,1]
    v_pk_mul_f32 v[106:107], v[194:195], v[106:107] op_sel:[0,0] op_sel_hi:[1,1]
    v_pk_mul_f32 v[108:109], v[192:193], v[108:109] op_sel:[0,0] op_sel_hi:[1,1]
    v_pk_mul_f32 v[110:111], v[194:195], v[110:111] op_sel:[0,0] op_sel_hi:[1,1]
    v_cvt_pk_bf16_f32 v44, v44, v45
    v_cvt_pk_bf16_f32 v52, v52, v53
    v_cvt_pk_bf16_f32 v60, v60, v61
    v_cvt_pk_bf16_f32 v68, v68, v69
    v_cvt_pk_bf16_f32 v226, v72, v73
    v_cvt_pk_bf16_f32 v227, v74, v75
    v_cvt_pk_bf16_f32 v152, v76, v77
    v_cvt_pk_bf16_f32 v153, v78, v79
    v_cvt_pk_bf16_f32 v228, v80, v81
    v_cvt_pk_bf16_f32 v229, v82, v83
    v_cvt_pk_bf16_f32 v154, v84, v85
    v_cvt_pk_bf16_f32 v155, v86, v87
    v_cvt_pk_bf16_f32 v230, v88, v89
    v_cvt_pk_bf16_f32 v231, v90, v91
    v_cvt_pk_bf16_f32 v156, v92, v93
    v_cvt_pk_bf16_f32 v157, v94, v95
    v_cvt_pk_bf16_f32 v232, v96, v97
    v_cvt_pk_bf16_f32 v233, v98, v99
    v_cvt_pk_bf16_f32 v158, v100, v101
    v_cvt_pk_bf16_f32 v159, v102, v103
    v_cvt_pk_bf16_f32 v234, v104, v105
    v_cvt_pk_bf16_f32 v235, v106, v107
    v_cvt_pk_bf16_f32 v160, v108, v109
    v_cvt_pk_bf16_f32 v161, v110, v111
    v_perm_b32 v4, v44, v44, v214
    v_perm_b32 v5, v44, v44, v215
    v_perm_b32 v6, v44, v44, v216
    v_perm_b32 v7, v44, v44, v217
    v_perm_b32 v12, v52, v52, v214
    v_perm_b32 v13, v52, v52, v215
    v_perm_b32 v14, v52, v52, v216
    v_perm_b32 v15, v52, v52, v217
    v_perm_b32 v20, v60, v60, v214
    v_perm_b32 v21, v60, v60, v215
    v_perm_b32 v22, v60, v60, v216
    v_perm_b32 v23, v60, v60, v217
    v_perm_b32 v28, v68, v68, v214
    v_perm_b32 v29, v68, v68, v215
    v_perm_b32 v30, v68, v68, v216
    v_perm_b32 v31, v68, v68, v217
    s_add_u32 s55, s88, 4096
    v_mfma_f32_16x16x32_bf16 v[0:3], v[222:225], v[4:7], 0
    v_mfma_f32_16x16x32_bf16 v[8:11], v[222:225], v[12:15], 0
    v_mfma_f32_16x16x32_bf16 v[16:19], v[222:225], v[20:23], 0
    v_mfma_f32_16x16x32_bf16 v[24:27], v[222:225], v[28:31], 0
    v_mfma_f32_16x16x32_bf16 v[72:75], v[226:229], v[4:7], 0
    v_mfma_f32_16x16x32_bf16 v[76:79], v[152:155], v[4:7], 0
    v_mfma_f32_16x16x32_bf16 v[80:83], v[228:231], v[12:15], 0
    v_mfma_f32_16x16x32_bf16 v[84:87], v[154:157], v[12:15], 0
    v_mfma_f32_16x16x32_bf16 v[88:91], v[230:233], v[20:23], 0
    v_mfma_f32_16x16x32_bf16 v[92:95], v[156:159], v[20:23], 0
    v_mfma_f32_16x16x32_bf16 v[96:99], v[232:235], v[28:31], 0
    v_mfma_f32_16x16x32_bf16 v[100:103], v[158:161], v[28:31], 0
    v_rcp_f32 v0, v0
    v_rcp_f32 v8, v8
    v_rcp_f32 v16, v16
    v_rcp_f32 v24, v24
    v_pk_mul_f32 v[72:73], v[0:1], v[72:73] op_sel:[0,0] op_sel_hi:[0,1]
    v_pk_mul_f32 v[74:75], v[0:1], v[74:75] op_sel:[0,0] op_sel_hi:[0,1]
    v_pk_mul_f32 v[76:77], v[0:1], v[76:77] op_sel:[0,0] op_sel_hi:[0,1]
    v_pk_mul_f32 v[78:79], v[0:1], v[78:79] op_sel:[0,0] op_sel_hi:[0,1]
    v_cvt_pk_bf16_f32 v72, v72, v73
    v_cvt_pk_bf16_f32 v73, v74, v75
    v_cvt_pk_bf16_f32 v74, v76, v77
    v_cvt_pk_bf16_f32 v75, v78, v79
    buffer_store_dwordx4 v[72:75], v254, s[4:7], s88 offen offset:0 sc0 sc1
    v_pk_mul_f32 v[80:81], v[8:9], v[80:81] op_sel:[0,0] op_sel_hi:[0,1]
    v_pk_mul_f32 v[82:83], v[8:9], v[82:83] op_sel:[0,0] op_sel_hi:[0,1]
    v_pk_mul_f32 v[84:85], v[8:9], v[84:85] op_sel:[0,0] op_sel_hi:[0,1]
    v_pk_mul_f32 v[86:87], v[8:9], v[86:87] op_sel:[0,0] op_sel_hi:[0,1]
    v_cvt_pk_bf16_f32 v80, v80, v81
    v_cvt_pk_bf16_f32 v81, v82, v83
    v_cvt_pk_bf16_f32 v82, v84, v85
    v_cvt_pk_bf16_f32 v83, v86, v87
    buffer_store_dwordx4 v[80:83], v254, s[4:7], s88 offen offset:2048 sc0 sc1
    v_pk_mul_f32 v[88:89], v[16:17], v[88:89] op_sel:[0,0] op_sel_hi:[0,1]
    v_pk_mul_f32 v[90:91], v[16:17], v[90:91] op_sel:[0,0] op_sel_hi:[0,1]
    v_pk_mul_f32 v[92:93], v[16:17], v[92:93] op_sel:[0,0] op_sel_hi:[0,1]
    v_pk_mul_f32 v[94:95], v[16:17], v[94:95] op_sel:[0,0] op_sel_hi:[0,1]
    v_cvt_pk_bf16_f32 v88, v88, v89
    v_cvt_pk_bf16_f32 v89, v90, v91
    v_cvt_pk_bf16_f32 v90, v92, v93
    v_cvt_pk_bf16_f32 v91, v94, v95
    buffer_store_dwordx4 v[88:91], v254, s[4:7], s55 offen offset:0 sc0 sc1
    s_nop 1
    v_pk_mul_f32 v[96:97], v[24:25], v[96:97] op_sel:[0,0] op_sel_hi:[0,1]
    v_pk_mul_f32 v[98:99], v[24:25], v[98:99] op_sel:[0,0] op_sel_hi:[0,1]
    v_pk_mul_f32 v[100:101], v[24:25], v[100:101] op_sel:[0,0] op_sel_hi:[0,1]
    v_pk_mul_f32 v[102:103], v[24:25], v[102:103] op_sel:[0,0] op_sel_hi:[0,1]
    v_cvt_pk_bf16_f32 v96, v96, v97
    v_cvt_pk_bf16_f32 v97, v98, v99
    v_cvt_pk_bf16_f32 v98, v100, v101
    v_cvt_pk_bf16_f32 v99, v102, v103
    buffer_store_dwordx4 v[96:99], v254, s[4:7], s55 offen offset:2048 sc0 sc1
    s_lshl_b32 s55, s43, 13
    s_add_u32 s55, s55, 98304
    v_add_u32 v136, s55, v254
    v_lshrrev_b32 v152, 6, v254
    v_lshrrev_b32 v153, 1, v152
    v_and_b32 v153, 3, v153
    s_lshl_b32 s55, s44, 1
    v_xor_b32 v153, s55, v153
    v_lshlrev_b32 v152, 7, v152
    v_lshl_add_u32 v152, v153, 5, v152
    v_and_b32 v153, 0x30, v254
    v_lshrrev_b32 v153, 1, v153
    v_add_u32 v137, v152, v153
    v_xor_b32 v138, 32, v137
    v_add_u32 v139, 49152, v137
    v_add_u32 v140, 49152, v138
    v_lshlrev_b32 v0, 16, v236
    v_and_b32 v1, 0xffff0000, v236
    v_lshlrev_b32 v2, 16, v237
    v_and_b32 v3, 0xffff0000, v237
    v_lshlrev_b32 v16, 16, v238
    v_and_b32 v17, 0xffff0000, v238
    v_lshlrev_b32 v18, 16, v239
    v_and_b32 v19, 0xffff0000, v239
    v_lshlrev_b32 v4, 16, v240
    v_and_b32 v5, 0xffff0000, v240
    v_lshlrev_b32 v6, 16, v241
    v_and_b32 v7, 0xffff0000, v241
    v_lshlrev_b32 v20, 16, v242
    v_and_b32 v21, 0xffff0000, v242
    v_lshlrev_b32 v22, 16, v243
    v_and_b32 v23, 0xffff0000, v243
    v_lshlrev_b32 v8, 16, v244
    v_and_b32 v9, 0xffff0000, v244
    v_lshlrev_b32 v10, 16, v245
    v_and_b32 v11, 0xffff0000, v245
    v_lshlrev_b32 v24, 16, v246
    v_and_b32 v25, 0xffff0000, v246
    v_lshlrev_b32 v26, 16, v247
    v_and_b32 v27, 0xffff0000, v247
    v_lshlrev_b32 v12, 16, v248
    v_and_b32 v13, 0xffff0000, v248
    v_lshlrev_b32 v14, 16, v249
    v_and_b32 v15, 0xffff0000, v249
    v_lshlrev_b32 v28, 16, v250
    v_and_b32 v29, 0xffff0000, v250
    v_lshlrev_b32 v30, 16, v251
    v_and_b32 v31, 0xffff0000, v251
    s_waitcnt vmcnt(0)
    s_barrier
    s_cmp_lg_u32 s42, 2
    s_cbranch_scc1 wf_16
    s_lshr_b32 s55, s2, 5
    s_lshl_b32 s55, s55, 2
    s_add_u32 s55, s55, s0
    v_mov_b32 v252, 0
    v_mov_b32 v253, 0x01010101
    s_mov_b64 exec, 1
    s_cmp_eq_u32 s45, 0
    s_cbranch_scc1 st_17
    buffer_store_dword v253, v252, s[4:7], s55 offen sc0 sc1
    s_branch st_18
st_17:
    buffer_store_dword v253, v252, s[4:7], s55 offen
st_18:
    s_mov_b64 exec, -1
wf_16:
    s_cmp_lg_u32 s42, 3
    s_cbranch_scc1 wf_19
    s_lshl_b32 s55, s51, 2
    s_add_u32 s55, s55, s54
    v_mov_b32 v252, 0
    v_mov_b32 v253, 0x01010101
    s_mov_b64 exec, 1
    buffer_store_dword v253, v252, s[4:7], s55 offen sc0 sc1
    s_mov_b64 exec, -1
wf_19:
    s_barrier
    ds_read_b64_tr_b16 v[104:105], v137 offset:32768
    ds_read_b64_tr_b16 v[106:107], v137 offset:34816
    ds_read_b128 v[32:35], v136 offset:0
    ds_read_b128 v[36:39], v136 offset:2048
    ds_read_b128 v[40:43], v136 offset:4096
    ds_read_b128 v[44:47], v136 offset:6144
    ds_read_b64_tr_b16 v[108:109], v138 offset:32768
    ds_read_b64_tr_b16 v[110:111], v138 offset:34816
    ds_read_b64_tr_b16 v[112:113], v137 offset:36864
    ds_read_b64_tr_b16 v[114:115], v137 offset:38912
    ds_read_b128 v[48:51], v136 offset:1024
    ds_read_b128 v[52:55], v136 offset:3072
    ds_read_b128 v[56:59], v136 offset:5120
    ds_read_b128 v[60:63], v136 offset:7168
    ds_read_b64_tr_b16 v[116:117], v138 offset:36864
    ds_read_b64_tr_b16 v[118:119], v138 offset:38912
    s_waitcnt lgkmcnt(0)
    s_barrier
    .p2align 3
    v_mfma_f32_16x16x32_bf16 v[0:3], v[104:107], v[32:35], v[0:3]
    ds_read_b64_tr_b16 v[120:121], v137 offset:40960
    ds_read_b64_tr_b16 v[122:123], v137 offset:43008
    v_mfma_f32_16x16x32_bf16 v[4:7], v[104:107], v[36:39], v[4:7]
    ds_read_b128 v[64:67], v136 offset:16384
    v_mfma_f32_16x16x32_bf16 v[8:11], v[104:107], v[40:43], v[8:11]
    ds_read_b128 v[68:71], v136 offset:18432
    v_mfma_f32_16x16x32_bf16 v[12:15], v[104:107], v[44:47], v[12:15]
    ds_read_b128 v[72:75], v136 offset:20480
    ds_read_b128 v[76:79], v136 offset:22528
    v_mfma_f32_16x16x32_bf16 v[16:19], v[108:111], v[32:35], v[16:19]
    ds_read_b64_tr_b16 v[124:125], v138 offset:40960
    v_mfma_f32_16x16x32_bf16 v[20:23], v[108:111], v[36:39], v[20:23]
    ds_read_b64_tr_b16 v[126:127], v138 offset:43008
    v_mfma_f32_16x16x32_bf16 v[24:27], v[108:111], v[40:43], v[24:27]
    ds_read_b64_tr_b16 v[128:129], v137 offset:45056
    ds_read_b64_tr_b16 v[130:131], v137 offset:47104
    v_mfma_f32_16x16x32_bf16 v[28:31], v[108:111], v[44:47], v[28:31]
    ds_read_b128 v[80:83], v136 offset:17408
    v_mfma_f32_16x16x32_bf16 v[0:3], v[112:115], v[48:51], v[0:3]
    ds_read_b128 v[84:87], v136 offset:19456
    v_mfma_f32_16x16x32_bf16 v[4:7], v[112:115], v[52:55], v[4:7]
    ds_read_b128 v[88:91], v136 offset:21504
    ds_read_b128 v[92:95], v136 offset:23552
    v_mfma_f32_16x16x32_bf16 v[8:11], v[112:115], v[56:59], v[8:11]
    ds_read_b64_tr_b16 v[132:133], v138 offset:45056
    v_mfma_f32_16x16x32_bf16 v[12:15], v[112:115], v[60:63], v[12:15]
    ds_read_b64_tr_b16 v[134:135], v138 offset:47104
    v_mfma_f32_16x16x32_bf16 v[16:19], v[116:119], v[48:51], v[16:19]
    v_mfma_f32_16x16x32_bf16 v[20:23], v[116:119], v[52:55], v[20:23]
    v_mfma_f32_16x16x32_bf16 v[24:27], v[116:119], v[56:59], v[24:27]
    v_mfma_f32_16x16x32_bf16 v[28:31], v[116:119], v[60:63], v[28:31]
    s_waitcnt lgkmcnt(0)
    s_barrier
    .p2align 3
    v_mfma_f32_16x16x32_bf16 v[0:3], v[120:123], v[64:67], v[0:3]
    ds_read_b64_tr_b16 v[104:105], v139 offset:0
    ds_read_b64_tr_b16 v[106:107], v139 offset:2048
    v_mfma_f32_16x16x32_bf16 v[4:7], v[120:123], v[68:71], v[4:7]
    ds_read_b128 v[32:35], v136 offset:32768
    v_mfma_f32_16x16x32_bf16 v[8:11], v[120:123], v[72:75], v[8:11]
    ds_read_b128 v[36:39], v136 offset:34816
    v_mfma_f32_16x16x32_bf16 v[12:15], v[120:123], v[76:79], v[12:15]
    ds_read_b128 v[40:43], v136 offset:36864
    ds_read_b128 v[44:47], v136 offset:38912
    v_mfma_f32_16x16x32_bf16 v[16:19], v[124:127], v[64:67], v[16:19]
    ds_read_b64_tr_b16 v[108:109], v140 offset:0
    v_mfma_f32_16x16x32_bf16 v[20:23], v[124:127], v[68:71], v[20:23]
    ds_read_b64_tr_b16 v[110:111], v140 offset:2048
    v_mfma_f32_16x16x32_bf16 v[24:27], v[124:127], v[72:75], v[24:27]
    ds_read_b64_tr_b16 v[112:113], v139 offset:4096
    ds_read_b64_tr_b16 v[114:115], v139 offset:6144
    v_mfma_f32_16x16x32_bf16 v[28:31], v[124:127], v[76:79], v[28:31]
    ds_read_b128 v[48:51], v136 offset:33792
    v_mfma_f32_16x16x32_bf16 v[0:3], v[128:131], v[80:83], v[0:3]
    ds_read_b128 v[52:55], v136 offset:35840
    v_mfma_f32_16x16x32_bf16 v[4:7], v[128:131], v[84:87], v[4:7]
    ds_read_b128 v[56:59], v136 offset:37888
    ds_read_b128 v[60:63], v136 offset:39936
    v_mfma_f32_16x16x32_bf16 v[8:11], v[128:131], v[88:91], v[8:11]
    ds_read_b64_tr_b16 v[116:117], v140 offset:4096
    v_mfma_f32_16x16x32_bf16 v[12:15], v[128:131], v[92:95], v[12:15]
    ds_read_b64_tr_b16 v[118:119], v140 offset:6144
    v_mfma_f32_16x16x32_bf16 v[16:19], v[132:135], v[80:83], v[16:19]
    v_mfma_f32_16x16x32_bf16 v[20:23], v[132:135], v[84:87], v[20:23]
    v_mfma_f32_16x16x32_bf16 v[24:27], v[132:135], v[88:91], v[24:27]
    v_mfma_f32_16x16x32_bf16 v[28:31], v[132:135], v[92:95], v[28:31]
    s_waitcnt lgkmcnt(0)
    s_barrier
    .p2align 3
    v_mfma_f32_16x16x32_bf16 v[0:3], v[104:107], v[32:35], v[0:3]
    ds_read_b64_tr_b16 v[120:121], v139 offset:8192
    ds_read_b64_tr_b16 v[122:123], v139 offset:10240
    v_mfma_f32_16x16x32_bf16 v[4:7], v[104:107], v[36:39], v[4:7]
    ds_read_b128 v[64:67], v136 offset:0
    v_mfma_f32_16x16x32_bf16 v[8:11], v[104:107], v[40:43], v[8:11]
    ds_read_b128 v[68:71], v136 offset:2048
    v_mfma_f32_16x16x32_bf16 v[12:15], v[104:107], v[44:47], v[12:15]
    ds_read_b128 v[72:75], v136 offset:4096
    ds_read_b128 v[76:79], v136 offset:6144
    v_mfma_f32_16x16x32_bf16 v[16:19], v[108:111], v[32:35], v[16:19]
    ds_read_b64_tr_b16 v[124:125], v140 offset:8192
    v_mfma_f32_16x16x32_bf16 v[20:23], v[108:111], v[36:39], v[20:23]
    ds_read_b64_tr_b16 v[126:127], v140 offset:10240
    v_mfma_f32_16x16x32_bf16 v[24:27], v[108:111], v[40:43], v[24:27]
    ds_read_b64_tr_b16 v[128:129], v139 offset:12288
    ds_read_b64_tr_b16 v[130:131], v139 offset:14336
    v_mfma_f32_16x16x32_bf16 v[28:31], v[108:111], v[44:47], v[28:31]
    ds_read_b128 v[80:83], v136 offset:1024
    v_mfma_f32_16x16x32_bf16 v[0:3], v[112:115], v[48:51], v[0:3]
    ds_read_b128 v[84:87], v136 offset:3072
    v_mfma_f32_16x16x32_bf16 v[4:7], v[112:115], v[52:55], v[4:7]
    ds_read_b128 v[88:91], v136 offset:5120
    ds_read_b128 v[92:95], v136 offset:7168
    v_mfma_f32_16x16x32_bf16 v[8:11], v[112:115], v[56:59], v[8:11]
    ds_read_b64_tr_b16 v[132:133], v140 offset:12288
    v_mfma_f32_16x16x32_bf16 v[12:15], v[112:115], v[60:63], v[12:15]
    ds_read_b64_tr_b16 v[134:135], v140 offset:14336
    v_mfma_f32_16x16x32_bf16 v[16:19], v[116:119], v[48:51], v[16:19]
    v_mfma_f32_16x16x32_bf16 v[20:23], v[116:119], v[52:55], v[20:23]
    v_mfma_f32_16x16x32_bf16 v[24:27], v[116:119], v[56:59], v[24:27]
    v_mfma_f32_16x16x32_bf16 v[28:31], v[116:119], v[60:63], v[28:31]
    s_waitcnt lgkmcnt(0)
    s_barrier
    .p2align 3
    v_mfma_f32_16x16x32_bf16 v[0:3], v[120:123], v[64:67], v[0:3]
    ds_read_b64_tr_b16 v[104:105], v139 offset:16384
    ds_read_b64_tr_b16 v[106:107], v139 offset:18432
    v_mfma_f32_16x16x32_bf16 v[4:7], v[120:123], v[68:71], v[4:7]
    ds_read_b128 v[32:35], v136 offset:16384
    v_mfma_f32_16x16x32_bf16 v[8:11], v[120:123], v[72:75], v[8:11]
    ds_read_b128 v[36:39], v136 offset:18432
    v_mfma_f32_16x16x32_bf16 v[12:15], v[120:123], v[76:79], v[12:15]
    ds_read_b128 v[40:43], v136 offset:20480
    ds_read_b128 v[44:47], v136 offset:22528
    v_mfma_f32_16x16x32_bf16 v[16:19], v[124:127], v[64:67], v[16:19]
    ds_read_b64_tr_b16 v[108:109], v140 offset:16384
    v_mfma_f32_16x16x32_bf16 v[20:23], v[124:127], v[68:71], v[20:23]
    ds_read_b64_tr_b16 v[110:111], v140 offset:18432
    v_mfma_f32_16x16x32_bf16 v[24:27], v[124:127], v[72:75], v[24:27]
    ds_read_b64_tr_b16 v[112:113], v139 offset:20480
    ds_read_b64_tr_b16 v[114:115], v139 offset:22528
    v_mfma_f32_16x16x32_bf16 v[28:31], v[124:127], v[76:79], v[28:31]
    ds_read_b128 v[48:51], v136 offset:17408
    v_mfma_f32_16x16x32_bf16 v[0:3], v[128:131], v[80:83], v[0:3]
    ds_read_b128 v[52:55], v136 offset:19456
    v_mfma_f32_16x16x32_bf16 v[4:7], v[128:131], v[84:87], v[4:7]
    ds_read_b128 v[56:59], v136 offset:21504
    ds_read_b128 v[60:63], v136 offset:23552
    v_mfma_f32_16x16x32_bf16 v[8:11], v[128:131], v[88:91], v[8:11]
    ds_read_b64_tr_b16 v[116:117], v140 offset:20480
    v_mfma_f32_16x16x32_bf16 v[12:15], v[128:131], v[92:95], v[12:15]
    ds_read_b64_tr_b16 v[118:119], v140 offset:22528
    v_mfma_f32_16x16x32_bf16 v[16:19], v[132:135], v[80:83], v[16:19]
    v_mfma_f32_16x16x32_bf16 v[20:23], v[132:135], v[84:87], v[20:23]
    v_mfma_f32_16x16x32_bf16 v[24:27], v[132:135], v[88:91], v[24:27]
    v_mfma_f32_16x16x32_bf16 v[28:31], v[132:135], v[92:95], v[28:31]
    s_waitcnt lgkmcnt(0)
    s_barrier
    .p2align 3
    v_mfma_f32_16x16x32_bf16 v[0:3], v[104:107], v[32:35], v[0:3]
    ds_read_b64_tr_b16 v[120:121], v139 offset:24576
    ds_read_b64_tr_b16 v[122:123], v139 offset:26624
    v_mfma_f32_16x16x32_bf16 v[4:7], v[104:107], v[36:39], v[4:7]
    ds_read_b128 v[64:67], v136 offset:32768
    v_mfma_f32_16x16x32_bf16 v[8:11], v[104:107], v[40:43], v[8:11]
    ds_read_b128 v[68:71], v136 offset:34816
    v_mfma_f32_16x16x32_bf16 v[12:15], v[104:107], v[44:47], v[12:15]
    ds_read_b128 v[72:75], v136 offset:36864
    ds_read_b128 v[76:79], v136 offset:38912
    v_mfma_f32_16x16x32_bf16 v[16:19], v[108:111], v[32:35], v[16:19]
    ds_read_b64_tr_b16 v[124:125], v140 offset:24576
    v_mfma_f32_16x16x32_bf16 v[20:23], v[108:111], v[36:39], v[20:23]
    ds_read_b64_tr_b16 v[126:127], v140 offset:26624
    v_mfma_f32_16x16x32_bf16 v[24:27], v[108:111], v[40:43], v[24:27]
    ds_read_b64_tr_b16 v[128:129], v139 offset:28672
    ds_read_b64_tr_b16 v[130:131], v139 offset:30720
    v_mfma_f32_16x16x32_bf16 v[28:31], v[108:111], v[44:47], v[28:31]
    ds_read_b128 v[80:83], v136 offset:33792
    v_mfma_f32_16x16x32_bf16 v[0:3], v[112:115], v[48:51], v[0:3]
    ds_read_b128 v[84:87], v136 offset:35840
    v_mfma_f32_16x16x32_bf16 v[4:7], v[112:115], v[52:55], v[4:7]
    ds_read_b128 v[88:91], v136 offset:37888
    ds_read_b128 v[92:95], v136 offset:39936
    v_mfma_f32_16x16x32_bf16 v[8:11], v[112:115], v[56:59], v[8:11]
    ds_read_b64_tr_b16 v[132:133], v140 offset:28672
    v_mfma_f32_16x16x32_bf16 v[12:15], v[112:115], v[60:63], v[12:15]
    ds_read_b64_tr_b16 v[134:135], v140 offset:30720
    v_mfma_f32_16x16x32_bf16 v[16:19], v[116:119], v[48:51], v[16:19]
    v_mfma_f32_16x16x32_bf16 v[20:23], v[116:119], v[52:55], v[20:23]
    v_mfma_f32_16x16x32_bf16 v[24:27], v[116:119], v[56:59], v[24:27]
    v_mfma_f32_16x16x32_bf16 v[28:31], v[116:119], v[60:63], v[28:31]
    s_waitcnt lgkmcnt(0)
    s_barrier
    .p2align 3
    v_mfma_f32_16x16x32_bf16 v[0:3], v[120:123], v[64:67], v[0:3]
    ds_read_b64_tr_b16 v[104:105], v139 offset:32768
    ds_read_b64_tr_b16 v[106:107], v139 offset:34816
    v_mfma_f32_16x16x32_bf16 v[4:7], v[120:123], v[68:71], v[4:7]
    ds_read_b128 v[32:35], v136 offset:0
    v_mfma_f32_16x16x32_bf16 v[8:11], v[120:123], v[72:75], v[8:11]
    ds_read_b128 v[36:39], v136 offset:2048
    v_mfma_f32_16x16x32_bf16 v[12:15], v[120:123], v[76:79], v[12:15]
    ds_read_b128 v[40:43], v136 offset:4096
    ds_read_b128 v[44:47], v136 offset:6144
    v_mfma_f32_16x16x32_bf16 v[16:19], v[124:127], v[64:67], v[16:19]
    ds_read_b64_tr_b16 v[108:109], v140 offset:32768
    v_mfma_f32_16x16x32_bf16 v[20:23], v[124:127], v[68:71], v[20:23]
    ds_read_b64_tr_b16 v[110:111], v140 offset:34816
    v_mfma_f32_16x16x32_bf16 v[24:27], v[124:127], v[72:75], v[24:27]
    ds_read_b64_tr_b16 v[112:113], v139 offset:36864
    ds_read_b64_tr_b16 v[114:115], v139 offset:38912
    v_mfma_f32_16x16x32_bf16 v[28:31], v[124:127], v[76:79], v[28:31]
    ds_read_b128 v[48:51], v136 offset:1024
    v_mfma_f32_16x16x32_bf16 v[0:3], v[128:131], v[80:83], v[0:3]
    ds_read_b128 v[52:55], v136 offset:3072
    v_mfma_f32_16x16x32_bf16 v[4:7], v[128:131], v[84:87], v[4:7]
    ds_read_b128 v[56:59], v136 offset:5120
    ds_read_b128 v[60:63], v136 offset:7168
    v_mfma_f32_16x16x32_bf16 v[8:11], v[128:131], v[88:91], v[8:11]
    ds_read_b64_tr_b16 v[116:117], v140 offset:36864
    v_mfma_f32_16x16x32_bf16 v[12:15], v[128:131], v[92:95], v[12:15]
    ds_read_b64_tr_b16 v[118:119], v140 offset:38912
    v_mfma_f32_16x16x32_bf16 v[16:19], v[132:135], v[80:83], v[16:19]
    v_mfma_f32_16x16x32_bf16 v[20:23], v[132:135], v[84:87], v[20:23]
    v_mfma_f32_16x16x32_bf16 v[24:27], v[132:135], v[88:91], v[24:27]
    v_mfma_f32_16x16x32_bf16 v[28:31], v[132:135], v[92:95], v[28:31]
    s_waitcnt lgkmcnt(0)
    s_barrier
    .p2align 3
    v_mfma_f32_16x16x32_bf16 v[0:3], v[104:107], v[32:35], v[0:3]
    ds_read_b64_tr_b16 v[120:121], v139 offset:40960
    ds_read_b64_tr_b16 v[122:123], v139 offset:43008
    v_mfma_f32_16x16x32_bf16 v[4:7], v[104:107], v[36:39], v[4:7]
    ds_read_b128 v[64:67], v136 offset:16384
    v_mfma_f32_16x16x32_bf16 v[8:11], v[104:107], v[40:43], v[8:11]
    ds_read_b128 v[68:71], v136 offset:18432
    v_mfma_f32_16x16x32_bf16 v[12:15], v[104:107], v[44:47], v[12:15]
    ds_read_b128 v[72:75], v136 offset:20480
    ds_read_b128 v[76:79], v136 offset:22528
    v_mfma_f32_16x16x32_bf16 v[16:19], v[108:111], v[32:35], v[16:19]
    ds_read_b64_tr_b16 v[124:125], v140 offset:40960
    v_mfma_f32_16x16x32_bf16 v[20:23], v[108:111], v[36:39], v[20:23]
    ds_read_b64_tr_b16 v[126:127], v140 offset:43008
    v_mfma_f32_16x16x32_bf16 v[24:27], v[108:111], v[40:43], v[24:27]
    ds_read_b64_tr_b16 v[128:129], v139 offset:45056
    ds_read_b64_tr_b16 v[130:131], v139 offset:47104
    v_mfma_f32_16x16x32_bf16 v[28:31], v[108:111], v[44:47], v[28:31]
    ds_read_b128 v[80:83], v136 offset:17408
    v_mfma_f32_16x16x32_bf16 v[0:3], v[112:115], v[48:51], v[0:3]
    ds_read_b128 v[84:87], v136 offset:19456
    v_mfma_f32_16x16x32_bf16 v[4:7], v[112:115], v[52:55], v[4:7]
    ds_read_b128 v[88:91], v136 offset:21504
    ds_read_b128 v[92:95], v136 offset:23552
    v_mfma_f32_16x16x32_bf16 v[8:11], v[112:115], v[56:59], v[8:11]
    ds_read_b64_tr_b16 v[132:133], v140 offset:45056
    v_mfma_f32_16x16x32_bf16 v[12:15], v[112:115], v[60:63], v[12:15]
    ds_read_b64_tr_b16 v[134:135], v140 offset:47104
    v_mfma_f32_16x16x32_bf16 v[16:19], v[116:119], v[48:51], v[16:19]
    v_mfma_f32_16x16x32_bf16 v[20:23], v[116:119], v[52:55], v[20:23]
    v_mfma_f32_16x16x32_bf16 v[24:27], v[116:119], v[56:59], v[24:27]
    v_mfma_f32_16x16x32_bf16 v[28:31], v[116:119], v[60:63], v[28:31]
    s_waitcnt lgkmcnt(0)
    s_barrier
    .p2align 3
    v_mfma_f32_16x16x32_bf16 v[0:3], v[120:123], v[64:67], v[0:3]
    ds_read_b64_tr_b16 v[104:105], v137 offset:0
    ds_read_b64_tr_b16 v[106:107], v137 offset:2048
    v_mfma_f32_16x16x32_bf16 v[4:7], v[120:123], v[68:71], v[4:7]
    ds_read_b128 v[32:35], v136 offset:32768
    v_mfma_f32_16x16x32_bf16 v[8:11], v[120:123], v[72:75], v[8:11]
    ds_read_b128 v[36:39], v136 offset:34816
    v_mfma_f32_16x16x32_bf16 v[12:15], v[120:123], v[76:79], v[12:15]
    ds_read_b128 v[40:43], v136 offset:36864
    ds_read_b128 v[44:47], v136 offset:38912
    v_mfma_f32_16x16x32_bf16 v[16:19], v[124:127], v[64:67], v[16:19]
    ds_read_b64_tr_b16 v[108:109], v138 offset:0
    v_mfma_f32_16x16x32_bf16 v[20:23], v[124:127], v[68:71], v[20:23]
    ds_read_b64_tr_b16 v[110:111], v138 offset:2048
    v_mfma_f32_16x16x32_bf16 v[24:27], v[124:127], v[72:75], v[24:27]
    ds_read_b64_tr_b16 v[112:113], v137 offset:4096
    ds_read_b64_tr_b16 v[114:115], v137 offset:6144
    v_mfma_f32_16x16x32_bf16 v[28:31], v[124:127], v[76:79], v[28:31]
    ds_read_b128 v[48:51], v136 offset:33792
    v_mfma_f32_16x16x32_bf16 v[0:3], v[128:131], v[80:83], v[0:3]
    ds_read_b128 v[52:55], v136 offset:35840
    v_mfma_f32_16x16x32_bf16 v[4:7], v[128:131], v[84:87], v[4:7]
    ds_read_b128 v[56:59], v136 offset:37888
    ds_read_b128 v[60:63], v136 offset:39936
    v_mfma_f32_16x16x32_bf16 v[8:11], v[128:131], v[88:91], v[8:11]
    ds_read_b64_tr_b16 v[116:117], v138 offset:4096
    v_mfma_f32_16x16x32_bf16 v[12:15], v[128:131], v[92:95], v[12:15]
    ds_read_b64_tr_b16 v[118:119], v138 offset:6144
    v_mfma_f32_16x16x32_bf16 v[16:19], v[132:135], v[80:83], v[16:19]
    v_mfma_f32_16x16x32_bf16 v[20:23], v[132:135], v[84:87], v[20:23]
    v_mfma_f32_16x16x32_bf16 v[24:27], v[132:135], v[88:91], v[24:27]
    v_mfma_f32_16x16x32_bf16 v[28:31], v[132:135], v[92:95], v[28:31]
    s_waitcnt lgkmcnt(0)
    s_barrier
    .p2align 3
    v_mfma_f32_16x16x32_bf16 v[0:3], v[104:107], v[32:35], v[0:3]
    ds_read_b64_tr_b16 v[120:121], v137 offset:8192
    ds_read_b64_tr_b16 v[122:123], v137 offset:10240
    v_mfma_f32_16x16x32_bf16 v[4:7], v[104:107], v[36:39], v[4:7]
    ds_read_b128 v[64:67], v136 offset:0
    v_mfma_f32_16x16x32_bf16 v[8:11], v[104:107], v[40:43], v[8:11]
    ds_read_b128 v[68:71], v136 offset:2048
    v_mfma_f32_16x16x32_bf16 v[12:15], v[104:107], v[44:47], v[12:15]
    ds_read_b128 v[72:75], v136 offset:4096
    ds_read_b128 v[76:79], v136 offset:6144
    v_mfma_f32_16x16x32_bf16 v[16:19], v[108:111], v[32:35], v[16:19]
    ds_read_b64_tr_b16 v[124:125], v138 offset:8192
    v_mfma_f32_16x16x32_bf16 v[20:23], v[108:111], v[36:39], v[20:23]
    ds_read_b64_tr_b16 v[126:127], v138 offset:10240
    v_mfma_f32_16x16x32_bf16 v[24:27], v[108:111], v[40:43], v[24:27]
    ds_read_b64_tr_b16 v[128:129], v137 offset:12288
    ds_read_b64_tr_b16 v[130:131], v137 offset:14336
    v_mfma_f32_16x16x32_bf16 v[28:31], v[108:111], v[44:47], v[28:31]
    ds_read_b128 v[80:83], v136 offset:1024
    v_mfma_f32_16x16x32_bf16 v[0:3], v[112:115], v[48:51], v[0:3]
    ds_read_b128 v[84:87], v136 offset:3072
    v_mfma_f32_16x16x32_bf16 v[4:7], v[112:115], v[52:55], v[4:7]
    ds_read_b128 v[88:91], v136 offset:5120
    ds_read_b128 v[92:95], v136 offset:7168
    v_mfma_f32_16x16x32_bf16 v[8:11], v[112:115], v[56:59], v[8:11]
    ds_read_b64_tr_b16 v[132:133], v138 offset:12288
    v_mfma_f32_16x16x32_bf16 v[12:15], v[112:115], v[60:63], v[12:15]
    ds_read_b64_tr_b16 v[134:135], v138 offset:14336
    v_mfma_f32_16x16x32_bf16 v[16:19], v[116:119], v[48:51], v[16:19]
    v_mfma_f32_16x16x32_bf16 v[20:23], v[116:119], v[52:55], v[20:23]
    v_mfma_f32_16x16x32_bf16 v[24:27], v[116:119], v[56:59], v[24:27]
    v_mfma_f32_16x16x32_bf16 v[28:31], v[116:119], v[60:63], v[28:31]
    s_waitcnt lgkmcnt(0)
    s_barrier
    .p2align 3
    v_mfma_f32_16x16x32_bf16 v[0:3], v[120:123], v[64:67], v[0:3]
    ds_read_b64_tr_b16 v[104:105], v137 offset:16384
    ds_read_b64_tr_b16 v[106:107], v137 offset:18432
    v_mfma_f32_16x16x32_bf16 v[4:7], v[120:123], v[68:71], v[4:7]
    ds_read_b128 v[32:35], v136 offset:16384
    v_mfma_f32_16x16x32_bf16 v[8:11], v[120:123], v[72:75], v[8:11]
    ds_read_b128 v[36:39], v136 offset:18432
    v_mfma_f32_16x16x32_bf16 v[12:15], v[120:123], v[76:79], v[12:15]
    ds_read_b128 v[40:43], v136 offset:20480
    ds_read_b128 v[44:47], v136 offset:22528
    v_mfma_f32_16x16x32_bf16 v[16:19], v[124:127], v[64:67], v[16:19]
    ds_read_b64_tr_b16 v[108:109], v138 offset:16384
    v_mfma_f32_16x16x32_bf16 v[20:23], v[124:127], v[68:71], v[20:23]
    ds_read_b64_tr_b16 v[110:111], v138 offset:18432
    v_mfma_f32_16x16x32_bf16 v[24:27], v[124:127], v[72:75], v[24:27]
    ds_read_b64_tr_b16 v[112:113], v137 offset:20480
    ds_read_b64_tr_b16 v[114:115], v137 offset:22528
    v_mfma_f32_16x16x32_bf16 v[28:31], v[124:127], v[76:79], v[28:31]
    ds_read_b128 v[48:51], v136 offset:17408
    v_mfma_f32_16x16x32_bf16 v[0:3], v[128:131], v[80:83], v[0:3]
    ds_read_b128 v[52:55], v136 offset:19456
    v_mfma_f32_16x16x32_bf16 v[4:7], v[128:131], v[84:87], v[4:7]
    ds_read_b128 v[56:59], v136 offset:21504
    ds_read_b128 v[60:63], v136 offset:23552
    v_mfma_f32_16x16x32_bf16 v[8:11], v[128:131], v[88:91], v[8:11]
    ds_read_b64_tr_b16 v[116:117], v138 offset:20480
    v_mfma_f32_16x16x32_bf16 v[12:15], v[128:131], v[92:95], v[12:15]
    ds_read_b64_tr_b16 v[118:119], v138 offset:22528
    v_mfma_f32_16x16x32_bf16 v[16:19], v[132:135], v[80:83], v[16:19]
    v_mfma_f32_16x16x32_bf16 v[20:23], v[132:135], v[84:87], v[20:23]
    v_mfma_f32_16x16x32_bf16 v[24:27], v[132:135], v[88:91], v[24:27]
    v_mfma_f32_16x16x32_bf16 v[28:31], v[132:135], v[92:95], v[28:31]
    s_waitcnt lgkmcnt(0)
    s_barrier
    .p2align 3
    v_mfma_f32_16x16x32_bf16 v[0:3], v[104:107], v[32:35], v[0:3]
    ds_read_b64_tr_b16 v[120:121], v137 offset:24576
    ds_read_b64_tr_b16 v[122:123], v137 offset:26624
    v_mfma_f32_16x16x32_bf16 v[4:7], v[104:107], v[36:39], v[4:7]
    ds_read_b128 v[64:67], v136 offset:32768
    v_mfma_f32_16x16x32_bf16 v[8:11], v[104:107], v[40:43], v[8:11]
    ds_read_b128 v[68:71], v136 offset:34816
    v_mfma_f32_16x16x32_bf16 v[12:15], v[104:107], v[44:47], v[12:15]
    ds_read_b128 v[72:75], v136 offset:36864
    ds_read_b128 v[76:79], v136 offset:38912
    v_mfma_f32_16x16x32_bf16 v[16:19], v[108:111], v[32:35], v[16:19]
    ds_read_b64_tr_b16 v[124:125], v138 offset:24576
    v_mfma_f32_16x16x32_bf16 v[20:23], v[108:111], v[36:39], v[20:23]
    ds_read_b64_tr_b16 v[126:127], v138 offset:26624
    v_mfma_f32_16x16x32_bf16 v[24:27], v[108:111], v[40:43], v[24:27]
    ds_read_b64_tr_b16 v[128:129], v137 offset:28672
    ds_read_b64_tr_b16 v[130:131], v137 offset:30720
    v_mfma_f32_16x16x32_bf16 v[28:31], v[108:111], v[44:47], v[28:31]
    ds_read_b128 v[80:83], v136 offset:33792
    v_mfma_f32_16x16x32_bf16 v[0:3], v[112:115], v[48:51], v[0:3]
    ds_read_b128 v[84:87], v136 offset:35840
    v_mfma_f32_16x16x32_bf16 v[4:7], v[112:115], v[52:55], v[4:7]
    ds_read_b128 v[88:91], v136 offset:37888
    ds_read_b128 v[92:95], v136 offset:39936
    v_mfma_f32_16x16x32_bf16 v[8:11], v[112:115], v[56:59], v[8:11]
    ds_read_b64_tr_b16 v[132:133], v138 offset:28672
    v_mfma_f32_16x16x32_bf16 v[12:15], v[112:115], v[60:63], v[12:15]
    ds_read_b64_tr_b16 v[134:135], v138 offset:30720
    v_mfma_f32_16x16x32_bf16 v[16:19], v[116:119], v[48:51], v[16:19]
    v_mfma_f32_16x16x32_bf16 v[20:23], v[116:119], v[52:55], v[20:23]
    v_mfma_f32_16x16x32_bf16 v[24:27], v[116:119], v[56:59], v[24:27]
    v_mfma_f32_16x16x32_bf16 v[28:31], v[116:119], v[60:63], v[28:31]
    s_waitcnt lgkmcnt(0)
    s_barrier
    .p2align 3
    v_mfma_f32_16x16x32_bf16 v[0:3], v[120:123], v[64:67], v[0:3]
    ds_read_b64_tr_b16 v[104:105], v137 offset:32768
    ds_read_b64_tr_b16 v[106:107], v137 offset:34816
    v_mfma_f32_16x16x32_bf16 v[4:7], v[120:123], v[68:71], v[4:7]
    ds_read_b128 v[32:35], v136 offset:0
    v_mfma_f32_16x16x32_bf16 v[8:11], v[120:123], v[72:75], v[8:11]
    ds_read_b128 v[36:39], v136 offset:2048
    v_mfma_f32_16x16x32_bf16 v[12:15], v[120:123], v[76:79], v[12:15]
    ds_read_b128 v[40:43], v136 offset:4096
    ds_read_b128 v[44:47], v136 offset:6144
    v_mfma_f32_16x16x32_bf16 v[16:19], v[124:127], v[64:67], v[16:19]
    ds_read_b64_tr_b16 v[108:109], v138 offset:32768
    v_mfma_f32_16x16x32_bf16 v[20:23], v[124:127], v[68:71], v[20:23]
    ds_read_b64_tr_b16 v[110:111], v138 offset:34816
    v_mfma_f32_16x16x32_bf16 v[24:27], v[124:127], v[72:75], v[24:27]
    ds_read_b64_tr_b16 v[112:113], v137 offset:36864
    ds_read_b64_tr_b16 v[114:115], v137 offset:38912
    v_mfma_f32_16x16x32_bf16 v[28:31], v[124:127], v[76:79], v[28:31]
    ds_read_b128 v[48:51], v136 offset:1024
    v_mfma_f32_16x16x32_bf16 v[0:3], v[128:131], v[80:83], v[0:3]
    ds_read_b128 v[52:55], v136 offset:3072
    v_mfma_f32_16x16x32_bf16 v[4:7], v[128:131], v[84:87], v[4:7]
    ds_read_b128 v[56:59], v136 offset:5120
    ds_read_b128 v[60:63], v136 offset:7168
    v_mfma_f32_16x16x32_bf16 v[8:11], v[128:131], v[88:91], v[8:11]
    ds_read_b64_tr_b16 v[116:117], v138 offset:36864
    v_mfma_f32_16x16x32_bf16 v[12:15], v[128:131], v[92:95], v[12:15]
    ds_read_b64_tr_b16 v[118:119], v138 offset:38912
    v_mfma_f32_16x16x32_bf16 v[16:19], v[132:135], v[80:83], v[16:19]
    v_mfma_f32_16x16x32_bf16 v[20:23], v[132:135], v[84:87], v[20:23]
    v_mfma_f32_16x16x32_bf16 v[24:27], v[132:135], v[88:91], v[24:27]
    v_mfma_f32_16x16x32_bf16 v[28:31], v[132:135], v[92:95], v[28:31]
    s_waitcnt lgkmcnt(0)
    s_barrier
    .p2align 3
    v_mfma_f32_16x16x32_bf16 v[0:3], v[104:107], v[32:35], v[0:3]
    ds_read_b64_tr_b16 v[120:121], v137 offset:40960
    ds_read_b64_tr_b16 v[122:123], v137 offset:43008
    v_mfma_f32_16x16x32_bf16 v[4:7], v[104:107], v[36:39], v[4:7]
    ds_read_b128 v[64:67], v136 offset:16384
    v_mfma_f32_16x16x32_bf16 v[8:11], v[104:107], v[40:43], v[8:11]
    ds_read_b128 v[68:71], v136 offset:18432
    v_mfma_f32_16x16x32_bf16 v[12:15], v[104:107], v[44:47], v[12:15]
    ds_read_b128 v[72:75], v136 offset:20480
    ds_read_b128 v[76:79], v136 offset:22528
    v_mfma_f32_16x16x32_bf16 v[16:19], v[108:111], v[32:35], v[16:19]
    ds_read_b64_tr_b16 v[124:125], v138 offset:40960
    v_mfma_f32_16x16x32_bf16 v[20:23], v[108:111], v[36:39], v[20:23]
    ds_read_b64_tr_b16 v[126:127], v138 offset:43008
    v_mfma_f32_16x16x32_bf16 v[24:27], v[108:111], v[40:43], v[24:27]
    ds_read_b64_tr_b16 v[128:129], v137 offset:45056
    ds_read_b64_tr_b16 v[130:131], v137 offset:47104
    v_mfma_f32_16x16x32_bf16 v[28:31], v[108:111], v[44:47], v[28:31]
    ds_read_b128 v[80:83], v136 offset:17408
    v_mfma_f32_16x16x32_bf16 v[0:3], v[112:115], v[48:51], v[0:3]
    ds_read_b128 v[84:87], v136 offset:19456
    v_mfma_f32_16x16x32_bf16 v[4:7], v[112:115], v[52:55], v[4:7]
    ds_read_b128 v[88:91], v136 offset:21504
    ds_read_b128 v[92:95], v136 offset:23552
    v_mfma_f32_16x16x32_bf16 v[8:11], v[112:115], v[56:59], v[8:11]
    ds_read_b64_tr_b16 v[132:133], v138 offset:45056
    v_mfma_f32_16x16x32_bf16 v[12:15], v[112:115], v[60:63], v[12:15]
    ds_read_b64_tr_b16 v[134:135], v138 offset:47104
    v_mfma_f32_16x16x32_bf16 v[16:19], v[116:119], v[48:51], v[16:19]
    v_mfma_f32_16x16x32_bf16 v[20:23], v[116:119], v[52:55], v[20:23]
    v_mfma_f32_16x16x32_bf16 v[24:27], v[116:119], v[56:59], v[24:27]
    v_mfma_f32_16x16x32_bf16 v[28:31], v[116:119], v[60:63], v[28:31]
    s_waitcnt lgkmcnt(0)
    s_barrier
    .p2align 3
    v_mfma_f32_16x16x32_bf16 v[0:3], v[120:123], v[64:67], v[0:3]
    ds_read_b64_tr_b16 v[104:105], v139 offset:0
    ds_read_b64_tr_b16 v[106:107], v139 offset:2048
    v_mfma_f32_16x16x32_bf16 v[4:7], v[120:123], v[68:71], v[4:7]
    ds_read_b128 v[32:35], v136 offset:32768
    v_mfma_f32_16x16x32_bf16 v[8:11], v[120:123], v[72:75], v[8:11]
    ds_read_b128 v[36:39], v136 offset:34816
    v_mfma_f32_16x16x32_bf16 v[12:15], v[120:123], v[76:79], v[12:15]
    ds_read_b128 v[40:43], v136 offset:36864
    ds_read_b128 v[44:47], v136 offset:38912
    v_mfma_f32_16x16x32_bf16 v[16:19], v[124:127], v[64:67], v[16:19]
    ds_read_b64_tr_b16 v[108:109], v140 offset:0
    v_mfma_f32_16x16x32_bf16 v[20:23], v[124:127], v[68:71], v[20:23]
    ds_read_b64_tr_b16 v[110:111], v140 offset:2048
    v_mfma_f32_16x16x32_bf16 v[24:27], v[124:127], v[72:75], v[24:27]
    ds_read_b64_tr_b16 v[112:113], v139 offset:4096
    ds_read_b64_tr_b16 v[114:115], v139 offset:6144
    v_mfma_f32_16x16x32_bf16 v[28:31], v[124:127], v[76:79], v[28:31]
    ds_read_b128 v[48:51], v136 offset:33792
    v_mfma_f32_16x16x32_bf16 v[0:3], v[128:131], v[80:83], v[0:3]
    ds_read_b128 v[52:55], v136 offset:35840
    v_mfma_f32_16x16x32_bf16 v[4:7], v[128:131], v[84:87], v[4:7]
    ds_read_b128 v[56:59], v136 offset:37888
    ds_read_b128 v[60:63], v136 offset:39936
    v_mfma_f32_16x16x32_bf16 v[8:11], v[128:131], v[88:91], v[8:11]
    ds_read_b64_tr_b16 v[116:117], v140 offset:4096
    v_mfma_f32_16x16x32_bf16 v[12:15], v[128:131], v[92:95], v[12:15]
    ds_read_b64_tr_b16 v[118:119], v140 offset:6144
    v_mfma_f32_16x16x32_bf16 v[16:19], v[132:135], v[80:83], v[16:19]
    v_mfma_f32_16x16x32_bf16 v[20:23], v[132:135], v[84:87], v[20:23]
    v_mfma_f32_16x16x32_bf16 v[24:27], v[132:135], v[88:91], v[24:27]
    v_mfma_f32_16x16x32_bf16 v[28:31], v[132:135], v[92:95], v[28:31]
    s_waitcnt lgkmcnt(0)
    s_barrier
    .p2align 3
    v_mfma_f32_16x16x32_bf16 v[0:3], v[104:107], v[32:35], v[0:3]
    ds_read_b64_tr_b16 v[120:121], v139 offset:8192
    ds_read_b64_tr_b16 v[122:123], v139 offset:10240
    v_mfma_f32_16x16x32_bf16 v[4:7], v[104:107], v[36:39], v[4:7]
    ds_read_b128 v[64:67], v136 offset:0
    v_mfma_f32_16x16x32_bf16 v[8:11], v[104:107], v[40:43], v[8:11]
    ds_read_b128 v[68:71], v136 offset:2048
    v_mfma_f32_16x16x32_bf16 v[12:15], v[104:107], v[44:47], v[12:15]
    ds_read_b128 v[72:75], v136 offset:4096
    ds_read_b128 v[76:79], v136 offset:6144
    v_mfma_f32_16x16x32_bf16 v[16:19], v[108:111], v[32:35], v[16:19]
    ds_read_b64_tr_b16 v[124:125], v140 offset:8192
    v_mfma_f32_16x16x32_bf16 v[20:23], v[108:111], v[36:39], v[20:23]
    ds_read_b64_tr_b16 v[126:127], v140 offset:10240
    v_mfma_f32_16x16x32_bf16 v[24:27], v[108:111], v[40:43], v[24:27]
    ds_read_b64_tr_b16 v[128:129], v139 offset:12288
    ds_read_b64_tr_b16 v[130:131], v139 offset:14336
    v_mfma_f32_16x16x32_bf16 v[28:31], v[108:111], v[44:47], v[28:31]
    ds_read_b128 v[80:83], v136 offset:1024
    v_mfma_f32_16x16x32_bf16 v[0:3], v[112:115], v[48:51], v[0:3]
    ds_read_b128 v[84:87], v136 offset:3072
    v_mfma_f32_16x16x32_bf16 v[4:7], v[112:115], v[52:55], v[4:7]
    ds_read_b128 v[88:91], v136 offset:5120
    ds_read_b128 v[92:95], v136 offset:7168
    v_mfma_f32_16x16x32_bf16 v[8:11], v[112:115], v[56:59], v[8:11]
    ds_read_b64_tr_b16 v[132:133], v140 offset:12288
    v_mfma_f32_16x16x32_bf16 v[12:15], v[112:115], v[60:63], v[12:15]
    ds_read_b64_tr_b16 v[134:135], v140 offset:14336
    v_mfma_f32_16x16x32_bf16 v[16:19], v[116:119], v[48:51], v[16:19]
    v_mfma_f32_16x16x32_bf16 v[20:23], v[116:119], v[52:55], v[20:23]
    v_mfma_f32_16x16x32_bf16 v[24:27], v[116:119], v[56:59], v[24:27]
    v_mfma_f32_16x16x32_bf16 v[28:31], v[116:119], v[60:63], v[28:31]
    s_waitcnt lgkmcnt(0)
    s_barrier
    .p2align 3
    v_mfma_f32_16x16x32_bf16 v[0:3], v[120:123], v[64:67], v[0:3]
    v_mfma_f32_16x16x32_bf16 v[4:7], v[120:123], v[68:71], v[4:7]
    v_mfma_f32_16x16x32_bf16 v[8:11], v[120:123], v[72:75], v[8:11]
    v_mfma_f32_16x16x32_bf16 v[12:15], v[120:123], v[76:79], v[12:15]
    v_mfma_f32_16x16x32_bf16 v[16:19], v[124:127], v[64:67], v[16:19]
    v_mfma_f32_16x16x32_bf16 v[20:23], v[124:127], v[68:71], v[20:23]
    v_mfma_f32_16x16x32_bf16 v[24:27], v[124:127], v[72:75], v[24:27]
    v_mfma_f32_16x16x32_bf16 v[28:31], v[124:127], v[76:79], v[28:31]
    v_mfma_f32_16x16x32_bf16 v[0:3], v[128:131], v[80:83], v[0:3]
    v_mfma_f32_16x16x32_bf16 v[4:7], v[128:131], v[84:87], v[4:7]
    v_mfma_f32_16x16x32_bf16 v[8:11], v[128:131], v[88:91], v[8:11]
    v_mfma_f32_16x16x32_bf16 v[12:15], v[128:131], v[92:95], v[12:15]
    v_mfma_f32_16x16x32_bf16 v[16:19], v[132:135], v[80:83], v[16:19]
    v_mfma_f32_16x16x32_bf16 v[20:23], v[132:135], v[84:87], v[20:23]
    v_mfma_f32_16x16x32_bf16 v[24:27], v[132:135], v[88:91], v[24:27]
    v_mfma_f32_16x16x32_bf16 v[28:31], v[132:135], v[92:95], v[28:31]
    s_nop 7
    s_add_u32 s59, s1, s49
    s_add_u32 s60, s59, 4096
    v_cvt_pk_bf16_f32 v32, v0, v1
    v_cvt_pk_bf16_f32 v33, v2, v3
    v_cvt_pk_bf16_f32 v34, v16, v17
    v_cvt_pk_bf16_f32 v35, v18, v19
    buffer_store_dwordx4 v[32:35], v254, s[4:7], s59 offen offset:0 sc0 sc1
    v_cvt_pk_bf16_f32 v36, v4, v5
    v_cvt_pk_bf16_f32 v37, v6, v7
    v_cvt_pk_bf16_f32 v38, v20, v21
    v_cvt_pk_bf16_f32 v39, v22, v23
    buffer_store_dwordx4 v[36:39], v254, s[4:7], s59 offen offset:2048 sc0 sc1
    v_cvt_pk_bf16_f32 v40, v8, v9
    v_cvt_pk_bf16_f32 v41, v10, v11
    v_cvt_pk_bf16_f32 v42, v24, v25
    v_cvt_pk_bf16_f32 v43, v26, v27
    buffer_store_dwordx4 v[40:43], v254, s[4:7], s60 offen offset:0 sc0 sc1
    v_cvt_pk_bf16_f32 v44, v12, v13
    v_cvt_pk_bf16_f32 v45, v14, v15
    v_cvt_pk_bf16_f32 v46, v28, v29
    v_cvt_pk_bf16_f32 v47, v30, v31
    buffer_store_dwordx4 v[44:47], v254, s[4:7], s60 offen offset:2048 sc0 sc1
    v_mov_b32 v56, 0x3f803f80
    v_dot2_f32_bf16 v48, v32, v56, 0
    v_dot2_f32_bf16 v52, v32, v32, 0
    v_dot2_f32_bf16 v49, v36, v56, 0
    v_dot2_f32_bf16 v53, v36, v36, 0
    v_dot2_f32_bf16 v50, v40, v56, 0
    v_dot2_f32_bf16 v54, v40, v40, 0
    v_dot2_f32_bf16 v51, v44, v56, 0
    v_dot2_f32_bf16 v55, v44, v44, 0
    v_dot2_f32_bf16 v48, v33, v56, v48
    v_dot2_f32_bf16 v52, v33, v33, v52
    v_dot2_f32_bf16 v49, v37, v56, v49
    v_dot2_f32_bf16 v53, v37, v37, v53
    v_dot2_f32_bf16 v50, v41, v56, v50
    v_dot2_f32_bf16 v54, v41, v41, v54
    v_dot2_f32_bf16 v51, v45, v56, v51
    v_dot2_f32_bf16 v55, v45, v45, v55
    v_dot2_f32_bf16 v48, v34, v56, v48
    v_dot2_f32_bf16 v52, v34, v34, v52
    v_dot2_f32_bf16 v49, v38, v56, v49
    v_dot2_f32_bf16 v53, v38, v38, v53
    v_dot2_f32_bf16 v50, v42, v56, v50
    v_dot2_f32_bf16 v54, v42, v42, v54
    v_dot2_f32_bf16 v51, v46, v56, v51
    v_dot2_f32_bf16 v55, v46, v46, v55
    v_dot2_f32_bf16 v48, v35, v56, v48
    v_dot2_f32_bf16 v52, v35, v35, v52
    v_dot2_f32_bf16 v49, v39, v56, v49
    v_dot2_f32_bf16 v53, v39, v39, v53
    v_dot2_f32_bf16 v50, v43, v56, v50
    v_dot2_f32_bf16 v54, v43, v43, v54
    v_dot2_f32_bf16 v51, v47, v56, v51
    v_dot2_f32_bf16 v55, v47, v47, v55
    s_lshl_b32 s55, s42, 9
    s_add_u32 s55, s55, 155648
    s_nop 1
    v_permlane32_swap_b32 v48, v50
    v_permlane32_swap_b32 v49, v51
    v_permlane32_swap_b32 v52, v54
    v_permlane32_swap_b32 v53, v55
    v_add_f32 v48, v48, v50
    v_add_f32 v49, v49, v51
    v_add_f32 v52, v52, v54
    v_add_f32 v53, v53, v55
    v_lshrrev_b32 v56, 1, v254
    v_add_u32 v56, s55, v56
    v_permlane16_swap_b32 v48, v49
    v_permlane16_swap_b32 v52, v53
    v_add_f32 v48, v48, v49
    v_add_f32 v49, v52, v53
    ds_write_b64 v56, v[48:49]
    s_lshl_b32 s55, s43, 13
    s_add_u32 s55, s55, 98304
    v_add_u32 v224, s55, v254
    s_lshl_b32 s56, s44, 2
    v_lshrrev_b32 v233, 6, v254
    v_and_b32 v234, 7, v233
    v_xor_b32 v234, s56, v234
    v_lshlrev_b32 v233, 8, v233
    v_lshl_add_u32 v233, v234, 5, v233
    v_and_b32 v234, 0x30, v254
    v_lshrrev_b32 v234, 1, v234
    v_add_u32 v233, v233, v234
    v_xor_b32 v225, 0, v233
    v_xor_b32 v226, 32, v233
    v_xor_b32 v227, 64, v233
    v_xor_b32 v228, 96, v233
    v_add_u32 v229, 49152, v225
    v_add_u32 v230, 49152, v226
    v_add_u32 v231, 49152, v227
    v_add_u32 v232, 49152, v228
    v_lshrrev_b32 v233, 7, v254
    v_and_b32 v234, 0x70, v254
    v_and_b32 v235, 6, v233
    v_lshlrev_b32 v235, 4, v235
    v_xor_b32 v234, v234, v235
    v_mul_u32_u24 v233, 7168, v233
    v_add3_u32 v236, v233, v234, s66
    v_add_u32 v237, 56320, v236
    v_add_u32 v242, s67, v254
    v_and_b32 v234, 0xf0, v254
    v_lshrrev_b32 v233, 8, v254
    v_lshlrev_b32 v235, 5, v233
    v_xor_b32 v234, v234, v235
    v_mul_u32_u24 v233, 2048, v233
    v_add_u32 v238, v233, v234
    v_xor_b32 v234, 0x80, v234
    v_add_u32 v233, v233, v234
    v_add_u32 v239, 7168, v233
    v_add_u32 v240, 14336, v238
    v_add_u32 v241, 14336, v239
    v_mov_b32 v243, v224
    s_and_b32 s56, s51, 1
    s_lshl_b32 s56, s56, 2
    s_lshl_b32 s55, s44, 1
    s_add_u32 s56, s56, s55
    v_lshrrev_b32 v233, 6, v254
    v_and_b32 v234, 7, v233
    v_xor_b32 v234, s56, v234
    v_lshlrev_b32 v233, 8, v233
    v_lshl_add_u32 v233, v234, 5, v233
    v_and_b32 v234, 0x30, v254
    v_lshrrev_b32 v234, 1, v234
    v_add_u32 v233, v233, v234
    v_xor_b32 v244, 0, v233
    v_xor_b32 v245, 32, v233
    v_xor_b32 v246, 128, v233
    v_xor_b32 v247, 160, v233
    v_add_u32 v248, 49152, v244
    v_add_u32 v249, 49152, v245
    v_add_u32 v250, 49152, v246
    v_add_u32 v251, 49152, v247
    s_and_b32 s55, s51, 1
    s_mul_i32 s55, s55, 458752
    s_add_u32 s95, s50, s55
    s_and_b32 s55, s41, 7
    s_lshl_b32 s55, s55, 14
    s_and_b32 s56, s1, 0x3fff
    s_add_u32 s55, s55, s56
    s_add_u32 s89, s55, s95
    s_and_b32 s55, s41, 6
    s_add_u32 s55, s55, 48
    s_lshl_b32 s55, s55, 13
    s_and_b32 s56, s41, 1
    s_lshl_b32 s56, s56, 10
    s_add_u32 s55, s55, s56
    s_add_u32 s55, s55, s62
    s_add_u32 s90, s55, s95
    s_add_u32 s88, s49, s62
    s_lshl_b32 s94, s51, 14
    s_waitcnt vmcnt(0) lgkmcnt(0)
    s_barrier
    s_cmp_lg_u32 s42, 2
    s_cbranch_scc1 wf_20
    s_lshr_b32 s55, s2, 5
    s_lshl_b32 s55, s55, 2
    s_add_u32 s55, s55, s0
    v_mov_b32 v252, 32
    v_mov_b32 v253, 0x01010101
    s_mov_b64 exec, 1
    s_cmp_eq_u32 s45, 0
    s_cbranch_scc1 st_21
    buffer_store_dword v253, v252, s[4:7], s55 offen sc0 sc1
    s_branch st_22
st_21:
    buffer_store_dword v253, v252, s[4:7], s55 offen
st_22:
    s_mov_b64 exec, -1
wf_20:
    s_cmp_lg_u32 s42, 0
    s_cbranch_scc1 so_23
    v_add_u32 v216, 155648, v254
    ds_read_b128 v[208:211], v216
    ds_read_b128 v[212:215], v216 offset:1024
    s_lshl_b32 s55, s51, 10
    s_add_u32 s55, s55, s52
    s_waitcnt lgkmcnt(0)
    v_add_f32 v208, v208, v212
    v_add_f32 v209, v209, v213
    v_add_f32 v210, v210, v214
    v_add_f32 v211, v211, v215
    buffer_store_dwordx4 v[208:211], v254, s[4:7], s55 offen sc0 sc1
so_23:
    s_barrier
    ds_read_b64_tr_b16 v[160:161], v229 offset:16384
    ds_read_b64_tr_b16 v[162:163], v229 offset:20480
    ds_read_b128 v[128:131], v224 offset:0
    ds_read_b128 v[132:135], v224 offset:2048
    ds_read_b128 v[136:139], v224 offset:4096
    ds_read_b128 v[140:143], v224 offset:6144
    ds_read_b64_tr_b16 v[176:177], v229 offset:24576
    ds_read_b64_tr_b16 v[178:179], v229 offset:28672
    ds_read_b64_tr_b16 v[164:165], v230 offset:16384
    ds_read_b64_tr_b16 v[166:167], v230 offset:20480
    ds_read_b64_tr_b16 v[180:181], v230 offset:24576
    ds_read_b64_tr_b16 v[182:183], v230 offset:28672
    ds_read_b64_tr_b16 v[168:169], v231 offset:16384
    ds_read_b64_tr_b16 v[170:171], v231 offset:20480
    ds_read_b64_tr_b16 v[184:185], v231 offset:24576
    ds_read_b64_tr_b16 v[186:187], v231 offset:28672
    ds_read_b64_tr_b16 v[172:173], v232 offset:16384
    ds_read_b64_tr_b16 v[174:175], v232 offset:20480
    ds_read_b64_tr_b16 v[188:189], v232 offset:24576
    ds_read_b64_tr_b16 v[190:191], v232 offset:28672
    s_mov_b32 s58, 5
    s_waitcnt lgkmcnt(0)
    s_barrier
    .p2align 3
    v_mfma_f32_16x16x32_bf16 v[0:3], v[160:163], v[128:131], 0
    ds_read_b64_tr_b16 v[192:193], v229 offset:32768
    v_mfma_f32_16x16x32_bf16 v[4:7], v[160:163], v[132:135], 0
    ds_read_b64_tr_b16 v[194:195], v229 offset:36864
    v_mfma_f32_16x16x32_bf16 v[8:11], v[160:163], v[136:139], 0
    ds_read_b128 v[144:147], v224 offset:1024
    v_mfma_f32_16x16x32_bf16 v[12:15], v[160:163], v[140:143], 0
    ds_read_b128 v[148:151], v224 offset:3072
    v_mfma_f32_16x16x32_bf16 v[64:67], v[176:179], v[128:131], 0
    ds_read_b128 v[152:155], v224 offset:5120
    v_mfma_f32_16x16x32_bf16 v[68:71], v[176:179], v[132:135], 0
    v_mfma_f32_16x16x32_bf16 v[72:75], v[176:179], v[136:139], 0
    ds_read_b128 v[156:159], v224 offset:7168
    v_mfma_f32_16x16x32_bf16 v[76:79], v[176:179], v[140:143], 0
    ds_read_b64_tr_b16 v[208:209], v229 offset:40960
    v_mfma_f32_16x16x32_bf16 v[16:19], v[164:167], v[128:131], 0
    ds_read_b64_tr_b16 v[210:211], v229 offset:45056
    v_mfma_f32_16x16x32_bf16 v[20:23], v[164:167], v[132:135], 0
    ds_read_b64_tr_b16 v[196:197], v230 offset:32768
    v_mfma_f32_16x16x32_bf16 v[24:27], v[164:167], v[136:139], 0
    ds_read_b64_tr_b16 v[198:199], v230 offset:36864
    v_mfma_f32_16x16x32_bf16 v[28:31], v[164:167], v[140:143], 0
    v_mfma_f32_16x16x32_bf16 v[80:83], v[180:183], v[128:131], 0
    ds_read_b64_tr_b16 v[212:213], v230 offset:40960
    v_mfma_f32_16x16x32_bf16 v[84:87], v[180:183], v[132:135], 0
    ds_read_b64_tr_b16 v[214:215], v230 offset:45056
    v_mfma_f32_16x16x32_bf16 v[88:91], v[180:183], v[136:139], 0
    ds_read_b64_tr_b16 v[200:201], v231 offset:32768
    v_mfma_f32_16x16x32_bf16 v[92:95], v[180:183], v[140:143], 0
    ds_read_b64_tr_b16 v[202:203], v231 offset:36864
    v_mfma_f32_16x16x32_bf16 v[32:35], v[168:171], v[128:131], 0
    ds_read_b64_tr_b16 v[216:217], v231 offset:40960
    v_mfma_f32_16x16x32_bf16 v[36:39], v[168:171], v[132:135], 0
    v_mfma_f32_16x16x32_bf16 v[40:43], v[168:171], v[136:139], 0
    ds_read_b64_tr_b16 v[218:219], v231 offset:45056
    v_mfma_f32_16x16x32_bf16 v[44:47], v[168:171], v[140:143], 0
    ds_read_b64_tr_b16 v[204:205], v232 offset:32768
    v_mfma_f32_16x16x32_bf16 v[96:99], v[184:187], v[128:131], 0
    ds_read_b64_tr_b16 v[206:207], v232 offset:36864
    v_mfma_f32_16x16x32_bf16 v[100:103], v[184:187], v[132:135], 0
    ds_read_b64_tr_b16 v[220:221], v232 offset:40960
    v_mfma_f32_16x16x32_bf16 v[104:107], v[184:187], v[136:139], 0
    ds_read_b64_tr_b16 v[222:223], v232 offset:45056
    v_mfma_f32_16x16x32_bf16 v[108:111], v[184:187], v[140:143], 0
    v_mfma_f32_16x16x32_bf16 v[48:51], v[172:175], v[128:131], 0
    v_mfma_f32_16x16x32_bf16 v[52:55], v[172:175], v[132:135], 0
    v_mfma_f32_16x16x32_bf16 v[56:59], v[172:175], v[136:139], 0
    v_mfma_f32_16x16x32_bf16 v[60:63], v[172:175], v[140:143], 0
    v_mfma_f32_16x16x32_bf16 v[112:115], v[188:191], v[128:131], 0
    v_mfma_f32_16x16x32_bf16 v[116:119], v[188:191], v[132:135], 0
    v_mfma_f32_16x16x32_bf16 v[120:123], v[188:191], v[136:139], 0
    v_mfma_f32_16x16x32_bf16 v[124:127], v[188:191], v[140:143], 0
    .p2align 3
loop_24:
    s_waitcnt lgkmcnt(0)
    s_barrier
    .p2align 3
    v_mfma_f32_16x16x32_bf16 v[0:3], v[192:195], v[144:147], v[0:3]
    ds_read_b64_tr_b16 v[160:161], v225 offset:0
    v_mfma_f32_16x16x32_bf16 v[4:7], v[192:195], v[148:151], v[4:7]
    ds_read_b64_tr_b16 v[162:163], v225 offset:4096
    v_mfma_f32_16x16x32_bf16 v[8:11], v[192:195], v[152:155], v[8:11]
    ds_read_b128 v[128:131], v224 offset:16384
    v_mfma_f32_16x16x32_bf16 v[12:15], v[192:195], v[156:159], v[12:15]
    ds_read_b128 v[132:135], v224 offset:18432
    v_mfma_f32_16x16x32_bf16 v[64:67], v[208:211], v[144:147], v[64:67]
    ds_read_b128 v[136:139], v224 offset:20480
    v_mfma_f32_16x16x32_bf16 v[68:71], v[208:211], v[148:151], v[68:71]
    v_mfma_f32_16x16x32_bf16 v[72:75], v[208:211], v[152:155], v[72:75]
    ds_read_b128 v[140:143], v224 offset:22528
    v_mfma_f32_16x16x32_bf16 v[76:79], v[208:211], v[156:159], v[76:79]
    ds_read_b64_tr_b16 v[176:177], v225 offset:8192
    v_mfma_f32_16x16x32_bf16 v[16:19], v[196:199], v[144:147], v[16:19]
    ds_read_b64_tr_b16 v[178:179], v225 offset:12288
    v_mfma_f32_16x16x32_bf16 v[20:23], v[196:199], v[148:151], v[20:23]
    ds_read_b64_tr_b16 v[164:165], v226 offset:0
    v_mfma_f32_16x16x32_bf16 v[24:27], v[196:199], v[152:155], v[24:27]
    ds_read_b64_tr_b16 v[166:167], v226 offset:4096
    v_mfma_f32_16x16x32_bf16 v[28:31], v[196:199], v[156:159], v[28:31]
    v_mfma_f32_16x16x32_bf16 v[80:83], v[212:215], v[144:147], v[80:83]
    ds_read_b64_tr_b16 v[180:181], v226 offset:8192
    v_mfma_f32_16x16x32_bf16 v[84:87], v[212:215], v[148:151], v[84:87]
    ds_read_b64_tr_b16 v[182:183], v226 offset:12288
    v_mfma_f32_16x16x32_bf16 v[88:91], v[212:215], v[152:155], v[88:91]
    ds_read_b64_tr_b16 v[168:169], v227 offset:0
    v_mfma_f32_16x16x32_bf16 v[92:95], v[212:215], v[156:159], v[92:95]
    ds_read_b64_tr_b16 v[170:171], v227 offset:4096
    v_mfma_f32_16x16x32_bf16 v[32:35], v[200:203], v[144:147], v[32:35]
    ds_read_b64_tr_b16 v[184:185], v227 offset:8192
    v_mfma_f32_16x16x32_bf16 v[36:39], v[200:203], v[148:151], v[36:39]
    v_mfma_f32_16x16x32_bf16 v[40:43], v[200:203], v[152:155], v[40:43]
    ds_read_b64_tr_b16 v[186:187], v227 offset:12288
    v_mfma_f32_16x16x32_bf16 v[44:47], v[200:203], v[156:159], v[44:47]
    ds_read_b64_tr_b16 v[172:173], v228 offset:0
    v_mfma_f32_16x16x32_bf16 v[96:99], v[216:219], v[144:147], v[96:99]
    ds_read_b64_tr_b16 v[174:175], v228 offset:4096
    v_mfma_f32_16x16x32_bf16 v[100:103], v[216:219], v[148:151], v[100:103]
    ds_read_b64_tr_b16 v[188:189], v228 offset:8192
    v_mfma_f32_16x16x32_bf16 v[104:107], v[216:219], v[152:155], v[104:107]
    ds_read_b64_tr_b16 v[190:191], v228 offset:12288
    v_mfma_f32_16x16x32_bf16 v[108:111], v[216:219], v[156:159], v[108:111]
    v_mfma_f32_16x16x32_bf16 v[48:51], v[204:207], v[144:147], v[48:51]
    v_mfma_f32_16x16x32_bf16 v[52:55], v[204:207], v[148:151], v[52:55]
    v_mfma_f32_16x16x32_bf16 v[56:59], v[204:207], v[152:155], v[56:59]
    v_mfma_f32_16x16x32_bf16 v[60:63], v[204:207], v[156:159], v[60:63]
    v_mfma_f32_16x16x32_bf16 v[112:115], v[220:223], v[144:147], v[112:115]
    v_mfma_f32_16x16x32_bf16 v[116:119], v[220:223], v[148:151], v[116:119]
    v_mfma_f32_16x16x32_bf16 v[120:123], v[220:223], v[152:155], v[120:123]
    v_mfma_f32_16x16x32_bf16 v[124:127], v[220:223], v[156:159], v[124:127]
    s_waitcnt vmcnt(0) lgkmcnt(0)
    s_barrier
    .p2align 3
    v_mfma_f32_16x16x32_bf16 v[0:3], v[160:163], v[128:131], v[0:3]
    ds_read_b64_tr_b16 v[192:193], v225 offset:16384
    v_mfma_f32_16x16x32_bf16 v[4:7], v[160:163], v[132:135], v[4:7]
    ds_read_b64_tr_b16 v[194:195], v225 offset:20480
    v_mfma_f32_16x16x32_bf16 v[8:11], v[160:163], v[136:139], v[8:11]
    ds_read_b128 v[144:147], v224 offset:17408
    v_mfma_f32_16x16x32_bf16 v[12:15], v[160:163], v[140:143], v[12:15]
    ds_read_b128 v[148:151], v224 offset:19456
    v_mfma_f32_16x16x32_bf16 v[64:67], v[176:179], v[128:131], v[64:67]
    ds_read_b128 v[152:155], v224 offset:21504
    v_mfma_f32_16x16x32_bf16 v[68:71], v[176:179], v[132:135], v[68:71]
    v_mfma_f32_16x16x32_bf16 v[72:75], v[176:179], v[136:139], v[72:75]
    ds_read_b128 v[156:159], v224 offset:23552
    v_mfma_f32_16x16x32_bf16 v[76:79], v[176:179], v[140:143], v[76:79]
    ds_read_b64_tr_b16 v[208:209], v225 offset:24576
    v_mfma_f32_16x16x32_bf16 v[16:19], v[164:167], v[128:131], v[16:19]
    ds_read_b64_tr_b16 v[210:211], v225 offset:28672
    v_mfma_f32_16x16x32_bf16 v[20:23], v[164:167], v[132:135], v[20:23]
    ds_read_b64_tr_b16 v[196:197], v226 offset:16384
    v_mfma_f32_16x16x32_bf16 v[24:27], v[164:167], v[136:139], v[24:27]
    ds_read_b64_tr_b16 v[198:199], v226 offset:20480
    v_mfma_f32_16x16x32_bf16 v[28:31], v[164:167], v[140:143], v[28:31]
    v_mfma_f32_16x16x32_bf16 v[80:83], v[180:183], v[128:131], v[80:83]
    ds_read_b64_tr_b16 v[212:213], v226 offset:24576
    v_mfma_f32_16x16x32_bf16 v[84:87], v[180:183], v[132:135], v[84:87]
    ds_read_b64_tr_b16 v[214:215], v226 offset:28672
    v_mfma_f32_16x16x32_bf16 v[88:91], v[180:183], v[136:139], v[88:91]
    ds_read_b64_tr_b16 v[200:201], v227 offset:16384
    v_mfma_f32_16x16x32_bf16 v[92:95], v[180:183], v[140:143], v[92:95]
    ds_read_b64_tr_b16 v[202:203], v227 offset:20480
    v_mfma_f32_16x16x32_bf16 v[32:35], v[168:171], v[128:131], v[32:35]
    ds_read_b64_tr_b16 v[216:217], v227 offset:24576
    v_mfma_f32_16x16x32_bf16 v[36:39], v[168:171], v[132:135], v[36:39]
    v_mfma_f32_16x16x32_bf16 v[40:43], v[168:171], v[136:139], v[40:43]
    ds_read_b64_tr_b16 v[218:219], v227 offset:28672
    v_mfma_f32_16x16x32_bf16 v[44:47], v[168:171], v[140:143], v[44:47]
    ds_read_b64_tr_b16 v[204:205], v228 offset:16384
    v_mfma_f32_16x16x32_bf16 v[96:99], v[184:187], v[128:131], v[96:99]
    ds_read_b64_tr_b16 v[206:207], v228 offset:20480
    v_mfma_f32_16x16x32_bf16 v[100:103], v[184:187], v[132:135], v[100:103]
    ds_read_b64_tr_b16 v[220:221], v228 offset:24576
    v_mfma_f32_16x16x32_bf16 v[104:107], v[184:187], v[136:139], v[104:107]
    ds_read_b64_tr_b16 v[222:223], v228 offset:28672
    v_mfma_f32_16x16x32_bf16 v[108:111], v[184:187], v[140:143], v[108:111]
    v_mfma_f32_16x16x32_bf16 v[48:51], v[172:175], v[128:131], v[48:51]
    v_mfma_f32_16x16x32_bf16 v[52:55], v[172:175], v[132:135], v[52:55]
    v_mfma_f32_16x16x32_bf16 v[56:59], v[172:175], v[136:139], v[56:59]
    v_mfma_f32_16x16x32_bf16 v[60:63], v[172:175], v[140:143], v[60:63]
    v_mfma_f32_16x16x32_bf16 v[112:115], v[188:191], v[128:131], v[112:115]
    v_mfma_f32_16x16x32_bf16 v[116:119], v[188:191], v[132:135], v[116:119]
    v_mfma_f32_16x16x32_bf16 v[120:123], v[188:191], v[136:139], v[120:123]
    v_mfma_f32_16x16x32_bf16 v[124:127], v[188:191], v[140:143], v[124:127]
    s_waitcnt lgkmcnt(0)
    s_barrier
    .p2align 3
    v_mfma_f32_16x16x32_bf16 v[0:3], v[192:195], v[144:147], v[0:3]
    ds_read_b64_tr_b16 v[160:161], v225 offset:32768
    v_mfma_f32_16x16x32_bf16 v[4:7], v[192:195], v[148:151], v[4:7]
    ds_read_b64_tr_b16 v[162:163], v225 offset:36864
    v_mfma_f32_16x16x32_bf16 v[8:11], v[192:195], v[152:155], v[8:11]
    ds_read_b128 v[128:131], v224 offset:32768
    v_mfma_f32_16x16x32_bf16 v[12:15], v[192:195], v[156:159], v[12:15]
    ds_read_b128 v[132:135], v224 offset:34816
    v_mfma_f32_16x16x32_bf16 v[64:67], v[208:211], v[144:147], v[64:67]
    ds_read_b128 v[136:139], v224 offset:36864
    v_mfma_f32_16x16x32_bf16 v[68:71], v[208:211], v[148:151], v[68:71]
    v_mfma_f32_16x16x32_bf16 v[72:75], v[208:211], v[152:155], v[72:75]
    ds_read_b128 v[140:143], v224 offset:38912
    v_mfma_f32_16x16x32_bf16 v[76:79], v[208:211], v[156:159], v[76:79]
    ds_read_b64_tr_b16 v[176:177], v225 offset:40960
    v_mfma_f32_16x16x32_bf16 v[16:19], v[196:199], v[144:147], v[16:19]
    ds_read_b64_tr_b16 v[178:179], v225 offset:45056
    v_mfma_f32_16x16x32_bf16 v[20:23], v[196:199], v[148:151], v[20:23]
    ds_read_b64_tr_b16 v[164:165], v226 offset:32768
    v_mfma_f32_16x16x32_bf16 v[24:27], v[196:199], v[152:155], v[24:27]
    ds_read_b64_tr_b16 v[166:167], v226 offset:36864
    v_mfma_f32_16x16x32_bf16 v[28:31], v[196:199], v[156:159], v[28:31]
    v_mfma_f32_16x16x32_bf16 v[80:83], v[212:215], v[144:147], v[80:83]
    ds_read_b64_tr_b16 v[180:181], v226 offset:40960
    v_mfma_f32_16x16x32_bf16 v[84:87], v[212:215], v[148:151], v[84:87]
    ds_read_b64_tr_b16 v[182:183], v226 offset:45056
    v_mfma_f32_16x16x32_bf16 v[88:91], v[212:215], v[152:155], v[88:91]
    ds_read_b64_tr_b16 v[168:169], v227 offset:32768
    v_mfma_f32_16x16x32_bf16 v[92:95], v[212:215], v[156:159], v[92:95]
    ds_read_b64_tr_b16 v[170:171], v227 offset:36864
    v_mfma_f32_16x16x32_bf16 v[32:35], v[200:203], v[144:147], v[32:35]
    ds_read_b64_tr_b16 v[184:185], v227 offset:40960
    v_mfma_f32_16x16x32_bf16 v[36:39], v[200:203], v[148:151], v[36:39]
    v_mfma_f32_16x16x32_bf16 v[40:43], v[200:203], v[152:155], v[40:43]
    ds_read_b64_tr_b16 v[186:187], v227 offset:45056
    v_mfma_f32_16x16x32_bf16 v[44:47], v[200:203], v[156:159], v[44:47]
    ds_read_b64_tr_b16 v[172:173], v228 offset:32768
    v_mfma_f32_16x16x32_bf16 v[96:99], v[216:219], v[144:147], v[96:99]
    ds_read_b64_tr_b16 v[174:175], v228 offset:36864
    v_mfma_f32_16x16x32_bf16 v[100:103], v[216:219], v[148:151], v[100:103]
    ds_read_b64_tr_b16 v[188:189], v228 offset:40960
    v_mfma_f32_16x16x32_bf16 v[104:107], v[216:219], v[152:155], v[104:107]
    ds_read_b64_tr_b16 v[190:191], v228 offset:45056
    v_mfma_f32_16x16x32_bf16 v[108:111], v[216:219], v[156:159], v[108:111]
    v_mfma_f32_16x16x32_bf16 v[48:51], v[204:207], v[144:147], v[48:51]
    v_mfma_f32_16x16x32_bf16 v[52:55], v[204:207], v[148:151], v[52:55]
    v_mfma_f32_16x16x32_bf16 v[56:59], v[204:207], v[152:155], v[56:59]
    v_mfma_f32_16x16x32_bf16 v[60:63], v[204:207], v[156:159], v[60:63]
    v_mfma_f32_16x16x32_bf16 v[112:115], v[220:223], v[144:147], v[112:115]
    v_mfma_f32_16x16x32_bf16 v[116:119], v[220:223], v[148:151], v[116:119]
    v_mfma_f32_16x16x32_bf16 v[120:123], v[220:223], v[152:155], v[120:123]
    v_mfma_f32_16x16x32_bf16 v[124:127], v[220:223], v[156:159], v[124:127]
    s_waitcnt lgkmcnt(0)
    s_barrier
    .p2align 3
    v_mfma_f32_16x16x32_bf16 v[0:3], v[160:163], v[128:131], v[0:3]
    ds_read_b64_tr_b16 v[192:193], v229 offset:0
    v_mfma_f32_16x16x32_bf16 v[4:7], v[160:163], v[132:135], v[4:7]
    ds_read_b64_tr_b16 v[194:195], v229 offset:4096
    v_mfma_f32_16x16x32_bf16 v[8:11], v[160:163], v[136:139], v[8:11]
    ds_read_b128 v[144:147], v224 offset:33792
    v_mfma_f32_16x16x32_bf16 v[12:15], v[160:163], v[140:143], v[12:15]
    ds_read_b128 v[148:151], v224 offset:35840
    v_mfma_f32_16x16x32_bf16 v[64:67], v[176:179], v[128:131], v[64:67]
    ds_read_b128 v[152:155], v224 offset:37888
    v_mfma_f32_16x16x32_bf16 v[68:71], v[176:179], v[132:135], v[68:71]
    v_mfma_f32_16x16x32_bf16 v[72:75], v[176:179], v[136:139], v[72:75]
    ds_read_b128 v[156:159], v224 offset:39936
    v_mfma_f32_16x16x32_bf16 v[76:79], v[176:179], v[140:143], v[76:79]
    ds_read_b64_tr_b16 v[208:209], v229 offset:8192
    v_mfma_f32_16x16x32_bf16 v[16:19], v[164:167], v[128:131], v[16:19]
    ds_read_b64_tr_b16 v[210:211], v229 offset:12288
    v_mfma_f32_16x16x32_bf16 v[20:23], v[164:167], v[132:135], v[20:23]
    ds_read_b64_tr_b16 v[196:197], v230 offset:0
    v_mfma_f32_16x16x32_bf16 v[24:27], v[164:167], v[136:139], v[24:27]
    ds_read_b64_tr_b16 v[198:199], v230 offset:4096
    v_mfma_f32_16x16x32_bf16 v[28:31], v[164:167], v[140:143], v[28:31]
    v_mfma_f32_16x16x32_bf16 v[80:83], v[180:183], v[128:131], v[80:83]
    ds_read_b64_tr_b16 v[212:213], v230 offset:8192
    v_mfma_f32_16x16x32_bf16 v[84:87], v[180:183], v[132:135], v[84:87]
    ds_read_b64_tr_b16 v[214:215], v230 offset:12288
    v_mfma_f32_16x16x32_bf16 v[88:91], v[180:183], v[136:139], v[88:91]
    ds_read_b64_tr_b16 v[200:201], v231 offset:0
    v_mfma_f32_16x16x32_bf16 v[92:95], v[180:183], v[140:143], v[92:95]
    ds_read_b64_tr_b16 v[202:203], v231 offset:4096
    v_mfma_f32_16x16x32_bf16 v[32:35], v[168:171], v[128:131], v[32:35]
    ds_read_b64_tr_b16 v[216:217], v231 offset:8192
    v_mfma_f32_16x16x32_bf16 v[36:39], v[168:171], v[132:135], v[36:39]
    v_mfma_f32_16x16x32_bf16 v[40:43], v[168:171], v[136:139], v[40:43]
    ds_read_b64_tr_b16 v[218:219], v231 offset:12288
    v_mfma_f32_16x16x32_bf16 v[44:47], v[168:171], v[140:143], v[44:47]
    ds_read_b64_tr_b16 v[204:205], v232 offset:0
    v_mfma_f32_16x16x32_bf16 v[96:99], v[184:187], v[128:131], v[96:99]
    ds_read_b64_tr_b16 v[206:207], v232 offset:4096
    v_mfma_f32_16x16x32_bf16 v[100:103], v[184:187], v[132:135], v[100:103]
    ds_read_b64_tr_b16 v[220:221], v232 offset:8192
    v_mfma_f32_16x16x32_bf16 v[104:107], v[184:187], v[136:139], v[104:107]
    ds_read_b64_tr_b16 v[222:223], v232 offset:12288
    v_mfma_f32_16x16x32_bf16 v[108:111], v[184:187], v[140:143], v[108:111]
    v_mfma_f32_16x16x32_bf16 v[48:51], v[172:175], v[128:131], v[48:51]
    v_mfma_f32_16x16x32_bf16 v[52:55], v[172:175], v[132:135], v[52:55]
    v_mfma_f32_16x16x32_bf16 v[56:59], v[172:175], v[136:139], v[56:59]
    v_mfma_f32_16x16x32_bf16 v[60:63], v[172:175], v[140:143], v[60:63]
    v_mfma_f32_16x16x32_bf16 v[112:115], v[188:191], v[128:131], v[112:115]
    v_mfma_f32_16x16x32_bf16 v[116:119], v[188:191], v[132:135], v[116:119]
    v_mfma_f32_16x16x32_bf16 v[120:123], v[188:191], v[136:139], v[120:123]
    v_mfma_f32_16x16x32_bf16 v[124:127], v[188:191], v[140:143], v[124:127]
    s_waitcnt lgkmcnt(0)
    s_barrier
    .p2align 3
    v_mfma_f32_16x16x32_bf16 v[0:3], v[192:195], v[144:147], v[0:3]
    ds_read_b64_tr_b16 v[160:161], v229 offset:16384
    v_mfma_f32_16x16x32_bf16 v[4:7], v[192:195], v[148:151], v[4:7]
    ds_read_b64_tr_b16 v[162:163], v229 offset:20480
    v_mfma_f32_16x16x32_bf16 v[8:11], v[192:195], v[152:155], v[8:11]
    ds_read_b128 v[128:131], v224 offset:0
    v_mfma_f32_16x16x32_bf16 v[12:15], v[192:195], v[156:159], v[12:15]
    ds_read_b128 v[132:135], v224 offset:2048
    v_mfma_f32_16x16x32_bf16 v[64:67], v[208:211], v[144:147], v[64:67]
    ds_read_b128 v[136:139], v224 offset:4096
    v_mfma_f32_16x16x32_bf16 v[68:71], v[208:211], v[148:151], v[68:71]
    v_mfma_f32_16x16x32_bf16 v[72:75], v[208:211], v[152:155], v[72:75]
    ds_read_b128 v[140:143], v224 offset:6144
    v_mfma_f32_16x16x32_bf16 v[76:79], v[208:211], v[156:159], v[76:79]
    ds_read_b64_tr_b16 v[176:177], v229 offset:24576
    v_mfma_f32_16x16x32_bf16 v[16:19], v[196:199], v[144:147], v[16:19]
    ds_read_b64_tr_b16 v[178:179], v229 offset:28672
    v_mfma_f32_16x16x32_bf16 v[20:23], v[196:199], v[148:151], v[20:23]
    ds_read_b64_tr_b16 v[164:165], v230 offset:16384
    v_mfma_f32_16x16x32_bf16 v[24:27], v[196:199], v[152:155], v[24:27]
    ds_read_b64_tr_b16 v[166:167], v230 offset:20480
    v_mfma_f32_16x16x32_bf16 v[28:31], v[196:199], v[156:159], v[28:31]
    v_mfma_f32_16x16x32_bf16 v[80:83], v[212:215], v[144:147], v[80:83]
    ds_read_b64_tr_b16 v[180:181], v230 offset:24576
    v_mfma_f32_16x16x32_bf16 v[84:87], v[212:215], v[148:151], v[84:87]
    ds_read_b64_tr_b16 v[182:183], v230 offset:28672
    v_mfma_f32_16x16x32_bf16 v[88:91], v[212:215], v[152:155], v[88:91]
    ds_read_b64_tr_b16 v[168:169], v231 offset:16384
    v_mfma_f32_16x16x32_bf16 v[92:95], v[212:215], v[156:159], v[92:95]
    ds_read_b64_tr_b16 v[170:171], v231 offset:20480
    v_mfma_f32_16x16x32_bf16 v[32:35], v[200:203], v[144:147], v[32:35]
    ds_read_b64_tr_b16 v[184:185], v231 offset:24576
    v_mfma_f32_16x16x32_bf16 v[36:39], v[200:203], v[148:151], v[36:39]
    v_mfma_f32_16x16x32_bf16 v[40:43], v[200:203], v[152:155], v[40:43]
    ds_read_b64_tr_b16 v[186:187], v231 offset:28672
    v_mfma_f32_16x16x32_bf16 v[44:47], v[200:203], v[156:159], v[44:47]
    ds_read_b64_tr_b16 v[172:173], v232 offset:16384
    v_mfma_f32_16x16x32_bf16 v[96:99], v[216:219], v[144:147], v[96:99]
    ds_read_b64_tr_b16 v[174:175], v232 offset:20480
    v_mfma_f32_16x16x32_bf16 v[100:103], v[216:219], v[148:151], v[100:103]
    ds_read_b64_tr_b16 v[188:189], v232 offset:24576
    v_mfma_f32_16x16x32_bf16 v[104:107], v[216:219], v[152:155], v[104:107]
    ds_read_b64_tr_b16 v[190:191], v232 offset:28672
    v_mfma_f32_16x16x32_bf16 v[108:111], v[216:219], v[156:159], v[108:111]
    v_mfma_f32_16x16x32_bf16 v[48:51], v[204:207], v[144:147], v[48:51]
    v_mfma_f32_16x16x32_bf16 v[52:55], v[204:207], v[148:151], v[52:55]
    v_mfma_f32_16x16x32_bf16 v[56:59], v[204:207], v[152:155], v[56:59]
    v_mfma_f32_16x16x32_bf16 v[60:63], v[204:207], v[156:159], v[60:63]
    v_mfma_f32_16x16x32_bf16 v[112:115], v[220:223], v[144:147], v[112:115]
    v_mfma_f32_16x16x32_bf16 v[116:119], v[220:223], v[148:151], v[116:119]
    v_mfma_f32_16x16x32_bf16 v[120:123], v[220:223], v[152:155], v[120:123]
    v_mfma_f32_16x16x32_bf16 v[124:127], v[220:223], v[156:159], v[124:127]
    s_waitcnt lgkmcnt(0)
    s_barrier
    .p2align 3
    v_mfma_f32_16x16x32_bf16 v[0:3], v[160:163], v[128:131], v[0:3]
    ds_read_b64_tr_b16 v[192:193], v229 offset:32768
    v_mfma_f32_16x16x32_bf16 v[4:7], v[160:163], v[132:135], v[4:7]
    ds_read_b64_tr_b16 v[194:195], v229 offset:36864
    v_mfma_f32_16x16x32_bf16 v[8:11], v[160:163], v[136:139], v[8:11]
    ds_read_b128 v[144:147], v224 offset:1024
    v_mfma_f32_16x16x32_bf16 v[12:15], v[160:163], v[140:143], v[12:15]
    ds_read_b128 v[148:151], v224 offset:3072
    v_mfma_f32_16x16x32_bf16 v[64:67], v[176:179], v[128:131], v[64:67]
    ds_read_b128 v[152:155], v224 offset:5120
    v_mfma_f32_16x16x32_bf16 v[68:71], v[176:179], v[132:135], v[68:71]
    v_mfma_f32_16x16x32_bf16 v[72:75], v[176:179], v[136:139], v[72:75]
    ds_read_b128 v[156:159], v224 offset:7168
    v_mfma_f32_16x16x32_bf16 v[76:79], v[176:179], v[140:143], v[76:79]
    ds_read_b64_tr_b16 v[208:209], v229 offset:40960
    v_mfma_f32_16x16x32_bf16 v[16:19], v[164:167], v[128:131], v[16:19]
    ds_read_b64_tr_b16 v[210:211], v229 offset:45056
    v_mfma_f32_16x16x32_bf16 v[20:23], v[164:167], v[132:135], v[20:23]
    ds_read_b64_tr_b16 v[196:197], v230 offset:32768
    v_mfma_f32_16x16x32_bf16 v[24:27], v[164:167], v[136:139], v[24:27]
    ds_read_b64_tr_b16 v[198:199], v230 offset:36864
    v_mfma_f32_16x16x32_bf16 v[28:31], v[164:167], v[140:143], v[28:31]
    v_mfma_f32_16x16x32_bf16 v[80:83], v[180:183], v[128:131], v[80:83]
    ds_read_b64_tr_b16 v[212:213], v230 offset:40960
    v_mfma_f32_16x16x32_bf16 v[84:87], v[180:183], v[132:135], v[84:87]
    ds_read_b64_tr_b16 v[214:215], v230 offset:45056
    v_mfma_f32_16x16x32_bf16 v[88:91], v[180:183], v[136:139], v[88:91]
    ds_read_b64_tr_b16 v[200:201], v231 offset:32768
    v_mfma_f32_16x16x32_bf16 v[92:95], v[180:183], v[140:143], v[92:95]
    ds_read_b64_tr_b16 v[202:203], v231 offset:36864
    v_mfma_f32_16x16x32_bf16 v[32:35], v[168:171], v[128:131], v[32:35]
    ds_read_b64_tr_b16 v[216:217], v231 offset:40960
    v_mfma_f32_16x16x32_bf16 v[36:39], v[168:171], v[132:135], v[36:39]
    v_mfma_f32_16x16x32_bf16 v[40:43], v[168:171], v[136:139], v[40:43]
    ds_read_b64_tr_b16 v[218:219], v231 offset:45056
    v_mfma_f32_16x16x32_bf16 v[44:47], v[168:171], v[140:143], v[44:47]
    ds_read_b64_tr_b16 v[204:205], v232 offset:32768
    v_mfma_f32_16x16x32_bf16 v[96:99], v[184:187], v[128:131], v[96:99]
    ds_read_b64_tr_b16 v[206:207], v232 offset:36864
    v_mfma_f32_16x16x32_bf16 v[100:103], v[184:187], v[132:135], v[100:103]
    ds_read_b64_tr_b16 v[220:221], v232 offset:40960
    v_mfma_f32_16x16x32_bf16 v[104:107], v[184:187], v[136:139], v[104:107]
    ds_read_b64_tr_b16 v[222:223], v232 offset:45056
    v_mfma_f32_16x16x32_bf16 v[108:111], v[184:187], v[140:143], v[108:111]
    v_mfma_f32_16x16x32_bf16 v[48:51], v[172:175], v[128:131], v[48:51]
    v_mfma_f32_16x16x32_bf16 v[52:55], v[172:175], v[132:135], v[52:55]
    v_mfma_f32_16x16x32_bf16 v[56:59], v[172:175], v[136:139], v[56:59]
    v_mfma_f32_16x16x32_bf16 v[60:63], v[172:175], v[140:143], v[60:63]
    v_mfma_f32_16x16x32_bf16 v[112:115], v[188:191], v[128:131], v[112:115]
    s_sub_u32 s58, s58, 1
    s_cmp_lg_u32 s58, 0
    .p2align 3
    v_mfma_f32_16x16x32_bf16 v[116:119], v[188:191], v[132:135], v[116:119]
    v_mfma_f32_16x16x32_bf16 v[120:123], v[188:191], v[136:139], v[120:123]
    v_mfma_f32_16x16x32_bf16 v[124:127], v[188:191], v[140:143], v[124:127]
    s_cbranch_scc1 loop_24
    s_waitcnt lgkmcnt(0)
    s_barrier
    .p2align 3
    v_mfma_f32_16x16x32_bf16 v[0:3], v[192:195], v[144:147], v[0:3]
    v_mfma_f32_16x16x32_bf16 v[4:7], v[192:195], v[148:151], v[4:7]
    v_mfma_f32_16x16x32_bf16 v[8:11], v[192:195], v[152:155], v[8:11]
    v_mfma_f32_16x16x32_bf16 v[12:15], v[192:195], v[156:159], v[12:15]
    v_mfma_f32_16x16x32_bf16 v[64:67], v[208:211], v[144:147], v[64:67]
    v_mfma_f32_16x16x32_bf16 v[68:71], v[208:211], v[148:151], v[68:71]
    v_mfma_f32_16x16x32_bf16 v[72:75], v[208:211], v[152:155], v[72:75]
    v_mfma_f32_16x16x32_bf16 v[76:79], v[208:211], v[156:159], v[76:79]
    v_mfma_f32_16x16x32_bf16 v[16:19], v[196:199], v[144:147], v[16:19]
    v_mfma_f32_16x16x32_bf16 v[20:23], v[196:199], v[148:151], v[20:23]
    v_mfma_f32_16x16x32_bf16 v[24:27], v[196:199], v[152:155], v[24:27]
    v_mfma_f32_16x16x32_bf16 v[28:31], v[196:199], v[156:159], v[28:31]
    v_mfma_f32_16x16x32_bf16 v[80:83], v[212:215], v[144:147], v[80:83]
    v_mfma_f32_16x16x32_bf16 v[84:87], v[212:215], v[148:151], v[84:87]
    v_mfma_f32_16x16x32_bf16 v[88:91], v[212:215], v[152:155], v[88:91]
    v_mfma_f32_16x16x32_bf16 v[92:95], v[212:215], v[156:159], v[92:95]
    v_mfma_f32_16x16x32_bf16 v[32:35], v[200:203], v[144:147], v[32:35]
    v_mfma_f32_16x16x32_bf16 v[36:39], v[200:203], v[148:151], v[36:39]
    v_mfma_f32_16x16x32_bf16 v[40:43], v[200:203], v[152:155], v[40:43]
    v_mfma_f32_16x16x32_bf16 v[44:47], v[200:203], v[156:159], v[44:47]
    v_mfma_f32_16x16x32_bf16 v[96:99], v[216:219], v[144:147], v[96:99]
    v_mfma_f32_16x16x32_bf16 v[100:103], v[216:219], v[148:151], v[100:103]
    v_mfma_f32_16x16x32_bf16 v[104:107], v[216:219], v[152:155], v[104:107]
    v_mfma_f32_16x16x32_bf16 v[108:111], v[216:219], v[156:159], v[108:111]
    v_mfma_f32_16x16x32_bf16 v[48:51], v[204:207], v[144:147], v[48:51]
    v_mfma_f32_16x16x32_bf16 v[52:55], v[204:207], v[148:151], v[52:55]
    v_mfma_f32_16x16x32_bf16 v[56:59], v[204:207], v[152:155], v[56:59]
    v_mfma_f32_16x16x32_bf16 v[60:63], v[204:207], v[156:159], v[60:63]
    v_mfma_f32_16x16x32_bf16 v[112:115], v[220:223], v[144:147], v[112:115]
    v_mfma_f32_16x16x32_bf16 v[116:119], v[220:223], v[148:151], v[116:119]
    v_mfma_f32_16x16x32_bf16 v[120:123], v[220:223], v[152:155], v[120:123]
    v_mfma_f32_16x16x32_bf16 v[124:127], v[220:223], v[156:159], v[124:127]
    s_setprio 1
    v_add_u32 v191, s88, v254
    s_barrier
    s_add_u32 s93, s51, 0
    s_and_b32 s93, s93, 15
    s_lshl_b32 s93, s93, 12
    s_add_u32 m0, s61, 0
    s_mul_i32 s59, s93, 112
    buffer_load_dwordx4 v236, s[16:19], s59 offen lds
    s_nop 7
    s_lshl_b32 s55, s43, 9
    s_add_u32 s55, s55, 159744
    v_and_b32 v232, 0xf0, v254
    v_lshrrev_b32 v232, 1, v232
    v_add_u32 v232, s55, v232
    ds_read_b64 v[220:221], v232 offset:0
    ds_read_b64 v[222:223], v232 offset:128
    ds_read_b64 v[224:225], v232 offset:256
    ds_read_b64 v[226:227], v232 offset:384
    s_waitcnt lgkmcnt(0)
    v_sub_f32 v192, 0, v220
    buffer_load_dwordx4 v237, s[16:19], s59 offen offset:1024 lds
    v_mul_f32 v196, 0xbfb8aa3b, v221
    v_mul_f32 v200, v221, v221
    v_sub_f32 v193, 0, v222
    v_mul_f32 v197, 0xbfb8aa3b, v223
    v_mul_f32 v201, v223, v223
    v_sub_f32 v194, 0, v224
    v_mul_f32 v198, 0xbfb8aa3b, v225
    v_mul_f32 v202, v225, v225
    buffer_load_dwordx4 v242, s[4:7], s93 offen offset:2048 lds
    s_add_u32 s93, s93, 2048
    s_and_b32 s93, s93, 65535
    v_sub_f32 v195, 0, v226
    v_mul_f32 v199, 0xbfb8aa3b, v227
    v_mul_f32 v203, v227, v227
    v_rcp_f32 v200, v200
    v_rcp_f32 v201, v201
    v_rcp_f32 v202, v202
    v_rcp_f32 v203, v203
    s_nop 0
    s_barrier
    s_add_u32 m0, s62, 114688
    s_nop 0
    buffer_load_dwordx4 v191, s[4:7], s94 offen lds
    s_lshl_b32 s55, s44, 8
    s_add_u32 s55, s55, 161664
    v_lshrrev_b32 v235, 8, v254
    v_lshlrev_b32 v235, 4, v235
    v_add_u32 v235, s55, v235
    ds_read_b128 v[204:207], v235 offset:0
    ds_read_b128 v[208:211], v235 offset:512
    ds_read_b128 v[212:215], v235 offset:64
    buffer_load_dwordx4 v191, s[4:7], s94 offen offset:1024 lds
    ds_read_b128 v[216:219], v235 offset:576
    s_waitcnt lgkmcnt(0)
    v_fmac_f32 v0, v192, v204
    v_fmac_f32 v1, v192, v205
    v_fmac_f32 v2, v192, v206
    s_add_u32 m0, s61, 16384
    s_mul_i32 s59, s93, 112
    buffer_load_dwordx4 v236, s[16:19], s59 offen lds
    v_fmac_f32 v3, v192, v207
    v_mul_f32 v220, v196, v0
    v_mul_f32 v221, v196, v1
    v_mul_f32 v222, v196, v2
    buffer_load_dwordx4 v237, s[16:19], s59 offen offset:1024 lds
    v_mul_f32 v223, v196, v3
    v_fmac_f32 v64, v192, v208
    v_fmac_f32 v65, v192, v209
    v_fmac_f32 v66, v192, v210
    v_fmac_f32 v67, v192, v211
    buffer_load_dwordx4 v242, s[4:7], s93 offen offset:2048 lds
    s_add_u32 s93, s93, 6144
    s_and_b32 s93, s93, 65535
    v_exp_f32 v220, v220
    v_exp_f32 v221, v221
    v_exp_f32 v222, v222
    v_exp_f32 v223, v223
    v_mul_f32 v0, v0, v64
    s_barrier
    s_add_u32 m0, s62, 114688
    s_nop 0
    buffer_load_dwordx4 v191, s[4:7], s94 offen offset:2048 lds
    v_mul_f32 v1, v1, v65
    v_mul_f32 v2, v2, v66
    v_mul_f32 v3, v3, v67
    v_fma_f32 v220, v220, v200, v200
    buffer_load_dwordx4 v191, s[4:7], s94 offen offset:3072 lds
    s_add_u32 s94, s94, 32768
    s_and_b32 s94, s94, 262143
    v_fma_f32 v221, v221, v200, v200
    v_fma_f32 v222, v222, v200, v200
    v_fma_f32 v223, v223, v200, v200
    v_rcp_f32 v220, v220
    v_rcp_f32 v221, v221
    s_add_u32 m0, s61, 32768
    s_mul_i32 s59, s93, 112
    buffer_load_dwordx4 v236, s[16:19], s59 offen lds
    v_rcp_f32 v222, v222
    v_rcp_f32 v223, v223
    v_mul_f32 v0, v0, v220
    v_mul_f32 v1, v1, v221
    v_mul_f32 v2, v2, v222
    buffer_load_dwordx4 v237, s[16:19], s59 offen offset:1024 lds
    v_mul_f32 v3, v3, v223
    v_cvt_pk_bf16_f32 v224, v0, v1
    v_cvt_pk_bf16_f32 v225, v2, v3
    v_fmac_f32 v16, v192, v212
    v_fmac_f32 v17, v192, v213
    buffer_load_dwordx4 v242, s[4:7], s93 offen offset:2048 lds
    s_add_u32 s93, s93, 2048
    s_and_b32 s93, s93, 65535
    v_fmac_f32 v18, v192, v214
    v_fmac_f32 v19, v192, v215
    v_mul_f32 v220, v196, v16
    v_mul_f32 v221, v196, v17
    v_mul_f32 v222, v196, v18
    s_barrier
    s_add_u32 m0, s62, 131072
    s_nop 0
    buffer_load_dwordx4 v191, s[4:7], s94 offen lds
    v_mul_f32 v223, v196, v19
    v_fmac_f32 v80, v192, v216
    v_fmac_f32 v81, v192, v217
    v_fmac_f32 v82, v192, v218
    buffer_load_dwordx4 v191, s[4:7], s94 offen offset:1024 lds
    v_fmac_f32 v83, v192, v219
    v_exp_f32 v220, v220
    v_exp_f32 v221, v221
    v_exp_f32 v222, v222
    s_add_u32 m0, s61, 49152
    s_mul_i32 s59, s93, 112
    buffer_load_dwordx4 v236, s[16:19], s59 offen lds
    v_exp_f32 v223, v223
    v_mul_f32 v16, v16, v80
    v_mul_f32 v17, v17, v81
    v_mul_f32 v18, v18, v82
    buffer_load_dwordx4 v237, s[16:19], s59 offen offset:1024 lds
    v_mul_f32 v19, v19, v83
    v_fma_f32 v220, v220, v200, v200
    v_fma_f32 v221, v221, v200, v200
    v_fma_f32 v222, v222, v200, v200
    buffer_load_dwordx4 v242, s[4:7], s93 offen offset:2048 lds
    s_add_u32 s93, s93, 6144
    s_and_b32 s93, s93, 65535
    v_fma_f32 v223, v223, v200, v200
    v_rcp_f32 v220, v220
    v_rcp_f32 v221, v221
    v_rcp_f32 v222, v222
    s_barrier
    s_add_u32 m0, s62, 131072
    s_nop 0
    buffer_load_dwordx4 v191, s[4:7], s94 offen offset:2048 lds
    v_rcp_f32 v223, v223
    v_mul_f32 v16, v16, v220
    v_mul_f32 v17, v17, v221
    v_mul_f32 v18, v18, v222
    buffer_load_dwordx4 v191, s[4:7], s94 offen offset:3072 lds
    s_add_u32 s94, s94, 32768
    s_and_b32 s94, s94, 262143
    v_mul_f32 v19, v19, v223
    v_cvt_pk_bf16_f32 v226, v16, v17
    v_cvt_pk_bf16_f32 v227, v18, v19
    s_add_u32 s55, s89, 0
    buffer_store_dwordx4 v[224:227], v254, s[4:7], s55 offen sc0 sc1
    s_add_u32 m0, s61, 65536
    s_mul_i32 s59, s93, 112
    buffer_load_dwordx4 v236, s[16:19], s59 offen lds
    v_fmac_f32 v4, v193, v204
    v_fmac_f32 v5, v193, v205
    v_fmac_f32 v6, v193, v206
    v_fmac_f32 v7, v193, v207
    v_mul_f32 v220, v197, v4
    buffer_load_dwordx4 v237, s[16:19], s59 offen offset:1024 lds
    v_mul_f32 v221, v197, v5
    v_mul_f32 v222, v197, v6
    v_mul_f32 v223, v197, v7
    v_fmac_f32 v68, v193, v208
    buffer_load_dwordx4 v242, s[4:7], s93 offen offset:2048 lds
    s_add_u32 s93, s93, 2048
    s_and_b32 s93, s93, 65535
    v_fmac_f32 v69, v193, v209
    v_fmac_f32 v70, v193, v210
    v_fmac_f32 v71, v193, v211
    v_exp_f32 v220, v220
    v_exp_f32 v221, v221
    s_waitcnt vmcnt(14)
    s_barrier
    s_add_u32 m0, s62, 98304
    s_nop 0
    buffer_load_dwordx4 v191, s[4:7], s94 offen lds
    v_exp_f32 v222, v222
    v_exp_f32 v223, v223
    v_mul_f32 v4, v4, v68
    v_mul_f32 v5, v5, v69
    buffer_load_dwordx4 v191, s[4:7], s94 offen offset:1024 lds
    v_mul_f32 v6, v6, v70
    v_mul_f32 v7, v7, v71
    v_fma_f32 v220, v220, v201, v201
    v_fma_f32 v221, v221, v201, v201
    s_add_u32 m0, s61, 81920
    s_mul_i32 s59, s93, 112
    buffer_load_dwordx4 v236, s[16:19], s59 offen lds
    v_fma_f32 v222, v222, v201, v201
    v_fma_f32 v223, v223, v201, v201
    v_rcp_f32 v220, v220
    v_rcp_f32 v221, v221
    v_rcp_f32 v222, v222
    buffer_load_dwordx4 v237, s[16:19], s59 offen offset:1024 lds
    v_rcp_f32 v223, v223
    v_mul_f32 v4, v4, v220
    v_mul_f32 v5, v5, v221
    v_mul_f32 v6, v6, v222
    buffer_load_dwordx4 v242, s[4:7], s93 offen offset:2048 lds
    s_add_u32 s93, s93, 6144
    s_and_b32 s93, s93, 65535
    v_mul_f32 v7, v7, v223
    v_cvt_pk_bf16_f32 v228, v4, v5
    v_cvt_pk_bf16_f32 v229, v6, v7
    v_fmac_f32 v20, v193, v212
    v_fmac_f32 v21, v193, v213
    s_barrier
    s_add_u32 m0, s62, 98304
    s_nop 0
    buffer_load_dwordx4 v191, s[4:7], s94 offen offset:2048 lds
    v_fmac_f32 v22, v193, v214
    v_fmac_f32 v23, v193, v215
    v_mul_f32 v220, v197, v20
    v_mul_f32 v221, v197, v21
    buffer_load_dwordx4 v191, s[4:7], s94 offen offset:3072 lds
    s_add_u32 s94, s94, 32768
    s_and_b32 s94, s94, 262143
    v_mul_f32 v222, v197, v22
    v_mul_f32 v223, v197, v23
    v_fmac_f32 v84, v193, v216
    v_fmac_f32 v85, v193, v217
    v_fmac_f32 v86, v193, v218
    s_add_u32 m0, s61, 0
    s_mul_i32 s59, s93, 112
    buffer_load_dwordx4 v236, s[16:19], s59 offen lds
    v_fmac_f32 v87, v193, v219
    v_exp_f32 v220, v220
    v_exp_f32 v221, v221
    v_exp_f32 v222, v222
    buffer_load_dwordx4 v237, s[16:19], s59 offen offset:1024 lds
    v_exp_f32 v223, v223
    v_mul_f32 v20, v20, v84
    v_mul_f32 v21, v21, v85
    v_mul_f32 v22, v22, v86
    v_mul_f32 v23, v23, v87
    buffer_load_dwordx4 v242, s[4:7], s93 offen offset:2048 lds
    s_add_u32 s93, s93, 2048
    s_and_b32 s93, s93, 65535
    v_fma_f32 v220, v220, v201, v201
    v_fma_f32 v221, v221, v201, v201
    v_fma_f32 v222, v222, v201, v201
    v_fma_f32 v223, v223, v201, v201
    v_rcp_f32 v220, v220
    s_waitcnt vmcnt(14)
    s_barrier
    s_add_u32 m0, s62, 114688
    s_nop 0
    buffer_load_dwordx4 v191, s[4:7], s94 offen lds
    v_rcp_f32 v221, v221
    v_rcp_f32 v222, v222
    v_rcp_f32 v223, v223
    v_mul_f32 v20, v20, v220
    buffer_load_dwordx4 v191, s[4:7], s94 offen offset:1024 lds
    v_mul_f32 v21, v21, v221
    v_mul_f32 v22, v22, v222
    v_mul_f32 v23, v23, v223
    v_cvt_pk_bf16_f32 v230, v20, v21
    s_add_u32 m0, s61, 16384
    s_mul_i32 s59, s93, 112
    buffer_load_dwordx4 v236, s[16:19], s59 offen lds
    v_cvt_pk_bf16_f32 v231, v22, v23
    s_add_u32 s55, s89, 2048
    buffer_store_dwordx4 v[228:231], v254, s[4:7], s55 offen sc0 sc1
    v_fmac_f32 v8, v194, v204
    v_fmac_f32 v9, v194, v205
    v_fmac_f32 v10, v194, v206
    buffer_load_dwordx4 v237, s[16:19], s59 offen offset:1024 lds
    v_fmac_f32 v11, v194, v207
    v_mul_f32 v220, v198, v8
    v_mul_f32 v221, v198, v9
    v_mul_f32 v222, v198, v10
    buffer_load_dwordx4 v242, s[4:7], s93 offen offset:2048 lds
    s_add_u32 s93, s93, 6144
    s_and_b32 s93, s93, 65535
    v_mul_f32 v223, v198, v11
    v_fmac_f32 v72, v194, v208
    v_fmac_f32 v73, v194, v209
    v_fmac_f32 v74, v194, v210
    v_fmac_f32 v75, v194, v211
    s_barrier
    s_add_u32 m0, s62, 114688
    s_nop 0
    buffer_load_dwordx4 v191, s[4:7], s94 offen offset:2048 lds
    v_exp_f32 v220, v220
    v_exp_f32 v221, v221
    v_exp_f32 v222, v222
    v_exp_f32 v223, v223
    buffer_load_dwordx4 v191, s[4:7], s94 offen offset:3072 lds
    s_add_u32 s94, s94, 32768
    s_and_b32 s94, s94, 262143
    v_mul_f32 v8, v8, v72
    v_mul_f32 v9, v9, v73
    v_mul_f32 v10, v10, v74
    v_mul_f32 v11, v11, v75
    s_add_u32 m0, s61, 32768
    s_mul_i32 s59, s93, 112
    buffer_load_dwordx4 v236, s[16:19], s59 offen lds
    v_fma_f32 v220, v220, v202, v202
    v_fma_f32 v221, v221, v202, v202
    v_fma_f32 v222, v222, v202, v202
    v_fma_f32 v223, v223, v202, v202
    buffer_load_dwordx4 v237, s[16:19], s59 offen offset:1024 lds
    v_rcp_f32 v220, v220
    v_rcp_f32 v221, v221
    v_rcp_f32 v222, v222
    v_rcp_f32 v223, v223
    buffer_load_dwordx4 v242, s[4:7], s93 offen offset:2048 lds
    s_add_u32 s93, s93, 2048
    s_and_b32 s93, s93, 65535
    v_mul_f32 v8, v8, v220
    v_mul_f32 v9, v9, v221
    v_mul_f32 v10, v10, v222
    v_mul_f32 v11, v11, v223
    s_waitcnt vmcnt(14)
    s_barrier
    s_add_u32 m0, s62, 131072
    s_nop 0
    buffer_load_dwordx4 v191, s[4:7], s94 offen lds
    v_cvt_pk_bf16_f32 v224, v8, v9
    v_cvt_pk_bf16_f32 v225, v10, v11
    v_fmac_f32 v24, v194, v212
    v_fmac_f32 v25, v194, v213
    buffer_load_dwordx4 v191, s[4:7], s94 offen offset:1024 lds
    v_fmac_f32 v26, v194, v214
    v_fmac_f32 v27, v194, v215
    v_mul_f32 v220, v198, v24
    v_mul_f32 v221, v198, v25
    v_mul_f32 v222, v198, v26
    s_add_u32 m0, s61, 49152
    s_mul_i32 s59, s93, 112
    buffer_load_dwordx4 v236, s[16:19], s59 offen lds
    v_mul_f32 v223, v198, v27
    v_fmac_f32 v88, v194, v216
    v_fmac_f32 v89, v194, v217
    v_fmac_f32 v90, v194, v218
    v_fmac_f32 v91, v194, v219
    buffer_load_dwordx4 v237, s[16:19], s59 offen offset:1024 lds
    v_exp_f32 v220, v220
    v_exp_f32 v221, v221
    v_exp_f32 v222, v222
    v_exp_f32 v223, v223
    v_mul_f32 v24, v24, v88
    buffer_load_dwordx4 v242, s[4:7], s93 offen offset:2048 lds
    s_add_u32 s93, s93, 6144
    s_and_b32 s93, s93, 65535
    v_mul_f32 v25, v25, v89
    v_mul_f32 v26, v26, v90
    v_mul_f32 v27, v27, v91
    v_fma_f32 v220, v220, v202, v202
    v_fma_f32 v221, v221, v202, v202
    s_barrier
    s_add_u32 m0, s62, 131072
    s_nop 0
    buffer_load_dwordx4 v191, s[4:7], s94 offen offset:2048 lds
    v_fma_f32 v222, v222, v202, v202
    v_fma_f32 v223, v223, v202, v202
    v_rcp_f32 v220, v220
    v_rcp_f32 v221, v221
    buffer_load_dwordx4 v191, s[4:7], s94 offen offset:3072 lds
    s_add_u32 s94, s94, 32768
    s_and_b32 s94, s94, 262143
    v_rcp_f32 v222, v222
    v_rcp_f32 v223, v223
    v_mul_f32 v24, v24, v220
    v_mul_f32 v25, v25, v221
    s_add_u32 m0, s61, 65536
    s_mul_i32 s59, s93, 112
    buffer_load_dwordx4 v236, s[16:19], s59 offen lds
    v_mul_f32 v26, v26, v222
    v_mul_f32 v27, v27, v223
    v_cvt_pk_bf16_f32 v226, v24, v25
    v_cvt_pk_bf16_f32 v227, v26, v27
    buffer_load_dwordx4 v237, s[16:19], s59 offen offset:1024 lds
    s_add_u32 s55, s89, 4096
    buffer_store_dwordx4 v[224:227], v254, s[4:7], s55 offen sc0 sc1
    v_fmac_f32 v12, v195, v204
    v_fmac_f32 v13, v195, v205
    v_fmac_f32 v14, v195, v206
    buffer_load_dwordx4 v242, s[4:7], s93 offen offset:2048 lds
    s_add_u32 s93, s93, 2048
    s_and_b32 s93, s93, 65535
    v_fmac_f32 v15, v195, v207
    v_mul_f32 v220, v199, v12
    v_mul_f32 v221, v199, v13
    v_mul_f32 v222, v199, v14
    v_mul_f32 v223, v199, v15
    s_waitcnt vmcnt(14)
    s_barrier
    s_add_u32 m0, s62, 98304
    s_nop 0
    buffer_load_dwordx4 v191, s[4:7], s94 offen lds
    v_fmac_f32 v76, v195, v208
    v_fmac_f32 v77, v195, v209
    v_fmac_f32 v78, v195, v210
    v_fmac_f32 v79, v195, v211
    buffer_load_dwordx4 v191, s[4:7], s94 offen offset:1024 lds
    v_exp_f32 v220, v220
    v_exp_f32 v221, v221
    v_exp_f32 v222, v222
    v_exp_f32 v223, v223
    s_add_u32 m0, s61, 81920
    s_mul_i32 s59, s93, 112
    buffer_load_dwordx4 v236, s[16:19], s59 offen lds
    v_mul_f32 v12, v12, v76
    v_mul_f32 v13, v13, v77
    v_mul_f32 v14, v14, v78
    v_mul_f32 v15, v15, v79
    buffer_load_dwordx4 v237, s[16:19], s59 offen offset:1024 lds
    v_fma_f32 v220, v220, v203, v203
    v_fma_f32 v221, v221, v203, v203
    v_fma_f32 v222, v222, v203, v203
    v_fma_f32 v223, v223, v203, v203
    buffer_load_dwordx4 v242, s[4:7], s93 offen offset:2048 lds
    s_add_u32 s93, s93, 6144
    s_and_b32 s93, s93, 65535
    v_rcp_f32 v220, v220
    v_rcp_f32 v221, v221
    v_rcp_f32 v222, v222
    v_rcp_f32 v223, v223
    s_barrier
    s_add_u32 m0, s62, 98304
    s_nop 0
    buffer_load_dwordx4 v191, s[4:7], s94 offen offset:2048 lds
    v_mul_f32 v12, v12, v220
    v_mul_f32 v13, v13, v221
    v_mul_f32 v14, v14, v222
    v_mul_f32 v15, v15, v223
    buffer_load_dwordx4 v191, s[4:7], s94 offen offset:3072 lds
    s_add_u32 s94, s94, 32768
    s_and_b32 s94, s94, 262143
    v_cvt_pk_bf16_f32 v228, v12, v13
    v_cvt_pk_bf16_f32 v229, v14, v15
    v_fmac_f32 v28, v195, v212
    v_fmac_f32 v29, v195, v213
    v_fmac_f32 v30, v195, v214
    s_add_u32 m0, s61, 0
    s_mul_i32 s59, s93, 112
    buffer_load_dwordx4 v236, s[16:19], s59 offen lds
    v_fmac_f32 v31, v195, v215
    v_mul_f32 v220, v199, v28
    v_mul_f32 v221, v199, v29
    v_mul_f32 v222, v199, v30
    v_mul_f32 v223, v199, v31
    buffer_load_dwordx4 v237, s[16:19], s59 offen offset:1024 lds
    v_fmac_f32 v92, v195, v216
    v_fmac_f32 v93, v195, v217
    v_fmac_f32 v94, v195, v218
    v_fmac_f32 v95, v195, v219
    v_exp_f32 v220, v220
    buffer_load_dwordx4 v242, s[4:7], s93 offen offset:2048 lds
    s_add_u32 s93, s93, 2048
    s_and_b32 s93, s93, 65535
    v_exp_f32 v221, v221
    v_exp_f32 v222, v222
    v_exp_f32 v223, v223
    v_mul_f32 v28, v28, v92
    v_mul_f32 v29, v29, v93
    s_waitcnt vmcnt(14)
    s_barrier
    s_add_u32 m0, s62, 114688
    s_nop 0
    buffer_load_dwordx4 v191, s[4:7], s94 offen lds
    v_mul_f32 v30, v30, v94
    v_mul_f32 v31, v31, v95
    v_fma_f32 v220, v220, v203, v203
    buffer_load_dwordx4 v191, s[4:7], s94 offen offset:1024 lds
    v_fma_f32 v221, v221, v203, v203
    v_fma_f32 v222, v222, v203, v203
    v_fma_f32 v223, v223, v203, v203
    s_add_u32 m0, s61, 16384
    s_mul_i32 s59, s93, 112
    buffer_load_dwordx4 v236, s[16:19], s59 offen lds
    v_rcp_f32 v220, v220
    v_rcp_f32 v221, v221
    v_rcp_f32 v222, v222
    v_rcp_f32 v223, v223
    buffer_load_dwordx4 v237, s[16:19], s59 offen offset:1024 lds
    v_mul_f32 v28, v28, v220
    v_mul_f32 v29, v29, v221
    v_mul_f32 v30, v30, v222
    buffer_load_dwordx4 v242, s[4:7], s93 offen offset:2048 lds
    s_add_u32 s93, s93, 6144
    s_and_b32 s93, s93, 65535
    v_mul_f32 v31, v31, v223
    v_cvt_pk_bf16_f32 v230, v28, v29
    v_cvt_pk_bf16_f32 v231, v30, v31
    s_add_u32 s55, s89, 6144
    buffer_store_dwordx4 v[228:231], v254, s[4:7], s55 offen sc0 sc1
    s_barrier
    s_add_u32 m0, s62, 114688
    s_nop 0
    buffer_load_dwordx4 v191, s[4:7], s94 offen offset:2048 lds
    ds_read_b128 v[204:207], v235 offset:128
    ds_read_b128 v[208:211], v235 offset:640
    ds_read_b128 v[212:215], v235 offset:192
    ds_read_b128 v[216:219], v235 offset:704
    s_waitcnt lgkmcnt(0)
    buffer_load_dwordx4 v191, s[4:7], s94 offen offset:3072 lds
    s_add_u32 s94, s94, 32768
    s_and_b32 s94, s94, 262143
    v_fmac_f32 v32, v192, v204
    v_fmac_f32 v33, v192, v205
    v_fmac_f32 v34, v192, v206
    v_fmac_f32 v35, v192, v207
    v_mul_f32 v220, v196, v32
    s_add_u32 m0, s61, 32768
    s_mul_i32 s59, s93, 112
    buffer_load_dwordx4 v236, s[16:19], s59 offen lds
    v_mul_f32 v221, v196, v33
    v_mul_f32 v222, v196, v34
    v_mul_f32 v223, v196, v35
    v_fmac_f32 v96, v192, v208
    v_fmac_f32 v97, v192, v209
    buffer_load_dwordx4 v237, s[16:19], s59 offen offset:1024 lds
    v_fmac_f32 v98, v192, v210
    v_fmac_f32 v99, v192, v211
    v_exp_f32 v220, v220
    v_exp_f32 v221, v221
    v_exp_f32 v222, v222
    buffer_load_dwordx4 v242, s[4:7], s93 offen offset:2048 lds
    s_add_u32 s93, s93, 2048
    s_and_b32 s93, s93, 65535
    v_exp_f32 v223, v223
    v_mul_f32 v32, v32, v96
    v_mul_f32 v33, v33, v97
    v_mul_f32 v34, v34, v98
    v_mul_f32 v35, v35, v99
    v_fma_f32 v220, v220, v200, v200
    s_waitcnt vmcnt(14)
    s_barrier
    s_add_u32 m0, s62, 131072
    s_nop 0
    buffer_load_dwordx4 v191, s[4:7], s94 offen lds
    v_fma_f32 v221, v221, v200, v200
    v_fma_f32 v222, v222, v200, v200
    v_fma_f32 v223, v223, v200, v200
    v_rcp_f32 v220, v220
    buffer_load_dwordx4 v191, s[4:7], s94 offen offset:1024 lds
    v_rcp_f32 v221, v221
    v_rcp_f32 v222, v222
    v_rcp_f32 v223, v223
    v_mul_f32 v32, v32, v220
    v_mul_f32 v33, v33, v221
    s_add_u32 m0, s61, 49152
    s_mul_i32 s59, s93, 112
    buffer_load_dwordx4 v236, s[16:19], s59 offen lds
    v_mul_f32 v34, v34, v222
    v_mul_f32 v35, v35, v223
    v_cvt_pk_bf16_f32 v224, v32, v33
    v_cvt_pk_bf16_f32 v225, v34, v35
    v_fmac_f32 v48, v192, v212
    buffer_load_dwordx4 v237, s[16:19], s59 offen offset:1024 lds
    v_fmac_f32 v49, v192, v213
    v_fmac_f32 v50, v192, v214
    v_fmac_f32 v51, v192, v215
    v_mul_f32 v220, v196, v48
    v_mul_f32 v221, v196, v49
    buffer_load_dwordx4 v242, s[4:7], s93 offen offset:2048 lds
    s_add_u32 s93, s93, 10240
    s_and_b32 s93, s93, 65535
    v_mul_f32 v222, v196, v50
    v_mul_f32 v223, v196, v51
    v_fmac_f32 v112, v192, v216
    v_fmac_f32 v113, v192, v217
    v_fmac_f32 v114, v192, v218
    s_barrier
    s_add_u32 m0, s62, 131072
    s_nop 0
    buffer_load_dwordx4 v191, s[4:7], s94 offen offset:2048 lds
    v_fmac_f32 v115, v192, v219
    v_exp_f32 v220, v220
    v_exp_f32 v221, v221
    v_exp_f32 v222, v222
    buffer_load_dwordx4 v191, s[4:7], s94 offen offset:3072 lds
    s_add_u32 s94, s94, 49152
    s_and_b32 s94, s94, 262143
    v_exp_f32 v223, v223
    v_mul_f32 v48, v48, v112
    v_mul_f32 v49, v49, v113
    v_mul_f32 v50, v50, v114
    s_add_u32 m0, s61, 65536
    s_mul_i32 s59, s93, 112
    buffer_load_dwordx4 v236, s[16:19], s59 offen lds
    v_mul_f32 v51, v51, v115
    v_fma_f32 v220, v220, v200, v200
    v_fma_f32 v221, v221, v200, v200
    v_fma_f32 v222, v222, v200, v200
    buffer_load_dwordx4 v237, s[16:19], s59 offen offset:1024 lds
    v_fma_f32 v223, v223, v200, v200
    v_rcp_f32 v220, v220
    v_rcp_f32 v221, v221
    v_rcp_f32 v222, v222
    buffer_load_dwordx4 v242, s[4:7], s93 offen offset:2048 lds
    s_add_u32 s93, s93, 2048
    s_and_b32 s93, s93, 65535
    v_rcp_f32 v223, v223
    v_mul_f32 v48, v48, v220
    v_mul_f32 v49, v49, v221
    v_mul_f32 v50, v50, v222
    s_waitcnt vmcnt(13)
    s_barrier
    s_cmp_lg_u32 s42, 0
    s_cbranch_scc1 wf_25
    s_lshr_b32 s55, s2, 5
    s_lshl_b32 s55, s55, 2
    s_add_u32 s55, s55, s0
    v_mov_b32 v252, 2048
    v_mov_b32 v253, 0x01010101
    s_mov_b64 exec, 1
    s_cmp_eq_u32 s45, 0
    s_cbranch_scc1 st_26
    buffer_store_dword v253, v252, s[4:7], s55 offen sc0 sc1
    s_branch st_27
st_26:
    buffer_store_dword v253, v252, s[4:7], s55 offen
st_27:
    s_mov_b64 exec, -1
wf_25:
    s_add_u32 m0, s62, 98304
    s_nop 0
    buffer_load_dwordx4 v191, s[4:7], s94 offen lds
    v_mul_f32 v51, v51, v223
    v_cvt_pk_bf16_f32 v226, v48, v49
    v_cvt_pk_bf16_f32 v227, v50, v51
    s_add_u32 s55, s89, 131072
    buffer_store_dwordx4 v[224:227], v254, s[4:7], s55 offen sc0 sc1
    buffer_load_dwordx4 v191, s[4:7], s94 offen offset:1024 lds
    v_fmac_f32 v36, v193, v204
    v_fmac_f32 v37, v193, v205
    v_fmac_f32 v38, v193, v206
    v_fmac_f32 v39, v193, v207
    s_add_u32 m0, s61, 81920
    s_mul_i32 s59, s93, 112
    buffer_load_dwordx4 v236, s[16:19], s59 offen lds
    v_mul_f32 v220, v197, v36
    v_mul_f32 v221, v197, v37
    v_mul_f32 v222, v197, v38
    v_mul_f32 v223, v197, v39
    buffer_load_dwordx4 v237, s[16:19], s59 offen offset:1024 lds
    v_fmac_f32 v100, v193, v208
    v_fmac_f32 v101, v193, v209
    v_fmac_f32 v102, v193, v210
    v_fmac_f32 v103, v193, v211
    buffer_load_dwordx4 v242, s[4:7], s93 offen offset:2048 lds
    s_add_u32 s93, s93, 6144
    s_and_b32 s93, s93, 65535
    v_exp_f32 v220, v220
    v_exp_f32 v221, v221
    v_exp_f32 v222, v222
    v_exp_f32 v223, v223
    v_mul_f32 v36, v36, v100
    s_barrier
    s_add_u32 m0, s62, 98304
    s_nop 0
    buffer_load_dwordx4 v191, s[4:7], s94 offen offset:2048 lds
    v_mul_f32 v37, v37, v101
    v_mul_f32 v38, v38, v102
    v_mul_f32 v39, v39, v103
    v_fma_f32 v220, v220, v201, v201
    buffer_load_dwordx4 v191, s[4:7], s94 offen offset:3072 lds
    s_add_u32 s94, s94, 32768
    s_and_b32 s94, s94, 262143
    v_fma_f32 v221, v221, v201, v201
    v_fma_f32 v222, v222, v201, v201
    v_fma_f32 v223, v223, v201, v201
    v_rcp_f32 v220, v220
    v_rcp_f32 v221, v221
    s_add_u32 m0, s61, 0
    s_mul_i32 s59, s93, 112
    buffer_load_dwordx4 v236, s[16:19], s59 offen lds
    v_rcp_f32 v222, v222
    v_rcp_f32 v223, v223
    v_mul_f32 v36, v36, v220
    v_mul_f32 v37, v37, v221
    v_mul_f32 v38, v38, v222
    buffer_load_dwordx4 v237, s[16:19], s59 offen offset:1024 lds
    v_mul_f32 v39, v39, v223
    v_cvt_pk_bf16_f32 v228, v36, v37
    v_cvt_pk_bf16_f32 v229, v38, v39
    v_fmac_f32 v52, v193, v212
    v_fmac_f32 v53, v193, v213
    buffer_load_dwordx4 v242, s[4:7], s93 offen offset:2048 lds
    s_add_u32 s93, s93, 2048
    s_and_b32 s93, s93, 65535
    v_fmac_f32 v54, v193, v214
    v_fmac_f32 v55, v193, v215
    v_mul_f32 v220, v197, v52
    v_mul_f32 v221, v197, v53
    v_mul_f32 v222, v197, v54
    s_waitcnt vmcnt(14)
    s_barrier
    s_add_u32 m0, s62, 114688
    s_nop 0
    buffer_load_dwordx4 v191, s[4:7], s94 offen lds
    v_mul_f32 v223, v197, v55
    v_fmac_f32 v116, v193, v216
    v_fmac_f32 v117, v193, v217
    v_fmac_f32 v118, v193, v218
    buffer_load_dwordx4 v191, s[4:7], s94 offen offset:1024 lds
    v_fmac_f32 v119, v193, v219
    v_exp_f32 v220, v220
    v_exp_f32 v221, v221
    v_exp_f32 v222, v222
    s_add_u32 m0, s61, 16384
    s_mul_i32 s59, s93, 112
    buffer_load_dwordx4 v236, s[16:19], s59 offen lds
    v_exp_f32 v223, v223
    v_mul_f32 v52, v52, v116
    v_mul_f32 v53, v53, v117
    v_mul_f32 v54, v54, v118
    buffer_load_dwordx4 v237, s[16:19], s59 offen offset:1024 lds
    v_mul_f32 v55, v55, v119
    v_fma_f32 v220, v220, v201, v201
    v_fma_f32 v221, v221, v201, v201
    v_fma_f32 v222, v222, v201, v201
    buffer_load_dwordx4 v242, s[4:7], s93 offen offset:2048 lds
    s_add_u32 s93, s93, 6144
    s_and_b32 s93, s93, 65535
    v_fma_f32 v223, v223, v201, v201
    v_rcp_f32 v220, v220
    v_rcp_f32 v221, v221
    v_rcp_f32 v222, v222
    s_barrier
    s_add_u32 m0, s62, 114688
    s_nop 0
    buffer_load_dwordx4 v191, s[4:7], s94 offen offset:2048 lds
    v_rcp_f32 v223, v223
    v_mul_f32 v52, v52, v220
    v_mul_f32 v53, v53, v221
    v_mul_f32 v54, v54, v222
    buffer_load_dwordx4 v191, s[4:7], s94 offen offset:3072 lds
    s_add_u32 s94, s94, 32768
    s_and_b32 s94, s94, 262143
    v_mul_f32 v55, v55, v223
    v_cvt_pk_bf16_f32 v230, v52, v53
    v_cvt_pk_bf16_f32 v231, v54, v55
    s_add_u32 s55, s89, 133120
    buffer_store_dwordx4 v[228:231], v254, s[4:7], s55 offen sc0 sc1
    s_add_u32 m0, s61, 32768
    s_mul_i32 s59, s93, 112
    buffer_load_dwordx4 v236, s[16:19], s59 offen lds
    v_fmac_f32 v40, v194, v204
    v_fmac_f32 v41, v194, v205
    v_fmac_f32 v42, v194, v206
    v_fmac_f32 v43, v194, v207
    v_mul_f32 v220, v198, v40
    buffer_load_dwordx4 v237, s[16:19], s59 offen offset:1024 lds
    v_mul_f32 v221, v198, v41
    v_mul_f32 v222, v198, v42
    v_mul_f32 v223, v198, v43
    v_fmac_f32 v104, v194, v208
    buffer_load_dwordx4 v242, s[4:7], s93 offen offset:2048 lds
    s_add_u32 s93, s93, 2048
    s_and_b32 s93, s93, 65535
    v_fmac_f32 v105, v194, v209
    v_fmac_f32 v106, v194, v210
    v_fmac_f32 v107, v194, v211
    v_exp_f32 v220, v220
    v_exp_f32 v221, v221
    s_waitcnt vmcnt(14)
    s_barrier
    s_add_u32 m0, s62, 131072
    s_nop 0
    buffer_load_dwordx4 v191, s[4:7], s94 offen lds
    v_exp_f32 v222, v222
    v_exp_f32 v223, v223
    v_mul_f32 v40, v40, v104
    v_mul_f32 v41, v41, v105
    buffer_load_dwordx4 v191, s[4:7], s94 offen offset:1024 lds
    v_mul_f32 v42, v42, v106
    v_mul_f32 v43, v43, v107
    v_fma_f32 v220, v220, v202, v202
    v_fma_f32 v221, v221, v202, v202
    s_add_u32 m0, s61, 49152
    s_mul_i32 s59, s93, 112
    buffer_load_dwordx4 v236, s[16:19], s59 offen lds
    v_fma_f32 v222, v222, v202, v202
    v_fma_f32 v223, v223, v202, v202
    v_rcp_f32 v220, v220
    v_rcp_f32 v221, v221
    v_rcp_f32 v222, v222
    buffer_load_dwordx4 v237, s[16:19], s59 offen offset:1024 lds
    v_rcp_f32 v223, v223
    v_mul_f32 v40, v40, v220
    v_mul_f32 v41, v41, v221
    v_mul_f32 v42, v42, v222
    buffer_load_dwordx4 v242, s[4:7], s93 offen offset:2048 lds
    s_add_u32 s93, s93, 6144
    s_and_b32 s93, s93, 65535
    v_mul_f32 v43, v43, v223
    v_cvt_pk_bf16_f32 v224, v40, v41
    v_cvt_pk_bf16_f32 v225, v42, v43
    v_fmac_f32 v56, v194, v212
    v_fmac_f32 v57, v194, v213
    s_barrier
    s_add_u32 m0, s62, 131072
    s_nop 0
    buffer_load_dwordx4 v191, s[4:7], s94 offen offset:2048 lds
    v_fmac_f32 v58, v194, v214
    v_fmac_f32 v59, v194, v215
    v_mul_f32 v220, v198, v56
    v_mul_f32 v221, v198, v57
    buffer_load_dwordx4 v191, s[4:7], s94 offen offset:3072 lds
    s_add_u32 s94, s94, 32768
    s_and_b32 s94, s94, 262143
    v_mul_f32 v222, v198, v58
    v_mul_f32 v223, v198, v59
    v_fmac_f32 v120, v194, v216
    v_fmac_f32 v121, v194, v217
    v_fmac_f32 v122, v194, v218
    s_add_u32 m0, s61, 65536
    s_mul_i32 s59, s93, 112
    buffer_load_dwordx4 v236, s[16:19], s59 offen lds
    v_fmac_f32 v123, v194, v219
    v_exp_f32 v220, v220
    v_exp_f32 v221, v221
    v_exp_f32 v222, v222
    buffer_load_dwordx4 v237, s[16:19], s59 offen offset:1024 lds
    v_exp_f32 v223, v223
    v_mul_f32 v56, v56, v120
    v_mul_f32 v57, v57, v121
    v_mul_f32 v58, v58, v122
    v_mul_f32 v59, v59, v123
    buffer_load_dwordx4 v242, s[4:7], s93 offen offset:2048 lds
    s_add_u32 s93, s93, 2048
    s_and_b32 s93, s93, 65535
    v_fma_f32 v220, v220, v202, v202
    v_fma_f32 v221, v221, v202, v202
    v_fma_f32 v222, v222, v202, v202
    v_fma_f32 v223, v223, v202, v202
    v_rcp_f32 v220, v220
    s_waitcnt vmcnt(14)
    s_barrier
    s_add_u32 m0, s62, 98304
    s_nop 0
    buffer_load_dwordx4 v191, s[4:7], s94 offen lds
    v_rcp_f32 v221, v221
    v_rcp_f32 v222, v222
    v_rcp_f32 v223, v223
    v_mul_f32 v56, v56, v220
    buffer_load_dwordx4 v191, s[4:7], s94 offen offset:1024 lds
    v_mul_f32 v57, v57, v221
    v_mul_f32 v58, v58, v222
    v_mul_f32 v59, v59, v223
    v_cvt_pk_bf16_f32 v226, v56, v57
    s_add_u32 m0, s61, 81920
    s_mul_i32 s59, s93, 112
    buffer_load_dwordx4 v236, s[16:19], s59 offen lds
    v_cvt_pk_bf16_f32 v227, v58, v59
    s_add_u32 s55, s89, 135168
    buffer_store_dwordx4 v[224:227], v254, s[4:7], s55 offen sc0 sc1
    v_fmac_f32 v44, v195, v204
    v_fmac_f32 v45, v195, v205
    v_fmac_f32 v46, v195, v206
    buffer_load_dwordx4 v237, s[16:19], s59 offen offset:1024 lds
    v_fmac_f32 v47, v195, v207
    v_mul_f32 v220, v199, v44
    v_mul_f32 v221, v199, v45
    v_mul_f32 v222, v199, v46
    buffer_load_dwordx4 v242, s[4:7], s93 offen offset:2048 lds
    s_add_u32 s93, s93, 6144
    s_and_b32 s93, s93, 65535
    v_mul_f32 v223, v199, v47
    v_fmac_f32 v108, v195, v208
    v_fmac_f32 v109, v195, v209
    v_fmac_f32 v110, v195, v210
    v_fmac_f32 v111, v195, v211
    s_barrier
    s_add_u32 m0, s62, 98304
    s_nop 0
    buffer_load_dwordx4 v191, s[4:7], s94 offen offset:2048 lds
    v_exp_f32 v220, v220
    v_exp_f32 v221, v221
    v_exp_f32 v222, v222
    v_exp_f32 v223, v223
    buffer_load_dwordx4 v191, s[4:7], s94 offen offset:3072 lds
    s_add_u32 s94, s94, 32768
    s_and_b32 s94, s94, 262143
    v_mul_f32 v44, v44, v108
    v_mul_f32 v45, v45, v109
    v_mul_f32 v46, v46, v110
    v_mul_f32 v47, v47, v111
    s_add_u32 m0, s61, 0
    s_mul_i32 s59, s93, 112
    buffer_load_dwordx4 v236, s[16:19], s59 offen lds
    v_fma_f32 v220, v220, v203, v203
    v_fma_f32 v221, v221, v203, v203
    v_fma_f32 v222, v222, v203, v203
    v_fma_f32 v223, v223, v203, v203
    buffer_load_dwordx4 v237, s[16:19], s59 offen offset:1024 lds
    v_rcp_f32 v220, v220
    v_rcp_f32 v221, v221
    v_rcp_f32 v222, v222
    v_rcp_f32 v223, v223
    buffer_load_dwordx4 v242, s[4:7], s93 offen offset:2048 lds
    s_add_u32 s93, s93, 2048
    s_and_b32 s93, s93, 65535
    v_mul_f32 v44, v44, v220
    v_mul_f32 v45, v45, v221
    v_mul_f32 v46, v46, v222
    v_mul_f32 v47, v47, v223
    s_waitcnt vmcnt(14)
    s_barrier
    v_lshrrev_b32 v252, 2, v254
    v_min_u32 v252, 28, v252
    s_add_u32 s55, s0, 2048
    buffer_load_dword v232, v252, s[4:7], s55 offen sc0 sc1
    s_add_u32 m0, s62, 114688
    s_nop 0
    buffer_load_dwordx4 v191, s[4:7], s94 offen lds
    v_cvt_pk_bf16_f32 v228, v44, v45
    v_cvt_pk_bf16_f32 v229, v46, v47
    v_fmac_f32 v60, v195, v212
    v_fmac_f32 v61, v195, v213
    buffer_load_dwordx4 v191, s[4:7], s94 offen offset:1024 lds
    v_fmac_f32 v62, v195, v214
    v_fmac_f32 v63, v195, v215
    v_mul_f32 v220, v199, v60
    v_mul_f32 v221, v199, v61
    v_mul_f32 v222, v199, v62
    s_add_u32 m0, s61, 16384
    s_mul_i32 s59, s93, 112
    buffer_load_dwordx4 v236, s[16:19], s59 offen lds
    v_mul_f32 v223, v199, v63
    v_fmac_f32 v124, v195, v216
    v_fmac_f32 v125, v195, v217
    v_fmac_f32 v126, v195, v218
    v_fmac_f32 v127, v195, v219
    buffer_load_dwordx4 v237, s[16:19], s59 offen offset:1024 lds
    v_exp_f32 v220, v220
    v_exp_f32 v221, v221
    v_exp_f32 v222, v222
    v_exp_f32 v223, v223
    v_mul_f32 v60, v60, v124
    buffer_load_dwordx4 v242, s[4:7], s93 offen offset:2048 lds
    v_mul_f32 v61, v61, v125
    v_mul_f32 v62, v62, v126
    v_mul_f32 v63, v63, v127
    v_fma_f32 v220, v220, v203, v203
    v_fma_f32 v221, v221, v203, v203
    s_barrier
    s_add_u32 m0, s62, 114688
    s_nop 0
    buffer_load_dwordx4 v191, s[4:7], s94 offen offset:2048 lds
    v_fma_f32 v222, v222, v203, v203
    v_fma_f32 v223, v223, v203, v203
    buffer_load_dwordx4 v191, s[4:7], s94 offen offset:3072 lds
    v_rcp_f32 v220, v220
    v_rcp_f32 v221, v221
    s_add_u32 m0, s62, 32768
    s_add_u32 s59, s68, 0
    buffer_load_dwordx4 v238, s[20:23], s59 offen lds
    v_rcp_f32 v222, v222
    v_rcp_f32 v223, v223
    buffer_load_dwordx4 v239, s[20:23], s59 offen offset:1024 lds
    v_mul_f32 v60, v60, v220
    v_mul_f32 v61, v61, v221
    buffer_load_dwordx4 v240, s[20:23], s59 offen offset:2048 lds
    v_mul_f32 v62, v62, v222
    v_mul_f32 v63, v63, v223
    buffer_load_dwordx4 v241, s[20:23], s59 offen offset:3072 lds
    v_cvt_pk_bf16_f32 v230, v60, v61
    v_cvt_pk_bf16_f32 v231, v62, v63
    s_add_u32 s55, s89, 137216
    buffer_store_dwordx4 v[228:231], v254, s[4:7], s55 offen sc0 sc1
    s_waitcnt vmcnt(16)
    s_barrier
    s_waitcnt vmcnt(12)
    v_cmp_ne_u32 vcc, 0x01010101, v232
    s_cbranch_vccz ap_28
    v_lshrrev_b32 v252, 2, v254
    v_min_u32 v252, 28, v252
    s_add_u32 s55, s0, 2048
    s_mov_b32 s56, 262144
poll_29:
    buffer_load_dword v253, v252, s[4:7], s55 offen sc0 sc1
    s_waitcnt vmcnt(0)
    v_cmp_ne_u32 vcc, 0x01010101, v253
    s_cbranch_vccz pd_30
    s_sleep 1
    s_sub_u32 s56, s56, 1
    s_cmp_lg_u32 s56, 0
    s_cbranch_scc1 poll_29
pd_30:
ap_28:
    s_add_u32 s88, s95, s62
    v_add_u32 v191, s88, v254
    s_add_u32 m0, s62, 131072
    s_mov_b32 s92, 0
    buffer_load_dwordx4 v191, s[4:7], s92 offen lds
    buffer_load_dwordx4 v191, s[4:7], s92 offen offset:1024 lds
    s_add_u32 m0, s62, 49152
    s_add_u32 s59, s68, 655360
    buffer_load_dwordx4 v238, s[20:23], s59 offen lds
    buffer_load_dwordx4 v239, s[20:23], s59 offen offset:1024 lds
    buffer_load_dwordx4 v240, s[20:23], s59 offen offset:2048 lds
    buffer_load_dwordx4 v241, s[20:23], s59 offen offset:3072 lds
    s_barrier
    s_add_u32 m0, s62, 131072
    s_mov_b32 s92, 0
    buffer_load_dwordx4 v191, s[4:7], s92 offen offset:2048 lds
    buffer_load_dwordx4 v191, s[4:7], s92 offen offset:3072 lds
    s_add_u32 m0, s62, 65536
    s_add_u32 s59, s68, 917504
    buffer_load_dwordx4 v238, s[20:23], s59 offen lds
    buffer_load_dwordx4 v239, s[20:23], s59 offen offset:1024 lds
    buffer_load_dwordx4 v240, s[20:23], s59 offen offset:2048 lds
    buffer_load_dwordx4 v241, s[20:23], s59 offen offset:3072 lds
    s_waitcnt vmcnt(17)
    s_barrier
    s_add_u32 m0, s62, 98304
    s_mov_b32 s92, 16384
    buffer_load_dwordx4 v191, s[4:7], s92 offen lds
    buffer_load_dwordx4 v191, s[4:7], s92 offen offset:1024 lds
    s_add_u32 m0, s62, 81920
    s_add_u32 s59, s68, 1572864
    buffer_load_dwordx4 v238, s[20:23], s59 offen lds
    buffer_load_dwordx4 v239, s[20:23], s59 offen offset:1024 lds
    buffer_load_dwordx4 v240, s[20:23], s59 offen offset:2048 lds
    buffer_load_dwordx4 v241, s[20:23], s59 offen offset:3072 lds
    s_waitcnt vmcnt(18)
    s_barrier
    s_cmp_lg_u32 s42, 1
    s_cbranch_scc1 wf_31
    s_lshr_b32 s55, s2, 5
    s_lshl_b32 s55, s55, 2
    s_add_u32 s55, s55, s0
    v_mov_b32 v252, 2080
    v_mov_b32 v253, 0x01010101
    s_mov_b64 exec, 1
    s_cmp_eq_u32 s45, 0
    s_cbranch_scc1 st_32
    buffer_store_dword v253, v252, s[4:7], s55 offen sc0 sc1
    s_branch st_33
st_32:
    buffer_store_dword v253, v252, s[4:7], s55 offen
st_33:
    s_mov_b64 exec, -1
wf_31:
    s_add_u32 m0, s62, 98304
    s_mov_b32 s92, 16384
    buffer_load_dwordx4 v191, s[4:7], s92 offen offset:2048 lds
    buffer_load_dwordx4 v191, s[4:7], s92 offen offset:3072 lds
    s_add_u32 m0, s62, 0
    s_add_u32 s59, s68, 1835008
    buffer_load_dwordx4 v238, s[20:23], s59 offen lds
    buffer_load_dwordx4 v239, s[20:23], s59 offen offset:1024 lds
    buffer_load_dwordx4 v240, s[20:23], s59 offen offset:2048 lds
    buffer_load_dwordx4 v241, s[20:23], s59 offen offset:3072 lds
    s_waitcnt vmcnt(16)
    s_barrier
    s_add_u32 m0, s62, 114688
    s_mov_b32 s92, 32768
    buffer_load_dwordx4 v191, s[4:7], s92 offen lds
    buffer_load_dwordx4 v191, s[4:7], s92 offen offset:1024 lds
    buffer_load_dwordx4 v191, s[4:7], s92 offen offset:2048 lds
    buffer_load_dwordx4 v191, s[4:7], s92 offen offset:3072 lds
    s_add_u32 m0, s62, 16384
    s_add_u32 s59, s68, 2490368
    buffer_load_dwordx4 v238, s[20:23], s59 offen lds
    buffer_load_dwordx4 v239, s[20:23], s59 offen offset:1024 lds
    buffer_load_dwordx4 v240, s[20:23], s59 offen offset:2048 lds
    buffer_load_dwordx4 v241, s[20:23], s59 offen offset:3072 lds
    s_setprio 0
    ds_read_b64_tr_b16 v[32:33], v244 offset:32768
    ds_read_b64_tr_b16 v[34:35], v244 offset:36864
    ds_read_b128 v[0:3], v243 offset:32768
    ds_read_b128 v[4:7], v243 offset:34816
    ds_read_b128 v[8:11], v243 offset:36864
    ds_read_b128 v[12:15], v243 offset:38912
    ds_read_b64_tr_b16 v[36:37], v245 offset:32768
    ds_read_b64_tr_b16 v[38:39], v245 offset:36864
    ds_read_b64_tr_b16 v[40:41], v246 offset:32768
    ds_read_b64_tr_b16 v[42:43], v246 offset:36864
    ds_read_b64_tr_b16 v[44:45], v247 offset:32768
    ds_read_b64_tr_b16 v[46:47], v247 offset:36864
    s_lshl_b32 s55, s51, 14
    s_add_u32 s55, s55, s62
    s_add_u32 s55, s55, s47
    s_add_u32 s88, s55, 1310720
    s_xor_b32 s89, s88, 16384
    s_add_u32 s59, s1, s49
    s_add_u32 s60, s59, 4096
    s_mov_b32 s58, 4
    s_waitcnt lgkmcnt(0)
    .p2align 3
    v_mfma_f32_16x16x32_bf16 v[128:131], v[32:35], v[0:3], 0
    ds_read_b64_tr_b16 v[48:49], v244 offset:40960
    v_mfma_f32_16x16x32_bf16 v[132:135], v[32:35], v[4:7], 0
    ds_read_b64_tr_b16 v[50:51], v244 offset:45056
    v_mfma_f32_16x16x32_bf16 v[136:139], v[32:35], v[8:11], 0
    ds_read_b128 v[16:19], v243 offset:33792
    v_mfma_f32_16x16x32_bf16 v[140:143], v[32:35], v[12:15], 0
    ds_read_b128 v[20:23], v243 offset:35840
    v_mfma_f32_16x16x32_bf16 v[144:147], v[36:39], v[0:3], 0
    ds_read_b128 v[24:27], v243 offset:37888
    v_mfma_f32_16x16x32_bf16 v[148:151], v[36:39], v[4:7], 0
    ds_read_b128 v[28:31], v243 offset:39936
    v_mfma_f32_16x16x32_bf16 v[152:155], v[36:39], v[8:11], 0
    ds_read_b64_tr_b16 v[52:53], v245 offset:40960
    v_mfma_f32_16x16x32_bf16 v[156:159], v[36:39], v[12:15], 0
    ds_read_b64_tr_b16 v[54:55], v245 offset:45056
    v_mfma_f32_16x16x32_bf16 v[160:163], v[40:43], v[0:3], 0
    ds_read_b64_tr_b16 v[56:57], v246 offset:40960
    v_mfma_f32_16x16x32_bf16 v[164:167], v[40:43], v[4:7], 0
    ds_read_b64_tr_b16 v[58:59], v246 offset:45056
    v_mfma_f32_16x16x32_bf16 v[168:171], v[40:43], v[8:11], 0
    ds_read_b64_tr_b16 v[60:61], v247 offset:40960
    v_mfma_f32_16x16x32_bf16 v[172:175], v[40:43], v[12:15], 0
    ds_read_b64_tr_b16 v[62:63], v247 offset:45056
    v_mfma_f32_16x16x32_bf16 v[176:179], v[44:47], v[0:3], 0
    v_mfma_f32_16x16x32_bf16 v[180:183], v[44:47], v[4:7], 0
    v_mfma_f32_16x16x32_bf16 v[184:187], v[44:47], v[8:11], 0
    v_mfma_f32_16x16x32_bf16 v[188:191], v[44:47], v[12:15], 0
    s_waitcnt vmcnt(12) lgkmcnt(0)
    s_barrier
    .p2align 3
    v_mfma_f32_16x16x32_bf16 v[128:131], v[48:51], v[16:19], v[128:131]
    ds_read_b64_tr_b16 v[32:33], v248 offset:0
    v_mfma_f32_16x16x32_bf16 v[132:135], v[48:51], v[20:23], v[132:135]
    ds_read_b64_tr_b16 v[34:35], v248 offset:4096
    v_mfma_f32_16x16x32_bf16 v[136:139], v[48:51], v[24:27], v[136:139]
    ds_read_b128 v[0:3], v243 offset:0
    v_mfma_f32_16x16x32_bf16 v[140:143], v[48:51], v[28:31], v[140:143]
    ds_read_b128 v[4:7], v243 offset:2048
    v_mfma_f32_16x16x32_bf16 v[144:147], v[52:55], v[16:19], v[144:147]
    ds_read_b128 v[8:11], v243 offset:4096
    v_mfma_f32_16x16x32_bf16 v[148:151], v[52:55], v[20:23], v[148:151]
    ds_read_b128 v[12:15], v243 offset:6144
    v_mfma_f32_16x16x32_bf16 v[152:155], v[52:55], v[24:27], v[152:155]
    ds_read_b64_tr_b16 v[36:37], v249 offset:0
    v_mfma_f32_16x16x32_bf16 v[156:159], v[52:55], v[28:31], v[156:159]
    ds_read_b64_tr_b16 v[38:39], v249 offset:4096
    v_mfma_f32_16x16x32_bf16 v[160:163], v[56:59], v[16:19], v[160:163]
    ds_read_b64_tr_b16 v[40:41], v250 offset:0
    v_mfma_f32_16x16x32_bf16 v[164:167], v[56:59], v[20:23], v[164:167]
    ds_read_b64_tr_b16 v[42:43], v250 offset:4096
    v_mfma_f32_16x16x32_bf16 v[168:171], v[56:59], v[24:27], v[168:171]
    ds_read_b64_tr_b16 v[44:45], v251 offset:0
    v_mfma_f32_16x16x32_bf16 v[172:175], v[56:59], v[28:31], v[172:175]
    ds_read_b64_tr_b16 v[46:47], v251 offset:4096
    v_mfma_f32_16x16x32_bf16 v[176:179], v[60:63], v[16:19], v[176:179]
    v_mfma_f32_16x16x32_bf16 v[180:183], v[60:63], v[20:23], v[180:183]
    v_mfma_f32_16x16x32_bf16 v[184:187], v[60:63], v[24:27], v[184:187]
    v_mfma_f32_16x16x32_bf16 v[188:191], v[60:63], v[28:31], v[188:191]
    .p2align 3
loop_34:
    s_waitcnt lgkmcnt(0)
    .p2align 3
    v_mfma_f32_16x16x32_bf16 v[128:131], v[32:35], v[0:3], v[128:131]
    ds_read_b64_tr_b16 v[48:49], v248 offset:8192
    v_mfma_f32_16x16x32_bf16 v[132:135], v[32:35], v[4:7], v[132:135]
    ds_read_b64_tr_b16 v[50:51], v248 offset:12288
    v_mfma_f32_16x16x32_bf16 v[136:139], v[32:35], v[8:11], v[136:139]
    ds_read_b128 v[16:19], v243 offset:1024
    v_mfma_f32_16x16x32_bf16 v[140:143], v[32:35], v[12:15], v[140:143]
    ds_read_b128 v[20:23], v243 offset:3072
    v_mfma_f32_16x16x32_bf16 v[144:147], v[36:39], v[0:3], v[144:147]
    ds_read_b128 v[24:27], v243 offset:5120
    v_mfma_f32_16x16x32_bf16 v[148:151], v[36:39], v[4:7], v[148:151]
    ds_read_b128 v[28:31], v243 offset:7168
    v_mfma_f32_16x16x32_bf16 v[152:155], v[36:39], v[8:11], v[152:155]
    ds_read_b64_tr_b16 v[52:53], v249 offset:8192
    v_mfma_f32_16x16x32_bf16 v[156:159], v[36:39], v[12:15], v[156:159]
    ds_read_b64_tr_b16 v[54:55], v249 offset:12288
    v_mfma_f32_16x16x32_bf16 v[160:163], v[40:43], v[0:3], v[160:163]
    ds_read_b64_tr_b16 v[56:57], v250 offset:8192
    v_mfma_f32_16x16x32_bf16 v[164:167], v[40:43], v[4:7], v[164:167]
    ds_read_b64_tr_b16 v[58:59], v250 offset:12288
    v_mfma_f32_16x16x32_bf16 v[168:171], v[40:43], v[8:11], v[168:171]
    ds_read_b64_tr_b16 v[60:61], v251 offset:8192
    v_mfma_f32_16x16x32_bf16 v[172:175], v[40:43], v[12:15], v[172:175]
    ds_read_b64_tr_b16 v[62:63], v251 offset:12288
    v_mfma_f32_16x16x32_bf16 v[176:179], v[44:47], v[0:3], v[176:179]
    v_mfma_f32_16x16x32_bf16 v[180:183], v[44:47], v[4:7], v[180:183]
    v_mfma_f32_16x16x32_bf16 v[184:187], v[44:47], v[8:11], v[184:187]
    v_mfma_f32_16x16x32_bf16 v[188:191], v[44:47], v[12:15], v[188:191]
    s_waitcnt vmcnt(4) lgkmcnt(0)
    s_barrier
    .p2align 3
    v_mfma_f32_16x16x32_bf16 v[128:131], v[48:51], v[16:19], v[128:131]
    ds_read_b64_tr_b16 v[32:33], v248 offset:16384
    v_mfma_f32_16x16x32_bf16 v[132:135], v[48:51], v[20:23], v[132:135]
    ds_read_b64_tr_b16 v[34:35], v248 offset:20480
    v_mfma_f32_16x16x32_bf16 v[136:139], v[48:51], v[24:27], v[136:139]
    ds_read_b128 v[0:3], v243 offset:16384
    v_mfma_f32_16x16x32_bf16 v[140:143], v[48:51], v[28:31], v[140:143]
    ds_read_b128 v[4:7], v243 offset:18432
    v_mfma_f32_16x16x32_bf16 v[144:147], v[52:55], v[16:19], v[144:147]
    ds_read_b128 v[8:11], v243 offset:20480
    v_mfma_f32_16x16x32_bf16 v[148:151], v[52:55], v[20:23], v[148:151]
    ds_read_b128 v[12:15], v243 offset:22528
    v_mfma_f32_16x16x32_bf16 v[152:155], v[52:55], v[24:27], v[152:155]
    ds_read_b64_tr_b16 v[36:37], v249 offset:16384
    v_mfma_f32_16x16x32_bf16 v[156:159], v[52:55], v[28:31], v[156:159]
    ds_read_b64_tr_b16 v[38:39], v249 offset:20480
    v_mfma_f32_16x16x32_bf16 v[160:163], v[56:59], v[16:19], v[160:163]
    ds_read_b64_tr_b16 v[40:41], v250 offset:16384
    v_mfma_f32_16x16x32_bf16 v[164:167], v[56:59], v[20:23], v[164:167]
    ds_read_b64_tr_b16 v[42:43], v250 offset:20480
    v_mfma_f32_16x16x32_bf16 v[168:171], v[56:59], v[24:27], v[168:171]
    ds_read_b64_tr_b16 v[44:45], v251 offset:16384
    v_mfma_f32_16x16x32_bf16 v[172:175], v[56:59], v[28:31], v[172:175]
    ds_read_b64_tr_b16 v[46:47], v251 offset:20480
    v_mfma_f32_16x16x32_bf16 v[176:179], v[60:63], v[16:19], v[176:179]
    v_mfma_f32_16x16x32_bf16 v[180:183], v[60:63], v[20:23], v[180:183]
    v_mfma_f32_16x16x32_bf16 v[184:187], v[60:63], v[24:27], v[184:187]
    v_mfma_f32_16x16x32_bf16 v[188:191], v[60:63], v[28:31], v[188:191]
    s_waitcnt lgkmcnt(0)
    .p2align 3
    v_mfma_f32_16x16x32_bf16 v[128:131], v[32:35], v[0:3], v[128:131]
    ds_read_b64_tr_b16 v[48:49], v248 offset:24576
    v_mfma_f32_16x16x32_bf16 v[132:135], v[32:35], v[4:7], v[132:135]
    ds_read_b64_tr_b16 v[50:51], v248 offset:28672
    v_mfma_f32_16x16x32_bf16 v[136:139], v[32:35], v[8:11], v[136:139]
    ds_read_b128 v[16:19], v243 offset:17408
    v_mfma_f32_16x16x32_bf16 v[140:143], v[32:35], v[12:15], v[140:143]
    ds_read_b128 v[20:23], v243 offset:19456
    v_mfma_f32_16x16x32_bf16 v[144:147], v[36:39], v[0:3], v[144:147]
    ds_read_b128 v[24:27], v243 offset:21504
    v_mfma_f32_16x16x32_bf16 v[148:151], v[36:39], v[4:7], v[148:151]
    ds_read_b128 v[28:31], v243 offset:23552
    v_mfma_f32_16x16x32_bf16 v[152:155], v[36:39], v[8:11], v[152:155]
    ds_read_b64_tr_b16 v[52:53], v249 offset:24576
    v_mfma_f32_16x16x32_bf16 v[156:159], v[36:39], v[12:15], v[156:159]
    ds_read_b64_tr_b16 v[54:55], v249 offset:28672
    v_mfma_f32_16x16x32_bf16 v[160:163], v[40:43], v[0:3], v[160:163]
    ds_read_b64_tr_b16 v[56:57], v250 offset:24576
    v_mfma_f32_16x16x32_bf16 v[164:167], v[40:43], v[4:7], v[164:167]
    ds_read_b64_tr_b16 v[58:59], v250 offset:28672
    v_mfma_f32_16x16x32_bf16 v[168:171], v[40:43], v[8:11], v[168:171]
    ds_read_b64_tr_b16 v[60:61], v251 offset:24576
    v_mfma_f32_16x16x32_bf16 v[172:175], v[40:43], v[12:15], v[172:175]
    ds_read_b64_tr_b16 v[62:63], v251 offset:28672
    v_mfma_f32_16x16x32_bf16 v[176:179], v[44:47], v[0:3], v[176:179]
    v_mfma_f32_16x16x32_bf16 v[180:183], v[44:47], v[4:7], v[180:183]
    v_mfma_f32_16x16x32_bf16 v[184:187], v[44:47], v[8:11], v[184:187]
    v_mfma_f32_16x16x32_bf16 v[188:191], v[44:47], v[12:15], v[188:191]
    s_waitcnt lgkmcnt(0)
    s_barrier
    .p2align 3
    v_mfma_f32_16x16x32_bf16 v[128:131], v[48:51], v[16:19], v[128:131]
    ds_read_b64_tr_b16 v[32:33], v248 offset:32768
    v_mfma_f32_16x16x32_bf16 v[132:135], v[48:51], v[20:23], v[132:135]
    ds_read_b64_tr_b16 v[34:35], v248 offset:36864
    v_mfma_f32_16x16x32_bf16 v[136:139], v[48:51], v[24:27], v[136:139]
    ds_read_b128 v[0:3], v243 offset:32768
    v_mfma_f32_16x16x32_bf16 v[140:143], v[48:51], v[28:31], v[140:143]
    ds_read_b128 v[4:7], v243 offset:34816
    v_mfma_f32_16x16x32_bf16 v[144:147], v[52:55], v[16:19], v[144:147]
    ds_read_b128 v[8:11], v243 offset:36864
    v_mfma_f32_16x16x32_bf16 v[148:151], v[52:55], v[20:23], v[148:151]
    ds_read_b128 v[12:15], v243 offset:38912
    v_mfma_f32_16x16x32_bf16 v[152:155], v[52:55], v[24:27], v[152:155]
    ds_read_b64_tr_b16 v[36:37], v249 offset:32768
    v_mfma_f32_16x16x32_bf16 v[156:159], v[52:55], v[28:31], v[156:159]
    ds_read_b64_tr_b16 v[38:39], v249 offset:36864
    v_mfma_f32_16x16x32_bf16 v[160:163], v[56:59], v[16:19], v[160:163]
    ds_read_b64_tr_b16 v[40:41], v250 offset:32768
    v_mfma_f32_16x16x32_bf16 v[164:167], v[56:59], v[20:23], v[164:167]
    ds_read_b64_tr_b16 v[42:43], v250 offset:36864
    v_mfma_f32_16x16x32_bf16 v[168:171], v[56:59], v[24:27], v[168:171]
    ds_read_b64_tr_b16 v[44:45], v251 offset:32768
    v_mfma_f32_16x16x32_bf16 v[172:175], v[56:59], v[28:31], v[172:175]
    ds_read_b64_tr_b16 v[46:47], v251 offset:36864
    v_mfma_f32_16x16x32_bf16 v[176:179], v[60:63], v[16:19], v[176:179]
    v_mfma_f32_16x16x32_bf16 v[180:183], v[60:63], v[20:23], v[180:183]
    v_mfma_f32_16x16x32_bf16 v[184:187], v[60:63], v[24:27], v[184:187]
    v_mfma_f32_16x16x32_bf16 v[188:191], v[60:63], v[28:31], v[188:191]
    s_waitcnt lgkmcnt(0)
    .p2align 3
    v_mfma_f32_16x16x32_bf16 v[128:131], v[32:35], v[0:3], v[128:131]
    ds_read_b64_tr_b16 v[48:49], v248 offset:40960
    v_mfma_f32_16x16x32_bf16 v[132:135], v[32:35], v[4:7], v[132:135]
    ds_read_b64_tr_b16 v[50:51], v248 offset:45056
    v_mfma_f32_16x16x32_bf16 v[136:139], v[32:35], v[8:11], v[136:139]
    ds_read_b128 v[16:19], v243 offset:33792
    v_mfma_f32_16x16x32_bf16 v[140:143], v[32:35], v[12:15], v[140:143]
    ds_read_b128 v[20:23], v243 offset:35840
    v_mfma_f32_16x16x32_bf16 v[144:147], v[36:39], v[0:3], v[144:147]
    ds_read_b128 v[24:27], v243 offset:37888
    v_mfma_f32_16x16x32_bf16 v[148:151], v[36:39], v[4:7], v[148:151]
    ds_read_b128 v[28:31], v243 offset:39936
    v_mfma_f32_16x16x32_bf16 v[152:155], v[36:39], v[8:11], v[152:155]
    ds_read_b64_tr_b16 v[52:53], v249 offset:40960
    v_mfma_f32_16x16x32_bf16 v[156:159], v[36:39], v[12:15], v[156:159]
    ds_read_b64_tr_b16 v[54:55], v249 offset:45056
    v_mfma_f32_16x16x32_bf16 v[160:163], v[40:43], v[0:3], v[160:163]
    ds_read_b64_tr_b16 v[56:57], v250 offset:40960
    v_mfma_f32_16x16x32_bf16 v[164:167], v[40:43], v[4:7], v[164:167]
    ds_read_b64_tr_b16 v[58:59], v250 offset:45056
    v_mfma_f32_16x16x32_bf16 v[168:171], v[40:43], v[8:11], v[168:171]
    ds_read_b64_tr_b16 v[60:61], v251 offset:40960
    v_mfma_f32_16x16x32_bf16 v[172:175], v[40:43], v[12:15], v[172:175]
    ds_read_b64_tr_b16 v[62:63], v251 offset:45056
    v_mfma_f32_16x16x32_bf16 v[176:179], v[44:47], v[0:3], v[176:179]
    v_mfma_f32_16x16x32_bf16 v[180:183], v[44:47], v[4:7], v[180:183]
    v_mfma_f32_16x16x32_bf16 v[184:187], v[44:47], v[8:11], v[184:187]
    v_mfma_f32_16x16x32_bf16 v[188:191], v[44:47], v[12:15], v[188:191]
    s_waitcnt lgkmcnt(0)
    s_barrier
    .p2align 3
    v_mfma_f32_16x16x32_bf16 v[128:131], v[48:51], v[16:19], v[128:131]
    ds_read_b64_tr_b16 v[32:33], v244 offset:0
    v_mfma_f32_16x16x32_bf16 v[132:135], v[48:51], v[20:23], v[132:135]
    ds_read_b64_tr_b16 v[34:35], v244 offset:4096
    v_mfma_f32_16x16x32_bf16 v[136:139], v[48:51], v[24:27], v[136:139]
    ds_read_b128 v[0:3], v243 offset:0
    v_mfma_f32_16x16x32_bf16 v[140:143], v[48:51], v[28:31], v[140:143]
    ds_read_b128 v[4:7], v243 offset:2048
    v_mfma_f32_16x16x32_bf16 v[144:147], v[52:55], v[16:19], v[144:147]
    ds_read_b128 v[8:11], v243 offset:4096
    v_mfma_f32_16x16x32_bf16 v[148:151], v[52:55], v[20:23], v[148:151]
    ds_read_b128 v[12:15], v243 offset:6144
    v_mfma_f32_16x16x32_bf16 v[152:155], v[52:55], v[24:27], v[152:155]
    ds_read_b64_tr_b16 v[36:37], v245 offset:0
    v_mfma_f32_16x16x32_bf16 v[156:159], v[52:55], v[28:31], v[156:159]
    ds_read_b64_tr_b16 v[38:39], v245 offset:4096
    v_mfma_f32_16x16x32_bf16 v[160:163], v[56:59], v[16:19], v[160:163]
    ds_read_b64_tr_b16 v[40:41], v246 offset:0
    v_mfma_f32_16x16x32_bf16 v[164:167], v[56:59], v[20:23], v[164:167]
    ds_read_b64_tr_b16 v[42:43], v246 offset:4096
    v_mfma_f32_16x16x32_bf16 v[168:171], v[56:59], v[24:27], v[168:171]
    ds_read_b64_tr_b16 v[44:45], v247 offset:0
    v_mfma_f32_16x16x32_bf16 v[172:175], v[56:59], v[28:31], v[172:175]
    ds_read_b64_tr_b16 v[46:47], v247 offset:4096
    v_mfma_f32_16x16x32_bf16 v[176:179], v[60:63], v[16:19], v[176:179]
    v_mfma_f32_16x16x32_bf16 v[180:183], v[60:63], v[20:23], v[180:183]
    v_mfma_f32_16x16x32_bf16 v[184:187], v[60:63], v[24:27], v[184:187]
    v_mfma_f32_16x16x32_bf16 v[188:191], v[60:63], v[28:31], v[188:191]
    s_waitcnt lgkmcnt(0)
    .p2align 3
    v_mfma_f32_16x16x32_bf16 v[128:131], v[32:35], v[0:3], v[128:131]
    ds_read_b64_tr_b16 v[48:49], v244 offset:8192
    v_mfma_f32_16x16x32_bf16 v[132:135], v[32:35], v[4:7], v[132:135]
    ds_read_b64_tr_b16 v[50:51], v244 offset:12288
    v_mfma_f32_16x16x32_bf16 v[136:139], v[32:35], v[8:11], v[136:139]
    ds_read_b128 v[16:19], v243 offset:1024
    v_mfma_f32_16x16x32_bf16 v[140:143], v[32:35], v[12:15], v[140:143]
    ds_read_b128 v[20:23], v243 offset:3072
    v_mfma_f32_16x16x32_bf16 v[144:147], v[36:39], v[0:3], v[144:147]
    ds_read_b128 v[24:27], v243 offset:5120
    v_mfma_f32_16x16x32_bf16 v[148:151], v[36:39], v[4:7], v[148:151]
    ds_read_b128 v[28:31], v243 offset:7168
    v_mfma_f32_16x16x32_bf16 v[152:155], v[36:39], v[8:11], v[152:155]
    ds_read_b64_tr_b16 v[52:53], v245 offset:8192
    v_mfma_f32_16x16x32_bf16 v[156:159], v[36:39], v[12:15], v[156:159]
    ds_read_b64_tr_b16 v[54:55], v245 offset:12288
    v_mfma_f32_16x16x32_bf16 v[160:163], v[40:43], v[0:3], v[160:163]
    ds_read_b64_tr_b16 v[56:57], v246 offset:8192
    v_mfma_f32_16x16x32_bf16 v[164:167], v[40:43], v[4:7], v[164:167]
    ds_read_b64_tr_b16 v[58:59], v246 offset:12288
    v_mfma_f32_16x16x32_bf16 v[168:171], v[40:43], v[8:11], v[168:171]
    ds_read_b64_tr_b16 v[60:61], v247 offset:8192
    v_mfma_f32_16x16x32_bf16 v[172:175], v[40:43], v[12:15], v[172:175]
    ds_read_b64_tr_b16 v[62:63], v247 offset:12288
    v_mfma_f32_16x16x32_bf16 v[176:179], v[44:47], v[0:3], v[176:179]
    v_mfma_f32_16x16x32_bf16 v[180:183], v[44:47], v[4:7], v[180:183]
    v_mfma_f32_16x16x32_bf16 v[184:187], v[44:47], v[8:11], v[184:187]
    v_mfma_f32_16x16x32_bf16 v[188:191], v[44:47], v[12:15], v[188:191]
    s_waitcnt vmcnt(0) lgkmcnt(0)
    s_barrier
    .p2align 3
    v_mfma_f32_16x16x32_bf16 v[128:131], v[48:51], v[16:19], v[128:131]
    ds_read_b64_tr_b16 v[32:33], v244 offset:16384
    v_mfma_f32_16x16x32_bf16 v[132:135], v[48:51], v[20:23], v[132:135]
    ds_read_b64_tr_b16 v[34:35], v244 offset:20480
    v_mfma_f32_16x16x32_bf16 v[136:139], v[48:51], v[24:27], v[136:139]
    ds_read_b128 v[0:3], v243 offset:16384
    v_mfma_f32_16x16x32_bf16 v[140:143], v[48:51], v[28:31], v[140:143]
    ds_read_b128 v[4:7], v243 offset:18432
    v_mfma_f32_16x16x32_bf16 v[144:147], v[52:55], v[16:19], v[144:147]
    ds_read_b128 v[8:11], v243 offset:20480
    v_mfma_f32_16x16x32_bf16 v[148:151], v[52:55], v[20:23], v[148:151]
    ds_read_b128 v[12:15], v243 offset:22528
    v_mfma_f32_16x16x32_bf16 v[152:155], v[52:55], v[24:27], v[152:155]
    ds_read_b64_tr_b16 v[36:37], v245 offset:16384
    v_mfma_f32_16x16x32_bf16 v[156:159], v[52:55], v[28:31], v[156:159]
    ds_read_b64_tr_b16 v[38:39], v245 offset:20480
    v_mfma_f32_16x16x32_bf16 v[160:163], v[56:59], v[16:19], v[160:163]
    ds_read_b64_tr_b16 v[40:41], v246 offset:16384
    v_mfma_f32_16x16x32_bf16 v[164:167], v[56:59], v[20:23], v[164:167]
    ds_read_b64_tr_b16 v[42:43], v246 offset:20480
    v_mfma_f32_16x16x32_bf16 v[168:171], v[56:59], v[24:27], v[168:171]
    ds_read_b64_tr_b16 v[44:45], v247 offset:16384
    v_mfma_f32_16x16x32_bf16 v[172:175], v[56:59], v[28:31], v[172:175]
    ds_read_b64_tr_b16 v[46:47], v247 offset:20480
    v_mfma_f32_16x16x32_bf16 v[176:179], v[60:63], v[16:19], v[176:179]
    v_mfma_f32_16x16x32_bf16 v[180:183], v[60:63], v[20:23], v[180:183]
    v_mfma_f32_16x16x32_bf16 v[184:187], v[60:63], v[24:27], v[184:187]
    v_mfma_f32_16x16x32_bf16 v[188:191], v[60:63], v[28:31], v[188:191]
    s_waitcnt lgkmcnt(0)
    .p2align 3
    v_mfma_f32_16x16x32_bf16 v[128:131], v[32:35], v[0:3], v[128:131]
    ds_read_b64_tr_b16 v[48:49], v244 offset:24576
    v_mfma_f32_16x16x32_bf16 v[132:135], v[32:35], v[4:7], v[132:135]
    ds_read_b64_tr_b16 v[50:51], v244 offset:28672
    v_mfma_f32_16x16x32_bf16 v[136:139], v[32:35], v[8:11], v[136:139]
    ds_read_b128 v[16:19], v243 offset:17408
    v_mfma_f32_16x16x32_bf16 v[140:143], v[32:35], v[12:15], v[140:143]
    ds_read_b128 v[20:23], v243 offset:19456
    v_mfma_f32_16x16x32_bf16 v[144:147], v[36:39], v[0:3], v[144:147]
    ds_read_b128 v[24:27], v243 offset:21504
    v_mfma_f32_16x16x32_bf16 v[148:151], v[36:39], v[4:7], v[148:151]
    ds_read_b128 v[28:31], v243 offset:23552
    v_mfma_f32_16x16x32_bf16 v[152:155], v[36:39], v[8:11], v[152:155]
    ds_read_b64_tr_b16 v[52:53], v245 offset:24576
    v_mfma_f32_16x16x32_bf16 v[156:159], v[36:39], v[12:15], v[156:159]
    ds_read_b64_tr_b16 v[54:55], v245 offset:28672
    v_mfma_f32_16x16x32_bf16 v[160:163], v[40:43], v[0:3], v[160:163]
    ds_read_b64_tr_b16 v[56:57], v246 offset:24576
    v_mfma_f32_16x16x32_bf16 v[164:167], v[40:43], v[4:7], v[164:167]
    ds_read_b64_tr_b16 v[58:59], v246 offset:28672
    v_mfma_f32_16x16x32_bf16 v[168:171], v[40:43], v[8:11], v[168:171]
    ds_read_b64_tr_b16 v[60:61], v247 offset:24576
    v_mfma_f32_16x16x32_bf16 v[172:175], v[40:43], v[12:15], v[172:175]
    ds_read_b64_tr_b16 v[62:63], v247 offset:28672
    v_mfma_f32_16x16x32_bf16 v[176:179], v[44:47], v[0:3], v[176:179]
    v_mfma_f32_16x16x32_bf16 v[180:183], v[44:47], v[4:7], v[180:183]
    v_mfma_f32_16x16x32_bf16 v[184:187], v[44:47], v[8:11], v[184:187]
    v_mfma_f32_16x16x32_bf16 v[188:191], v[44:47], v[12:15], v[188:191]
    s_waitcnt lgkmcnt(0)
    s_barrier
    .p2align 3
    v_mfma_f32_16x16x32_bf16 v[128:131], v[48:51], v[16:19], v[128:131]
    ds_read_b64_tr_b16 v[32:33], v244 offset:32768
    v_mfma_f32_16x16x32_bf16 v[132:135], v[48:51], v[20:23], v[132:135]
    ds_read_b64_tr_b16 v[34:35], v244 offset:36864
    v_mfma_f32_16x16x32_bf16 v[136:139], v[48:51], v[24:27], v[136:139]
    ds_read_b128 v[0:3], v243 offset:32768
    v_mfma_f32_16x16x32_bf16 v[140:143], v[48:51], v[28:31], v[140:143]
    ds_read_b128 v[4:7], v243 offset:34816
    v_mfma_f32_16x16x32_bf16 v[144:147], v[52:55], v[16:19], v[144:147]
    ds_read_b128 v[8:11], v243 offset:36864
    v_mfma_f32_16x16x32_bf16 v[148:151], v[52:55], v[20:23], v[148:151]
    ds_read_b128 v[12:15], v243 offset:38912
    v_mfma_f32_16x16x32_bf16 v[152:155], v[52:55], v[24:27], v[152:155]
    ds_read_b64_tr_b16 v[36:37], v245 offset:32768
    v_mfma_f32_16x16x32_bf16 v[156:159], v[52:55], v[28:31], v[156:159]
    ds_read_b64_tr_b16 v[38:39], v245 offset:36864
    v_mfma_f32_16x16x32_bf16 v[160:163], v[56:59], v[16:19], v[160:163]
    ds_read_b64_tr_b16 v[40:41], v246 offset:32768
    v_mfma_f32_16x16x32_bf16 v[164:167], v[56:59], v[20:23], v[164:167]
    ds_read_b64_tr_b16 v[42:43], v246 offset:36864
    v_mfma_f32_16x16x32_bf16 v[168:171], v[56:59], v[24:27], v[168:171]
    ds_read_b64_tr_b16 v[44:45], v247 offset:32768
    v_mfma_f32_16x16x32_bf16 v[172:175], v[56:59], v[28:31], v[172:175]
    ds_read_b64_tr_b16 v[46:47], v247 offset:36864
    v_mfma_f32_16x16x32_bf16 v[176:179], v[60:63], v[16:19], v[176:179]
    v_mfma_f32_16x16x32_bf16 v[180:183], v[60:63], v[20:23], v[180:183]
    v_mfma_f32_16x16x32_bf16 v[184:187], v[60:63], v[24:27], v[184:187]
    v_mfma_f32_16x16x32_bf16 v[188:191], v[60:63], v[28:31], v[188:191]
    s_waitcnt lgkmcnt(0)
    .p2align 3
    v_mfma_f32_16x16x32_bf16 v[128:131], v[32:35], v[0:3], v[128:131]
    ds_read_b64_tr_b16 v[48:49], v244 offset:40960
    v_mfma_f32_16x16x32_bf16 v[132:135], v[32:35], v[4:7], v[132:135]
    ds_read_b64_tr_b16 v[50:51], v244 offset:45056
    v_mfma_f32_16x16x32_bf16 v[136:139], v[32:35], v[8:11], v[136:139]
    ds_read_b128 v[16:19], v243 offset:33792
    v_mfma_f32_16x16x32_bf16 v[140:143], v[32:35], v[12:15], v[140:143]
    ds_read_b128 v[20:23], v243 offset:35840
    v_mfma_f32_16x16x32_bf16 v[144:147], v[36:39], v[0:3], v[144:147]
    ds_read_b128 v[24:27], v243 offset:37888
    v_mfma_f32_16x16x32_bf16 v[148:151], v[36:39], v[4:7], v[148:151]
    ds_read_b128 v[28:31], v243 offset:39936
    v_mfma_f32_16x16x32_bf16 v[152:155], v[36:39], v[8:11], v[152:155]
    ds_read_b64_tr_b16 v[52:53], v245 offset:40960
    v_mfma_f32_16x16x32_bf16 v[156:159], v[36:39], v[12:15], v[156:159]
    ds_read_b64_tr_b16 v[54:55], v245 offset:45056
    v_mfma_f32_16x16x32_bf16 v[160:163], v[40:43], v[0:3], v[160:163]
    ds_read_b64_tr_b16 v[56:57], v246 offset:40960
    v_mfma_f32_16x16x32_bf16 v[164:167], v[40:43], v[4:7], v[164:167]
    ds_read_b64_tr_b16 v[58:59], v246 offset:45056
    v_mfma_f32_16x16x32_bf16 v[168:171], v[40:43], v[8:11], v[168:171]
    ds_read_b64_tr_b16 v[60:61], v247 offset:40960
    v_mfma_f32_16x16x32_bf16 v[172:175], v[40:43], v[12:15], v[172:175]
    ds_read_b64_tr_b16 v[62:63], v247 offset:45056
    v_mfma_f32_16x16x32_bf16 v[176:179], v[44:47], v[0:3], v[176:179]
    v_mfma_f32_16x16x32_bf16 v[180:183], v[44:47], v[4:7], v[180:183]
    v_mfma_f32_16x16x32_bf16 v[184:187], v[44:47], v[8:11], v[184:187]
    v_mfma_f32_16x16x32_bf16 v[188:191], v[44:47], v[12:15], v[188:191]
    s_waitcnt lgkmcnt(0)
    s_barrier
    .p2align 3
    v_mfma_f32_16x16x32_bf16 v[128:131], v[48:51], v[16:19], v[128:131]
    ds_read_b64_tr_b16 v[32:33], v248 offset:0
    v_mfma_f32_16x16x32_bf16 v[132:135], v[48:51], v[20:23], v[132:135]
    ds_read_b64_tr_b16 v[34:35], v248 offset:4096
    v_mfma_f32_16x16x32_bf16 v[136:139], v[48:51], v[24:27], v[136:139]
    ds_read_b128 v[0:3], v243 offset:0
    v_mfma_f32_16x16x32_bf16 v[140:143], v[48:51], v[28:31], v[140:143]
    ds_read_b128 v[4:7], v243 offset:2048
    v_mfma_f32_16x16x32_bf16 v[144:147], v[52:55], v[16:19], v[144:147]
    ds_read_b128 v[8:11], v243 offset:4096
    v_mfma_f32_16x16x32_bf16 v[148:151], v[52:55], v[20:23], v[148:151]
    ds_read_b128 v[12:15], v243 offset:6144
    v_mfma_f32_16x16x32_bf16 v[152:155], v[52:55], v[24:27], v[152:155]
    ds_read_b64_tr_b16 v[36:37], v249 offset:0
    v_mfma_f32_16x16x32_bf16 v[156:159], v[52:55], v[28:31], v[156:159]
    ds_read_b64_tr_b16 v[38:39], v249 offset:4096
    v_mfma_f32_16x16x32_bf16 v[160:163], v[56:59], v[16:19], v[160:163]
    ds_read_b64_tr_b16 v[40:41], v250 offset:0
    v_mfma_f32_16x16x32_bf16 v[164:167], v[56:59], v[20:23], v[164:167]
    ds_read_b64_tr_b16 v[42:43], v250 offset:4096
    v_mfma_f32_16x16x32_bf16 v[168:171], v[56:59], v[24:27], v[168:171]
    ds_read_b64_tr_b16 v[44:45], v251 offset:0
    v_mfma_f32_16x16x32_bf16 v[172:175], v[56:59], v[28:31], v[172:175]
    ds_read_b64_tr_b16 v[46:47], v251 offset:4096
    v_mfma_f32_16x16x32_bf16 v[176:179], v[60:63], v[16:19], v[176:179]
    v_mfma_f32_16x16x32_bf16 v[180:183], v[60:63], v[20:23], v[180:183]
    s_sub_u32 s58, s58, 1
    s_cmp_lg_u32 s58, 0
    .p2align 3
    v_mfma_f32_16x16x32_bf16 v[184:187], v[60:63], v[24:27], v[184:187]
    v_mfma_f32_16x16x32_bf16 v[188:191], v[60:63], v[28:31], v[188:191]
    s_cbranch_scc1 loop_34
    s_waitcnt lgkmcnt(0)
    .p2align 3
    v_mfma_f32_16x16x32_bf16 v[128:131], v[32:35], v[0:3], v[128:131]
    ds_read_b64_tr_b16 v[48:49], v248 offset:8192
    v_mfma_f32_16x16x32_bf16 v[132:135], v[32:35], v[4:7], v[132:135]
    ds_read_b64_tr_b16 v[50:51], v248 offset:12288
    v_mfma_f32_16x16x32_bf16 v[136:139], v[32:35], v[8:11], v[136:139]
    ds_read_b128 v[16:19], v243 offset:1024
    v_mfma_f32_16x16x32_bf16 v[140:143], v[32:35], v[12:15], v[140:143]
    ds_read_b128 v[20:23], v243 offset:3072
    v_mfma_f32_16x16x32_bf16 v[144:147], v[36:39], v[0:3], v[144:147]
    ds_read_b128 v[24:27], v243 offset:5120
    v_mfma_f32_16x16x32_bf16 v[148:151], v[36:39], v[4:7], v[148:151]
    ds_read_b128 v[28:31], v243 offset:7168
    v_mfma_f32_16x16x32_bf16 v[152:155], v[36:39], v[8:11], v[152:155]
    ds_read_b64_tr_b16 v[52:53], v249 offset:8192
    v_mfma_f32_16x16x32_bf16 v[156:159], v[36:39], v[12:15], v[156:159]
    ds_read_b64_tr_b16 v[54:55], v249 offset:12288
    v_mfma_f32_16x16x32_bf16 v[160:163], v[40:43], v[0:3], v[160:163]
    ds_read_b64_tr_b16 v[56:57], v250 offset:8192
    v_mfma_f32_16x16x32_bf16 v[164:167], v[40:43], v[4:7], v[164:167]
    ds_read_b64_tr_b16 v[58:59], v250 offset:12288
    v_mfma_f32_16x16x32_bf16 v[168:171], v[40:43], v[8:11], v[168:171]
    ds_read_b64_tr_b16 v[60:61], v251 offset:8192
    v_mfma_f32_16x16x32_bf16 v[172:175], v[40:43], v[12:15], v[172:175]
    ds_read_b64_tr_b16 v[62:63], v251 offset:12288
    v_mfma_f32_16x16x32_bf16 v[176:179], v[44:47], v[0:3], v[176:179]
    v_mfma_f32_16x16x32_bf16 v[180:183], v[44:47], v[4:7], v[180:183]
    v_mfma_f32_16x16x32_bf16 v[184:187], v[44:47], v[8:11], v[184:187]
    v_mfma_f32_16x16x32_bf16 v[188:191], v[44:47], v[12:15], v[188:191]
    s_waitcnt lgkmcnt(0)
    s_barrier
    .p2align 3
    v_mfma_f32_16x16x32_bf16 v[128:131], v[48:51], v[16:19], v[128:131]
    ds_read_b64_tr_b16 v[32:33], v248 offset:16384
    v_mfma_f32_16x16x32_bf16 v[132:135], v[48:51], v[20:23], v[132:135]
    ds_read_b64_tr_b16 v[34:35], v248 offset:20480
    v_mfma_f32_16x16x32_bf16 v[136:139], v[48:51], v[24:27], v[136:139]
    ds_read_b128 v[0:3], v243 offset:16384
    v_mfma_f32_16x16x32_bf16 v[140:143], v[48:51], v[28:31], v[140:143]
    ds_read_b128 v[4:7], v243 offset:18432
    v_mfma_f32_16x16x32_bf16 v[144:147], v[52:55], v[16:19], v[144:147]
    ds_read_b128 v[8:11], v243 offset:20480
    v_mfma_f32_16x16x32_bf16 v[148:151], v[52:55], v[20:23], v[148:151]
    ds_read_b128 v[12:15], v243 offset:22528
    v_mfma_f32_16x16x32_bf16 v[152:155], v[52:55], v[24:27], v[152:155]
    ds_read_b64_tr_b16 v[36:37], v249 offset:16384
    v_mfma_f32_16x16x32_bf16 v[156:159], v[52:55], v[28:31], v[156:159]
    ds_read_b64_tr_b16 v[38:39], v249 offset:20480
    v_mfma_f32_16x16x32_bf16 v[160:163], v[56:59], v[16:19], v[160:163]
    ds_read_b64_tr_b16 v[40:41], v250 offset:16384
    v_mfma_f32_16x16x32_bf16 v[164:167], v[56:59], v[20:23], v[164:167]
    ds_read_b64_tr_b16 v[42:43], v250 offset:20480
    v_mfma_f32_16x16x32_bf16 v[168:171], v[56:59], v[24:27], v[168:171]
    ds_read_b64_tr_b16 v[44:45], v251 offset:16384
    v_mfma_f32_16x16x32_bf16 v[172:175], v[56:59], v[28:31], v[172:175]
    ds_read_b64_tr_b16 v[46:47], v251 offset:20480
    v_mfma_f32_16x16x32_bf16 v[176:179], v[60:63], v[16:19], v[176:179]
    v_mfma_f32_16x16x32_bf16 v[180:183], v[60:63], v[20:23], v[180:183]
    v_mfma_f32_16x16x32_bf16 v[184:187], v[60:63], v[24:27], v[184:187]
    v_mfma_f32_16x16x32_bf16 v[188:191], v[60:63], v[28:31], v[188:191]
    s_waitcnt lgkmcnt(0)
    .p2align 3
    v_mfma_f32_16x16x32_bf16 v[128:131], v[32:35], v[0:3], v[128:131]
    ds_read_b64_tr_b16 v[48:49], v248 offset:24576
    v_mfma_f32_16x16x32_bf16 v[132:135], v[32:35], v[4:7], v[132:135]
    ds_read_b64_tr_b16 v[50:51], v248 offset:28672
    v_mfma_f32_16x16x32_bf16 v[136:139], v[32:35], v[8:11], v[136:139]
    ds_read_b128 v[16:19], v243 offset:17408
    v_mfma_f32_16x16x32_bf16 v[140:143], v[32:35], v[12:15], v[140:143]
    ds_read_b128 v[20:23], v243 offset:19456
    v_mfma_f32_16x16x32_bf16 v[144:147], v[36:39], v[0:3], v[144:147]
    ds_read_b128 v[24:27], v243 offset:21504
    v_mfma_f32_16x16x32_bf16 v[148:151], v[36:39], v[4:7], v[148:151]
    ds_read_b128 v[28:31], v243 offset:23552
    v_mfma_f32_16x16x32_bf16 v[152:155], v[36:39], v[8:11], v[152:155]
    ds_read_b64_tr_b16 v[52:53], v249 offset:24576
    v_mfma_f32_16x16x32_bf16 v[156:159], v[36:39], v[12:15], v[156:159]
    ds_read_b64_tr_b16 v[54:55], v249 offset:28672
    v_mfma_f32_16x16x32_bf16 v[160:163], v[40:43], v[0:3], v[160:163]
    ds_read_b64_tr_b16 v[56:57], v250 offset:24576
    v_mfma_f32_16x16x32_bf16 v[164:167], v[40:43], v[4:7], v[164:167]
    ds_read_b64_tr_b16 v[58:59], v250 offset:28672
    v_mfma_f32_16x16x32_bf16 v[168:171], v[40:43], v[8:11], v[168:171]
    ds_read_b64_tr_b16 v[60:61], v251 offset:24576
    v_mfma_f32_16x16x32_bf16 v[172:175], v[40:43], v[12:15], v[172:175]
    ds_read_b64_tr_b16 v[62:63], v251 offset:28672
    v_mfma_f32_16x16x32_bf16 v[176:179], v[44:47], v[0:3], v[176:179]
    v_mfma_f32_16x16x32_bf16 v[180:183], v[44:47], v[4:7], v[180:183]
    buffer_load_dwordx4 v[96:99], v254, s[4:7], s59 offen offset:0
    .p2align 3
    v_mfma_f32_16x16x32_bf16 v[184:187], v[44:47], v[8:11], v[184:187]
    v_mfma_f32_16x16x32_bf16 v[188:191], v[44:47], v[12:15], v[188:191]
    s_waitcnt lgkmcnt(0)
    s_barrier
    .p2align 3
    v_mfma_f32_16x16x32_bf16 v[128:131], v[48:51], v[16:19], v[128:131]
    ds_read_b64_tr_b16 v[32:33], v248 offset:32768
    v_mfma_f32_16x16x32_bf16 v[132:135], v[48:51], v[20:23], v[132:135]
    ds_read_b64_tr_b16 v[34:35], v248 offset:36864
    v_mfma_f32_16x16x32_bf16 v[136:139], v[48:51], v[24:27], v[136:139]
    ds_read_b128 v[0:3], v243 offset:32768
    v_mfma_f32_16x16x32_bf16 v[140:143], v[48:51], v[28:31], v[140:143]
    ds_read_b128 v[4:7], v243 offset:34816
    v_mfma_f32_16x16x32_bf16 v[144:147], v[52:55], v[16:19], v[144:147]
    ds_read_b128 v[8:11], v243 offset:36864
    v_mfma_f32_16x16x32_bf16 v[148:151], v[52:55], v[20:23], v[148:151]
    ds_read_b128 v[12:15], v243 offset:38912
    v_mfma_f32_16x16x32_bf16 v[152:155], v[52:55], v[24:27], v[152:155]
    ds_read_b64_tr_b16 v[36:37], v249 offset:32768
    v_mfma_f32_16x16x32_bf16 v[156:159], v[52:55], v[28:31], v[156:159]
    ds_read_b64_tr_b16 v[38:39], v249 offset:36864
    v_mfma_f32_16x16x32_bf16 v[160:163], v[56:59], v[16:19], v[160:163]
    ds_read_b64_tr_b16 v[40:41], v250 offset:32768
    v_mfma_f32_16x16x32_bf16 v[164:167], v[56:59], v[20:23], v[164:167]
    ds_read_b64_tr_b16 v[42:43], v250 offset:36864
    v_mfma_f32_16x16x32_bf16 v[168:171], v[56:59], v[24:27], v[168:171]
    ds_read_b64_tr_b16 v[44:45], v251 offset:32768
    v_mfma_f32_16x16x32_bf16 v[172:175], v[56:59], v[28:31], v[172:175]
    ds_read_b64_tr_b16 v[46:47], v251 offset:36864
    v_mfma_f32_16x16x32_bf16 v[176:179], v[60:63], v[16:19], v[176:179]
    v_mfma_f32_16x16x32_bf16 v[180:183], v[60:63], v[20:23], v[180:183]
    buffer_load_dwordx4 v[100:103], v254, s[4:7], s59 offen offset:2048
    .p2align 3
    v_mfma_f32_16x16x32_bf16 v[184:187], v[60:63], v[24:27], v[184:187]
    v_mfma_f32_16x16x32_bf16 v[188:191], v[60:63], v[28:31], v[188:191]
    s_waitcnt lgkmcnt(0)
    .p2align 3
    v_mfma_f32_16x16x32_bf16 v[128:131], v[32:35], v[0:3], v[128:131]
    ds_read_b64_tr_b16 v[48:49], v248 offset:40960
    v_mfma_f32_16x16x32_bf16 v[132:135], v[32:35], v[4:7], v[132:135]
    ds_read_b64_tr_b16 v[50:51], v248 offset:45056
    v_mfma_f32_16x16x32_bf16 v[136:139], v[32:35], v[8:11], v[136:139]
    ds_read_b128 v[16:19], v243 offset:33792
    v_mfma_f32_16x16x32_bf16 v[140:143], v[32:35], v[12:15], v[140:143]
    ds_read_b128 v[20:23], v243 offset:35840
    v_mfma_f32_16x16x32_bf16 v[144:147], v[36:39], v[0:3], v[144:147]
    ds_read_b128 v[24:27], v243 offset:37888
    v_mfma_f32_16x16x32_bf16 v[148:151], v[36:39], v[4:7], v[148:151]
    ds_read_b128 v[28:31], v243 offset:39936
    v_mfma_f32_16x16x32_bf16 v[152:155], v[36:39], v[8:11], v[152:155]
    ds_read_b64_tr_b16 v[52:53], v249 offset:40960
    v_mfma_f32_16x16x32_bf16 v[156:159], v[36:39], v[12:15], v[156:159]
    ds_read_b64_tr_b16 v[54:55], v249 offset:45056
    v_mfma_f32_16x16x32_bf16 v[160:163], v[40:43], v[0:3], v[160:163]
    ds_read_b64_tr_b16 v[56:57], v250 offset:40960
    v_mfma_f32_16x16x32_bf16 v[164:167], v[40:43], v[4:7], v[164:167]
    ds_read_b64_tr_b16 v[58:59], v250 offset:45056
    v_mfma_f32_16x16x32_bf16 v[168:171], v[40:43], v[8:11], v[168:171]
    ds_read_b64_tr_b16 v[60:61], v251 offset:40960
    v_mfma_f32_16x16x32_bf16 v[172:175], v[40:43], v[12:15], v[172:175]
    ds_read_b64_tr_b16 v[62:63], v251 offset:45056
    v_mfma_f32_16x16x32_bf16 v[176:179], v[44:47], v[0:3], v[176:179]
    v_mfma_f32_16x16x32_bf16 v[180:183], v[44:47], v[4:7], v[180:183]
    buffer_load_dwordx4 v[104:107], v254, s[4:7], s60 offen offset:0
    .p2align 3
    v_mfma_f32_16x16x32_bf16 v[184:187], v[44:47], v[8:11], v[184:187]
    v_mfma_f32_16x16x32_bf16 v[188:191], v[44:47], v[12:15], v[188:191]
    s_waitcnt lgkmcnt(0)
    s_barrier
    .p2align 3
    v_mfma_f32_16x16x32_bf16 v[128:131], v[48:51], v[16:19], v[128:131]
    v_mfma_f32_16x16x32_bf16 v[132:135], v[48:51], v[20:23], v[132:135]
    v_mfma_f32_16x16x32_bf16 v[136:139], v[48:51], v[24:27], v[136:139]
    v_mfma_f32_16x16x32_bf16 v[140:143], v[48:51], v[28:31], v[140:143]
    v_mfma_f32_16x16x32_bf16 v[144:147], v[52:55], v[16:19], v[144:147]
    v_mfma_f32_16x16x32_bf16 v[148:151], v[52:55], v[20:23], v[148:151]
    v_mfma_f32_16x16x32_bf16 v[152:155], v[52:55], v[24:27], v[152:155]
    v_mfma_f32_16x16x32_bf16 v[156:159], v[52:55], v[28:31], v[156:159]
    v_mfma_f32_16x16x32_bf16 v[160:163], v[56:59], v[16:19], v[160:163]
    v_mfma_f32_16x16x32_bf16 v[164:167], v[56:59], v[20:23], v[164:167]
    v_mfma_f32_16x16x32_bf16 v[168:171], v[56:59], v[24:27], v[168:171]
    v_mfma_f32_16x16x32_bf16 v[172:175], v[56:59], v[28:31], v[172:175]
    v_mfma_f32_16x16x32_bf16 v[176:179], v[60:63], v[16:19], v[176:179]
    v_mfma_f32_16x16x32_bf16 v[180:183], v[60:63], v[20:23], v[180:183]
    buffer_load_dwordx4 v[108:111], v254, s[4:7], s60 offen offset:2048
    .p2align 3
    v_mfma_f32_16x16x32_bf16 v[184:187], v[60:63], v[24:27], v[184:187]
    v_mfma_f32_16x16x32_bf16 v[188:191], v[60:63], v[28:31], v[188:191]
    s_nop 7
    v_cvt_pk_bf16_f32 v64, v160, v161
    v_cvt_pk_bf16_f32 v65, v162, v163
    v_cvt_pk_bf16_f32 v66, v176, v177
    v_cvt_pk_bf16_f32 v67, v178, v179
    v_min_u32 v64, -2, v64
    v_min_u32 v65, -2, v65
    v_min_u32 v66, -2, v66
    v_min_u32 v67, -2, v67
    buffer_store_dwordx4 v[64:67], v254, s[4:7], s88 offen offset:0 sc0 sc1
    v_cvt_pk_bf16_f32 v68, v164, v165
    v_cvt_pk_bf16_f32 v69, v166, v167
    v_cvt_pk_bf16_f32 v70, v180, v181
    v_cvt_pk_bf16_f32 v71, v182, v183
    v_min_u32 v68, -2, v68
    v_min_u32 v69, -2, v69
    v_min_u32 v70, -2, v70
    v_min_u32 v71, -2, v71
    buffer_store_dwordx4 v[68:71], v254, s[4:7], s88 offen offset:1024 sc0 sc1
    v_cvt_pk_bf16_f32 v72, v168, v169
    v_cvt_pk_bf16_f32 v73, v170, v171
    v_cvt_pk_bf16_f32 v74, v184, v185
    v_cvt_pk_bf16_f32 v75, v186, v187
    v_min_u32 v72, -2, v72
    v_min_u32 v73, -2, v73
    v_min_u32 v74, -2, v74
    v_min_u32 v75, -2, v75
    buffer_store_dwordx4 v[72:75], v254, s[4:7], s88 offen offset:2048 sc0 sc1
    v_cvt_pk_bf16_f32 v76, v172, v173
    v_cvt_pk_bf16_f32 v77, v174, v175
    v_cvt_pk_bf16_f32 v78, v188, v189
    v_cvt_pk_bf16_f32 v79, v190, v191
    v_min_u32 v76, -2, v76
    v_min_u32 v77, -2, v77
    v_min_u32 v78, -2, v78
    v_min_u32 v79, -2, v79
    buffer_store_dwordx4 v[76:79], v254, s[4:7], s88 offen offset:3072 sc0 sc1
    s_waitcnt vmcnt(4)
    v_lshlrev_b32 v160, 16, v96
    v_and_b32 v161, 0xffff0000, v96
    v_lshlrev_b32 v162, 16, v97
    v_and_b32 v163, 0xffff0000, v97
    v_pk_add_f32 v[128:129], v[128:129], v[160:161]
    v_pk_add_f32 v[130:131], v[130:131], v[162:163]
    v_lshlrev_b32 v164, 16, v98
    v_and_b32 v165, 0xffff0000, v98
    v_lshlrev_b32 v166, 16, v99
    v_and_b32 v167, 0xffff0000, v99
    v_pk_add_f32 v[144:145], v[144:145], v[164:165]
    v_pk_add_f32 v[146:147], v[146:147], v[166:167]
    v_lshlrev_b32 v168, 16, v100
    v_and_b32 v169, 0xffff0000, v100
    v_lshlrev_b32 v170, 16, v101
    v_and_b32 v171, 0xffff0000, v101
    v_pk_add_f32 v[132:133], v[132:133], v[168:169]
    v_pk_add_f32 v[134:135], v[134:135], v[170:171]
    v_lshlrev_b32 v172, 16, v102
    v_and_b32 v173, 0xffff0000, v102
    v_lshlrev_b32 v174, 16, v103
    v_and_b32 v175, 0xffff0000, v103
    v_pk_add_f32 v[148:149], v[148:149], v[172:173]
    v_pk_add_f32 v[150:151], v[150:151], v[174:175]
    v_lshlrev_b32 v160, 16, v104
    v_and_b32 v161, 0xffff0000, v104
    v_lshlrev_b32 v162, 16, v105
    v_and_b32 v163, 0xffff0000, v105
    v_pk_add_f32 v[136:137], v[136:137], v[160:161]
    v_pk_add_f32 v[138:139], v[138:139], v[162:163]
    v_lshlrev_b32 v164, 16, v106
    v_and_b32 v165, 0xffff0000, v106
    v_lshlrev_b32 v166, 16, v107
    v_and_b32 v167, 0xffff0000, v107
    v_pk_add_f32 v[152:153], v[152:153], v[164:165]
    v_pk_add_f32 v[154:155], v[154:155], v[166:167]
    v_lshlrev_b32 v168, 16, v108
    v_and_b32 v169, 0xffff0000, v108
    v_lshlrev_b32 v170, 16, v109
    v_and_b32 v171, 0xffff0000, v109
    v_pk_add_f32 v[140:141], v[140:141], v[168:169]
    v_pk_add_f32 v[142:143], v[142:143], v[170:171]
    v_lshlrev_b32 v172, 16, v110
    v_and_b32 v173, 0xffff0000, v110
    v_lshlrev_b32 v174, 16, v111
    v_and_b32 v175, 0xffff0000, v111
    v_pk_add_f32 v[156:157], v[156:157], v[172:173]
    v_pk_add_f32 v[158:159], v[158:159], v[174:175]
    s_mov_b32 s56, 262144
poll_35:
    buffer_load_dwordx4 v[80:83], v254, s[4:7], s89 offen offset:0 sc0 sc1
    buffer_load_dwordx4 v[84:87], v254, s[4:7], s89 offen offset:1024 sc0 sc1
    buffer_load_dwordx4 v[88:91], v254, s[4:7], s89 offen offset:2048 sc0 sc1
    buffer_load_dwordx4 v[92:95], v254, s[4:7], s89 offen offset:3072 sc0 sc1
    s_waitcnt vmcnt(0)
    v_max3_u32 v192, v80, v81, v82
    v_max3_u32 v193, v83, v84, v85
    v_max3_u32 v192, v192, v86, v87
    v_max3_u32 v193, v193, v88, v89
    v_max3_u32 v192, v192, v90, v91
    v_max3_u32 v193, v193, v92, v93
    v_max3_u32 v192, v192, v94, v95
    v_max_u32 v192, v192, v193
    v_cmp_eq_u32 vcc, -1, v192
    s_cbranch_vccz pd_36
    s_sub_u32 s56, s56, 1
    s_cmp_lg_u32 s56, 0
    s_cbranch_scc1 poll_35
pd_36:
    v_lshlrev_b32 v160, 16, v80
    v_and_b32 v161, 0xffff0000, v80
    v_lshlrev_b32 v162, 16, v81
    v_and_b32 v163, 0xffff0000, v81
    v_pk_add_f32 v[128:129], v[128:129], v[160:161]
    v_pk_add_f32 v[130:131], v[130:131], v[162:163]
    v_lshlrev_b32 v164, 16, v82
    v_and_b32 v165, 0xffff0000, v82
    v_lshlrev_b32 v166, 16, v83
    v_and_b32 v167, 0xffff0000, v83
    v_pk_add_f32 v[144:145], v[144:145], v[164:165]
    v_pk_add_f32 v[146:147], v[146:147], v[166:167]
    v_lshlrev_b32 v168, 16, v84
    v_and_b32 v169, 0xffff0000, v84
    v_lshlrev_b32 v170, 16, v85
    v_and_b32 v171, 0xffff0000, v85
    v_pk_add_f32 v[132:133], v[132:133], v[168:169]
    v_pk_add_f32 v[134:135], v[134:135], v[170:171]
    v_lshlrev_b32 v172, 16, v86
    v_and_b32 v173, 0xffff0000, v86
    v_lshlrev_b32 v174, 16, v87
    v_and_b32 v175, 0xffff0000, v87
    v_pk_add_f32 v[148:149], v[148:149], v[172:173]
    v_pk_add_f32 v[150:151], v[150:151], v[174:175]
    v_lshlrev_b32 v160, 16, v88
    v_and_b32 v161, 0xffff0000, v88
    v_lshlrev_b32 v162, 16, v89
    v_and_b32 v163, 0xffff0000, v89
    v_pk_add_f32 v[136:137], v[136:137], v[160:161]
    v_pk_add_f32 v[138:139], v[138:139], v[162:163]
    v_lshlrev_b32 v164, 16, v90
    v_and_b32 v165, 0xffff0000, v90
    v_lshlrev_b32 v166, 16, v91
    v_and_b32 v167, 0xffff0000, v91
    v_pk_add_f32 v[152:153], v[152:153], v[164:165]
    v_pk_add_f32 v[154:155], v[154:155], v[166:167]
    v_lshlrev_b32 v168, 16, v92
    v_and_b32 v169, 0xffff0000, v92
    v_lshlrev_b32 v170, 16, v93
    v_and_b32 v171, 0xffff0000, v93
    v_pk_add_f32 v[140:141], v[140:141], v[168:169]
    v_pk_add_f32 v[142:143], v[142:143], v[170:171]
    v_lshlrev_b32 v172, 16, v94
    v_and_b32 v173, 0xffff0000, v94
    v_lshlrev_b32 v174, 16, v95
    v_and_b32 v175, 0xffff0000, v95
    v_pk_add_f32 v[156:157], v[156:157], v[172:173]
    v_pk_add_f32 v[158:159], v[158:159], v[174:175]
    s_cmp_lg_u32 s46, 0
    s_cbranch_scc1 X_fin
    s_add_u32 s59, s1, s48
    s_add_u32 s60, s59, 4096
    v_cvt_pk_bf16_f32 v236, v128, v129
    v_cvt_pk_bf16_f32 v237, v130, v131
    v_cvt_pk_bf16_f32 v238, v144, v145
    v_cvt_pk_bf16_f32 v239, v146, v147
    buffer_store_dwordx4 v[236:239], v254, s[4:7], s59 offen offset:0 sc0 sc1
    v_cvt_pk_bf16_f32 v240, v132, v133
    v_cvt_pk_bf16_f32 v241, v134, v135
    v_cvt_pk_bf16_f32 v242, v148, v149
    v_cvt_pk_bf16_f32 v243, v150, v151
    buffer_store_dwordx4 v[240:243], v254, s[4:7], s59 offen offset:2048 sc0 sc1
    v_cvt_pk_bf16_f32 v244, v136, v137
    v_cvt_pk_bf16_f32 v245, v138, v139
    v_cvt_pk_bf16_f32 v246, v152, v153
    v_cvt_pk_bf16_f32 v247, v154, v155
    buffer_store_dwordx4 v[244:247], v254, s[4:7], s60 offen offset:0 sc0 sc1
    v_cvt_pk_bf16_f32 v248, v140, v141
    v_cvt_pk_bf16_f32 v249, v142, v143
    v_cvt_pk_bf16_f32 v250, v156, v157
    v_cvt_pk_bf16_f32 v251, v158, v159
    buffer_store_dwordx4 v[248:251], v254, s[4:7], s60 offen offset:2048 sc0 sc1
    v_mov_b32 v234, 0x3f803f80
    v_dot2_f32_bf16 v226, v236, v234, 0
    v_dot2_f32_bf16 v230, v236, v236, 0
    v_dot2_f32_bf16 v227, v240, v234, 0
    v_dot2_f32_bf16 v231, v240, v240, 0
    v_dot2_f32_bf16 v228, v244, v234, 0
    v_dot2_f32_bf16 v232, v244, v244, 0
    v_dot2_f32_bf16 v229, v248, v234, 0
    v_dot2_f32_bf16 v233, v248, v248, 0
    v_dot2_f32_bf16 v226, v237, v234, v226
    v_dot2_f32_bf16 v230, v237, v237, v230
    v_dot2_f32_bf16 v227, v241, v234, v227
    v_dot2_f32_bf16 v231, v241, v241, v231
    v_dot2_f32_bf16 v228, v245, v234, v228
    v_dot2_f32_bf16 v232, v245, v245, v232
    v_dot2_f32_bf16 v229, v249, v234, v229
    v_dot2_f32_bf16 v233, v249, v249, v233
    v_dot2_f32_bf16 v226, v238, v234, v226
    v_dot2_f32_bf16 v230, v238, v238, v230
    v_dot2_f32_bf16 v227, v242, v234, v227
    v_dot2_f32_bf16 v231, v242, v242, v231
    v_dot2_f32_bf16 v228, v246, v234, v228
    v_dot2_f32_bf16 v232, v246, v246, v232
    v_dot2_f32_bf16 v229, v250, v234, v229
    v_dot2_f32_bf16 v233, v250, v250, v233
    v_dot2_f32_bf16 v226, v239, v234, v226
    v_dot2_f32_bf16 v230, v239, v239, v230
    v_dot2_f32_bf16 v227, v243, v234, v227
    v_dot2_f32_bf16 v231, v243, v243, v231
    v_dot2_f32_bf16 v228, v247, v234, v228
    v_dot2_f32_bf16 v232, v247, v247, v232
    v_dot2_f32_bf16 v229, v251, v234, v229
    v_dot2_f32_bf16 v233, v251, v251, v233
    s_lshl_b32 s55, s42, 9
    s_add_u32 s55, s55, 155648
    s_nop 1
    v_permlane32_swap_b32 v226, v228
    v_permlane32_swap_b32 v227, v229
    v_permlane32_swap_b32 v230, v232
    v_permlane32_swap_b32 v231, v233
    v_add_f32 v226, v226, v228
    v_add_f32 v227, v227, v229
    v_add_f32 v230, v230, v232
    v_add_f32 v231, v231, v233
    v_lshrrev_b32 v234, 1, v254
    v_add_u32 v234, s55, v234
    v_permlane16_swap_b32 v226, v227
    v_permlane16_swap_b32 v230, v231
    v_add_f32 v226, v226, v227
    v_add_f32 v227, v230, v231
    ds_write_b64 v234, v[226:227]
    s_mov_b32 s46, 1
    s_add_u32 s47, s47, 262144
    s_add_u32 s49, s49, 524288
    s_add_u32 s50, s50, 917504
    s_add_u32 s52, s52, 65536
    s_add_u32 s54, s54, 32768
    s_add_u32 s0, s0, 32768
    s_branch X_layer
X_fin:
    v_and_b32 v192, 0xf0, v254
    v_lshlrev_b32 v192, 7, v192
    v_and_b32 v193, 0x100, v254
    v_lshrrev_b32 v193, 3, v193
    v_add_u32 v192, v192, v193
    v_and_b32 v193, 0x200, v254
    v_lshrrev_b32 v193, 5, v193
    v_add_u32 v192, v192, v193
    s_lshl_b32 s55, s40, 18
    s_lshl_b32 s56, s43, 17
    s_add_u32 s55, s55, s56
    s_lshl_b32 s56, s51, 7
    s_add_u32 s55, s55, s56
    s_lshl_b32 s56, s44, 6
    s_add_u32 s55, s55, s56
    v_cvt_pk_bf16_f32 v0, v128, v129
    v_cvt_pk_bf16_f32 v1, v130, v131
    v_cvt_pk_bf16_f32 v2, v144, v145
    v_cvt_pk_bf16_f32 v3, v146, v147
    s_nop 1
    v_permlane16_swap_b32 v0, v2
    v_permlane16_swap_b32 v1, v3
    buffer_store_dwordx4 v[0:3], v192, s[28:31], s55 offen
    s_add_u32 s55, s55, 32768
    v_cvt_pk_bf16_f32 v4, v132, v133
    v_cvt_pk_bf16_f32 v5, v134, v135
    v_cvt_pk_bf16_f32 v6, v148, v149
    v_cvt_pk_bf16_f32 v7, v150, v151
    s_nop 1
    v_permlane16_swap_b32 v4, v6
    v_permlane16_swap_b32 v5, v7
    buffer_store_dwordx4 v[4:7], v192, s[28:31], s55 offen
    s_add_u32 s55, s55, 32768
    v_cvt_pk_bf16_f32 v8, v136, v137
    v_cvt_pk_bf16_f32 v9, v138, v139
    v_cvt_pk_bf16_f32 v10, v152, v153
    v_cvt_pk_bf16_f32 v11, v154, v155
    s_nop 1
    v_permlane16_swap_b32 v8, v10
    v_permlane16_swap_b32 v9, v11
    buffer_store_dwordx4 v[8:11], v192, s[28:31], s55 offen
    s_add_u32 s55, s55, 32768
    v_cvt_pk_bf16_f32 v12, v140, v141
    v_cvt_pk_bf16_f32 v13, v142, v143
    v_cvt_pk_bf16_f32 v14, v156, v157
    v_cvt_pk_bf16_f32 v15, v158, v159
    s_nop 1
    v_permlane16_swap_b32 v12, v14
    v_permlane16_swap_b32 v13, v15
    buffer_store_dwordx4 v[12:15], v192, s[28:31], s55 offen
    s_add_u32 s55, s55, 32768
    s_endpgm
Y_first:
    s_setprio 1
    s_waitcnt vmcnt(27)
    s_barrier
    s_waitcnt vmcnt(24)
    s_barrier
    s_add_u32 m0, s61, 0
    s_mul_i32 s59, s93, 96
    buffer_load_dwordx4 v200, s[8:11], s59 offen lds
    v_lshrrev_b32 v224, 7, v254
    v_and_b32 v225, 0x70, v254
    v_and_b32 v226, 6, v224
    v_lshlrev_b32 v226, 4, v226
    v_xor_b32 v225, v225, v226
    v_mul_u32_u24 v224, 2048, v224
    v_add3_u32 v203, v224, v225, s64
    buffer_load_dwordx4 v201, s[8:11], s59 offen offset:1024 lds
    v_add_u32 v204, 15360, v203
    v_add_u32 v205, 30720, v203
    v_add_u32 v206, 46080, v203
    v_and_b32 v225, 0xf0, v254
    v_lshrrev_b32 v224, 8, v254
    v_lshlrev_b32 v226, 5, v224
    v_xor_b32 v225, v225, v226
    buffer_load_dwordx4 v202, s[8:11], s59 offen offset:2048 lds
    s_add_u32 s93, s93, 2048
    s_and_b32 s93, s93, 65535
    v_mul_u32_u24 v224, 7168, v224
    v_add_u32 v224, s65, v224
    v_add_u32 v207, v224, v225
    v_xor_b32 v225, 0x80, v225
    v_add_u32 v224, v224, v225
    v_add_u32 v208, 27648, v224
    v_add_u32 v209, 55296, v207
    v_add_u32 v210, 55296, v208
    s_waitcnt vmcnt(17)
    s_barrier
    s_add_u32 m0, s91, 98304
    s_mov_b64 exec, s[84:85]
    buffer_load_dwordx4 v221, s[36:39], s94 offen lds
    s_mov_b64 exec, -1
    v_lshrrev_b32 v224, 7, v254
    v_and_b32 v225, 0x70, v254
    v_and_b32 v226, 6, v224
    s_add_u32 m0, s62, 100352
    s_nop 0
    buffer_load_dwordx4 v217, s[36:39], s94 offen lds
    v_lshlrev_b32 v226, 4, v226
    v_xor_b32 v225, v225, v226
    v_mul_u32_u24 v224, 7168, v224
    buffer_load_dwordx4 v218, s[36:39], s94 offen offset:1024 lds
    v_add3_u32 v211, v224, v225, s66
    v_add_u32 v212, 56320, v211
    v_add_u32 v222, s67, v254
    v_and_b32 v225, 0xf0, v254
    s_add_u32 m0, s61, 16384
    s_mul_i32 s59, s93, 96
    buffer_load_dwordx4 v200, s[8:11], s59 offen lds
    v_lshrrev_b32 v224, 8, v254
    v_lshlrev_b32 v226, 5, v224
    v_xor_b32 v225, v225, v226
    buffer_load_dwordx4 v201, s[8:11], s59 offen offset:1024 lds
    v_mul_u32_u24 v224, 2048, v224
    v_add_u32 v213, v224, v225
    v_xor_b32 v225, 0x80, v225
    buffer_load_dwordx4 v202, s[8:11], s59 offen offset:2048 lds
    s_add_u32 s93, s93, 6144
    s_and_b32 s93, s93, 65535
    v_add_u32 v224, v224, v225
    v_add_u32 v214, 7168, v224
    v_add_u32 v215, 14336, v213
    v_add_u32 v216, 14336, v214
    s_waitcnt vmcnt(15)
    s_barrier
    s_add_u32 m0, s62, 100352
    s_nop 0
    buffer_load_dwordx4 v219, s[36:39], s94 offen offset:2048 lds
    s_lshr_b32 s55, s2, 1
    s_cmp_lt_u32 s55, 56
    s_cselect_b32 s72, s80, s82
    s_cselect_b32 s73, s81, s83
    s_cselect_b32 s56, 0, 56
    s_sub_u32 s55, s55, s56
    s_lshl_b32 s76, s55, 7
    s_and_b32 s55, s2, 1
    s_lshl_b32 s55, s55, 2
    s_add_u32 s55, s55, s42
    s_mul_i32 s55, s55, 917504
    s_add_u32 s76, s76, s55
    s_cmp_lt_u32 s2, 224
    s_cselect_b32 s76, s76, 2130706432
    v_lshrrev_b32 v96, 7, v254
    buffer_load_dwordx4 v220, s[36:39], s94 offen offset:3072 lds
    s_add_u32 s94, s94, 256
    s_and_b32 s94, s94, 2047
    v_mul_u32_u24 v96, 7168, v96
    v_and_b32 v224, 0x70, v254
    s_add_u32 m0, s61, 32768
    s_mul_i32 s59, s93, 96
    buffer_load_dwordx4 v200, s[8:11], s59 offen lds
    v_add_u32 v96, v96, v224
    v_lshrrev_b32 v97, 6, v254
    v_mul_u32_u24 v97, 7168, v97
    buffer_load_dwordx4 v201, s[8:11], s59 offen offset:1024 lds
    v_lshrrev_b32 v224, 3, v254
    v_and_b32 v224, 0x20, v224
    buffer_load_dwordx4 v202, s[8:11], s59 offen offset:2048 lds
    s_add_u32 s93, s93, 2048
    s_and_b32 s93, s93, 65535
    v_and_b32 v225, 0x30, v254
    v_xor_b32 v224, v224, v225
    v_add_u32 v97, v97, v224
    s_cmp_lg_u32 s42, 1
    s_cbranch_scc1 hs_37
    v_mov_b32 v252, 0
    v_mov_b32 v253, 1
    s_lshl_b32 s55, s2, 2
    s_add_u32 s55, s55, 71565312
    s_mov_b64 exec, 1
    buffer_store_dword v253, v252, s[4:7], s55 offen sc0 sc1
    s_mov_b64 exec, -1
hs_37:
    s_waitcnt vmcnt(17)
    s_barrier
    s_add_u32 m0, s91, 116736
    s_mov_b64 exec, s[84:85]
    buffer_load_dwordx4 v221, s[36:39], s94 offen lds
    s_mov_b64 exec, -1
    s_add_u32 m0, s62, 118784
    s_nop 0
    buffer_load_dwordx4 v217, s[36:39], s94 offen lds
    buffer_load_dwordx4 v218, s[36:39], s94 offen offset:1024 lds
    s_add_u32 m0, s61, 49152
    s_mul_i32 s59, s93, 96
    buffer_load_dwordx4 v200, s[8:11], s59 offen lds
    buffer_load_dwordx4 v201, s[8:11], s59 offen offset:1024 lds
    buffer_load_dwordx4 v202, s[8:11], s59 offen offset:2048 lds
    s_add_u32 s93, s93, 6144
    s_and_b32 s93, s93, 65535
    s_getreg_b32 s77, hwreg(HW_REG_XCC_ID, 0, 4)
    s_mul_i32 s55, s77, s77
    s_lshl_b32 s55, s55, 15
    s_lshl_b32 s77, s77, 6
    s_add_u32 s77, s77, s55
    s_add_u32 s77, s77, 1
    s_waitcnt vmcnt(20)
    s_barrier
    s_add_u32 m0, s62, 118784
    s_nop 0
    buffer_load_dwordx4 v219, s[36:39], s94 offen offset:2048 lds
    buffer_load_dwordx4 v220, s[36:39], s94 offen offset:3072 lds
    s_add_u32 s94, s94, 256
    s_and_b32 s94, s94, 2047
    s_add_u32 m0, s61, 65536
    s_mul_i32 s59, s93, 96
    buffer_load_dwordx4 v200, s[8:11], s59 offen lds
    buffer_load_dwordx4 v201, s[8:11], s59 offen offset:1024 lds
    buffer_load_dwordx4 v202, s[8:11], s59 offen offset:2048 lds
    s_add_u32 s93, s93, 2048
    s_and_b32 s93, s93, 65535
    s_waitcnt vmcnt(14)
    s_barrier
    s_add_u32 m0, s91, 135168
    s_mov_b64 exec, s[84:85]
    buffer_load_dwordx4 v221, s[36:39], s94 offen lds
    s_mov_b64 exec, -1
    s_add_u32 m0, s62, 137216
    s_nop 0
    buffer_load_dwordx4 v217, s[36:39], s94 offen lds
    buffer_load_dwordx4 v218, s[36:39], s94 offen offset:1024 lds
    s_add_u32 m0, s61, 81920
    s_mul_i32 s59, s93, 96
    buffer_load_dwordx4 v200, s[8:11], s59 offen lds
    buffer_load_dwordx4 v201, s[8:11], s59 offen offset:1024 lds
    buffer_load_dwordx4 v202, s[8:11], s59 offen offset:2048 lds
    s_add_u32 s93, s93, 6144
    s_and_b32 s93, s93, 65535
    s_barrier
    s_add_u32 m0, s62, 137216
    s_nop 0
    buffer_load_dwordx4 v219, s[36:39], s94 offen offset:2048 lds
    buffer_load_dwordx4 v220, s[36:39], s94 offen offset:3072 lds
    s_add_u32 s94, s94, 256
    s_and_b32 s94, s94, 2047
    s_add_u32 m0, s61, 0
    s_mul_i32 s59, s93, 96
    buffer_load_dwordx4 v200, s[8:11], s59 offen lds
    buffer_load_dwordx4 v201, s[8:11], s59 offen offset:1024 lds
    buffer_load_dwordx4 v202, s[8:11], s59 offen offset:2048 lds
    s_add_u32 s93, s93, 2048
    s_and_b32 s93, s93, 65535
    s_waitcnt vmcnt(14)
    s_barrier
    s_add_u32 m0, s91, 98304
    s_mov_b64 exec, s[84:85]
    buffer_load_dwordx4 v221, s[36:39], s94 offen lds
    s_mov_b64 exec, -1
    s_add_u32 m0, s62, 100352
    s_nop 0
    buffer_load_dwordx4 v217, s[36:39], s94 offen lds
    buffer_load_dwordx4 v218, s[36:39], s94 offen offset:1024 lds
    s_add_u32 m0, s61, 16384
    s_mul_i32 s59, s93, 96
    buffer_load_dwordx4 v200, s[8:11], s59 offen lds
    buffer_load_dwordx4 v201, s[8:11], s59 offen offset:1024 lds
    buffer_load_dwordx4 v202, s[8:11], s59 offen offset:2048 lds
    s_add_u32 s93, s93, 6144
    s_and_b32 s93, s93, 65535
    s_barrier
    s_add_u32 m0, s62, 100352
    s_nop 0
    buffer_load_dwordx4 v219, s[36:39], s94 offen offset:2048 lds
    buffer_load_dwordx4 v220, s[36:39], s94 offen offset:3072 lds
    s_add_u32 s94, s94, 256
    s_and_b32 s94, s94, 2047
    s_lshr_b32 s55, s2, 3
    s_lshl_b32 s55, s55, 1
    s_add_u32 s55, s55, s44
    s_and_b32 s56, s2, 7
    s_lshl_b32 s78, s43, 3
    s_add_u32 s78, s78, s56
    s_lshl_b32 s78, s78, 7
    s_add_u32 s78, s78, s55
    s_lshl_b32 s78, s78, 10
    s_add_u32 s78, s78, 67108864
    s_mul_i32 s55, s55, 114688
    s_mul_i32 s56, s56, 896
    s_add_u32 s70, s55, s56
    s_add_u32 m0, s61, 32768
    s_mul_i32 s59, s93, 96
    buffer_load_dwordx4 v200, s[8:11], s59 offen lds
    buffer_load_dwordx4 v201, s[8:11], s59 offen offset:1024 lds
    buffer_load_dwordx4 v[64:67], v97, s[16:19], s70 offen offset:384
    buffer_load_dwordx4 v202, s[8:11], s59 offen offset:2048 lds
    s_add_u32 s93, s93, 2048
    s_and_b32 s93, s93, 65535
    buffer_load_dwordx4 v[68:71], v97, s[16:19], s70 offen offset:448
    s_waitcnt vmcnt(16)
    s_barrier
    s_add_u32 m0, s91, 116736
    s_mov_b64 exec, s[84:85]
    buffer_load_dwordx4 v221, s[36:39], s94 offen lds
    s_mov_b64 exec, -1
    s_add_u32 m0, s62, 118784
    s_nop 0
    buffer_load_dwordx4 v217, s[36:39], s94 offen lds
    buffer_load_dwordx4 v218, s[36:39], s94 offen offset:1024 lds
    s_add_u32 m0, s61, 49152
    s_mul_i32 s59, s93, 96
    buffer_load_dwordx4 v200, s[8:11], s59 offen lds
    buffer_load_dwordx4 v201, s[8:11], s59 offen offset:1024 lds
    buffer_load_dwordx4 v202, s[8:11], s59 offen offset:2048 lds
    s_add_u32 s93, s93, 10240
    s_and_b32 s93, s93, 65535
    s_barrier
    s_add_u32 m0, s62, 118784
    s_nop 0
    buffer_load_dwordx4 v219, s[36:39], s94 offen offset:2048 lds
    buffer_load_dwordx4 v220, s[36:39], s94 offen offset:3072 lds
    s_add_u32 s94, s94, 384
    s_and_b32 s94, s94, 2047
    s_add_u32 m0, s61, 65536
    s_mul_i32 s59, s93, 96
    buffer_load_dwordx4 v200, s[8:11], s59 offen lds
    buffer_load_dwordx4 v201, s[8:11], s59 offen offset:1024 lds
    buffer_load_dwordx4 v202, s[8:11], s59 offen offset:2048 lds
    s_add_u32 s93, s93, 2048
    s_and_b32 s93, s93, 65535
    buffer_load_dwordx4 v[0:3], v96, s[72:75], s76 offen
    s_add_u32 s76, s76, 57344
    s_waitcnt vmcnt(17)
    s_barrier
    s_add_u32 m0, s91, 135168
    s_mov_b64 exec, s[84:85]
    buffer_load_dwordx4 v221, s[36:39], s94 offen lds
    s_mov_b64 exec, -1
    s_add_u32 m0, s62, 137216
    s_nop 0
    buffer_load_dwordx4 v217, s[36:39], s94 offen lds
    buffer_load_dwordx4 v218, s[36:39], s94 offen offset:1024 lds
    s_add_u32 m0, s61, 81920
    s_mul_i32 s59, s93, 96
    buffer_load_dwordx4 v200, s[8:11], s59 offen lds
    buffer_load_dwordx4 v201, s[8:11], s59 offen offset:1024 lds
    buffer_load_dwordx4 v202, s[8:11], s59 offen offset:2048 lds
    s_add_u32 s93, s93, 6144
    s_and_b32 s93, s93, 65535
    buffer_load_dwordx4 v[4:7], v96, s[72:75], s76 offen
    s_add_u32 s76, s76, 57344
    s_barrier
    s_waitcnt vmcnt(19)
    s_add_u32 m0, s62, 137216
    s_nop 0
    buffer_load_dwordx4 v219, s[36:39], s94 offen offset:2048 lds
    buffer_load_dwordx4 v220, s[36:39], s94 offen offset:3072 lds
    s_add_u32 s94, s94, 256
    s_and_b32 s94, s94, 2047
    s_add_u32 m0, s61, 0
    s_mul_i32 s59, s93, 96
    buffer_load_dwordx4 v200, s[8:11], s59 offen lds
    buffer_store_dwordx4 v[64:67], v254, s[4:7], s78 offen sc0 sc1
    s_add_u32 s78, s78, 65536
    buffer_load_dwordx4 v201, s[8:11], s59 offen offset:1024 lds
    buffer_load_dwordx4 v202, s[8:11], s59 offen offset:2048 lds
    s_add_u32 s93, s93, 2048
    s_and_b32 s93, s93, 65535
    buffer_store_dwordx4 v[68:71], v254, s[4:7], s78 offen sc0 sc1
    s_add_u32 s78, s78, 65536
    buffer_load_dwordx4 v[8:11], v96, s[72:75], s76 offen
    s_add_u32 s76, s76, 57344
    s_waitcnt vmcnt(19)
    s_barrier
    v_lshlrev_b32 v227, 1, v254
    v_and_b32 v227, 0xff, v227
    buffer_load_dword v98, v227, s[32:35], 0 offen sc0 sc1
    s_add_u32 m0, s91, 98304
    s_mov_b64 exec, s[84:85]
    buffer_load_dwordx4 v221, s[36:39], s94 offen lds
    s_mov_b64 exec, -1
    s_add_u32 m0, s62, 100352
    s_nop 0
    buffer_load_dwordx4 v217, s[36:39], s94 offen lds
    buffer_load_dwordx4 v218, s[36:39], s94 offen offset:1024 lds
    s_add_u32 m0, s61, 16384
    s_mul_i32 s59, s93, 96
    buffer_load_dwordx4 v200, s[8:11], s59 offen lds
    buffer_load_dwordx4 v201, s[8:11], s59 offen offset:1024 lds
    buffer_load_dwordx4 v202, s[8:11], s59 offen offset:2048 lds
    s_add_u32 s93, s93, 6144
    s_and_b32 s93, s93, 65535
    buffer_load_dwordx4 v[12:15], v96, s[72:75], s76 offen
    s_add_u32 s76, s76, 57344
    s_barrier
    s_add_u32 m0, s62, 100352
    s_nop 0
    buffer_load_dwordx4 v219, s[36:39], s94 offen offset:2048 lds
    buffer_load_dwordx4 v220, s[36:39], s94 offen offset:3072 lds
    s_add_u32 s94, s94, 256
    s_and_b32 s94, s94, 2047
    s_add_u32 m0, s61, 32768
    s_mul_i32 s59, s93, 96
    buffer_load_dwordx4 v200, s[8:11], s59 offen lds
    buffer_load_dwordx4 v201, s[8:11], s59 offen offset:1024 lds
    buffer_load_dwordx4 v202, s[8:11], s59 offen offset:2048 lds
    s_add_u32 s93, s93, 2048
    s_and_b32 s93, s93, 65535
    buffer_load_dwordx4 v[16:19], v96, s[72:75], s76 offen
    s_add_u32 s76, s76, 57344
    s_waitcnt vmcnt(20)
    s_barrier
    s_add_u32 m0, s91, 116736
    s_mov_b64 exec, s[84:85]
    buffer_load_dwordx4 v221, s[36:39], s94 offen lds
    s_mov_b64 exec, -1
    s_add_u32 m0, s62, 118784
    s_nop 0
    buffer_load_dwordx4 v217, s[36:39], s94 offen lds
    buffer_load_dwordx4 v218, s[36:39], s94 offen offset:1024 lds
    s_add_u32 m0, s61, 49152
    s_mul_i32 s59, s93, 96
    buffer_load_dwordx4 v200, s[8:11], s59 offen lds
    buffer_load_dwordx4 v201, s[8:11], s59 offen offset:1024 lds
    buffer_load_dwordx4 v202, s[8:11], s59 offen offset:2048 lds
    s_add_u32 s93, s93, 6144
    s_and_b32 s93, s93, 65535
    buffer_load_dwordx4 v[20:23], v96, s[72:75], s76 offen
    s_add_u32 s76, s76, 57344
    s_barrier
    s_waitcnt vmcnt(20)
    s_mov_b32 s56, 262144
hs_38:
    v_and_b32 v225, 63, v98
    v_cmp_ne_u32 vcc, 32, v225
    s_cbranch_vccz hs_39
    buffer_load_dword v98, v227, s[32:35], 0 offen sc0 sc1
    s_waitcnt vmcnt(0)
    s_sub_u32 s56, s56, 1
    s_cmp_lg_u32 s56, 0
    s_cbranch_scc1 hs_38
hs_39:
    s_mov_b32 s55, 71565312
    buffer_load_dwordx4 v[72:75], v254, s[4:7], s55 offen sc0 sc1
    s_add_u32 m0, s62, 118784
    s_nop 0
    buffer_load_dwordx4 v219, s[36:39], s94 offen offset:2048 lds
    buffer_load_dwordx4 v220, s[36:39], s94 offen offset:3072 lds
    s_add_u32 s94, s94, 256
    s_and_b32 s94, s94, 2047
    s_add_u32 m0, s61, 65536
    s_mul_i32 s59, s93, 96
    buffer_load_dwordx4 v200, s[8:11], s59 offen lds
    buffer_load_dwordx4 v201, s[8:11], s59 offen offset:1024 lds
    buffer_load_dwordx4 v202, s[8:11], s59 offen offset:2048 lds
    s_add_u32 s93, s93, 2048
    s_and_b32 s93, s93, 65535
    s_and_b32 s55, s2, 7
    s_lshl_b32 s56, s77, 5
    v_readlane_b32 s55, v98, s55
    s_nop 3
    s_cmp_lg_u32 s55, s56
    s_cselect_b32 s45, 1, 0
    v_mov_b32 v224, 163712
    v_mov_b32 v225, s45
    ds_write_b32 v224, v225
    buffer_load_dwordx4 v[24:27], v96, s[72:75], s76 offen
    s_add_u32 s76, s76, 57344
    s_waitcnt vmcnt(18)
    s_barrier
    s_add_u32 m0, s91, 135168
    s_mov_b64 exec, s[84:85]
    buffer_load_dwordx4 v221, s[36:39], s94 offen lds
    s_mov_b64 exec, -1
    v_and_b32 v226, 0xf0, v254
    s_add_u32 m0, s62, 137216
    s_nop 0
    buffer_load_dwordx4 v217, s[36:39], s94 offen lds
    v_min_u32 v226, 0xb0, v226
    s_mul_i32 s55, s42, 192
    v_add_u32 v226, s55, v226
    buffer_load_dwordx4 v218, s[36:39], s94 offen offset:1024 lds
    v_lshrrev_b32 v224, 8, v226
    s_add_u32 m0, s61, 81920
    s_mul_i32 s59, s93, 96
    buffer_load_dwordx4 v200, s[8:11], s59 offen lds
    v_and_b32 v225, 0xff, v226
    v_lshl_add_u32 v224, v224, 12, v225
    buffer_load_dwordx4 v201, s[8:11], s59 offen offset:1024 lds
    v_lshrrev_b32 v225, 8, v254
    buffer_load_dwordx4 v202, s[8:11], s59 offen offset:2048 lds
    s_add_u32 s93, s93, 6144
    s_and_b32 s93, s93, 65535
    v_mul_u32_u24 v225, 12288, v225
    v_add_u32 v227, v224, v225
    buffer_load_dwordx4 v[28:31], v96, s[72:75], s76 offen
    s_add_u32 s76, s76, 57344
    s_barrier
    s_add_u32 m0, s62, 137216
    s_nop 0
    buffer_load_dwordx4 v219, s[36:39], s94 offen offset:2048 lds
    buffer_load_dwordx4 v220, s[36:39], s94 offen offset:3072 lds
    s_add_u32 s94, s94, 256
    s_and_b32 s94, s94, 2047
    s_add_u32 m0, s61, 0
    s_mul_i32 s59, s93, 96
    buffer_load_dwordx4 v200, s[8:11], s59 offen lds
    buffer_load_dwordx4 v201, s[8:11], s59 offen offset:1024 lds
    buffer_load_dwordx4 v202, s[8:11], s59 offen offset:2048 lds
    s_add_u32 s93, s93, 2048
    s_and_b32 s93, s93, 65535
    buffer_load_dwordx4 v[32:35], v96, s[72:75], s76 offen
    s_add_u32 s76, s76, 57344
    s_waitcnt vmcnt(17)
    s_barrier
    v_and_b32 v72, v72, v73
    v_and_b32 v74, v74, v75
    v_and_b32 v72, v72, v74
    v_cmp_ne_u32 vcc, 1, v72
    s_cbranch_vccz a4_40
    s_mov_b32 s55, 71565312
    s_mov_b32 s56, 262144
p4_41:
    buffer_load_dwordx4 v[72:75], v254, s[4:7], s55 offen sc0 sc1
    s_waitcnt vmcnt(0)
    v_and_b32 v72, v72, v73
    v_and_b32 v74, v74, v75
    v_and_b32 v72, v72, v74
    v_cmp_ne_u32 vcc, 1, v72
    s_cbranch_vccz p4_42
    s_sleep 1
    s_sub_u32 s56, s56, 1
    s_cmp_lg_u32 s56, 0
    s_cbranch_scc1 p4_41
p4_42:
a4_40:
    s_add_u32 m0, s91, 98304
    s_mov_b64 exec, s[84:85]
    buffer_load_dwordx4 v221, s[36:39], s94 offen lds
    s_mov_b64 exec, -1
    s_add_u32 m0, s62, 100352
    s_nop 0
    buffer_load_dwordx4 v217, s[36:39], s94 offen lds
    v_lshrrev_b32 v224, 1, v254
    s_lshl_b32 s55, s40, 10
    s_mul_i32 s56, s42, 288
    s_add_u32 s55, s55, s56
    s_add_u32 s55, s55, 70254464
    buffer_load_dwordx2 v[72:73], v224, s[4:7], s55 offen sc1
    s_lshl_b32 s70, s51, 8
    s_add_u32 s70, s70, 70516736
    buffer_load_dwordx4 v218, s[36:39], s94 offen offset:1024 lds
    s_add_u32 m0, s61, 16384
    s_mul_i32 s59, s93, 96
    buffer_load_dwordx4 v200, s[8:11], s59 offen lds
    buffer_load_dwordx4 v[76:79], v227, s[4:7], s70 offen sc1
    s_add_u32 s70, s70, 49152
    buffer_load_dwordx4 v201, s[8:11], s59 offen offset:1024 lds
    buffer_load_dwordx4 v202, s[8:11], s59 offen offset:2048 lds
    s_add_u32 s93, s93, 6144
    s_and_b32 s93, s93, 65535
    buffer_load_dwordx4 v[80:83], v227, s[4:7], s70 offen sc1
    s_add_u32 s70, s70, 49152
    buffer_load_dwordx4 v[36:39], v96, s[72:75], s76 offen
    s_add_u32 s76, s76, 57344
    s_barrier
    s_add_u32 m0, s62, 100352
    s_nop 0
    buffer_load_dwordx4 v219, s[36:39], s94 offen offset:2048 lds
    buffer_load_dwordx4 v220, s[36:39], s94 offen offset:3072 lds
    s_add_u32 s94, s94, 256
    s_and_b32 s94, s94, 2047
    s_add_u32 m0, s61, 32768
    s_mul_i32 s59, s93, 96
    buffer_load_dwordx4 v200, s[8:11], s59 offen lds
    buffer_load_dwordx4 v[84:87], v227, s[4:7], s70 offen sc1
    s_add_u32 s70, s70, 49152
    buffer_load_dwordx4 v201, s[8:11], s59 offen offset:1024 lds
    buffer_load_dwordx4 v202, s[8:11], s59 offen offset:2048 lds
    s_add_u32 s93, s93, 2048
    s_and_b32 s93, s93, 65535
    buffer_load_dwordx4 v[88:91], v227, s[4:7], s70 offen sc1
    s_add_u32 s70, s70, 49152
    buffer_load_dwordx4 v[40:43], v96, s[72:75], s76 offen
    s_add_u32 s76, s76, 57344
    s_waitcnt vmcnt(22)
    s_barrier
    s_add_u32 m0, s91, 116736
    s_mov_b64 exec, s[84:85]
    buffer_load_dwordx4 v221, s[36:39], s94 offen lds
    s_mov_b64 exec, -1
    s_add_u32 m0, s62, 118784
    s_nop 0
    buffer_load_dwordx4 v217, s[36:39], s94 offen lds
    buffer_load_dwordx4 v218, s[36:39], s94 offen offset:1024 lds
    s_add_u32 m0, s61, 49152
    s_mul_i32 s59, s93, 96
    buffer_load_dwordx4 v200, s[8:11], s59 offen lds
    buffer_load_dwordx4 v201, s[8:11], s59 offen offset:1024 lds
    buffer_load_dwordx4 v202, s[8:11], s59 offen offset:2048 lds
    s_add_u32 s93, s93, 6144
    s_and_b32 s93, s93, 65535
    buffer_load_dwordx4 v[44:47], v96, s[72:75], s76 offen
    s_add_u32 s76, s76, 57344
    s_barrier
    s_add_u32 m0, s62, 118784
    s_nop 0
    buffer_load_dwordx4 v219, s[36:39], s94 offen offset:2048 lds
    buffer_load_dwordx4 v220, s[36:39], s94 offen offset:3072 lds
    s_add_u32 s94, s94, 256
    s_and_b32 s94, s94, 2047
    s_add_u32 m0, s61, 65536
    s_mul_i32 s59, s93, 96
    buffer_load_dwordx4 v200, s[8:11], s59 offen lds
    buffer_load_dwordx4 v201, s[8:11], s59 offen offset:1024 lds
    buffer_load_dwordx4 v202, s[8:11], s59 offen offset:2048 lds
    s_add_u32 s93, s93, 2048
    s_and_b32 s93, s93, 65535
    buffer_load_dwordx4 v[48:51], v96, s[72:75], s76 offen
    s_add_u32 s76, s76, 57344
    s_waitcnt vmcnt(19)
    s_barrier
    s_add_u32 m0, s91, 135168
    s_mov_b64 exec, s[84:85]
    buffer_load_dwordx4 v221, s[36:39], s94 offen lds
    s_mov_b64 exec, -1
    s_or_b32 s55, s40, s42
    s_cmp_eq_u32 s55, 0
    s_cselect_b32 s70, 0xffff, 0
    s_mov_b32 s71, 0
    v_cndmask_b32 v72, v72, 0, s[70:71]
    v_cndmask_b32 v73, v73, 0, s[70:71]
    v_mul_f32 v72, 0x3a800000, v72
    v_mul_f32 v73, 0x3a800000, v73
    s_add_u32 m0, s62, 137216
    s_nop 0
    buffer_load_dwordx4 v217, s[36:39], s94 offen lds
    v_fma_f32 v73, -v72, v72, v73
    v_max_f32 v73, 0, v73
    v_cvt_pk_bf16_f32 v72, v72, v72
    buffer_load_dwordx4 v218, s[36:39], s94 offen offset:1024 lds
    v_lshlrev_b32 v72, 16, v72
    v_cvt_pk_bf16_f32 v73, v73, v73
    v_lshlrev_b32 v73, 16, v73
    s_add_u32 m0, s61, 81920
    s_mul_i32 s59, s93, 96
    buffer_load_dwordx4 v200, s[8:11], s59 offen lds
    v_add_f32 v73, 0x3727c5ac, v73
    v_cvt_pk_bf16_f32 v73, v73, v73
    v_lshlrev_b32 v73, 16, v73
    buffer_load_dwordx4 v201, s[8:11], s59 offen offset:1024 lds
    v_sqrt_f32 v73, v73
    s_nop 0
    v_cvt_pk_bf16_f32 v73, v73, v73
    buffer_load_dwordx4 v202, s[8:11], s59 offen offset:2048 lds
    s_add_u32 s93, s93, 6144
    s_and_b32 s93, s93, 65535
    v_lshlrev_b32 v73, 16, v73
    v_rcp_f32 v73, v73
    s_nop 0
    buffer_load_dwordx4 v[52:55], v96, s[72:75], s76 offen
    s_add_u32 s76, s76, 57344
    s_barrier
    s_waitcnt vmcnt(21)
    s_add_u32 m0, s62, 137216
    s_nop 0
    buffer_load_dwordx4 v219, s[36:39], s94 offen offset:2048 lds
    v_lshrrev_b32 v224, 2, v254
    s_mul_i32 s55, s42, 144
    s_add_u32 s55, s55, 159744
    v_add_u32 v224, s55, v224
    v_sub_f32 v72, 0, v72
    s_mov_b32 s70, -1
    s_mov_b32 s71, 0xf
    s_mov_b64 exec, s[70:71]
    ds_write_b32 v224, v72
    ds_write_b32 v224, v73 offset:576
    s_mov_b64 exec, -1
    v_add_f32 v76, v76, v80
    buffer_load_dwordx4 v220, s[36:39], s94 offen offset:3072 lds
    s_add_u32 s94, s94, 256
    s_and_b32 s94, s94, 2047
    v_add_f32 v77, v77, v81
    v_add_f32 v78, v78, v82
    v_add_f32 v79, v79, v83
    s_add_u32 m0, s61, 0
    s_mul_i32 s59, s93, 96
    buffer_load_dwordx4 v200, s[8:11], s59 offen lds
    v_add_f32 v84, v84, v88
    v_add_f32 v85, v85, v89
    buffer_load_dwordx4 v201, s[8:11], s59 offen offset:1024 lds
    v_add_f32 v86, v86, v90
    v_add_f32 v87, v87, v91
    v_add_f32 v76, v76, v84
    buffer_load_dwordx4 v202, s[8:11], s59 offen offset:2048 lds
    s_add_u32 s93, s93, 2048
    s_and_b32 s93, s93, 65535
    v_add_f32 v77, v77, v85
    v_add_f32 v78, v78, v86
    v_add_f32 v79, v79, v87
    buffer_load_dwordx4 v[56:59], v96, s[72:75], s76 offen
    s_add_u32 s76, s76, 57344
    s_waitcnt vmcnt(17)
    s_barrier
    s_add_u32 m0, s91, 98304
    s_mov_b64 exec, s[84:85]
    buffer_load_dwordx4 v221, s[36:39], s94 offen lds
    s_mov_b64 exec, -1
    v_mov_b32 v80, v76
    v_mov_b32 v81, v77
    v_mov_b32 v82, v78
    v_mov_b32 v83, v79
    s_add_u32 m0, s62, 100352
    s_nop 0
    buffer_load_dwordx4 v217, s[36:39], s94 offen lds
    s_nop 1
    v_permlane16_swap_b32 v76, v80
    v_permlane16_swap_b32 v77, v81
    v_permlane16_swap_b32 v78, v82
    v_permlane16_swap_b32 v79, v83
    buffer_load_dwordx4 v218, s[36:39], s94 offen offset:1024 lds
    v_add_f32 v76, v76, v80
    v_add_f32 v77, v77, v81
    v_add_f32 v78, v78, v82
    v_add_f32 v79, v79, v83
    v_mov_b32 v80, v76
    s_add_u32 m0, s61, 16384
    s_mul_i32 s59, s93, 96
    buffer_load_dwordx4 v200, s[8:11], s59 offen lds
    v_mov_b32 v81, v77
    v_mov_b32 v82, v78
    v_mov_b32 v83, v79
    s_nop 1
    buffer_load_dwordx4 v201, s[8:11], s59 offen offset:1024 lds
    v_permlane32_swap_b32 v76, v80
    v_permlane32_swap_b32 v77, v81
    v_permlane32_swap_b32 v78, v82
    v_permlane32_swap_b32 v79, v83
    v_add_f32 v76, v76, v80
    buffer_load_dwordx4 v202, s[8:11], s59 offen offset:2048 lds
    v_add_f32 v77, v77, v81
    v_add_f32 v78, v78, v82
    v_add_f32 v79, v79, v83
    v_add_u32 v226, 160896, v226
    ds_write_b128 v226, v[76:79]
    buffer_load_dwordx4 v[60:63], v96, s[72:75], s76 offen
    s_add_u32 s76, s76, 57344
    s_barrier
    s_add_u32 m0, s62, 100352
    s_nop 0
    buffer_load_dwordx4 v219, s[36:39], s94 offen offset:2048 lds
    buffer_load_dwordx4 v220, s[36:39], s94 offen offset:3072 lds
    s_lshl_b32 s93, s43, 1
    s_add_u32 s93, s51, s93
    s_and_b32 s93, s93, 15
    s_add_u32 m0, s62, 32768
    s_lshl_b32 s93, s93, 17
    buffer_load_dwordx4 v203, s[12:15], s93 offen lds
    buffer_load_dwordx4 v204, s[12:15], s93 offen offset:1024 lds
    buffer_load_dwordx4 v205, s[12:15], s93 offen offset:2048 lds
    buffer_load_dwordx4 v206, s[12:15], s93 offen offset:3072 lds
    s_add_u32 s93, s93, 524288
    s_and_b32 s93, s93, 2097151
    s_waitcnt vmcnt(17)
    s_barrier
    s_add_u32 m0, s62, 49152
    s_nop 0
    buffer_load_dwordx4 v203, s[12:15], s93 offen lds
    buffer_load_dwordx4 v204, s[12:15], s93 offen offset:1024 lds
    buffer_load_dwordx4 v205, s[12:15], s93 offen offset:2048 lds
    buffer_load_dwordx4 v206, s[12:15], s93 offen offset:3072 lds
    s_add_u32 s93, s93, 524288
    s_and_b32 s93, s93, 2097151
    s_barrier
    s_add_u32 m0, s62, 65536
    s_nop 0
    buffer_load_dwordx4 v203, s[12:15], s93 offen lds
    buffer_load_dwordx4 v204, s[12:15], s93 offen offset:1024 lds
    buffer_load_dwordx4 v205, s[12:15], s93 offen offset:2048 lds
    buffer_load_dwordx4 v206, s[12:15], s93 offen offset:3072 lds
    s_add_u32 s93, s93, 524288
    s_and_b32 s93, s93, 2097151
    s_waitcnt vmcnt(12)
    s_barrier
    s_add_u32 m0, s62, 81920
    s_nop 0
    buffer_load_dwordx4 v203, s[12:15], s93 offen lds
    buffer_load_dwordx4 v204, s[12:15], s93 offen offset:1024 lds
    buffer_load_dwordx4 v205, s[12:15], s93 offen offset:2048 lds
    buffer_load_dwordx4 v206, s[12:15], s93 offen offset:3072 lds
    s_add_u32 s93, s93, 655360
    s_and_b32 s93, s93, 2097151
    s_barrier
    s_add_u32 m0, s62, 0
    s_nop 0
    buffer_load_dwordx4 v203, s[12:15], s93 offen lds
    buffer_load_dwordx4 v204, s[12:15], s93 offen offset:1024 lds
    buffer_load_dwordx4 v205, s[12:15], s93 offen offset:2048 lds
    buffer_load_dwordx4 v206, s[12:15], s93 offen offset:3072 lds
    s_add_u32 s93, s93, 524288
    s_and_b32 s93, s93, 2097151
    s_waitcnt lgkmcnt(0)
    s_barrier
    s_add_u32 m0, s62, 16384
    s_nop 0
    buffer_load_dwordx4 v203, s[12:15], s93 offen lds
    buffer_load_dwordx4 v204, s[12:15], s93 offen offset:1024 lds
    buffer_load_dwordx4 v205, s[12:15], s93 offen offset:2048 lds
    buffer_load_dwordx4 v206, s[12:15], s93 offen offset:3072 lds
    s_add_u32 s93, s93, 524288
    s_and_b32 s93, s93, 2097151
    s_setprio 0
    s_branch Y_g2
Y_layer:
    s_mov_b32 s36, s4
    s_mov_b32 s37, s5
    s_mov_b32 s38, s6
    s_mov_b32 s39, s7
    s_add_u32 s88, s48, s62
    s_lshl_b32 s56, s43, 10
    s_add_u32 s89, s48, s56
    s_sub_u32 s89, s89, 4179968
    v_add_u32 v217, s88, v254
    s_lshl_b32 s94, s51, 14
    s_cmp_eq_u32 s40, 0
    s_cselect_b32 s89, 2130706432, s89
    s_sub_u32 s89, s89, s88
    v_add_u32 v221, s89, v217
    s_lshl_b32 s91, s43, 10
    s_cmp_eq_u32 s44, 0
    s_cselect_b32 s84, -1, 0
    s_not_b32 s85, s84
    s_add_u32 s59, s0, 4294967232
    s_add_u32 s60, s54, 8064
    s_and_b32 s55, s40, 3
    s_cselect_b32 s59, s59, s60
    s_cselect_b32 s60, 28, 60
    s_add_u32 s55, s0, 64
    s_cmp_eq_u32 s40, 0
    s_cselect_b32 s59, s55, s59
    s_cselect_b32 s60, 28, s60
    v_lshrrev_b32 v224, 2, v254
    v_and_b32 v224, 60, v224
    v_min_u32 v225, s60, v224
    v_add_u32 v225, s59, v225
    v_min_u32 v224, 28, v224
    v_add_u32 v224, s55, v224
    v_cmp_gt_u32 vcc, 256, v254
    v_lshlrev_b32 v226, 3, v254
    v_and_b32 v226, 0xfff, v226
    v_cndmask_b32 v224, v225, v224, vcc
    s_add_u32 s92, s88, s94
    s_barrier
    buffer_load_dword v251, v226, s[4:7], s92 offen sc0 sc1
    s_mov_b32 s56, 262144
poll_43:
    buffer_load_dword v225, v224, s[4:7], 0 offen sc0 sc1
    s_waitcnt vmcnt(0)
    v_cmp_ne_u32 vcc, 0x01010101, v225
    s_cbranch_vccz pd_44
    s_sleep 1
    s_sub_u32 s56, s56, 1
    s_cmp_lg_u32 s56, 0
    s_cbranch_scc1 poll_43
pd_44:
    s_add_u32 m0, s91, 98304
    s_mov_b64 exec, s[84:85]
    buffer_load_dwordx4 v221, s[36:39], s94 offen lds
    s_mov_b64 exec, -1
    s_add_u32 m0, s62, 100352
    s_nop 0
    buffer_load_dwordx4 v217, s[36:39], s94 offen lds
    buffer_load_dwordx4 v217, s[36:39], s94 offen offset:1024 lds
    buffer_load_dwordx4 v217, s[36:39], s94 offen offset:2048 lds
    buffer_load_dwordx4 v217, s[36:39], s94 offen offset:3072 lds
    s_add_u32 s94, s94, 32768
    s_and_b32 s94, s94, 262143
    s_add_u32 m0, s91, 116736
    s_mov_b64 exec, s[84:85]
    buffer_load_dwordx4 v221, s[36:39], s94 offen lds
    s_mov_b64 exec, -1
    s_add_u32 m0, s62, 118784
    s_nop 0
    buffer_load_dwordx4 v217, s[36:39], s94 offen lds
    buffer_load_dwordx4 v217, s[36:39], s94 offen offset:1024 lds
    buffer_load_dwordx4 v217, s[36:39], s94 offen offset:2048 lds
    buffer_load_dwordx4 v217, s[36:39], s94 offen offset:3072 lds
    s_add_u32 s94, s94, 32768
    s_and_b32 s94, s94, 262143
    s_add_u32 m0, s91, 135168
    s_mov_b64 exec, s[84:85]
    buffer_load_dwordx4 v221, s[36:39], s94 offen lds
    s_mov_b64 exec, -1
    s_add_u32 m0, s62, 137216
    s_nop 0
    buffer_load_dwordx4 v217, s[36:39], s94 offen lds
    buffer_load_dwordx4 v217, s[36:39], s94 offen offset:1024 lds
    buffer_load_dwordx4 v217, s[36:39], s94 offen offset:2048 lds
    buffer_load_dwordx4 v217, s[36:39], s94 offen offset:3072 lds
    s_add_u32 s94, s94, 32768
    s_and_b32 s94, s94, 262143
    s_setprio 1
    s_waitcnt vmcnt(10)
    s_barrier
    s_barrier
    s_add_u32 m0, s61, 0
    s_mul_i32 s59, s93, 96
    buffer_load_dwordx4 v200, s[8:11], s59 offen lds
    buffer_load_dwordx4 v201, s[8:11], s59 offen offset:1024 lds
    buffer_load_dwordx4 v202, s[8:11], s59 offen offset:2048 lds
    s_add_u32 s93, s93, 2048
    s_and_b32 s93, s93, 65535
    s_waitcnt vmcnt(8)
    s_barrier
    s_add_u32 m0, s91, 98304
    s_mov_b64 exec, s[84:85]
    buffer_load_dwordx4 v221, s[36:39], s94 offen lds
    s_mov_b64 exec, -1
    s_add_u32 m0, s62, 100352
    s_nop 0
    buffer_load_dwordx4 v217, s[36:39], s94 offen lds
    buffer_load_dwordx4 v217, s[36:39], s94 offen offset:1024 lds
    s_add_u32 m0, s61, 16384
    s_mul_i32 s59, s93, 96
    buffer_load_dwordx4 v200, s[8:11], s59 offen lds
    buffer_load_dwordx4 v201, s[8:11], s59 offen offset:1024 lds
    buffer_load_dwordx4 v202, s[8:11], s59 offen offset:2048 lds
    s_add_u32 s93, s93, 6144
    s_and_b32 s93, s93, 65535
    s_barrier
    s_add_u32 m0, s62, 100352
    s_nop 0
    buffer_load_dwordx4 v217, s[36:39], s94 offen offset:2048 lds
    buffer_load_dwordx4 v217, s[36:39], s94 offen offset:3072 lds
    s_add_u32 s94, s94, 32768
    s_and_b32 s94, s94, 262143
    s_add_u32 m0, s61, 32768
    s_mul_i32 s59, s93, 96
    buffer_load_dwordx4 v200, s[8:11], s59 offen lds
    buffer_load_dwordx4 v201, s[8:11], s59 offen offset:1024 lds
    buffer_load_dwordx4 v202, s[8:11], s59 offen offset:2048 lds
    s_add_u32 s93, s93, 2048
    s_and_b32 s93, s93, 65535
    s_cmp_lg_u32 s42, 0
    s_cbranch_scc1 wf_45
    s_lshl_b32 s55, s51, 2
    s_add_u32 s55, s55, s54
    v_mov_b32 v252, 14336
    v_mov_b32 v253, 0x01010101
    s_mov_b64 exec, 1
    buffer_store_dword v253, v252, s[4:7], s55 offen sc0 sc1
    s_mov_b64 exec, -1
wf_45:
    s_waitcnt vmcnt(14)
    s_barrier
    s_add_u32 m0, s91, 116736
    s_mov_b64 exec, s[84:85]
    buffer_load_dwordx4 v221, s[36:39], s94 offen lds
    s_mov_b64 exec, -1
    s_add_u32 m0, s62, 118784
    s_nop 0
    buffer_load_dwordx4 v217, s[36:39], s94 offen lds
    buffer_load_dwordx4 v217, s[36:39], s94 offen offset:1024 lds
    s_add_u32 m0, s61, 49152
    s_mul_i32 s59, s93, 96
    buffer_load_dwordx4 v200, s[8:11], s59 offen lds
    buffer_load_dwordx4 v201, s[8:11], s59 offen offset:1024 lds
    buffer_load_dwordx4 v202, s[8:11], s59 offen offset:2048 lds
    s_add_u32 s93, s93, 6144
    s_and_b32 s93, s93, 65535
    s_barrier
    s_add_u32 m0, s62, 118784
    s_nop 0
    buffer_load_dwordx4 v217, s[36:39], s94 offen offset:2048 lds
    buffer_load_dwordx4 v217, s[36:39], s94 offen offset:3072 lds
    s_add_u32 s94, s94, 32768
    s_and_b32 s94, s94, 262143
    s_add_u32 m0, s61, 65536
    s_mul_i32 s59, s93, 96
    buffer_load_dwordx4 v200, s[8:11], s59 offen lds
    buffer_load_dwordx4 v201, s[8:11], s59 offen offset:1024 lds
    buffer_load_dwordx4 v202, s[8:11], s59 offen offset:2048 lds
    s_add_u32 s93, s93, 2048
    s_and_b32 s93, s93, 65535
    s_waitcnt vmcnt(14)
    s_barrier
    s_add_u32 m0, s91, 135168
    s_mov_b64 exec, s[84:85]
    buffer_load_dwordx4 v221, s[36:39], s94 offen lds
    s_mov_b64 exec, -1
    s_add_u32 m0, s62, 137216
    s_nop 0
    buffer_load_dwordx4 v217, s[36:39], s94 offen lds
    buffer_load_dwordx4 v217, s[36:39], s94 offen offset:1024 lds
    s_add_u32 m0, s61, 81920
    s_mul_i32 s59, s93, 96
    buffer_load_dwordx4 v200, s[8:11], s59 offen lds
    buffer_load_dwordx4 v201, s[8:11], s59 offen offset:1024 lds
    buffer_load_dwordx4 v202, s[8:11], s59 offen offset:2048 lds
    s_add_u32 s93, s93, 6144
    s_and_b32 s93, s93, 65535
    s_barrier
    s_add_u32 m0, s62, 137216
    s_nop 0
    buffer_load_dwordx4 v217, s[36:39], s94 offen offset:2048 lds
    buffer_load_dwordx4 v217, s[36:39], s94 offen offset:3072 lds
    s_add_u32 s94, s94, 32768
    s_and_b32 s94, s94, 262143
    s_add_u32 m0, s61, 0
    s_mul_i32 s59, s93, 96
    buffer_load_dwordx4 v200, s[8:11], s59 offen lds
    buffer_load_dwordx4 v201, s[8:11], s59 offen offset:1024 lds
    buffer_load_dwordx4 v202, s[8:11], s59 offen offset:2048 lds
    s_add_u32 s93, s93, 2048
    s_and_b32 s93, s93, 65535
    s_waitcnt vmcnt(14)
    s_barrier
    v_lshrrev_b32 v224, 2, v254
    v_and_b32 v225, 64, v224
    v_and_b32 v224, 60, v224
    s_cmp_eq_u32 s40, 0
    s_cselect_b32 s55, 0, 2
    v_mul_lo_u32 v225, v225, s55
    v_sub_u32 v98, v224, v225
    v_add_u32 v98, 14336, v98
    buffer_load_dword v251, v98, s[4:7], s54 offen sc0 sc1
    s_add_u32 m0, s91, 98304
    s_mov_b64 exec, s[84:85]
    buffer_load_dwordx4 v221, s[36:39], s94 offen lds
    s_mov_b64 exec, -1
    s_add_u32 m0, s62, 100352
    s_nop 0
    buffer_load_dwordx4 v217, s[36:39], s94 offen lds
    buffer_load_dwordx4 v217, s[36:39], s94 offen offset:1024 lds
    s_add_u32 m0, s61, 16384
    s_mul_i32 s59, s93, 96
    buffer_load_dwordx4 v200, s[8:11], s59 offen lds
    buffer_load_dwordx4 v201, s[8:11], s59 offen offset:1024 lds
    buffer_load_dwordx4 v202, s[8:11], s59 offen offset:2048 lds
    s_add_u32 s93, s93, 6144
    s_and_b32 s93, s93, 65535
    s_barrier
    s_add_u32 m0, s62, 100352
    s_nop 0
    buffer_load_dwordx4 v217, s[36:39], s94 offen offset:2048 lds
    buffer_load_dwordx4 v217, s[36:39], s94 offen offset:3072 lds
    s_add_u32 s94, s94, 32768
    s_and_b32 s94, s94, 262143
    s_add_u32 m0, s61, 32768
    s_mul_i32 s59, s93, 96
    buffer_load_dwordx4 v200, s[8:11], s59 offen lds
    buffer_load_dwordx4 v201, s[8:11], s59 offen offset:1024 lds
    buffer_load_dwordx4 v202, s[8:11], s59 offen offset:2048 lds
    s_add_u32 s93, s93, 2048
    s_and_b32 s93, s93, 65535
    s_waitcnt vmcnt(15)
    s_barrier
    s_add_u32 m0, s91, 116736
    s_mov_b64 exec, s[84:85]
    buffer_load_dwordx4 v221, s[36:39], s94 offen lds
    s_mov_b64 exec, -1
    s_add_u32 m0, s62, 118784
    s_nop 0
    buffer_load_dwordx4 v217, s[36:39], s94 offen lds
    buffer_load_dwordx4 v217, s[36:39], s94 offen offset:1024 lds
    s_add_u32 m0, s61, 49152
    s_mul_i32 s59, s93, 96
    buffer_load_dwordx4 v200, s[8:11], s59 offen lds
    buffer_load_dwordx4 v201, s[8:11], s59 offen offset:1024 lds
    buffer_load_dwordx4 v202, s[8:11], s59 offen offset:2048 lds
    s_add_u32 s93, s93, 10240
    s_and_b32 s93, s93, 65535
    s_barrier
    s_waitcnt vmcnt(17)
    s_mov_b32 s56, 262144
poll_46:
    v_cmp_ne_u32 vcc, 0x01010101, v251
    s_cbranch_vccz pd_47
    buffer_load_dword v251, v98, s[4:7], s54 offen sc0 sc1
    s_waitcnt vmcnt(0)
    s_sub_u32 s56, s56, 1
    s_cmp_lg_u32 s56, 0
    s_cbranch_scc1 poll_46
pd_47:
    s_add_u32 m0, s62, 118784
    s_nop 0
    buffer_load_dwordx4 v217, s[36:39], s94 offen offset:2048 lds
    buffer_load_dwordx4 v217, s[36:39], s94 offen offset:3072 lds
    s_add_u32 s94, s94, 49152
    s_and_b32 s94, s94, 262143
    s_add_u32 m0, s61, 65536
    s_mul_i32 s59, s93, 96
    buffer_load_dwordx4 v200, s[8:11], s59 offen lds
    buffer_load_dwordx4 v201, s[8:11], s59 offen offset:1024 lds
    buffer_load_dwordx4 v202, s[8:11], s59 offen offset:2048 lds
    s_add_u32 s93, s93, 2048
    s_and_b32 s93, s93, 65535
    s_waitcnt vmcnt(14)
    s_barrier
    s_add_u32 m0, s91, 135168
    s_mov_b64 exec, s[84:85]
    buffer_load_dwordx4 v221, s[36:39], s94 offen lds
    s_mov_b64 exec, -1
    s_add_u32 m0, s62, 137216
    s_nop 0
    buffer_load_dwordx4 v217, s[36:39], s94 offen lds
    buffer_load_dwordx4 v217, s[36:39], s94 offen offset:1024 lds
    v_and_b32 v226, 0xf0, v254
    v_and_b32 v227, 0x300, v254
    v_lshl_add_u32 v227, v227, 2, v226
    s_lshl_b32 s78, s42, 8
    s_add_u32 s78, s78, s53
    s_add_u32 m0, s61, 81920
    s_mul_i32 s59, s93, 96
    buffer_load_dwordx4 v200, s[8:11], s59 offen lds
    buffer_load_dwordx4 v201, s[8:11], s59 offen offset:1024 lds
    buffer_load_dwordx4 v202, s[8:11], s59 offen offset:2048 lds
    s_add_u32 s93, s93, 6144
    s_and_b32 s93, s93, 65535
    buffer_load_dwordx4 v[0:3], v227, s[4:7], s78 offen
    s_add_u32 s78, s78, 4096
    s_barrier
    s_add_u32 m0, s62, 137216
    s_nop 0
    buffer_load_dwordx4 v217, s[36:39], s94 offen offset:2048 lds
    buffer_load_dwordx4 v217, s[36:39], s94 offen offset:3072 lds
    s_add_u32 s94, s94, 32768
    s_and_b32 s94, s94, 262143
    s_add_u32 m0, s61, 0
    s_mul_i32 s59, s93, 96
    buffer_load_dwordx4 v200, s[8:11], s59 offen lds
    buffer_load_dwordx4 v201, s[8:11], s59 offen offset:1024 lds
    buffer_load_dwordx4 v202, s[8:11], s59 offen offset:2048 lds
    s_add_u32 s93, s93, 2048
    s_and_b32 s93, s93, 65535
    buffer_load_dwordx4 v[4:7], v227, s[4:7], s78 offen
    s_add_u32 s78, s78, 4096
    s_waitcnt vmcnt(16)
    s_barrier
    s_add_u32 m0, s91, 98304
    s_mov_b64 exec, s[84:85]
    buffer_load_dwordx4 v221, s[36:39], s94 offen lds
    s_mov_b64 exec, -1
    s_add_u32 m0, s62, 100352
    s_nop 0
    buffer_load_dwordx4 v217, s[36:39], s94 offen lds
    buffer_load_dwordx4 v217, s[36:39], s94 offen offset:1024 lds
    s_add_u32 m0, s61, 16384
    s_mul_i32 s59, s93, 96
    buffer_load_dwordx4 v200, s[8:11], s59 offen lds
    buffer_load_dwordx4 v201, s[8:11], s59 offen offset:1024 lds
    buffer_load_dwordx4 v202, s[8:11], s59 offen offset:2048 lds
    s_add_u32 s93, s93, 6144
    s_and_b32 s93, s93, 65535
    buffer_load_dwordx4 v[8:11], v227, s[4:7], s78 offen
    s_add_u32 s78, s78, 4096
    s_barrier
    s_add_u32 m0, s62, 100352
    s_nop 0
    buffer_load_dwordx4 v217, s[36:39], s94 offen offset:2048 lds
    buffer_load_dwordx4 v217, s[36:39], s94 offen offset:3072 lds
    s_add_u32 s94, s94, 32768
    s_and_b32 s94, s94, 262143
    s_add_u32 m0, s61, 32768
    s_mul_i32 s59, s93, 96
    buffer_load_dwordx4 v200, s[8:11], s59 offen lds
    buffer_load_dwordx4 v201, s[8:11], s59 offen offset:1024 lds
    buffer_load_dwordx4 v202, s[8:11], s59 offen offset:2048 lds
    s_add_u32 s93, s93, 2048
    s_and_b32 s93, s93, 65535
    buffer_load_dwordx4 v[12:15], v227, s[4:7], s78 offen
    s_add_u32 s78, s78, 4096
    s_waitcnt vmcnt(17)
    s_barrier
    s_add_u32 m0, s91, 116736
    s_mov_b64 exec, s[84:85]
    buffer_load_dwordx4 v221, s[36:39], s94 offen lds
    s_mov_b64 exec, -1
    s_add_u32 m0, s62, 118784
    s_nop 0
    buffer_load_dwordx4 v217, s[36:39], s94 offen lds
    buffer_load_dwordx4 v217, s[36:39], s94 offen offset:1024 lds
    s_add_u32 m0, s61, 49152
    s_mul_i32 s59, s93, 96
    buffer_load_dwordx4 v200, s[8:11], s59 offen lds
    buffer_load_dwordx4 v201, s[8:11], s59 offen offset:1024 lds
    buffer_load_dwordx4 v202, s[8:11], s59 offen offset:2048 lds
    s_add_u32 s93, s93, 6144
    s_and_b32 s93, s93, 65535
    s_barrier
    s_add_u32 m0, s62, 118784
    s_nop 0
    buffer_load_dwordx4 v217, s[36:39], s94 offen offset:2048 lds
    buffer_load_dwordx4 v217, s[36:39], s94 offen offset:3072 lds
    s_add_u32 s94, s94, 32768
    s_and_b32 s94, s94, 262143
    v_lshrrev_b32 v224, 7, v254
    v_and_b32 v97, 0x70, v254
    v_lshl_add_u32 v224, v224, 10, v97
    s_sub_u32 s70, s53, 4193408
    s_cmp_eq_u32 s40, 0
    s_cselect_b32 s70, 2130706432, s70
    s_add_u32 m0, s61, 65536
    s_mul_i32 s59, s93, 96
    buffer_load_dwordx4 v200, s[8:11], s59 offen lds
    buffer_load_dwordx4 v201, s[8:11], s59 offen offset:1024 lds
    buffer_load_dwordx4 v[24:27], v224, s[4:7], s70 offen
    s_add_u32 s70, s70, 8192
    buffer_load_dwordx4 v202, s[8:11], s59 offen offset:2048 lds
    s_add_u32 s93, s93, 2048
    s_and_b32 s93, s93, 65535
    buffer_load_dwordx4 v[28:31], v224, s[4:7], s70 offen
    s_add_u32 s70, s70, 8192
    s_waitcnt vmcnt(17)
    s_barrier
    s_waitcnt vmcnt(13)
    s_add_u32 m0, s91, 135168
    s_mov_b64 exec, s[84:85]
    buffer_load_dwordx4 v221, s[36:39], s94 offen lds
    s_mov_b64 exec, -1
    v_add_f32 v0, v0, v4
    v_add_f32 v1, v1, v5
    v_add_f32 v2, v2, v6
    v_add_f32 v3, v3, v7
    s_add_u32 m0, s62, 137216
    s_nop 0
    buffer_load_dwordx4 v217, s[36:39], s94 offen lds
    v_add_f32 v8, v8, v12
    v_add_f32 v9, v9, v13
    v_add_f32 v10, v10, v14
    v_add_f32 v11, v11, v15
    buffer_load_dwordx4 v217, s[36:39], s94 offen offset:1024 lds
    v_add_f32 v16, v0, v8
    v_add_f32 v17, v1, v9
    v_add_f32 v18, v2, v10
    v_add_f32 v19, v3, v11
    s_add_u32 m0, s61, 81920
    s_mul_i32 s59, s93, 96
    buffer_load_dwordx4 v200, s[8:11], s59 offen lds
    v_mov_b32 v0, v16
    v_mov_b32 v1, v17
    v_mov_b32 v2, v18
    v_mov_b32 v3, v19
    buffer_load_dwordx4 v201, s[8:11], s59 offen offset:1024 lds
    s_nop 1
    v_permlane16_swap_b32 v16, v0
    v_permlane16_swap_b32 v17, v1
    v_permlane16_swap_b32 v18, v2
    buffer_load_dwordx4 v202, s[8:11], s59 offen offset:2048 lds
    s_add_u32 s93, s93, 6144
    s_and_b32 s93, s93, 65535
    v_permlane16_swap_b32 v19, v3
    v_add_f32 v16, v16, v0
    v_add_f32 v17, v17, v1
    v_add_f32 v18, v18, v2
    v_add_f32 v19, v19, v3
    s_barrier
    s_add_u32 m0, s62, 137216
    s_nop 0
    buffer_load_dwordx4 v217, s[36:39], s94 offen offset:2048 lds
    v_mov_b32 v0, v16
    v_mov_b32 v1, v17
    buffer_load_dwordx4 v217, s[36:39], s94 offen offset:3072 lds
    s_add_u32 s94, s94, 32768
    s_and_b32 s94, s94, 262143
    v_mov_b32 v2, v18
    v_mov_b32 v3, v19
    s_nop 1
    s_add_u32 m0, s61, 0
    s_mul_i32 s59, s93, 96
    buffer_load_dwordx4 v200, s[8:11], s59 offen lds
    v_permlane32_swap_b32 v16, v0
    v_permlane32_swap_b32 v17, v1
    buffer_load_dwordx4 v201, s[8:11], s59 offen offset:1024 lds
    v_permlane32_swap_b32 v18, v2
    v_permlane32_swap_b32 v19, v3
    v_add_f32 v16, v16, v0
    buffer_load_dwordx4 v202, s[8:11], s59 offen offset:2048 lds
    s_add_u32 s93, s93, 2048
    s_and_b32 s93, s93, 65535
    v_add_f32 v17, v17, v1
    v_add_f32 v18, v18, v2
    v_add_f32 v19, v19, v3
    s_waitcnt vmcnt(16)
    s_barrier
    s_add_u32 m0, s91, 98304
    s_mov_b64 exec, s[84:85]
    buffer_load_dwordx4 v221, s[36:39], s94 offen lds
    s_mov_b64 exec, -1
    v_mul_f32 v16, 0x3a800000, v16
    v_mul_f32 v17, 0x3a800000, v17
    s_add_u32 m0, s62, 100352
    s_nop 0
    buffer_load_dwordx4 v217, s[36:39], s94 offen lds
    v_fma_f32 v17, -v16, v16, v17
    v_max_f32 v17, 0, v17
    v_cvt_pk_bf16_f32 v16, v16, v16
    buffer_load_dwordx4 v217, s[36:39], s94 offen offset:1024 lds
    v_lshlrev_b32 v16, 16, v16
    v_cvt_pk_bf16_f32 v17, v17, v17
    v_lshlrev_b32 v17, 16, v17
    s_add_u32 m0, s61, 16384
    s_mul_i32 s59, s93, 96
    buffer_load_dwordx4 v200, s[8:11], s59 offen lds
    v_add_f32 v17, 0x3727c5ac, v17
    v_cvt_pk_bf16_f32 v17, v17, v17
    v_lshlrev_b32 v17, 16, v17
    buffer_load_dwordx4 v201, s[8:11], s59 offen offset:1024 lds
    v_sqrt_f32 v17, v17
    s_nop 0
    v_cvt_pk_bf16_f32 v17, v17, v17
    buffer_load_dwordx4 v202, s[8:11], s59 offen offset:2048 lds
    s_add_u32 s93, s93, 6144
    s_and_b32 s93, s93, 65535
    v_lshlrev_b32 v17, 16, v17
    v_rcp_f32 v17, v17
    s_nop 0
    s_barrier
    s_add_u32 m0, s62, 100352
    s_nop 0
    buffer_load_dwordx4 v217, s[36:39], s94 offen offset:2048 lds
    v_mul_f32 v18, 0x3a800000, v18
    v_mul_f32 v19, 0x3a800000, v19
    v_fma_f32 v19, -v18, v18, v19
    buffer_load_dwordx4 v217, s[36:39], s94 offen offset:3072 lds
    s_add_u32 s94, s94, 32768
    s_and_b32 s94, s94, 262143
    v_max_f32 v19, 0, v19
    v_cvt_pk_bf16_f32 v18, v18, v18
    v_lshlrev_b32 v18, 16, v18
    v_cvt_pk_bf16_f32 v19, v19, v19
    s_add_u32 m0, s61, 32768
    s_mul_i32 s59, s93, 96
    buffer_load_dwordx4 v200, s[8:11], s59 offen lds
    v_lshlrev_b32 v19, 16, v19
    v_add_f32 v19, 0x3727c5ac, v19
    v_cvt_pk_bf16_f32 v19, v19, v19
    buffer_load_dwordx4 v201, s[8:11], s59 offen offset:1024 lds
    v_lshlrev_b32 v19, 16, v19
    v_sqrt_f32 v19, v19
    s_nop 0
    v_cvt_pk_bf16_f32 v19, v19, v19
    buffer_load_dwordx4 v202, s[8:11], s59 offen offset:2048 lds
    s_add_u32 s93, s93, 2048
    s_and_b32 s93, s93, 65535
    v_lshlrev_b32 v19, 16, v19
    v_rcp_f32 v19, v19
    s_nop 0
    v_lshrrev_b32 v226, 1, v226
    s_lshl_b32 s55, s42, 7
    s_add_u32 s55, s55, 159808
    v_add_u32 v226, s55, v226
    v_sub_f32 v16, 0, v16
    v_sub_f32 v18, 0, v18
    ds_write2_b32 v226, v16, v18 offset0:0 offset1:1
    ds_write2_b32 v226, v17, v19 offset0:144 offset1:145
    s_waitcnt vmcnt(14)
    s_barrier
    s_add_u32 m0, s91, 116736
    s_mov_b64 exec, s[84:85]
    buffer_load_dwordx4 v221, s[36:39], s94 offen lds
    s_mov_b64 exec, -1
    v_add_f32 v24, v24, v28
    v_add_f32 v25, v25, v29
    v_add_f32 v26, v26, v30
    s_add_u32 m0, s62, 118784
    s_nop 0
    buffer_load_dwordx4 v217, s[36:39], s94 offen lds
    v_add_f32 v27, v27, v31
    s_nop 1
    v_add_f32_dpp v24, v24, v24 row_ror:8 row_mask:0xf bank_mask:0xf
    v_add_f32_dpp v25, v25, v25 row_ror:8 row_mask:0xf bank_mask:0xf
    buffer_load_dwordx4 v217, s[36:39], s94 offen offset:1024 lds
    v_add_f32_dpp v26, v26, v26 row_ror:8 row_mask:0xf bank_mask:0xf
    v_add_f32_dpp v27, v27, v27 row_ror:8 row_mask:0xf bank_mask:0xf
    v_mov_b32 v28, v24
    v_mov_b32 v29, v25
    s_add_u32 m0, s61, 49152
    s_mul_i32 s59, s93, 96
    buffer_load_dwordx4 v200, s[8:11], s59 offen lds
    v_mov_b32 v30, v26
    v_mov_b32 v31, v27
    s_nop 1
    buffer_load_dwordx4 v201, s[8:11], s59 offen offset:1024 lds
    v_permlane16_swap_b32 v24, v28
    v_permlane16_swap_b32 v25, v29
    v_permlane16_swap_b32 v26, v30
    v_permlane16_swap_b32 v27, v31
    buffer_load_dwordx4 v202, s[8:11], s59 offen offset:2048 lds
    s_add_u32 s93, s93, 6144
    s_and_b32 s93, s93, 65535
    v_add_f32 v24, v24, v28
    v_add_f32 v25, v25, v29
    v_add_f32 v26, v26, v30
    v_add_f32 v27, v27, v31
    s_barrier
    s_add_u32 m0, s62, 118784
    s_nop 0
    buffer_load_dwordx4 v217, s[36:39], s94 offen offset:2048 lds
    v_mov_b32 v28, v24
    v_mov_b32 v29, v25
    buffer_load_dwordx4 v217, s[36:39], s94 offen offset:3072 lds
    s_add_u32 s94, s94, 32768
    s_and_b32 s94, s94, 262143
    v_mov_b32 v30, v26
    v_mov_b32 v31, v27
    s_nop 1
    s_add_u32 m0, s61, 65536
    s_mul_i32 s59, s93, 96
    buffer_load_dwordx4 v200, s[8:11], s59 offen lds
    v_permlane32_swap_b32 v24, v28
    v_permlane32_swap_b32 v25, v29
    buffer_load_dwordx4 v201, s[8:11], s59 offen offset:1024 lds
    v_permlane32_swap_b32 v26, v30
    v_permlane32_swap_b32 v27, v31
    v_add_f32 v24, v24, v28
    buffer_load_dwordx4 v202, s[8:11], s59 offen offset:2048 lds
    s_add_u32 s93, s93, 2048
    s_and_b32 s93, s93, 65535
    v_add_f32 v25, v25, v29
    v_add_f32 v26, v26, v30
    v_add_f32 v27, v27, v31
    s_waitcnt vmcnt(14)
    s_barrier
    s_add_u32 m0, s91, 135168
    s_mov_b64 exec, s[84:85]
    buffer_load_dwordx4 v221, s[36:39], s94 offen lds
    s_mov_b64 exec, -1
    v_mul_f32 v24, 0x3a800000, v24
    v_mul_f32 v25, 0x3a800000, v25
    s_add_u32 m0, s62, 137216
    s_nop 0
    buffer_load_dwordx4 v217, s[36:39], s94 offen lds
    v_fma_f32 v25, -v24, v24, v25
    v_max_f32 v25, 0, v25
    v_cvt_pk_bf16_f32 v24, v24, v24
    buffer_load_dwordx4 v217, s[36:39], s94 offen offset:1024 lds
    v_lshlrev_b32 v24, 16, v24
    v_cvt_pk_bf16_f32 v25, v25, v25
    v_lshlrev_b32 v25, 16, v25
    s_add_u32 m0, s61, 81920
    s_mul_i32 s59, s93, 96
    buffer_load_dwordx4 v200, s[8:11], s59 offen lds
    v_add_f32 v25, 0x3727c5ac, v25
    v_cvt_pk_bf16_f32 v25, v25, v25
    v_lshlrev_b32 v25, 16, v25
    buffer_load_dwordx4 v201, s[8:11], s59 offen offset:1024 lds
    v_sqrt_f32 v25, v25
    s_nop 0
    v_cvt_pk_bf16_f32 v25, v25, v25
    buffer_load_dwordx4 v202, s[8:11], s59 offen offset:2048 lds
    s_add_u32 s93, s93, 6144
    s_and_b32 s93, s93, 65535
    v_lshlrev_b32 v25, 16, v25
    v_rcp_f32 v25, v25
    s_nop 0
    s_barrier
    s_add_u32 m0, s62, 137216
    s_nop 0
    buffer_load_dwordx4 v217, s[36:39], s94 offen offset:2048 lds
    v_mul_f32 v26, 0x3a800000, v26
    v_mul_f32 v27, 0x3a800000, v27
    v_fma_f32 v27, -v26, v26, v27
    v_max_f32 v27, 0, v27
    buffer_load_dwordx4 v217, s[36:39], s94 offen offset:3072 lds
    s_add_u32 s94, s94, 32768
    s_and_b32 s94, s94, 262143
    v_cvt_pk_bf16_f32 v26, v26, v26
    v_lshlrev_b32 v26, 16, v26
    v_cvt_pk_bf16_f32 v27, v27, v27
    v_lshlrev_b32 v27, 16, v27
    v_add_f32 v27, 0x3727c5ac, v27
    s_add_u32 m0, s61, 0
    s_mul_i32 s59, s93, 96
    buffer_load_dwordx4 v200, s[8:11], s59 offen lds
    v_cvt_pk_bf16_f32 v27, v27, v27
    v_lshlrev_b32 v27, 16, v27
    v_sqrt_f32 v27, v27
    s_nop 0
    buffer_load_dwordx4 v201, s[8:11], s59 offen offset:1024 lds
    v_cvt_pk_bf16_f32 v27, v27, v27
    v_lshlrev_b32 v27, 16, v27
    v_rcp_f32 v27, v27
    s_nop 0
    v_lshrrev_b32 v97, 1, v97
    buffer_load_dwordx4 v202, s[8:11], s59 offen offset:2048 lds
    s_add_u32 s93, s93, 2048
    s_and_b32 s93, s93, 65535
    v_add_u32 v97, 159744, v97
    v_sub_f32 v24, 0, v24
    v_sub_f32 v26, 0, v26
    ds_write2_b32 v97, v24, v26 offset0:0 offset1:1
    ds_write2_b32 v97, v25, v27 offset0:144 offset1:145
    s_waitcnt vmcnt(14)
    s_barrier
    s_add_u32 m0, s91, 98304
    s_mov_b64 exec, s[84:85]
    buffer_load_dwordx4 v221, s[36:39], s94 offen lds
    s_mov_b64 exec, -1
    s_add_u32 m0, s62, 100352
    s_nop 0
    buffer_load_dwordx4 v217, s[36:39], s94 offen lds
    buffer_load_dwordx4 v217, s[36:39], s94 offen offset:1024 lds
    s_add_u32 m0, s61, 16384
    s_mul_i32 s59, s93, 96
    buffer_load_dwordx4 v200, s[8:11], s59 offen lds
    buffer_load_dwordx4 v201, s[8:11], s59 offen offset:1024 lds
    buffer_load_dwordx4 v202, s[8:11], s59 offen offset:2048 lds
    s_barrier
    s_add_u32 m0, s62, 100352
    s_nop 0
    buffer_load_dwordx4 v217, s[36:39], s94 offen offset:2048 lds
    buffer_load_dwordx4 v217, s[36:39], s94 offen offset:3072 lds
    s_lshl_b32 s93, s43, 1
    s_add_u32 s93, s51, s93
    s_and_b32 s93, s93, 15
    s_add_u32 m0, s62, 32768
    s_lshl_b32 s93, s93, 17
    buffer_load_dwordx4 v203, s[12:15], s93 offen lds
    buffer_load_dwordx4 v204, s[12:15], s93 offen offset:1024 lds
    buffer_load_dwordx4 v205, s[12:15], s93 offen offset:2048 lds
    buffer_load_dwordx4 v206, s[12:15], s93 offen offset:3072 lds
    s_add_u32 s93, s93, 524288
    s_and_b32 s93, s93, 2097151
    s_waitcnt vmcnt(15)
    s_barrier
    s_add_u32 m0, s62, 49152
    s_nop 0
    buffer_load_dwordx4 v203, s[12:15], s93 offen lds
    buffer_load_dwordx4 v204, s[12:15], s93 offen offset:1024 lds
    buffer_load_dwordx4 v205, s[12:15], s93 offen offset:2048 lds
    buffer_load_dwordx4 v206, s[12:15], s93 offen offset:3072 lds
    s_add_u32 s93, s93, 524288
    s_and_b32 s93, s93, 2097151
    s_barrier
    s_add_u32 m0, s62, 65536
    s_nop 0
    buffer_load_dwordx4 v203, s[12:15], s93 offen lds
    buffer_load_dwordx4 v204, s[12:15], s93 offen offset:1024 lds
    buffer_load_dwordx4 v205, s[12:15], s93 offen offset:2048 lds
    buffer_load_dwordx4 v206, s[12:15], s93 offen offset:3072 lds
    s_add_u32 s93, s93, 524288
    s_and_b32 s93, s93, 2097151
    s_waitcnt vmcnt(12)
    s_barrier
    s_add_u32 m0, s62, 81920
    s_nop 0
    buffer_load_dwordx4 v203, s[12:15], s93 offen lds
    buffer_load_dwordx4 v204, s[12:15], s93 offen offset:1024 lds
    buffer_load_dwordx4 v205, s[12:15], s93 offen offset:2048 lds
    buffer_load_dwordx4 v206, s[12:15], s93 offen offset:3072 lds
    s_add_u32 s93, s93, 655360
    s_and_b32 s93, s93, 2097151
    s_barrier
    s_add_u32 m0, s62, 0
    s_nop 0
    buffer_load_dwordx4 v203, s[12:15], s93 offen lds
    buffer_load_dwordx4 v204, s[12:15], s93 offen offset:1024 lds
    buffer_load_dwordx4 v205, s[12:15], s93 offen offset:2048 lds
    buffer_load_dwordx4 v206, s[12:15], s93 offen offset:3072 lds
    s_add_u32 s93, s93, 524288
    s_and_b32 s93, s93, 2097151
    s_waitcnt lgkmcnt(0)
    s_barrier
    s_add_u32 m0, s62, 16384
    s_nop 0
    buffer_load_dwordx4 v203, s[12:15], s93 offen lds
    buffer_load_dwordx4 v204, s[12:15], s93 offen offset:1024 lds
    buffer_load_dwordx4 v205, s[12:15], s93 offen offset:2048 lds
    buffer_load_dwordx4 v206, s[12:15], s93 offen offset:3072 lds
    s_add_u32 s93, s93, 524288
    s_and_b32 s93, s93, 2097151
    s_setprio 0
Y_g2:
    v_lshlrev_b32 v224, 7, v254
    s_lshl_b32 s55, s44, 19
    s_add_u32 s55, s55, s93
    s_and_b32 s55, s55, 2097151
    s_add_u32 s55, s55, s63
    buffer_load_dword v251, v224, s[12:15], s55 offen
    v_mov_b32 v112, -1
    v_mov_b32 v113, -1
    v_mov_b32 v114, -1
    v_mov_b32 v115, -1
    s_lshl_b32 s94, s51, 14
    s_add_u32 s88, s47, s62
    v_add_u32 v217, s88, v254
    s_add_u32 s55, s88, s94
    s_add_u32 s55, s55, 1310720
    buffer_store_dwordx4 v[112:115], v254, s[4:7], s55 offen offset:0 sc0 sc1
    buffer_store_dwordx4 v[112:115], v254, s[4:7], s55 offen offset:1024 sc0 sc1
    buffer_store_dwordx4 v[112:115], v254, s[4:7], s55 offen offset:2048 sc0 sc1
    buffer_store_dwordx4 v[112:115], v254, s[4:7], s55 offen offset:3072 sc0 sc1
    s_barrier
    s_add_u32 m0, s62, 98304
    s_nop 0
    buffer_load_dwordx4 v217, s[4:7], s94 offen lds
    buffer_load_dwordx4 v217, s[4:7], s94 offen offset:1024 lds
    buffer_load_dwordx4 v217, s[4:7], s94 offen offset:2048 lds
    buffer_load_dwordx4 v217, s[4:7], s94 offen offset:3072 lds
    s_add_u32 s94, s94, 32768
    s_and_b32 s94, s94, 262143
    s_waitcnt vmcnt(0)
    s_barrier
    v_lshrrev_b32 v252, 2, v254
    v_min_u32 v252, 28, v252
    s_add_u32 s55, s0, 0
    s_mov_b32 s56, 262144
poll_48:
    buffer_load_dword v253, v252, s[4:7], s55 offen sc0 sc1
    s_waitcnt vmcnt(0)
    v_cmp_ne_u32 vcc, 0x01010101, v253
    s_cbranch_vccz pd_49
    s_sleep 1
    s_sub_u32 s56, s56, 1
    s_cmp_lg_u32 s56, 0
    s_cbranch_scc1 poll_48
pd_49:
    s_add_u32 m0, s62, 114688
    s_nop 0
    buffer_load_dwordx4 v217, s[4:7], s94 offen lds
    buffer_load_dwordx4 v217, s[4:7], s94 offen offset:1024 lds
    buffer_load_dwordx4 v217, s[4:7], s94 offen offset:2048 lds
    buffer_load_dwordx4 v217, s[4:7], s94 offen offset:3072 lds
    s_add_u32 s94, s94, 32768
    s_and_b32 s94, s94, 262143
    s_add_u32 m0, s62, 131072
    s_nop 0
    buffer_load_dwordx4 v217, s[4:7], s94 offen lds
    buffer_load_dwordx4 v217, s[4:7], s94 offen offset:1024 lds
    buffer_load_dwordx4 v217, s[4:7], s94 offen offset:2048 lds
    buffer_load_dwordx4 v217, s[4:7], s94 offen offset:3072 lds
    s_add_u32 s94, s94, 32768
    s_and_b32 s94, s94, 262143
    s_waitcnt vmcnt(4)
    s_barrier
    s_add_u32 m0, s62, 98304
    s_nop 0
    buffer_load_dwordx4 v217, s[4:7], s94 offen lds
    buffer_load_dwordx4 v217, s[4:7], s94 offen offset:1024 lds
    buffer_load_dwordx4 v217, s[4:7], s94 offen offset:2048 lds
    buffer_load_dwordx4 v217, s[4:7], s94 offen offset:3072 lds
    s_add_u32 s94, s94, 32768
    s_and_b32 s94, s94, 262143
    s_waitcnt vmcnt(4)
    s_barrier
    s_add_u32 m0, s62, 114688
    s_nop 0
    buffer_load_dwordx4 v217, s[4:7], s94 offen lds
    buffer_load_dwordx4 v217, s[4:7], s94 offen offset:1024 lds
    buffer_load_dwordx4 v217, s[4:7], s94 offen offset:2048 lds
    buffer_load_dwordx4 v217, s[4:7], s94 offen offset:3072 lds
    s_add_u32 s94, s94, 32768
    s_and_b32 s94, s94, 262143
    s_add_u32 m0, s62, 32768
    s_nop 0
    buffer_load_dwordx4 v203, s[12:15], s93 offen lds
    buffer_load_dwordx4 v204, s[12:15], s93 offen offset:1024 lds
    buffer_load_dwordx4 v205, s[12:15], s93 offen offset:2048 lds
    buffer_load_dwordx4 v206, s[12:15], s93 offen offset:3072 lds
    s_add_u32 s93, s93, 524288
    s_and_b32 s93, s93, 2097151
    s_waitcnt vmcnt(8)
    s_barrier
    s_add_u32 m0, s62, 131072
    s_nop 0
    buffer_load_dwordx4 v217, s[4:7], s94 offen lds
    buffer_load_dwordx4 v217, s[4:7], s94 offen offset:1024 lds
    buffer_load_dwordx4 v217, s[4:7], s94 offen offset:2048 lds
    buffer_load_dwordx4 v217, s[4:7], s94 offen offset:3072 lds
    s_add_u32 s94, s94, 32768
    s_and_b32 s94, s94, 262143
    s_waitcnt vmcnt(8)
    s_barrier
    v_lshrrev_b32 v252, 2, v254
    v_min_u32 v252, 60, v252
    s_add_u32 s55, s54, 0
    buffer_load_dword v251, v252, s[4:7], s55 offen sc0 sc1
    s_add_u32 m0, s62, 98304
    s_nop 0
    buffer_load_dwordx4 v217, s[4:7], s94 offen lds
    buffer_load_dwordx4 v217, s[4:7], s94 offen offset:1024 lds
    buffer_load_dwordx4 v217, s[4:7], s94 offen offset:2048 lds
    buffer_load_dwordx4 v217, s[4:7], s94 offen offset:3072 lds
    s_add_u32 s94, s94, 32768
    s_and_b32 s94, s94, 262143
    s_add_u32 m0, s62, 49152
    s_nop 0
    buffer_load_dwordx4 v203, s[12:15], s93 offen lds
    buffer_load_dwordx4 v204, s[12:15], s93 offen offset:1024 lds
    buffer_load_dwordx4 v205, s[12:15], s93 offen offset:2048 lds
    buffer_load_dwordx4 v206, s[12:15], s93 offen offset:3072 lds
    s_add_u32 s93, s93, 524288
    s_and_b32 s93, s93, 2097151
    s_waitcnt vmcnt(9)
    s_barrier
    s_add_u32 m0, s62, 114688
    s_nop 0
    buffer_load_dwordx4 v217, s[4:7], s94 offen lds
    buffer_load_dwordx4 v217, s[4:7], s94 offen offset:1024 lds
    buffer_load_dwordx4 v217, s[4:7], s94 offen offset:2048 lds
    buffer_load_dwordx4 v217, s[4:7], s94 offen offset:3072 lds
    s_add_u32 s94, s94, 49152
    s_and_b32 s94, s94, 262143
    s_waitcnt vmcnt(8)
    s_barrier
    v_cmp_ne_u32 vcc, 0x01010101, v251
    s_cbranch_vccz ap_50
    v_lshrrev_b32 v252, 2, v254
    v_min_u32 v252, 60, v252
    s_add_u32 s55, s54, 0
    s_mov_b32 s56, 262144
poll_51:
    buffer_load_dword v253, v252, s[4:7], s55 offen sc0 sc1
    s_waitcnt vmcnt(0)
    v_cmp_ne_u32 vcc, 0x01010101, v253
    s_cbranch_vccz pd_52
    s_sleep 1
    s_sub_u32 s56, s56, 1
    s_cmp_lg_u32 s56, 0
    s_cbranch_scc1 poll_51
pd_52:
ap_50:
    s_add_u32 m0, s62, 131072
    s_nop 0
    buffer_load_dwordx4 v217, s[4:7], s94 offen lds
    buffer_load_dwordx4 v217, s[4:7], s94 offen offset:1024 lds
    buffer_load_dwordx4 v217, s[4:7], s94 offen offset:2048 lds
    buffer_load_dwordx4 v217, s[4:7], s94 offen offset:3072 lds
    s_add_u32 s94, s94, 32768
    s_and_b32 s94, s94, 262143
    s_waitcnt vmcnt(4)
    s_barrier
    s_add_u32 m0, s62, 98304
    s_nop 0
    buffer_load_dwordx4 v217, s[4:7], s94 offen lds
    buffer_load_dwordx4 v217, s[4:7], s94 offen offset:1024 lds
    buffer_load_dwordx4 v217, s[4:7], s94 offen offset:2048 lds
    buffer_load_dwordx4 v217, s[4:7], s94 offen offset:3072 lds
    s_add_u32 s94, s94, 32768
    s_and_b32 s94, s94, 262143
    s_waitcnt vmcnt(4)
    s_barrier
    s_add_u32 m0, s62, 114688
    s_nop 0
    buffer_load_dwordx4 v217, s[4:7], s94 offen lds
    buffer_load_dwordx4 v217, s[4:7], s94 offen offset:1024 lds
    buffer_load_dwordx4 v217, s[4:7], s94 offen offset:2048 lds
    buffer_load_dwordx4 v217, s[4:7], s94 offen offset:3072 lds
    s_add_u32 s94, s94, 32768
    s_and_b32 s94, s94, 262143
    s_waitcnt vmcnt(4)
    s_barrier
    s_add_u32 m0, s62, 131072
    s_nop 0
    buffer_load_dwordx4 v217, s[4:7], s94 offen lds
    buffer_load_dwordx4 v217, s[4:7], s94 offen offset:1024 lds
    buffer_load_dwordx4 v217, s[4:7], s94 offen offset:2048 lds
    buffer_load_dwordx4 v217, s[4:7], s94 offen offset:3072 lds
    s_add_u32 s94, s94, 32768
    s_and_b32 s94, s94, 262143
    s_waitcnt vmcnt(4)
    s_barrier
    s_add_u32 m0, s62, 98304
    s_nop 0
    buffer_load_dwordx4 v217, s[4:7], s94 offen lds
    buffer_load_dwordx4 v217, s[4:7], s94 offen offset:1024 lds
    buffer_load_dwordx4 v217, s[4:7], s94 offen offset:2048 lds
    buffer_load_dwordx4 v217, s[4:7], s94 offen offset:3072 lds
    s_add_u32 s94, s94, 32768
    s_and_b32 s94, s94, 262143
    s_waitcnt vmcnt(4)
    s_barrier
    s_add_u32 m0, s62, 114688
    s_nop 0
    buffer_load_dwordx4 v217, s[4:7], s94 offen lds
    buffer_load_dwordx4 v217, s[4:7], s94 offen offset:1024 lds
    buffer_load_dwordx4 v217, s[4:7], s94 offen offset:2048 lds
    buffer_load_dwordx4 v217, s[4:7], s94 offen offset:3072 lds
    s_add_u32 s94, s94, 32768
    s_and_b32 s94, s94, 262143
    s_waitcnt vmcnt(4)
    s_barrier
    s_add_u32 m0, s62, 131072
    s_nop 0
    buffer_load_dwordx4 v217, s[4:7], s94 offen lds
    buffer_load_dwordx4 v217, s[4:7], s94 offen offset:1024 lds
    buffer_load_dwordx4 v217, s[4:7], s94 offen offset:2048 lds
    buffer_load_dwordx4 v217, s[4:7], s94 offen offset:3072 lds
    s_add_u32 s94, s94, 32768
    s_and_b32 s94, s94, 262143
    s_waitcnt vmcnt(4)
    s_barrier
    s_add_u32 m0, s62, 98304
    s_nop 0
    buffer_load_dwordx4 v217, s[4:7], s94 offen lds
    buffer_load_dwordx4 v217, s[4:7], s94 offen offset:1024 lds
    buffer_load_dwordx4 v217, s[4:7], s94 offen offset:2048 lds
    buffer_load_dwordx4 v217, s[4:7], s94 offen offset:3072 lds
    s_waitcnt vmcnt(4)
    s_barrier
    s_lshl_b32 s93, s51, 12
    s_add_u32 m0, s62, 65536
    s_mul_i32 s59, s93, 112
    buffer_load_dwordx4 v207, s[16:19], s59 offen lds
    buffer_load_dwordx4 v208, s[16:19], s59 offen offset:1024 lds
    buffer_load_dwordx4 v209, s[16:19], s59 offen offset:2048 lds
    buffer_load_dwordx4 v210, s[16:19], s59 offen offset:3072 lds
    s_add_u32 s93, s93, 2048
    s_and_b32 s93, s93, 65535
    s_waitcnt vmcnt(4)
    s_barrier
    s_add_u32 m0, s62, 81920
    s_mul_i32 s59, s93, 112
    buffer_load_dwordx4 v207, s[16:19], s59 offen lds
    buffer_load_dwordx4 v208, s[16:19], s59 offen offset:1024 lds
    buffer_load_dwordx4 v209, s[16:19], s59 offen offset:2048 lds
    buffer_load_dwordx4 v210, s[16:19], s59 offen offset:3072 lds
    s_add_u32 s93, s93, 6144
    s_and_b32 s93, s93, 65535
    s_barrier
    s_add_u32 m0, s62, 0
    s_mul_i32 s59, s93, 112
    buffer_load_dwordx4 v207, s[16:19], s59 offen lds
    buffer_load_dwordx4 v208, s[16:19], s59 offen offset:1024 lds
    buffer_load_dwordx4 v209, s[16:19], s59 offen offset:2048 lds
    buffer_load_dwordx4 v210, s[16:19], s59 offen offset:3072 lds
    s_add_u32 s93, s93, 2048
    s_and_b32 s93, s93, 65535
    s_cmp_lg_u32 s46, 0
    s_cbranch_scc1 jf_53
    v_mov_b32 v104, 0x3f80
    v_lshrrev_b32 v224, 4, v254
    v_and_b32 v225, 1, v224
    v_lshlrev_b32 v225, 4, v225
    v_lshlrev_b32 v225, v225, v104
    v_bfe_u32 v224, v224, 1, 3
    v_cmp_eq_u32 vcc, 0, v224
    s_nop 1
    v_cndmask_b32 v104, 0, v225, vcc
    v_cmp_eq_u32 vcc, 1, v224
    s_nop 1
    v_cndmask_b32 v105, 0, v225, vcc
    v_cmp_eq_u32 vcc, 2, v224
    s_nop 1
    v_cndmask_b32 v106, 0, v225, vcc
    v_cmp_eq_u32 vcc, 3, v224
    s_nop 1
    v_cndmask_b32 v107, 0, v225, vcc
    s_nop 1
    v_mfma_f32_16x16x32_bf16 v[100:103], v[104:107], v[0:3], 0
    v_mfma_f32_16x16x32_bf16 v[100:103], v[104:107], v[4:7], v[100:103]
    v_mfma_f32_16x16x32_bf16 v[100:103], v[104:107], v[8:11], v[100:103]
    v_mfma_f32_16x16x32_bf16 v[100:103], v[104:107], v[12:15], v[100:103]
    v_mfma_f32_16x16x32_bf16 v[100:103], v[104:107], v[16:19], v[100:103]
    v_mfma_f32_16x16x32_bf16 v[100:103], v[104:107], v[20:23], v[100:103]
    v_mfma_f32_16x16x32_bf16 v[100:103], v[104:107], v[24:27], v[100:103]
    v_mfma_f32_16x16x32_bf16 v[100:103], v[104:107], v[28:31], v[100:103]
    v_mfma_f32_16x16x32_bf16 v[100:103], v[104:107], v[32:35], v[100:103]
    v_mfma_f32_16x16x32_bf16 v[100:103], v[104:107], v[36:39], v[100:103]
    v_mfma_f32_16x16x32_bf16 v[100:103], v[104:107], v[40:43], v[100:103]
    v_mfma_f32_16x16x32_bf16 v[100:103], v[104:107], v[44:47], v[100:103]
    v_mfma_f32_16x16x32_bf16 v[100:103], v[104:107], v[48:51], v[100:103]
    v_mfma_f32_16x16x32_bf16 v[100:103], v[104:107], v[52:55], v[100:103]
    v_mfma_f32_16x16x32_bf16 v[100:103], v[104:107], v[56:59], v[100:103]
    v_mfma_f32_16x16x32_bf16 v[100:103], v[104:107], v[60:63], v[100:103]
    s_and_b32 s56, s2, 1
    s_lshl_b32 s56, s56, 2
    s_add_u32 s56, s56, s42
    s_mul_i32 s56, s56, 28672
    s_lshr_b32 s55, s2, 1
    s_lshl_b32 s55, s55, 8
    s_add_u32 s55, s55, s56
    s_add_u32 s55, s55, 70778880
    s_cmp_lt_u32 s2, 224
    s_cselect_b32 s55, s55, 2130706432
    v_and_b32 v224, 0x70, v254
    v_lshrrev_b32 v225, 4, v254
    v_and_b32 v225, 16, v225
    v_lshl_add_u32 v224, v224, 1, v225
    s_nop 2
    v_add_f32_dpp v100, v100, v100 row_ror:8 row_mask:0xf bank_mask:0xf
    v_add_f32_dpp v101, v101, v101 row_ror:8 row_mask:0xf bank_mask:0xf
    v_add_f32_dpp v102, v102, v102 row_ror:8 row_mask:0xf bank_mask:0xf
    v_add_f32_dpp v103, v103, v103 row_ror:8 row_mask:0xf bank_mask:0xf
    s_mov_b64 exec, 0x00ff00ff
    buffer_store_dwordx4 v[100:103], v224, s[4:7], s55 offen sc0 sc1
    s_mov_b64 exec, -1
jf_53:
    s_add_u32 s88, s49, s62
    s_lshl_b32 s94, s51, 14
    v_add_u32 v217, s88, v254
    s_and_b32 s55, s51, 1
    s_mul_i32 s55, s55, 458752
    s_add_u32 s95, s50, s55
    s_and_b32 s55, s41, 7
    s_lshl_b32 s55, s55, 14
    s_and_b32 s56, s1, 0x3fff
    s_add_u32 s55, s55, s56
    s_add_u32 s89, s55, s95
    s_and_b32 s55, s41, 6
    s_add_u32 s55, s55, 48
    s_lshl_b32 s55, s55, 13
    s_and_b32 s56, s41, 1
    s_lshl_b32 s56, s56, 10
    s_add_u32 s55, s55, s56
    s_add_u32 s55, s55, s62
    s_add_u32 s90, s55, s95
    s_barrier
    s_add_u32 m0, s62, 98304
    s_nop 0
    buffer_load_dwordx4 v217, s[4:7], s94 offen lds
    buffer_load_dwordx4 v217, s[4:7], s94 offen offset:1024 lds
    buffer_load_dwordx4 v217, s[4:7], s94 offen offset:2048 lds
    buffer_load_dwordx4 v217, s[4:7], s94 offen offset:3072 lds
    s_add_u32 s94, s94, 32768
    s_and_b32 s94, s94, 262143
    s_waitcnt vmcnt(0)
    s_barrier
    v_lshrrev_b32 v252, 2, v254
    v_min_u32 v252, 28, v252
    s_add_u32 s55, s0, 32
    buffer_load_dword v251, v252, s[4:7], s55 offen sc0 sc1
    s_setprio 1
    s_barrier
    s_waitcnt vmcnt(0)
    v_cmp_ne_u32 vcc, 0x01010101, v251
    s_cbranch_vccz ap_54
    v_lshrrev_b32 v252, 2, v254
    v_min_u32 v252, 28, v252
    s_add_u32 s55, s0, 32
    s_mov_b32 s56, 262144
poll_55:
    buffer_load_dword v253, v252, s[4:7], s55 offen sc0 sc1
    s_waitcnt vmcnt(0)
    v_cmp_ne_u32 vcc, 0x01010101, v253
    s_cbranch_vccz pd_56
    s_sleep 1
    s_sub_u32 s56, s56, 1
    s_cmp_lg_u32 s56, 0
    s_cbranch_scc1 poll_55
pd_56:
ap_54:
    s_add_u32 m0, s62, 114688
    s_nop 0
    buffer_load_dwordx4 v217, s[4:7], s94 offen lds
    buffer_load_dwordx4 v217, s[4:7], s94 offen offset:1024 lds
    buffer_load_dwordx4 v217, s[4:7], s94 offen offset:2048 lds
    buffer_load_dwordx4 v217, s[4:7], s94 offen offset:3072 lds
    s_add_u32 s94, s94, 32768
    s_and_b32 s94, s94, 262143
    s_add_u32 m0, s62, 131072
    s_nop 0
    buffer_load_dwordx4 v217, s[4:7], s94 offen lds
    buffer_load_dwordx4 v217, s[4:7], s94 offen offset:1024 lds
    buffer_load_dwordx4 v217, s[4:7], s94 offen offset:2048 lds
    buffer_load_dwordx4 v217, s[4:7], s94 offen offset:3072 lds
    s_add_u32 s94, s94, 32768
    s_and_b32 s94, s94, 262143
    s_add_u32 m0, s62, 16384
    s_mul_i32 s59, s93, 112
    buffer_load_dwordx4 v207, s[16:19], s59 offen lds
    buffer_load_dwordx4 v208, s[16:19], s59 offen offset:1024 lds
    buffer_load_dwordx4 v209, s[16:19], s59 offen offset:2048 lds
    buffer_load_dwordx4 v210, s[16:19], s59 offen offset:3072 lds
    s_add_u32 s93, s93, 6144
    s_and_b32 s93, s93, 65535
    s_waitcnt vmcnt(8)
    s_barrier
    s_add_u32 m0, s62, 98304
    s_nop 0
    buffer_load_dwordx4 v217, s[4:7], s94 offen lds
    buffer_load_dwordx4 v217, s[4:7], s94 offen offset:1024 lds
    s_add_u32 m0, s62, 32768
    s_mul_i32 s59, s93, 112
    buffer_load_dwordx4 v207, s[16:19], s59 offen lds
    buffer_load_dwordx4 v208, s[16:19], s59 offen offset:1024 lds
    buffer_load_dwordx4 v209, s[16:19], s59 offen offset:2048 lds
    buffer_load_dwordx4 v210, s[16:19], s59 offen offset:3072 lds
    s_add_u32 s93, s93, 2048
    s_and_b32 s93, s93, 65535
    s_add_u32 m0, s62, 49152
    s_mul_i32 s59, s93, 112
    buffer_load_dwordx4 v207, s[16:19], s59 offen lds
    s_waitcnt vmcnt(7)
    s_barrier
    s_add_u32 m0, s62, 98304
    s_nop 0
    buffer_load_dwordx4 v217, s[4:7], s94 offen offset:2048 lds
    buffer_load_dwordx4 v217, s[4:7], s94 offen offset:3072 lds
    s_add_u32 s94, s94, 32768
    s_and_b32 s94, s94, 262143
    s_add_u32 m0, s62, 49152
    s_nop 0
    buffer_load_dwordx4 v208, s[16:19], s59 offen offset:1024 lds
    buffer_load_dwordx4 v209, s[16:19], s59 offen offset:2048 lds
    buffer_load_dwordx4 v210, s[16:19], s59 offen offset:3072 lds
    s_add_u32 s93, s93, 6144
    s_and_b32 s93, s93, 65535
    s_add_u32 m0, s62, 65536
    s_mul_i32 s59, s93, 112
    buffer_load_dwordx4 v207, s[16:19], s59 offen lds
    buffer_load_dwordx4 v208, s[16:19], s59 offen offset:1024 lds
    s_cmp_lg_u32 s42, 0
    s_cbranch_scc1 wf_57
    s_lshl_b32 s55, s51, 2
    s_add_u32 s55, s55, s54
    v_mov_b32 v252, 12288
    v_mov_b32 v253, 0x01010101
    s_mov_b64 exec, 1
    buffer_store_dword v253, v252, s[4:7], s55 offen sc0 sc1
    s_mov_b64 exec, -1
wf_57:
    s_xor_b32 s55, s42, 1
    s_or_b32 s55, s46, s55
    s_cbranch_scc1 cf_58
    v_mov_b32 v252, 0
    v_mov_b32 v253, 1
    s_lshl_b32 s55, s2, 2
    s_add_u32 s55, s55, 71566336
    s_mov_b64 exec, 1
    buffer_store_dword v253, v252, s[4:7], s55 offen sc0 sc1
    s_mov_b64 exec, -1
cf_58:
    s_waitcnt vmcnt(8)
    s_barrier
    s_add_u32 m0, s62, 114688
    s_nop 0
    buffer_load_dwordx4 v217, s[4:7], s94 offen lds
    buffer_load_dwordx4 v217, s[4:7], s94 offen offset:1024 lds
    s_add_u32 m0, s62, 65536
    s_nop 0
    buffer_load_dwordx4 v209, s[16:19], s59 offen offset:2048 lds
    buffer_load_dwordx4 v210, s[16:19], s59 offen offset:3072 lds
    s_add_u32 s93, s93, 2048
    s_and_b32 s93, s93, 65535
    s_add_u32 m0, s62, 81920
    s_mul_i32 s59, s93, 112
    buffer_load_dwordx4 v207, s[16:19], s59 offen lds
    buffer_load_dwordx4 v208, s[16:19], s59 offen offset:1024 lds
    buffer_load_dwordx4 v209, s[16:19], s59 offen offset:2048 lds
    s_waitcnt vmcnt(9)
    s_barrier
    s_add_u32 m0, s62, 114688
    s_nop 0
    buffer_load_dwordx4 v217, s[4:7], s94 offen offset:2048 lds
    buffer_load_dwordx4 v217, s[4:7], s94 offen offset:3072 lds
    s_add_u32 s94, s94, 32768
    s_and_b32 s94, s94, 262143
    s_add_u32 m0, s62, 81920
    s_nop 0
    buffer_load_dwordx4 v210, s[16:19], s59 offen offset:3072 lds
    s_add_u32 s93, s93, 6144
    s_and_b32 s93, s93, 65535
    s_add_u32 m0, s62, 0
    s_mul_i32 s59, s93, 112
    buffer_load_dwordx4 v207, s[16:19], s59 offen lds
    buffer_load_dwordx4 v208, s[16:19], s59 offen offset:1024 lds
    buffer_load_dwordx4 v209, s[16:19], s59 offen offset:2048 lds
    buffer_load_dwordx4 v210, s[16:19], s59 offen offset:3072 lds
    s_add_u32 s93, s93, 2048
    s_and_b32 s93, s93, 65535
    s_lshl_b32 s55, s46, 4
    s_lshr_b32 s56, s40, 1
    s_add_u32 s55, s55, s56
    s_cmp_lg_u32 s55, 0
    s_cbranch_scc1 w2_59
    v_lshlrev_b32 v252, 3, v254
    s_lshl_b32 s55, s2, 2
    s_add_u32 s55, s55, s42
    s_lshl_b32 s55, s55, 13
    buffer_load_dword v250, v252, s[20:23], s55 offen
w2_59:
    s_waitcnt vmcnt(10)
    s_barrier
    s_add_u32 m0, s62, 131072
    s_nop 0
    buffer_load_dwordx4 v217, s[4:7], s94 offen lds
    buffer_load_dwordx4 v217, s[4:7], s94 offen offset:1024 lds
    s_add_u32 m0, s62, 16384
    s_mul_i32 s59, s93, 112
    buffer_load_dwordx4 v207, s[16:19], s59 offen lds
    buffer_load_dwordx4 v208, s[16:19], s59 offen offset:1024 lds
    buffer_load_dwordx4 v209, s[16:19], s59 offen offset:2048 lds
    buffer_load_dwordx4 v210, s[16:19], s59 offen offset:3072 lds
    s_add_u32 s93, s93, 6144
    s_and_b32 s93, s93, 65535
    s_add_u32 m0, s62, 32768
    s_mul_i32 s59, s93, 112
    buffer_load_dwordx4 v207, s[16:19], s59 offen lds
    s_waitcnt vmcnt(11)
    s_barrier
    v_lshrrev_b32 v252, 2, v254
    v_min_u32 v252, 60, v252
    s_add_u32 s55, s54, 12288
    buffer_load_dword v251, v252, s[4:7], s55 offen sc0 sc1
    s_add_u32 m0, s62, 131072
    s_nop 0
    buffer_load_dwordx4 v217, s[4:7], s94 offen offset:2048 lds
    buffer_load_dwordx4 v217, s[4:7], s94 offen offset:3072 lds
    s_add_u32 s94, s94, 32768
    s_and_b32 s94, s94, 262143
    s_add_u32 m0, s62, 32768
    s_nop 0
    buffer_load_dwordx4 v208, s[16:19], s59 offen offset:1024 lds
    buffer_load_dwordx4 v209, s[16:19], s59 offen offset:2048 lds
    buffer_load_dwordx4 v210, s[16:19], s59 offen offset:3072 lds
    s_add_u32 s93, s93, 2048
    s_and_b32 s93, s93, 65535
    s_add_u32 m0, s62, 49152
    s_mul_i32 s59, s93, 112
    buffer_load_dwordx4 v207, s[16:19], s59 offen lds
    buffer_load_dwordx4 v208, s[16:19], s59 offen offset:1024 lds
    s_lshl_b32 s55, s46, 4
    s_lshr_b32 s56, s40, 1
    s_add_u32 s55, s55, s56
    s_cmp_lg_u32 s55, 1
    s_cbranch_scc1 w2_60
    v_lshlrev_b32 v252, 3, v254
    s_lshl_b32 s55, s2, 2
    s_add_u32 s55, s55, s42
    s_lshl_b32 s55, s55, 13
    buffer_load_dword v250, v252, s[20:23], s55 offen
w2_60:
    s_waitcnt vmcnt(15)
    s_barrier
    s_add_u32 m0, s62, 98304
    s_nop 0
    buffer_load_dwordx4 v217, s[4:7], s94 offen lds
    buffer_load_dwordx4 v217, s[4:7], s94 offen offset:1024 lds
    s_add_u32 m0, s62, 49152
    s_nop 0
    buffer_load_dwordx4 v209, s[16:19], s59 offen offset:2048 lds
    buffer_load_dwordx4 v210, s[16:19], s59 offen offset:3072 lds
    s_add_u32 s93, s93, 6144
    s_and_b32 s93, s93, 65535
    s_add_u32 m0, s62, 65536
    s_mul_i32 s59, s93, 112
    buffer_load_dwordx4 v207, s[16:19], s59 offen lds
    buffer_load_dwordx4 v208, s[16:19], s59 offen offset:1024 lds
    buffer_load_dwordx4 v209, s[16:19], s59 offen offset:2048 lds
    s_waitcnt vmcnt(16)
    s_barrier
    s_add_u32 m0, s62, 98304
    s_nop 0
    buffer_load_dwordx4 v217, s[4:7], s94 offen offset:2048 lds
    buffer_load_dwordx4 v217, s[4:7], s94 offen offset:3072 lds
    s_add_u32 s94, s94, 32768
    s_and_b32 s94, s94, 262143
    s_add_u32 m0, s62, 65536
    s_nop 0
    buffer_load_dwordx4 v210, s[16:19], s59 offen offset:3072 lds
    s_add_u32 s93, s93, 2048
    s_and_b32 s93, s93, 65535
    s_add_u32 m0, s62, 81920
    s_mul_i32 s59, s93, 112
    buffer_load_dwordx4 v207, s[16:19], s59 offen lds
    buffer_load_dwordx4 v208, s[16:19], s59 offen offset:1024 lds
    buffer_load_dwordx4 v209, s[16:19], s59 offen offset:2048 lds
    buffer_load_dwordx4 v210, s[16:19], s59 offen offset:3072 lds
    s_add_u32 s93, s93, 6144
    s_and_b32 s93, s93, 65535
    s_lshl_b32 s55, s46, 4
    s_lshr_b32 s56, s40, 1
    s_add_u32 s55, s55, s56
    s_cmp_lg_u32 s55, 2
    s_cbranch_scc1 w2_61
    v_lshlrev_b32 v252, 3, v254
    s_lshl_b32 s55, s2, 2
    s_add_u32 s55, s55, s42
    s_lshl_b32 s55, s55, 13
    buffer_load_dword v250, v252, s[20:23], s55 offen
w2_61:
    s_waitcnt vmcnt(16)
    s_barrier
    v_cmp_ne_u32 vcc, 0x01010101, v251
    s_cbranch_vccz ap_62
    v_lshrrev_b32 v252, 2, v254
    v_min_u32 v252, 60, v252
    s_add_u32 s55, s54, 12288
    s_mov_b32 s56, 262144
poll_63:
    buffer_load_dword v253, v252, s[4:7], s55 offen sc0 sc1
    s_waitcnt vmcnt(0)
    v_cmp_ne_u32 vcc, 0x01010101, v253
    s_cbranch_vccz pd_64
    s_sleep 1
    s_sub_u32 s56, s56, 1
    s_cmp_lg_u32 s56, 0
    s_cbranch_scc1 poll_63
pd_64:
ap_62:
    s_add_u32 m0, s62, 114688
    s_nop 0
    buffer_load_dwordx4 v217, s[4:7], s94 offen lds
    buffer_load_dwordx4 v217, s[4:7], s94 offen offset:1024 lds
    s_add_u32 m0, s62, 0
    s_mul_i32 s59, s93, 112
    buffer_load_dwordx4 v207, s[16:19], s59 offen lds
    v_and_b32 v226, 0xf0, v254
    v_and_b32 v227, 0x300, v254
    v_lshl_add_u32 v227, v227, 2, v226
    s_lshl_b32 s78, s42, 8
    s_add_u32 s78, s78, s52
    buffer_load_dwordx4 v208, s[16:19], s59 offen offset:1024 lds
    buffer_load_dwordx4 v209, s[16:19], s59 offen offset:2048 lds
    buffer_load_dwordx4 v210, s[16:19], s59 offen offset:3072 lds
    s_add_u32 s93, s93, 2048
    s_and_b32 s93, s93, 65535
    buffer_load_dwordx4 v[96:99], v227, s[4:7], s78 offen
    s_add_u32 s78, s78, 4096
    s_waitcnt vmcnt(17)
    s_barrier
    s_mov_b32 s55, 71566336
    buffer_load_dwordx4 v[128:131], v254, s[4:7], s55 offen sc0 sc1
    s_add_u32 m0, s62, 114688
    s_nop 0
    buffer_load_dwordx4 v217, s[4:7], s94 offen offset:2048 lds
    buffer_load_dwordx4 v217, s[4:7], s94 offen offset:3072 lds
    s_add_u32 s94, s94, 49152
    s_and_b32 s94, s94, 262143
    s_add_u32 m0, s62, 16384
    s_mul_i32 s59, s93, 112
    buffer_load_dwordx4 v207, s[16:19], s59 offen lds
    buffer_load_dwordx4 v208, s[16:19], s59 offen offset:1024 lds
    buffer_load_dwordx4 v209, s[16:19], s59 offen offset:2048 lds
    buffer_load_dwordx4 v210, s[16:19], s59 offen offset:3072 lds
    s_add_u32 s93, s93, 10240
    s_and_b32 s93, s93, 65535
    buffer_load_dwordx4 v[100:103], v227, s[4:7], s78 offen
    s_add_u32 s78, s78, 4096
    s_lshl_b32 s55, s46, 4
    s_lshr_b32 s56, s40, 1
    s_add_u32 s55, s55, s56
    s_cmp_lg_u32 s55, 3
    s_cbranch_scc1 w2_65
    v_lshlrev_b32 v252, 3, v254
    s_lshl_b32 s55, s2, 2
    s_add_u32 s55, s55, s42
    s_lshl_b32 s55, s55, 13
    buffer_load_dword v250, v252, s[20:23], s55 offen
w2_65:
    s_waitcnt vmcnt(19)
    s_barrier
    s_add_u32 m0, s62, 131072
    s_nop 0
    buffer_load_dwordx4 v217, s[4:7], s94 offen lds
    buffer_load_dwordx4 v217, s[4:7], s94 offen offset:1024 lds
    s_add_u32 m0, s62, 32768
    s_mul_i32 s59, s93, 112
    buffer_load_dwordx4 v207, s[16:19], s59 offen lds
    buffer_load_dwordx4 v208, s[16:19], s59 offen offset:1024 lds
    buffer_load_dwordx4 v209, s[16:19], s59 offen offset:2048 lds
    buffer_load_dwordx4 v210, s[16:19], s59 offen offset:3072 lds
    s_add_u32 s93, s93, 2048
    s_and_b32 s93, s93, 65535
    buffer_load_dwordx4 v[104:107], v227, s[4:7], s78 offen
    s_add_u32 s78, s78, 4096
    s_waitcnt vmcnt(22)
    s_barrier
    s_add_u32 m0, s62, 131072
    s_nop 0
    buffer_load_dwordx4 v217, s[4:7], s94 offen offset:2048 lds
    buffer_load_dwordx4 v217, s[4:7], s94 offen offset:3072 lds
    s_add_u32 s94, s94, 32768
    s_and_b32 s94, s94, 262143
    s_add_u32 m0, s62, 49152
    s_mul_i32 s59, s93, 112
    buffer_load_dwordx4 v207, s[16:19], s59 offen lds
    buffer_load_dwordx4 v208, s[16:19], s59 offen offset:1024 lds
    buffer_load_dwordx4 v209, s[16:19], s59 offen offset:2048 lds
    buffer_load_dwordx4 v210, s[16:19], s59 offen offset:3072 lds
    s_add_u32 s93, s93, 6144
    s_and_b32 s93, s93, 65535
    buffer_load_dwordx4 v[108:111], v227, s[4:7], s78 offen
    s_add_u32 s78, s78, 4096
    s_lshl_b32 s55, s46, 4
    s_lshr_b32 s56, s40, 1
    s_add_u32 s55, s55, s56
    s_cmp_lg_u32 s55, 4
    s_cbranch_scc1 w2_66
    v_lshlrev_b32 v252, 3, v254
    s_lshl_b32 s55, s2, 2
    s_add_u32 s55, s55, s42
    s_lshl_b32 s55, s55, 13
    buffer_load_dword v250, v252, s[20:23], s55 offen
w2_66:
    s_waitcnt vmcnt(19)
    s_barrier
    s_cmp_eq_u32 s46, 1
    s_cbranch_scc1 a4_67
    v_and_b32 v128, v128, v129
    v_and_b32 v130, v130, v131
    v_and_b32 v128, v128, v130
    v_cmp_ne_u32 vcc, 1, v128
    s_cbranch_vccz a4_67
    s_mov_b32 s55, 71566336
    s_mov_b32 s56, 262144
p4_68:
    buffer_load_dwordx4 v[128:131], v254, s[4:7], s55 offen sc0 sc1
    s_waitcnt vmcnt(0)
    v_and_b32 v128, v128, v129
    v_and_b32 v130, v130, v131
    v_and_b32 v128, v128, v130
    v_cmp_ne_u32 vcc, 1, v128
    s_cbranch_vccz p4_69
    s_sleep 1
    s_sub_u32 s56, s56, 1
    s_cmp_lg_u32 s56, 0
    s_cbranch_scc1 p4_68
p4_69:
a4_67:
    s_cmp_lg_u32 s46, 0
    s_cbranch_scc1 cs_70
    s_and_b32 s55, s41, 1
    s_mul_i32 s56, s55, 384
    s_xor_b32 s55, s55, 1
    s_lshl_b32 s55, s55, 9
    s_cmp_eq_u32 s44, 0
    s_cselect_b32 s55, s56, s55
    s_mul_i32 s56, s41, 896
    s_add_u32 s55, s55, s56
    s_mul_i32 s56, s43, 14336
    s_add_u32 s55, s55, s56
    s_add_u32 s55, s55, 70778880
    v_lshrrev_b32 v224, 9, v254
    v_mul_u32_u24 v224, 28672, v224
    v_and_b32 v225, 0x1f0, v254
    v_add_u32 v224, v224, v225
    buffer_load_dwordx4 v[128:131], v224, s[4:7], s55 offen sc1
    s_add_u32 s55, s55, 57344
    buffer_load_dwordx4 v[132:135], v224, s[4:7], s55 offen sc1
    s_add_u32 s55, s55, 57344
    buffer_load_dwordx4 v[136:139], v224, s[4:7], s55 offen sc1
    s_add_u32 s55, s55, 57344
    buffer_load_dwordx4 v[140:143], v224, s[4:7], s55 offen sc1
    s_add_u32 s55, s55, 57344
cs_70:
    s_add_u32 m0, s62, 98304
    s_nop 0
    buffer_load_dwordx4 v217, s[4:7], s94 offen lds
    buffer_load_dwordx4 v217, s[4:7], s94 offen offset:1024 lds
    s_add_u32 m0, s62, 65536
    s_mul_i32 s59, s93, 112
    buffer_load_dwordx4 v207, s[16:19], s59 offen lds
    buffer_load_dwordx4 v208, s[16:19], s59 offen offset:1024 lds
    buffer_load_dwordx4 v209, s[16:19], s59 offen offset:2048 lds
    buffer_load_dwordx4 v210, s[16:19], s59 offen offset:3072 lds
    s_add_u32 s93, s93, 2048
    s_and_b32 s93, s93, 65535
    s_add_u32 m0, s62, 81920
    s_mul_i32 s59, s93, 112
    buffer_load_dwordx4 v207, s[16:19], s59 offen lds
    s_waitcnt vmcnt(22)
    s_barrier
    s_add_u32 m0, s62, 98304
    s_nop 0
    buffer_load_dwordx4 v217, s[4:7], s94 offen offset:2048 lds
    buffer_load_dwordx4 v217, s[4:7], s94 offen offset:3072 lds
    s_add_u32 s94, s94, 32768
    s_and_b32 s94, s94, 262143
    s_add_u32 m0, s62, 81920
    s_nop 0
    buffer_load_dwordx4 v208, s[16:19], s59 offen offset:1024 lds
    buffer_load_dwordx4 v209, s[16:19], s59 offen offset:2048 lds
    buffer_load_dwordx4 v210, s[16:19], s59 offen offset:3072 lds
    s_add_u32 s93, s93, 6144
    s_and_b32 s93, s93, 65535
    s_add_u32 m0, s62, 0
    s_mul_i32 s59, s93, 112
    buffer_load_dwordx4 v207, s[16:19], s59 offen lds
    buffer_load_dwordx4 v208, s[16:19], s59 offen offset:1024 lds
    s_lshl_b32 s55, s46, 4
    s_lshr_b32 s56, s40, 1
    s_add_u32 s55, s55, s56
    s_cmp_lg_u32 s55, 5
    s_cbranch_scc1 w2_71
    v_lshlrev_b32 v252, 3, v254
    s_lshl_b32 s55, s2, 2
    s_add_u32 s55, s55, s42
    s_lshl_b32 s55, s55, 13
    buffer_load_dword v250, v252, s[20:23], s55 offen
w2_71:
    s_waitcnt vmcnt(19)
    s_barrier
    s_waitcnt vmcnt(14)
    s_add_u32 m0, s62, 114688
    s_nop 0
    buffer_load_dwordx4 v217, s[4:7], s94 offen lds
    v_add_f32 v96, v96, v100
    v_add_f32 v97, v97, v101
    v_add_f32 v98, v98, v102
    buffer_load_dwordx4 v217, s[4:7], s94 offen offset:1024 lds
    v_add_f32 v99, v99, v103
    v_add_f32 v104, v104, v108
    v_add_f32 v105, v105, v109
    v_add_f32 v106, v106, v110
    s_add_u32 m0, s62, 0
    s_nop 0
    buffer_load_dwordx4 v209, s[16:19], s59 offen offset:2048 lds
    v_add_f32 v107, v107, v111
    v_add_f32 v192, v96, v104
    v_add_f32 v193, v97, v105
    buffer_load_dwordx4 v210, s[16:19], s59 offen offset:3072 lds
    s_add_u32 s93, s93, 2048
    s_and_b32 s93, s93, 65535
    v_add_f32 v194, v98, v106
    v_add_f32 v195, v99, v107
    v_mov_b32 v96, v192
    v_mov_b32 v97, v193
    s_add_u32 m0, s62, 16384
    s_mul_i32 s59, s93, 112
    buffer_load_dwordx4 v207, s[16:19], s59 offen lds
    v_mov_b32 v98, v194
    v_mov_b32 v99, v195
    s_nop 1
    buffer_load_dwordx4 v208, s[16:19], s59 offen offset:1024 lds
    v_permlane16_swap_b32 v192, v96
    v_permlane16_swap_b32 v193, v97
    v_permlane16_swap_b32 v194, v98
    v_permlane16_swap_b32 v195, v99
    buffer_load_dwordx4 v209, s[16:19], s59 offen offset:2048 lds
    v_add_f32 v192, v192, v96
    v_add_f32 v193, v193, v97
    v_add_f32 v194, v194, v98
    v_add_f32 v195, v195, v99
    s_barrier
    s_add_u32 m0, s62, 114688
    s_nop 0
    buffer_load_dwordx4 v217, s[4:7], s94 offen offset:2048 lds
    v_mov_b32 v96, v192
    buffer_load_dwordx4 v217, s[4:7], s94 offen offset:3072 lds
    s_add_u32 s94, s94, 32768
    s_and_b32 s94, s94, 262143
    v_mov_b32 v97, v193
    v_mov_b32 v98, v194
    s_add_u32 m0, s62, 16384
    s_nop 0
    buffer_load_dwordx4 v210, s[16:19], s59 offen offset:3072 lds
    s_add_u32 s93, s93, 6144
    s_and_b32 s93, s93, 65535
    v_mov_b32 v99, v195
    s_nop 1
    s_add_u32 m0, s62, 32768
    s_mul_i32 s59, s93, 112
    buffer_load_dwordx4 v207, s[16:19], s59 offen lds
    v_permlane32_swap_b32 v192, v96
    v_permlane32_swap_b32 v193, v97
    buffer_load_dwordx4 v208, s[16:19], s59 offen offset:1024 lds
    v_permlane32_swap_b32 v194, v98
    v_permlane32_swap_b32 v195, v99
    buffer_load_dwordx4 v209, s[16:19], s59 offen offset:2048 lds
    v_add_f32 v192, v192, v96
    v_add_f32 v193, v193, v97
    buffer_load_dwordx4 v210, s[16:19], s59 offen offset:3072 lds
    s_add_u32 s93, s93, 2048
    s_and_b32 s93, s93, 65535
    v_add_f32 v194, v194, v98
    v_add_f32 v195, v195, v99
    s_lshl_b32 s55, s46, 4
    s_lshr_b32 s56, s40, 1
    s_add_u32 s55, s55, s56
    s_cmp_lg_u32 s55, 6
    s_cbranch_scc1 w2_72
    v_lshlrev_b32 v252, 3, v254
    s_lshl_b32 s55, s2, 2
    s_add_u32 s55, s55, s42
    s_lshl_b32 s55, s55, 13
    buffer_load_dword v250, v252, s[20:23], s55 offen
w2_72:
    s_waitcnt vmcnt(19)
    s_barrier
    s_cmp_lg_u32 s46, 0
    s_cbranch_scc1 cs_73
    v_add_f32 v128, v128, v132
    v_add_f32 v136, v136, v140
    v_add_f32 v129, v129, v133
    v_add_f32 v137, v137, v141
    v_add_f32 v130, v130, v134
    v_add_f32 v138, v138, v142
    v_add_f32 v131, v131, v135
    v_add_f32 v139, v139, v143
    v_add_f32 v128, v128, v136
    v_add_f32 v129, v129, v137
    v_add_f32 v130, v130, v138
    v_add_f32 v131, v131, v139
    v_mov_b32 v132, v128
    v_mov_b32 v133, v129
    v_mov_b32 v134, v130
    v_mov_b32 v135, v131
    s_nop 1
    v_permlane32_swap_b32 v128, v132
    v_permlane32_swap_b32 v129, v133
    v_permlane32_swap_b32 v130, v134
    v_permlane32_swap_b32 v131, v135
    v_add_f32 v128, v128, v132
    v_add_f32 v129, v129, v133
    v_add_f32 v130, v130, v134
    v_add_f32 v131, v131, v135
    s_lshl_b32 s55, s42, 9
    s_add_u32 s55, s55, 161664
    v_and_b32 v225, 0x1f0, v254
    v_add_u32 v224, s55, v225
    ds_write_b128 v224, v[128:131]
cs_73:
    s_add_u32 m0, s62, 131072
    s_nop 0
    buffer_load_dwordx4 v217, s[4:7], s94 offen lds
    v_mul_f32 v192, 0x3a800000, v192
    v_mul_f32 v193, 0x3a800000, v193
    buffer_load_dwordx4 v217, s[4:7], s94 offen offset:1024 lds
    v_fma_f32 v193, -v192, v192, v193
    v_max_f32 v193, 0, v193
    v_cvt_pk_bf16_f32 v192, v192, v192
    s_add_u32 m0, s62, 49152
    s_mul_i32 s59, s93, 112
    buffer_load_dwordx4 v207, s[16:19], s59 offen lds
    v_lshlrev_b32 v192, 16, v192
    v_cvt_pk_bf16_f32 v193, v193, v193
    v_lshlrev_b32 v193, 16, v193
    buffer_load_dwordx4 v208, s[16:19], s59 offen offset:1024 lds
    v_add_f32 v193, 0x3727c5ac, v193
    v_cvt_pk_bf16_f32 v193, v193, v193
    v_lshlrev_b32 v193, 16, v193
    buffer_load_dwordx4 v209, s[16:19], s59 offen offset:2048 lds
    v_sqrt_f32 v193, v193
    s_nop 0
    v_cvt_pk_bf16_f32 v193, v193, v193
    buffer_load_dwordx4 v210, s[16:19], s59 offen offset:3072 lds
    s_add_u32 s93, s93, 6144
    s_and_b32 s93, s93, 65535
    v_lshlrev_b32 v193, 16, v193
    v_rcp_f32 v193, v193
    s_nop 0
    s_waitcnt vmcnt(22)
    s_barrier
    s_add_u32 m0, s62, 131072
    s_nop 0
    buffer_load_dwordx4 v217, s[4:7], s94 offen offset:2048 lds
    v_mul_f32 v194, 0x3a800000, v194
    v_mul_f32 v195, 0x3a800000, v195
    v_fma_f32 v195, -v194, v194, v195
    buffer_load_dwordx4 v217, s[4:7], s94 offen offset:3072 lds
    s_add_u32 s94, s94, 32768
    s_and_b32 s94, s94, 262143
    v_max_f32 v195, 0, v195
    v_cvt_pk_bf16_f32 v194, v194, v194
    v_lshlrev_b32 v194, 16, v194
    s_add_u32 m0, s62, 65536
    s_mul_i32 s59, s93, 112
    buffer_load_dwordx4 v207, s[16:19], s59 offen lds
    v_cvt_pk_bf16_f32 v195, v195, v195
    v_lshlrev_b32 v195, 16, v195
    v_add_f32 v195, 0x3727c5ac, v195
    buffer_load_dwordx4 v208, s[16:19], s59 offen offset:1024 lds
    v_cvt_pk_bf16_f32 v195, v195, v195
    v_lshlrev_b32 v195, 16, v195
    v_sqrt_f32 v195, v195
    buffer_load_dwordx4 v209, s[16:19], s59 offen offset:2048 lds
    s_nop 0
    v_cvt_pk_bf16_f32 v195, v195, v195
    v_lshlrev_b32 v195, 16, v195
    buffer_load_dwordx4 v210, s[16:19], s59 offen offset:3072 lds
    s_add_u32 s93, s93, 2048
    s_and_b32 s93, s93, 65535
    v_rcp_f32 v195, v195
    s_nop 0
    s_lshl_b32 s55, s42, 8
    s_add_u32 s55, s55, 159744
    v_add_u32 v226, s55, v226
    ds_write_b128 v226, v[192:195]
    s_lshl_b32 s55, s46, 4
    s_lshr_b32 s56, s40, 1
    s_add_u32 s55, s55, s56
    s_cmp_lg_u32 s55, 7
    s_cbranch_scc1 w2_74
    v_lshlrev_b32 v252, 3, v254
    s_lshl_b32 s55, s2, 2
    s_add_u32 s55, s55, s42
    s_lshl_b32 s55, s55, 13
    buffer_load_dword v250, v252, s[20:23], s55 offen
w2_74:
    s_waitcnt vmcnt(17)
    s_barrier
    s_add_u32 m0, s62, 98304
    s_nop 0
    buffer_load_dwordx4 v217, s[4:7], s94 offen lds
    buffer_load_dwordx4 v217, s[4:7], s94 offen offset:1024 lds
    s_add_u32 m0, s62, 81920
    s_mul_i32 s59, s93, 112
    buffer_load_dwordx4 v207, s[16:19], s59 offen lds
    buffer_load_dwordx4 v208, s[16:19], s59 offen offset:1024 lds
    buffer_load_dwordx4 v209, s[16:19], s59 offen offset:2048 lds
    buffer_load_dwordx4 v210, s[16:19], s59 offen offset:3072 lds
    s_add_u32 s93, s93, 6144
    s_and_b32 s93, s93, 65535
    s_waitcnt vmcnt(22)
    s_barrier
    s_add_u32 m0, s62, 98304
    s_nop 0
    buffer_load_dwordx4 v217, s[4:7], s94 offen offset:2048 lds
    s_lshl_b32 s55, s43, 13
    s_add_u32 s55, s55, 98304
    v_add_u32 v176, s55, v254
    v_lshrrev_b32 v224, 6, v254
    v_lshrrev_b32 v225, 1, v224
    buffer_load_dwordx4 v217, s[4:7], s94 offen offset:3072 lds
    s_add_u32 s94, s94, 32768
    s_and_b32 s94, s94, 262143
    v_and_b32 v225, 3, v225
    s_lshl_b32 s55, s44, 1
    v_xor_b32 v225, s55, v225
    v_lshlrev_b32 v225, 5, v225
    v_lshl_add_u32 v225, v224, 7, v225
    s_add_u32 m0, s62, 0
    s_mul_i32 s59, s93, 112
    buffer_load_dwordx4 v207, s[16:19], s59 offen lds
    v_and_b32 v180, 0x30, v254
    v_lshrrev_b32 v180, 1, v180
    v_add_u32 v177, v225, v180
    buffer_load_dwordx4 v208, s[16:19], s59 offen offset:1024 lds
    v_xor_b32 v178, 32, v177
    v_lshrrev_b32 v225, 2, v224
    v_and_b32 v225, 1, v225
    v_xor_b32 v225, s44, v225
    buffer_load_dwordx4 v209, s[16:19], s59 offen offset:2048 lds
    v_lshlrev_b32 v225, 5, v225
    v_lshl_add_u32 v225, v224, 6, v225
    v_add_u32 v225, v225, v180
    buffer_load_dwordx4 v210, s[16:19], s59 offen offset:3072 lds
    s_add_u32 s93, s93, 2048
    s_and_b32 s93, s93, 65535
    v_add_u32 v179, 2048, v225
    v_add_u32 v180, 49152, v177
    v_add_u32 v181, 49152, v178
    v_add_u32 v182, 49152, v179
    s_waitcnt vmcnt(16)
    s_barrier
    s_add_u32 m0, s62, 114688
    s_nop 0
    buffer_load_dwordx4 v217, s[4:7], s94 offen lds
    buffer_load_dwordx4 v217, s[4:7], s94 offen offset:1024 lds
    s_add_u32 m0, s62, 16384
    s_mul_i32 s59, s93, 112
    buffer_load_dwordx4 v207, s[16:19], s59 offen lds
    buffer_load_dwordx4 v208, s[16:19], s59 offen offset:1024 lds
    buffer_load_dwordx4 v209, s[16:19], s59 offen offset:2048 lds
    buffer_load_dwordx4 v210, s[16:19], s59 offen offset:3072 lds
    s_add_u32 s93, s93, 6144
    s_and_b32 s93, s93, 65535
    s_waitcnt lgkmcnt(0)
    s_barrier
    s_add_u32 m0, s62, 114688
    s_nop 0
    buffer_load_dwordx4 v217, s[4:7], s94 offen offset:2048 lds
    s_lshl_b32 s55, s43, 9
    s_add_u32 s55, s55, 159744
    v_and_b32 v224, 0xf0, v254
    v_lshrrev_b32 v224, 1, v224
    v_add_u32 v224, s55, v224
    ds_read_b64 v[96:97], v224 offset:0
    ds_read_b64 v[98:99], v224 offset:128
    buffer_load_dwordx4 v217, s[4:7], s94 offen offset:3072 lds
    s_add_u32 s94, s94, 32768
    s_and_b32 s94, s94, 262143
    ds_read_b64 v[100:101], v224 offset:256
    ds_read_b64 v[102:103], v224 offset:384
    s_waitcnt lgkmcnt(0)
    s_add_u32 m0, s62, 32768
    s_mul_i32 s59, s93, 112
    buffer_load_dwordx4 v207, s[16:19], s59 offen lds
    v_sub_f32 v196, 0, v96
    v_mul_f32 v184, 0xbfb8aa3b, v97
    v_mul_f32 v188, v97, v97
    v_sub_f32 v197, 0, v98
    buffer_load_dwordx4 v208, s[16:19], s59 offen offset:1024 lds
    v_mul_f32 v185, 0xbfb8aa3b, v99
    v_mul_f32 v189, v99, v99
    v_sub_f32 v198, 0, v100
    buffer_load_dwordx4 v209, s[16:19], s59 offen offset:2048 lds
    v_mul_f32 v186, 0xbfb8aa3b, v101
    v_mul_f32 v190, v101, v101
    v_sub_f32 v199, 0, v102
    buffer_load_dwordx4 v210, s[16:19], s59 offen offset:3072 lds
    s_add_u32 s93, s93, 2048
    s_and_b32 s93, s93, 65535
    v_mul_f32 v187, 0xbfb8aa3b, v103
    v_mul_f32 v191, v103, v103
    v_rcp_f32 v188, v188
    v_rcp_f32 v189, v189
    s_waitcnt vmcnt(16)
    s_barrier
    s_add_u32 m0, s62, 131072
    s_nop 0
    buffer_load_dwordx4 v217, s[4:7], s94 offen lds
    v_rcp_f32 v190, v190
    v_rcp_f32 v191, v191
    s_nop 0
    buffer_load_dwordx4 v217, s[4:7], s94 offen offset:1024 lds
    v_lshrrev_b32 v224, 8, v254
    v_lshlrev_b32 v224, 4, v224
    v_add_u32 v224, 162688, v224
    s_and_b32 s56, s41, 1
    s_add_u32 s55, s56, s44
    s_lshl_b32 s55, s55, 7
    v_add_u32 v225, s55, v224
    s_xor_b32 s56, s56, 1
    s_lshl_b32 s56, s56, 2
    s_add_u32 s56, s56, s44
    s_lshl_b32 s56, s56, 6
    v_add_u32 v224, s56, v224
    s_add_u32 m0, s62, 49152
    s_mul_i32 s59, s93, 112
    buffer_load_dwordx4 v207, s[16:19], s59 offen lds
    ds_read_b128 v[96:99], v225 offset:0
    ds_read_b128 v[100:103], v225 offset:64
    ds_read_b128 v[104:107], v224 offset:0
    buffer_load_dwordx4 v208, s[16:19], s59 offen offset:1024 lds
    ds_read_b128 v[108:111], v225 offset:512
    ds_read_b128 v[112:115], v225 offset:576
    ds_read_b128 v[116:119], v224 offset:512
    s_waitcnt lgkmcnt(0)
    buffer_load_dwordx4 v209, s[16:19], s59 offen offset:2048 lds
    v_mul_f32 v0, v196, v96
    v_mul_f32 v1, v196, v97
    v_mul_f32 v2, v196, v98
    buffer_load_dwordx4 v210, s[16:19], s59 offen offset:3072 lds
    s_add_u32 s93, s93, 6144
    s_and_b32 s93, s93, 65535
    v_mul_f32 v3, v196, v99
    v_mul_f32 v4, v197, v96
    v_mul_f32 v5, v197, v97
    v_mul_f32 v6, v197, v98
    s_barrier
    s_add_u32 m0, s62, 131072
    s_nop 0
    buffer_load_dwordx4 v217, s[4:7], s94 offen offset:2048 lds
    v_mul_f32 v7, v197, v99
    v_mul_f32 v8, v198, v96
    v_mul_f32 v9, v198, v97
    v_mul_f32 v10, v198, v98
    buffer_load_dwordx4 v217, s[4:7], s94 offen offset:3072 lds
    s_add_u32 s94, s94, 32768
    s_and_b32 s94, s94, 262143
    v_mul_f32 v11, v198, v99
    v_mul_f32 v12, v199, v96
    v_mul_f32 v13, v199, v97
    v_mul_f32 v14, v199, v98
    s_add_u32 m0, s62, 65536
    s_mul_i32 s59, s93, 112
    buffer_load_dwordx4 v207, s[16:19], s59 offen lds
    v_mul_f32 v15, v199, v99
    v_mul_f32 v16, v196, v100
    v_mul_f32 v17, v196, v101
    v_mul_f32 v18, v196, v102
    buffer_load_dwordx4 v208, s[16:19], s59 offen offset:1024 lds
    v_mul_f32 v19, v196, v103
    v_mul_f32 v20, v197, v100
    v_mul_f32 v21, v197, v101
    v_mul_f32 v22, v197, v102
    buffer_load_dwordx4 v209, s[16:19], s59 offen offset:2048 lds
    v_mul_f32 v23, v197, v103
    v_mul_f32 v24, v198, v100
    v_mul_f32 v25, v198, v101
    v_mul_f32 v26, v198, v102
    buffer_load_dwordx4 v210, s[16:19], s59 offen offset:3072 lds
    s_add_u32 s93, s93, 2048
    s_and_b32 s93, s93, 65535
    v_mul_f32 v27, v198, v103
    v_mul_f32 v28, v199, v100
    v_mul_f32 v29, v199, v101
    v_mul_f32 v30, v199, v102
    s_waitcnt vmcnt(16)
    s_barrier
    s_add_u32 m0, s62, 98304
    s_nop 0
    buffer_load_dwordx4 v217, s[4:7], s94 offen lds
    v_mul_f32 v31, v199, v103
    v_mul_f32 v32, v196, v104
    v_mul_f32 v33, v196, v105
    v_mul_f32 v34, v196, v106
    buffer_load_dwordx4 v217, s[4:7], s94 offen offset:1024 lds
    v_mul_f32 v35, v196, v107
    v_mul_f32 v36, v197, v104
    v_mul_f32 v37, v197, v105
    v_mul_f32 v38, v197, v106
    s_add_u32 m0, s62, 81920
    s_mul_i32 s59, s93, 112
    buffer_load_dwordx4 v207, s[16:19], s59 offen lds
    v_mul_f32 v39, v197, v107
    v_mul_f32 v40, v198, v104
    v_mul_f32 v41, v198, v105
    v_mul_f32 v42, v198, v106
    buffer_load_dwordx4 v208, s[16:19], s59 offen offset:1024 lds
    v_mul_f32 v43, v198, v107
    v_mul_f32 v44, v199, v104
    v_mul_f32 v45, v199, v105
    v_mul_f32 v46, v199, v106
    buffer_load_dwordx4 v209, s[16:19], s59 offen offset:2048 lds
    v_mul_f32 v47, v199, v107
    v_mul_f32 v48, v196, v108
    v_mul_f32 v49, v196, v109
    v_mul_f32 v50, v196, v110
    buffer_load_dwordx4 v210, s[16:19], s59 offen offset:3072 lds
    v_mul_f32 v51, v196, v111
    v_mul_f32 v52, v197, v108
    v_mul_f32 v53, v197, v109
    v_mul_f32 v54, v197, v110
    s_barrier
    s_add_u32 m0, s62, 98304
    s_nop 0
    buffer_load_dwordx4 v217, s[4:7], s94 offen offset:2048 lds
    v_mul_f32 v55, v197, v111
    v_mul_f32 v56, v198, v108
    v_mul_f32 v57, v198, v109
    v_mul_f32 v58, v198, v110
    buffer_load_dwordx4 v217, s[4:7], s94 offen offset:3072 lds
    v_mul_f32 v59, v198, v111
    v_mul_f32 v60, v199, v108
    v_mul_f32 v61, v199, v109
    v_mul_f32 v62, v199, v110
    v_mul_f32 v63, v199, v111
    s_add_u32 s93, s51, 11
    s_and_b32 s93, s93, 15
    s_lshl_b32 s93, s93, 12
    s_add_u32 m0, s61, 0
    s_mul_i32 s59, s93, 112
    buffer_load_dwordx4 v211, s[16:19], s59 offen lds
    v_mul_f32 v64, v196, v112
    v_mul_f32 v65, v196, v113
    v_mul_f32 v66, v196, v114
    v_mul_f32 v67, v196, v115
    v_mul_f32 v68, v197, v112
    buffer_load_dwordx4 v212, s[16:19], s59 offen offset:1024 lds
    v_mul_f32 v69, v197, v113
    v_mul_f32 v70, v197, v114
    v_mul_f32 v71, v197, v115
    v_mul_f32 v72, v198, v112
    v_mul_f32 v73, v198, v113
    buffer_load_dwordx4 v222, s[4:7], s93 offen offset:2048 lds
    s_add_u32 s93, s93, 2048
    s_and_b32 s93, s93, 65535
    v_mul_f32 v74, v198, v114
    v_mul_f32 v75, v198, v115
    v_mul_f32 v76, v199, v112
    v_mul_f32 v77, v199, v113
    v_mul_f32 v78, v199, v114
    s_waitcnt vmcnt(15)
    s_barrier
    s_add_u32 m0, s61, 16384
    s_mul_i32 s59, s93, 112
    buffer_load_dwordx4 v211, s[16:19], s59 offen lds
    v_mul_f32 v79, v199, v115
    v_mul_f32 v80, v196, v116
    v_mul_f32 v81, v196, v117
    v_mul_f32 v82, v196, v118
    v_mul_f32 v83, v196, v119
    buffer_load_dwordx4 v212, s[16:19], s59 offen offset:1024 lds
    v_mul_f32 v84, v197, v116
    v_mul_f32 v85, v197, v117
    v_mul_f32 v86, v197, v118
    v_mul_f32 v87, v197, v119
    v_mul_f32 v88, v198, v116
    v_mul_f32 v89, v198, v117
    buffer_load_dwordx4 v222, s[4:7], s93 offen offset:2048 lds
    s_add_u32 s93, s93, 6144
    s_and_b32 s93, s93, 65535
    v_mul_f32 v90, v198, v118
    v_mul_f32 v91, v198, v119
    v_mul_f32 v92, v199, v116
    v_mul_f32 v93, v199, v117
    v_mul_f32 v94, v199, v118
    v_mul_f32 v95, v199, v119
    s_barrier
    s_add_u32 m0, s61, 32768
    s_mul_i32 s59, s93, 112
    buffer_load_dwordx4 v211, s[16:19], s59 offen lds
    buffer_load_dwordx4 v212, s[16:19], s59 offen offset:1024 lds
    buffer_load_dwordx4 v222, s[4:7], s93 offen offset:2048 lds
    s_add_u32 s93, s93, 2048
    s_and_b32 s93, s93, 65535
    s_waitcnt vmcnt(9)
    s_barrier
    s_add_u32 m0, s61, 49152
    s_mul_i32 s59, s93, 112
    buffer_load_dwordx4 v211, s[16:19], s59 offen lds
    buffer_load_dwordx4 v212, s[16:19], s59 offen offset:1024 lds
    buffer_load_dwordx4 v222, s[4:7], s93 offen offset:2048 lds
    s_add_u32 s93, s93, 6144
    s_and_b32 s93, s93, 65535
    s_barrier
    s_add_u32 m0, s61, 65536
    s_mul_i32 s59, s93, 112
    buffer_load_dwordx4 v211, s[16:19], s59 offen lds
    buffer_load_dwordx4 v212, s[16:19], s59 offen offset:1024 lds
    buffer_load_dwordx4 v222, s[4:7], s93 offen offset:2048 lds
    s_add_u32 s93, s93, 2048
    s_and_b32 s93, s93, 65535
    s_waitcnt vmcnt(12)
    s_barrier
    s_add_u32 m0, s61, 81920
    s_mul_i32 s59, s93, 112
    buffer_load_dwordx4 v211, s[16:19], s59 offen lds
    buffer_load_dwordx4 v212, s[16:19], s59 offen offset:1024 lds
    buffer_load_dwordx4 v222, s[4:7], s93 offen offset:2048 lds
    s_add_u32 s93, s93, 2048
    s_and_b32 s93, s93, 65535
    s_setprio 0
    ds_read_b64_tr_b16 v[128:129], v177 offset:0
    ds_read_b64_tr_b16 v[130:131], v177 offset:3072
    ds_read_b128 v[96:99], v176 offset:16384
    ds_read_b128 v[100:103], v176 offset:18432
    ds_read_b128 v[104:107], v176 offset:20480
    ds_read_b128 v[108:111], v176 offset:22528
    ds_read_b64_tr_b16 v[140:141], v177 offset:6144
    ds_read_b64_tr_b16 v[142:143], v177 offset:9216
    ds_read_b64_tr_b16 v[132:133], v178 offset:0
    ds_read_b64_tr_b16 v[134:135], v178 offset:3072
    ds_read_b64_tr_b16 v[144:145], v178 offset:6144
    ds_read_b64_tr_b16 v[146:147], v178 offset:9216
    ds_read_b64_tr_b16 v[136:137], v179 offset:0
    ds_read_b64_tr_b16 v[138:139], v179 offset:3072
    ds_read_b64_tr_b16 v[148:149], v179 offset:6144
    ds_read_b64_tr_b16 v[150:151], v179 offset:9216
    s_add_u32 s88, s95, s62
    v_add_u32 v217, s88, v254
    s_mov_b32 s58, 5
    s_waitcnt vmcnt(12) lgkmcnt(0)
    s_barrier
    .p2align 3
    v_mfma_f32_16x16x32_bf16 v[0:3], v[128:131], v[96:99], v[0:3]
    ds_read_b64_tr_b16 v[152:153], v177 offset:16384
    v_mfma_f32_16x16x32_bf16 v[4:7], v[128:131], v[100:103], v[4:7]
    ds_read_b64_tr_b16 v[154:155], v177 offset:19456
    v_mfma_f32_16x16x32_bf16 v[8:11], v[128:131], v[104:107], v[8:11]
    ds_read_b128 v[112:115], v176 offset:17408
    v_mfma_f32_16x16x32_bf16 v[12:15], v[128:131], v[108:111], v[12:15]
    ds_read_b128 v[116:119], v176 offset:19456
    v_mfma_f32_16x16x32_bf16 v[48:51], v[140:143], v[96:99], v[48:51]
    ds_read_b128 v[120:123], v176 offset:21504
    v_mfma_f32_16x16x32_bf16 v[52:55], v[140:143], v[100:103], v[52:55]
    ds_read_b128 v[124:127], v176 offset:23552
    v_mfma_f32_16x16x32_bf16 v[56:59], v[140:143], v[104:107], v[56:59]
    ds_read_b64_tr_b16 v[164:165], v177 offset:22528
    v_mfma_f32_16x16x32_bf16 v[60:63], v[140:143], v[108:111], v[60:63]
    ds_read_b64_tr_b16 v[166:167], v177 offset:25600
    v_mfma_f32_16x16x32_bf16 v[16:19], v[132:135], v[96:99], v[16:19]
    v_mfma_f32_16x16x32_bf16 v[20:23], v[132:135], v[100:103], v[20:23]
    ds_read_b64_tr_b16 v[156:157], v178 offset:16384
    v_mfma_f32_16x16x32_bf16 v[24:27], v[132:135], v[104:107], v[24:27]
    ds_read_b64_tr_b16 v[158:159], v178 offset:19456
    v_mfma_f32_16x16x32_bf16 v[28:31], v[132:135], v[108:111], v[28:31]
    ds_read_b64_tr_b16 v[168:169], v178 offset:22528
    v_mfma_f32_16x16x32_bf16 v[64:67], v[144:147], v[96:99], v[64:67]
    ds_read_b64_tr_b16 v[170:171], v178 offset:25600
    v_mfma_f32_16x16x32_bf16 v[68:71], v[144:147], v[100:103], v[68:71]
    ds_read_b64_tr_b16 v[160:161], v179 offset:16384
    v_mfma_f32_16x16x32_bf16 v[72:75], v[144:147], v[104:107], v[72:75]
    ds_read_b64_tr_b16 v[162:163], v179 offset:19456
    v_mfma_f32_16x16x32_bf16 v[76:79], v[144:147], v[108:111], v[76:79]
    ds_read_b64_tr_b16 v[172:173], v179 offset:22528
    v_mfma_f32_16x16x32_bf16 v[32:35], v[136:139], v[96:99], v[32:35]
    ds_read_b64_tr_b16 v[174:175], v179 offset:25600
    v_mfma_f32_16x16x32_bf16 v[36:39], v[136:139], v[100:103], v[36:39]
    v_mfma_f32_16x16x32_bf16 v[40:43], v[136:139], v[104:107], v[40:43]
    v_mfma_f32_16x16x32_bf16 v[44:47], v[136:139], v[108:111], v[44:47]
    v_mfma_f32_16x16x32_bf16 v[80:83], v[148:151], v[96:99], v[80:83]
    v_mfma_f32_16x16x32_bf16 v[84:87], v[148:151], v[100:103], v[84:87]
    v_mfma_f32_16x16x32_bf16 v[88:91], v[148:151], v[104:107], v[88:91]
    v_mfma_f32_16x16x32_bf16 v[92:95], v[148:151], v[108:111], v[92:95]
    .p2align 3
loop_75:
    s_waitcnt vmcnt(9) lgkmcnt(0)
    s_barrier
    .p2align 3
    v_mfma_f32_16x16x32_bf16 v[0:3], v[152:155], v[112:115], v[0:3]
    ds_read_b64_tr_b16 v[128:129], v177 offset:32768
    v_mfma_f32_16x16x32_bf16 v[4:7], v[152:155], v[116:119], v[4:7]
    ds_read_b64_tr_b16 v[130:131], v177 offset:35840
    v_mfma_f32_16x16x32_bf16 v[8:11], v[152:155], v[120:123], v[8:11]
    ds_read_b128 v[96:99], v176 offset:32768
    v_mfma_f32_16x16x32_bf16 v[12:15], v[152:155], v[124:127], v[12:15]
    ds_read_b128 v[100:103], v176 offset:34816
    v_mfma_f32_16x16x32_bf16 v[48:51], v[164:167], v[112:115], v[48:51]
    ds_read_b128 v[104:107], v176 offset:36864
    v_mfma_f32_16x16x32_bf16 v[52:55], v[164:167], v[116:119], v[52:55]
    ds_read_b128 v[108:111], v176 offset:38912
    v_mfma_f32_16x16x32_bf16 v[56:59], v[164:167], v[120:123], v[56:59]
    ds_read_b64_tr_b16 v[140:141], v177 offset:38912
    v_mfma_f32_16x16x32_bf16 v[60:63], v[164:167], v[124:127], v[60:63]
    ds_read_b64_tr_b16 v[142:143], v177 offset:41984
    v_mfma_f32_16x16x32_bf16 v[16:19], v[156:159], v[112:115], v[16:19]
    v_mfma_f32_16x16x32_bf16 v[20:23], v[156:159], v[116:119], v[20:23]
    ds_read_b64_tr_b16 v[132:133], v178 offset:32768
    v_mfma_f32_16x16x32_bf16 v[24:27], v[156:159], v[120:123], v[24:27]
    ds_read_b64_tr_b16 v[134:135], v178 offset:35840
    v_mfma_f32_16x16x32_bf16 v[28:31], v[156:159], v[124:127], v[28:31]
    ds_read_b64_tr_b16 v[144:145], v178 offset:38912
    v_mfma_f32_16x16x32_bf16 v[64:67], v[168:171], v[112:115], v[64:67]
    ds_read_b64_tr_b16 v[146:147], v178 offset:41984
    v_mfma_f32_16x16x32_bf16 v[68:71], v[168:171], v[116:119], v[68:71]
    ds_read_b64_tr_b16 v[136:137], v179 offset:32768
    v_mfma_f32_16x16x32_bf16 v[72:75], v[168:171], v[120:123], v[72:75]
    ds_read_b64_tr_b16 v[138:139], v179 offset:35840
    v_mfma_f32_16x16x32_bf16 v[76:79], v[168:171], v[124:127], v[76:79]
    ds_read_b64_tr_b16 v[148:149], v179 offset:38912
    v_mfma_f32_16x16x32_bf16 v[32:35], v[160:163], v[112:115], v[32:35]
    ds_read_b64_tr_b16 v[150:151], v179 offset:41984
    v_mfma_f32_16x16x32_bf16 v[36:39], v[160:163], v[116:119], v[36:39]
    v_mfma_f32_16x16x32_bf16 v[40:43], v[160:163], v[120:123], v[40:43]
    v_mfma_f32_16x16x32_bf16 v[44:47], v[160:163], v[124:127], v[44:47]
    v_mfma_f32_16x16x32_bf16 v[80:83], v[172:175], v[112:115], v[80:83]
    v_mfma_f32_16x16x32_bf16 v[84:87], v[172:175], v[116:119], v[84:87]
    v_mfma_f32_16x16x32_bf16 v[88:91], v[172:175], v[120:123], v[88:91]
    v_mfma_f32_16x16x32_bf16 v[92:95], v[172:175], v[124:127], v[92:95]
    s_waitcnt vmcnt(6) lgkmcnt(0)
    s_barrier
    .p2align 3
    v_mfma_f32_16x16x32_bf16 v[0:3], v[128:131], v[96:99], v[0:3]
    ds_read_b64_tr_b16 v[152:153], v180 offset:0
    v_mfma_f32_16x16x32_bf16 v[4:7], v[128:131], v[100:103], v[4:7]
    ds_read_b64_tr_b16 v[154:155], v180 offset:3072
    v_mfma_f32_16x16x32_bf16 v[8:11], v[128:131], v[104:107], v[8:11]
    ds_read_b128 v[112:115], v176 offset:33792
    v_mfma_f32_16x16x32_bf16 v[12:15], v[128:131], v[108:111], v[12:15]
    ds_read_b128 v[116:119], v176 offset:35840
    v_mfma_f32_16x16x32_bf16 v[48:51], v[140:143], v[96:99], v[48:51]
    ds_read_b128 v[120:123], v176 offset:37888
    v_mfma_f32_16x16x32_bf16 v[52:55], v[140:143], v[100:103], v[52:55]
    ds_read_b128 v[124:127], v176 offset:39936
    v_mfma_f32_16x16x32_bf16 v[56:59], v[140:143], v[104:107], v[56:59]
    ds_read_b64_tr_b16 v[164:165], v180 offset:6144
    v_mfma_f32_16x16x32_bf16 v[60:63], v[140:143], v[108:111], v[60:63]
    ds_read_b64_tr_b16 v[166:167], v180 offset:9216
    v_mfma_f32_16x16x32_bf16 v[16:19], v[132:135], v[96:99], v[16:19]
    v_mfma_f32_16x16x32_bf16 v[20:23], v[132:135], v[100:103], v[20:23]
    ds_read_b64_tr_b16 v[156:157], v181 offset:0
    v_mfma_f32_16x16x32_bf16 v[24:27], v[132:135], v[104:107], v[24:27]
    ds_read_b64_tr_b16 v[158:159], v181 offset:3072
    v_mfma_f32_16x16x32_bf16 v[28:31], v[132:135], v[108:111], v[28:31]
    ds_read_b64_tr_b16 v[168:169], v181 offset:6144
    v_mfma_f32_16x16x32_bf16 v[64:67], v[144:147], v[96:99], v[64:67]
    ds_read_b64_tr_b16 v[170:171], v181 offset:9216
    v_mfma_f32_16x16x32_bf16 v[68:71], v[144:147], v[100:103], v[68:71]
    ds_read_b64_tr_b16 v[160:161], v182 offset:0
    v_mfma_f32_16x16x32_bf16 v[72:75], v[144:147], v[104:107], v[72:75]
    ds_read_b64_tr_b16 v[162:163], v182 offset:3072
    v_mfma_f32_16x16x32_bf16 v[76:79], v[144:147], v[108:111], v[76:79]
    ds_read_b64_tr_b16 v[172:173], v182 offset:6144
    v_mfma_f32_16x16x32_bf16 v[32:35], v[136:139], v[96:99], v[32:35]
    ds_read_b64_tr_b16 v[174:175], v182 offset:9216
    v_mfma_f32_16x16x32_bf16 v[36:39], v[136:139], v[100:103], v[36:39]
    v_mfma_f32_16x16x32_bf16 v[40:43], v[136:139], v[104:107], v[40:43]
    v_mfma_f32_16x16x32_bf16 v[44:47], v[136:139], v[108:111], v[44:47]
    v_mfma_f32_16x16x32_bf16 v[80:83], v[148:151], v[96:99], v[80:83]
    v_mfma_f32_16x16x32_bf16 v[84:87], v[148:151], v[100:103], v[84:87]
    v_mfma_f32_16x16x32_bf16 v[88:91], v[148:151], v[104:107], v[88:91]
    v_mfma_f32_16x16x32_bf16 v[92:95], v[148:151], v[108:111], v[92:95]
    s_waitcnt vmcnt(3) lgkmcnt(0)
    s_barrier
    .p2align 3
    v_mfma_f32_16x16x32_bf16 v[0:3], v[152:155], v[112:115], v[0:3]
    ds_read_b64_tr_b16 v[128:129], v180 offset:16384
    v_mfma_f32_16x16x32_bf16 v[4:7], v[152:155], v[116:119], v[4:7]
    ds_read_b64_tr_b16 v[130:131], v180 offset:19456
    v_mfma_f32_16x16x32_bf16 v[8:11], v[152:155], v[120:123], v[8:11]
    ds_read_b128 v[96:99], v176 offset:0
    v_mfma_f32_16x16x32_bf16 v[12:15], v[152:155], v[124:127], v[12:15]
    ds_read_b128 v[100:103], v176 offset:2048
    v_mfma_f32_16x16x32_bf16 v[48:51], v[164:167], v[112:115], v[48:51]
    ds_read_b128 v[104:107], v176 offset:4096
    v_mfma_f32_16x16x32_bf16 v[52:55], v[164:167], v[116:119], v[52:55]
    ds_read_b128 v[108:111], v176 offset:6144
    v_mfma_f32_16x16x32_bf16 v[56:59], v[164:167], v[120:123], v[56:59]
    ds_read_b64_tr_b16 v[140:141], v180 offset:22528
    v_mfma_f32_16x16x32_bf16 v[60:63], v[164:167], v[124:127], v[60:63]
    ds_read_b64_tr_b16 v[142:143], v180 offset:25600
    v_mfma_f32_16x16x32_bf16 v[16:19], v[156:159], v[112:115], v[16:19]
    v_mfma_f32_16x16x32_bf16 v[20:23], v[156:159], v[116:119], v[20:23]
    ds_read_b64_tr_b16 v[132:133], v181 offset:16384
    v_mfma_f32_16x16x32_bf16 v[24:27], v[156:159], v[120:123], v[24:27]
    ds_read_b64_tr_b16 v[134:135], v181 offset:19456
    v_mfma_f32_16x16x32_bf16 v[28:31], v[156:159], v[124:127], v[28:31]
    ds_read_b64_tr_b16 v[144:145], v181 offset:22528
    v_mfma_f32_16x16x32_bf16 v[64:67], v[168:171], v[112:115], v[64:67]
    ds_read_b64_tr_b16 v[146:147], v181 offset:25600
    v_mfma_f32_16x16x32_bf16 v[68:71], v[168:171], v[116:119], v[68:71]
    ds_read_b64_tr_b16 v[136:137], v182 offset:16384
    v_mfma_f32_16x16x32_bf16 v[72:75], v[168:171], v[120:123], v[72:75]
    ds_read_b64_tr_b16 v[138:139], v182 offset:19456
    v_mfma_f32_16x16x32_bf16 v[76:79], v[168:171], v[124:127], v[76:79]
    ds_read_b64_tr_b16 v[148:149], v182 offset:22528
    v_mfma_f32_16x16x32_bf16 v[32:35], v[160:163], v[112:115], v[32:35]
    ds_read_b64_tr_b16 v[150:151], v182 offset:25600
    v_mfma_f32_16x16x32_bf16 v[36:39], v[160:163], v[116:119], v[36:39]
    v_mfma_f32_16x16x32_bf16 v[40:43], v[160:163], v[120:123], v[40:43]
    v_mfma_f32_16x16x32_bf16 v[44:47], v[160:163], v[124:127], v[44:47]
    v_mfma_f32_16x16x32_bf16 v[80:83], v[172:175], v[112:115], v[80:83]
    v_mfma_f32_16x16x32_bf16 v[84:87], v[172:175], v[116:119], v[84:87]
    v_mfma_f32_16x16x32_bf16 v[88:91], v[172:175], v[120:123], v[88:91]
    v_mfma_f32_16x16x32_bf16 v[92:95], v[172:175], v[124:127], v[92:95]
    s_waitcnt vmcnt(0) lgkmcnt(0)
    s_barrier
    .p2align 3
    v_mfma_f32_16x16x32_bf16 v[0:3], v[128:131], v[96:99], v[0:3]
    ds_read_b64_tr_b16 v[152:153], v180 offset:32768
    v_mfma_f32_16x16x32_bf16 v[4:7], v[128:131], v[100:103], v[4:7]
    ds_read_b64_tr_b16 v[154:155], v180 offset:35840
    v_mfma_f32_16x16x32_bf16 v[8:11], v[128:131], v[104:107], v[8:11]
    ds_read_b128 v[112:115], v176 offset:1024
    v_mfma_f32_16x16x32_bf16 v[12:15], v[128:131], v[108:111], v[12:15]
    ds_read_b128 v[116:119], v176 offset:3072
    v_mfma_f32_16x16x32_bf16 v[48:51], v[140:143], v[96:99], v[48:51]
    ds_read_b128 v[120:123], v176 offset:5120
    v_mfma_f32_16x16x32_bf16 v[52:55], v[140:143], v[100:103], v[52:55]
    ds_read_b128 v[124:127], v176 offset:7168
    v_mfma_f32_16x16x32_bf16 v[56:59], v[140:143], v[104:107], v[56:59]
    ds_read_b64_tr_b16 v[164:165], v180 offset:38912
    v_mfma_f32_16x16x32_bf16 v[60:63], v[140:143], v[108:111], v[60:63]
    ds_read_b64_tr_b16 v[166:167], v180 offset:41984
    v_mfma_f32_16x16x32_bf16 v[16:19], v[132:135], v[96:99], v[16:19]
    v_mfma_f32_16x16x32_bf16 v[20:23], v[132:135], v[100:103], v[20:23]
    ds_read_b64_tr_b16 v[156:157], v181 offset:32768
    v_mfma_f32_16x16x32_bf16 v[24:27], v[132:135], v[104:107], v[24:27]
    ds_read_b64_tr_b16 v[158:159], v181 offset:35840
    v_mfma_f32_16x16x32_bf16 v[28:31], v[132:135], v[108:111], v[28:31]
    ds_read_b64_tr_b16 v[168:169], v181 offset:38912
    v_mfma_f32_16x16x32_bf16 v[64:67], v[144:147], v[96:99], v[64:67]
    ds_read_b64_tr_b16 v[170:171], v181 offset:41984
    v_mfma_f32_16x16x32_bf16 v[68:71], v[144:147], v[100:103], v[68:71]
    ds_read_b64_tr_b16 v[160:161], v182 offset:32768
    v_mfma_f32_16x16x32_bf16 v[72:75], v[144:147], v[104:107], v[72:75]
    ds_read_b64_tr_b16 v[162:163], v182 offset:35840
    v_mfma_f32_16x16x32_bf16 v[76:79], v[144:147], v[108:111], v[76:79]
    ds_read_b64_tr_b16 v[172:173], v182 offset:38912
    v_mfma_f32_16x16x32_bf16 v[32:35], v[136:139], v[96:99], v[32:35]
    ds_read_b64_tr_b16 v[174:175], v182 offset:41984
    v_mfma_f32_16x16x32_bf16 v[36:39], v[136:139], v[100:103], v[36:39]
    v_mfma_f32_16x16x32_bf16 v[40:43], v[136:139], v[104:107], v[40:43]
    v_mfma_f32_16x16x32_bf16 v[44:47], v[136:139], v[108:111], v[44:47]
    v_mfma_f32_16x16x32_bf16 v[80:83], v[148:151], v[96:99], v[80:83]
    v_mfma_f32_16x16x32_bf16 v[84:87], v[148:151], v[100:103], v[84:87]
    v_mfma_f32_16x16x32_bf16 v[88:91], v[148:151], v[104:107], v[88:91]
    v_mfma_f32_16x16x32_bf16 v[92:95], v[148:151], v[108:111], v[92:95]
    s_waitcnt lgkmcnt(0)
    s_barrier
    .p2align 3
    v_mfma_f32_16x16x32_bf16 v[0:3], v[152:155], v[112:115], v[0:3]
    ds_read_b64_tr_b16 v[128:129], v177 offset:0
    v_mfma_f32_16x16x32_bf16 v[4:7], v[152:155], v[116:119], v[4:7]
    ds_read_b64_tr_b16 v[130:131], v177 offset:3072
    v_mfma_f32_16x16x32_bf16 v[8:11], v[152:155], v[120:123], v[8:11]
    ds_read_b128 v[96:99], v176 offset:16384
    v_mfma_f32_16x16x32_bf16 v[12:15], v[152:155], v[124:127], v[12:15]
    ds_read_b128 v[100:103], v176 offset:18432
    v_mfma_f32_16x16x32_bf16 v[48:51], v[164:167], v[112:115], v[48:51]
    ds_read_b128 v[104:107], v176 offset:20480
    v_mfma_f32_16x16x32_bf16 v[52:55], v[164:167], v[116:119], v[52:55]
    ds_read_b128 v[108:111], v176 offset:22528
    v_mfma_f32_16x16x32_bf16 v[56:59], v[164:167], v[120:123], v[56:59]
    ds_read_b64_tr_b16 v[140:141], v177 offset:6144
    v_mfma_f32_16x16x32_bf16 v[60:63], v[164:167], v[124:127], v[60:63]
    ds_read_b64_tr_b16 v[142:143], v177 offset:9216
    v_mfma_f32_16x16x32_bf16 v[16:19], v[156:159], v[112:115], v[16:19]
    v_mfma_f32_16x16x32_bf16 v[20:23], v[156:159], v[116:119], v[20:23]
    ds_read_b64_tr_b16 v[132:133], v178 offset:0
    v_mfma_f32_16x16x32_bf16 v[24:27], v[156:159], v[120:123], v[24:27]
    ds_read_b64_tr_b16 v[134:135], v178 offset:3072
    v_mfma_f32_16x16x32_bf16 v[28:31], v[156:159], v[124:127], v[28:31]
    ds_read_b64_tr_b16 v[144:145], v178 offset:6144
    v_mfma_f32_16x16x32_bf16 v[64:67], v[168:171], v[112:115], v[64:67]
    ds_read_b64_tr_b16 v[146:147], v178 offset:9216
    v_mfma_f32_16x16x32_bf16 v[68:71], v[168:171], v[116:119], v[68:71]
    ds_read_b64_tr_b16 v[136:137], v179 offset:0
    v_mfma_f32_16x16x32_bf16 v[72:75], v[168:171], v[120:123], v[72:75]
    ds_read_b64_tr_b16 v[138:139], v179 offset:3072
    v_mfma_f32_16x16x32_bf16 v[76:79], v[168:171], v[124:127], v[76:79]
    ds_read_b64_tr_b16 v[148:149], v179 offset:6144
    v_mfma_f32_16x16x32_bf16 v[32:35], v[160:163], v[112:115], v[32:35]
    ds_read_b64_tr_b16 v[150:151], v179 offset:9216
    v_mfma_f32_16x16x32_bf16 v[36:39], v[160:163], v[116:119], v[36:39]
    v_mfma_f32_16x16x32_bf16 v[40:43], v[160:163], v[120:123], v[40:43]
    v_mfma_f32_16x16x32_bf16 v[44:47], v[160:163], v[124:127], v[44:47]
    v_mfma_f32_16x16x32_bf16 v[80:83], v[172:175], v[112:115], v[80:83]
    v_mfma_f32_16x16x32_bf16 v[84:87], v[172:175], v[116:119], v[84:87]
    v_mfma_f32_16x16x32_bf16 v[88:91], v[172:175], v[120:123], v[88:91]
    v_mfma_f32_16x16x32_bf16 v[92:95], v[172:175], v[124:127], v[92:95]
    s_waitcnt lgkmcnt(0)
    s_barrier
    .p2align 3
    v_mfma_f32_16x16x32_bf16 v[0:3], v[128:131], v[96:99], v[0:3]
    ds_read_b64_tr_b16 v[152:153], v177 offset:16384
    v_mfma_f32_16x16x32_bf16 v[4:7], v[128:131], v[100:103], v[4:7]
    ds_read_b64_tr_b16 v[154:155], v177 offset:19456
    v_mfma_f32_16x16x32_bf16 v[8:11], v[128:131], v[104:107], v[8:11]
    ds_read_b128 v[112:115], v176 offset:17408
    v_mfma_f32_16x16x32_bf16 v[12:15], v[128:131], v[108:111], v[12:15]
    ds_read_b128 v[116:119], v176 offset:19456
    v_mfma_f32_16x16x32_bf16 v[48:51], v[140:143], v[96:99], v[48:51]
    ds_read_b128 v[120:123], v176 offset:21504
    v_mfma_f32_16x16x32_bf16 v[52:55], v[140:143], v[100:103], v[52:55]
    ds_read_b128 v[124:127], v176 offset:23552
    v_mfma_f32_16x16x32_bf16 v[56:59], v[140:143], v[104:107], v[56:59]
    ds_read_b64_tr_b16 v[164:165], v177 offset:22528
    v_mfma_f32_16x16x32_bf16 v[60:63], v[140:143], v[108:111], v[60:63]
    ds_read_b64_tr_b16 v[166:167], v177 offset:25600
    v_mfma_f32_16x16x32_bf16 v[16:19], v[132:135], v[96:99], v[16:19]
    v_mfma_f32_16x16x32_bf16 v[20:23], v[132:135], v[100:103], v[20:23]
    ds_read_b64_tr_b16 v[156:157], v178 offset:16384
    v_mfma_f32_16x16x32_bf16 v[24:27], v[132:135], v[104:107], v[24:27]
    ds_read_b64_tr_b16 v[158:159], v178 offset:19456
    v_mfma_f32_16x16x32_bf16 v[28:31], v[132:135], v[108:111], v[28:31]
    ds_read_b64_tr_b16 v[168:169], v178 offset:22528
    v_mfma_f32_16x16x32_bf16 v[64:67], v[144:147], v[96:99], v[64:67]
    ds_read_b64_tr_b16 v[170:171], v178 offset:25600
    v_mfma_f32_16x16x32_bf16 v[68:71], v[144:147], v[100:103], v[68:71]
    ds_read_b64_tr_b16 v[160:161], v179 offset:16384
    v_mfma_f32_16x16x32_bf16 v[72:75], v[144:147], v[104:107], v[72:75]
    ds_read_b64_tr_b16 v[162:163], v179 offset:19456
    v_mfma_f32_16x16x32_bf16 v[76:79], v[144:147], v[108:111], v[76:79]
    ds_read_b64_tr_b16 v[172:173], v179 offset:22528
    v_mfma_f32_16x16x32_bf16 v[32:35], v[136:139], v[96:99], v[32:35]
    ds_read_b64_tr_b16 v[174:175], v179 offset:25600
    v_mfma_f32_16x16x32_bf16 v[36:39], v[136:139], v[100:103], v[36:39]
    v_mfma_f32_16x16x32_bf16 v[40:43], v[136:139], v[104:107], v[40:43]
    v_mfma_f32_16x16x32_bf16 v[44:47], v[136:139], v[108:111], v[44:47]
    v_mfma_f32_16x16x32_bf16 v[80:83], v[148:151], v[96:99], v[80:83]
    s_sub_u32 s58, s58, 1
    s_cmp_lg_u32 s58, 0
    .p2align 3
    v_mfma_f32_16x16x32_bf16 v[84:87], v[148:151], v[100:103], v[84:87]
    v_mfma_f32_16x16x32_bf16 v[88:91], v[148:151], v[104:107], v[88:91]
    v_mfma_f32_16x16x32_bf16 v[92:95], v[148:151], v[108:111], v[92:95]
    s_cbranch_scc1 loop_75
    s_waitcnt lgkmcnt(0)
    s_barrier
    .p2align 3
    v_mfma_f32_16x16x32_bf16 v[0:3], v[152:155], v[112:115], v[0:3]
    v_mfma_f32_16x16x32_bf16 v[4:7], v[152:155], v[116:119], v[4:7]
    v_mfma_f32_16x16x32_bf16 v[8:11], v[152:155], v[120:123], v[8:11]
    v_mfma_f32_16x16x32_bf16 v[12:15], v[152:155], v[124:127], v[12:15]
    v_mfma_f32_16x16x32_bf16 v[48:51], v[164:167], v[112:115], v[48:51]
    v_mfma_f32_16x16x32_bf16 v[52:55], v[164:167], v[116:119], v[52:55]
    v_mfma_f32_16x16x32_bf16 v[56:59], v[164:167], v[120:123], v[56:59]
    v_mfma_f32_16x16x32_bf16 v[60:63], v[164:167], v[124:127], v[60:63]
    v_mfma_f32_16x16x32_bf16 v[16:19], v[156:159], v[112:115], v[16:19]
    v_mfma_f32_16x16x32_bf16 v[20:23], v[156:159], v[116:119], v[20:23]
    v_mfma_f32_16x16x32_bf16 v[24:27], v[156:159], v[120:123], v[24:27]
    v_mfma_f32_16x16x32_bf16 v[28:31], v[156:159], v[124:127], v[28:31]
    v_mfma_f32_16x16x32_bf16 v[64:67], v[168:171], v[112:115], v[64:67]
    v_mfma_f32_16x16x32_bf16 v[68:71], v[168:171], v[116:119], v[68:71]
    v_mfma_f32_16x16x32_bf16 v[72:75], v[168:171], v[120:123], v[72:75]
    v_mfma_f32_16x16x32_bf16 v[76:79], v[168:171], v[124:127], v[76:79]
    v_mfma_f32_16x16x32_bf16 v[32:35], v[160:163], v[112:115], v[32:35]
    v_mfma_f32_16x16x32_bf16 v[36:39], v[160:163], v[116:119], v[36:39]
    v_mfma_f32_16x16x32_bf16 v[40:43], v[160:163], v[120:123], v[40:43]
    v_mfma_f32_16x16x32_bf16 v[44:47], v[160:163], v[124:127], v[44:47]
    v_mfma_f32_16x16x32_bf16 v[80:83], v[172:175], v[112:115], v[80:83]
    v_mfma_f32_16x16x32_bf16 v[84:87], v[172:175], v[116:119], v[84:87]
    v_mfma_f32_16x16x32_bf16 v[88:91], v[172:175], v[120:123], v[88:91]
    v_mfma_f32_16x16x32_bf16 v[92:95], v[172:175], v[124:127], v[92:95]
    s_setprio 1
    s_nop 7
    v_mul_f32 v96, v184, v0
    v_mul_f32 v97, v184, v1
    v_mul_f32 v98, v184, v2
    v_mul_f32 v99, v184, v3
    v_exp_f32 v96, v96
    v_exp_f32 v97, v97
    v_exp_f32 v98, v98
    v_exp_f32 v99, v99
    v_mul_f32 v0, v0, v48
    v_mul_f32 v1, v1, v49
    v_mul_f32 v2, v2, v50
    v_mul_f32 v3, v3, v51
    v_fma_f32 v96, v96, v188, v188
    v_fma_f32 v97, v97, v188, v188
    v_fma_f32 v98, v98, v188, v188
    v_fma_f32 v99, v99, v188, v188
    v_rcp_f32 v96, v96
    s_barrier
    s_add_u32 m0, s62, 131072
    s_mov_b32 s92, 49152
    buffer_load_dwordx4 v217, s[4:7], s92 offen lds
    v_rcp_f32 v97, v97
    v_rcp_f32 v98, v98
    v_rcp_f32 v99, v99
    buffer_load_dwordx4 v217, s[4:7], s92 offen offset:1024 lds
    v_mul_f32 v0, v0, v96
    v_mul_f32 v1, v1, v97
    v_mul_f32 v2, v2, v98
    buffer_load_dwordx4 v217, s[4:7], s92 offen offset:2048 lds
    v_mul_f32 v3, v3, v99
    v_cvt_pk_bf16_f32 v100, v0, v1
    v_cvt_pk_bf16_f32 v101, v2, v3
    v_mul_f32 v96, v184, v16
    buffer_load_dwordx4 v217, s[4:7], s92 offen offset:3072 lds
    v_mul_f32 v97, v184, v17
    v_mul_f32 v98, v184, v18
    v_mul_f32 v99, v184, v19
    s_add_u32 m0, s62, 32768
    s_add_u32 s59, s68, 2752512
    buffer_load_dwordx4 v213, s[20:23], s59 offen lds
    v_exp_f32 v96, v96
    v_exp_f32 v97, v97
    v_exp_f32 v98, v98
    buffer_load_dwordx4 v214, s[20:23], s59 offen offset:1024 lds
    v_exp_f32 v99, v99
    v_mul_f32 v16, v16, v64
    v_mul_f32 v17, v17, v65
    v_mul_f32 v18, v18, v66
    buffer_load_dwordx4 v215, s[20:23], s59 offen offset:2048 lds
    v_mul_f32 v19, v19, v67
    v_fma_f32 v96, v96, v188, v188
    v_fma_f32 v97, v97, v188, v188
    buffer_load_dwordx4 v216, s[20:23], s59 offen offset:3072 lds
    v_fma_f32 v98, v98, v188, v188
    v_fma_f32 v99, v99, v188, v188
    v_rcp_f32 v96, v96
    v_rcp_f32 v97, v97
    s_barrier
    s_add_u32 m0, s62, 98304
    s_mov_b32 s92, 65536
    buffer_load_dwordx4 v217, s[4:7], s92 offen lds
    v_rcp_f32 v98, v98
    v_rcp_f32 v99, v99
    v_mul_f32 v16, v16, v96
    buffer_load_dwordx4 v217, s[4:7], s92 offen offset:1024 lds
    v_mul_f32 v17, v17, v97
    v_mul_f32 v18, v18, v98
    v_mul_f32 v19, v19, v99
    buffer_load_dwordx4 v217, s[4:7], s92 offen offset:2048 lds
    v_cvt_pk_bf16_f32 v102, v16, v17
    v_cvt_pk_bf16_f32 v103, v18, v19
    s_add_u32 s55, s89, 262144
    buffer_store_dwordx4 v[100:103], v254, s[4:7], s55 offen sc0 sc1
    buffer_load_dwordx4 v217, s[4:7], s92 offen offset:3072 lds
    v_mul_f32 v96, v185, v4
    v_mul_f32 v97, v185, v5
    v_mul_f32 v98, v185, v6
    v_mul_f32 v99, v185, v7
    s_add_u32 m0, s62, 49152
    s_add_u32 s59, s68, 3407872
    buffer_load_dwordx4 v213, s[20:23], s59 offen lds
    v_exp_f32 v96, v96
    v_exp_f32 v97, v97
    v_exp_f32 v98, v98
    buffer_load_dwordx4 v214, s[20:23], s59 offen offset:1024 lds
    v_exp_f32 v99, v99
    v_mul_f32 v4, v4, v52
    v_mul_f32 v5, v5, v53
    buffer_load_dwordx4 v215, s[20:23], s59 offen offset:2048 lds
    v_mul_f32 v6, v6, v54
    v_mul_f32 v7, v7, v55
    v_fma_f32 v96, v96, v189, v189
    buffer_load_dwordx4 v216, s[20:23], s59 offen offset:3072 lds
    v_fma_f32 v97, v97, v189, v189
    v_fma_f32 v98, v98, v189, v189
    v_fma_f32 v99, v99, v189, v189
    v_rcp_f32 v96, v96
    s_waitcnt vmcnt(13)
    s_barrier
    s_add_u32 m0, s62, 114688
    s_mov_b32 s92, 81920
    buffer_load_dwordx4 v217, s[4:7], s92 offen lds
    v_rcp_f32 v97, v97
    v_rcp_f32 v98, v98
    v_rcp_f32 v99, v99
    buffer_load_dwordx4 v217, s[4:7], s92 offen offset:1024 lds
    v_mul_f32 v4, v4, v96
    v_mul_f32 v5, v5, v97
    v_mul_f32 v6, v6, v98
    buffer_load_dwordx4 v217, s[4:7], s92 offen offset:2048 lds
    v_mul_f32 v7, v7, v99
    v_cvt_pk_bf16_f32 v104, v4, v5
    v_cvt_pk_bf16_f32 v105, v6, v7
    v_mul_f32 v96, v185, v20
    buffer_load_dwordx4 v217, s[4:7], s92 offen offset:3072 lds
    v_mul_f32 v97, v185, v21
    v_mul_f32 v98, v185, v22
    v_mul_f32 v99, v185, v23
    s_add_u32 m0, s62, 65536
    s_add_u32 s59, s68, 65536
    buffer_load_dwordx4 v213, s[20:23], s59 offen lds
    v_exp_f32 v96, v96
    v_exp_f32 v97, v97
    v_exp_f32 v98, v98
    buffer_load_dwordx4 v214, s[20:23], s59 offen offset:1024 lds
    v_exp_f32 v99, v99
    v_mul_f32 v20, v20, v68
    v_mul_f32 v21, v21, v69
    v_mul_f32 v22, v22, v70
    buffer_load_dwordx4 v215, s[20:23], s59 offen offset:2048 lds
    v_mul_f32 v23, v23, v71
    v_fma_f32 v96, v96, v189, v189
    v_fma_f32 v97, v97, v189, v189
    buffer_load_dwordx4 v216, s[20:23], s59 offen offset:3072 lds
    v_fma_f32 v98, v98, v189, v189
    v_fma_f32 v99, v99, v189, v189
    v_rcp_f32 v96, v96
    v_rcp_f32 v97, v97
    s_waitcnt vmcnt(12)
    s_barrier
    v_lshrrev_b32 v252, 2, v254
    v_min_u32 v252, 28, v252
    s_add_u32 s55, s0, 2080
    buffer_load_dword v251, v252, s[4:7], s55 offen sc0 sc1
    s_add_u32 m0, s62, 131072
    s_mov_b32 s92, 98304
    buffer_load_dwordx4 v217, s[4:7], s92 offen lds
    v_rcp_f32 v98, v98
    v_rcp_f32 v99, v99
    v_mul_f32 v20, v20, v96
    buffer_load_dwordx4 v217, s[4:7], s92 offen offset:1024 lds
    v_mul_f32 v21, v21, v97
    v_mul_f32 v22, v22, v98
    v_mul_f32 v23, v23, v99
    buffer_load_dwordx4 v217, s[4:7], s92 offen offset:2048 lds
    v_cvt_pk_bf16_f32 v106, v20, v21
    v_cvt_pk_bf16_f32 v107, v22, v23
    s_add_u32 s55, s89, 264192
    buffer_store_dwordx4 v[104:107], v254, s[4:7], s55 offen sc0 sc1
    buffer_load_dwordx4 v217, s[4:7], s92 offen offset:3072 lds
    v_mul_f32 v96, v186, v8
    v_mul_f32 v97, v186, v9
    v_mul_f32 v98, v186, v10
    v_mul_f32 v99, v186, v11
    s_add_u32 m0, s62, 81920
    s_add_u32 s59, s68, 720896
    buffer_load_dwordx4 v213, s[20:23], s59 offen lds
    v_exp_f32 v96, v96
    v_exp_f32 v97, v97
    v_exp_f32 v98, v98
    buffer_load_dwordx4 v214, s[20:23], s59 offen offset:1024 lds
    v_exp_f32 v99, v99
    v_mul_f32 v8, v8, v56
    v_mul_f32 v9, v9, v57
    buffer_load_dwordx4 v215, s[20:23], s59 offen offset:2048 lds
    v_mul_f32 v10, v10, v58
    v_mul_f32 v11, v11, v59
    v_fma_f32 v96, v96, v190, v190
    buffer_load_dwordx4 v216, s[20:23], s59 offen offset:3072 lds
    v_fma_f32 v97, v97, v190, v190
    v_fma_f32 v98, v98, v190, v190
    v_fma_f32 v99, v99, v190, v190
    v_rcp_f32 v96, v96
    s_waitcnt vmcnt(14)
    s_barrier
    s_add_u32 m0, s62, 98304
    s_mov_b32 s92, 114688
    buffer_load_dwordx4 v217, s[4:7], s92 offen lds
    v_rcp_f32 v97, v97
    v_rcp_f32 v98, v98
    v_rcp_f32 v99, v99
    buffer_load_dwordx4 v217, s[4:7], s92 offen offset:1024 lds
    v_mul_f32 v8, v8, v96
    v_mul_f32 v9, v9, v97
    v_mul_f32 v10, v10, v98
    buffer_load_dwordx4 v217, s[4:7], s92 offen offset:2048 lds
    v_mul_f32 v11, v11, v99
    v_cvt_pk_bf16_f32 v100, v8, v9
    v_cvt_pk_bf16_f32 v101, v10, v11
    v_mul_f32 v96, v186, v24
    buffer_load_dwordx4 v217, s[4:7], s92 offen offset:3072 lds
    v_mul_f32 v97, v186, v25
    v_mul_f32 v98, v186, v26
    v_mul_f32 v99, v186, v27
    s_add_u32 m0, s62, 0
    s_add_u32 s59, s68, 983040
    buffer_load_dwordx4 v213, s[20:23], s59 offen lds
    v_exp_f32 v96, v96
    v_exp_f32 v97, v97
    v_exp_f32 v98, v98
    buffer_load_dwordx4 v214, s[20:23], s59 offen offset:1024 lds
    v_exp_f32 v99, v99
    v_mul_f32 v24, v24, v72
    v_mul_f32 v25, v25, v73
    v_mul_f32 v26, v26, v74
    buffer_load_dwordx4 v215, s[20:23], s59 offen offset:2048 lds
    v_mul_f32 v27, v27, v75
    v_fma_f32 v96, v96, v190, v190
    v_fma_f32 v97, v97, v190, v190
    buffer_load_dwordx4 v216, s[20:23], s59 offen offset:3072 lds
    v_fma_f32 v98, v98, v190, v190
    v_fma_f32 v99, v99, v190, v190
    v_rcp_f32 v96, v96
    v_rcp_f32 v97, v97
    s_waitcnt vmcnt(12)
    s_barrier
    v_cmp_ne_u32 vcc, 0x01010101, v251
    s_cbranch_vccz ap_76
    v_lshrrev_b32 v252, 2, v254
    v_min_u32 v252, 28, v252
    s_add_u32 s55, s0, 2080
    s_mov_b32 s56, 262144
poll_77:
    buffer_load_dword v253, v252, s[4:7], s55 offen sc0 sc1
    s_waitcnt vmcnt(0)
    v_cmp_ne_u32 vcc, 0x01010101, v253
    s_cbranch_vccz pd_78
    s_sleep 1
    s_sub_u32 s56, s56, 1
    s_cmp_lg_u32 s56, 0
    s_cbranch_scc1 poll_77
pd_78:
ap_76:
    s_add_u32 m0, s62, 114688
    s_mov_b32 s92, 131072
    buffer_load_dwordx4 v217, s[4:7], s92 offen lds
    v_rcp_f32 v98, v98
    v_rcp_f32 v99, v99
    v_mul_f32 v24, v24, v96
    buffer_load_dwordx4 v217, s[4:7], s92 offen offset:1024 lds
    v_mul_f32 v25, v25, v97
    v_mul_f32 v26, v26, v98
    v_mul_f32 v27, v27, v99
    buffer_load_dwordx4 v217, s[4:7], s92 offen offset:2048 lds
    v_cvt_pk_bf16_f32 v102, v24, v25
    v_cvt_pk_bf16_f32 v103, v26, v27
    s_add_u32 s55, s89, 266240
    buffer_store_dwordx4 v[100:103], v254, s[4:7], s55 offen sc0 sc1
    buffer_load_dwordx4 v217, s[4:7], s92 offen offset:3072 lds
    v_mul_f32 v96, v187, v12
    v_mul_f32 v97, v187, v13
    v_mul_f32 v98, v187, v14
    v_mul_f32 v99, v187, v15
    s_add_u32 m0, s62, 16384
    s_add_u32 s59, s68, 1638400
    buffer_load_dwordx4 v213, s[20:23], s59 offen lds
    v_exp_f32 v96, v96
    v_exp_f32 v97, v97
    v_exp_f32 v98, v98
    buffer_load_dwordx4 v214, s[20:23], s59 offen offset:1024 lds
    v_exp_f32 v99, v99
    v_mul_f32 v12, v12, v60
    v_mul_f32 v13, v13, v61
    buffer_load_dwordx4 v215, s[20:23], s59 offen offset:2048 lds
    v_mul_f32 v14, v14, v62
    v_mul_f32 v15, v15, v63
    v_fma_f32 v96, v96, v191, v191
    buffer_load_dwordx4 v216, s[20:23], s59 offen offset:3072 lds
    v_fma_f32 v97, v97, v191, v191
    v_fma_f32 v98, v98, v191, v191
    v_fma_f32 v99, v99, v191, v191
    v_rcp_f32 v96, v96
    s_waitcnt vmcnt(13)
    s_barrier
    s_add_u32 m0, s62, 131072
    s_mov_b32 s92, 147456
    buffer_load_dwordx4 v217, s[4:7], s92 offen lds
    v_rcp_f32 v97, v97
    v_rcp_f32 v98, v98
    v_rcp_f32 v99, v99
    buffer_load_dwordx4 v217, s[4:7], s92 offen offset:1024 lds
    v_mul_f32 v12, v12, v96
    v_mul_f32 v13, v13, v97
    v_mul_f32 v14, v14, v98
    buffer_load_dwordx4 v217, s[4:7], s92 offen offset:2048 lds
    v_mul_f32 v15, v15, v99
    v_cvt_pk_bf16_f32 v104, v12, v13
    v_cvt_pk_bf16_f32 v105, v14, v15
    v_mul_f32 v96, v187, v28
    buffer_load_dwordx4 v217, s[4:7], s92 offen offset:3072 lds
    v_mul_f32 v97, v187, v29
    v_mul_f32 v98, v187, v30
    v_mul_f32 v99, v187, v31
    s_add_u32 m0, s62, 32768
    s_add_u32 s59, s68, 1900544
    buffer_load_dwordx4 v213, s[20:23], s59 offen lds
    v_exp_f32 v96, v96
    v_exp_f32 v97, v97
    v_exp_f32 v98, v98
    buffer_load_dwordx4 v214, s[20:23], s59 offen offset:1024 lds
    v_exp_f32 v99, v99
    v_mul_f32 v28, v28, v76
    v_mul_f32 v29, v29, v77
    v_mul_f32 v30, v30, v78
    buffer_load_dwordx4 v215, s[20:23], s59 offen offset:2048 lds
    v_mul_f32 v31, v31, v79
    v_fma_f32 v96, v96, v191, v191
    v_fma_f32 v97, v97, v191, v191
    buffer_load_dwordx4 v216, s[20:23], s59 offen offset:3072 lds
    v_fma_f32 v98, v98, v191, v191
    v_fma_f32 v99, v99, v191, v191
    v_rcp_f32 v96, v96
    v_rcp_f32 v97, v97
    s_waitcnt vmcnt(12)
    s_barrier
    s_add_u32 m0, s62, 98304
    s_mov_b32 s92, 163840
    buffer_load_dwordx4 v217, s[4:7], s92 offen lds
    v_rcp_f32 v98, v98
    v_rcp_f32 v99, v99
    buffer_load_dwordx4 v217, s[4:7], s92 offen offset:1024 lds
    v_mul_f32 v28, v28, v96
    v_mul_f32 v29, v29, v97
    v_mul_f32 v30, v30, v98
    buffer_load_dwordx4 v217, s[4:7], s92 offen offset:2048 lds
    v_mul_f32 v31, v31, v99
    v_cvt_pk_bf16_f32 v106, v28, v29
    buffer_load_dwordx4 v217, s[4:7], s92 offen offset:3072 lds
    v_cvt_pk_bf16_f32 v107, v30, v31
    s_add_u32 s55, s89, 268288
    buffer_store_dwordx4 v[104:107], v254, s[4:7], s55 offen sc0 sc1
    s_lshl_b32 s55, s43, 12
    s_lshl_b32 s56, s44, 3
    s_add_u32 s55, s55, s56
    s_add_u32 s55, s55, 147456
    v_add_u32 v120, s55, v254
    s_add_u32 m0, s62, 49152
    s_add_u32 s59, s68, 2555904
    buffer_load_dwordx4 v213, s[20:23], s59 offen lds
    v_mul_f32 v96, v184, v32
    v_mul_f32 v97, v184, v33
    v_mul_f32 v98, v184, v34
    buffer_load_dwordx4 v214, s[20:23], s59 offen offset:1024 lds
    v_mul_f32 v99, v184, v35
    v_exp_f32 v96, v96
    buffer_load_dwordx4 v215, s[20:23], s59 offen offset:2048 lds
    v_exp_f32 v97, v97
    v_exp_f32 v98, v98
    v_exp_f32 v99, v99
    buffer_load_dwordx4 v216, s[20:23], s59 offen offset:3072 lds
    v_mul_f32 v32, v32, v80
    v_mul_f32 v33, v33, v81
    v_mul_f32 v34, v34, v82
    s_waitcnt vmcnt(13)
    s_barrier
    s_add_u32 m0, s62, 114688
    s_mov_b32 s92, 180224
    buffer_load_dwordx4 v217, s[4:7], s92 offen lds
    v_mul_f32 v35, v35, v83
    v_fma_f32 v96, v96, v188, v188
    v_fma_f32 v97, v97, v188, v188
    buffer_load_dwordx4 v217, s[4:7], s92 offen offset:1024 lds
    v_fma_f32 v98, v98, v188, v188
    v_fma_f32 v99, v99, v188, v188
    v_rcp_f32 v96, v96
    v_rcp_f32 v97, v97
    buffer_load_dwordx4 v217, s[4:7], s92 offen offset:2048 lds
    v_rcp_f32 v98, v98
    v_rcp_f32 v99, v99
    v_mul_f32 v32, v32, v96
    buffer_load_dwordx4 v217, s[4:7], s92 offen offset:3072 lds
    v_mul_f32 v33, v33, v97
    v_mul_f32 v34, v34, v98
    v_mul_f32 v35, v35, v99
    v_cvt_pk_bf16_f32 v108, v32, v33
    s_add_u32 m0, s62, 65536
    s_add_u32 s59, s68, 2818048
    buffer_load_dwordx4 v213, s[20:23], s59 offen lds
    v_cvt_pk_bf16_f32 v109, v34, v35
    ds_write_b64 v120, v[108:109] offset:0
    v_mul_f32 v96, v185, v36
    buffer_load_dwordx4 v214, s[20:23], s59 offen offset:1024 lds
    v_mul_f32 v97, v185, v37
    v_mul_f32 v98, v185, v38
    v_mul_f32 v99, v185, v39
    v_exp_f32 v96, v96
    buffer_load_dwordx4 v215, s[20:23], s59 offen offset:2048 lds
    v_exp_f32 v97, v97
    v_exp_f32 v98, v98
    v_exp_f32 v99, v99
    buffer_load_dwordx4 v216, s[20:23], s59 offen offset:3072 lds
    v_mul_f32 v36, v36, v84
    v_mul_f32 v37, v37, v85
    v_mul_f32 v38, v38, v86
    v_mul_f32 v39, v39, v87
    s_waitcnt vmcnt(13)
    s_barrier
    s_add_u32 m0, s62, 131072
    s_mov_b32 s92, 196608
    buffer_load_dwordx4 v217, s[4:7], s92 offen lds
    v_fma_f32 v96, v96, v189, v189
    v_fma_f32 v97, v97, v189, v189
    v_fma_f32 v98, v98, v189, v189
    buffer_load_dwordx4 v217, s[4:7], s92 offen offset:1024 lds
    v_fma_f32 v99, v99, v189, v189
    v_rcp_f32 v96, v96
    v_rcp_f32 v97, v97
    v_rcp_f32 v98, v98
    buffer_load_dwordx4 v217, s[4:7], s92 offen offset:2048 lds
    v_rcp_f32 v99, v99
    v_mul_f32 v36, v36, v96
    v_mul_f32 v37, v37, v97
    buffer_load_dwordx4 v217, s[4:7], s92 offen offset:3072 lds
    v_mul_f32 v38, v38, v98
    v_mul_f32 v39, v39, v99
    v_cvt_pk_bf16_f32 v110, v36, v37
    v_cvt_pk_bf16_f32 v111, v38, v39
    s_add_u32 m0, s62, 81920
    s_add_u32 s59, s68, 3473408
    buffer_load_dwordx4 v213, s[20:23], s59 offen lds
    ds_write_b64 v120, v[110:111] offset:1024
    v_mul_f32 v96, v186, v40
    v_mul_f32 v97, v186, v41
    buffer_load_dwordx4 v214, s[20:23], s59 offen offset:1024 lds
    v_mul_f32 v98, v186, v42
    v_mul_f32 v99, v186, v43
    v_exp_f32 v96, v96
    v_exp_f32 v97, v97
    buffer_load_dwordx4 v215, s[20:23], s59 offen offset:2048 lds
    v_exp_f32 v98, v98
    v_exp_f32 v99, v99
    v_mul_f32 v40, v40, v88
    buffer_load_dwordx4 v216, s[20:23], s59 offen offset:3072 lds
    v_mul_f32 v41, v41, v89
    v_mul_f32 v42, v42, v90
    v_mul_f32 v43, v43, v91
    v_fma_f32 v96, v96, v190, v190
    s_waitcnt vmcnt(12)
    s_barrier
    s_cmp_lg_u32 s42, 0
    s_cbranch_scc1 wf_79
    s_lshr_b32 s55, s2, 5
    s_lshl_b32 s55, s55, 2
    s_add_u32 s55, s55, s0
    v_mov_b32 v252, 2112
    v_mov_b32 v253, 0x01010101
    s_mov_b64 exec, 1
    s_cmp_eq_u32 s45, 0
    s_cbranch_scc1 st_80
    buffer_store_dword v253, v252, s[4:7], s55 offen sc0 sc1
    s_branch st_81
st_80:
    buffer_store_dword v253, v252, s[4:7], s55 offen
st_81:
    s_mov_b64 exec, -1
wf_79:
    s_add_u32 m0, s62, 98304
    s_mov_b32 s92, 212992
    buffer_load_dwordx4 v217, s[4:7], s92 offen lds
    v_fma_f32 v97, v97, v190, v190
    v_fma_f32 v98, v98, v190, v190
    v_fma_f32 v99, v99, v190, v190
    buffer_load_dwordx4 v217, s[4:7], s92 offen offset:1024 lds
    v_rcp_f32 v96, v96
    v_rcp_f32 v97, v97
    v_rcp_f32 v98, v98
    v_rcp_f32 v99, v99
    buffer_load_dwordx4 v217, s[4:7], s92 offen offset:2048 lds
    v_mul_f32 v40, v40, v96
    v_mul_f32 v41, v41, v97
    v_mul_f32 v42, v42, v98
    buffer_load_dwordx4 v217, s[4:7], s92 offen offset:3072 lds
    v_mul_f32 v43, v43, v99
    v_cvt_pk_bf16_f32 v112, v40, v41
    v_cvt_pk_bf16_f32 v113, v42, v43
    ds_write_b64 v120, v[112:113] offset:2048
    s_add_u32 m0, s62, 0
    s_add_u32 s59, s69, 262144
    buffer_load_dwordx4 v213, s[20:23], s59 offen lds
    v_mul_f32 v96, v187, v44
    v_mul_f32 v97, v187, v45
    v_mul_f32 v98, v187, v46
    buffer_load_dwordx4 v214, s[20:23], s59 offen offset:1024 lds
    v_mul_f32 v99, v187, v47
    v_exp_f32 v96, v96
    v_exp_f32 v97, v97
    v_exp_f32 v98, v98
    buffer_load_dwordx4 v215, s[20:23], s59 offen offset:2048 lds
    v_exp_f32 v99, v99
    v_mul_f32 v44, v44, v92
    v_mul_f32 v45, v45, v93
    buffer_load_dwordx4 v216, s[20:23], s59 offen offset:3072 lds
    v_mul_f32 v46, v46, v94
    v_mul_f32 v47, v47, v95
    v_fma_f32 v96, v96, v191, v191
    v_fma_f32 v97, v97, v191, v191
    s_waitcnt vmcnt(12)
    s_barrier
    v_lshrrev_b32 v252, 2, v254
    v_min_u32 v252, 28, v252
    s_add_u32 s55, s0, 2112
    buffer_load_dword v251, v252, s[4:7], s55 offen sc0 sc1
    s_add_u32 m0, s62, 114688
    s_mov_b32 s92, 229376
    buffer_load_dwordx4 v217, s[4:7], s92 offen lds
    v_fma_f32 v98, v98, v191, v191
    buffer_load_dwordx4 v217, s[4:7], s92 offen offset:1024 lds
    v_fma_f32 v99, v99, v191, v191
    v_rcp_f32 v96, v96
    buffer_load_dwordx4 v217, s[4:7], s92 offen offset:2048 lds
    v_rcp_f32 v97, v97
    v_rcp_f32 v98, v98
    buffer_load_dwordx4 v217, s[4:7], s92 offen offset:3072 lds
    v_rcp_f32 v99, v99
    v_mul_f32 v44, v44, v96
    s_add_u32 m0, s62, 16384
    s_add_u32 s59, s69, 524288
    buffer_load_dwordx4 v213, s[20:23], s59 offen lds
    v_mul_f32 v45, v45, v97
    buffer_load_dwordx4 v214, s[20:23], s59 offen offset:1024 lds
    v_mul_f32 v46, v46, v98
    v_mul_f32 v47, v47, v99
    buffer_load_dwordx4 v215, s[20:23], s59 offen offset:2048 lds
    v_cvt_pk_bf16_f32 v114, v44, v45
    v_cvt_pk_bf16_f32 v115, v46, v47
    buffer_load_dwordx4 v216, s[20:23], s59 offen offset:3072 lds
    ds_write_b64 v120, v[114:115] offset:3072
    s_lshr_b32 s55, s62, 1
    s_add_u32 s55, s55, 147456
    v_add_u32 v121, s55, v254
    s_waitcnt vmcnt(13) lgkmcnt(0)
    s_barrier
    s_add_u32 m0, s62, 131072
    s_mov_b32 s92, 245760
    buffer_load_dwordx4 v217, s[4:7], s92 offen lds
    ds_read_b128 v[100:103], v121 offset:0
    buffer_load_dwordx4 v217, s[4:7], s92 offen offset:1024 lds
    ds_read_b128 v[104:107], v121 offset:1024
    s_waitcnt lgkmcnt(0)
    buffer_load_dwordx4 v217, s[4:7], s92 offen offset:2048 lds
    buffer_store_dwordx4 v[100:103], v254, s[4:7], s90 offen offset:0 sc0 sc1
    buffer_store_dwordx4 v[104:107], v254, s[4:7], s90 offen offset:2048 sc0 sc1
    buffer_load_dwordx4 v217, s[4:7], s92 offen offset:3072 lds
    s_cmp_eq_u32 s46, 0
    s_cselect_b32 s63, s63, 2130706432
    v_lshrrev_b32 v224, 7, v254
    s_add_u32 m0, s62, 32768
    s_add_u32 s59, s69, 1179648
    buffer_load_dwordx4 v213, s[20:23], s59 offen lds
    v_and_b32 v225, 0x70, v254
    v_and_b32 v226, 6, v224
    buffer_load_dwordx4 v214, s[20:23], s59 offen offset:1024 lds
    v_lshlrev_b32 v226, 4, v226
    v_xor_b32 v225, v225, v226
    buffer_load_dwordx4 v215, s[20:23], s59 offen offset:2048 lds
    v_mul_u32_u24 v224, 6144, v224
    v_add3_u32 v224, v224, v225, s63
    buffer_load_dwordx4 v216, s[20:23], s59 offen offset:3072 lds
    s_lshr_b32 s55, s61, 10
    s_add_u32 s55, s55, 0
    s_and_b32 s56, s55, 3
    s_lshl_b32 s56, s56, 3
    s_mul_i32 s56, s56, 6144
    s_lshr_b32 s55, s55, 2
    s_lshl_b32 s55, s55, 11
    s_add_u32 s55, s55, s56
    s_sub_u32 s55, s55, 0
    v_add_u32 v200, s55, v224
    s_lshr_b32 s55, s61, 10
    s_add_u32 s55, s55, 1
    s_and_b32 s56, s55, 3
    s_lshl_b32 s56, s56, 3
    s_mul_i32 s56, s56, 6144
    s_lshr_b32 s55, s55, 2
    s_lshl_b32 s55, s55, 11
    s_add_u32 s55, s55, s56
    s_sub_u32 s55, s55, 1024
    v_add_u32 v201, s55, v224
    s_waitcnt vmcnt(14)
    s_barrier
    v_cmp_ne_u32 vcc, 0x01010101, v251
    s_cbranch_vccz ap_82
    v_lshrrev_b32 v252, 2, v254
    v_min_u32 v252, 28, v252
    s_add_u32 s55, s0, 2112
    s_mov_b32 s56, 262144
poll_83:
    buffer_load_dword v253, v252, s[4:7], s55 offen sc0 sc1
    s_waitcnt vmcnt(0)
    v_cmp_ne_u32 vcc, 0x01010101, v253
    s_cbranch_vccz pd_84
    s_sleep 1
    s_sub_u32 s56, s56, 1
    s_cmp_lg_u32 s56, 0
    s_cbranch_scc1 poll_83
pd_84:
ap_82:
    s_add_u32 m0, s62, 98304
    s_mov_b32 s92, 262144
    buffer_load_dwordx4 v217, s[4:7], s92 offen lds
    buffer_load_dwordx4 v217, s[4:7], s92 offen offset:1024 lds
    buffer_load_dwordx4 v217, s[4:7], s92 offen offset:2048 lds
    buffer_load_dwordx4 v217, s[4:7], s92 offen offset:3072 lds
    s_add_u32 m0, s62, 49152
    s_add_u32 s59, s69, 1441792
    buffer_load_dwordx4 v213, s[20:23], s59 offen lds
    buffer_load_dwordx4 v214, s[20:23], s59 offen offset:1024 lds
    buffer_load_dwordx4 v215, s[20:23], s59 offen offset:2048 lds
    buffer_load_dwordx4 v216, s[20:23], s59 offen offset:3072 lds
    s_lshr_b32 s55, s61, 10
    s_add_u32 s55, s55, 2
    s_and_b32 s56, s55, 3
    s_lshl_b32 s56, s56, 3
    s_mul_i32 s56, s56, 6144
    s_lshr_b32 s55, s55, 2
    s_lshl_b32 s55, s55, 11
    s_add_u32 s55, s55, s56
    s_sub_u32 s55, s55, 2048
    v_add_u32 v202, s55, v224
    s_waitcnt vmcnt(12)
    s_barrier
    s_add_u32 m0, s62, 114688
    s_mov_b32 s92, 278528
    buffer_load_dwordx4 v217, s[4:7], s92 offen lds
    buffer_load_dwordx4 v217, s[4:7], s92 offen offset:1024 lds
    buffer_load_dwordx4 v217, s[4:7], s92 offen offset:2048 lds
    buffer_load_dwordx4 v217, s[4:7], s92 offen offset:3072 lds
    s_add_u32 m0, s62, 65536
    s_add_u32 s59, s69, 2097152
    buffer_load_dwordx4 v213, s[20:23], s59 offen lds
    buffer_load_dwordx4 v214, s[20:23], s59 offen offset:1024 lds
    buffer_load_dwordx4 v215, s[20:23], s59 offen offset:2048 lds
    buffer_load_dwordx4 v216, s[20:23], s59 offen offset:3072 lds
    s_waitcnt vmcnt(12)
    s_barrier
    s_cmp_lg_u32 s42, 1
    s_cbranch_scc1 wf_85
    s_lshr_b32 s55, s2, 5
    s_lshl_b32 s55, s55, 2
    s_add_u32 s55, s55, s0
    v_mov_b32 v252, 2144
    v_mov_b32 v253, 0x01010101
    s_mov_b64 exec, 1
    s_cmp_eq_u32 s45, 0
    s_cbranch_scc1 st_86
    buffer_store_dword v253, v252, s[4:7], s55 offen sc0 sc1
    s_branch st_87
st_86:
    buffer_store_dword v253, v252, s[4:7], s55 offen
st_87:
    s_mov_b64 exec, -1
wf_85:
    s_add_u32 m0, s62, 131072
    s_mov_b32 s92, 294912
    buffer_load_dwordx4 v217, s[4:7], s92 offen lds
    buffer_load_dwordx4 v217, s[4:7], s92 offen offset:1024 lds
    buffer_load_dwordx4 v217, s[4:7], s92 offen offset:2048 lds
    buffer_load_dwordx4 v217, s[4:7], s92 offen offset:3072 lds
    s_add_u32 m0, s62, 81920
    s_add_u32 s59, s69, 2359296
    buffer_load_dwordx4 v213, s[20:23], s59 offen lds
    buffer_load_dwordx4 v214, s[20:23], s59 offen offset:1024 lds
    buffer_load_dwordx4 v215, s[20:23], s59 offen offset:2048 lds
    buffer_load_dwordx4 v216, s[20:23], s59 offen offset:3072 lds
    s_waitcnt vmcnt(12)
    s_barrier
    s_add_u32 m0, s62, 98304
    s_mov_b32 s92, 311296
    buffer_load_dwordx4 v217, s[4:7], s92 offen lds
    buffer_load_dwordx4 v217, s[4:7], s92 offen offset:1024 lds
    buffer_load_dwordx4 v217, s[4:7], s92 offen offset:2048 lds
    buffer_load_dwordx4 v217, s[4:7], s92 offen offset:3072 lds
    s_add_u32 m0, s62, 0
    s_add_u32 s59, s69, 3014656
    buffer_load_dwordx4 v213, s[20:23], s59 offen lds
    buffer_load_dwordx4 v214, s[20:23], s59 offen offset:1024 lds
    buffer_load_dwordx4 v215, s[20:23], s59 offen offset:2048 lds
    buffer_load_dwordx4 v216, s[20:23], s59 offen offset:3072 lds
    s_waitcnt vmcnt(12)
    s_barrier
    s_add_u32 m0, s62, 114688
    s_mov_b32 s92, 327680
    buffer_load_dwordx4 v217, s[4:7], s92 offen lds
    buffer_load_dwordx4 v217, s[4:7], s92 offen offset:1024 lds
    buffer_load_dwordx4 v217, s[4:7], s92 offen offset:2048 lds
    buffer_load_dwordx4 v217, s[4:7], s92 offen offset:3072 lds
    s_add_u32 m0, s62, 16384
    s_add_u32 s59, s69, 3276800
    buffer_load_dwordx4 v213, s[20:23], s59 offen lds
    buffer_load_dwordx4 v214, s[20:23], s59 offen offset:1024 lds
    buffer_load_dwordx4 v215, s[20:23], s59 offen offset:2048 lds
    buffer_load_dwordx4 v216, s[20:23], s59 offen offset:3072 lds
    s_waitcnt vmcnt(12)
    s_barrier
    s_add_u32 m0, s62, 131072
    s_mov_b32 s92, 344064
    buffer_load_dwordx4 v217, s[4:7], s92 offen lds
    buffer_load_dwordx4 v217, s[4:7], s92 offen offset:1024 lds
    buffer_load_dwordx4 v217, s[4:7], s92 offen offset:2048 lds
    buffer_load_dwordx4 v217, s[4:7], s92 offen offset:3072 lds
    s_add_u32 m0, s62, 32768
    s_add_u32 s59, s69, 393216
    buffer_load_dwordx4 v213, s[20:23], s59 offen lds
    buffer_load_dwordx4 v214, s[20:23], s59 offen offset:1024 lds
    buffer_load_dwordx4 v215, s[20:23], s59 offen offset:2048 lds
    buffer_load_dwordx4 v216, s[20:23], s59 offen offset:3072 lds
    s_waitcnt vmcnt(12)
    s_barrier
    v_lshrrev_b32 v252, 2, v254
    v_min_u32 v252, 28, v252
    s_add_u32 s55, s0, 2144
    buffer_load_dword v251, v252, s[4:7], s55 offen sc0 sc1
    s_add_u32 m0, s62, 98304
    s_mov_b32 s92, 360448
    buffer_load_dwordx4 v217, s[4:7], s92 offen lds
    buffer_load_dwordx4 v217, s[4:7], s92 offen offset:1024 lds
    buffer_load_dwordx4 v217, s[4:7], s92 offen offset:2048 lds
    buffer_load_dwordx4 v217, s[4:7], s92 offen offset:3072 lds
    s_add_u32 m0, s62, 49152
    s_add_u32 s59, s69, 1310720
    buffer_load_dwordx4 v213, s[20:23], s59 offen lds
    buffer_load_dwordx4 v214, s[20:23], s59 offen offset:1024 lds
    buffer_load_dwordx4 v215, s[20:23], s59 offen offset:2048 lds
    buffer_load_dwordx4 v216, s[20:23], s59 offen offset:3072 lds
    s_waitcnt vmcnt(13)
    s_barrier
    s_add_u32 m0, s62, 114688
    s_mov_b32 s92, 376832
    buffer_load_dwordx4 v217, s[4:7], s92 offen lds
    buffer_load_dwordx4 v217, s[4:7], s92 offen offset:1024 lds
    buffer_load_dwordx4 v217, s[4:7], s92 offen offset:2048 lds
    buffer_load_dwordx4 v217, s[4:7], s92 offen offset:3072 lds
    s_add_u32 m0, s62, 65536
    s_add_u32 s59, s69, 2228224
    buffer_load_dwordx4 v213, s[20:23], s59 offen lds
    buffer_load_dwordx4 v214, s[20:23], s59 offen offset:1024 lds
    buffer_load_dwordx4 v215, s[20:23], s59 offen offset:2048 lds
    buffer_load_dwordx4 v216, s[20:23], s59 offen offset:3072 lds
    s_waitcnt vmcnt(12)
    s_barrier
    v_cmp_ne_u32 vcc, 0x01010101, v251
    s_cbranch_vccz ap_88
    v_lshrrev_b32 v252, 2, v254
    v_min_u32 v252, 28, v252
    s_add_u32 s55, s0, 2144
    s_mov_b32 s56, 262144
poll_89:
    buffer_load_dword v253, v252, s[4:7], s55 offen sc0 sc1
    s_waitcnt vmcnt(0)
    v_cmp_ne_u32 vcc, 0x01010101, v253
    s_cbranch_vccz pd_90
    s_sleep 1
    s_sub_u32 s56, s56, 1
    s_cmp_lg_u32 s56, 0
    s_cbranch_scc1 poll_89
pd_90:
ap_88:
    s_add_u32 m0, s62, 131072
    s_mov_b32 s92, 393216
    buffer_load_dwordx4 v217, s[4:7], s92 offen lds
    buffer_load_dwordx4 v217, s[4:7], s92 offen offset:1024 lds
    buffer_load_dwordx4 v217, s[4:7], s92 offen offset:2048 lds
    buffer_load_dwordx4 v217, s[4:7], s92 offen offset:3072 lds
    s_add_u32 m0, s62, 81920
    s_add_u32 s59, s69, 3145728
    buffer_load_dwordx4 v213, s[20:23], s59 offen lds
    buffer_load_dwordx4 v214, s[20:23], s59 offen offset:1024 lds
    buffer_load_dwordx4 v215, s[20:23], s59 offen offset:2048 lds
    buffer_load_dwordx4 v216, s[20:23], s59 offen offset:3072 lds
    s_waitcnt vmcnt(12)
    s_barrier
    s_add_u32 m0, s62, 98304
    s_mov_b32 s92, 409600
    buffer_load_dwordx4 v217, s[4:7], s92 offen lds
    buffer_load_dwordx4 v217, s[4:7], s92 offen offset:1024 lds
    buffer_load_dwordx4 v217, s[4:7], s92 offen offset:2048 lds
    buffer_load_dwordx4 v217, s[4:7], s92 offen offset:3072 lds
    s_lshl_b32 s93, s51, 12
    s_add_u32 m0, s61, 0
    s_mul_i32 s59, s93, 96
    buffer_load_dwordx4 v200, s[8:11], s59 offen lds
    buffer_load_dwordx4 v201, s[8:11], s59 offen offset:1024 lds
    buffer_load_dwordx4 v202, s[8:11], s59 offen offset:2048 lds
    s_add_u32 s93, s93, 2048
    s_and_b32 s93, s93, 65535
    s_waitcnt vmcnt(11)
    s_barrier
    s_add_u32 m0, s62, 114688
    s_mov_b32 s92, 425984
    buffer_load_dwordx4 v217, s[4:7], s92 offen lds
    buffer_load_dwordx4 v217, s[4:7], s92 offen offset:1024 lds
    buffer_load_dwordx4 v217, s[4:7], s92 offen offset:2048 lds
    buffer_load_dwordx4 v217, s[4:7], s92 offen offset:3072 lds
    s_add_u32 m0, s61, 16384
    s_mul_i32 s59, s93, 96
    buffer_load_dwordx4 v200, s[8:11], s59 offen lds
    buffer_load_dwordx4 v201, s[8:11], s59 offen offset:1024 lds
    buffer_load_dwordx4 v202, s[8:11], s59 offen offset:2048 lds
    s_add_u32 s93, s93, 6144
    s_and_b32 s93, s93, 65535
    s_waitcnt vmcnt(10)
    s_barrier
    s_add_u32 m0, s62, 131072
    s_mov_b32 s92, 442368
    buffer_load_dwordx4 v217, s[4:7], s92 offen lds
    buffer_load_dwordx4 v217, s[4:7], s92 offen offset:1024 lds
    buffer_load_dwordx4 v217, s[4:7], s92 offen offset:2048 lds
    buffer_load_dwordx4 v217, s[4:7], s92 offen offset:3072 lds
    s_add_u32 m0, s61, 32768
    s_mul_i32 s59, s93, 96
    buffer_load_dwordx4 v200, s[8:11], s59 offen lds
    buffer_load_dwordx4 v201, s[8:11], s59 offen offset:1024 lds
    buffer_load_dwordx4 v202, s[8:11], s59 offen offset:2048 lds
    s_add_u32 s93, s93, 2048
    s_and_b32 s93, s93, 65535
    s_waitcnt vmcnt(10)
    s_barrier
    s_add_u32 m0, s61, 49152
    s_mul_i32 s59, s93, 96
    buffer_load_dwordx4 v200, s[8:11], s59 offen lds
    buffer_load_dwordx4 v201, s[8:11], s59 offen offset:1024 lds
    buffer_load_dwordx4 v202, s[8:11], s59 offen offset:2048 lds
    s_add_u32 s93, s93, 6144
    s_and_b32 s93, s93, 65535
    s_waitcnt vmcnt(6)
    s_barrier
    s_add_u32 m0, s61, 65536
    s_mul_i32 s59, s93, 96
    buffer_load_dwordx4 v200, s[8:11], s59 offen lds
    buffer_load_dwordx4 v201, s[8:11], s59 offen offset:1024 lds
    buffer_load_dwordx4 v202, s[8:11], s59 offen offset:2048 lds
    s_add_u32 s93, s93, 2048
    s_and_b32 s93, s93, 65535
    s_barrier
    s_add_u32 m0, s61, 81920
    s_mul_i32 s59, s93, 96
    buffer_load_dwordx4 v200, s[8:11], s59 offen lds
    buffer_load_dwordx4 v201, s[8:11], s59 offen offset:1024 lds
    buffer_load_dwordx4 v202, s[8:11], s59 offen offset:2048 lds
    s_add_u32 s93, s93, 6144
    s_and_b32 s93, s93, 65535
    s_setprio 0
    s_cmp_lg_u32 s46, 0
    s_cbranch_scc1 K_end
    s_mov_b32 s46, 1
    s_add_u32 s47, s47, 262144
    s_add_u32 s49, s49, 524288
    s_add_u32 s50, s50, 917504
    s_add_u32 s52, s52, 65536
    s_add_u32 s54, s54, 32768
    s_add_u32 s0, s0, 32768
    s_branch Y_layer
K_end:
    s_endpgm

.section .rodata,"a"
.p2align 6
.amdhsa_kernel interleave_layers__sliding_local_dilated__glu_gated_swiglu__prompt_kernel
  .amdhsa_next_free_vgpr 256
  .amdhsa_next_free_sgpr 102
  .amdhsa_accum_offset 256
  .amdhsa_group_segment_fixed_size 0
  .amdhsa_kernarg_size 80
  .amdhsa_user_sgpr_count 2
  .amdhsa_user_sgpr_kernarg_segment_ptr 1
  .amdhsa_system_sgpr_workgroup_id_x 1
.end_amdhsa_kernel
```

```asm
; @launch grid=(256,1,1) block=(512,1,1) lds=163840
.amdgcn_target "amdgcn-amd-amdhsa--gfx950"
.text
.globl interleave_layers__sliding_local_dilated__glu_gated_swiglu__prompt_kernel
.p2align 8
.type interleave_layers__sliding_local_dilated__glu_gated_swiglu__prompt_kernel,@function
interleave_layers__sliding_local_dilated__glu_gated_swiglu__prompt_kernel:
    s_cmp_ge_u32 s2, 256
    s_cbranch_scc0 K_go
    s_endpgm
K_go:
    s_load_dwordx4 s[72:75], s[0:1], 0
    s_load_dwordx2 s[76:77], s[0:1], 16
    s_load_dwordx8 s[80:87], s[0:1], 32
    s_load_dwordx4 s[88:91], s[0:1], 64
    v_lshrrev_b32 v1, 6, v0
    v_and_b32 v254, 63, v0
    v_readfirstlane_b32 s3, v1
    v_lshlrev_b32 v254, 4, v254
    s_and_b32 s55, s2, 6
    s_lshl_b32 s55, s55, 1
    s_lshr_b32 s56, s2, 3
    s_and_b32 s56, s56, 3
    s_add_u32 s40, s55, s56
    s_and_b32 s55, s2, 1
    s_lshr_b32 s56, s2, 5
    s_lshl_b32 s41, s55, 3
    s_add_u32 s41, s41, s56
    s_lshl_b32 s51, s56, 1
    s_add_u32 s51, s51, s55
    s_and_b32 s42, s3, 3
    s_and_b32 s43, s3, 1
    s_lshr_b32 s44, s42, 1
    s_lshl_b32 s55, s43, 1
    s_add_u32 s55, s55, s44
    s_mul_i32 s61, s55, 3072
    s_lshl_b32 s62, s55, 12
    s_mov_b32 s45, 1
    s_mov_b32 s46, 0
    s_lshl_b32 s47, s40, 22
    s_add_u32 s49, s47, 524288
    s_add_u32 s48, s47, 786432
    s_add_u32 s50, s47, 2097152
    s_add_u32 s52, s47, 1835008
    s_add_u32 s53, s52, 32768
    s_lshl_b32 s54, s40, 7
    s_add_u32 s54, s54, 71303168
    s_lshl_b32 s63, s51, 7
    s_lshl_b32 s55, s44, 16
    s_add_u32 s64, s63, s55
    s_mul_i32 s55, s44, 114688
    s_mul_i32 s56, s41, 448
    s_add_u32 s55, s55, s56
    s_and_b32 s56, s41, 1
    s_mul_i32 s56, s56, 192
    s_add_u32 s65, s55, s56
    s_sub_u32 s66, s55, s56
    s_add_u32 s66, s66, 256
    s_lshl_b32 s55, s43, 4
    s_add_u32 s55, s55, s41
    s_lshl_b32 s55, s55, 6
    s_add_u32 s55, s55, s44
    s_lshl_b32 s55, s55, 10
    s_add_u32 s67, s55, 67106816
    s_and_b32 s55, s51, 1
    s_mul_i32 s55, s55, 3670016
    s_lshr_b32 s56, s51, 1
    s_lshl_b32 s56, s56, 8
    s_add_u32 s55, s55, s56
    s_lshl_b32 s56, s44, 15
    s_add_u32 s55, s55, s56
    s_lshl_b32 s56, s43, 16
    s_add_u32 s69, s55, s56
    s_add_u32 s68, s69, s56
    s_waitcnt lgkmcnt(0)
    s_mov_b32 s8, s74
    s_mov_b32 s9, s75
    s_mov_b32 s10, 6291456
    s_mov_b32 s11, 0x00020000
    s_mov_b32 s36, s72
    s_mov_b32 s37, s73
    s_mov_b32 s38, 4194304
    s_mov_b32 s39, 0x00020000
    s_mov_b32 s4, s90
    s_mov_b32 s5, s91
    s_mov_b32 s6, 268435456
    s_mov_b32 s7, 0x00020000
    s_mov_b32 s24, s72
    s_mov_b32 s25, s73
    s_mov_b32 s26, 4194304
    s_mov_b32 s27, 0x00020000
    s_mov_b32 s12, s76
    s_mov_b32 s13, s77
    s_mov_b32 s14, 2097152
    s_mov_b32 s15, 0x00020000
    s_cmp_eq_u32 s43, 0
    s_cselect_b32 s16, s80, s82
    s_cselect_b32 s17, s81, s83
    s_mov_b32 s18, 7340032
    s_mov_b32 s19, 0x00020000
    s_mov_b32 s20, s84
    s_mov_b32 s21, s85
    s_mov_b32 s22, 7340032
    s_mov_b32 s23, 0x00020000
    s_mov_b32 s28, s86
    s_mov_b32 s29, s87
    s_mov_b32 s30, 4194304
    s_mov_b32 s31, 0x00020000
    s_mov_b32 s32, s88
    s_mov_b32 s33, s89
    s_mov_b32 s34, 256
    s_mov_b32 s35, 0x00020000
    s_and_b32 s55, s2, 1
    s_lshl_b32 s55, s55, 13
    s_add_u32 s55, s55, 16384
    s_add_u32 s0, s54, s55
    s_lshl_b32 s55, s51, 14
    s_lshl_b32 s56, s43, 13
    s_add_u32 s55, s55, s56
    s_lshl_b32 s56, s44, 10
    s_add_u32 s1, s55, s56
    s_cmp_lt_u32 s3, 4
    s_cbranch_scc1 X_start
    v_lshrrev_b32 v224, 7, v254
    v_and_b32 v225, 0x70, v254
    v_and_b32 v226, 6, v224
    v_lshlrev_b32 v226, 4, v226
    v_xor_b32 v225, v225, v226
    v_and_b32 v226, 4, v224
    v_add_u32 v224, v224, v226
    v_mul_u32_u24 v224, 6144, v224
    v_add3_u32 v224, v224, v225, s63
    s_lshr_b32 s55, s61, 10
    s_add_u32 s55, s55, 0
    s_and_b32 s56, s55, 3
    s_and_b32 s57, s56, 1
    s_lshl_b32 s57, s57, 4
    s_and_b32 s56, s56, 2
    s_lshl_b32 s56, s56, 1
    s_add_u32 s56, s56, s57
    s_mul_i32 s56, s56, 6144
    s_lshr_b32 s55, s55, 2
    s_lshl_b32 s55, s55, 11
    s_add_u32 s55, s55, s56
    s_sub_u32 s55, s55, 0
    v_add_u32 v200, s55, v224
    s_lshr_b32 s55, s61, 10
    s_add_u32 s55, s55, 1
    s_and_b32 s56, s55, 3
    s_and_b32 s57, s56, 1
    s_lshl_b32 s57, s57, 4
    s_and_b32 s56, s56, 2
    s_lshl_b32 s56, s56, 1
    s_add_u32 s56, s56, s57
    s_mul_i32 s56, s56, 6144
    s_lshr_b32 s55, s55, 2
    s_lshl_b32 s55, s55, 11
    s_add_u32 s55, s55, s56
    s_sub_u32 s55, s55, 1024
    v_add_u32 v201, s55, v224
    s_lshr_b32 s55, s61, 10
    s_add_u32 s55, s55, 2
    s_and_b32 s56, s55, 3
    s_and_b32 s57, s56, 1
    s_lshl_b32 s57, s57, 4
    s_and_b32 s56, s56, 2
    s_lshl_b32 s56, s56, 1
    s_add_u32 s56, s56, s57
    s_mul_i32 s56, s56, 6144
    s_lshr_b32 s55, s55, 2
    s_lshl_b32 s55, s55, 11
    s_add_u32 s55, s55, s56
    s_sub_u32 s55, s55, 2048
    v_add_u32 v202, s55, v224
    s_lshl_b32 s93, s51, 12
    s_add_u32 m0, s61, 0
    s_mul_i32 s59, s93, 96
    buffer_load_dwordx4 v200, s[8:11], s59 offen lds
    buffer_load_dwordx4 v201, s[8:11], s59 offen offset:1024 lds
    buffer_load_dwordx4 v202, s[8:11], s59 offen offset:2048 lds
    s_add_u32 s93, s93, 2048
    s_and_b32 s93, s93, 65535
    s_lshl_b32 s55, s40, 18
    s_lshl_b32 s56, s62, 4
    s_add_u32 s88, s55, s56
    s_lshl_b32 s56, s43, 14
    s_add_u32 s89, s55, s56
    s_sub_u32 s89, s89, 32768
    v_lshrrev_b32 v224, 7, v254
    v_and_b32 v225, 0x70, v254
    v_and_b32 v226, 6, v224
    v_lshlrev_b32 v226, 4, v226
    v_xor_b32 v225, v225, v226
    v_mul_u32_u24 v224, 2048, v224
    v_add3_u32 v217, v224, v225, s88
    v_add_u32 v218, 15360, v217
    v_add_u32 v219, 30720, v217
    v_add_u32 v220, 46080, v217
    s_lshl_b32 s94, s51, 7
    s_cmp_eq_u32 s40, 0
    s_cselect_b32 s89, 2130706432, s89
    s_sub_u32 s89, s89, s88
    v_add_u32 v221, s89, v217
    s_lshl_b32 s91, s43, 10
    s_cmp_eq_u32 s44, 0
    s_cselect_b32 s84, -1, 0
    s_not_b32 s85, s84
    s_add_u32 m0, s91, 98304
    s_mov_b64 exec, s[84:85]
    buffer_load_dwordx4 v221, s[36:39], s94 offen lds
    s_mov_b64 exec, -1
    s_add_u32 m0, s62, 100352
    s_nop 0
    buffer_load_dwordx4 v217, s[36:39], s94 offen lds
    buffer_load_dwordx4 v218, s[36:39], s94 offen offset:1024 lds
    buffer_load_dwordx4 v219, s[36:39], s94 offen offset:2048 lds
    buffer_load_dwordx4 v220, s[36:39], s94 offen offset:3072 lds
    s_add_u32 s94, s94, 256
    s_and_b32 s94, s94, 2047
    s_add_u32 m0, s61, 16384
    s_mul_i32 s59, s93, 96
    buffer_load_dwordx4 v200, s[8:11], s59 offen lds
    buffer_load_dwordx4 v201, s[8:11], s59 offen offset:1024 lds
    buffer_load_dwordx4 v202, s[8:11], s59 offen offset:2048 lds
    s_add_u32 s93, s93, 6144
    s_and_b32 s93, s93, 65535
    s_cmp_lt_u32 s2, 128
    s_cselect_b32 s72, s80, s82
    s_cselect_b32 s73, s81, s83
    s_mov_b32 s74, 7340032
    s_mov_b32 s75, 0x00020000
    s_and_b32 s55, s2, 127
    s_mul_i32 s55, s55, 57344
    s_lshl_b32 s56, s42, 14
    s_add_u32 s55, s55, s56
    v_lshlrev_b32 v227, 3, v254
    buffer_load_dword v251, v227, s[72:75], s55 offen
    s_cmp_eq_u32 s42, 3
    s_cbranch_scc1 t_1
    s_add_u32 s55, s55, 8192
    buffer_load_dword v251, v227, s[72:75], s55 offen
    s_branch t_2
t_1:
    s_lshl_b32 s55, s2, 13
    buffer_load_dword v251, v227, s[12:15], s55 offen
t_2:
    s_add_u32 m0, s91, 116736
    s_mov_b64 exec, s[84:85]
    buffer_load_dwordx4 v221, s[36:39], s94 offen lds
    s_mov_b64 exec, -1
    s_add_u32 m0, s62, 118784
    s_nop 0
    buffer_load_dwordx4 v217, s[36:39], s94 offen lds
    buffer_load_dwordx4 v218, s[36:39], s94 offen offset:1024 lds
    buffer_load_dwordx4 v219, s[36:39], s94 offen offset:2048 lds
    buffer_load_dwordx4 v220, s[36:39], s94 offen offset:3072 lds
    s_add_u32 s94, s94, 256
    s_and_b32 s94, s94, 2047
    s_add_u32 m0, s61, 32768
    s_mul_i32 s59, s93, 96
    buffer_load_dwordx4 v200, s[8:11], s59 offen lds
    buffer_load_dwordx4 v201, s[8:11], s59 offen offset:1024 lds
    buffer_load_dwordx4 v202, s[8:11], s59 offen offset:2048 lds
    s_add_u32 s93, s93, 2048
    s_and_b32 s93, s93, 65535
    s_add_u32 m0, s91, 135168
    s_mov_b64 exec, s[84:85]
    buffer_load_dwordx4 v221, s[36:39], s94 offen lds
    s_mov_b64 exec, -1
    s_add_u32 m0, s62, 137216
    s_nop 0
    buffer_load_dwordx4 v217, s[36:39], s94 offen lds
    buffer_load_dwordx4 v218, s[36:39], s94 offen offset:1024 lds
    buffer_load_dwordx4 v219, s[36:39], s94 offen offset:2048 lds
    buffer_load_dwordx4 v220, s[36:39], s94 offen offset:3072 lds
    s_add_u32 s94, s94, 256
    s_and_b32 s94, s94, 2047
    s_add_u32 m0, s61, 49152
    s_mul_i32 s59, s93, 96
    buffer_load_dwordx4 v200, s[8:11], s59 offen lds
    buffer_load_dwordx4 v201, s[8:11], s59 offen offset:1024 lds
    buffer_load_dwordx4 v202, s[8:11], s59 offen offset:2048 lds
    s_add_u32 s93, s93, 6144
    s_and_b32 s93, s93, 65535
    s_add_u32 m0, s61, 65536
    s_mul_i32 s59, s93, 96
    buffer_load_dwordx4 v200, s[8:11], s59 offen lds
    buffer_load_dwordx4 v201, s[8:11], s59 offen offset:1024 lds
    buffer_load_dwordx4 v202, s[8:11], s59 offen offset:2048 lds
    s_add_u32 s93, s93, 2048
    s_and_b32 s93, s93, 65535
    s_add_u32 m0, s61, 81920
    s_mul_i32 s59, s93, 96
    buffer_load_dwordx4 v200, s[8:11], s59 offen lds
    buffer_load_dwordx4 v201, s[8:11], s59 offen offset:1024 lds
    buffer_load_dwordx4 v202, s[8:11], s59 offen offset:2048 lds
    s_add_u32 s93, s93, 6144
    s_and_b32 s93, s93, 65535
    s_branch Y_first
X_start:
    s_cmp_lg_u32 s42, 0
    s_cbranch_scc1 xz_5
    v_mov_b32 v103, 0
    v_lshrrev_b32 v100, 2, v254
    s_lshl_b32 s55, s2, 8
    s_add_u32 s55, s55, 71303168
    buffer_store_dword v103, v100, s[4:7], s55 offen sc0 sc1
    v_lshlrev_b32 v100, 6, v254
    s_lshl_b32 s55, s2, 2
    s_add_u32 s55, s55, 71565312
    s_mov_b64 exec, 15
    buffer_store_dword v103, v100, s[4:7], s55 offen sc0 sc1
    s_mov_b64 exec, -1
xz_5:
    s_getpc_b64 s[72:73]
K_pc:
    s_mov_b32 s74, K_end-K_pc
    s_mov_b32 s75, 0x00020000
    s_lshr_b32 s55, s2, 3
    s_lshl_b32 s55, s55, 2
    s_add_u32 s55, s55, s42
    s_lshl_b32 s55, s55, 10
    v_lshlrev_b32 v100, 3, v254
    s_mov_b64 exec, 0xff
    buffer_load_dword v101, v100, s[72:75], s55 offen
    s_mov_b64 exec, -1
    v_lshrrev_b32 v100, 7, v254
    v_and_b32 v102, 0x70, v254
    s_cmp_eq_u32 s42, 3
    s_cbranch_scc1 xp_3
    v_mul_u32_u24 v100, 6144, v100
    v_add_u32 v100, v100, v102
    s_mul_i32 s56, s2, 3
    s_add_u32 s56, s56, s42
    s_and_b32 s55, s56, 15
    s_mul_i32 s55, s55, 393216
    s_lshr_b32 s57, s56, 4
    s_lshl_b32 s57, s57, 7
    s_add_u32 s55, s55, s57
    buffer_load_dwordx4 v[0:3], v100, s[8:11], s55 offen
    s_add_u32 s55, s55, 49152
    buffer_load_dwordx4 v[4:7], v100, s[8:11], s55 offen
    s_add_u32 s55, s55, 49152
    buffer_load_dwordx4 v[8:11], v100, s[8:11], s55 offen
    s_add_u32 s55, s55, 49152
    buffer_load_dwordx4 v[12:15], v100, s[8:11], s55 offen
    s_add_u32 s55, s55, 49152
    buffer_load_dwordx4 v[16:19], v100, s[8:11], s55 offen
    s_add_u32 s55, s55, 49152
    buffer_load_dwordx4 v[20:23], v100, s[8:11], s55 offen
    s_add_u32 s55, s55, 49152
    buffer_load_dwordx4 v[24:27], v100, s[8:11], s55 offen
    s_add_u32 s55, s55, 49152
    buffer_load_dwordx4 v[28:31], v100, s[8:11], s55 offen
    s_add_u32 s55, s55, 49152
    v_mov_b32 v64, 0
    v_mov_b32 v65, 0
    v_mov_b32 v66, 0
    v_mov_b32 v67, 0
    v_mov_b32 v68, 0
    v_mov_b32 v69, 0
    v_mov_b32 v70, 0
    v_mov_b32 v71, 0
    v_mov_b32 v102, 0x00003f80
    v_mov_b32 v103, 0x3f800000
    s_waitcnt vmcnt(7)
    v_dot2_f32_bf16 v64, v0, v102, v64
    v_dot2_f32_bf16 v65, v0, v103, v65
    v_dot2_f32_bf16 v66, v1, v102, v66
    v_dot2_f32_bf16 v67, v1, v103, v67
    v_dot2_f32_bf16 v68, v2, v102, v68
    v_dot2_f32_bf16 v69, v2, v103, v69
    v_dot2_f32_bf16 v70, v3, v102, v70
    v_dot2_f32_bf16 v71, v3, v103, v71
    s_waitcnt vmcnt(6)
    v_dot2_f32_bf16 v64, v4, v102, v64
    v_dot2_f32_bf16 v65, v4, v103, v65
    v_dot2_f32_bf16 v66, v5, v102, v66
    v_dot2_f32_bf16 v67, v5, v103, v67
    v_dot2_f32_bf16 v68, v6, v102, v68
    v_dot2_f32_bf16 v69, v6, v103, v69
    v_dot2_f32_bf16 v70, v7, v102, v70
    v_dot2_f32_bf16 v71, v7, v103, v71
    s_waitcnt vmcnt(5)
    v_dot2_f32_bf16 v64, v8, v102, v64
    v_dot2_f32_bf16 v65, v8, v103, v65
    v_dot2_f32_bf16 v66, v9, v102, v66
    v_dot2_f32_bf16 v67, v9, v103, v67
    v_dot2_f32_bf16 v68, v10, v102, v68
    v_dot2_f32_bf16 v69, v10, v103, v69
    v_dot2_f32_bf16 v70, v11, v102, v70
    v_dot2_f32_bf16 v71, v11, v103, v71
    s_waitcnt vmcnt(4)
    v_dot2_f32_bf16 v64, v12, v102, v64
    v_dot2_f32_bf16 v65, v12, v103, v65
    v_dot2_f32_bf16 v66, v13, v102, v66
    v_dot2_f32_bf16 v67, v13, v103, v67
    v_dot2_f32_bf16 v68, v14, v102, v68
    v_dot2_f32_bf16 v69, v14, v103, v69
    v_dot2_f32_bf16 v70, v15, v102, v70
    v_dot2_f32_bf16 v71, v15, v103, v71
    s_waitcnt vmcnt(3)
    v_dot2_f32_bf16 v64, v16, v102, v64
    v_dot2_f32_bf16 v65, v16, v103, v65
    v_dot2_f32_bf16 v66, v17, v102, v66
    v_dot2_f32_bf16 v67, v17, v103, v67
    v_dot2_f32_bf16 v68, v18, v102, v68
    v_dot2_f32_bf16 v69, v18, v103, v69
    v_dot2_f32_bf16 v70, v19, v102, v70
    v_dot2_f32_bf16 v71, v19, v103, v71
    s_waitcnt vmcnt(2)
    v_dot2_f32_bf16 v64, v20, v102, v64
    v_dot2_f32_bf16 v65, v20, v103, v65
    v_dot2_f32_bf16 v66, v21, v102, v66
    v_dot2_f32_bf16 v67, v21, v103, v67
    v_dot2_f32_bf16 v68, v22, v102, v68
    v_dot2_f32_bf16 v69, v22, v103, v69
    v_dot2_f32_bf16 v70, v23, v102, v70
    v_dot2_f32_bf16 v71, v23, v103, v71
    s_waitcnt vmcnt(1)
    v_dot2_f32_bf16 v64, v24, v102, v64
    v_dot2_f32_bf16 v65, v24, v103, v65
    v_dot2_f32_bf16 v66, v25, v102, v66
    v_dot2_f32_bf16 v67, v25, v103, v67
    v_dot2_f32_bf16 v68, v26, v102, v68
    v_dot2_f32_bf16 v69, v26, v103, v69
    v_dot2_f32_bf16 v70, v27, v102, v70
    v_dot2_f32_bf16 v71, v27, v103, v71
    s_waitcnt vmcnt(0)
    v_dot2_f32_bf16 v64, v28, v102, v64
    v_dot2_f32_bf16 v65, v28, v103, v65
    v_dot2_f32_bf16 v66, v29, v102, v66
    v_dot2_f32_bf16 v67, v29, v103, v67
    v_dot2_f32_bf16 v68, v30, v102, v68
    v_dot2_f32_bf16 v69, v30, v103, v69
    v_dot2_f32_bf16 v70, v31, v102, v70
    v_dot2_f32_bf16 v71, v31, v103, v71
    s_cmp_lg_u32 s42, 0
    s_cbranch_scc1 xz_6
    s_getreg_b32 s59, hwreg(HW_REG_XCC_ID, 0, 4)
    s_mul_i32 s55, s59, s59
    s_lshl_b32 s55, s55, 15
    s_lshl_b32 s59, s59, 6
    s_add_u32 s59, s59, s55
    s_add_u32 s59, s59, 1
    v_mov_b32 v253, s59
    s_and_b32 s55, s2, 7
    s_lshl_b32 s55, s55, 5
    v_mov_b32 v252, 0
    s_mov_b64 exec, 1
    buffer_atomic_add v253, v252, s[32:35], s55 offen sc1
    s_mov_b64 exec, -1
xz_6:
    s_nop 3
    v_add_f32_dpp v64, v64, v64 row_ror:8 row_mask:0xf bank_mask:0xf
    v_add_f32_dpp v65, v65, v65 row_ror:8 row_mask:0xf bank_mask:0xf
    v_add_f32_dpp v66, v66, v66 row_ror:8 row_mask:0xf bank_mask:0xf
    v_add_f32_dpp v67, v67, v67 row_ror:8 row_mask:0xf bank_mask:0xf
    v_add_f32_dpp v68, v68, v68 row_ror:8 row_mask:0xf bank_mask:0xf
    v_add_f32_dpp v69, v69, v69 row_ror:8 row_mask:0xf bank_mask:0xf
    v_add_f32_dpp v70, v70, v70 row_ror:8 row_mask:0xf bank_mask:0xf
    v_add_f32_dpp v71, v71, v71 row_ror:8 row_mask:0xf bank_mask:0xf
    v_mov_b32 v80, v64
    v_mov_b32 v81, v65
    v_mov_b32 v82, v66
    v_mov_b32 v83, v67
    v_mov_b32 v84, v68
    v_mov_b32 v85, v69
    v_mov_b32 v86, v70
    v_mov_b32 v87, v71
    s_nop 1
    v_permlane16_swap_b32 v64, v80
    v_permlane16_swap_b32 v65, v81
    v_permlane16_swap_b32 v66, v82
    v_permlane16_swap_b32 v67, v83
    v_permlane16_swap_b32 v68, v84
    v_permlane16_swap_b32 v69, v85
    v_permlane16_swap_b32 v70, v86
    v_permlane16_swap_b32 v71, v87
    v_add_f32 v64, v64, v80
    v_add_f32 v65, v65, v81
    v_add_f32 v66, v66, v82
    v_add_f32 v67, v67, v83
    v_add_f32 v68, v68, v84
    v_add_f32 v69, v69, v85
    v_add_f32 v70, v70, v86
    v_add_f32 v71, v71, v87
    v_mov_b32 v80, v64
    v_mov_b32 v81, v65
    v_mov_b32 v82, v66
    v_mov_b32 v83, v67
    v_mov_b32 v84, v68
    v_mov_b32 v85, v69
    v_mov_b32 v86, v70
    v_mov_b32 v87, v71
    s_nop 1
    v_permlane32_swap_b32 v64, v80
    v_permlane32_swap_b32 v65, v81
    v_permlane32_swap_b32 v66, v82
    v_permlane32_swap_b32 v67, v83
    v_permlane32_swap_b32 v68, v84
    v_permlane32_swap_b32 v69, v85
    v_permlane32_swap_b32 v70, v86
    v_permlane32_swap_b32 v71, v87
    v_add_f32 v64, v64, v80
    v_add_f32 v65, v65, v81
    v_add_f32 v66, v66, v82
    v_add_f32 v67, v67, v83
    v_add_f32 v68, v68, v84
    v_add_f32 v69, v69, v85
    v_add_f32 v70, v70, v86
    v_add_f32 v71, v71, v87
    s_and_b32 s55, s56, 15
    s_mul_i32 s55, s55, 12288
    s_lshl_b32 s57, s57, 1
    s_add_u32 s55, s55, s57
    s_add_u32 s55, s55, 70516736
    v_lshlrev_b32 v100, 1, v254
    s_mov_b64 exec, 0xff
    buffer_store_dwordx4 v[64:67], v100, s[4:7], s55 offen sc0 sc1
    buffer_store_dwordx4 v[68:71], v100, s[4:7], s55 offen offset:16 sc0 sc1
    s_mov_b64 exec, -1
    s_branch xp_4
xp_3:
    v_lshl_add_u32 v100, v100, 11, v102
    s_lshl_b32 s55, s2, 14
    buffer_load_dwordx4 v[0:3], v100, s[24:27], s55 offen offset:0
    buffer_load_dwordx4 v[4:7], v100, s[24:27], s55 offen offset:128
    buffer_load_dwordx4 v[8:11], v100, s[24:27], s55 offen offset:256
    buffer_load_dwordx4 v[12:15], v100, s[24:27], s55 offen offset:384
    buffer_load_dwordx4 v[16:19], v100, s[24:27], s55 offen offset:512
    buffer_load_dwordx4 v[20:23], v100, s[24:27], s55 offen offset:640
    buffer_load_dwordx4 v[24:27], v100, s[24:27], s55 offen offset:768
    buffer_load_dwordx4 v[28:31], v100, s[24:27], s55 offen offset:896
    buffer_load_dwordx4 v[32:35], v100, s[24:27], s55 offen offset:1024
    buffer_load_dwordx4 v[36:39], v100, s[24:27], s55 offen offset:1152
    buffer_load_dwordx4 v[40:43], v100, s[24:27], s55 offen offset:1280
    buffer_load_dwordx4 v[44:47], v100, s[24:27], s55 offen offset:1408
    buffer_load_dwordx4 v[48:51], v100, s[24:27], s55 offen offset:1536
    buffer_load_dwordx4 v[52:55], v100, s[24:27], s55 offen offset:1664
    buffer_load_dwordx4 v[56:59], v100, s[24:27], s55 offen offset:1792
    buffer_load_dwordx4 v[60:63], v100, s[24:27], s55 offen offset:1920
    v_mov_b32 v64, 0
    v_mov_b32 v65, 0
    v_mov_b32 v66, 0
    v_mov_b32 v67, 0
    v_mov_b32 v102, 0x3f803f80
    s_waitcnt vmcnt(15)
    v_dot2_f32_bf16 v64, v0, v102, v64
    v_dot2_f32_bf16 v65, v0, v0, v65
    v_dot2_f32_bf16 v66, v1, v102, v66
    v_dot2_f32_bf16 v67, v1, v1, v67
    v_dot2_f32_bf16 v64, v2, v102, v64
    v_dot2_f32_bf16 v65, v2, v2, v65
    v_dot2_f32_bf16 v66, v3, v102, v66
    v_dot2_f32_bf16 v67, v3, v3, v67
    s_waitcnt vmcnt(14)
    v_dot2_f32_bf16 v64, v4, v102, v64
    v_dot2_f32_bf16 v65, v4, v4, v65
    v_dot2_f32_bf16 v66, v5, v102, v66
    v_dot2_f32_bf16 v67, v5, v5, v67
    v_dot2_f32_bf16 v64, v6, v102, v64
    v_dot2_f32_bf16 v65, v6, v6, v65
    v_dot2_f32_bf16 v66, v7, v102, v66
    v_dot2_f32_bf16 v67, v7, v7, v67
    s_waitcnt vmcnt(13)
    v_dot2_f32_bf16 v64, v8, v102, v64
    v_dot2_f32_bf16 v65, v8, v8, v65
    v_dot2_f32_bf16 v66, v9, v102, v66
    v_dot2_f32_bf16 v67, v9, v9, v67
    v_dot2_f32_bf16 v64, v10, v102, v64
    v_dot2_f32_bf16 v65, v10, v10, v65
    v_dot2_f32_bf16 v66, v11, v102, v66
    v_dot2_f32_bf16 v67, v11, v11, v67
    s_waitcnt vmcnt(12)
    v_dot2_f32_bf16 v64, v12, v102, v64
    v_dot2_f32_bf16 v65, v12, v12, v65
    v_dot2_f32_bf16 v66, v13, v102, v66
    v_dot2_f32_bf16 v67, v13, v13, v67
    v_dot2_f32_bf16 v64, v14, v102, v64
    v_dot2_f32_bf16 v65, v14, v14, v65
    v_dot2_f32_bf16 v66, v15, v102, v66
    v_dot2_f32_bf16 v67, v15, v15, v67
    s_waitcnt vmcnt(11)
    v_dot2_f32_bf16 v64, v16, v102, v64
    v_dot2_f32_bf16 v65, v16, v16, v65
    v_dot2_f32_bf16 v66, v17, v102, v66
    v_dot2_f32_bf16 v67, v17, v17, v67
    v_dot2_f32_bf16 v64, v18, v102, v64
    v_dot2_f32_bf16 v65, v18, v18, v65
    v_dot2_f32_bf16 v66, v19, v102, v66
    v_dot2_f32_bf16 v67, v19, v19, v67
    s_waitcnt vmcnt(10)
    v_dot2_f32_bf16 v64, v20, v102, v64
    v_dot2_f32_bf16 v65, v20, v20, v65
    v_dot2_f32_bf16 v66, v21, v102, v66
    v_dot2_f32_bf16 v67, v21, v21, v67
    v_dot2_f32_bf16 v64, v22, v102, v64
    v_dot2_f32_bf16 v65, v22, v22, v65
    v_dot2_f32_bf16 v66, v23, v102, v66
    v_dot2_f32_bf16 v67, v23, v23, v67
    s_waitcnt vmcnt(9)
    v_dot2_f32_bf16 v64, v24, v102, v64
    v_dot2_f32_bf16 v65, v24, v24, v65
    v_dot2_f32_bf16 v66, v25, v102, v66
    v_dot2_f32_bf16 v67, v25, v25, v67
    v_dot2_f32_bf16 v64, v26, v102, v64
    v_dot2_f32_bf16 v65, v26, v26, v65
    v_dot2_f32_bf16 v66, v27, v102, v66
    v_dot2_f32_bf16 v67, v27, v27, v67
    s_waitcnt vmcnt(8)
    v_dot2_f32_bf16 v64, v28, v102, v64
    v_dot2_f32_bf16 v65, v28, v28, v65
    v_dot2_f32_bf16 v66, v29, v102, v66
    v_dot2_f32_bf16 v67, v29, v29, v67
    v_dot2_f32_bf16 v64, v30, v102, v64
    v_dot2_f32_bf16 v65, v30, v30, v65
    v_dot2_f32_bf16 v66, v31, v102, v66
    v_dot2_f32_bf16 v67, v31, v31, v67
    s_waitcnt vmcnt(7)
    v_dot2_f32_bf16 v64, v32, v102, v64
    v_dot2_f32_bf16 v65, v32, v32, v65
    v_dot2_f32_bf16 v66, v33, v102, v66
    v_dot2_f32_bf16 v67, v33, v33, v67
    v_dot2_f32_bf16 v64, v34, v102, v64
    v_dot2_f32_bf16 v65, v34, v34, v65
    v_dot2_f32_bf16 v66, v35, v102, v66
    v_dot2_f32_bf16 v67, v35, v35, v67
    s_waitcnt vmcnt(6)
    v_dot2_f32_bf16 v64, v36, v102, v64
    v_dot2_f32_bf16 v65, v36, v36, v65
    v_dot2_f32_bf16 v66, v37, v102, v66
    v_dot2_f32_bf16 v67, v37, v37, v67
    v_dot2_f32_bf16 v64, v38, v102, v64
    v_dot2_f32_bf16 v65, v38, v38, v65
    v_dot2_f32_bf16 v66, v39, v102, v66
    v_dot2_f32_bf16 v67, v39, v39, v67
    s_waitcnt vmcnt(5)
    v_dot2_f32_bf16 v64, v40, v102, v64
    v_dot2_f32_bf16 v65, v40, v40, v65
    v_dot2_f32_bf16 v66, v41, v102, v66
    v_dot2_f32_bf16 v67, v41, v41, v67
    v_dot2_f32_bf16 v64, v42, v102, v64
    v_dot2_f32_bf16 v65, v42, v42, v65
    v_dot2_f32_bf16 v66, v43, v102, v66
    v_dot2_f32_bf16 v67, v43, v43, v67
    s_waitcnt vmcnt(4)
    v_dot2_f32_bf16 v64, v44, v102, v64
    v_dot2_f32_bf16 v65, v44, v44, v65
    v_dot2_f32_bf16 v66, v45, v102, v66
    v_dot2_f32_bf16 v67, v45, v45, v67
    v_dot2_f32_bf16 v64, v46, v102, v64
    v_dot2_f32_bf16 v65, v46, v46, v65
    v_dot2_f32_bf16 v66, v47, v102, v66
    v_dot2_f32_bf16 v67, v47, v47, v67
    s_waitcnt vmcnt(3)
    v_dot2_f32_bf16 v64, v48, v102, v64
    v_dot2_f32_bf16 v65, v48, v48, v65
    v_dot2_f32_bf16 v66, v49, v102, v66
    v_dot2_f32_bf16 v67, v49, v49, v67
    v_dot2_f32_bf16 v64, v50, v102, v64
    v_dot2_f32_bf16 v65, v50, v50, v65
    v_dot2_f32_bf16 v66, v51, v102, v66
    v_dot2_f32_bf16 v67, v51, v51, v67
    s_waitcnt vmcnt(2)
    v_dot2_f32_bf16 v64, v52, v102, v64
    v_dot2_f32_bf16 v65, v52, v52, v65
    v_dot2_f32_bf16 v66, v53, v102, v66
    v_dot2_f32_bf16 v67, v53, v53, v67
    v_dot2_f32_bf16 v64, v54, v102, v64
    v_dot2_f32_bf16 v65, v54, v54, v65
    v_dot2_f32_bf16 v66, v55, v102, v66
    v_dot2_f32_bf16 v67, v55, v55, v67
    s_waitcnt vmcnt(1)
    v_dot2_f32_bf16 v64, v56, v102, v64
    v_dot2_f32_bf16 v65, v56, v56, v65
    v_dot2_f32_bf16 v66, v57, v102, v66
    v_dot2_f32_bf16 v67, v57, v57, v67
    v_dot2_f32_bf16 v64, v58, v102, v64
    v_dot2_f32_bf16 v65, v58, v58, v65
    v_dot2_f32_bf16 v66, v59, v102, v66
    v_dot2_f32_bf16 v67, v59, v59, v67
    s_waitcnt vmcnt(0)
    v_dot2_f32_bf16 v64, v60, v102, v64
    v_dot2_f32_bf16 v65, v60, v60, v65
    v_dot2_f32_bf16 v66, v61, v102, v66
    v_dot2_f32_bf16 v67, v61, v61, v67
    v_dot2_f32_bf16 v64, v62, v102, v64
    v_dot2_f32_bf16 v65, v62, v62, v65
    v_dot2_f32_bf16 v66, v63, v102, v66
    v_dot2_f32_bf16 v67, v63, v63, v67
    s_nop 3
    v_add_f32 v64, v64, v66
    v_add_f32 v65, v65, v67
    s_nop 1
    v_add_f32_dpp v64, v64, v64 quad_perm:[1,0,3,2] row_mask:0xf bank_mask:0xf
    v_add_f32_dpp v65, v65, v65 quad_perm:[1,0,3,2] row_mask:0xf bank_mask:0xf
    s_nop 1
    v_add_f32_dpp v64, v64, v64 quad_perm:[2,3,0,1] row_mask:0xf bank_mask:0xf
    v_add_f32_dpp v65, v65, v65 quad_perm:[2,3,0,1] row_mask:0xf bank_mask:0xf
    s_nop 1
    v_add_f32_dpp v64, v64, v64 row_half_mirror row_mask:0xf bank_mask:0xf
    v_add_f32_dpp v65, v65, v65 row_half_mirror row_mask:0xf bank_mask:0xf
    v_lshrrev_b32 v100, 4, v254
    s_lshl_b32 s55, s2, 6
    s_add_u32 s55, s55, 70254592
    s_mov_b32 s70, 0x01010101
    s_mov_b32 s71, 0x01010101
    s_mov_b64 exec, s[70:71]
    buffer_store_dwordx2 v[64:65], v100, s[4:7], s55 offen sc0 sc1
    s_mov_b64 exec, -1
xp_4:
    v_and_b32 v100, 0xf0, v254
    v_lshlrev_b32 v100, 7, v100
    v_lshrrev_b32 v102, 8, v254
    v_lshl_add_u32 v100, v102, 3, v100
    s_lshl_b32 s55, s40, 18
    s_lshl_b32 s56, s43, 17
    s_add_u32 s55, s55, s56
    s_lshl_b32 s56, s51, 7
    s_add_u32 s55, s55, s56
    s_lshl_b32 s56, s44, 6
    s_add_u32 s55, s55, s56
    buffer_load_dwordx2 v[236:237], v100, s[24:27], s55 offen offset:0
    buffer_load_dwordx2 v[238:239], v100, s[24:27], s55 offen offset:32
    s_add_u32 s55, s55, 32768
    buffer_load_dwordx2 v[240:241], v100, s[24:27], s55 offen offset:0
    buffer_load_dwordx2 v[242:243], v100, s[24:27], s55 offen offset:32
    s_add_u32 s55, s55, 32768
    buffer_load_dwordx2 v[244:245], v100, s[24:27], s55 offen offset:0
    buffer_load_dwordx2 v[246:247], v100, s[24:27], s55 offen offset:32
    s_add_u32 s55, s55, 32768
    buffer_load_dwordx2 v[248:249], v100, s[24:27], s55 offen offset:0
    buffer_load_dwordx2 v[250:251], v100, s[24:27], s55 offen offset:32
    s_add_u32 s55, s55, 32768
X_layer:
    v_lshrrev_b32 v206, 4, v254
    v_lshrrev_b32 v207, 8, v254
    v_and_b32 v208, 15, v206
    s_lshl_b32 s55, s43, 13
    s_add_u32 s55, s55, 98304
    s_cmp_lg_u32 s46, 0
    s_cbranch_scc1 g1_7
    v_and_b32 v210, 6, v208
    v_xor_b32 v210, v210, v207
    v_lshlrev_b32 v210, 4, v210
    v_lshl_add_u32 v200, v208, 7, v210
    v_xor_b32 v201, 64, v200
    s_branch g1_8
g1_7:
    v_mov_b32 v200, v254
    v_add_u32 v201, 1024, v254
g1_8:
    v_add_u32 v200, s55, v200
    v_add_u32 v201, s55, v201
    v_lshrrev_b32 v209, 6, v254
    v_lshrrev_b32 v210, 1, v209
    v_and_b32 v210, 3, v210
    s_lshl_b32 s55, s44, 1
    v_xor_b32 v210, s55, v210
    v_lshlrev_b32 v209, 7, v209
    v_lshl_add_u32 v209, v210, 5, v209
    v_and_b32 v210, 0x30, v254
    v_lshrrev_b32 v210, 1, v210
    v_add_u32 v202, v209, v210
    v_xor_b32 v203, 32, v202
    v_add_u32 v204, 49152, v202
    v_add_u32 v205, 49152, v203
    s_add_u32 s88, s1, s47
    v_lshlrev_b32 v209, 2, v207
    v_sub_u32 v209, v208, v209
    v_cmp_le_i32 s[72:73], 0, v209
    v_cmp_le_i32 s[74:75], 1, v209
    v_cmp_le_i32 s[76:77], 2, v209
    v_cmp_le_i32 s[78:79], 3, v209
    v_and_b32 v210, 1, v208
    v_cmp_eq_u32 s[80:81], 1, v210
    v_sub_u32 v209, v209, v210
    v_mov_b32 v212, 0x0c0c0c0c
    v_mov_b32 v210, 0xc0c0100
    v_mov_b32 v211, 0x1000c0c
    v_cmp_le_i32 vcc, 0, v209
    v_cndmask_b32 v210, v210, v211, s[80:81]
    s_not_b64 s[82:83], vcc
    v_cndmask_b32 v214, v210, v212, vcc
    v_cndmask_b32 v216, v212, v210, vcc
    v_mov_b32 v210, 0xc0c0302
    v_mov_b32 v211, 0x3020c0c
    v_cmp_le_i32 vcc, 2, v209
    v_cndmask_b32 v210, v210, v211, s[80:81]
    s_not_b64 s[84:85], vcc
    v_cndmask_b32 v215, v210, v212, vcc
    v_cndmask_b32 v217, v212, v210, vcc
    s_or_b32 s55, s40, s43
    s_cmp_eq_u32 s55, 0
    s_cselect_b64 s[82:83], s[82:83], 0
    s_cselect_b64 s[84:85], s[84:85], 0
    s_lshl_b32 s55, s43, 8
    s_add_u32 s55, s55, 159744
    v_lshlrev_b32 v218, 2, v208
    v_add_u32 v218, s55, v218
    v_lshlrev_b32 v219, 4, v207
    v_add_u32 v219, s55, v219
    s_lshl_b32 s55, s44, 7
    s_add_u32 s55, s55, 160896
    v_lshlrev_b32 v220, 4, v207
    v_add_u32 v220, s55, v220
    v_lshlrev_b32 v221, 2, v208
    v_add_u32 v221, s55, v221
    v_mov_b32 v222, 0x3f803f80
    v_mov_b32 v223, 0x3f803f80
    v_mov_b32 v224, 0x3f803f80
    v_mov_b32 v225, 0x3f803f80
    v_mov_b32 v213, 163712
    s_cmp_eq_u32 s46, 0
    s_cbranch_scc1 g1_9
    s_waitcnt vmcnt(0) lgkmcnt(0)
    s_barrier
    s_cmp_lg_u32 s42, 2
    s_cbranch_scc1 wf_10
    s_lshr_b32 s55, s2, 5
    s_lshl_b32 s55, s55, 2
    s_add_u32 s55, s55, s0
    v_mov_b32 v252, 64
    v_mov_b32 v253, 0x01010101
    s_mov_b64 exec, 1
    s_cmp_eq_u32 s45, 0
    s_cbranch_scc1 st_11
    buffer_store_dword v253, v252, s[4:7], s55 offen sc0 sc1
    s_branch st_12
st_11:
    buffer_store_dword v253, v252, s[4:7], s55 offen
st_12:
    s_mov_b64 exec, -1
wf_10:
    s_cmp_lg_u32 s42, 3
    s_cbranch_scc1 wf_13
    s_lshl_b32 s55, s51, 2
    s_add_u32 s55, s55, s54
    v_mov_b32 v252, 8192
    v_mov_b32 v253, 0x01010101
    s_mov_b64 exec, 1
    buffer_store_dword v253, v252, s[4:7], s55 offen sc0 sc1
    s_mov_b64 exec, -1
wf_13:
    s_cmp_lg_u32 s42, 0
    s_cbranch_scc1 so_14
    v_add_u32 v234, 155648, v254
    ds_read_b128 v[226:229], v234
    ds_read_b128 v[230:233], v234 offset:1024
    s_lshl_b32 s55, s51, 10
    s_add_u32 s55, s55, s53
    s_waitcnt lgkmcnt(0)
    v_add_f32 v226, v226, v230
    v_add_f32 v227, v227, v231
    v_add_f32 v228, v228, v232
    v_add_f32 v229, v229, v233
    buffer_store_dwordx4 v[226:229], v254, s[4:7], s55 offen sc0 sc1
so_14:
g1_9:
    s_barrier
    ds_read_b64_tr_b16 v[152:153], v202 offset:0
    ds_read_b64_tr_b16 v[154:155], v202 offset:2048
    ds_read_b128 v[116:119], v200 offset:2048
    ds_read_b128 v[120:123], v200 offset:4096
    ds_read_b128 v[124:127], v200 offset:6144
    ds_read_b128 v[128:131], v200 offset:8192
    ds_read_b64_tr_b16 v[156:157], v203 offset:0
    ds_read_b64_tr_b16 v[158:159], v203 offset:2048
    ds_read_b64_tr_b16 v[160:161], v202 offset:4096
    ds_read_b64_tr_b16 v[162:163], v202 offset:6144
    ds_read_b128 v[112:115], v200 offset:0
    ds_read_b64_tr_b16 v[164:165], v203 offset:4096
    ds_read_b64_tr_b16 v[166:167], v203 offset:6144
    ds_read_b64_tr_b16 v[168:169], v202 offset:8192
    ds_read_b64_tr_b16 v[170:171], v202 offset:10240
    ds_read_b64_tr_b16 v[172:173], v203 offset:8192
    ds_read_b64_tr_b16 v[174:175], v203 offset:10240
    s_mov_b32 s58, 5
    s_waitcnt lgkmcnt(0)
    s_barrier
    .p2align 3
    v_mfma_f32_16x16x32_bf16 v[0:3], v[152:155], v[116:119], 0
    ds_read_b64_tr_b16 v[176:177], v202 offset:16384
    v_mfma_f32_16x16x32_bf16 v[8:11], v[152:155], v[120:123], 0
    ds_read_b64_tr_b16 v[178:179], v202 offset:18432
    v_mfma_f32_16x16x32_bf16 v[16:19], v[152:155], v[124:127], 0
    ds_read_b128 v[136:139], v201 offset:2048
    v_mfma_f32_16x16x32_bf16 v[24:27], v[152:155], v[128:131], 0
    ds_read_b128 v[140:143], v201 offset:4096
    v_mfma_f32_16x16x32_bf16 v[28:31], v[156:159], v[128:131], 0
    ds_read_b128 v[144:147], v201 offset:6144
    v_mfma_f32_16x16x32_bf16 v[20:23], v[156:159], v[124:127], 0
    v_mfma_f32_16x16x32_bf16 v[12:15], v[156:159], v[120:123], 0
    ds_read_b128 v[148:151], v201 offset:8192
    v_mfma_f32_16x16x32_bf16 v[4:7], v[156:159], v[116:119], 0
    ds_read_b64_tr_b16 v[180:181], v203 offset:16384
    v_mfma_f32_16x16x32_bf16 v[40:43], v[160:163], v[116:119], 0
    ds_read_b64_tr_b16 v[182:183], v203 offset:18432
    v_mfma_f32_16x16x32_bf16 v[48:51], v[160:163], v[120:123], 0
    ds_read_b64_tr_b16 v[184:185], v202 offset:20480
    v_mfma_f32_16x16x32_bf16 v[56:59], v[160:163], v[124:127], 0
    v_mfma_f32_16x16x32_bf16 v[64:67], v[160:163], v[128:131], 0
    ds_read_b64_tr_b16 v[186:187], v202 offset:22528
    v_mfma_f32_16x16x32_bf16 v[32:35], v[160:163], v[112:115], 0
    ds_read_b128 v[132:135], v201 offset:0
    v_mfma_f32_16x16x32_bf16 v[36:39], v[164:167], v[112:115], 0
    ds_read_b64_tr_b16 v[188:189], v203 offset:20480
    v_mfma_f32_16x16x32_bf16 v[68:71], v[164:167], v[128:131], 0
    ds_read_b64_tr_b16 v[190:191], v203 offset:22528
    v_mfma_f32_16x16x32_bf16 v[60:63], v[164:167], v[124:127], 0
    v_mfma_f32_16x16x32_bf16 v[52:55], v[164:167], v[120:123], 0
    ds_read_b64_tr_b16 v[192:193], v202 offset:24576
    v_mfma_f32_16x16x32_bf16 v[44:47], v[164:167], v[116:119], 0
    ds_read_b64_tr_b16 v[194:195], v202 offset:26624
    v_mfma_f32_16x16x32_bf16 v[72:75], v[112:115], v[168:171], 0
    ds_read_b64_tr_b16 v[196:197], v203 offset:24576
    v_mfma_f32_16x16x32_bf16 v[80:83], v[116:119], v[168:171], 0
    ds_read_b64_tr_b16 v[198:199], v203 offset:26624
    v_mfma_f32_16x16x32_bf16 v[88:91], v[120:123], v[168:171], 0
    v_mfma_f32_16x16x32_bf16 v[96:99], v[124:127], v[168:171], 0
    v_mfma_f32_16x16x32_bf16 v[104:107], v[128:131], v[168:171], 0
    v_mfma_f32_16x16x32_bf16 v[108:111], v[128:131], v[172:175], 0
    v_mfma_f32_16x16x32_bf16 v[100:103], v[124:127], v[172:175], 0
    v_mfma_f32_16x16x32_bf16 v[92:95], v[120:123], v[172:175], 0
    v_mfma_f32_16x16x32_bf16 v[84:87], v[116:119], v[172:175], 0
    v_mfma_f32_16x16x32_bf16 v[76:79], v[112:115], v[172:175], 0
    .p2align 3
loop_15:
    s_waitcnt lgkmcnt(0)
    s_barrier
    .p2align 3
    v_mfma_f32_16x16x32_bf16 v[0:3], v[176:179], v[136:139], v[0:3]
    ds_read_b64_tr_b16 v[152:153], v202 offset:32768
    v_mfma_f32_16x16x32_bf16 v[8:11], v[176:179], v[140:143], v[8:11]
    ds_read_b64_tr_b16 v[154:155], v202 offset:34816
    v_mfma_f32_16x16x32_bf16 v[16:19], v[176:179], v[144:147], v[16:19]
    ds_read_b128 v[116:119], v200 offset:20480
    v_mfma_f32_16x16x32_bf16 v[24:27], v[176:179], v[148:151], v[24:27]
    ds_read_b128 v[120:123], v200 offset:22528
    v_mfma_f32_16x16x32_bf16 v[28:31], v[180:183], v[148:151], v[28:31]
    ds_read_b128 v[124:127], v200 offset:24576
    v_mfma_f32_16x16x32_bf16 v[20:23], v[180:183], v[144:147], v[20:23]
    v_mfma_f32_16x16x32_bf16 v[12:15], v[180:183], v[140:143], v[12:15]
    ds_read_b128 v[128:131], v200 offset:26624
    v_mfma_f32_16x16x32_bf16 v[4:7], v[180:183], v[136:139], v[4:7]
    ds_read_b64_tr_b16 v[156:157], v203 offset:32768
    v_mfma_f32_16x16x32_bf16 v[40:43], v[184:187], v[136:139], v[40:43]
    ds_read_b64_tr_b16 v[158:159], v203 offset:34816
    v_mfma_f32_16x16x32_bf16 v[48:51], v[184:187], v[140:143], v[48:51]
    ds_read_b64_tr_b16 v[160:161], v202 offset:36864
    v_mfma_f32_16x16x32_bf16 v[56:59], v[184:187], v[144:147], v[56:59]
    v_mfma_f32_16x16x32_bf16 v[64:67], v[184:187], v[148:151], v[64:67]
    ds_read_b64_tr_b16 v[162:163], v202 offset:38912
    v_mfma_f32_16x16x32_bf16 v[32:35], v[184:187], v[132:135], v[32:35]
    ds_read_b128 v[112:115], v200 offset:18432
    v_mfma_f32_16x16x32_bf16 v[36:39], v[188:191], v[132:135], v[36:39]
    ds_read_b64_tr_b16 v[164:165], v203 offset:36864
    v_mfma_f32_16x16x32_bf16 v[68:71], v[188:191], v[148:151], v[68:71]
    ds_read_b64_tr_b16 v[166:167], v203 offset:38912
    v_mfma_f32_16x16x32_bf16 v[60:63], v[188:191], v[144:147], v[60:63]
    v_mfma_f32_16x16x32_bf16 v[52:55], v[188:191], v[140:143], v[52:55]
    ds_read_b64_tr_b16 v[168:169], v202 offset:40960
    v_mfma_f32_16x16x32_bf16 v[44:47], v[188:191], v[136:139], v[44:47]
    ds_read_b64_tr_b16 v[170:171], v202 offset:43008
    v_mfma_f32_16x16x32_bf16 v[72:75], v[132:135], v[192:195], v[72:75]
    ds_read_b64_tr_b16 v[172:173], v203 offset:40960
    v_mfma_f32_16x16x32_bf16 v[80:83], v[136:139], v[192:195], v[80:83]
    ds_read_b64_tr_b16 v[174:175], v203 offset:43008
    v_mfma_f32_16x16x32_bf16 v[88:91], v[140:143], v[192:195], v[88:91]
    v_mfma_f32_16x16x32_bf16 v[96:99], v[144:147], v[192:195], v[96:99]
    v_mfma_f32_16x16x32_bf16 v[104:107], v[148:151], v[192:195], v[104:107]
    v_mfma_f32_16x16x32_bf16 v[108:111], v[148:151], v[196:199], v[108:111]
    v_mfma_f32_16x16x32_bf16 v[100:103], v[144:147], v[196:199], v[100:103]
    v_mfma_f32_16x16x32_bf16 v[92:95], v[140:143], v[196:199], v[92:95]
    v_mfma_f32_16x16x32_bf16 v[84:87], v[136:139], v[196:199], v[84:87]
    v_mfma_f32_16x16x32_bf16 v[76:79], v[132:135], v[196:199], v[76:79]
    s_waitcnt vmcnt(0) lgkmcnt(0)
    s_barrier
    .p2align 3
    v_mfma_f32_16x16x32_bf16 v[0:3], v[152:155], v[116:119], v[0:3]
    ds_read_b64_tr_b16 v[176:177], v204 offset:0
    v_mfma_f32_16x16x32_bf16 v[8:11], v[152:155], v[120:123], v[8:11]
    ds_read_b64_tr_b16 v[178:179], v204 offset:2048
    v_mfma_f32_16x16x32_bf16 v[16:19], v[152:155], v[124:127], v[16:19]
    ds_read_b128 v[136:139], v201 offset:20480
    v_mfma_f32_16x16x32_bf16 v[24:27], v[152:155], v[128:131], v[24:27]
    ds_read_b128 v[140:143], v201 offset:22528
    v_mfma_f32_16x16x32_bf16 v[28:31], v[156:159], v[128:131], v[28:31]
    ds_read_b128 v[144:147], v201 offset:24576
    v_mfma_f32_16x16x32_bf16 v[20:23], v[156:159], v[124:127], v[20:23]
    v_mfma_f32_16x16x32_bf16 v[12:15], v[156:159], v[120:123], v[12:15]
    ds_read_b128 v[148:151], v201 offset:26624
    v_mfma_f32_16x16x32_bf16 v[4:7], v[156:159], v[116:119], v[4:7]
    ds_read_b64_tr_b16 v[180:181], v205 offset:0
    v_mfma_f32_16x16x32_bf16 v[40:43], v[160:163], v[116:119], v[40:43]
    ds_read_b64_tr_b16 v[182:183], v205 offset:2048
    v_mfma_f32_16x16x32_bf16 v[48:51], v[160:163], v[120:123], v[48:51]
    ds_read_b64_tr_b16 v[184:185], v204 offset:4096
    v_mfma_f32_16x16x32_bf16 v[56:59], v[160:163], v[124:127], v[56:59]
    v_mfma_f32_16x16x32_bf16 v[64:67], v[160:163], v[128:131], v[64:67]
    ds_read_b64_tr_b16 v[186:187], v204 offset:6144
    v_mfma_f32_16x16x32_bf16 v[32:35], v[160:163], v[112:115], v[32:35]
    ds_read_b128 v[132:135], v201 offset:18432
    v_mfma_f32_16x16x32_bf16 v[36:39], v[164:167], v[112:115], v[36:39]
    ds_read_b64_tr_b16 v[188:189], v205 offset:4096
    v_mfma_f32_16x16x32_bf16 v[68:71], v[164:167], v[128:131], v[68:71]
    ds_read_b64_tr_b16 v[190:191], v205 offset:6144
    v_mfma_f32_16x16x32_bf16 v[60:63], v[164:167], v[124:127], v[60:63]
    v_mfma_f32_16x16x32_bf16 v[52:55], v[164:167], v[120:123], v[52:55]
    ds_read_b64_tr_b16 v[192:193], v204 offset:8192
    v_mfma_f32_16x16x32_bf16 v[44:47], v[164:167], v[116:119], v[44:47]
    ds_read_b64_tr_b16 v[194:195], v204 offset:10240
    v_mfma_f32_16x16x32_bf16 v[72:75], v[112:115], v[168:171], v[72:75]
    ds_read_b64_tr_b16 v[196:197], v205 offset:8192
    v_mfma_f32_16x16x32_bf16 v[80:83], v[116:119], v[168:171], v[80:83]
    ds_read_b64_tr_b16 v[198:199], v205 offset:10240
    v_mfma_f32_16x16x32_bf16 v[88:91], v[120:123], v[168:171], v[88:91]
    v_mfma_f32_16x16x32_bf16 v[96:99], v[124:127], v[168:171], v[96:99]
    v_mfma_f32_16x16x32_bf16 v[104:107], v[128:131], v[168:171], v[104:107]
    v_mfma_f32_16x16x32_bf16 v[108:111], v[128:131], v[172:175], v[108:111]
    v_mfma_f32_16x16x32_bf16 v[100:103], v[124:127], v[172:175], v[100:103]
    v_mfma_f32_16x16x32_bf16 v[92:95], v[120:123], v[172:175], v[92:95]
    v_mfma_f32_16x16x32_bf16 v[84:87], v[116:119], v[172:175], v[84:87]
    v_mfma_f32_16x16x32_bf16 v[76:79], v[112:115], v[172:175], v[76:79]
    s_waitcnt lgkmcnt(0)
    s_barrier
    .p2align 3
    v_mfma_f32_16x16x32_bf16 v[0:3], v[176:179], v[136:139], v[0:3]
    ds_read_b64_tr_b16 v[152:153], v204 offset:16384
    v_mfma_f32_16x16x32_bf16 v[8:11], v[176:179], v[140:143], v[8:11]
    ds_read_b64_tr_b16 v[154:155], v204 offset:18432
    v_mfma_f32_16x16x32_bf16 v[16:19], v[176:179], v[144:147], v[16:19]
    ds_read_b128 v[116:119], v200 offset:38912
    v_mfma_f32_16x16x32_bf16 v[24:27], v[176:179], v[148:151], v[24:27]
    ds_read_b128 v[120:123], v200 offset:40960
    v_mfma_f32_16x16x32_bf16 v[28:31], v[180:183], v[148:151], v[28:31]
    ds_read_b128 v[124:127], v200 offset:43008
    v_mfma_f32_16x16x32_bf16 v[20:23], v[180:183], v[144:147], v[20:23]
    v_mfma_f32_16x16x32_bf16 v[12:15], v[180:183], v[140:143], v[12:15]
    ds_read_b128 v[128:131], v200 offset:45056
    v_mfma_f32_16x16x32_bf16 v[4:7], v[180:183], v[136:139], v[4:7]
    ds_read_b64_tr_b16 v[156:157], v205 offset:16384
    v_mfma_f32_16x16x32_bf16 v[40:43], v[184:187], v[136:139], v[40:43]
    ds_read_b64_tr_b16 v[158:159], v205 offset:18432
    v_mfma_f32_16x16x32_bf16 v[48:51], v[184:187], v[140:143], v[48:51]
    ds_read_b64_tr_b16 v[160:161], v204 offset:20480
    v_mfma_f32_16x16x32_bf16 v[56:59], v[184:187], v[144:147], v[56:59]
    v_mfma_f32_16x16x32_bf16 v[64:67], v[184:187], v[148:151], v[64:67]
    ds_read_b64_tr_b16 v[162:163], v204 offset:22528
    v_mfma_f32_16x16x32_bf16 v[32:35], v[184:187], v[132:135], v[32:35]
    ds_read_b128 v[112:115], v200 offset:36864
    v_mfma_f32_16x16x32_bf16 v[36:39], v[188:191], v[132:135], v[36:39]
    ds_read_b64_tr_b16 v[164:165], v205 offset:20480
    v_mfma_f32_16x16x32_bf16 v[68:71], v[188:191], v[148:151], v[68:71]
    ds_read_b64_tr_b16 v[166:167], v205 offset:22528
    v_mfma_f32_16x16x32_bf16 v[60:63], v[188:191], v[144:147], v[60:63]
    v_mfma_f32_16x16x32_bf16 v[52:55], v[188:191], v[140:143], v[52:55]
    ds_read_b64_tr_b16 v[168:169], v204 offset:24576
    v_mfma_f32_16x16x32_bf16 v[44:47], v[188:191], v[136:139], v[44:47]
    ds_read_b64_tr_b16 v[170:171], v204 offset:26624
    v_mfma_f32_16x16x32_bf16 v[72:75], v[132:135], v[192:195], v[72:75]
    ds_read_b64_tr_b16 v[172:173], v205 offset:24576
    v_mfma_f32_16x16x32_bf16 v[80:83], v[136:139], v[192:195], v[80:83]
    ds_read_b64_tr_b16 v[174:175], v205 offset:26624
    v_mfma_f32_16x16x32_bf16 v[88:91], v[140:143], v[192:195], v[88:91]
    v_mfma_f32_16x16x32_bf16 v[96:99], v[144:147], v[192:195], v[96:99]
    v_mfma_f32_16x16x32_bf16 v[104:107], v[148:151], v[192:195], v[104:107]
    v_mfma_f32_16x16x32_bf16 v[108:111], v[148:151], v[196:199], v[108:111]
    v_mfma_f32_16x16x32_bf16 v[100:103], v[144:147], v[196:199], v[100:103]
    v_mfma_f32_16x16x32_bf16 v[92:95], v[140:143], v[196:199], v[92:95]
    v_mfma_f32_16x16x32_bf16 v[84:87], v[136:139], v[196:199], v[84:87]
    v_mfma_f32_16x16x32_bf16 v[76:79], v[132:135], v[196:199], v[76:79]
    s_waitcnt lgkmcnt(0)
    s_barrier
    .p2align 3
    v_mfma_f32_16x16x32_bf16 v[0:3], v[152:155], v[116:119], v[0:3]
    ds_read_b64_tr_b16 v[176:177], v204 offset:32768
    v_mfma_f32_16x16x32_bf16 v[8:11], v[152:155], v[120:123], v[8:11]
    ds_read_b64_tr_b16 v[178:179], v204 offset:34816
    v_mfma_f32_16x16x32_bf16 v[16:19], v[152:155], v[124:127], v[16:19]
    ds_read_b128 v[136:139], v201 offset:38912
    v_mfma_f32_16x16x32_bf16 v[24:27], v[152:155], v[128:131], v[24:27]
    ds_read_b128 v[140:143], v201 offset:40960
    v_mfma_f32_16x16x32_bf16 v[28:31], v[156:159], v[128:131], v[28:31]
    ds_read_b128 v[144:147], v201 offset:43008
    v_mfma_f32_16x16x32_bf16 v[20:23], v[156:159], v[124:127], v[20:23]
    v_mfma_f32_16x16x32_bf16 v[12:15], v[156:159], v[120:123], v[12:15]
    ds_read_b128 v[148:151], v201 offset:45056
    v_mfma_f32_16x16x32_bf16 v[4:7], v[156:159], v[116:119], v[4:7]
    ds_read_b64_tr_b16 v[180:181], v205 offset:32768
    v_mfma_f32_16x16x32_bf16 v[40:43], v[160:163], v[116:119], v[40:43]
    ds_read_b64_tr_b16 v[182:183], v205 offset:34816
    v_mfma_f32_16x16x32_bf16 v[48:51], v[160:163], v[120:123], v[48:51]
    ds_read_b64_tr_b16 v[184:185], v204 offset:36864
    v_mfma_f32_16x16x32_bf16 v[56:59], v[160:163], v[124:127], v[56:59]
    v_mfma_f32_16x16x32_bf16 v[64:67], v[160:163], v[128:131], v[64:67]
    ds_read_b64_tr_b16 v[186:187], v204 offset:38912
    v_mfma_f32_16x16x32_bf16 v[32:35], v[160:163], v[112:115], v[32:35]
    ds_read_b128 v[132:135], v201 offset:36864
    v_mfma_f32_16x16x32_bf16 v[36:39], v[164:167], v[112:115], v[36:39]
    ds_read_b64_tr_b16 v[188:189], v205 offset:36864
    v_mfma_f32_16x16x32_bf16 v[68:71], v[164:167], v[128:131], v[68:71]
    ds_read_b64_tr_b16 v[190:191], v205 offset:38912
    v_mfma_f32_16x16x32_bf16 v[60:63], v[164:167], v[124:127], v[60:63]
    v_mfma_f32_16x16x32_bf16 v[52:55], v[164:167], v[120:123], v[52:55]
    ds_read_b64_tr_b16 v[192:193], v204 offset:40960
    v_mfma_f32_16x16x32_bf16 v[44:47], v[164:167], v[116:119], v[44:47]
    ds_read_b64_tr_b16 v[194:195], v204 offset:43008
    v_mfma_f32_16x16x32_bf16 v[72:75], v[112:115], v[168:171], v[72:75]
    ds_read_b64_tr_b16 v[196:197], v205 offset:40960
    v_mfma_f32_16x16x32_bf16 v[80:83], v[116:119], v[168:171], v[80:83]
    ds_read_b64_tr_b16 v[198:199], v205 offset:43008
    v_mfma_f32_16x16x32_bf16 v[88:91], v[120:123], v[168:171], v[88:91]
    v_mfma_f32_16x16x32_bf16 v[96:99], v[124:127], v[168:171], v[96:99]
    v_mfma_f32_16x16x32_bf16 v[104:107], v[128:131], v[168:171], v[104:107]
    v_mfma_f32_16x16x32_bf16 v[108:111], v[128:131], v[172:175], v[108:111]
    v_mfma_f32_16x16x32_bf16 v[100:103], v[124:127], v[172:175], v[100:103]
    v_mfma_f32_16x16x32_bf16 v[92:95], v[120:123], v[172:175], v[92:95]
    v_mfma_f32_16x16x32_bf16 v[84:87], v[116:119], v[172:175], v[84:87]
    v_mfma_f32_16x16x32_bf16 v[76:79], v[112:115], v[172:175], v[76:79]
    s_waitcnt lgkmcnt(0)
    s_barrier
    .p2align 3
    v_mfma_f32_16x16x32_bf16 v[0:3], v[176:179], v[136:139], v[0:3]
    ds_read_b64_tr_b16 v[152:153], v202 offset:0
    v_mfma_f32_16x16x32_bf16 v[8:11], v[176:179], v[140:143], v[8:11]
    ds_read_b64_tr_b16 v[154:155], v202 offset:2048
    v_mfma_f32_16x16x32_bf16 v[16:19], v[176:179], v[144:147], v[16:19]
    ds_read_b128 v[116:119], v200 offset:2048
    v_mfma_f32_16x16x32_bf16 v[24:27], v[176:179], v[148:151], v[24:27]
    ds_read_b128 v[120:123], v200 offset:4096
    v_mfma_f32_16x16x32_bf16 v[28:31], v[180:183], v[148:151], v[28:31]
    ds_read_b128 v[124:127], v200 offset:6144
    v_mfma_f32_16x16x32_bf16 v[20:23], v[180:183], v[144:147], v[20:23]
    v_mfma_f32_16x16x32_bf16 v[12:15], v[180:183], v[140:143], v[12:15]
    ds_read_b128 v[128:131], v200 offset:8192
    v_mfma_f32_16x16x32_bf16 v[4:7], v[180:183], v[136:139], v[4:7]
    ds_read_b64_tr_b16 v[156:157], v203 offset:0
    v_mfma_f32_16x16x32_bf16 v[40:43], v[184:187], v[136:139], v[40:43]
    ds_read_b64_tr_b16 v[158:159], v203 offset:2048
    v_mfma_f32_16x16x32_bf16 v[48:51], v[184:187], v[140:143], v[48:51]
    ds_read_b64_tr_b16 v[160:161], v202 offset:4096
    v_mfma_f32_16x16x32_bf16 v[56:59], v[184:187], v[144:147], v[56:59]
    v_mfma_f32_16x16x32_bf16 v[64:67], v[184:187], v[148:151], v[64:67]
    ds_read_b64_tr_b16 v[162:163], v202 offset:6144
    v_mfma_f32_16x16x32_bf16 v[32:35], v[184:187], v[132:135], v[32:35]
    ds_read_b128 v[112:115], v200 offset:0
    v_mfma_f32_16x16x32_bf16 v[36:39], v[188:191], v[132:135], v[36:39]
    ds_read_b64_tr_b16 v[164:165], v203 offset:4096
    v_mfma_f32_16x16x32_bf16 v[68:71], v[188:191], v[148:151], v[68:71]
    ds_read_b64_tr_b16 v[166:167], v203 offset:6144
    v_mfma_f32_16x16x32_bf16 v[60:63], v[188:191], v[144:147], v[60:63]
    v_mfma_f32_16x16x32_bf16 v[52:55], v[188:191], v[140:143], v[52:55]
    ds_read_b64_tr_b16 v[168:169], v202 offset:8192
    v_mfma_f32_16x16x32_bf16 v[44:47], v[188:191], v[136:139], v[44:47]
    ds_read_b64_tr_b16 v[170:171], v202 offset:10240
    v_mfma_f32_16x16x32_bf16 v[72:75], v[132:135], v[192:195], v[72:75]
    ds_read_b64_tr_b16 v[172:173], v203 offset:8192
    v_mfma_f32_16x16x32_bf16 v[80:83], v[136:139], v[192:195], v[80:83]
    ds_read_b64_tr_b16 v[174:175], v203 offset:10240
    v_mfma_f32_16x16x32_bf16 v[88:91], v[140:143], v[192:195], v[88:91]
    v_mfma_f32_16x16x32_bf16 v[96:99], v[144:147], v[192:195], v[96:99]
    v_mfma_f32_16x16x32_bf16 v[104:107], v[148:151], v[192:195], v[104:107]
    v_mfma_f32_16x16x32_bf16 v[108:111], v[148:151], v[196:199], v[108:111]
    v_mfma_f32_16x16x32_bf16 v[100:103], v[144:147], v[196:199], v[100:103]
    v_mfma_f32_16x16x32_bf16 v[92:95], v[140:143], v[196:199], v[92:95]
    v_mfma_f32_16x16x32_bf16 v[84:87], v[136:139], v[196:199], v[84:87]
    v_mfma_f32_16x16x32_bf16 v[76:79], v[132:135], v[196:199], v[76:79]
    s_waitcnt lgkmcnt(0)
    s_barrier
    .p2align 3
    v_mfma_f32_16x16x32_bf16 v[0:3], v[152:155], v[116:119], v[0:3]
    ds_read_b64_tr_b16 v[176:177], v202 offset:16384
    v_mfma_f32_16x16x32_bf16 v[8:11], v[152:155], v[120:123], v[8:11]
    ds_read_b64_tr_b16 v[178:179], v202 offset:18432
    v_mfma_f32_16x16x32_bf16 v[16:19], v[152:155], v[124:127], v[16:19]
    ds_read_b128 v[136:139], v201 offset:2048
    v_mfma_f32_16x16x32_bf16 v[24:27], v[152:155], v[128:131], v[24:27]
    ds_read_b128 v[140:143], v201 offset:4096
    v_mfma_f32_16x16x32_bf16 v[28:31], v[156:159], v[128:131], v[28:31]
    ds_read_b128 v[144:147], v201 offset:6144
    v_mfma_f32_16x16x32_bf16 v[20:23], v[156:159], v[124:127], v[20:23]
    v_mfma_f32_16x16x32_bf16 v[12:15], v[156:159], v[120:123], v[12:15]
    ds_read_b128 v[148:151], v201 offset:8192
    v_mfma_f32_16x16x32_bf16 v[4:7], v[156:159], v[116:119], v[4:7]
    ds_read_b64_tr_b16 v[180:181], v203 offset:16384
    v_mfma_f32_16x16x32_bf16 v[40:43], v[160:163], v[116:119], v[40:43]
    ds_read_b64_tr_b16 v[182:183], v203 offset:18432
    v_mfma_f32_16x16x32_bf16 v[48:51], v[160:163], v[120:123], v[48:51]
    ds_read_b64_tr_b16 v[184:185], v202 offset:20480
    v_mfma_f32_16x16x32_bf16 v[56:59], v[160:163], v[124:127], v[56:59]
    v_mfma_f32_16x16x32_bf16 v[64:67], v[160:163], v[128:131], v[64:67]
    ds_read_b64_tr_b16 v[186:187], v202 offset:22528
    v_mfma_f32_16x16x32_bf16 v[32:35], v[160:163], v[112:115], v[32:35]
    ds_read_b128 v[132:135], v201 offset:0
    v_mfma_f32_16x16x32_bf16 v[36:39], v[164:167], v[112:115], v[36:39]
    ds_read_b64_tr_b16 v[188:189], v203 offset:20480
    v_mfma_f32_16x16x32_bf16 v[68:71], v[164:167], v[128:131], v[68:71]
    ds_read_b64_tr_b16 v[190:191], v203 offset:22528
    v_mfma_f32_16x16x32_bf16 v[60:63], v[164:167], v[124:127], v[60:63]
    v_mfma_f32_16x16x32_bf16 v[52:55], v[164:167], v[120:123], v[52:55]
    ds_read_b64_tr_b16 v[192:193], v202 offset:24576
    v_mfma_f32_16x16x32_bf16 v[44:47], v[164:167], v[116:119], v[44:47]
    ds_read_b64_tr_b16 v[194:195], v202 offset:26624
    v_mfma_f32_16x16x32_bf16 v[72:75], v[112:115], v[168:171], v[72:75]
    ds_read_b64_tr_b16 v[196:197], v203 offset:24576
    v_mfma_f32_16x16x32_bf16 v[80:83], v[116:119], v[168:171], v[80:83]
    ds_read_b64_tr_b16 v[198:199], v203 offset:26624
    v_mfma_f32_16x16x32_bf16 v[88:91], v[120:123], v[168:171], v[88:91]
    v_mfma_f32_16x16x32_bf16 v[96:99], v[124:127], v[168:171], v[96:99]
    v_mfma_f32_16x16x32_bf16 v[104:107], v[128:131], v[168:171], v[104:107]
    v_mfma_f32_16x16x32_bf16 v[108:111], v[128:131], v[172:175], v[108:111]
    v_mfma_f32_16x16x32_bf16 v[100:103], v[124:127], v[172:175], v[100:103]
    s_sub_u32 s58, s58, 1
    s_cmp_lg_u32 s58, 0
    .p2align 3
    v_mfma_f32_16x16x32_bf16 v[92:95], v[120:123], v[172:175], v[92:95]
    v_mfma_f32_16x16x32_bf16 v[84:87], v[116:119], v[172:175], v[84:87]
    v_mfma_f32_16x16x32_bf16 v[76:79], v[112:115], v[172:175], v[76:79]
    s_cbranch_scc1 loop_15
    s_waitcnt lgkmcnt(0)
    s_barrier
    .p2align 3
    v_mfma_f32_16x16x32_bf16 v[0:3], v[176:179], v[136:139], v[0:3]
    ds_read_b128 v[152:155], v220 offset:0
    v_mfma_f32_16x16x32_bf16 v[8:11], v[176:179], v[140:143], v[8:11]
    ds_read_b128 v[156:159], v220 offset:64
    v_mfma_f32_16x16x32_bf16 v[16:19], v[176:179], v[144:147], v[16:19]
    ds_read_b128 v[160:163], v220 offset:256
    v_mfma_f32_16x16x32_bf16 v[24:27], v[176:179], v[148:151], v[24:27]
    ds_read_b128 v[164:167], v220 offset:320
    v_mfma_f32_16x16x32_bf16 v[28:31], v[180:183], v[148:151], v[28:31]
    ds_read_b32 v112, v218 offset:0
    v_mfma_f32_16x16x32_bf16 v[20:23], v[180:183], v[144:147], v[20:23]
    v_mfma_f32_16x16x32_bf16 v[12:15], v[180:183], v[140:143], v[12:15]
    ds_read_b32 v113, v218 offset:64
    v_mfma_f32_16x16x32_bf16 v[4:7], v[180:183], v[136:139], v[4:7]
    ds_read_b32 v114, v218 offset:128
    v_mfma_f32_16x16x32_bf16 v[40:43], v[184:187], v[136:139], v[40:43]
    ds_read_b32 v115, v218 offset:192
    v_mfma_f32_16x16x32_bf16 v[48:51], v[184:187], v[140:143], v[48:51]
    ds_read_b32 v116, v218 offset:256
    v_mfma_f32_16x16x32_bf16 v[56:59], v[184:187], v[144:147], v[56:59]
    v_mfma_f32_16x16x32_bf16 v[64:67], v[184:187], v[148:151], v[64:67]
    ds_read_b32 v118, v218 offset:576
    v_mfma_f32_16x16x32_bf16 v[32:35], v[184:187], v[132:135], v[32:35]
    ds_read_b32 v119, v218 offset:640
    v_mfma_f32_16x16x32_bf16 v[36:39], v[188:191], v[132:135], v[36:39]
    ds_read_b32 v120, v218 offset:704
    v_mfma_f32_16x16x32_bf16 v[68:71], v[188:191], v[148:151], v[68:71]
    ds_read_b32 v121, v218 offset:768
    v_mfma_f32_16x16x32_bf16 v[60:63], v[188:191], v[144:147], v[60:63]
    v_mfma_f32_16x16x32_bf16 v[52:55], v[188:191], v[140:143], v[52:55]
    ds_read_b32 v122, v218 offset:832
    v_mfma_f32_16x16x32_bf16 v[44:47], v[188:191], v[136:139], v[44:47]
    ds_read_b32 v168, v221 offset:512
    v_mfma_f32_16x16x32_bf16 v[72:75], v[132:135], v[192:195], v[72:75]
    ds_read_b32 v169, v221 offset:576
    v_mfma_f32_16x16x32_bf16 v[80:83], v[136:139], v[192:195], v[80:83]
    ds_read_b32 v170, v213
    v_mfma_f32_16x16x32_bf16 v[88:91], v[140:143], v[192:195], v[88:91]
    v_mfma_f32_16x16x32_bf16 v[96:99], v[144:147], v[192:195], v[96:99]
    v_mfma_f32_16x16x32_bf16 v[104:107], v[148:151], v[192:195], v[104:107]
    v_mfma_f32_16x16x32_bf16 v[108:111], v[148:151], v[196:199], v[108:111]
    v_mfma_f32_16x16x32_bf16 v[100:103], v[144:147], v[196:199], v[100:103]
    v_mfma_f32_16x16x32_bf16 v[92:95], v[140:143], v[196:199], v[92:95]
    v_mfma_f32_16x16x32_bf16 v[84:87], v[136:139], v[196:199], v[84:87]
    v_mfma_f32_16x16x32_bf16 v[76:79], v[132:135], v[196:199], v[76:79]
    s_waitcnt lgkmcnt(0)
    .p2align 3
    ds_read_b128 v[132:135], v219 offset:0
    ds_read_b128 v[176:179], v219 offset:576
    ds_read_b128 v[136:139], v219 offset:64
    ds_read_b128 v[180:183], v219 offset:640
    ds_read_b128 v[140:143], v219 offset:128
    ds_read_b128 v[184:187], v219 offset:704
    ds_read_b128 v[144:147], v219 offset:192
    ds_read_b128 v[188:191], v219 offset:768
    ds_read_b128 v[148:151], v219 offset:256
    ds_read_b128 v[192:195], v219 offset:832
    v_pk_fma_f32 v[0:1], v[112:113], v[152:153], v[0:1] op_sel:[1,0,0] op_sel_hi:[1,1,1]
    v_pk_fma_f32 v[2:3], v[112:113], v[154:155], v[2:3] op_sel:[1,0,0] op_sel_hi:[1,1,1]
    v_pk_fma_f32 v[4:5], v[112:113], v[156:157], v[4:5] op_sel:[1,0,0] op_sel_hi:[1,1,1]
    v_pk_fma_f32 v[6:7], v[112:113], v[158:159], v[6:7] op_sel:[1,0,0] op_sel_hi:[1,1,1]
    v_pk_fma_f32 v[8:9], v[114:115], v[152:153], v[8:9] op_sel:[0,0,0] op_sel_hi:[0,1,1]
    v_pk_fma_f32 v[10:11], v[114:115], v[154:155], v[10:11] op_sel:[0,0,0] op_sel_hi:[0,1,1]
    v_pk_fma_f32 v[12:13], v[114:115], v[156:157], v[12:13] op_sel:[0,0,0] op_sel_hi:[0,1,1]
    v_pk_fma_f32 v[14:15], v[114:115], v[158:159], v[14:15] op_sel:[0,0,0] op_sel_hi:[0,1,1]
    v_pk_fma_f32 v[16:17], v[114:115], v[152:153], v[16:17] op_sel:[1,0,0] op_sel_hi:[1,1,1]
    v_pk_fma_f32 v[18:19], v[114:115], v[154:155], v[18:19] op_sel:[1,0,0] op_sel_hi:[1,1,1]
    v_pk_fma_f32 v[20:21], v[114:115], v[156:157], v[20:21] op_sel:[1,0,0] op_sel_hi:[1,1,1]
    v_pk_fma_f32 v[22:23], v[114:115], v[158:159], v[22:23] op_sel:[1,0,0] op_sel_hi:[1,1,1]
    v_pk_fma_f32 v[24:25], v[116:117], v[152:153], v[24:25] op_sel:[0,0,0] op_sel_hi:[0,1,1]
    v_pk_fma_f32 v[26:27], v[116:117], v[154:155], v[26:27] op_sel:[0,0,0] op_sel_hi:[0,1,1]
    v_pk_fma_f32 v[28:29], v[116:117], v[156:157], v[28:29] op_sel:[0,0,0] op_sel_hi:[0,1,1]
    v_pk_fma_f32 v[30:31], v[116:117], v[158:159], v[30:31] op_sel:[0,0,0] op_sel_hi:[0,1,1]
    v_pk_fma_f32 v[32:33], v[112:113], v[160:161], v[32:33] op_sel:[0,0,0] op_sel_hi:[0,1,1]
    v_pk_fma_f32 v[34:35], v[112:113], v[162:163], v[34:35] op_sel:[0,0,0] op_sel_hi:[0,1,1]
    v_pk_fma_f32 v[36:37], v[112:113], v[164:165], v[36:37] op_sel:[0,0,0] op_sel_hi:[0,1,1]
    v_pk_fma_f32 v[38:39], v[112:113], v[166:167], v[38:39] op_sel:[0,0,0] op_sel_hi:[0,1,1]
    v_pk_fma_f32 v[40:41], v[112:113], v[160:161], v[40:41] op_sel:[1,0,0] op_sel_hi:[1,1,1]
    v_pk_fma_f32 v[42:43], v[112:113], v[162:163], v[42:43] op_sel:[1,0,0] op_sel_hi:[1,1,1]
    v_pk_fma_f32 v[44:45], v[112:113], v[164:165], v[44:45] op_sel:[1,0,0] op_sel_hi:[1,1,1]
    v_pk_fma_f32 v[46:47], v[112:113], v[166:167], v[46:47] op_sel:[1,0,0] op_sel_hi:[1,1,1]
    v_pk_fma_f32 v[48:49], v[114:115], v[160:161], v[48:49] op_sel:[0,0,0] op_sel_hi:[0,1,1]
    v_pk_fma_f32 v[50:51], v[114:115], v[162:163], v[50:51] op_sel:[0,0,0] op_sel_hi:[0,1,1]
    v_pk_fma_f32 v[52:53], v[114:115], v[164:165], v[52:53] op_sel:[0,0,0] op_sel_hi:[0,1,1]
    v_pk_fma_f32 v[54:55], v[114:115], v[166:167], v[54:55] op_sel:[0,0,0] op_sel_hi:[0,1,1]
    v_pk_fma_f32 v[56:57], v[114:115], v[160:161], v[56:57] op_sel:[1,0,0] op_sel_hi:[1,1,1]
    v_pk_fma_f32 v[58:59], v[114:115], v[162:163], v[58:59] op_sel:[1,0,0] op_sel_hi:[1,1,1]
    v_pk_fma_f32 v[60:61], v[114:115], v[164:165], v[60:61] op_sel:[1,0,0] op_sel_hi:[1,1,1]
    v_pk_fma_f32 v[62:63], v[114:115], v[166:167], v[62:63] op_sel:[1,0,0] op_sel_hi:[1,1,1]
    v_pk_fma_f32 v[64:65], v[116:117], v[160:161], v[64:65] op_sel:[0,0,0] op_sel_hi:[0,1,1]
    v_pk_fma_f32 v[66:67], v[116:117], v[162:163], v[66:67] op_sel:[0,0,0] op_sel_hi:[0,1,1]
    v_pk_fma_f32 v[68:69], v[116:117], v[164:165], v[68:69] op_sel:[0,0,0] op_sel_hi:[0,1,1]
    v_pk_fma_f32 v[70:71], v[116:117], v[166:167], v[70:71] op_sel:[0,0,0] op_sel_hi:[0,1,1]
    v_cvt_pk_bf16_f32 v0, v0, v1
    v_cvt_pk_bf16_f32 v1, v2, v3
    v_cvt_pk_bf16_f32 v2, v4, v5
    v_cvt_pk_bf16_f32 v3, v6, v7
    v_cvt_pk_bf16_f32 v8, v8, v9
    v_cvt_pk_bf16_f32 v9, v10, v11
    v_cvt_pk_bf16_f32 v10, v12, v13
    v_cvt_pk_bf16_f32 v11, v14, v15
    v_cvt_pk_bf16_f32 v16, v16, v17
    v_cvt_pk_bf16_f32 v17, v18, v19
    v_cvt_pk_bf16_f32 v18, v20, v21
    v_cvt_pk_bf16_f32 v19, v22, v23
    v_cvt_pk_bf16_f32 v24, v24, v25
    v_cvt_pk_bf16_f32 v25, v26, v27
    v_cvt_pk_bf16_f32 v26, v28, v29
    v_cvt_pk_bf16_f32 v27, v30, v31
    v_pk_mul_f32 v[32:33], v[118:119], v[32:33] op_sel:[0,0] op_sel_hi:[0,1]
    v_pk_mul_f32 v[34:35], v[118:119], v[34:35] op_sel:[0,0] op_sel_hi:[0,1]
    v_pk_mul_f32 v[36:37], v[118:119], v[36:37] op_sel:[0,0] op_sel_hi:[0,1]
    v_pk_mul_f32 v[38:39], v[118:119], v[38:39] op_sel:[0,0] op_sel_hi:[0,1]
    v_pk_mul_f32 v[40:41], v[118:119], v[40:41] op_sel:[1,0] op_sel_hi:[1,1]
    v_pk_mul_f32 v[42:43], v[118:119], v[42:43] op_sel:[1,0] op_sel_hi:[1,1]
    v_pk_mul_f32 v[44:45], v[118:119], v[44:45] op_sel:[1,0] op_sel_hi:[1,1]
    v_pk_mul_f32 v[46:47], v[118:119], v[46:47] op_sel:[1,0] op_sel_hi:[1,1]
    v_pk_mul_f32 v[48:49], v[120:121], v[48:49] op_sel:[0,0] op_sel_hi:[0,1]
    v_pk_mul_f32 v[50:51], v[120:121], v[50:51] op_sel:[0,0] op_sel_hi:[0,1]
    v_pk_mul_f32 v[52:53], v[120:121], v[52:53] op_sel:[0,0] op_sel_hi:[0,1]
    v_pk_mul_f32 v[54:55], v[120:121], v[54:55] op_sel:[0,0] op_sel_hi:[0,1]
    v_pk_mul_f32 v[56:57], v[120:121], v[56:57] op_sel:[1,0] op_sel_hi:[1,1]
    v_pk_mul_f32 v[58:59], v[120:121], v[58:59] op_sel:[1,0] op_sel_hi:[1,1]
    v_pk_mul_f32 v[60:61], v[120:121], v[60:61] op_sel:[1,0] op_sel_hi:[1,1]
    v_pk_mul_f32 v[62:63], v[120:121], v[62:63] op_sel:[1,0] op_sel_hi:[1,1]
    v_pk_mul_f32 v[64:65], v[122:123], v[64:65] op_sel:[0,0] op_sel_hi:[0,1]
    v_pk_mul_f32 v[66:67], v[122:123], v[66:67] op_sel:[0,0] op_sel_hi:[0,1]
    v_pk_mul_f32 v[68:69], v[122:123], v[68:69] op_sel:[0,0] op_sel_hi:[0,1]
    v_pk_mul_f32 v[70:71], v[122:123], v[70:71] op_sel:[0,0] op_sel_hi:[0,1]
    v_cvt_pk_bf16_f32 v32, v32, v33
    v_cvt_pk_bf16_f32 v33, v34, v35
    v_cvt_pk_bf16_f32 v34, v36, v37
    v_cvt_pk_bf16_f32 v35, v38, v39
    v_cvt_pk_bf16_f32 v40, v40, v41
    v_cvt_pk_bf16_f32 v41, v42, v43
    v_cvt_pk_bf16_f32 v42, v44, v45
    v_cvt_pk_bf16_f32 v43, v46, v47
    v_cvt_pk_bf16_f32 v48, v48, v49
    v_cvt_pk_bf16_f32 v49, v50, v51
    v_cvt_pk_bf16_f32 v50, v52, v53
    v_cvt_pk_bf16_f32 v51, v54, v55
    v_cvt_pk_bf16_f32 v56, v56, v57
    v_cvt_pk_bf16_f32 v57, v58, v59
    v_cvt_pk_bf16_f32 v58, v60, v61
    v_cvt_pk_bf16_f32 v59, v62, v63
    v_cvt_pk_bf16_f32 v64, v64, v65
    v_cvt_pk_bf16_f32 v65, v66, v67
    v_cvt_pk_bf16_f32 v66, v68, v69
    v_cvt_pk_bf16_f32 v67, v70, v71
    v_readfirstlane_b32 s45, v170
    s_waitcnt lgkmcnt(0)
    v_mfma_f32_16x16x32_bf16 v[4:7], v[40:43], v[0:3], 0
    v_mfma_f32_16x16x32_bf16 v[44:47], v[32:35], v[0:3], 0
    v_mfma_f32_16x16x32_bf16 v[12:15], v[48:51], v[8:11], 0
    v_mfma_f32_16x16x32_bf16 v[52:55], v[40:43], v[8:11], 0
    v_mfma_f32_16x16x32_bf16 v[20:23], v[56:59], v[16:19], 0
    v_mfma_f32_16x16x32_bf16 v[60:63], v[48:51], v[16:19], 0
    v_mfma_f32_16x16x32_bf16 v[28:31], v[64:67], v[24:27], 0
    v_mfma_f32_16x16x32_bf16 v[68:71], v[56:59], v[24:27], 0
    v_pk_fma_f32 v[72:73], v[132:133], v[168:169], v[72:73] op_sel:[0,0,0] op_sel_hi:[1,0,1]
    v_pk_fma_f32 v[74:75], v[134:135], v[168:169], v[74:75] op_sel:[0,0,0] op_sel_hi:[1,0,1]
    v_pk_fma_f32 v[76:77], v[132:133], v[168:169], v[76:77] op_sel:[0,1,0] op_sel_hi:[1,1,1]
    v_pk_fma_f32 v[78:79], v[134:135], v[168:169], v[78:79] op_sel:[0,1,0] op_sel_hi:[1,1,1]
    v_pk_fma_f32 v[80:81], v[136:137], v[168:169], v[80:81] op_sel:[0,0,0] op_sel_hi:[1,0,1]
    v_pk_fma_f32 v[82:83], v[138:139], v[168:169], v[82:83] op_sel:[0,0,0] op_sel_hi:[1,0,1]
    v_pk_fma_f32 v[84:85], v[136:137], v[168:169], v[84:85] op_sel:[0,1,0] op_sel_hi:[1,1,1]
    v_pk_fma_f32 v[86:87], v[138:139], v[168:169], v[86:87] op_sel:[0,1,0] op_sel_hi:[1,1,1]
    v_pk_fma_f32 v[88:89], v[140:141], v[168:169], v[88:89] op_sel:[0,0,0] op_sel_hi:[1,0,1]
    v_pk_fma_f32 v[90:91], v[142:143], v[168:169], v[90:91] op_sel:[0,0,0] op_sel_hi:[1,0,1]
    v_pk_fma_f32 v[92:93], v[140:141], v[168:169], v[92:93] op_sel:[0,1,0] op_sel_hi:[1,1,1]
    v_pk_fma_f32 v[94:95], v[142:143], v[168:169], v[94:95] op_sel:[0,1,0] op_sel_hi:[1,1,1]
    v_pk_fma_f32 v[96:97], v[144:145], v[168:169], v[96:97] op_sel:[0,0,0] op_sel_hi:[1,0,1]
    v_pk_fma_f32 v[98:99], v[146:147], v[168:169], v[98:99] op_sel:[0,0,0] op_sel_hi:[1,0,1]
    v_pk_fma_f32 v[100:101], v[144:145], v[168:169], v[100:101] op_sel:[0,1,0] op_sel_hi:[1,1,1]
    v_pk_fma_f32 v[102:103], v[146:147], v[168:169], v[102:103] op_sel:[0,1,0] op_sel_hi:[1,1,1]
    v_pk_fma_f32 v[104:105], v[148:149], v[168:169], v[104:105] op_sel:[0,0,0] op_sel_hi:[1,0,1]
    v_pk_fma_f32 v[106:107], v[150:151], v[168:169], v[106:107] op_sel:[0,0,0] op_sel_hi:[1,0,1]
    v_pk_fma_f32 v[108:109], v[148:149], v[168:169], v[108:109] op_sel:[0,1,0] op_sel_hi:[1,1,1]
    v_pk_fma_f32 v[110:111], v[150:151], v[168:169], v[110:111] op_sel:[0,1,0] op_sel_hi:[1,1,1]
    v_cndmask_b32 v44, v44, v4, s[72:73]
    v_cndmask_b32 v45, v45, v5, s[74:75]
    v_cndmask_b32 v46, v46, v6, s[76:77]
    v_cndmask_b32 v47, v47, v7, s[78:79]
    v_cndmask_b32 v52, v52, v12, s[72:73]
    v_cndmask_b32 v53, v53, v13, s[74:75]
    v_cndmask_b32 v54, v54, v14, s[76:77]
    v_cndmask_b32 v55, v55, v15, s[78:79]
    v_cndmask_b32 v60, v60, v20, s[72:73]
    v_cndmask_b32 v61, v61, v21, s[74:75]
    v_cndmask_b32 v62, v62, v22, s[76:77]
    v_cndmask_b32 v63, v63, v23, s[78:79]
    v_cndmask_b32 v68, v68, v28, s[72:73]
    v_cndmask_b32 v69, v69, v29, s[74:75]
    v_cndmask_b32 v70, v70, v30, s[76:77]
    v_cndmask_b32 v71, v71, v31, s[78:79]
    v_cndmask_b32 v44, v44, v45, s[80:81]
    v_cndmask_b32 v45, v46, v47, s[80:81]
    v_cndmask_b32 v52, v52, v53, s[80:81]
    v_cndmask_b32 v53, v54, v55, s[80:81]
    v_cndmask_b32 v60, v60, v61, s[80:81]
    v_cndmask_b32 v61, v62, v63, s[80:81]
    v_cndmask_b32 v68, v68, v69, s[80:81]
    v_cndmask_b32 v69, v70, v71, s[80:81]
    v_mov_b32 v209, 0xf149f2ca
    v_cndmask_b32 v44, v44, v209, s[82:83]
    v_cndmask_b32 v45, v45, v209, s[84:85]
    v_max_f32 v46, v44, v45
    v_max_f32 v54, v52, v53
    v_max_f32 v62, v60, v61
    v_max_f32 v70, v68, v69
    v_pk_mul_f32 v[72:73], v[176:177], v[72:73] op_sel:[0,0] op_sel_hi:[1,1]
    v_pk_mul_f32 v[74:75], v[178:179], v[74:75] op_sel:[0,0] op_sel_hi:[1,1]
    v_permlane32_swap_b32 v46, v62
    v_permlane32_swap_b32 v54, v70
    v_max_f32 v46, v46, v62
    v_max_f32 v54, v54, v70
    v_pk_mul_f32 v[76:77], v[176:177], v[76:77] op_sel:[0,0] op_sel_hi:[1,1]
    v_pk_mul_f32 v[78:79], v[178:179], v[78:79] op_sel:[0,0] op_sel_hi:[1,1]
    v_permlane16_swap_b32 v46, v54
    v_max_f32 v46, v46, v54
    v_mov_b32 v54, v46
    v_pk_mul_f32 v[80:81], v[180:181], v[80:81] op_sel:[0,0] op_sel_hi:[1,1]
    v_pk_mul_f32 v[82:83], v[182:183], v[82:83] op_sel:[0,0] op_sel_hi:[1,1]
    v_permlane16_swap_b32 v46, v54
    v_mov_b32 v62, v46
    v_mov_b32 v70, v54
    v_pk_mul_f32 v[84:85], v[180:181], v[84:85] op_sel:[0,0] op_sel_hi:[1,1]
    v_pk_mul_f32 v[86:87], v[182:183], v[86:87] op_sel:[0,0] op_sel_hi:[1,1]
    v_permlane32_swap_b32 v46, v62
    v_permlane32_swap_b32 v54, v70
    v_mul_f32 v119, 0x3e8293ee, v119
    v_mul_f32 v120, 0x3e8293ee, v120
    v_mul_f32 v121, 0x3e8293ee, v121
    v_mul_f32 v122, 0x3e8293ee, v122
    v_sub_f32 v44, v44, v46
    v_sub_f32 v45, v45, v46
    v_sub_f32 v52, v52, v54
    v_sub_f32 v53, v53, v54
    v_sub_f32 v60, v60, v62
    v_sub_f32 v61, v61, v62
    v_sub_f32 v68, v68, v70
    v_sub_f32 v69, v69, v70
    v_mul_f32 v44, v119, v44
    v_mul_f32 v45, v119, v45
    v_mul_f32 v52, v120, v52
    v_mul_f32 v53, v120, v53
    v_mul_f32 v60, v121, v60
    v_mul_f32 v61, v121, v61
    v_mul_f32 v68, v122, v68
    v_mul_f32 v69, v122, v69
    v_exp_f32 v44, v44
    v_exp_f32 v45, v45
    v_exp_f32 v52, v52
    v_exp_f32 v53, v53
    v_exp_f32 v60, v60
    v_exp_f32 v61, v61
    v_exp_f32 v68, v68
    v_exp_f32 v69, v69
    .p2align 3
    v_pk_mul_f32 v[88:89], v[184:185], v[88:89] op_sel:[0,0] op_sel_hi:[1,1]
    v_pk_mul_f32 v[90:91], v[186:187], v[90:91] op_sel:[0,0] op_sel_hi:[1,1]
    v_pk_mul_f32 v[92:93], v[184:185], v[92:93] op_sel:[0,0] op_sel_hi:[1,1]
    v_pk_mul_f32 v[94:95], v[186:187], v[94:95] op_sel:[0,0] op_sel_hi:[1,1]
    v_pk_mul_f32 v[96:97], v[188:189], v[96:97] op_sel:[0,0] op_sel_hi:[1,1]
    v_pk_mul_f32 v[98:99], v[190:191], v[98:99] op_sel:[0,0] op_sel_hi:[1,1]
    v_pk_mul_f32 v[100:101], v[188:189], v[100:101] op_sel:[0,0] op_sel_hi:[1,1]
    v_pk_mul_f32 v[102:103], v[190:191], v[102:103] op_sel:[0,0] op_sel_hi:[1,1]
    v_pk_mul_f32 v[104:105], v[192:193], v[104:105] op_sel:[0,0] op_sel_hi:[1,1]
    v_pk_mul_f32 v[106:107], v[194:195], v[106:107] op_sel:[0,0] op_sel_hi:[1,1]
    v_pk_mul_f32 v[108:109], v[192:193], v[108:109] op_sel:[0,0] op_sel_hi:[1,1]
    v_pk_mul_f32 v[110:111], v[194:195], v[110:111] op_sel:[0,0] op_sel_hi:[1,1]
    v_cvt_pk_bf16_f32 v44, v44, v45
    v_cvt_pk_bf16_f32 v52, v52, v53
    v_cvt_pk_bf16_f32 v60, v60, v61
    v_cvt_pk_bf16_f32 v68, v68, v69
    v_cvt_pk_bf16_f32 v226, v72, v73
    v_cvt_pk_bf16_f32 v227, v74, v75
    v_cvt_pk_bf16_f32 v152, v76, v77
    v_cvt_pk_bf16_f32 v153, v78, v79
    v_cvt_pk_bf16_f32 v228, v80, v81
    v_cvt_pk_bf16_f32 v229, v82, v83
    v_cvt_pk_bf16_f32 v154, v84, v85
    v_cvt_pk_bf16_f32 v155, v86, v87
    v_cvt_pk_bf16_f32 v230, v88, v89
    v_cvt_pk_bf16_f32 v231, v90, v91
    v_cvt_pk_bf16_f32 v156, v92, v93
    v_cvt_pk_bf16_f32 v157, v94, v95
    v_cvt_pk_bf16_f32 v232, v96, v97
    v_cvt_pk_bf16_f32 v233, v98, v99
    v_cvt_pk_bf16_f32 v158, v100, v101
    v_cvt_pk_bf16_f32 v159, v102, v103
    v_cvt_pk_bf16_f32 v234, v104, v105
    v_cvt_pk_bf16_f32 v235, v106, v107
    v_cvt_pk_bf16_f32 v160, v108, v109
    v_cvt_pk_bf16_f32 v161, v110, v111
    v_perm_b32 v4, v44, v44, v214
    v_perm_b32 v5, v44, v44, v215
    v_perm_b32 v6, v44, v44, v216
    v_perm_b32 v7, v44, v44, v217
    v_perm_b32 v12, v52, v52, v214
    v_perm_b32 v13, v52, v52, v215
    v_perm_b32 v14, v52, v52, v216
    v_perm_b32 v15, v52, v52, v217
    v_perm_b32 v20, v60, v60, v214
    v_perm_b32 v21, v60, v60, v215
    v_perm_b32 v22, v60, v60, v216
    v_perm_b32 v23, v60, v60, v217
    v_perm_b32 v28, v68, v68, v214
    v_perm_b32 v29, v68, v68, v215
    v_perm_b32 v30, v68, v68, v216
    v_perm_b32 v31, v68, v68, v217
    s_add_u32 s55, s88, 4096
    v_mfma_f32_16x16x32_bf16 v[0:3], v[222:225], v[4:7], 0
    v_mfma_f32_16x16x32_bf16 v[8:11], v[222:225], v[12:15], 0
    v_mfma_f32_16x16x32_bf16 v[16:19], v[222:225], v[20:23], 0
    v_mfma_f32_16x16x32_bf16 v[24:27], v[222:225], v[28:31], 0
    v_mfma_f32_16x16x32_bf16 v[72:75], v[226:229], v[4:7], 0
    v_mfma_f32_16x16x32_bf16 v[76:79], v[152:155], v[4:7], 0
    v_mfma_f32_16x16x32_bf16 v[80:83], v[228:231], v[12:15], 0
    v_mfma_f32_16x16x32_bf16 v[84:87], v[154:157], v[12:15], 0
    v_mfma_f32_16x16x32_bf16 v[88:91], v[230:233], v[20:23], 0
    v_mfma_f32_16x16x32_bf16 v[92:95], v[156:159], v[20:23], 0
    v_mfma_f32_16x16x32_bf16 v[96:99], v[232:235], v[28:31], 0
    v_mfma_f32_16x16x32_bf16 v[100:103], v[158:161], v[28:31], 0
    v_rcp_f32 v0, v0
    v_rcp_f32 v8, v8
    v_rcp_f32 v16, v16
    v_rcp_f32 v24, v24
    v_pk_mul_f32 v[72:73], v[0:1], v[72:73] op_sel:[0,0] op_sel_hi:[0,1]
    v_pk_mul_f32 v[74:75], v[0:1], v[74:75] op_sel:[0,0] op_sel_hi:[0,1]
    v_pk_mul_f32 v[76:77], v[0:1], v[76:77] op_sel:[0,0] op_sel_hi:[0,1]
    v_pk_mul_f32 v[78:79], v[0:1], v[78:79] op_sel:[0,0] op_sel_hi:[0,1]
    v_cvt_pk_bf16_f32 v72, v72, v73
    v_cvt_pk_bf16_f32 v73, v74, v75
    v_cvt_pk_bf16_f32 v74, v76, v77
    v_cvt_pk_bf16_f32 v75, v78, v79
    buffer_store_dwordx4 v[72:75], v254, s[4:7], s88 offen offset:0 sc0 sc1
    v_pk_mul_f32 v[80:81], v[8:9], v[80:81] op_sel:[0,0] op_sel_hi:[0,1]
    v_pk_mul_f32 v[82:83], v[8:9], v[82:83] op_sel:[0,0] op_sel_hi:[0,1]
    v_pk_mul_f32 v[84:85], v[8:9], v[84:85] op_sel:[0,0] op_sel_hi:[0,1]
    v_pk_mul_f32 v[86:87], v[8:9], v[86:87] op_sel:[0,0] op_sel_hi:[0,1]
    v_cvt_pk_bf16_f32 v80, v80, v81
    v_cvt_pk_bf16_f32 v81, v82, v83
    v_cvt_pk_bf16_f32 v82, v84, v85
    v_cvt_pk_bf16_f32 v83, v86, v87
    buffer_store_dwordx4 v[80:83], v254, s[4:7], s88 offen offset:2048 sc0 sc1
    v_pk_mul_f32 v[88:89], v[16:17], v[88:89] op_sel:[0,0] op_sel_hi:[0,1]
    v_pk_mul_f32 v[90:91], v[16:17], v[90:91] op_sel:[0,0] op_sel_hi:[0,1]
    v_pk_mul_f32 v[92:93], v[16:17], v[92:93] op_sel:[0,0] op_sel_hi:[0,1]
    v_pk_mul_f32 v[94:95], v[16:17], v[94:95] op_sel:[0,0] op_sel_hi:[0,1]
    v_cvt_pk_bf16_f32 v88, v88, v89
    v_cvt_pk_bf16_f32 v89, v90, v91
    v_cvt_pk_bf16_f32 v90, v92, v93
    v_cvt_pk_bf16_f32 v91, v94, v95
    buffer_store_dwordx4 v[88:91], v254, s[4:7], s55 offen offset:0 sc0 sc1
    s_nop 1
    v_pk_mul_f32 v[96:97], v[24:25], v[96:97] op_sel:[0,0] op_sel_hi:[0,1]
    v_pk_mul_f32 v[98:99], v[24:25], v[98:99] op_sel:[0,0] op_sel_hi:[0,1]
    v_pk_mul_f32 v[100:101], v[24:25], v[100:101] op_sel:[0,0] op_sel_hi:[0,1]
    v_pk_mul_f32 v[102:103], v[24:25], v[102:103] op_sel:[0,0] op_sel_hi:[0,1]
    v_cvt_pk_bf16_f32 v96, v96, v97
    v_cvt_pk_bf16_f32 v97, v98, v99
    v_cvt_pk_bf16_f32 v98, v100, v101
    v_cvt_pk_bf16_f32 v99, v102, v103
    buffer_store_dwordx4 v[96:99], v254, s[4:7], s55 offen offset:2048 sc0 sc1
    s_lshl_b32 s55, s43, 13
    s_add_u32 s55, s55, 98304
    v_add_u32 v136, s55, v254
    v_lshrrev_b32 v152, 6, v254
    v_lshrrev_b32 v153, 1, v152
    v_and_b32 v153, 3, v153
    s_lshl_b32 s55, s44, 1
    v_xor_b32 v153, s55, v153
    v_lshlrev_b32 v152, 7, v152
    v_lshl_add_u32 v152, v153, 5, v152
    v_and_b32 v153, 0x30, v254
    v_lshrrev_b32 v153, 1, v153
    v_add_u32 v137, v152, v153
    v_xor_b32 v138, 32, v137
    v_add_u32 v139, 49152, v137
    v_add_u32 v140, 49152, v138
    v_lshlrev_b32 v0, 16, v236
    v_and_b32 v1, 0xffff0000, v236
    v_lshlrev_b32 v2, 16, v237
    v_and_b32 v3, 0xffff0000, v237
    v_lshlrev_b32 v16, 16, v238
    v_and_b32 v17, 0xffff0000, v238
    v_lshlrev_b32 v18, 16, v239
    v_and_b32 v19, 0xffff0000, v239
    v_lshlrev_b32 v4, 16, v240
    v_and_b32 v5, 0xffff0000, v240
    v_lshlrev_b32 v6, 16, v241
    v_and_b32 v7, 0xffff0000, v241
    v_lshlrev_b32 v20, 16, v242
    v_and_b32 v21, 0xffff0000, v242
    v_lshlrev_b32 v22, 16, v243
    v_and_b32 v23, 0xffff0000, v243
    v_lshlrev_b32 v8, 16, v244
    v_and_b32 v9, 0xffff0000, v244
    v_lshlrev_b32 v10, 16, v245
    v_and_b32 v11, 0xffff0000, v245
    v_lshlrev_b32 v24, 16, v246
    v_and_b32 v25, 0xffff0000, v246
    v_lshlrev_b32 v26, 16, v247
    v_and_b32 v27, 0xffff0000, v247
    v_lshlrev_b32 v12, 16, v248
    v_and_b32 v13, 0xffff0000, v248
    v_lshlrev_b32 v14, 16, v249
    v_and_b32 v15, 0xffff0000, v249
    v_lshlrev_b32 v28, 16, v250
    v_and_b32 v29, 0xffff0000, v250
    v_lshlrev_b32 v30, 16, v251
    v_and_b32 v31, 0xffff0000, v251
    s_waitcnt vmcnt(0)
    s_barrier
    s_cmp_lg_u32 s42, 2
    s_cbranch_scc1 wf_16
    s_lshr_b32 s55, s2, 5
    s_lshl_b32 s55, s55, 2
    s_add_u32 s55, s55, s0
    v_mov_b32 v252, 0
    v_mov_b32 v253, 0x01010101
    s_mov_b64 exec, 1
    s_cmp_eq_u32 s45, 0
    s_cbranch_scc1 st_17
    buffer_store_dword v253, v252, s[4:7], s55 offen sc0 sc1
    s_branch st_18
st_17:
    buffer_store_dword v253, v252, s[4:7], s55 offen
st_18:
    s_mov_b64 exec, -1
wf_16:
    s_cmp_lg_u32 s42, 3
    s_cbranch_scc1 wf_19
    s_lshl_b32 s55, s51, 2
    s_add_u32 s55, s55, s54
    v_mov_b32 v252, 0
    v_mov_b32 v253, 0x01010101
    s_mov_b64 exec, 1
    buffer_store_dword v253, v252, s[4:7], s55 offen sc0 sc1
    s_mov_b64 exec, -1
wf_19:
    s_barrier
    ds_read_b64_tr_b16 v[104:105], v137 offset:32768
    ds_read_b64_tr_b16 v[106:107], v137 offset:34816
    ds_read_b128 v[32:35], v136 offset:0
    ds_read_b128 v[36:39], v136 offset:2048
    ds_read_b128 v[40:43], v136 offset:4096
    ds_read_b128 v[44:47], v136 offset:6144
    ds_read_b64_tr_b16 v[108:109], v138 offset:32768
    ds_read_b64_tr_b16 v[110:111], v138 offset:34816
    ds_read_b64_tr_b16 v[112:113], v137 offset:36864
    ds_read_b64_tr_b16 v[114:115], v137 offset:38912
    ds_read_b128 v[48:51], v136 offset:1024
    ds_read_b128 v[52:55], v136 offset:3072
    ds_read_b128 v[56:59], v136 offset:5120
    ds_read_b128 v[60:63], v136 offset:7168
    ds_read_b64_tr_b16 v[116:117], v138 offset:36864
    ds_read_b64_tr_b16 v[118:119], v138 offset:38912
    s_waitcnt lgkmcnt(0)
    s_barrier
    .p2align 3
    v_mfma_f32_16x16x32_bf16 v[0:3], v[104:107], v[32:35], v[0:3]
    ds_read_b64_tr_b16 v[120:121], v137 offset:40960
    ds_read_b64_tr_b16 v[122:123], v137 offset:43008
    v_mfma_f32_16x16x32_bf16 v[0:3], v[112:115], v[48:51], v[0:3]
    ds_read_b128 v[64:67], v136 offset:16384
    v_mfma_f32_16x16x32_bf16 v[4:7], v[112:115], v[52:55], v[4:7]
    ds_read_b128 v[68:71], v136 offset:18432
    v_mfma_f32_16x16x32_bf16 v[4:7], v[104:107], v[36:39], v[4:7]
    ds_read_b128 v[72:75], v136 offset:20480
    ds_read_b128 v[76:79], v136 offset:22528
    v_mfma_f32_16x16x32_bf16 v[8:11], v[104:107], v[40:43], v[8:11]
    ds_read_b64_tr_b16 v[124:125], v138 offset:40960
    v_mfma_f32_16x16x32_bf16 v[8:11], v[112:115], v[56:59], v[8:11]
    ds_read_b64_tr_b16 v[126:127], v138 offset:43008
    v_mfma_f32_16x16x32_bf16 v[12:15], v[112:115], v[60:63], v[12:15]
    ds_read_b64_tr_b16 v[128:129], v137 offset:45056
    ds_read_b64_tr_b16 v[130:131], v137 offset:47104
    v_mfma_f32_16x16x32_bf16 v[12:15], v[104:107], v[44:47], v[12:15]
    ds_read_b128 v[80:83], v136 offset:17408
    v_mfma_f32_16x16x32_bf16 v[28:31], v[108:111], v[44:47], v[28:31]
    ds_read_b128 v[84:87], v136 offset:19456
    v_mfma_f32_16x16x32_bf16 v[28:31], v[116:119], v[60:63], v[28:31]
    ds_read_b128 v[88:91], v136 offset:21504
    ds_read_b128 v[92:95], v136 offset:23552
    v_mfma_f32_16x16x32_bf16 v[24:27], v[116:119], v[56:59], v[24:27]
    ds_read_b64_tr_b16 v[132:133], v138 offset:45056
    v_mfma_f32_16x16x32_bf16 v[24:27], v[108:111], v[40:43], v[24:27]
    ds_read_b64_tr_b16 v[134:135], v138 offset:47104
    v_mfma_f32_16x16x32_bf16 v[20:23], v[108:111], v[36:39], v[20:23]
    v_mfma_f32_16x16x32_bf16 v[20:23], v[116:119], v[52:55], v[20:23]
    v_mfma_f32_16x16x32_bf16 v[16:19], v[116:119], v[48:51], v[16:19]
    v_mfma_f32_16x16x32_bf16 v[16:19], v[108:111], v[32:35], v[16:19]
    s_waitcnt lgkmcnt(0)
    s_barrier
    .p2align 3
    v_mfma_f32_16x16x32_bf16 v[0:3], v[120:123], v[64:67], v[0:3]
    ds_read_b64_tr_b16 v[104:105], v139 offset:0
    ds_read_b64_tr_b16 v[106:107], v139 offset:2048
    v_mfma_f32_16x16x32_bf16 v[0:3], v[128:131], v[80:83], v[0:3]
    ds_read_b128 v[32:35], v136 offset:32768
    v_mfma_f32_16x16x32_bf16 v[4:7], v[128:131], v[84:87], v[4:7]
    ds_read_b128 v[36:39], v136 offset:34816
    v_mfma_f32_16x16x32_bf16 v[4:7], v[120:123], v[68:71], v[4:7]
    ds_read_b128 v[40:43], v136 offset:36864
    ds_read_b128 v[44:47], v136 offset:38912
    v_mfma_f32_16x16x32_bf16 v[8:11], v[120:123], v[72:75], v[8:11]
    ds_read_b64_tr_b16 v[108:109], v140 offset:0
    v_mfma_f32_16x16x32_bf16 v[8:11], v[128:131], v[88:91], v[8:11]
    ds_read_b64_tr_b16 v[110:111], v140 offset:2048
    v_mfma_f32_16x16x32_bf16 v[12:15], v[128:131], v[92:95], v[12:15]
    ds_read_b64_tr_b16 v[112:113], v139 offset:4096
    ds_read_b64_tr_b16 v[114:115], v139 offset:6144
    v_mfma_f32_16x16x32_bf16 v[12:15], v[120:123], v[76:79], v[12:15]
    ds_read_b128 v[48:51], v136 offset:33792
    v_mfma_f32_16x16x32_bf16 v[28:31], v[124:127], v[76:79], v[28:31]
    ds_read_b128 v[52:55], v136 offset:35840
    v_mfma_f32_16x16x32_bf16 v[28:31], v[132:135], v[92:95], v[28:31]
    ds_read_b128 v[56:59], v136 offset:37888
    ds_read_b128 v[60:63], v136 offset:39936
    v_mfma_f32_16x16x32_bf16 v[24:27], v[132:135], v[88:91], v[24:27]
    ds_read_b64_tr_b16 v[116:117], v140 offset:4096
    v_mfma_f32_16x16x32_bf16 v[24:27], v[124:127], v[72:75], v[24:27]
    ds_read_b64_tr_b16 v[118:119], v140 offset:6144
    v_mfma_f32_16x16x32_bf16 v[20:23], v[124:127], v[68:71], v[20:23]
    v_mfma_f32_16x16x32_bf16 v[20:23], v[132:135], v[84:87], v[20:23]
    v_mfma_f32_16x16x32_bf16 v[16:19], v[132:135], v[80:83], v[16:19]
    v_mfma_f32_16x16x32_bf16 v[16:19], v[124:127], v[64:67], v[16:19]
    s_waitcnt lgkmcnt(0)
    s_barrier
    .p2align 3
    v_mfma_f32_16x16x32_bf16 v[0:3], v[104:107], v[32:35], v[0:3]
    ds_read_b64_tr_b16 v[120:121], v139 offset:8192
    ds_read_b64_tr_b16 v[122:123], v139 offset:10240
    v_mfma_f32_16x16x32_bf16 v[0:3], v[112:115], v[48:51], v[0:3]
    ds_read_b128 v[64:67], v136 offset:0
    v_mfma_f32_16x16x32_bf16 v[4:7], v[112:115], v[52:55], v[4:7]
    ds_read_b128 v[68:71], v136 offset:2048
    v_mfma_f32_16x16x32_bf16 v[4:7], v[104:107], v[36:39], v[4:7]
    ds_read_b128 v[72:75], v136 offset:4096
    ds_read_b128 v[76:79], v136 offset:6144
    v_mfma_f32_16x16x32_bf16 v[8:11], v[104:107], v[40:43], v[8:11]
    ds_read_b64_tr_b16 v[124:125], v140 offset:8192
    v_mfma_f32_16x16x32_bf16 v[8:11], v[112:115], v[56:59], v[8:11]
    ds_read_b64_tr_b16 v[126:127], v140 offset:10240
    v_mfma_f32_16x16x32_bf16 v[12:15], v[112:115], v[60:63], v[12:15]
    ds_read_b64_tr_b16 v[128:129], v139 offset:12288
    ds_read_b64_tr_b16 v[130:131], v139 offset:14336
    v_mfma_f32_16x16x32_bf16 v[12:15], v[104:107], v[44:47], v[12:15]
    ds_read_b128 v[80:83], v136 offset:1024
    v_mfma_f32_16x16x32_bf16 v[28:31], v[108:111], v[44:47], v[28:31]
    ds_read_b128 v[84:87], v136 offset:3072
    v_mfma_f32_16x16x32_bf16 v[28:31], v[116:119], v[60:63], v[28:31]
    ds_read_b128 v[88:91], v136 offset:5120
    ds_read_b128 v[92:95], v136 offset:7168
    v_mfma_f32_16x16x32_bf16 v[24:27], v[116:119], v[56:59], v[24:27]
    ds_read_b64_tr_b16 v[132:133], v140 offset:12288
    v_mfma_f32_16x16x32_bf16 v[24:27], v[108:111], v[40:43], v[24:27]
    ds_read_b64_tr_b16 v[134:135], v140 offset:14336
    v_mfma_f32_16x16x32_bf16 v[20:23], v[108:111], v[36:39], v[20:23]
    v_mfma_f32_16x16x32_bf16 v[20:23], v[116:119], v[52:55], v[20:23]
    v_mfma_f32_16x16x32_bf16 v[16:19], v[116:119], v[48:51], v[16:19]
    v_mfma_f32_16x16x32_bf16 v[16:19], v[108:111], v[32:35], v[16:19]
    s_waitcnt lgkmcnt(0)
    s_barrier
    .p2align 3
    v_mfma_f32_16x16x32_bf16 v[0:3], v[120:123], v[64:67], v[0:3]
    ds_read_b64_tr_b16 v[104:105], v139 offset:16384
    ds_read_b64_tr_b16 v[106:107], v139 offset:18432
    v_mfma_f32_16x16x32_bf16 v[0:3], v[128:131], v[80:83], v[0:3]
    ds_read_b128 v[32:35], v136 offset:16384
    v_mfma_f32_16x16x32_bf16 v[4:7], v[128:131], v[84:87], v[4:7]
    ds_read_b128 v[36:39], v136 offset:18432
    v_mfma_f32_16x16x32_bf16 v[4:7], v[120:123], v[68:71], v[4:7]
    ds_read_b128 v[40:43], v136 offset:20480
    ds_read_b128 v[44:47], v136 offset:22528
    v_mfma_f32_16x16x32_bf16 v[8:11], v[120:123], v[72:75], v[8:11]
    ds_read_b64_tr_b16 v[108:109], v140 offset:16384
    v_mfma_f32_16x16x32_bf16 v[8:11], v[128:131], v[88:91], v[8:11]
    ds_read_b64_tr_b16 v[110:111], v140 offset:18432
    v_mfma_f32_16x16x32_bf16 v[12:15], v[128:131], v[92:95], v[12:15]
    ds_read_b64_tr_b16 v[112:113], v139 offset:20480
    ds_read_b64_tr_b16 v[114:115], v139 offset:22528
    v_mfma_f32_16x16x32_bf16 v[12:15], v[120:123], v[76:79], v[12:15]
    ds_read_b128 v[48:51], v136 offset:17408
    v_mfma_f32_16x16x32_bf16 v[28:31], v[124:127], v[76:79], v[28:31]
    ds_read_b128 v[52:55], v136 offset:19456
    v_mfma_f32_16x16x32_bf16 v[28:31], v[132:135], v[92:95], v[28:31]
    ds_read_b128 v[56:59], v136 offset:21504
    ds_read_b128 v[60:63], v136 offset:23552
    v_mfma_f32_16x16x32_bf16 v[24:27], v[132:135], v[88:91], v[24:27]
    ds_read_b64_tr_b16 v[116:117], v140 offset:20480
    v_mfma_f32_16x16x32_bf16 v[24:27], v[124:127], v[72:75], v[24:27]
    ds_read_b64_tr_b16 v[118:119], v140 offset:22528
    v_mfma_f32_16x16x32_bf16 v[20:23], v[124:127], v[68:71], v[20:23]
    v_mfma_f32_16x16x32_bf16 v[20:23], v[132:135], v[84:87], v[20:23]
    v_mfma_f32_16x16x32_bf16 v[16:19], v[132:135], v[80:83], v[16:19]
    v_mfma_f32_16x16x32_bf16 v[16:19], v[124:127], v[64:67], v[16:19]
    s_waitcnt lgkmcnt(0)
    s_barrier
    .p2align 3
    v_mfma_f32_16x16x32_bf16 v[0:3], v[104:107], v[32:35], v[0:3]
    ds_read_b64_tr_b16 v[120:121], v139 offset:24576
    ds_read_b64_tr_b16 v[122:123], v139 offset:26624
    v_mfma_f32_16x16x32_bf16 v[0:3], v[112:115], v[48:51], v[0:3]
    ds_read_b128 v[64:67], v136 offset:32768
    v_mfma_f32_16x16x32_bf16 v[4:7], v[112:115], v[52:55], v[4:7]
    ds_read_b128 v[68:71], v136 offset:34816
    v_mfma_f32_16x16x32_bf16 v[4:7], v[104:107], v[36:39], v[4:7]
    ds_read_b128 v[72:75], v136 offset:36864
    ds_read_b128 v[76:79], v136 offset:38912
    v_mfma_f32_16x16x32_bf16 v[8:11], v[104:107], v[40:43], v[8:11]
    ds_read_b64_tr_b16 v[124:125], v140 offset:24576
    v_mfma_f32_16x16x32_bf16 v[8:11], v[112:115], v[56:59], v[8:11]
    ds_read_b64_tr_b16 v[126:127], v140 offset:26624
    v_mfma_f32_16x16x32_bf16 v[12:15], v[112:115], v[60:63], v[12:15]
    ds_read_b64_tr_b16 v[128:129], v139 offset:28672
    ds_read_b64_tr_b16 v[130:131], v139 offset:30720
    v_mfma_f32_16x16x32_bf16 v[12:15], v[104:107], v[44:47], v[12:15]
    ds_read_b128 v[80:83], v136 offset:33792
    v_mfma_f32_16x16x32_bf16 v[28:31], v[108:111], v[44:47], v[28:31]
    ds_read_b128 v[84:87], v136 offset:35840
    v_mfma_f32_16x16x32_bf16 v[28:31], v[116:119], v[60:63], v[28:31]
    ds_read_b128 v[88:91], v136 offset:37888
    ds_read_b128 v[92:95], v136 offset:39936
    v_mfma_f32_16x16x32_bf16 v[24:27], v[116:119], v[56:59], v[24:27]
    ds_read_b64_tr_b16 v[132:133], v140 offset:28672
    v_mfma_f32_16x16x32_bf16 v[24:27], v[108:111], v[40:43], v[24:27]
    ds_read_b64_tr_b16 v[134:135], v140 offset:30720
    v_mfma_f32_16x16x32_bf16 v[20:23], v[108:111], v[36:39], v[20:23]
    v_mfma_f32_16x16x32_bf16 v[20:23], v[116:119], v[52:55], v[20:23]
    v_mfma_f32_16x16x32_bf16 v[16:19], v[116:119], v[48:51], v[16:19]
    v_mfma_f32_16x16x32_bf16 v[16:19], v[108:111], v[32:35], v[16:19]
    s_waitcnt lgkmcnt(0)
    s_barrier
    .p2align 3
    v_mfma_f32_16x16x32_bf16 v[0:3], v[120:123], v[64:67], v[0:3]
    ds_read_b64_tr_b16 v[104:105], v139 offset:32768
    ds_read_b64_tr_b16 v[106:107], v139 offset:34816
    v_mfma_f32_16x16x32_bf16 v[0:3], v[128:131], v[80:83], v[0:3]
    ds_read_b128 v[32:35], v136 offset:0
    v_mfma_f32_16x16x32_bf16 v[4:7], v[128:131], v[84:87], v[4:7]
    ds_read_b128 v[36:39], v136 offset:2048
    v_mfma_f32_16x16x32_bf16 v[4:7], v[120:123], v[68:71], v[4:7]
    ds_read_b128 v[40:43], v136 offset:4096
    ds_read_b128 v[44:47], v136 offset:6144
    v_mfma_f32_16x16x32_bf16 v[8:11], v[120:123], v[72:75], v[8:11]
    ds_read_b64_tr_b16 v[108:109], v140 offset:32768
    v_mfma_f32_16x16x32_bf16 v[8:11], v[128:131], v[88:91], v[8:11]
    ds_read_b64_tr_b16 v[110:111], v140 offset:34816
    v_mfma_f32_16x16x32_bf16 v[12:15], v[128:131], v[92:95], v[12:15]
    ds_read_b64_tr_b16 v[112:113], v139 offset:36864
    ds_read_b64_tr_b16 v[114:115], v139 offset:38912
    v_mfma_f32_16x16x32_bf16 v[12:15], v[120:123], v[76:79], v[12:15]
    ds_read_b128 v[48:51], v136 offset:1024
    v_mfma_f32_16x16x32_bf16 v[28:31], v[124:127], v[76:79], v[28:31]
    ds_read_b128 v[52:55], v136 offset:3072
    v_mfma_f32_16x16x32_bf16 v[28:31], v[132:135], v[92:95], v[28:31]
    ds_read_b128 v[56:59], v136 offset:5120
    ds_read_b128 v[60:63], v136 offset:7168
    v_mfma_f32_16x16x32_bf16 v[24:27], v[132:135], v[88:91], v[24:27]
    ds_read_b64_tr_b16 v[116:117], v140 offset:36864
    v_mfma_f32_16x16x32_bf16 v[24:27], v[124:127], v[72:75], v[24:27]
    ds_read_b64_tr_b16 v[118:119], v140 offset:38912
    v_mfma_f32_16x16x32_bf16 v[20:23], v[124:127], v[68:71], v[20:23]
    v_mfma_f32_16x16x32_bf16 v[20:23], v[132:135], v[84:87], v[20:23]
    v_mfma_f32_16x16x32_bf16 v[16:19], v[132:135], v[80:83], v[16:19]
    v_mfma_f32_16x16x32_bf16 v[16:19], v[124:127], v[64:67], v[16:19]
    s_waitcnt lgkmcnt(0)
    s_barrier
    .p2align 3
    v_mfma_f32_16x16x32_bf16 v[0:3], v[104:107], v[32:35], v[0:3]
    ds_read_b64_tr_b16 v[120:121], v139 offset:40960
    ds_read_b64_tr_b16 v[122:123], v139 offset:43008
    v_mfma_f32_16x16x32_bf16 v[0:3], v[112:115], v[48:51], v[0:3]
    ds_read_b128 v[64:67], v136 offset:16384
    v_mfma_f32_16x16x32_bf16 v[4:7], v[112:115], v[52:55], v[4:7]
    ds_read_b128 v[68:71], v136 offset:18432
    v_mfma_f32_16x16x32_bf16 v[4:7], v[104:107], v[36:39], v[4:7]
    ds_read_b128 v[72:75], v136 offset:20480
    ds_read_b128 v[76:79], v136 offset:22528
    v_mfma_f32_16x16x32_bf16 v[8:11], v[104:107], v[40:43], v[8:11]
    ds_read_b64_tr_b16 v[124:125], v140 offset:40960
    v_mfma_f32_16x16x32_bf16 v[8:11], v[112:115], v[56:59], v[8:11]
    ds_read_b64_tr_b16 v[126:127], v140 offset:43008
    v_mfma_f32_16x16x32_bf16 v[12:15], v[112:115], v[60:63], v[12:15]
    ds_read_b64_tr_b16 v[128:129], v139 offset:45056
    ds_read_b64_tr_b16 v[130:131], v139 offset:47104
    v_mfma_f32_16x16x32_bf16 v[12:15], v[104:107], v[44:47], v[12:15]
    ds_read_b128 v[80:83], v136 offset:17408
    v_mfma_f32_16x16x32_bf16 v[28:31], v[108:111], v[44:47], v[28:31]
    ds_read_b128 v[84:87], v136 offset:19456
    v_mfma_f32_16x16x32_bf16 v[28:31], v[116:119], v[60:63], v[28:31]
    ds_read_b128 v[88:91], v136 offset:21504
    ds_read_b128 v[92:95], v136 offset:23552
    v_mfma_f32_16x16x32_bf16 v[24:27], v[116:119], v[56:59], v[24:27]
    ds_read_b64_tr_b16 v[132:133], v140 offset:45056
    v_mfma_f32_16x16x32_bf16 v[24:27], v[108:111], v[40:43], v[24:27]
    ds_read_b64_tr_b16 v[134:135], v140 offset:47104
    v_mfma_f32_16x16x32_bf16 v[20:23], v[108:111], v[36:39], v[20:23]
    v_mfma_f32_16x16x32_bf16 v[20:23], v[116:119], v[52:55], v[20:23]
    v_mfma_f32_16x16x32_bf16 v[16:19], v[116:119], v[48:51], v[16:19]
    v_mfma_f32_16x16x32_bf16 v[16:19], v[108:111], v[32:35], v[16:19]
    s_waitcnt lgkmcnt(0)
    s_barrier
    .p2align 3
    v_mfma_f32_16x16x32_bf16 v[0:3], v[120:123], v[64:67], v[0:3]
    ds_read_b64_tr_b16 v[104:105], v137 offset:0
    ds_read_b64_tr_b16 v[106:107], v137 offset:2048
    v_mfma_f32_16x16x32_bf16 v[0:3], v[128:131], v[80:83], v[0:3]
    ds_read_b128 v[32:35], v136 offset:32768
    v_mfma_f32_16x16x32_bf16 v[4:7], v[128:131], v[84:87], v[4:7]
    ds_read_b128 v[36:39], v136 offset:34816
    v_mfma_f32_16x16x32_bf16 v[4:7], v[120:123], v[68:71], v[4:7]
    ds_read_b128 v[40:43], v136 offset:36864
    ds_read_b128 v[44:47], v136 offset:38912
    v_mfma_f32_16x16x32_bf16 v[8:11], v[120:123], v[72:75], v[8:11]
    ds_read_b64_tr_b16 v[108:109], v138 offset:0
    v_mfma_f32_16x16x32_bf16 v[8:11], v[128:131], v[88:91], v[8:11]
    ds_read_b64_tr_b16 v[110:111], v138 offset:2048
    v_mfma_f32_16x16x32_bf16 v[12:15], v[128:131], v[92:95], v[12:15]
    ds_read_b64_tr_b16 v[112:113], v137 offset:4096
    ds_read_b64_tr_b16 v[114:115], v137 offset:6144
    v_mfma_f32_16x16x32_bf16 v[12:15], v[120:123], v[76:79], v[12:15]
    ds_read_b128 v[48:51], v136 offset:33792
    v_mfma_f32_16x16x32_bf16 v[28:31], v[124:127], v[76:79], v[28:31]
    ds_read_b128 v[52:55], v136 offset:35840
    v_mfma_f32_16x16x32_bf16 v[28:31], v[132:135], v[92:95], v[28:31]
    ds_read_b128 v[56:59], v136 offset:37888
    ds_read_b128 v[60:63], v136 offset:39936
    v_mfma_f32_16x16x32_bf16 v[24:27], v[132:135], v[88:91], v[24:27]
    ds_read_b64_tr_b16 v[116:117], v138 offset:4096
    v_mfma_f32_16x16x32_bf16 v[24:27], v[124:127], v[72:75], v[24:27]
    ds_read_b64_tr_b16 v[118:119], v138 offset:6144
    v_mfma_f32_16x16x32_bf16 v[20:23], v[124:127], v[68:71], v[20:23]
    v_mfma_f32_16x16x32_bf16 v[20:23], v[132:135], v[84:87], v[20:23]
    v_mfma_f32_16x16x32_bf16 v[16:19], v[132:135], v[80:83], v[16:19]
    v_mfma_f32_16x16x32_bf16 v[16:19], v[124:127], v[64:67], v[16:19]
    s_waitcnt lgkmcnt(0)
    s_barrier
    .p2align 3
    v_mfma_f32_16x16x32_bf16 v[0:3], v[104:107], v[32:35], v[0:3]
    ds_read_b64_tr_b16 v[120:121], v137 offset:8192
    ds_read_b64_tr_b16 v[122:123], v137 offset:10240
    v_mfma_f32_16x16x32_bf16 v[0:3], v[112:115], v[48:51], v[0:3]
    ds_read_b128 v[64:67], v136 offset:0
    v_mfma_f32_16x16x32_bf16 v[4:7], v[112:115], v[52:55], v[4:7]
    ds_read_b128 v[68:71], v136 offset:2048
    v_mfma_f32_16x16x32_bf16 v[4:7], v[104:107], v[36:39], v[4:7]
    ds_read_b128 v[72:75], v136 offset:4096
    ds_read_b128 v[76:79], v136 offset:6144
    v_mfma_f32_16x16x32_bf16 v[8:11], v[104:107], v[40:43], v[8:11]
    ds_read_b64_tr_b16 v[124:125], v138 offset:8192
    v_mfma_f32_16x16x32_bf16 v[8:11], v[112:115], v[56:59], v[8:11]
    ds_read_b64_tr_b16 v[126:127], v138 offset:10240
    v_mfma_f32_16x16x32_bf16 v[12:15], v[112:115], v[60:63], v[12:15]
    ds_read_b64_tr_b16 v[128:129], v137 offset:12288
    ds_read_b64_tr_b16 v[130:131], v137 offset:14336
    v_mfma_f32_16x16x32_bf16 v[12:15], v[104:107], v[44:47], v[12:15]
    ds_read_b128 v[80:83], v136 offset:1024
    v_mfma_f32_16x16x32_bf16 v[28:31], v[108:111], v[44:47], v[28:31]
    ds_read_b128 v[84:87], v136 offset:3072
    v_mfma_f32_16x16x32_bf16 v[28:31], v[116:119], v[60:63], v[28:31]
    ds_read_b128 v[88:91], v136 offset:5120
    ds_read_b128 v[92:95], v136 offset:7168
    v_mfma_f32_16x16x32_bf16 v[24:27], v[116:119], v[56:59], v[24:27]
    ds_read_b64_tr_b16 v[132:133], v138 offset:12288
    v_mfma_f32_16x16x32_bf16 v[24:27], v[108:111], v[40:43], v[24:27]
    ds_read_b64_tr_b16 v[134:135], v138 offset:14336
    v_mfma_f32_16x16x32_bf16 v[20:23], v[108:111], v[36:39], v[20:23]
    v_mfma_f32_16x16x32_bf16 v[20:23], v[116:119], v[52:55], v[20:23]
    v_mfma_f32_16x16x32_bf16 v[16:19], v[116:119], v[48:51], v[16:19]
    v_mfma_f32_16x16x32_bf16 v[16:19], v[108:111], v[32:35], v[16:19]
    s_waitcnt lgkmcnt(0)
    s_barrier
    .p2align 3
    v_mfma_f32_16x16x32_bf16 v[0:3], v[120:123], v[64:67], v[0:3]
    ds_read_b64_tr_b16 v[104:105], v137 offset:16384
    ds_read_b64_tr_b16 v[106:107], v137 offset:18432
    v_mfma_f32_16x16x32_bf16 v[0:3], v[128:131], v[80:83], v[0:3]
    ds_read_b128 v[32:35], v136 offset:16384
    v_mfma_f32_16x16x32_bf16 v[4:7], v[128:131], v[84:87], v[4:7]
    ds_read_b128 v[36:39], v136 offset:18432
    v_mfma_f32_16x16x32_bf16 v[4:7], v[120:123], v[68:71], v[4:7]
    ds_read_b128 v[40:43], v136 offset:20480
    ds_read_b128 v[44:47], v136 offset:22528
    v_mfma_f32_16x16x32_bf16 v[8:11], v[120:123], v[72:75], v[8:11]
    ds_read_b64_tr_b16 v[108:109], v138 offset:16384
    v_mfma_f32_16x16x32_bf16 v[8:11], v[128:131], v[88:91], v[8:11]
    ds_read_b64_tr_b16 v[110:111], v138 offset:18432
    v_mfma_f32_16x16x32_bf16 v[12:15], v[128:131], v[92:95], v[12:15]
    ds_read_b64_tr_b16 v[112:113], v137 offset:20480
    ds_read_b64_tr_b16 v[114:115], v137 offset:22528
    v_mfma_f32_16x16x32_bf16 v[12:15], v[120:123], v[76:79], v[12:15]
    ds_read_b128 v[48:51], v136 offset:17408
    v_mfma_f32_16x16x32_bf16 v[28:31], v[124:127], v[76:79], v[28:31]
    ds_read_b128 v[52:55], v136 offset:19456
    v_mfma_f32_16x16x32_bf16 v[28:31], v[132:135], v[92:95], v[28:31]
    ds_read_b128 v[56:59], v136 offset:21504
    ds_read_b128 v[60:63], v136 offset:23552
    v_mfma_f32_16x16x32_bf16 v[24:27], v[132:135], v[88:91], v[24:27]
    ds_read_b64_tr_b16 v[116:117], v138 offset:20480
    v_mfma_f32_16x16x32_bf16 v[24:27], v[124:127], v[72:75], v[24:27]
    ds_read_b64_tr_b16 v[118:119], v138 offset:22528
    v_mfma_f32_16x16x32_bf16 v[20:23], v[124:127], v[68:71], v[20:23]
    v_mfma_f32_16x16x32_bf16 v[20:23], v[132:135], v[84:87], v[20:23]
    v_mfma_f32_16x16x32_bf16 v[16:19], v[132:135], v[80:83], v[16:19]
    v_mfma_f32_16x16x32_bf16 v[16:19], v[124:127], v[64:67], v[16:19]
    s_waitcnt lgkmcnt(0)
    s_barrier
    .p2align 3
    v_mfma_f32_16x16x32_bf16 v[0:3], v[104:107], v[32:35], v[0:3]
    ds_read_b64_tr_b16 v[120:121], v137 offset:24576
    ds_read_b64_tr_b16 v[122:123], v137 offset:26624
    v_mfma_f32_16x16x32_bf16 v[0:3], v[112:115], v[48:51], v[0:3]
    ds_read_b128 v[64:67], v136 offset:32768
    v_mfma_f32_16x16x32_bf16 v[4:7], v[112:115], v[52:55], v[4:7]
    ds_read_b128 v[68:71], v136 offset:34816
    v_mfma_f32_16x16x32_bf16 v[4:7], v[104:107], v[36:39], v[4:7]
    ds_read_b128 v[72:75], v136 offset:36864
    ds_read_b128 v[76:79], v136 offset:38912
    v_mfma_f32_16x16x32_bf16 v[8:11], v[104:107], v[40:43], v[8:11]
    ds_read_b64_tr_b16 v[124:125], v138 offset:24576
    v_mfma_f32_16x16x32_bf16 v[8:11], v[112:115], v[56:59], v[8:11]
    ds_read_b64_tr_b16 v[126:127], v138 offset:26624
    v_mfma_f32_16x16x32_bf16 v[12:15], v[112:115], v[60:63], v[12:15]
    ds_read_b64_tr_b16 v[128:129], v137 offset:28672
    ds_read_b64_tr_b16 v[130:131], v137 offset:30720
    v_mfma_f32_16x16x32_bf16 v[12:15], v[104:107], v[44:47], v[12:15]
    ds_read_b128 v[80:83], v136 offset:33792
    v_mfma_f32_16x16x32_bf16 v[28:31], v[108:111], v[44:47], v[28:31]
    ds_read_b128 v[84:87], v136 offset:35840
    v_mfma_f32_16x16x32_bf16 v[28:31], v[116:119], v[60:63], v[28:31]
    ds_read_b128 v[88:91], v136 offset:37888
    ds_read_b128 v[92:95], v136 offset:39936
    v_mfma_f32_16x16x32_bf16 v[24:27], v[116:119], v[56:59], v[24:27]
    ds_read_b64_tr_b16 v[132:133], v138 offset:28672
    v_mfma_f32_16x16x32_bf16 v[24:27], v[108:111], v[40:43], v[24:27]
    ds_read_b64_tr_b16 v[134:135], v138 offset:30720
    v_mfma_f32_16x16x32_bf16 v[20:23], v[108:111], v[36:39], v[20:23]
    v_mfma_f32_16x16x32_bf16 v[20:23], v[116:119], v[52:55], v[20:23]
    v_mfma_f32_16x16x32_bf16 v[16:19], v[116:119], v[48:51], v[16:19]
    v_mfma_f32_16x16x32_bf16 v[16:19], v[108:111], v[32:35], v[16:19]
    s_waitcnt lgkmcnt(0)
    s_barrier
    .p2align 3
    v_mfma_f32_16x16x32_bf16 v[0:3], v[120:123], v[64:67], v[0:3]
    ds_read_b64_tr_b16 v[104:105], v137 offset:32768
    ds_read_b64_tr_b16 v[106:107], v137 offset:34816
    v_mfma_f32_16x16x32_bf16 v[0:3], v[128:131], v[80:83], v[0:3]
    ds_read_b128 v[32:35], v136 offset:0
    v_mfma_f32_16x16x32_bf16 v[4:7], v[128:131], v[84:87], v[4:7]
    ds_read_b128 v[36:39], v136 offset:2048
    v_mfma_f32_16x16x32_bf16 v[4:7], v[120:123], v[68:71], v[4:7]
    ds_read_b128 v[40:43], v136 offset:4096
    ds_read_b128 v[44:47], v136 offset:6144
    v_mfma_f32_16x16x32_bf16 v[8:11], v[120:123], v[72:75], v[8:11]
    ds_read_b64_tr_b16 v[108:109], v138 offset:32768
    v_mfma_f32_16x16x32_bf16 v[8:11], v[128:131], v[88:91], v[8:11]
    ds_read_b64_tr_b16 v[110:111], v138 offset:34816
    v_mfma_f32_16x16x32_bf16 v[12:15], v[128:131], v[92:95], v[12:15]
    ds_read_b64_tr_b16 v[112:113], v137 offset:36864
    ds_read_b64_tr_b16 v[114:115], v137 offset:38912
    v_mfma_f32_16x16x32_bf16 v[12:15], v[120:123], v[76:79], v[12:15]
    ds_read_b128 v[48:51], v136 offset:1024
    v_mfma_f32_16x16x32_bf16 v[28:31], v[124:127], v[76:79], v[28:31]
    ds_read_b128 v[52:55], v136 offset:3072
    v_mfma_f32_16x16x32_bf16 v[28:31], v[132:135], v[92:95], v[28:31]
    ds_read_b128 v[56:59], v136 offset:5120
    ds_read_b128 v[60:63], v136 offset:7168
    v_mfma_f32_16x16x32_bf16 v[24:27], v[132:135], v[88:91], v[24:27]
    ds_read_b64_tr_b16 v[116:117], v138 offset:36864
    v_mfma_f32_16x16x32_bf16 v[24:27], v[124:127], v[72:75], v[24:27]
    ds_read_b64_tr_b16 v[118:119], v138 offset:38912
    v_mfma_f32_16x16x32_bf16 v[20:23], v[124:127], v[68:71], v[20:23]
    v_mfma_f32_16x16x32_bf16 v[20:23], v[132:135], v[84:87], v[20:23]
    v_mfma_f32_16x16x32_bf16 v[16:19], v[132:135], v[80:83], v[16:19]
    v_mfma_f32_16x16x32_bf16 v[16:19], v[124:127], v[64:67], v[16:19]
    s_waitcnt lgkmcnt(0)
    s_barrier
    .p2align 3
    v_mfma_f32_16x16x32_bf16 v[0:3], v[104:107], v[32:35], v[0:3]
    ds_read_b64_tr_b16 v[120:121], v137 offset:40960
    ds_read_b64_tr_b16 v[122:123], v137 offset:43008
    v_mfma_f32_16x16x32_bf16 v[0:3], v[112:115], v[48:51], v[0:3]
    ds_read_b128 v[64:67], v136 offset:16384
    v_mfma_f32_16x16x32_bf16 v[4:7], v[112:115], v[52:55], v[4:7]
    ds_read_b128 v[68:71], v136 offset:18432
    v_mfma_f32_16x16x32_bf16 v[4:7], v[104:107], v[36:39], v[4:7]
    ds_read_b128 v[72:75], v136 offset:20480
    ds_read_b128 v[76:79], v136 offset:22528
    v_mfma_f32_16x16x32_bf16 v[8:11], v[104:107], v[40:43], v[8:11]
    ds_read_b64_tr_b16 v[124:125], v138 offset:40960
    v_mfma_f32_16x16x32_bf16 v[8:11], v[112:115], v[56:59], v[8:11]
    ds_read_b64_tr_b16 v[126:127], v138 offset:43008
    v_mfma_f32_16x16x32_bf16 v[12:15], v[112:115], v[60:63], v[12:15]
    ds_read_b64_tr_b16 v[128:129], v137 offset:45056
    ds_read_b64_tr_b16 v[130:131], v137 offset:47104
    v_mfma_f32_16x16x32_bf16 v[12:15], v[104:107], v[44:47], v[12:15]
    ds_read_b128 v[80:83], v136 offset:17408
    v_mfma_f32_16x16x32_bf16 v[28:31], v[108:111], v[44:47], v[28:31]
    ds_read_b128 v[84:87], v136 offset:19456
    v_mfma_f32_16x16x32_bf16 v[28:31], v[116:119], v[60:63], v[28:31]
    ds_read_b128 v[88:91], v136 offset:21504
    ds_read_b128 v[92:95], v136 offset:23552
    v_mfma_f32_16x16x32_bf16 v[24:27], v[116:119], v[56:59], v[24:27]
    ds_read_b64_tr_b16 v[132:133], v138 offset:45056
    v_mfma_f32_16x16x32_bf16 v[24:27], v[108:111], v[40:43], v[24:27]
    ds_read_b64_tr_b16 v[134:135], v138 offset:47104
    v_mfma_f32_16x16x32_bf16 v[20:23], v[108:111], v[36:39], v[20:23]
    v_mfma_f32_16x16x32_bf16 v[20:23], v[116:119], v[52:55], v[20:23]
    v_mfma_f32_16x16x32_bf16 v[16:19], v[116:119], v[48:51], v[16:19]
    v_mfma_f32_16x16x32_bf16 v[16:19], v[108:111], v[32:35], v[16:19]
    s_waitcnt lgkmcnt(0)
    s_barrier
    .p2align 3
    v_mfma_f32_16x16x32_bf16 v[0:3], v[120:123], v[64:67], v[0:3]
    ds_read_b64_tr_b16 v[104:105], v139 offset:0
    ds_read_b64_tr_b16 v[106:107], v139 offset:2048
    v_mfma_f32_16x16x32_bf16 v[0:3], v[128:131], v[80:83], v[0:3]
    ds_read_b128 v[32:35], v136 offset:32768
    v_mfma_f32_16x16x32_bf16 v[4:7], v[128:131], v[84:87], v[4:7]
    ds_read_b128 v[36:39], v136 offset:34816
    v_mfma_f32_16x16x32_bf16 v[4:7], v[120:123], v[68:71], v[4:7]
    ds_read_b128 v[40:43], v136 offset:36864
    ds_read_b128 v[44:47], v136 offset:38912
    v_mfma_f32_16x16x32_bf16 v[8:11], v[120:123], v[72:75], v[8:11]
    ds_read_b64_tr_b16 v[108:109], v140 offset:0
    v_mfma_f32_16x16x32_bf16 v[8:11], v[128:131], v[88:91], v[8:11]
    ds_read_b64_tr_b16 v[110:111], v140 offset:2048
    v_mfma_f32_16x16x32_bf16 v[12:15], v[128:131], v[92:95], v[12:15]
    ds_read_b64_tr_b16 v[112:113], v139 offset:4096
    ds_read_b64_tr_b16 v[114:115], v139 offset:6144
    v_mfma_f32_16x16x32_bf16 v[12:15], v[120:123], v[76:79], v[12:15]
    ds_read_b128 v[48:51], v136 offset:33792
    v_mfma_f32_16x16x32_bf16 v[28:31], v[124:127], v[76:79], v[28:31]
    ds_read_b128 v[52:55], v136 offset:35840
    v_mfma_f32_16x16x32_bf16 v[28:31], v[132:135], v[92:95], v[28:31]
    ds_read_b128 v[56:59], v136 offset:37888
    ds_read_b128 v[60:63], v136 offset:39936
    v_mfma_f32_16x16x32_bf16 v[24:27], v[132:135], v[88:91], v[24:27]
    ds_read_b64_tr_b16 v[116:117], v140 offset:4096
    v_mfma_f32_16x16x32_bf16 v[24:27], v[124:127], v[72:75], v[24:27]
    ds_read_b64_tr_b16 v[118:119], v140 offset:6144
    v_mfma_f32_16x16x32_bf16 v[20:23], v[124:127], v[68:71], v[20:23]
    v_mfma_f32_16x16x32_bf16 v[20:23], v[132:135], v[84:87], v[20:23]
    v_mfma_f32_16x16x32_bf16 v[16:19], v[132:135], v[80:83], v[16:19]
    v_mfma_f32_16x16x32_bf16 v[16:19], v[124:127], v[64:67], v[16:19]
    s_waitcnt lgkmcnt(0)
    s_barrier
    .p2align 3
    v_mfma_f32_16x16x32_bf16 v[0:3], v[104:107], v[32:35], v[0:3]
    ds_read_b64_tr_b16 v[120:121], v139 offset:8192
    ds_read_b64_tr_b16 v[122:123], v139 offset:10240
    v_mfma_f32_16x16x32_bf16 v[0:3], v[112:115], v[48:51], v[0:3]
    ds_read_b128 v[64:67], v136 offset:0
    v_mfma_f32_16x16x32_bf16 v[4:7], v[112:115], v[52:55], v[4:7]
    ds_read_b128 v[68:71], v136 offset:2048
    v_mfma_f32_16x16x32_bf16 v[4:7], v[104:107], v[36:39], v[4:7]
    ds_read_b128 v[72:75], v136 offset:4096
    ds_read_b128 v[76:79], v136 offset:6144
    v_mfma_f32_16x16x32_bf16 v[8:11], v[104:107], v[40:43], v[8:11]
    ds_read_b64_tr_b16 v[124:125], v140 offset:8192
    v_mfma_f32_16x16x32_bf16 v[8:11], v[112:115], v[56:59], v[8:11]
    ds_read_b64_tr_b16 v[126:127], v140 offset:10240
    v_mfma_f32_16x16x32_bf16 v[12:15], v[112:115], v[60:63], v[12:15]
    ds_read_b64_tr_b16 v[128:129], v139 offset:12288
    ds_read_b64_tr_b16 v[130:131], v139 offset:14336
    v_mfma_f32_16x16x32_bf16 v[12:15], v[104:107], v[44:47], v[12:15]
    ds_read_b128 v[80:83], v136 offset:1024
    v_mfma_f32_16x16x32_bf16 v[28:31], v[108:111], v[44:47], v[28:31]
    ds_read_b128 v[84:87], v136 offset:3072
    v_mfma_f32_16x16x32_bf16 v[28:31], v[116:119], v[60:63], v[28:31]
    ds_read_b128 v[88:91], v136 offset:5120
    ds_read_b128 v[92:95], v136 offset:7168
    v_mfma_f32_16x16x32_bf16 v[24:27], v[116:119], v[56:59], v[24:27]
    ds_read_b64_tr_b16 v[132:133], v140 offset:12288
    v_mfma_f32_16x16x32_bf16 v[24:27], v[108:111], v[40:43], v[24:27]
    ds_read_b64_tr_b16 v[134:135], v140 offset:14336
    v_mfma_f32_16x16x32_bf16 v[20:23], v[108:111], v[36:39], v[20:23]
    v_mfma_f32_16x16x32_bf16 v[20:23], v[116:119], v[52:55], v[20:23]
    v_mfma_f32_16x16x32_bf16 v[16:19], v[116:119], v[48:51], v[16:19]
    v_mfma_f32_16x16x32_bf16 v[16:19], v[108:111], v[32:35], v[16:19]
    s_waitcnt lgkmcnt(0)
    s_barrier
    .p2align 3
    v_mfma_f32_16x16x32_bf16 v[0:3], v[120:123], v[64:67], v[0:3]
    v_mfma_f32_16x16x32_bf16 v[0:3], v[128:131], v[80:83], v[0:3]
    v_mfma_f32_16x16x32_bf16 v[4:7], v[128:131], v[84:87], v[4:7]
    v_mfma_f32_16x16x32_bf16 v[4:7], v[120:123], v[68:71], v[4:7]
    v_mfma_f32_16x16x32_bf16 v[8:11], v[120:123], v[72:75], v[8:11]
    v_mfma_f32_16x16x32_bf16 v[8:11], v[128:131], v[88:91], v[8:11]
    v_mfma_f32_16x16x32_bf16 v[12:15], v[128:131], v[92:95], v[12:15]
    v_mfma_f32_16x16x32_bf16 v[12:15], v[120:123], v[76:79], v[12:15]
    v_mfma_f32_16x16x32_bf16 v[28:31], v[124:127], v[76:79], v[28:31]
    v_mfma_f32_16x16x32_bf16 v[28:31], v[132:135], v[92:95], v[28:31]
    v_mfma_f32_16x16x32_bf16 v[24:27], v[132:135], v[88:91], v[24:27]
    v_mfma_f32_16x16x32_bf16 v[24:27], v[124:127], v[72:75], v[24:27]
    v_mfma_f32_16x16x32_bf16 v[20:23], v[124:127], v[68:71], v[20:23]
    v_mfma_f32_16x16x32_bf16 v[20:23], v[132:135], v[84:87], v[20:23]
    v_mfma_f32_16x16x32_bf16 v[16:19], v[132:135], v[80:83], v[16:19]
    v_mfma_f32_16x16x32_bf16 v[16:19], v[124:127], v[64:67], v[16:19]
    s_nop 7
    s_add_u32 s59, s1, s49
    s_add_u32 s60, s59, 4096
    v_cvt_pk_bf16_f32 v32, v0, v1
    v_cvt_pk_bf16_f32 v33, v2, v3
    v_cvt_pk_bf16_f32 v34, v16, v17
    v_cvt_pk_bf16_f32 v35, v18, v19
    buffer_store_dwordx4 v[32:35], v254, s[4:7], s59 offen offset:0 sc0 sc1
    v_cvt_pk_bf16_f32 v36, v4, v5
    v_cvt_pk_bf16_f32 v37, v6, v7
    v_cvt_pk_bf16_f32 v38, v20, v21
    v_cvt_pk_bf16_f32 v39, v22, v23
    buffer_store_dwordx4 v[36:39], v254, s[4:7], s59 offen offset:2048 sc0 sc1
    v_cvt_pk_bf16_f32 v40, v8, v9
    v_cvt_pk_bf16_f32 v41, v10, v11
    v_cvt_pk_bf16_f32 v42, v24, v25
    v_cvt_pk_bf16_f32 v43, v26, v27
    buffer_store_dwordx4 v[40:43], v254, s[4:7], s60 offen offset:0 sc0 sc1
    v_cvt_pk_bf16_f32 v44, v12, v13
    v_cvt_pk_bf16_f32 v45, v14, v15
    v_cvt_pk_bf16_f32 v46, v28, v29
    v_cvt_pk_bf16_f32 v47, v30, v31
    buffer_store_dwordx4 v[44:47], v254, s[4:7], s60 offen offset:2048 sc0 sc1
    v_mov_b32 v56, 0x3f803f80
    v_dot2_f32_bf16 v48, v32, v56, 0
    v_dot2_f32_bf16 v52, v32, v32, 0
    v_dot2_f32_bf16 v49, v36, v56, 0
    v_dot2_f32_bf16 v53, v36, v36, 0
    v_dot2_f32_bf16 v50, v40, v56, 0
    v_dot2_f32_bf16 v54, v40, v40, 0
    v_dot2_f32_bf16 v51, v44, v56, 0
    v_dot2_f32_bf16 v55, v44, v44, 0
    v_dot2_f32_bf16 v48, v33, v56, v48
    v_dot2_f32_bf16 v52, v33, v33, v52
    v_dot2_f32_bf16 v49, v37, v56, v49
    v_dot2_f32_bf16 v53, v37, v37, v53
    v_dot2_f32_bf16 v50, v41, v56, v50
    v_dot2_f32_bf16 v54, v41, v41, v54
    v_dot2_f32_bf16 v51, v45, v56, v51
    v_dot2_f32_bf16 v55, v45, v45, v55
    v_dot2_f32_bf16 v48, v34, v56, v48
    v_dot2_f32_bf16 v52, v34, v34, v52
    v_dot2_f32_bf16 v49, v38, v56, v49
    v_dot2_f32_bf16 v53, v38, v38, v53
    v_dot2_f32_bf16 v50, v42, v56, v50
    v_dot2_f32_bf16 v54, v42, v42, v54
    v_dot2_f32_bf16 v51, v46, v56, v51
    v_dot2_f32_bf16 v55, v46, v46, v55
    v_dot2_f32_bf16 v48, v35, v56, v48
    v_dot2_f32_bf16 v52, v35, v35, v52
    v_dot2_f32_bf16 v49, v39, v56, v49
    v_dot2_f32_bf16 v53, v39, v39, v53
    v_dot2_f32_bf16 v50, v43, v56, v50
    v_dot2_f32_bf16 v54, v43, v43, v54
    v_dot2_f32_bf16 v51, v47, v56, v51
    v_dot2_f32_bf16 v55, v47, v47, v55
    s_lshl_b32 s55, s42, 9
    s_add_u32 s55, s55, 155648
    s_nop 1
    v_permlane32_swap_b32 v48, v50
    v_permlane32_swap_b32 v49, v51
    v_permlane32_swap_b32 v52, v54
    v_permlane32_swap_b32 v53, v55
    v_add_f32 v48, v48, v50
    v_add_f32 v49, v49, v51
    v_add_f32 v52, v52, v54
    v_add_f32 v53, v53, v55
    v_lshrrev_b32 v56, 1, v254
    v_add_u32 v56, s55, v56
    v_permlane16_swap_b32 v48, v49
    v_permlane16_swap_b32 v52, v53
    v_add_f32 v48, v48, v49
    v_add_f32 v49, v52, v53
    ds_write_b64 v56, v[48:49]
    s_lshl_b32 s55, s43, 13
    s_add_u32 s55, s55, 98304
    v_add_u32 v224, s55, v254
    s_lshl_b32 s56, s44, 2
    v_lshrrev_b32 v233, 6, v254
    v_and_b32 v234, 7, v233
    v_xor_b32 v234, s56, v234
    v_lshlrev_b32 v233, 8, v233
    v_lshl_add_u32 v233, v234, 5, v233
    v_and_b32 v234, 0x30, v254
    v_lshrrev_b32 v234, 1, v234
    v_add_u32 v233, v233, v234
    v_xor_b32 v225, 0, v233
    v_xor_b32 v226, 32, v233
    v_xor_b32 v227, 64, v233
    v_xor_b32 v228, 96, v233
    v_add_u32 v229, 49152, v225
    v_add_u32 v230, 49152, v226
    v_add_u32 v231, 49152, v227
    v_add_u32 v232, 49152, v228
    v_lshrrev_b32 v233, 7, v254
    v_and_b32 v234, 0x70, v254
    v_and_b32 v235, 6, v233
    v_lshlrev_b32 v235, 4, v235
    v_xor_b32 v234, v234, v235
    v_mul_u32_u24 v233, 7168, v233
    v_add3_u32 v236, v233, v234, s66
    v_add_u32 v237, 56320, v236
    v_add_u32 v242, s67, v254
    v_and_b32 v234, 0xf0, v254
    v_lshrrev_b32 v233, 8, v254
    v_lshlrev_b32 v235, 5, v233
    v_xor_b32 v234, v234, v235
    v_mul_u32_u24 v233, 2048, v233
    v_add_u32 v238, v233, v234
    v_xor_b32 v234, 0x80, v234
    v_add_u32 v233, v233, v234
    v_add_u32 v239, 7168, v233
    v_add_u32 v240, 14336, v238
    v_add_u32 v241, 14336, v239
    v_mov_b32 v243, v224
    s_and_b32 s56, s51, 1
    s_lshl_b32 s56, s56, 2
    s_lshl_b32 s55, s44, 1
    s_add_u32 s56, s56, s55
    v_lshrrev_b32 v233, 6, v254
    v_and_b32 v234, 7, v233
    v_xor_b32 v234, s56, v234
    v_lshlrev_b32 v233, 8, v233
    v_lshl_add_u32 v233, v234, 5, v233
    v_and_b32 v234, 0x30, v254
    v_lshrrev_b32 v234, 1, v234
    v_add_u32 v233, v233, v234
    v_xor_b32 v244, 0, v233
    v_xor_b32 v245, 32, v233
    v_xor_b32 v246, 128, v233
    v_xor_b32 v247, 160, v233
    v_add_u32 v248, 49152, v244
    v_add_u32 v249, 49152, v245
    v_add_u32 v250, 49152, v246
    v_add_u32 v251, 49152, v247
    s_and_b32 s55, s51, 1
    s_mul_i32 s55, s55, 458752
    s_add_u32 s95, s50, s55
    s_and_b32 s55, s41, 7
    s_lshl_b32 s55, s55, 14
    s_and_b32 s56, s1, 0x3fff
    s_add_u32 s55, s55, s56
    s_add_u32 s89, s55, s95
    s_and_b32 s55, s41, 6
    s_add_u32 s55, s55, 48
    s_lshl_b32 s55, s55, 13
    s_and_b32 s56, s41, 1
    s_lshl_b32 s56, s56, 10
    s_add_u32 s55, s55, s56
    s_add_u32 s55, s55, s62
    s_add_u32 s90, s55, s95
    s_lshl_b32 s60, s43, 23
    s_add_u32 s60, s60, 83886336
    s_add_u32 s55, s4, s60
    s_addc_u32 s56, s5, 0
    s_lshr_b32 s57, 16392, s41
    s_and_b32 s57, s57, 1
    s_cselect_b32 s24, s55, s16
    s_cselect_b32 s25, s56, s17
    s_mov_b32 s26, 7340032
    s_mov_b32 s27, 0x00020000
    s_add_u32 s55, s4, 100663552
    s_addc_u32 s56, s5, 0
    s_lshr_b32 s57, 3084, s51
    s_and_b32 s57, s57, 1
    s_cselect_b32 s20, s55, s20
    s_cselect_b32 s21, s56, s21
    s_add_u32 s88, s49, s62
    s_lshl_b32 s94, s51, 14
    s_waitcnt vmcnt(0) lgkmcnt(0)
    s_barrier
    s_cmp_lg_u32 s42, 2
    s_cbranch_scc1 wf_20
    s_lshr_b32 s55, s2, 5
    s_lshl_b32 s55, s55, 2
    s_add_u32 s55, s55, s0
    v_mov_b32 v252, 32
    v_mov_b32 v253, 0x01010101
    s_mov_b64 exec, 1
    s_cmp_eq_u32 s45, 0
    s_cbranch_scc1 st_21
    buffer_store_dword v253, v252, s[4:7], s55 offen sc0 sc1
    s_branch st_22
st_21:
    buffer_store_dword v253, v252, s[4:7], s55 offen
st_22:
    s_mov_b64 exec, -1
wf_20:
    s_cmp_lg_u32 s42, 0
    s_cbranch_scc1 so_23
    v_add_u32 v216, 155648, v254
    ds_read_b128 v[208:211], v216
    ds_read_b128 v[212:215], v216 offset:1024
    s_lshl_b32 s55, s51, 10
    s_add_u32 s55, s55, s52
    s_waitcnt lgkmcnt(0)
    v_add_f32 v208, v208, v212
    v_add_f32 v209, v209, v213
    v_add_f32 v210, v210, v214
    v_add_f32 v211, v211, v215
    buffer_store_dwordx4 v[208:211], v254, s[4:7], s55 offen sc0 sc1
so_23:
    s_barrier
    ds_read_b64_tr_b16 v[160:161], v229 offset:16384
    ds_read_b64_tr_b16 v[162:163], v229 offset:20480
    ds_read_b128 v[128:131], v224 offset:0
    ds_read_b128 v[132:135], v224 offset:2048
    ds_read_b128 v[136:139], v224 offset:4096
    ds_read_b128 v[140:143], v224 offset:6144
    ds_read_b64_tr_b16 v[176:177], v229 offset:24576
    ds_read_b64_tr_b16 v[178:179], v229 offset:28672
    ds_read_b64_tr_b16 v[164:165], v230 offset:16384
    ds_read_b64_tr_b16 v[166:167], v230 offset:20480
    ds_read_b64_tr_b16 v[180:181], v230 offset:24576
    ds_read_b64_tr_b16 v[182:183], v230 offset:28672
    ds_read_b64_tr_b16 v[168:169], v231 offset:16384
    ds_read_b64_tr_b16 v[170:171], v231 offset:20480
    ds_read_b64_tr_b16 v[184:185], v231 offset:24576
    ds_read_b64_tr_b16 v[186:187], v231 offset:28672
    ds_read_b64_tr_b16 v[172:173], v232 offset:16384
    ds_read_b64_tr_b16 v[174:175], v232 offset:20480
    ds_read_b64_tr_b16 v[188:189], v232 offset:24576
    ds_read_b64_tr_b16 v[190:191], v232 offset:28672
    s_mov_b32 s58, 5
    s_waitcnt lgkmcnt(0)
    s_barrier
    .p2align 3
    v_mfma_f32_16x16x32_bf16 v[0:3], v[160:163], v[128:131], 0
    ds_read_b64_tr_b16 v[192:193], v229 offset:32768
    v_mfma_f32_16x16x32_bf16 v[4:7], v[160:163], v[132:135], 0
    ds_read_b64_tr_b16 v[194:195], v229 offset:36864
    v_mfma_f32_16x16x32_bf16 v[8:11], v[160:163], v[136:139], 0
    ds_read_b128 v[144:147], v224 offset:1024
    v_mfma_f32_16x16x32_bf16 v[12:15], v[160:163], v[140:143], 0
    ds_read_b128 v[148:151], v224 offset:3072
    v_mfma_f32_16x16x32_bf16 v[76:79], v[176:179], v[140:143], 0
    ds_read_b128 v[152:155], v224 offset:5120
    v_mfma_f32_16x16x32_bf16 v[72:75], v[176:179], v[136:139], 0
    v_mfma_f32_16x16x32_bf16 v[68:71], v[176:179], v[132:135], 0
    ds_read_b128 v[156:159], v224 offset:7168
    v_mfma_f32_16x16x32_bf16 v[64:67], v[176:179], v[128:131], 0
    ds_read_b64_tr_b16 v[208:209], v229 offset:40960
    v_mfma_f32_16x16x32_bf16 v[16:19], v[164:167], v[128:131], 0
    ds_read_b64_tr_b16 v[210:211], v229 offset:45056
    v_mfma_f32_16x16x32_bf16 v[20:23], v[164:167], v[132:135], 0
    ds_read_b64_tr_b16 v[196:197], v230 offset:32768
    v_mfma_f32_16x16x32_bf16 v[24:27], v[164:167], v[136:139], 0
    ds_read_b64_tr_b16 v[198:199], v230 offset:36864
    v_mfma_f32_16x16x32_bf16 v[28:31], v[164:167], v[140:143], 0
    v_mfma_f32_16x16x32_bf16 v[92:95], v[180:183], v[140:143], 0
    ds_read_b64_tr_b16 v[212:213], v230 offset:40960
    v_mfma_f32_16x16x32_bf16 v[88:91], v[180:183], v[136:139], 0
    ds_read_b64_tr_b16 v[214:215], v230 offset:45056
    v_mfma_f32_16x16x32_bf16 v[84:87], v[180:183], v[132:135], 0
    ds_read_b64_tr_b16 v[200:201], v231 offset:32768
    v_mfma_f32_16x16x32_bf16 v[80:83], v[180:183], v[128:131], 0
    ds_read_b64_tr_b16 v[202:203], v231 offset:36864
    v_mfma_f32_16x16x32_bf16 v[32:35], v[168:171], v[128:131], 0
    ds_read_b64_tr_b16 v[216:217], v231 offset:40960
    v_mfma_f32_16x16x32_bf16 v[36:39], v[168:171], v[132:135], 0
    v_mfma_f32_16x16x32_bf16 v[40:43], v[168:171], v[136:139], 0
    ds_read_b64_tr_b16 v[218:219], v231 offset:45056
    v_mfma_f32_16x16x32_bf16 v[44:47], v[168:171], v[140:143], 0
    ds_read_b64_tr_b16 v[204:205], v232 offset:32768
    v_mfma_f32_16x16x32_bf16 v[108:111], v[184:187], v[140:143], 0
    ds_read_b64_tr_b16 v[206:207], v232 offset:36864
    v_mfma_f32_16x16x32_bf16 v[104:107], v[184:187], v[136:139], 0
    ds_read_b64_tr_b16 v[220:221], v232 offset:40960
    v_mfma_f32_16x16x32_bf16 v[100:103], v[184:187], v[132:135], 0
    ds_read_b64_tr_b16 v[222:223], v232 offset:45056
    v_mfma_f32_16x16x32_bf16 v[96:99], v[184:187], v[128:131], 0
    v_mfma_f32_16x16x32_bf16 v[48:51], v[172:175], v[128:131], 0
    v_mfma_f32_16x16x32_bf16 v[52:55], v[172:175], v[132:135], 0
    v_mfma_f32_16x16x32_bf16 v[56:59], v[172:175], v[136:139], 0
    v_mfma_f32_16x16x32_bf16 v[60:63], v[172:175], v[140:143], 0
    v_mfma_f32_16x16x32_bf16 v[124:127], v[188:191], v[140:143], 0
    v_mfma_f32_16x16x32_bf16 v[120:123], v[188:191], v[136:139], 0
    v_mfma_f32_16x16x32_bf16 v[116:119], v[188:191], v[132:135], 0
    v_mfma_f32_16x16x32_bf16 v[112:115], v[188:191], v[128:131], 0
    .p2align 3
loop_24:
    s_waitcnt lgkmcnt(0)
    s_barrier
    .p2align 3
    v_mfma_f32_16x16x32_bf16 v[0:3], v[192:195], v[144:147], v[0:3]
    ds_read_b64_tr_b16 v[160:161], v225 offset:0
    v_mfma_f32_16x16x32_bf16 v[4:7], v[192:195], v[148:151], v[4:7]
    ds_read_b64_tr_b16 v[162:163], v225 offset:4096
    v_mfma_f32_16x16x32_bf16 v[8:11], v[192:195], v[152:155], v[8:11]
    ds_read_b128 v[128:131], v224 offset:16384
    v_mfma_f32_16x16x32_bf16 v[12:15], v[192:195], v[156:159], v[12:15]
    ds_read_b128 v[132:135], v224 offset:18432
    v_mfma_f32_16x16x32_bf16 v[76:79], v[208:211], v[156:159], v[76:79]
    ds_read_b128 v[136:139], v224 offset:20480
    v_mfma_f32_16x16x32_bf16 v[72:75], v[208:211], v[152:155], v[72:75]
    v_mfma_f32_16x16x32_bf16 v[68:71], v[208:211], v[148:151], v[68:71]
    ds_read_b128 v[140:143], v224 offset:22528
    v_mfma_f32_16x16x32_bf16 v[64:67], v[208:211], v[144:147], v[64:67]
    ds_read_b64_tr_b16 v[176:177], v225 offset:8192
    v_mfma_f32_16x16x32_bf16 v[16:19], v[196:199], v[144:147], v[16:19]
    ds_read_b64_tr_b16 v[178:179], v225 offset:12288
    v_mfma_f32_16x16x32_bf16 v[20:23], v[196:199], v[148:151], v[20:23]
    ds_read_b64_tr_b16 v[164:165], v226 offset:0
    v_mfma_f32_16x16x32_bf16 v[24:27], v[196:199], v[152:155], v[24:27]
    ds_read_b64_tr_b16 v[166:167], v226 offset:4096
    v_mfma_f32_16x16x32_bf16 v[28:31], v[196:199], v[156:159], v[28:31]
    v_mfma_f32_16x16x32_bf16 v[92:95], v[212:215], v[156:159], v[92:95]
    ds_read_b64_tr_b16 v[180:181], v226 offset:8192
    v_mfma_f32_16x16x32_bf16 v[88:91], v[212:215], v[152:155], v[88:91]
    ds_read_b64_tr_b16 v[182:183], v226 offset:12288
    v_mfma_f32_16x16x32_bf16 v[84:87], v[212:215], v[148:151], v[84:87]
    ds_read_b64_tr_b16 v[168:169], v227 offset:0
    v_mfma_f32_16x16x32_bf16 v[80:83], v[212:215], v[144:147], v[80:83]
    ds_read_b64_tr_b16 v[170:171], v227 offset:4096
    v_mfma_f32_16x16x32_bf16 v[32:35], v[200:203], v[144:147], v[32:35]
    ds_read_b64_tr_b16 v[184:185], v227 offset:8192
    v_mfma_f32_16x16x32_bf16 v[36:39], v[200:203], v[148:151], v[36:39]
    v_mfma_f32_16x16x32_bf16 v[40:43], v[200:203], v[152:155], v[40:43]
    ds_read_b64_tr_b16 v[186:187], v227 offset:12288
    v_mfma_f32_16x16x32_bf16 v[44:47], v[200:203], v[156:159], v[44:47]
    ds_read_b64_tr_b16 v[172:173], v228 offset:0
    v_mfma_f32_16x16x32_bf16 v[108:111], v[216:219], v[156:159], v[108:111]
    ds_read_b64_tr_b16 v[174:175], v228 offset:4096
    v_mfma_f32_16x16x32_bf16 v[104:107], v[216:219], v[152:155], v[104:107]
    ds_read_b64_tr_b16 v[188:189], v228 offset:8192
    v_mfma_f32_16x16x32_bf16 v[100:103], v[216:219], v[148:151], v[100:103]
    ds_read_b64_tr_b16 v[190:191], v228 offset:12288
    v_mfma_f32_16x16x32_bf16 v[96:99], v[216:219], v[144:147], v[96:99]
    v_mfma_f32_16x16x32_bf16 v[48:51], v[204:207], v[144:147], v[48:51]
    v_mfma_f32_16x16x32_bf16 v[52:55], v[204:207], v[148:151], v[52:55]
    v_mfma_f32_16x16x32_bf16 v[56:59], v[204:207], v[152:155], v[56:59]
    v_mfma_f32_16x16x32_bf16 v[60:63], v[204:207], v[156:159], v[60:63]
    v_mfma_f32_16x16x32_bf16 v[124:127], v[220:223], v[156:159], v[124:127]
    v_mfma_f32_16x16x32_bf16 v[120:123], v[220:223], v[152:155], v[120:123]
    v_mfma_f32_16x16x32_bf16 v[116:119], v[220:223], v[148:151], v[116:119]
    v_mfma_f32_16x16x32_bf16 v[112:115], v[220:223], v[144:147], v[112:115]
    s_waitcnt vmcnt(0) lgkmcnt(0)
    s_barrier
    .p2align 3
    v_mfma_f32_16x16x32_bf16 v[0:3], v[160:163], v[128:131], v[0:3]
    ds_read_b64_tr_b16 v[192:193], v225 offset:16384
    v_mfma_f32_16x16x32_bf16 v[4:7], v[160:163], v[132:135], v[4:7]
    ds_read_b64_tr_b16 v[194:195], v225 offset:20480
    v_mfma_f32_16x16x32_bf16 v[8:11], v[160:163], v[136:139], v[8:11]
    ds_read_b128 v[144:147], v224 offset:17408
    v_mfma_f32_16x16x32_bf16 v[12:15], v[160:163], v[140:143], v[12:15]
    ds_read_b128 v[148:151], v224 offset:19456
    v_mfma_f32_16x16x32_bf16 v[76:79], v[176:179], v[140:143], v[76:79]
    ds_read_b128 v[152:155], v224 offset:21504
    v_mfma_f32_16x16x32_bf16 v[72:75], v[176:179], v[136:139], v[72:75]
    v_mfma_f32_16x16x32_bf16 v[68:71], v[176:179], v[132:135], v[68:71]
    ds_read_b128 v[156:159], v224 offset:23552
    v_mfma_f32_16x16x32_bf16 v[64:67], v[176:179], v[128:131], v[64:67]
    ds_read_b64_tr_b16 v[208:209], v225 offset:24576
    v_mfma_f32_16x16x32_bf16 v[16:19], v[164:167], v[128:131], v[16:19]
    ds_read_b64_tr_b16 v[210:211], v225 offset:28672
    v_mfma_f32_16x16x32_bf16 v[20:23], v[164:167], v[132:135], v[20:23]
    ds_read_b64_tr_b16 v[196:197], v226 offset:16384
    v_mfma_f32_16x16x32_bf16 v[24:27], v[164:167], v[136:139], v[24:27]
    ds_read_b64_tr_b16 v[198:199], v226 offset:20480
    v_mfma_f32_16x16x32_bf16 v[28:31], v[164:167], v[140:143], v[28:31]
    v_mfma_f32_16x16x32_bf16 v[92:95], v[180:183], v[140:143], v[92:95]
    ds_read_b64_tr_b16 v[212:213], v226 offset:24576
    v_mfma_f32_16x16x32_bf16 v[88:91], v[180:183], v[136:139], v[88:91]
    ds_read_b64_tr_b16 v[214:215], v226 offset:28672
    v_mfma_f32_16x16x32_bf16 v[84:87], v[180:183], v[132:135], v[84:87]
    ds_read_b64_tr_b16 v[200:201], v227 offset:16384
    v_mfma_f32_16x16x32_bf16 v[80:83], v[180:183], v[128:131], v[80:83]
    ds_read_b64_tr_b16 v[202:203], v227 offset:20480
    v_mfma_f32_16x16x32_bf16 v[32:35], v[168:171], v[128:131], v[32:35]
    ds_read_b64_tr_b16 v[216:217], v227 offset:24576
    v_mfma_f32_16x16x32_bf16 v[36:39], v[168:171], v[132:135], v[36:39]
    v_mfma_f32_16x16x32_bf16 v[40:43], v[168:171], v[136:139], v[40:43]
    ds_read_b64_tr_b16 v[218:219], v227 offset:28672
    v_mfma_f32_16x16x32_bf16 v[44:47], v[168:171], v[140:143], v[44:47]
    ds_read_b64_tr_b16 v[204:205], v228 offset:16384
    v_mfma_f32_16x16x32_bf16 v[108:111], v[184:187], v[140:143], v[108:111]
    ds_read_b64_tr_b16 v[206:207], v228 offset:20480
    v_mfma_f32_16x16x32_bf16 v[104:107], v[184:187], v[136:139], v[104:107]
    ds_read_b64_tr_b16 v[220:221], v228 offset:24576
    v_mfma_f32_16x16x32_bf16 v[100:103], v[184:187], v[132:135], v[100:103]
    ds_read_b64_tr_b16 v[222:223], v228 offset:28672
    v_mfma_f32_16x16x32_bf16 v[96:99], v[184:187], v[128:131], v[96:99]
    v_mfma_f32_16x16x32_bf16 v[48:51], v[172:175], v[128:131], v[48:51]
    v_mfma_f32_16x16x32_bf16 v[52:55], v[172:175], v[132:135], v[52:55]
    v_mfma_f32_16x16x32_bf16 v[56:59], v[172:175], v[136:139], v[56:59]
    v_mfma_f32_16x16x32_bf16 v[60:63], v[172:175], v[140:143], v[60:63]
    v_mfma_f32_16x16x32_bf16 v[124:127], v[188:191], v[140:143], v[124:127]
    v_mfma_f32_16x16x32_bf16 v[120:123], v[188:191], v[136:139], v[120:123]
    v_mfma_f32_16x16x32_bf16 v[116:119], v[188:191], v[132:135], v[116:119]
    v_mfma_f32_16x16x32_bf16 v[112:115], v[188:191], v[128:131], v[112:115]
    s_waitcnt lgkmcnt(0)
    s_barrier
    .p2align 3
    v_mfma_f32_16x16x32_bf16 v[0:3], v[192:195], v[144:147], v[0:3]
    ds_read_b64_tr_b16 v[160:161], v225 offset:32768
    v_mfma_f32_16x16x32_bf16 v[4:7], v[192:195], v[148:151], v[4:7]
    ds_read_b64_tr_b16 v[162:163], v225 offset:36864
    v_mfma_f32_16x16x32_bf16 v[8:11], v[192:195], v[152:155], v[8:11]
    ds_read_b128 v[128:131], v224 offset:32768
    v_mfma_f32_16x16x32_bf16 v[12:15], v[192:195], v[156:159], v[12:15]
    ds_read_b128 v[132:135], v224 offset:34816
    v_mfma_f32_16x16x32_bf16 v[76:79], v[208:211], v[156:159], v[76:79]
    ds_read_b128 v[136:139], v224 offset:36864
    v_mfma_f32_16x16x32_bf16 v[72:75], v[208:211], v[152:155], v[72:75]
    v_mfma_f32_16x16x32_bf16 v[68:71], v[208:211], v[148:151], v[68:71]
    ds_read_b128 v[140:143], v224 offset:38912
    v_mfma_f32_16x16x32_bf16 v[64:67], v[208:211], v[144:147], v[64:67]
    ds_read_b64_tr_b16 v[176:177], v225 offset:40960
    v_mfma_f32_16x16x32_bf16 v[16:19], v[196:199], v[144:147], v[16:19]
    ds_read_b64_tr_b16 v[178:179], v225 offset:45056
    v_mfma_f32_16x16x32_bf16 v[20:23], v[196:199], v[148:151], v[20:23]
    ds_read_b64_tr_b16 v[164:165], v226 offset:32768
    v_mfma_f32_16x16x32_bf16 v[24:27], v[196:199], v[152:155], v[24:27]
    ds_read_b64_tr_b16 v[166:167], v226 offset:36864
    v_mfma_f32_16x16x32_bf16 v[28:31], v[196:199], v[156:159], v[28:31]
    v_mfma_f32_16x16x32_bf16 v[92:95], v[212:215], v[156:159], v[92:95]
    ds_read_b64_tr_b16 v[180:181], v226 offset:40960
    v_mfma_f32_16x16x32_bf16 v[88:91], v[212:215], v[152:155], v[88:91]
    ds_read_b64_tr_b16 v[182:183], v226 offset:45056
    v_mfma_f32_16x16x32_bf16 v[84:87], v[212:215], v[148:151], v[84:87]
    ds_read_b64_tr_b16 v[168:169], v227 offset:32768
    v_mfma_f32_16x16x32_bf16 v[80:83], v[212:215], v[144:147], v[80:83]
    ds_read_b64_tr_b16 v[170:171], v227 offset:36864
    v_mfma_f32_16x16x32_bf16 v[32:35], v[200:203], v[144:147], v[32:35]
    ds_read_b64_tr_b16 v[184:185], v227 offset:40960
    v_mfma_f32_16x16x32_bf16 v[36:39], v[200:203], v[148:151], v[36:39]
    v_mfma_f32_16x16x32_bf16 v[40:43], v[200:203], v[152:155], v[40:43]
    ds_read_b64_tr_b16 v[186:187], v227 offset:45056
    v_mfma_f32_16x16x32_bf16 v[44:47], v[200:203], v[156:159], v[44:47]
    ds_read_b64_tr_b16 v[172:173], v228 offset:32768
    v_mfma_f32_16x16x32_bf16 v[108:111], v[216:219], v[156:159], v[108:111]
    ds_read_b64_tr_b16 v[174:175], v228 offset:36864
    v_mfma_f32_16x16x32_bf16 v[104:107], v[216:219], v[152:155], v[104:107]
    ds_read_b64_tr_b16 v[188:189], v228 offset:40960
    v_mfma_f32_16x16x32_bf16 v[100:103], v[216:219], v[148:151], v[100:103]
    ds_read_b64_tr_b16 v[190:191], v228 offset:45056
    v_mfma_f32_16x16x32_bf16 v[96:99], v[216:219], v[144:147], v[96:99]
    v_mfma_f32_16x16x32_bf16 v[48:51], v[204:207], v[144:147], v[48:51]
    v_mfma_f32_16x16x32_bf16 v[52:55], v[204:207], v[148:151], v[52:55]
    v_mfma_f32_16x16x32_bf16 v[56:59], v[204:207], v[152:155], v[56:59]
    v_mfma_f32_16x16x32_bf16 v[60:63], v[204:207], v[156:159], v[60:63]
    v_mfma_f32_16x16x32_bf16 v[124:127], v[220:223], v[156:159], v[124:127]
    v_mfma_f32_16x16x32_bf16 v[120:123], v[220:223], v[152:155], v[120:123]
    v_mfma_f32_16x16x32_bf16 v[116:119], v[220:223], v[148:151], v[116:119]
    v_mfma_f32_16x16x32_bf16 v[112:115], v[220:223], v[144:147], v[112:115]
    s_waitcnt lgkmcnt(0)
    s_barrier
    .p2align 3
    v_mfma_f32_16x16x32_bf16 v[0:3], v[160:163], v[128:131], v[0:3]
    ds_read_b64_tr_b16 v[192:193], v229 offset:0
    v_mfma_f32_16x16x32_bf16 v[4:7], v[160:163], v[132:135], v[4:7]
    ds_read_b64_tr_b16 v[194:195], v229 offset:4096
    v_mfma_f32_16x16x32_bf16 v[8:11], v[160:163], v[136:139], v[8:11]
    ds_read_b128 v[144:147], v224 offset:33792
    v_mfma_f32_16x16x32_bf16 v[12:15], v[160:163], v[140:143], v[12:15]
    ds_read_b128 v[148:151], v224 offset:35840
    v_mfma_f32_16x16x32_bf16 v[76:79], v[176:179], v[140:143], v[76:79]
    ds_read_b128 v[152:155], v224 offset:37888
    v_mfma_f32_16x16x32_bf16 v[72:75], v[176:179], v[136:139], v[72:75]
    v_mfma_f32_16x16x32_bf16 v[68:71], v[176:179], v[132:135], v[68:71]
    ds_read_b128 v[156:159], v224 offset:39936
    v_mfma_f32_16x16x32_bf16 v[64:67], v[176:179], v[128:131], v[64:67]
    ds_read_b64_tr_b16 v[208:209], v229 offset:8192
    v_mfma_f32_16x16x32_bf16 v[16:19], v[164:167], v[128:131], v[16:19]
    ds_read_b64_tr_b16 v[210:211], v229 offset:12288
    v_mfma_f32_16x16x32_bf16 v[20:23], v[164:167], v[132:135], v[20:23]
    ds_read_b64_tr_b16 v[196:197], v230 offset:0
    v_mfma_f32_16x16x32_bf16 v[24:27], v[164:167], v[136:139], v[24:27]
    ds_read_b64_tr_b16 v[198:199], v230 offset:4096
    v_mfma_f32_16x16x32_bf16 v[28:31], v[164:167], v[140:143], v[28:31]
    v_mfma_f32_16x16x32_bf16 v[92:95], v[180:183], v[140:143], v[92:95]
    ds_read_b64_tr_b16 v[212:213], v230 offset:8192
    v_mfma_f32_16x16x32_bf16 v[88:91], v[180:183], v[136:139], v[88:91]
    ds_read_b64_tr_b16 v[214:215], v230 offset:12288
    v_mfma_f32_16x16x32_bf16 v[84:87], v[180:183], v[132:135], v[84:87]
    ds_read_b64_tr_b16 v[200:201], v231 offset:0
    v_mfma_f32_16x16x32_bf16 v[80:83], v[180:183], v[128:131], v[80:83]
    ds_read_b64_tr_b16 v[202:203], v231 offset:4096
    v_mfma_f32_16x16x32_bf16 v[32:35], v[168:171], v[128:131], v[32:35]
    ds_read_b64_tr_b16 v[216:217], v231 offset:8192
    v_mfma_f32_16x16x32_bf16 v[36:39], v[168:171], v[132:135], v[36:39]
    v_mfma_f32_16x16x32_bf16 v[40:43], v[168:171], v[136:139], v[40:43]
    ds_read_b64_tr_b16 v[218:219], v231 offset:12288
    v_mfma_f32_16x16x32_bf16 v[44:47], v[168:171], v[140:143], v[44:47]
    ds_read_b64_tr_b16 v[204:205], v232 offset:0
    v_mfma_f32_16x16x32_bf16 v[108:111], v[184:187], v[140:143], v[108:111]
    ds_read_b64_tr_b16 v[206:207], v232 offset:4096
    v_mfma_f32_16x16x32_bf16 v[104:107], v[184:187], v[136:139], v[104:107]
    ds_read_b64_tr_b16 v[220:221], v232 offset:8192
    v_mfma_f32_16x16x32_bf16 v[100:103], v[184:187], v[132:135], v[100:103]
    ds_read_b64_tr_b16 v[222:223], v232 offset:12288
    v_mfma_f32_16x16x32_bf16 v[96:99], v[184:187], v[128:131], v[96:99]
    v_mfma_f32_16x16x32_bf16 v[48:51], v[172:175], v[128:131], v[48:51]
    v_mfma_f32_16x16x32_bf16 v[52:55], v[172:175], v[132:135], v[52:55]
    v_mfma_f32_16x16x32_bf16 v[56:59], v[172:175], v[136:139], v[56:59]
    v_mfma_f32_16x16x32_bf16 v[60:63], v[172:175], v[140:143], v[60:63]
    v_mfma_f32_16x16x32_bf16 v[124:127], v[188:191], v[140:143], v[124:127]
    v_mfma_f32_16x16x32_bf16 v[120:123], v[188:191], v[136:139], v[120:123]
    v_mfma_f32_16x16x32_bf16 v[116:119], v[188:191], v[132:135], v[116:119]
    v_mfma_f32_16x16x32_bf16 v[112:115], v[188:191], v[128:131], v[112:115]
    s_waitcnt lgkmcnt(0)
    s_barrier
    .p2align 3
    v_mfma_f32_16x16x32_bf16 v[0:3], v[192:195], v[144:147], v[0:3]
    ds_read_b64_tr_b16 v[160:161], v229 offset:16384
    v_mfma_f32_16x16x32_bf16 v[4:7], v[192:195], v[148:151], v[4:7]
    ds_read_b64_tr_b16 v[162:163], v229 offset:20480
    v_mfma_f32_16x16x32_bf16 v[8:11], v[192:195], v[152:155], v[8:11]
    ds_read_b128 v[128:131], v224 offset:0
    v_mfma_f32_16x16x32_bf16 v[12:15], v[192:195], v[156:159], v[12:15]
    ds_read_b128 v[132:135], v224 offset:2048
    v_mfma_f32_16x16x32_bf16 v[76:79], v[208:211], v[156:159], v[76:79]
    ds_read_b128 v[136:139], v224 offset:4096
    v_mfma_f32_16x16x32_bf16 v[72:75], v[208:211], v[152:155], v[72:75]
    v_mfma_f32_16x16x32_bf16 v[68:71], v[208:211], v[148:151], v[68:71]
    ds_read_b128 v[140:143], v224 offset:6144
    v_mfma_f32_16x16x32_bf16 v[64:67], v[208:211], v[144:147], v[64:67]
    ds_read_b64_tr_b16 v[176:177], v229 offset:24576
    v_mfma_f32_16x16x32_bf16 v[16:19], v[196:199], v[144:147], v[16:19]
    ds_read_b64_tr_b16 v[178:179], v229 offset:28672
    v_mfma_f32_16x16x32_bf16 v[20:23], v[196:199], v[148:151], v[20:23]
    ds_read_b64_tr_b16 v[164:165], v230 offset:16384
    v_mfma_f32_16x16x32_bf16 v[24:27], v[196:199], v[152:155], v[24:27]
    ds_read_b64_tr_b16 v[166:167], v230 offset:20480
    v_mfma_f32_16x16x32_bf16 v[28:31], v[196:199], v[156:159], v[28:31]
    v_mfma_f32_16x16x32_bf16 v[92:95], v[212:215], v[156:159], v[92:95]
    ds_read_b64_tr_b16 v[180:181], v230 offset:24576
    v_mfma_f32_16x16x32_bf16 v[88:91], v[212:215], v[152:155], v[88:91]
    ds_read_b64_tr_b16 v[182:183], v230 offset:28672
    v_mfma_f32_16x16x32_bf16 v[84:87], v[212:215], v[148:151], v[84:87]
    ds_read_b64_tr_b16 v[168:169], v231 offset:16384
    v_mfma_f32_16x16x32_bf16 v[80:83], v[212:215], v[144:147], v[80:83]
    ds_read_b64_tr_b16 v[170:171], v231 offset:20480
    v_mfma_f32_16x16x32_bf16 v[32:35], v[200:203], v[144:147], v[32:35]
    ds_read_b64_tr_b16 v[184:185], v231 offset:24576
    v_mfma_f32_16x16x32_bf16 v[36:39], v[200:203], v[148:151], v[36:39]
    v_mfma_f32_16x16x32_bf16 v[40:43], v[200:203], v[152:155], v[40:43]
    ds_read_b64_tr_b16 v[186:187], v231 offset:28672
    v_mfma_f32_16x16x32_bf16 v[44:47], v[200:203], v[156:159], v[44:47]
    ds_read_b64_tr_b16 v[172:173], v232 offset:16384
    v_mfma_f32_16x16x32_bf16 v[108:111], v[216:219], v[156:159], v[108:111]
    ds_read_b64_tr_b16 v[174:175], v232 offset:20480
    v_mfma_f32_16x16x32_bf16 v[104:107], v[216:219], v[152:155], v[104:107]
    ds_read_b64_tr_b16 v[188:189], v232 offset:24576
    v_mfma_f32_16x16x32_bf16 v[100:103], v[216:219], v[148:151], v[100:103]
    ds_read_b64_tr_b16 v[190:191], v232 offset:28672
    v_mfma_f32_16x16x32_bf16 v[96:99], v[216:219], v[144:147], v[96:99]
    v_mfma_f32_16x16x32_bf16 v[48:51], v[204:207], v[144:147], v[48:51]
    v_mfma_f32_16x16x32_bf16 v[52:55], v[204:207], v[148:151], v[52:55]
    v_mfma_f32_16x16x32_bf16 v[56:59], v[204:207], v[152:155], v[56:59]
    v_mfma_f32_16x16x32_bf16 v[60:63], v[204:207], v[156:159], v[60:63]
    v_mfma_f32_16x16x32_bf16 v[124:127], v[220:223], v[156:159], v[124:127]
    v_mfma_f32_16x16x32_bf16 v[120:123], v[220:223], v[152:155], v[120:123]
    v_mfma_f32_16x16x32_bf16 v[116:119], v[220:223], v[148:151], v[116:119]
    v_mfma_f32_16x16x32_bf16 v[112:115], v[220:223], v[144:147], v[112:115]
    s_waitcnt lgkmcnt(0)
    s_barrier
    .p2align 3
    v_mfma_f32_16x16x32_bf16 v[0:3], v[160:163], v[128:131], v[0:3]
    ds_read_b64_tr_b16 v[192:193], v229 offset:32768
    v_mfma_f32_16x16x32_bf16 v[4:7], v[160:163], v[132:135], v[4:7]
    ds_read_b64_tr_b16 v[194:195], v229 offset:36864
    v_mfma_f32_16x16x32_bf16 v[8:11], v[160:163], v[136:139], v[8:11]
    ds_read_b128 v[144:147], v224 offset:1024
    v_mfma_f32_16x16x32_bf16 v[12:15], v[160:163], v[140:143], v[12:15]
    ds_read_b128 v[148:151], v224 offset:3072
    v_mfma_f32_16x16x32_bf16 v[76:79], v[176:179], v[140:143], v[76:79]
    ds_read_b128 v[152:155], v224 offset:5120
    v_mfma_f32_16x16x32_bf16 v[72:75], v[176:179], v[136:139], v[72:75]
    v_mfma_f32_16x16x32_bf16 v[68:71], v[176:179], v[132:135], v[68:71]
    ds_read_b128 v[156:159], v224 offset:7168
    v_mfma_f32_16x16x32_bf16 v[64:67], v[176:179], v[128:131], v[64:67]
    ds_read_b64_tr_b16 v[208:209], v229 offset:40960
    v_mfma_f32_16x16x32_bf16 v[16:19], v[164:167], v[128:131], v[16:19]
    ds_read_b64_tr_b16 v[210:211], v229 offset:45056
    v_mfma_f32_16x16x32_bf16 v[20:23], v[164:167], v[132:135], v[20:23]
    ds_read_b64_tr_b16 v[196:197], v230 offset:32768
    v_mfma_f32_16x16x32_bf16 v[24:27], v[164:167], v[136:139], v[24:27]
    ds_read_b64_tr_b16 v[198:199], v230 offset:36864
    v_mfma_f32_16x16x32_bf16 v[28:31], v[164:167], v[140:143], v[28:31]
    v_mfma_f32_16x16x32_bf16 v[92:95], v[180:183], v[140:143], v[92:95]
    ds_read_b64_tr_b16 v[212:213], v230 offset:40960
    v_mfma_f32_16x16x32_bf16 v[88:91], v[180:183], v[136:139], v[88:91]
    ds_read_b64_tr_b16 v[214:215], v230 offset:45056
    v_mfma_f32_16x16x32_bf16 v[84:87], v[180:183], v[132:135], v[84:87]
    ds_read_b64_tr_b16 v[200:201], v231 offset:32768
    v_mfma_f32_16x16x32_bf16 v[80:83], v[180:183], v[128:131], v[80:83]
    ds_read_b64_tr_b16 v[202:203], v231 offset:36864
    v_mfma_f32_16x16x32_bf16 v[32:35], v[168:171], v[128:131], v[32:35]
    ds_read_b64_tr_b16 v[216:217], v231 offset:40960
    v_mfma_f32_16x16x32_bf16 v[36:39], v[168:171], v[132:135], v[36:39]
    v_mfma_f32_16x16x32_bf16 v[40:43], v[168:171], v[136:139], v[40:43]
    ds_read_b64_tr_b16 v[218:219], v231 offset:45056
    v_mfma_f32_16x16x32_bf16 v[44:47], v[168:171], v[140:143], v[44:47]
    ds_read_b64_tr_b16 v[204:205], v232 offset:32768
    v_mfma_f32_16x16x32_bf16 v[108:111], v[184:187], v[140:143], v[108:111]
    ds_read_b64_tr_b16 v[206:207], v232 offset:36864
    v_mfma_f32_16x16x32_bf16 v[104:107], v[184:187], v[136:139], v[104:107]
    ds_read_b64_tr_b16 v[220:221], v232 offset:40960
    v_mfma_f32_16x16x32_bf16 v[100:103], v[184:187], v[132:135], v[100:103]
    ds_read_b64_tr_b16 v[222:223], v232 offset:45056
    v_mfma_f32_16x16x32_bf16 v[96:99], v[184:187], v[128:131], v[96:99]
    v_mfma_f32_16x16x32_bf16 v[48:51], v[172:175], v[128:131], v[48:51]
    v_mfma_f32_16x16x32_bf16 v[52:55], v[172:175], v[132:135], v[52:55]
    v_mfma_f32_16x16x32_bf16 v[56:59], v[172:175], v[136:139], v[56:59]
    v_mfma_f32_16x16x32_bf16 v[60:63], v[172:175], v[140:143], v[60:63]
    v_mfma_f32_16x16x32_bf16 v[124:127], v[188:191], v[140:143], v[124:127]
    s_sub_u32 s58, s58, 1
    s_cmp_lg_u32 s58, 0
    .p2align 3
    v_mfma_f32_16x16x32_bf16 v[120:123], v[188:191], v[136:139], v[120:123]
    v_mfma_f32_16x16x32_bf16 v[116:119], v[188:191], v[132:135], v[116:119]
    v_mfma_f32_16x16x32_bf16 v[112:115], v[188:191], v[128:131], v[112:115]
    s_cbranch_scc1 loop_24
    s_waitcnt lgkmcnt(0)
    s_barrier
    .p2align 3
    v_mfma_f32_16x16x32_bf16 v[0:3], v[192:195], v[144:147], v[0:3]
    v_mfma_f32_16x16x32_bf16 v[4:7], v[192:195], v[148:151], v[4:7]
    v_mfma_f32_16x16x32_bf16 v[8:11], v[192:195], v[152:155], v[8:11]
    v_mfma_f32_16x16x32_bf16 v[12:15], v[192:195], v[156:159], v[12:15]
    v_mfma_f32_16x16x32_bf16 v[76:79], v[208:211], v[156:159], v[76:79]
    v_mfma_f32_16x16x32_bf16 v[72:75], v[208:211], v[152:155], v[72:75]
    v_mfma_f32_16x16x32_bf16 v[68:71], v[208:211], v[148:151], v[68:71]
    v_mfma_f32_16x16x32_bf16 v[64:67], v[208:211], v[144:147], v[64:67]
    v_mfma_f32_16x16x32_bf16 v[16:19], v[196:199], v[144:147], v[16:19]
    v_mfma_f32_16x16x32_bf16 v[20:23], v[196:199], v[148:151], v[20:23]
    v_mfma_f32_16x16x32_bf16 v[24:27], v[196:199], v[152:155], v[24:27]
    v_mfma_f32_16x16x32_bf16 v[28:31], v[196:199], v[156:159], v[28:31]
    v_mfma_f32_16x16x32_bf16 v[92:95], v[212:215], v[156:159], v[92:95]
    v_mfma_f32_16x16x32_bf16 v[88:91], v[212:215], v[152:155], v[88:91]
    v_mfma_f32_16x16x32_bf16 v[84:87], v[212:215], v[148:151], v[84:87]
    v_mfma_f32_16x16x32_bf16 v[80:83], v[212:215], v[144:147], v[80:83]
    v_mfma_f32_16x16x32_bf16 v[32:35], v[200:203], v[144:147], v[32:35]
    v_mfma_f32_16x16x32_bf16 v[36:39], v[200:203], v[148:151], v[36:39]
    v_mfma_f32_16x16x32_bf16 v[40:43], v[200:203], v[152:155], v[40:43]
    v_mfma_f32_16x16x32_bf16 v[44:47], v[200:203], v[156:159], v[44:47]
    v_mfma_f32_16x16x32_bf16 v[108:111], v[216:219], v[156:159], v[108:111]
    v_mfma_f32_16x16x32_bf16 v[104:107], v[216:219], v[152:155], v[104:107]
    v_mfma_f32_16x16x32_bf16 v[100:103], v[216:219], v[148:151], v[100:103]
    v_mfma_f32_16x16x32_bf16 v[96:99], v[216:219], v[144:147], v[96:99]
    v_mfma_f32_16x16x32_bf16 v[48:51], v[204:207], v[144:147], v[48:51]
    v_mfma_f32_16x16x32_bf16 v[52:55], v[204:207], v[148:151], v[52:55]
    v_mfma_f32_16x16x32_bf16 v[56:59], v[204:207], v[152:155], v[56:59]
    v_mfma_f32_16x16x32_bf16 v[60:63], v[204:207], v[156:159], v[60:63]
    v_mfma_f32_16x16x32_bf16 v[124:127], v[220:223], v[156:159], v[124:127]
    v_mfma_f32_16x16x32_bf16 v[120:123], v[220:223], v[152:155], v[120:123]
    v_mfma_f32_16x16x32_bf16 v[116:119], v[220:223], v[148:151], v[116:119]
    v_mfma_f32_16x16x32_bf16 v[112:115], v[220:223], v[144:147], v[112:115]
    s_setprio 1
    v_add_u32 v191, s88, v254
    s_barrier
    s_add_u32 s93, s51, 0
    s_and_b32 s93, s93, 15
    s_lshl_b32 s93, s93, 12
    s_add_u32 m0, s61, 0
    s_mul_i32 s59, s93, 112
    buffer_load_dwordx4 v236, s[24:27], s59 offen lds
    s_nop 7
    s_lshl_b32 s55, s43, 9
    s_add_u32 s55, s55, 159744
    v_and_b32 v232, 0xf0, v254
    v_lshrrev_b32 v232, 1, v232
    v_add_u32 v232, s55, v232
    ds_read_b64 v[220:221], v232 offset:0
    ds_read_b64 v[222:223], v232 offset:128
    ds_read_b64 v[224:225], v232 offset:256
    ds_read_b64 v[226:227], v232 offset:384
    s_waitcnt lgkmcnt(0)
    v_sub_f32 v192, 0, v220
    buffer_load_dwordx4 v237, s[24:27], s59 offen offset:1024 lds
    v_mul_f32 v196, 0xbfb8aa3b, v221
    v_mul_f32 v200, v221, v221
    v_sub_f32 v193, 0, v222
    v_mul_f32 v197, 0xbfb8aa3b, v223
    v_mul_f32 v201, v223, v223
    v_sub_f32 v194, 0, v224
    v_mul_f32 v198, 0xbfb8aa3b, v225
    v_mul_f32 v202, v225, v225
    buffer_load_dwordx4 v242, s[4:7], s93 offen offset:2048 lds
    s_add_u32 s93, s93, 2048
    s_and_b32 s93, s93, 65535
    v_sub_f32 v195, 0, v226
    v_mul_f32 v199, 0xbfb8aa3b, v227
    v_mul_f32 v203, v227, v227
    v_rcp_f32 v200, v200
    v_rcp_f32 v201, v201
    v_rcp_f32 v202, v202
    v_rcp_f32 v203, v203
    s_nop 0
    s_barrier
    s_add_u32 m0, s62, 114688
    s_nop 0
    buffer_load_dwordx4 v191, s[4:7], s94 offen lds
    s_lshl_b32 s55, s44, 8
    s_add_u32 s55, s55, 161664
    v_lshrrev_b32 v235, 8, v254
    v_lshlrev_b32 v235, 4, v235
    v_add_u32 v235, s55, v235
    ds_read_b128 v[204:207], v235 offset:0
    ds_read_b128 v[208:211], v235 offset:512
    ds_read_b128 v[212:215], v235 offset:64
    buffer_load_dwordx4 v191, s[4:7], s94 offen offset:1024 lds
    ds_read_b128 v[216:219], v235 offset:576
    s_waitcnt lgkmcnt(0)
    v_fmac_f32 v0, v192, v204
    v_fmac_f32 v1, v192, v205
    v_fmac_f32 v2, v192, v206
    s_add_u32 m0, s61, 16384
    s_mul_i32 s59, s93, 112
    buffer_load_dwordx4 v236, s[24:27], s59 offen lds
    v_fmac_f32 v3, v192, v207
    v_mul_f32 v220, v196, v0
    v_mul_f32 v221, v196, v1
    v_mul_f32 v222, v196, v2
    buffer_load_dwordx4 v237, s[24:27], s59 offen offset:1024 lds
    v_mul_f32 v223, v196, v3
    v_fmac_f32 v64, v192, v208
    v_fmac_f32 v65, v192, v209
    v_fmac_f32 v66, v192, v210
    v_fmac_f32 v67, v192, v211
    buffer_load_dwordx4 v242, s[4:7], s93 offen offset:2048 lds
    s_add_u32 s93, s93, 6144
    s_and_b32 s93, s93, 65535
    v_exp_f32 v220, v220
    v_exp_f32 v221, v221
    v_exp_f32 v222, v222
    v_exp_f32 v223, v223
    v_mul_f32 v0, v0, v64
    s_barrier
    s_add_u32 m0, s62, 114688
    s_nop 0
    buffer_load_dwordx4 v191, s[4:7], s94 offen offset:2048 lds
    v_mul_f32 v1, v1, v65
    v_mul_f32 v2, v2, v66
    v_mul_f32 v3, v3, v67
    v_fma_f32 v220, v220, v200, v200
    buffer_load_dwordx4 v191, s[4:7], s94 offen offset:3072 lds
    s_add_u32 s94, s94, 32768
    s_and_b32 s94, s94, 262143
    v_fma_f32 v221, v221, v200, v200
    v_fma_f32 v222, v222, v200, v200
    v_fma_f32 v223, v223, v200, v200
    v_rcp_f32 v220, v220
    v_rcp_f32 v221, v221
    s_add_u32 m0, s61, 32768
    s_mul_i32 s59, s93, 112
    buffer_load_dwordx4 v236, s[24:27], s59 offen lds
    v_rcp_f32 v222, v222
    v_rcp_f32 v223, v223
    v_mul_f32 v0, v0, v220
    v_mul_f32 v1, v1, v221
    v_mul_f32 v2, v2, v222
    buffer_load_dwordx4 v237, s[24:27], s59 offen offset:1024 lds
    v_mul_f32 v3, v3, v223
    v_cvt_pk_bf16_f32 v224, v0, v1
    v_cvt_pk_bf16_f32 v225, v2, v3
    v_fmac_f32 v16, v192, v212
    v_fmac_f32 v17, v192, v213
    buffer_load_dwordx4 v242, s[4:7], s93 offen offset:2048 lds
    s_add_u32 s93, s93, 2048
    s_and_b32 s93, s93, 65535
    v_fmac_f32 v18, v192, v214
    v_fmac_f32 v19, v192, v215
    v_mul_f32 v220, v196, v16
    v_mul_f32 v221, v196, v17
    v_mul_f32 v222, v196, v18
    s_barrier
    s_add_u32 m0, s62, 131072
    s_nop 0
    buffer_load_dwordx4 v191, s[4:7], s94 offen lds
    v_mul_f32 v223, v196, v19
    v_fmac_f32 v80, v192, v216
    v_fmac_f32 v81, v192, v217
    v_fmac_f32 v82, v192, v218
    buffer_load_dwordx4 v191, s[4:7], s94 offen offset:1024 lds
    v_fmac_f32 v83, v192, v219
    v_exp_f32 v220, v220
    v_exp_f32 v221, v221
    v_exp_f32 v222, v222
    s_add_u32 m0, s61, 49152
    s_mul_i32 s59, s93, 112
    buffer_load_dwordx4 v236, s[24:27], s59 offen lds
    v_exp_f32 v223, v223
    v_mul_f32 v16, v16, v80
    v_mul_f32 v17, v17, v81
    v_mul_f32 v18, v18, v82
    buffer_load_dwordx4 v237, s[24:27], s59 offen offset:1024 lds
    v_mul_f32 v19, v19, v83
    v_fma_f32 v220, v220, v200, v200
    v_fma_f32 v221, v221, v200, v200
    v_fma_f32 v222, v222, v200, v200
    buffer_load_dwordx4 v242, s[4:7], s93 offen offset:2048 lds
    s_add_u32 s93, s93, 6144
    s_and_b32 s93, s93, 65535
    v_fma_f32 v223, v223, v200, v200
    v_rcp_f32 v220, v220
    v_rcp_f32 v221, v221
    v_rcp_f32 v222, v222
    s_barrier
    s_add_u32 m0, s62, 131072
    s_nop 0
    buffer_load_dwordx4 v191, s[4:7], s94 offen offset:2048 lds
    v_rcp_f32 v223, v223
    v_mul_f32 v16, v16, v220
    v_mul_f32 v17, v17, v221
    v_mul_f32 v18, v18, v222
    buffer_load_dwordx4 v191, s[4:7], s94 offen offset:3072 lds
    s_add_u32 s94, s94, 32768
    s_and_b32 s94, s94, 262143
    v_mul_f32 v19, v19, v223
    v_cvt_pk_bf16_f32 v226, v16, v17
    v_cvt_pk_bf16_f32 v227, v18, v19
    s_add_u32 s55, s89, 0
    buffer_store_dwordx4 v[224:227], v254, s[4:7], s55 offen sc0 sc1
    s_add_u32 m0, s61, 65536
    s_mul_i32 s59, s93, 112
    buffer_load_dwordx4 v236, s[24:27], s59 offen lds
    v_fmac_f32 v4, v193, v204
    v_fmac_f32 v5, v193, v205
    v_fmac_f32 v6, v193, v206
    v_fmac_f32 v7, v193, v207
    v_mul_f32 v220, v197, v4
    buffer_load_dwordx4 v237, s[24:27], s59 offen offset:1024 lds
    v_mul_f32 v221, v197, v5
    v_mul_f32 v222, v197, v6
    v_mul_f32 v223, v197, v7
    v_fmac_f32 v68, v193, v208
    buffer_load_dwordx4 v242, s[4:7], s93 offen offset:2048 lds
    s_add_u32 s93, s93, 2048
    s_and_b32 s93, s93, 65535
    v_fmac_f32 v69, v193, v209
    v_fmac_f32 v70, v193, v210
    v_fmac_f32 v71, v193, v211
    v_exp_f32 v220, v220
    v_exp_f32 v221, v221
    s_waitcnt vmcnt(14)
    s_barrier
    s_add_u32 m0, s62, 98304
    s_nop 0
    buffer_load_dwordx4 v191, s[4:7], s94 offen lds
    v_exp_f32 v222, v222
    v_exp_f32 v223, v223
    v_mul_f32 v4, v4, v68
    v_mul_f32 v5, v5, v69
    buffer_load_dwordx4 v191, s[4:7], s94 offen offset:1024 lds
    v_mul_f32 v6, v6, v70
    v_mul_f32 v7, v7, v71
    v_fma_f32 v220, v220, v201, v201
    v_fma_f32 v221, v221, v201, v201
    s_add_u32 m0, s61, 81920
    s_mul_i32 s59, s93, 112
    buffer_load_dwordx4 v236, s[24:27], s59 offen lds
    v_fma_f32 v222, v222, v201, v201
    v_fma_f32 v223, v223, v201, v201
    v_rcp_f32 v220, v220
    v_rcp_f32 v221, v221
    v_rcp_f32 v222, v222
    buffer_load_dwordx4 v237, s[24:27], s59 offen offset:1024 lds
    v_rcp_f32 v223, v223
    v_mul_f32 v4, v4, v220
    v_mul_f32 v5, v5, v221
    v_mul_f32 v6, v6, v222
    buffer_load_dwordx4 v242, s[4:7], s93 offen offset:2048 lds
    s_add_u32 s93, s93, 6144
    s_and_b32 s93, s93, 65535
    v_mul_f32 v7, v7, v223
    v_cvt_pk_bf16_f32 v228, v4, v5
    v_cvt_pk_bf16_f32 v229, v6, v7
    v_fmac_f32 v20, v193, v212
    v_fmac_f32 v21, v193, v213
    s_barrier
    s_add_u32 m0, s62, 98304
    s_nop 0
    buffer_load_dwordx4 v191, s[4:7], s94 offen offset:2048 lds
    v_fmac_f32 v22, v193, v214
    v_fmac_f32 v23, v193, v215
    v_mul_f32 v220, v197, v20
    v_mul_f32 v221, v197, v21
    buffer_load_dwordx4 v191, s[4:7], s94 offen offset:3072 lds
    s_add_u32 s94, s94, 32768
    s_and_b32 s94, s94, 262143
    v_mul_f32 v222, v197, v22
    v_mul_f32 v223, v197, v23
    v_fmac_f32 v84, v193, v216
    v_fmac_f32 v85, v193, v217
    v_fmac_f32 v86, v193, v218
    s_add_u32 m0, s61, 0
    s_mul_i32 s59, s93, 112
    buffer_load_dwordx4 v236, s[24:27], s59 offen lds
    v_fmac_f32 v87, v193, v219
    v_exp_f32 v220, v220
    v_exp_f32 v221, v221
    v_exp_f32 v222, v222
    buffer_load_dwordx4 v237, s[24:27], s59 offen offset:1024 lds
    v_exp_f32 v223, v223
    v_mul_f32 v20, v20, v84
    v_mul_f32 v21, v21, v85
    v_mul_f32 v22, v22, v86
    v_mul_f32 v23, v23, v87
    buffer_load_dwordx4 v242, s[4:7], s93 offen offset:2048 lds
    s_add_u32 s93, s93, 2048
    s_and_b32 s93, s93, 65535
    v_fma_f32 v220, v220, v201, v201
    v_fma_f32 v221, v221, v201, v201
    v_fma_f32 v222, v222, v201, v201
    v_fma_f32 v223, v223, v201, v201
    v_rcp_f32 v220, v220
    s_waitcnt vmcnt(14)
    s_barrier
    s_xor_b32 s55, s42, 3
    s_or_b32 s55, s46, s55
    s_cbranch_scc1 cf_25
    v_mov_b32 v252, 0
    v_mov_b32 v253, 1
    s_lshl_b32 s55, s2, 2
    s_add_u32 s55, s55, 71568384
    s_mov_b64 exec, 1
    buffer_store_dword v253, v252, s[4:7], s55 offen sc0 sc1
    s_mov_b64 exec, -1
cf_25:
    s_add_u32 m0, s62, 114688
    s_nop 0
    buffer_load_dwordx4 v191, s[4:7], s94 offen lds
    v_rcp_f32 v221, v221
    v_rcp_f32 v222, v222
    v_rcp_f32 v223, v223
    v_mul_f32 v20, v20, v220
    buffer_load_dwordx4 v191, s[4:7], s94 offen offset:1024 lds
    v_mul_f32 v21, v21, v221
    v_mul_f32 v22, v22, v222
    v_mul_f32 v23, v23, v223
    v_cvt_pk_bf16_f32 v230, v20, v21
    s_add_u32 m0, s61, 16384
    s_mul_i32 s59, s93, 112
    buffer_load_dwordx4 v236, s[24:27], s59 offen lds
    v_cvt_pk_bf16_f32 v231, v22, v23
    s_add_u32 s55, s89, 2048
    buffer_store_dwordx4 v[228:231], v254, s[4:7], s55 offen sc0 sc1
    v_fmac_f32 v8, v194, v204
    v_fmac_f32 v9, v194, v205
    v_fmac_f32 v10, v194, v206
    buffer_load_dwordx4 v237, s[24:27], s59 offen offset:1024 lds
    v_fmac_f32 v11, v194, v207
    v_mul_f32 v220, v198, v8
    v_mul_f32 v221, v198, v9
    v_mul_f32 v222, v198, v10
    buffer_load_dwordx4 v242, s[4:7], s93 offen offset:2048 lds
    s_add_u32 s93, s93, 6144
    s_and_b32 s93, s93, 65535
    v_mul_f32 v223, v198, v11
    v_fmac_f32 v72, v194, v208
    v_fmac_f32 v73, v194, v209
    v_fmac_f32 v74, v194, v210
    v_fmac_f32 v75, v194, v211
    s_barrier
    s_add_u32 m0, s62, 114688
    s_nop 0
    buffer_load_dwordx4 v191, s[4:7], s94 offen offset:2048 lds
    v_exp_f32 v220, v220
    v_exp_f32 v221, v221
    v_exp_f32 v222, v222
    v_exp_f32 v223, v223
    buffer_load_dwordx4 v191, s[4:7], s94 offen offset:3072 lds
    s_add_u32 s94, s94, 32768
    s_and_b32 s94, s94, 262143
    v_mul_f32 v8, v8, v72
    v_mul_f32 v9, v9, v73
    v_mul_f32 v10, v10, v74
    v_mul_f32 v11, v11, v75
    s_add_u32 m0, s61, 32768
    s_mul_i32 s59, s93, 112
    buffer_load_dwordx4 v236, s[24:27], s59 offen lds
    v_fma_f32 v220, v220, v202, v202
    v_fma_f32 v221, v221, v202, v202
    v_fma_f32 v222, v222, v202, v202
    v_fma_f32 v223, v223, v202, v202
    buffer_load_dwordx4 v237, s[24:27], s59 offen offset:1024 lds
    v_rcp_f32 v220, v220
    v_rcp_f32 v221, v221
    v_rcp_f32 v222, v222
    v_rcp_f32 v223, v223
    buffer_load_dwordx4 v242, s[4:7], s93 offen offset:2048 lds
    s_add_u32 s93, s93, 2048
    s_and_b32 s93, s93, 65535
    v_mul_f32 v8, v8, v220
    v_mul_f32 v9, v9, v221
    v_mul_f32 v10, v10, v222
    v_mul_f32 v11, v11, v223
    s_waitcnt vmcnt(14)
    s_barrier
    s_add_u32 m0, s62, 131072
    s_nop 0
    buffer_load_dwordx4 v191, s[4:7], s94 offen lds
    v_cvt_pk_bf16_f32 v224, v8, v9
    v_cvt_pk_bf16_f32 v225, v10, v11
    v_fmac_f32 v24, v194, v212
    v_fmac_f32 v25, v194, v213
    buffer_load_dwordx4 v191, s[4:7], s94 offen offset:1024 lds
    v_fmac_f32 v26, v194, v214
    v_fmac_f32 v27, v194, v215
    v_mul_f32 v220, v198, v24
    v_mul_f32 v221, v198, v25
    v_mul_f32 v222, v198, v26
    s_add_u32 m0, s61, 49152
    s_mul_i32 s59, s93, 112
    buffer_load_dwordx4 v236, s[24:27], s59 offen lds
    v_mul_f32 v223, v198, v27
    v_fmac_f32 v88, v194, v216
    v_fmac_f32 v89, v194, v217
    v_fmac_f32 v90, v194, v218
    v_fmac_f32 v91, v194, v219
    buffer_load_dwordx4 v237, s[24:27], s59 offen offset:1024 lds
    v_exp_f32 v220, v220
    v_exp_f32 v221, v221
    v_exp_f32 v222, v222
    v_exp_f32 v223, v223
    v_mul_f32 v24, v24, v88
    buffer_load_dwordx4 v242, s[4:7], s93 offen offset:2048 lds
    s_add_u32 s93, s93, 6144
    s_and_b32 s93, s93, 65535
    v_mul_f32 v25, v25, v89
    v_mul_f32 v26, v26, v90
    v_mul_f32 v27, v27, v91
    v_fma_f32 v220, v220, v202, v202
    v_fma_f32 v221, v221, v202, v202
    s_barrier
    s_add_u32 m0, s62, 131072
    s_nop 0
    buffer_load_dwordx4 v191, s[4:7], s94 offen offset:2048 lds
    v_fma_f32 v222, v222, v202, v202
    v_fma_f32 v223, v223, v202, v202
    v_rcp_f32 v220, v220
    v_rcp_f32 v221, v221
    buffer_load_dwordx4 v191, s[4:7], s94 offen offset:3072 lds
    s_add_u32 s94, s94, 32768
    s_and_b32 s94, s94, 262143
    v_rcp_f32 v222, v222
    v_rcp_f32 v223, v223
    v_mul_f32 v24, v24, v220
    v_mul_f32 v25, v25, v221
    s_add_u32 m0, s61, 65536
    s_mul_i32 s59, s93, 112
    buffer_load_dwordx4 v236, s[24:27], s59 offen lds
    v_mul_f32 v26, v26, v222
    v_mul_f32 v27, v27, v223
    v_cvt_pk_bf16_f32 v226, v24, v25
    v_cvt_pk_bf16_f32 v227, v26, v27
    buffer_load_dwordx4 v237, s[24:27], s59 offen offset:1024 lds
    s_add_u32 s55, s89, 4096
    buffer_store_dwordx4 v[224:227], v254, s[4:7], s55 offen sc0 sc1
    v_fmac_f32 v12, v195, v204
    v_fmac_f32 v13, v195, v205
    v_fmac_f32 v14, v195, v206
    buffer_load_dwordx4 v242, s[4:7], s93 offen offset:2048 lds
    s_add_u32 s93, s93, 2048
    s_and_b32 s93, s93, 65535
    v_fmac_f32 v15, v195, v207
    v_mul_f32 v220, v199, v12
    v_mul_f32 v221, v199, v13
    v_mul_f32 v222, v199, v14
    v_mul_f32 v223, v199, v15
    s_waitcnt vmcnt(14)
    s_barrier
    s_add_u32 m0, s62, 98304
    s_nop 0
    buffer_load_dwordx4 v191, s[4:7], s94 offen lds
    v_fmac_f32 v76, v195, v208
    v_fmac_f32 v77, v195, v209
    v_fmac_f32 v78, v195, v210
    v_fmac_f32 v79, v195, v211
    buffer_load_dwordx4 v191, s[4:7], s94 offen offset:1024 lds
    v_exp_f32 v220, v220
    v_exp_f32 v221, v221
    v_exp_f32 v222, v222
    v_exp_f32 v223, v223
    s_add_u32 m0, s61, 81920
    s_mul_i32 s59, s93, 112
    buffer_load_dwordx4 v236, s[24:27], s59 offen lds
    v_mul_f32 v12, v12, v76
    v_mul_f32 v13, v13, v77
    v_mul_f32 v14, v14, v78
    v_mul_f32 v15, v15, v79
    buffer_load_dwordx4 v237, s[24:27], s59 offen offset:1024 lds
    v_fma_f32 v220, v220, v203, v203
    v_fma_f32 v221, v221, v203, v203
    v_fma_f32 v222, v222, v203, v203
    v_fma_f32 v223, v223, v203, v203
    buffer_load_dwordx4 v242, s[4:7], s93 offen offset:2048 lds
    s_add_u32 s93, s93, 6144
    s_and_b32 s93, s93, 65535
    v_rcp_f32 v220, v220
    v_rcp_f32 v221, v221
    v_rcp_f32 v222, v222
    v_rcp_f32 v223, v223
    s_barrier
    s_add_u32 m0, s62, 98304
    s_nop 0
    buffer_load_dwordx4 v191, s[4:7], s94 offen offset:2048 lds
    v_mul_f32 v12, v12, v220
    v_mul_f32 v13, v13, v221
    v_mul_f32 v14, v14, v222
    v_mul_f32 v15, v15, v223
    buffer_load_dwordx4 v191, s[4:7], s94 offen offset:3072 lds
    s_add_u32 s94, s94, 32768
    s_and_b32 s94, s94, 262143
    v_cvt_pk_bf16_f32 v228, v12, v13
    v_cvt_pk_bf16_f32 v229, v14, v15
    v_fmac_f32 v28, v195, v212
    v_fmac_f32 v29, v195, v213
    v_fmac_f32 v30, v195, v214
    s_add_u32 m0, s61, 0
    s_mul_i32 s59, s93, 112
    buffer_load_dwordx4 v236, s[24:27], s59 offen lds
    v_fmac_f32 v31, v195, v215
    v_mul_f32 v220, v199, v28
    v_mul_f32 v221, v199, v29
    v_mul_f32 v222, v199, v30
    v_mul_f32 v223, v199, v31
    buffer_load_dwordx4 v237, s[24:27], s59 offen offset:1024 lds
    v_fmac_f32 v92, v195, v216
    v_fmac_f32 v93, v195, v217
    v_fmac_f32 v94, v195, v218
    v_fmac_f32 v95, v195, v219
    v_exp_f32 v220, v220
    buffer_load_dwordx4 v242, s[4:7], s93 offen offset:2048 lds
    s_add_u32 s93, s93, 2048
    s_and_b32 s93, s93, 65535
    v_exp_f32 v221, v221
    v_exp_f32 v222, v222
    v_exp_f32 v223, v223
    v_mul_f32 v28, v28, v92
    v_mul_f32 v29, v29, v93
    s_waitcnt vmcnt(14)
    s_barrier
    s_add_u32 m0, s62, 114688
    s_nop 0
    buffer_load_dwordx4 v191, s[4:7], s94 offen lds
    v_mul_f32 v30, v30, v94
    v_mul_f32 v31, v31, v95
    v_fma_f32 v220, v220, v203, v203
    buffer_load_dwordx4 v191, s[4:7], s94 offen offset:1024 lds
    v_fma_f32 v221, v221, v203, v203
    v_fma_f32 v222, v222, v203, v203
    v_fma_f32 v223, v223, v203, v203
    s_add_u32 m0, s61, 16384
    s_mul_i32 s59, s93, 112
    buffer_load_dwordx4 v236, s[24:27], s59 offen lds
    v_rcp_f32 v220, v220
    v_rcp_f32 v221, v221
    v_rcp_f32 v222, v222
    v_rcp_f32 v223, v223
    buffer_load_dwordx4 v237, s[24:27], s59 offen offset:1024 lds
    v_mul_f32 v28, v28, v220
    v_mul_f32 v29, v29, v221
    v_mul_f32 v30, v30, v222
    buffer_load_dwordx4 v242, s[4:7], s93 offen offset:2048 lds
    s_add_u32 s93, s93, 6144
    s_and_b32 s93, s93, 65535
    v_mul_f32 v31, v31, v223
    v_cvt_pk_bf16_f32 v230, v28, v29
    v_cvt_pk_bf16_f32 v231, v30, v31
    s_add_u32 s55, s89, 6144
    buffer_store_dwordx4 v[228:231], v254, s[4:7], s55 offen sc0 sc1
    s_barrier
    s_add_u32 m0, s62, 114688
    s_nop 0
    buffer_load_dwordx4 v191, s[4:7], s94 offen offset:2048 lds
    ds_read_b128 v[204:207], v235 offset:128
    ds_read_b128 v[208:211], v235 offset:640
    ds_read_b128 v[212:215], v235 offset:192
    ds_read_b128 v[216:219], v235 offset:704
    s_waitcnt lgkmcnt(0)
    buffer_load_dwordx4 v191, s[4:7], s94 offen offset:3072 lds
    s_add_u32 s94, s94, 32768
    s_and_b32 s94, s94, 262143
    v_fmac_f32 v32, v192, v204
    v_fmac_f32 v33, v192, v205
    v_fmac_f32 v34, v192, v206
    v_fmac_f32 v35, v192, v207
    v_mul_f32 v220, v196, v32
    s_add_u32 m0, s61, 32768
    s_mul_i32 s59, s93, 112
    buffer_load_dwordx4 v236, s[24:27], s59 offen lds
    v_mul_f32 v221, v196, v33
    v_mul_f32 v222, v196, v34
    v_mul_f32 v223, v196, v35
    v_fmac_f32 v96, v192, v208
    v_fmac_f32 v97, v192, v209
    buffer_load_dwordx4 v237, s[24:27], s59 offen offset:1024 lds
    v_fmac_f32 v98, v192, v210
    v_fmac_f32 v99, v192, v211
    v_exp_f32 v220, v220
    v_exp_f32 v221, v221
    v_exp_f32 v222, v222
    buffer_load_dwordx4 v242, s[4:7], s93 offen offset:2048 lds
    s_add_u32 s93, s93, 2048
    s_and_b32 s93, s93, 65535
    v_exp_f32 v223, v223
    v_mul_f32 v32, v32, v96
    v_mul_f32 v33, v33, v97
    v_mul_f32 v34, v34, v98
    v_mul_f32 v35, v35, v99
    v_fma_f32 v220, v220, v200, v200
    s_waitcnt vmcnt(14)
    s_barrier
    s_add_u32 m0, s62, 131072
    s_nop 0
    buffer_load_dwordx4 v191, s[4:7], s94 offen lds
    v_fma_f32 v221, v221, v200, v200
    v_fma_f32 v222, v222, v200, v200
    v_fma_f32 v223, v223, v200, v200
    v_rcp_f32 v220, v220
    buffer_load_dwordx4 v191, s[4:7], s94 offen offset:1024 lds
    v_rcp_f32 v221, v221
    v_rcp_f32 v222, v222
    v_rcp_f32 v223, v223
    v_mul_f32 v32, v32, v220
    v_mul_f32 v33, v33, v221
    s_add_u32 m0, s61, 49152
    s_mul_i32 s59, s93, 112
    buffer_load_dwordx4 v236, s[24:27], s59 offen lds
    v_mul_f32 v34, v34, v222
    v_mul_f32 v35, v35, v223
    v_cvt_pk_bf16_f32 v224, v32, v33
    v_cvt_pk_bf16_f32 v225, v34, v35
    v_fmac_f32 v48, v192, v212
    buffer_load_dwordx4 v237, s[24:27], s59 offen offset:1024 lds
    v_fmac_f32 v49, v192, v213
    v_fmac_f32 v50, v192, v214
    v_fmac_f32 v51, v192, v215
    v_mul_f32 v220, v196, v48
    v_mul_f32 v221, v196, v49
    buffer_load_dwordx4 v242, s[4:7], s93 offen offset:2048 lds
    s_add_u32 s93, s93, 10240
    s_and_b32 s93, s93, 65535
    v_mul_f32 v222, v196, v50
    v_mul_f32 v223, v196, v51
    v_fmac_f32 v112, v192, v216
    v_fmac_f32 v113, v192, v217
    v_fmac_f32 v114, v192, v218
    s_barrier
    s_add_u32 m0, s62, 131072
    s_nop 0
    buffer_load_dwordx4 v191, s[4:7], s94 offen offset:2048 lds
    v_fmac_f32 v115, v192, v219
    v_exp_f32 v220, v220
    v_exp_f32 v221, v221
    v_exp_f32 v222, v222
    buffer_load_dwordx4 v191, s[4:7], s94 offen offset:3072 lds
    s_add_u32 s94, s94, 49152
    s_and_b32 s94, s94, 262143
    v_exp_f32 v223, v223
    v_mul_f32 v48, v48, v112
    v_mul_f32 v49, v49, v113
    v_mul_f32 v50, v50, v114
    s_add_u32 m0, s61, 65536
    s_mul_i32 s59, s93, 112
    buffer_load_dwordx4 v236, s[24:27], s59 offen lds
    v_mul_f32 v51, v51, v115
    v_fma_f32 v220, v220, v200, v200
    v_fma_f32 v221, v221, v200, v200
    v_fma_f32 v222, v222, v200, v200
    buffer_load_dwordx4 v237, s[24:27], s59 offen offset:1024 lds
    v_fma_f32 v223, v223, v200, v200
    v_rcp_f32 v220, v220
    v_rcp_f32 v221, v221
    v_rcp_f32 v222, v222
    buffer_load_dwordx4 v242, s[4:7], s93 offen offset:2048 lds
    s_add_u32 s93, s93, 2048
    s_and_b32 s93, s93, 65535
    v_rcp_f32 v223, v223
    v_mul_f32 v48, v48, v220
    v_mul_f32 v49, v49, v221
    v_mul_f32 v50, v50, v222
    s_waitcnt vmcnt(13)
    s_barrier
    s_cmp_lg_u32 s42, 0
    s_cbranch_scc1 wf_26
    s_lshr_b32 s55, s2, 5
    s_lshl_b32 s55, s55, 2
    s_add_u32 s55, s55, s0
    v_mov_b32 v252, 2048
    v_mov_b32 v253, 0x01010101
    s_mov_b64 exec, 1
    s_cmp_eq_u32 s45, 0
    s_cbranch_scc1 st_27
    buffer_store_dword v253, v252, s[4:7], s55 offen sc0 sc1
    s_branch st_28
st_27:
    buffer_store_dword v253, v252, s[4:7], s55 offen
st_28:
    s_mov_b64 exec, -1
wf_26:
    s_add_u32 m0, s62, 98304
    s_nop 0
    buffer_load_dwordx4 v191, s[4:7], s94 offen lds
    v_mul_f32 v51, v51, v223
    v_cvt_pk_bf16_f32 v226, v48, v49
    v_cvt_pk_bf16_f32 v227, v50, v51
    s_add_u32 s55, s89, 131072
    buffer_store_dwordx4 v[224:227], v254, s[4:7], s55 offen sc0 sc1
    buffer_load_dwordx4 v191, s[4:7], s94 offen offset:1024 lds
    v_fmac_f32 v36, v193, v204
    v_fmac_f32 v37, v193, v205
    v_fmac_f32 v38, v193, v206
    v_fmac_f32 v39, v193, v207
    s_add_u32 m0, s61, 81920
    s_mul_i32 s59, s93, 112
    buffer_load_dwordx4 v236, s[24:27], s59 offen lds
    v_mul_f32 v220, v197, v36
    v_mul_f32 v221, v197, v37
    v_mul_f32 v222, v197, v38
    v_mul_f32 v223, v197, v39
    buffer_load_dwordx4 v237, s[24:27], s59 offen offset:1024 lds
    v_fmac_f32 v100, v193, v208
    v_fmac_f32 v101, v193, v209
    v_fmac_f32 v102, v193, v210
    v_fmac_f32 v103, v193, v211
    buffer_load_dwordx4 v242, s[4:7], s93 offen offset:2048 lds
    s_add_u32 s93, s93, 6144
    s_and_b32 s93, s93, 65535
    v_exp_f32 v220, v220
    v_exp_f32 v221, v221
    v_exp_f32 v222, v222
    v_exp_f32 v223, v223
    v_mul_f32 v36, v36, v100
    s_barrier
    s_add_u32 m0, s62, 98304
    s_nop 0
    buffer_load_dwordx4 v191, s[4:7], s94 offen offset:2048 lds
    v_mul_f32 v37, v37, v101
    v_mul_f32 v38, v38, v102
    v_mul_f32 v39, v39, v103
    v_fma_f32 v220, v220, v201, v201
    buffer_load_dwordx4 v191, s[4:7], s94 offen offset:3072 lds
    s_add_u32 s94, s94, 32768
    s_and_b32 s94, s94, 262143
    v_fma_f32 v221, v221, v201, v201
    v_fma_f32 v222, v222, v201, v201
    v_fma_f32 v223, v223, v201, v201
    v_rcp_f32 v220, v220
    v_rcp_f32 v221, v221
    s_add_u32 m0, s61, 0
    s_mul_i32 s59, s93, 112
    buffer_load_dwordx4 v236, s[24:27], s59 offen lds
    v_rcp_f32 v222, v222
    v_rcp_f32 v223, v223
    v_mul_f32 v36, v36, v220
    v_mul_f32 v37, v37, v221
    v_mul_f32 v38, v38, v222
    buffer_load_dwordx4 v237, s[24:27], s59 offen offset:1024 lds
    v_mul_f32 v39, v39, v223
    v_cvt_pk_bf16_f32 v228, v36, v37
    v_cvt_pk_bf16_f32 v229, v38, v39
    v_fmac_f32 v52, v193, v212
    v_fmac_f32 v53, v193, v213
    buffer_load_dwordx4 v242, s[4:7], s93 offen offset:2048 lds
    s_add_u32 s93, s93, 2048
    s_and_b32 s93, s93, 65535
    v_fmac_f32 v54, v193, v214
    v_fmac_f32 v55, v193, v215
    v_mul_f32 v220, v197, v52
    v_mul_f32 v221, v197, v53
    v_mul_f32 v222, v197, v54
    s_waitcnt vmcnt(14)
    s_barrier
    s_add_u32 m0, s62, 114688
    s_nop 0
    buffer_load_dwordx4 v191, s[4:7], s94 offen lds
    v_mul_f32 v223, v197, v55
    v_fmac_f32 v116, v193, v216
    v_fmac_f32 v117, v193, v217
    v_fmac_f32 v118, v193, v218
    buffer_load_dwordx4 v191, s[4:7], s94 offen offset:1024 lds
    v_fmac_f32 v119, v193, v219
    v_exp_f32 v220, v220
    v_exp_f32 v221, v221
    v_exp_f32 v222, v222
    s_add_u32 m0, s61, 16384
    s_mul_i32 s59, s93, 112
    buffer_load_dwordx4 v236, s[24:27], s59 offen lds
    v_exp_f32 v223, v223
    v_mul_f32 v52, v52, v116
    v_mul_f32 v53, v53, v117
    v_mul_f32 v54, v54, v118
    buffer_load_dwordx4 v237, s[24:27], s59 offen offset:1024 lds
    v_mul_f32 v55, v55, v119
    v_fma_f32 v220, v220, v201, v201
    v_fma_f32 v221, v221, v201, v201
    v_fma_f32 v222, v222, v201, v201
    buffer_load_dwordx4 v242, s[4:7], s93 offen offset:2048 lds
    s_add_u32 s93, s93, 6144
    s_and_b32 s93, s93, 65535
    v_fma_f32 v223, v223, v201, v201
    v_rcp_f32 v220, v220
    v_rcp_f32 v221, v221
    v_rcp_f32 v222, v222
    s_barrier
    s_add_u32 m0, s62, 114688
    s_nop 0
    buffer_load_dwordx4 v191, s[4:7], s94 offen offset:2048 lds
    v_rcp_f32 v223, v223
    v_mul_f32 v52, v52, v220
    v_mul_f32 v53, v53, v221
    v_mul_f32 v54, v54, v222
    buffer_load_dwordx4 v191, s[4:7], s94 offen offset:3072 lds
    s_add_u32 s94, s94, 32768
    s_and_b32 s94, s94, 262143
    v_mul_f32 v55, v55, v223
    v_cvt_pk_bf16_f32 v230, v52, v53
    v_cvt_pk_bf16_f32 v231, v54, v55
    s_add_u32 s55, s89, 133120
    buffer_store_dwordx4 v[228:231], v254, s[4:7], s55 offen sc0 sc1
    s_add_u32 m0, s61, 32768
    s_mul_i32 s59, s93, 112
    buffer_load_dwordx4 v236, s[24:27], s59 offen lds
    v_fmac_f32 v40, v194, v204
    v_fmac_f32 v41, v194, v205
    v_fmac_f32 v42, v194, v206
    v_fmac_f32 v43, v194, v207
    v_mul_f32 v220, v198, v40
    buffer_load_dwordx4 v237, s[24:27], s59 offen offset:1024 lds
    v_mul_f32 v221, v198, v41
    v_mul_f32 v222, v198, v42
    v_mul_f32 v223, v198, v43
    v_fmac_f32 v104, v194, v208
    buffer_load_dwordx4 v242, s[4:7], s93 offen offset:2048 lds
    s_add_u32 s93, s93, 2048
    s_and_b32 s93, s93, 65535
    v_fmac_f32 v105, v194, v209
    v_fmac_f32 v106, v194, v210
    v_fmac_f32 v107, v194, v211
    v_exp_f32 v220, v220
    v_exp_f32 v221, v221
    s_waitcnt vmcnt(14)
    s_barrier
    s_mov_b32 s55, 71568384
    buffer_load_dwordx4 v[184:187], v254, s[4:7], s55 offen sc0 sc1
    s_add_u32 m0, s62, 131072
    s_nop 0
    buffer_load_dwordx4 v191, s[4:7], s94 offen lds
    v_exp_f32 v222, v222
    v_exp_f32 v223, v223
    v_mul_f32 v40, v40, v104
    v_mul_f32 v41, v41, v105
    buffer_load_dwordx4 v191, s[4:7], s94 offen offset:1024 lds
    v_mul_f32 v42, v42, v106
    v_mul_f32 v43, v43, v107
    v_fma_f32 v220, v220, v202, v202
    v_fma_f32 v221, v221, v202, v202
    s_add_u32 m0, s61, 49152
    s_mul_i32 s59, s93, 112
    buffer_load_dwordx4 v236, s[24:27], s59 offen lds
    v_fma_f32 v222, v222, v202, v202
    v_fma_f32 v223, v223, v202, v202
    v_rcp_f32 v220, v220
    v_rcp_f32 v221, v221
    v_rcp_f32 v222, v222
    buffer_load_dwordx4 v237, s[24:27], s59 offen offset:1024 lds
    v_rcp_f32 v223, v223
    v_mul_f32 v40, v40, v220
    v_mul_f32 v41, v41, v221
    v_mul_f32 v42, v42, v222
    buffer_load_dwordx4 v242, s[4:7], s93 offen offset:2048 lds
    s_add_u32 s93, s93, 6144
    s_and_b32 s93, s93, 65535
    v_mul_f32 v43, v43, v223
    v_cvt_pk_bf16_f32 v224, v40, v41
    v_cvt_pk_bf16_f32 v225, v42, v43
    v_fmac_f32 v56, v194, v212
    v_fmac_f32 v57, v194, v213
    s_barrier
    s_add_u32 m0, s62, 131072
    s_nop 0
    buffer_load_dwordx4 v191, s[4:7], s94 offen offset:2048 lds
    v_fmac_f32 v58, v194, v214
    v_fmac_f32 v59, v194, v215
    v_mul_f32 v220, v198, v56
    v_mul_f32 v221, v198, v57
    buffer_load_dwordx4 v191, s[4:7], s94 offen offset:3072 lds
    s_add_u32 s94, s94, 32768
    s_and_b32 s94, s94, 262143
    v_mul_f32 v222, v198, v58
    v_mul_f32 v223, v198, v59
    v_fmac_f32 v120, v194, v216
    v_fmac_f32 v121, v194, v217
    v_fmac_f32 v122, v194, v218
    s_add_u32 m0, s61, 65536
    s_mul_i32 s59, s93, 112
    buffer_load_dwordx4 v236, s[24:27], s59 offen lds
    v_fmac_f32 v123, v194, v219
    v_exp_f32 v220, v220
    v_exp_f32 v221, v221
    v_exp_f32 v222, v222
    buffer_load_dwordx4 v237, s[24:27], s59 offen offset:1024 lds
    v_exp_f32 v223, v223
    v_mul_f32 v56, v56, v120
    v_mul_f32 v57, v57, v121
    v_mul_f32 v58, v58, v122
    v_mul_f32 v59, v59, v123
    buffer_load_dwordx4 v242, s[4:7], s93 offen offset:2048 lds
    s_add_u32 s93, s93, 2048
    s_and_b32 s93, s93, 65535
    v_fma_f32 v220, v220, v202, v202
    v_fma_f32 v221, v221, v202, v202
    v_fma_f32 v222, v222, v202, v202
    v_fma_f32 v223, v223, v202, v202
    v_rcp_f32 v220, v220
    s_waitcnt vmcnt(15)
    s_barrier
    s_add_u32 m0, s62, 98304
    s_nop 0
    buffer_load_dwordx4 v191, s[4:7], s94 offen lds
    v_rcp_f32 v221, v221
    v_rcp_f32 v222, v222
    v_rcp_f32 v223, v223
    v_mul_f32 v56, v56, v220
    buffer_load_dwordx4 v191, s[4:7], s94 offen offset:1024 lds
    v_mul_f32 v57, v57, v221
    v_mul_f32 v58, v58, v222
    v_mul_f32 v59, v59, v223
    v_cvt_pk_bf16_f32 v226, v56, v57
    s_add_u32 m0, s61, 81920
    s_mul_i32 s59, s93, 112
    buffer_load_dwordx4 v236, s[24:27], s59 offen lds
    v_cvt_pk_bf16_f32 v227, v58, v59
    s_add_u32 s55, s89, 135168
    buffer_store_dwordx4 v[224:227], v254, s[4:7], s55 offen sc0 sc1
    v_fmac_f32 v44, v195, v204
    v_fmac_f32 v45, v195, v205
    v_fmac_f32 v46, v195, v206
    buffer_load_dwordx4 v237, s[24:27], s59 offen offset:1024 lds
    v_fmac_f32 v47, v195, v207
    v_mul_f32 v220, v199, v44
    v_mul_f32 v221, v199, v45
    v_mul_f32 v222, v199, v46
    buffer_load_dwordx4 v242, s[4:7], s93 offen offset:2048 lds
    s_add_u32 s93, s93, 6144
    s_and_b32 s93, s93, 65535
    v_mul_f32 v223, v199, v47
    v_fmac_f32 v108, v195, v208
    v_fmac_f32 v109, v195, v209
    v_fmac_f32 v110, v195, v210
    v_fmac_f32 v111, v195, v211
    s_barrier
    s_waitcnt vmcnt(16)
    s_cmp_eq_u32 s46, 1
    s_cbranch_scc1 a4_29
    v_and_b32 v184, v184, v185
    v_and_b32 v186, v186, v187
    v_and_b32 v184, v184, v186
    v_cmp_ne_u32 vcc, 1, v184
    s_cbranch_vccz a4_29
    s_mov_b32 s55, 71568384
    s_mov_b32 s56, 262144
p4_30:
    buffer_load_dwordx4 v[184:187], v254, s[4:7], s55 offen sc0 sc1
    s_waitcnt vmcnt(0)
    v_and_b32 v184, v184, v185
    v_and_b32 v186, v186, v187
    v_and_b32 v184, v184, v186
    v_cmp_ne_u32 vcc, 1, v184
    s_cbranch_vccz p4_31
    s_sleep 1
    s_sub_u32 s56, s56, 1
    s_cmp_lg_u32 s56, 0
    s_cbranch_scc1 p4_30
p4_31:
a4_29:
    s_add_u32 m0, s62, 98304
    s_nop 0
    buffer_load_dwordx4 v191, s[4:7], s94 offen offset:2048 lds
    v_exp_f32 v220, v220
    v_exp_f32 v221, v221
    v_exp_f32 v222, v222
    v_exp_f32 v223, v223
    buffer_load_dwordx4 v191, s[4:7], s94 offen offset:3072 lds
    s_add_u32 s94, s94, 32768
    s_and_b32 s94, s94, 262143
    v_mul_f32 v44, v44, v108
    v_mul_f32 v45, v45, v109
    v_mul_f32 v46, v46, v110
    v_mul_f32 v47, v47, v111
    s_add_u32 m0, s61, 0
    s_mul_i32 s59, s93, 112
    buffer_load_dwordx4 v236, s[24:27], s59 offen lds
    v_fma_f32 v220, v220, v203, v203
    v_fma_f32 v221, v221, v203, v203
    v_fma_f32 v222, v222, v203, v203
    v_fma_f32 v223, v223, v203, v203
    buffer_load_dwordx4 v237, s[24:27], s59 offen offset:1024 lds
    v_rcp_f32 v220, v220
    v_rcp_f32 v221, v221
    v_rcp_f32 v222, v222
    v_rcp_f32 v223, v223
    buffer_load_dwordx4 v242, s[4:7], s93 offen offset:2048 lds
    s_add_u32 s93, s93, 2048
    s_and_b32 s93, s93, 65535
    v_mul_f32 v44, v44, v220
    v_mul_f32 v45, v45, v221
    v_mul_f32 v46, v46, v222
    v_mul_f32 v47, v47, v223
    s_waitcnt vmcnt(14)
    s_barrier
    v_lshrrev_b32 v252, 2, v254
    v_min_u32 v252, 28, v252
    s_add_u32 s55, s0, 2048
    buffer_load_dword v232, v252, s[4:7], s55 offen sc0 sc1
    s_add_u32 m0, s62, 114688
    s_nop 0
    buffer_load_dwordx4 v191, s[4:7], s94 offen lds
    v_cvt_pk_bf16_f32 v228, v44, v45
    v_cvt_pk_bf16_f32 v229, v46, v47
    v_fmac_f32 v60, v195, v212
    v_fmac_f32 v61, v195, v213
    buffer_load_dwordx4 v191, s[4:7], s94 offen offset:1024 lds
    v_fmac_f32 v62, v195, v214
    v_fmac_f32 v63, v195, v215
    v_mul_f32 v220, v199, v60
    v_mul_f32 v221, v199, v61
    v_mul_f32 v222, v199, v62
    s_add_u32 m0, s61, 16384
    s_mul_i32 s59, s93, 112
    buffer_load_dwordx4 v236, s[24:27], s59 offen lds
    v_mul_f32 v223, v199, v63
    v_fmac_f32 v124, v195, v216
    v_fmac_f32 v125, v195, v217
    v_fmac_f32 v126, v195, v218
    v_fmac_f32 v127, v195, v219
    buffer_load_dwordx4 v237, s[24:27], s59 offen offset:1024 lds
    v_exp_f32 v220, v220
    v_exp_f32 v221, v221
    v_exp_f32 v222, v222
    v_exp_f32 v223, v223
    v_mul_f32 v60, v60, v124
    buffer_load_dwordx4 v242, s[4:7], s93 offen offset:2048 lds
    v_mul_f32 v61, v61, v125
    v_mul_f32 v62, v62, v126
    v_mul_f32 v63, v63, v127
    v_fma_f32 v220, v220, v203, v203
    v_fma_f32 v221, v221, v203, v203
    s_barrier
    s_add_u32 m0, s62, 114688
    s_nop 0
    buffer_load_dwordx4 v191, s[4:7], s94 offen offset:2048 lds
    v_fma_f32 v222, v222, v203, v203
    v_fma_f32 v223, v223, v203, v203
    buffer_load_dwordx4 v191, s[4:7], s94 offen offset:3072 lds
    v_rcp_f32 v220, v220
    v_rcp_f32 v221, v221
    s_add_u32 m0, s62, 32768
    s_add_u32 s59, s68, 0
    buffer_load_dwordx4 v238, s[20:23], s59 offen lds
    v_rcp_f32 v222, v222
    v_rcp_f32 v223, v223
    buffer_load_dwordx4 v239, s[20:23], s59 offen offset:1024 lds
    v_mul_f32 v60, v60, v220
    v_mul_f32 v61, v61, v221
    buffer_load_dwordx4 v240, s[20:23], s59 offen offset:2048 lds
    v_mul_f32 v62, v62, v222
    v_mul_f32 v63, v63, v223
    buffer_load_dwordx4 v241, s[20:23], s59 offen offset:3072 lds
    v_cvt_pk_bf16_f32 v230, v60, v61
    v_cvt_pk_bf16_f32 v231, v62, v63
    s_add_u32 s55, s89, 137216
    buffer_store_dwordx4 v[228:231], v254, s[4:7], s55 offen sc0 sc1
    s_waitcnt vmcnt(16)
    s_barrier
    s_waitcnt vmcnt(12)
    v_cmp_ne_u32 vcc, 0x01010101, v232
    s_cbranch_vccz ap_32
    v_lshrrev_b32 v252, 2, v254
    v_min_u32 v252, 28, v252
    s_add_u32 s55, s0, 2048
    s_mov_b32 s56, 262144
poll_33:
    buffer_load_dword v253, v252, s[4:7], s55 offen sc0 sc1
    s_waitcnt vmcnt(0)
    v_cmp_ne_u32 vcc, 0x01010101, v253
    s_cbranch_vccz pd_34
    s_sleep 1
    s_sub_u32 s56, s56, 1
    s_cmp_lg_u32 s56, 0
    s_cbranch_scc1 poll_33
pd_34:
ap_32:
    s_add_u32 s88, s95, s62
    v_add_u32 v191, s88, v254
    s_add_u32 m0, s62, 131072
    s_mov_b32 s92, 0
    buffer_load_dwordx4 v191, s[4:7], s92 offen lds
    buffer_load_dwordx4 v191, s[4:7], s92 offen offset:1024 lds
    s_add_u32 m0, s62, 49152
    s_add_u32 s59, s68, 655360
    buffer_load_dwordx4 v238, s[20:23], s59 offen lds
    buffer_load_dwordx4 v239, s[20:23], s59 offen offset:1024 lds
    buffer_load_dwordx4 v240, s[20:23], s59 offen offset:2048 lds
    buffer_load_dwordx4 v241, s[20:23], s59 offen offset:3072 lds
    s_barrier
    s_add_u32 m0, s62, 131072
    s_mov_b32 s92, 0
    buffer_load_dwordx4 v191, s[4:7], s92 offen offset:2048 lds
    buffer_load_dwordx4 v191, s[4:7], s92 offen offset:3072 lds
    s_add_u32 m0, s62, 65536
    s_add_u32 s59, s68, 917504
    buffer_load_dwordx4 v238, s[20:23], s59 offen lds
    buffer_load_dwordx4 v239, s[20:23], s59 offen offset:1024 lds
    buffer_load_dwordx4 v240, s[20:23], s59 offen offset:2048 lds
    buffer_load_dwordx4 v241, s[20:23], s59 offen offset:3072 lds
    s_waitcnt vmcnt(17)
    s_barrier
    s_add_u32 m0, s62, 98304
    s_mov_b32 s92, 16384
    buffer_load_dwordx4 v191, s[4:7], s92 offen lds
    buffer_load_dwordx4 v191, s[4:7], s92 offen offset:1024 lds
    s_add_u32 m0, s62, 81920
    s_add_u32 s59, s68, 1572864
    buffer_load_dwordx4 v238, s[20:23], s59 offen lds
    buffer_load_dwordx4 v239, s[20:23], s59 offen offset:1024 lds
    buffer_load_dwordx4 v240, s[20:23], s59 offen offset:2048 lds
    buffer_load_dwordx4 v241, s[20:23], s59 offen offset:3072 lds
    s_waitcnt vmcnt(18)
    s_barrier
    s_cmp_lg_u32 s42, 1
    s_cbranch_scc1 wf_35
    s_lshr_b32 s55, s2, 5
    s_lshl_b32 s55, s55, 2
    s_add_u32 s55, s55, s0
    v_mov_b32 v252, 2080
    v_mov_b32 v253, 0x01010101
    s_mov_b64 exec, 1
    s_cmp_eq_u32 s45, 0
    s_cbranch_scc1 st_36
    buffer_store_dword v253, v252, s[4:7], s55 offen sc0 sc1
    s_branch st_37
st_36:
    buffer_store_dword v253, v252, s[4:7], s55 offen
st_37:
    s_mov_b64 exec, -1
wf_35:
    s_add_u32 m0, s62, 98304
    s_mov_b32 s92, 16384
    buffer_load_dwordx4 v191, s[4:7], s92 offen offset:2048 lds
    buffer_load_dwordx4 v191, s[4:7], s92 offen offset:3072 lds
    s_add_u32 m0, s62, 0
    s_add_u32 s59, s68, 1835008
    buffer_load_dwordx4 v238, s[20:23], s59 offen lds
    buffer_load_dwordx4 v239, s[20:23], s59 offen offset:1024 lds
    buffer_load_dwordx4 v240, s[20:23], s59 offen offset:2048 lds
    buffer_load_dwordx4 v241, s[20:23], s59 offen offset:3072 lds
    s_waitcnt vmcnt(16)
    s_barrier
    ds_read_b64_tr_b16 v[32:33], v244 offset:32768
    ds_read_b64_tr_b16 v[34:35], v244 offset:36864
    ds_read_b128 v[0:3], v243 offset:32768
    ds_read_b128 v[4:7], v243 offset:34816
    ds_read_b128 v[8:11], v243 offset:36864
    ds_read_b128 v[12:15], v243 offset:38912
    ds_read_b64_tr_b16 v[36:37], v245 offset:32768
    ds_read_b64_tr_b16 v[38:39], v245 offset:36864
    ds_read_b64_tr_b16 v[40:41], v246 offset:32768
    ds_read_b64_tr_b16 v[42:43], v246 offset:36864
    ds_read_b64_tr_b16 v[44:45], v247 offset:32768
    ds_read_b64_tr_b16 v[46:47], v247 offset:36864
    ds_read_b64_tr_b16 v[48:49], v244 offset:40960
    ds_read_b64_tr_b16 v[50:51], v244 offset:45056
    ds_read_b128 v[16:19], v243 offset:33792
    ds_read_b128 v[20:23], v243 offset:35840
    ds_read_b128 v[24:27], v243 offset:37888
    ds_read_b128 v[28:31], v243 offset:39936
    ds_read_b64_tr_b16 v[52:53], v245 offset:40960
    ds_read_b64_tr_b16 v[54:55], v245 offset:45056
    ds_read_b64_tr_b16 v[56:57], v246 offset:40960
    ds_read_b64_tr_b16 v[58:59], v246 offset:45056
    ds_read_b64_tr_b16 v[60:61], v247 offset:40960
    ds_read_b64_tr_b16 v[62:63], v247 offset:45056
    s_add_u32 m0, s62, 114688
    s_mov_b32 s92, 32768
    buffer_load_dwordx4 v191, s[4:7], s92 offen lds
    buffer_load_dwordx4 v191, s[4:7], s92 offen offset:1024 lds
    buffer_load_dwordx4 v191, s[4:7], s92 offen offset:2048 lds
    buffer_load_dwordx4 v191, s[4:7], s92 offen offset:3072 lds
    s_setprio 0
    s_lshl_b32 s55, s51, 14
    s_add_u32 s55, s55, s62
    s_add_u32 s55, s55, s47
    s_add_u32 s88, s55, 1310720
    s_xor_b32 s89, s88, 16384
    s_add_u32 s59, s1, s49
    s_add_u32 s60, s59, 4096
    s_mov_b32 s58, 4
    s_waitcnt vmcnt(8) lgkmcnt(0)
    s_barrier
    .p2align 3
    v_mfma_f32_16x16x32_bf16 v[128:131], v[32:35], v[0:3], 0
    ds_read_b64_tr_b16 v[96:97], v248 offset:0
    v_mfma_f32_16x16x32_bf16 v[128:131], v[48:51], v[16:19], v[128:131]
    ds_read_b64_tr_b16 v[98:99], v248 offset:4096
    v_mfma_f32_16x16x32_bf16 v[132:135], v[48:51], v[20:23], 0
    ds_read_b128 v[64:67], v243 offset:0
    v_mfma_f32_16x16x32_bf16 v[132:135], v[32:35], v[4:7], v[132:135]
    ds_read_b128 v[68:71], v243 offset:2048
    v_mfma_f32_16x16x32_bf16 v[136:139], v[32:35], v[8:11], 0
    ds_read_b128 v[72:75], v243 offset:4096
    v_mfma_f32_16x16x32_bf16 v[136:139], v[48:51], v[24:27], v[136:139]
    ds_read_b128 v[76:79], v243 offset:6144
    v_mfma_f32_16x16x32_bf16 v[140:143], v[48:51], v[28:31], 0
    ds_read_b64_tr_b16 v[100:101], v249 offset:0
    v_mfma_f32_16x16x32_bf16 v[140:143], v[32:35], v[12:15], v[140:143]
    ds_read_b64_tr_b16 v[102:103], v249 offset:4096
    v_mfma_f32_16x16x32_bf16 v[156:159], v[36:39], v[12:15], 0
    v_mfma_f32_16x16x32_bf16 v[156:159], v[52:55], v[28:31], v[156:159]
    ds_read_b64_tr_b16 v[104:105], v250 offset:0
    v_mfma_f32_16x16x32_bf16 v[152:155], v[52:55], v[24:27], 0
    ds_read_b64_tr_b16 v[106:107], v250 offset:4096
    v_mfma_f32_16x16x32_bf16 v[152:155], v[36:39], v[8:11], v[152:155]
    ds_read_b64_tr_b16 v[108:109], v251 offset:0
    v_mfma_f32_16x16x32_bf16 v[148:151], v[36:39], v[4:7], 0
    ds_read_b64_tr_b16 v[110:111], v251 offset:4096
    v_mfma_f32_16x16x32_bf16 v[148:151], v[52:55], v[20:23], v[148:151]
    ds_read_b64_tr_b16 v[112:113], v248 offset:8192
    v_mfma_f32_16x16x32_bf16 v[144:147], v[52:55], v[16:19], 0
    ds_read_b64_tr_b16 v[114:115], v248 offset:12288
    v_mfma_f32_16x16x32_bf16 v[144:147], v[36:39], v[0:3], v[144:147]
    ds_read_b128 v[80:83], v243 offset:1024
    v_mfma_f32_16x16x32_bf16 v[160:163], v[40:43], v[0:3], 0
    ds_read_b128 v[84:87], v243 offset:3072
    v_mfma_f32_16x16x32_bf16 v[160:163], v[56:59], v[16:19], v[160:163]
    v_mfma_f32_16x16x32_bf16 v[164:167], v[56:59], v[20:23], 0
    ds_read_b128 v[88:91], v243 offset:5120
    v_mfma_f32_16x16x32_bf16 v[164:167], v[40:43], v[4:7], v[164:167]
    ds_read_b128 v[92:95], v243 offset:7168
    v_mfma_f32_16x16x32_bf16 v[168:171], v[40:43], v[8:11], 0
    ds_read_b64_tr_b16 v[116:117], v249 offset:8192
    v_mfma_f32_16x16x32_bf16 v[168:171], v[56:59], v[24:27], v[168:171]
    ds_read_b64_tr_b16 v[118:119], v249 offset:12288
    v_mfma_f32_16x16x32_bf16 v[172:175], v[56:59], v[28:31], 0
    ds_read_b64_tr_b16 v[120:121], v250 offset:8192
    v_mfma_f32_16x16x32_bf16 v[172:175], v[40:43], v[12:15], v[172:175]
    ds_read_b64_tr_b16 v[122:123], v250 offset:12288
    v_mfma_f32_16x16x32_bf16 v[188:191], v[44:47], v[12:15], 0
    ds_read_b64_tr_b16 v[124:125], v251 offset:8192
    v_mfma_f32_16x16x32_bf16 v[188:191], v[60:63], v[28:31], v[188:191]
    ds_read_b64_tr_b16 v[126:127], v251 offset:12288
    v_mfma_f32_16x16x32_bf16 v[184:187], v[60:63], v[24:27], 0
    v_mfma_f32_16x16x32_bf16 v[184:187], v[44:47], v[8:11], v[184:187]
    v_mfma_f32_16x16x32_bf16 v[180:183], v[44:47], v[4:7], 0
    v_mfma_f32_16x16x32_bf16 v[180:183], v[60:63], v[20:23], v[180:183]
    v_mfma_f32_16x16x32_bf16 v[176:179], v[60:63], v[16:19], 0
    v_mfma_f32_16x16x32_bf16 v[176:179], v[44:47], v[0:3], v[176:179]
    .p2align 3
loop_38:
    s_waitcnt vmcnt(0) lgkmcnt(0)
    s_barrier
    .p2align 3
    v_mfma_f32_16x16x32_bf16 v[128:131], v[96:99], v[64:67], v[128:131]
    ds_read_b64_tr_b16 v[32:33], v248 offset:16384
    v_mfma_f32_16x16x32_bf16 v[128:131], v[112:115], v[80:83], v[128:131]
    ds_read_b64_tr_b16 v[34:35], v248 offset:20480
    v_mfma_f32_16x16x32_bf16 v[132:135], v[112:115], v[84:87], v[132:135]
    ds_read_b128 v[0:3], v243 offset:16384
    v_mfma_f32_16x16x32_bf16 v[132:135], v[96:99], v[68:71], v[132:135]
    ds_read_b128 v[4:7], v243 offset:18432
    v_mfma_f32_16x16x32_bf16 v[136:139], v[96:99], v[72:75], v[136:139]
    ds_read_b128 v[8:11], v243 offset:20480
    v_mfma_f32_16x16x32_bf16 v[136:139], v[112:115], v[88:91], v[136:139]
    ds_read_b128 v[12:15], v243 offset:22528
    v_mfma_f32_16x16x32_bf16 v[140:143], v[112:115], v[92:95], v[140:143]
    ds_read_b64_tr_b16 v[36:37], v249 offset:16384
    v_mfma_f32_16x16x32_bf16 v[140:143], v[96:99], v[76:79], v[140:143]
    ds_read_b64_tr_b16 v[38:39], v249 offset:20480
    v_mfma_f32_16x16x32_bf16 v[156:159], v[100:103], v[76:79], v[156:159]
    v_mfma_f32_16x16x32_bf16 v[156:159], v[116:119], v[92:95], v[156:159]
    ds_read_b64_tr_b16 v[40:41], v250 offset:16384
    v_mfma_f32_16x16x32_bf16 v[152:155], v[116:119], v[88:91], v[152:155]
    ds_read_b64_tr_b16 v[42:43], v250 offset:20480
    v_mfma_f32_16x16x32_bf16 v[152:155], v[100:103], v[72:75], v[152:155]
    ds_read_b64_tr_b16 v[44:45], v251 offset:16384
    v_mfma_f32_16x16x32_bf16 v[148:151], v[100:103], v[68:71], v[148:151]
    ds_read_b64_tr_b16 v[46:47], v251 offset:20480
    v_mfma_f32_16x16x32_bf16 v[148:151], v[116:119], v[84:87], v[148:151]
    ds_read_b64_tr_b16 v[48:49], v248 offset:24576
    v_mfma_f32_16x16x32_bf16 v[144:147], v[116:119], v[80:83], v[144:147]
    ds_read_b64_tr_b16 v[50:51], v248 offset:28672
    v_mfma_f32_16x16x32_bf16 v[144:147], v[100:103], v[64:67], v[144:147]
    ds_read_b128 v[16:19], v243 offset:17408
    v_mfma_f32_16x16x32_bf16 v[160:163], v[104:107], v[64:67], v[160:163]
    ds_read_b128 v[20:23], v243 offset:19456
    v_mfma_f32_16x16x32_bf16 v[160:163], v[120:123], v[80:83], v[160:163]
    v_mfma_f32_16x16x32_bf16 v[164:167], v[120:123], v[84:87], v[164:167]
    ds_read_b128 v[24:27], v243 offset:21504
    v_mfma_f32_16x16x32_bf16 v[164:167], v[104:107], v[68:71], v[164:167]
    ds_read_b128 v[28:31], v243 offset:23552
    v_mfma_f32_16x16x32_bf16 v[168:171], v[104:107], v[72:75], v[168:171]
    ds_read_b64_tr_b16 v[52:53], v249 offset:24576
    v_mfma_f32_16x16x32_bf16 v[168:171], v[120:123], v[88:91], v[168:171]
    ds_read_b64_tr_b16 v[54:55], v249 offset:28672
    v_mfma_f32_16x16x32_bf16 v[172:175], v[120:123], v[92:95], v[172:175]
    ds_read_b64_tr_b16 v[56:57], v250 offset:24576
    v_mfma_f32_16x16x32_bf16 v[172:175], v[104:107], v[76:79], v[172:175]
    ds_read_b64_tr_b16 v[58:59], v250 offset:28672
    v_mfma_f32_16x16x32_bf16 v[188:191], v[108:111], v[76:79], v[188:191]
    ds_read_b64_tr_b16 v[60:61], v251 offset:24576
    v_mfma_f32_16x16x32_bf16 v[188:191], v[124:127], v[92:95], v[188:191]
    ds_read_b64_tr_b16 v[62:63], v251 offset:28672
    v_mfma_f32_16x16x32_bf16 v[184:187], v[124:127], v[88:91], v[184:187]
    v_mfma_f32_16x16x32_bf16 v[184:187], v[108:111], v[72:75], v[184:187]
    v_mfma_f32_16x16x32_bf16 v[180:183], v[108:111], v[68:71], v[180:183]
    v_mfma_f32_16x16x32_bf16 v[180:183], v[124:127], v[84:87], v[180:183]
    v_mfma_f32_16x16x32_bf16 v[176:179], v[124:127], v[80:83], v[176:179]
    v_mfma_f32_16x16x32_bf16 v[176:179], v[108:111], v[64:67], v[176:179]
    s_waitcnt lgkmcnt(0)
    s_barrier
    .p2align 3
    v_mfma_f32_16x16x32_bf16 v[128:131], v[32:35], v[0:3], v[128:131]
    ds_read_b64_tr_b16 v[96:97], v248 offset:32768
    v_mfma_f32_16x16x32_bf16 v[128:131], v[48:51], v[16:19], v[128:131]
    ds_read_b64_tr_b16 v[98:99], v248 offset:36864
    v_mfma_f32_16x16x32_bf16 v[132:135], v[48:51], v[20:23], v[132:135]
    ds_read_b128 v[64:67], v243 offset:32768
    v_mfma_f32_16x16x32_bf16 v[132:135], v[32:35], v[4:7], v[132:135]
    ds_read_b128 v[68:71], v243 offset:34816
    v_mfma_f32_16x16x32_bf16 v[136:139], v[32:35], v[8:11], v[136:139]
    ds_read_b128 v[72:75], v243 offset:36864
    v_mfma_f32_16x16x32_bf16 v[136:139], v[48:51], v[24:27], v[136:139]
    ds_read_b128 v[76:79], v243 offset:38912
    v_mfma_f32_16x16x32_bf16 v[140:143], v[48:51], v[28:31], v[140:143]
    ds_read_b64_tr_b16 v[100:101], v249 offset:32768
    v_mfma_f32_16x16x32_bf16 v[140:143], v[32:35], v[12:15], v[140:143]
    ds_read_b64_tr_b16 v[102:103], v249 offset:36864
    v_mfma_f32_16x16x32_bf16 v[156:159], v[36:39], v[12:15], v[156:159]
    v_mfma_f32_16x16x32_bf16 v[156:159], v[52:55], v[28:31], v[156:159]
    ds_read_b64_tr_b16 v[104:105], v250 offset:32768
    v_mfma_f32_16x16x32_bf16 v[152:155], v[52:55], v[24:27], v[152:155]
    ds_read_b64_tr_b16 v[106:107], v250 offset:36864
    v_mfma_f32_16x16x32_bf16 v[152:155], v[36:39], v[8:11], v[152:155]
    ds_read_b64_tr_b16 v[108:109], v251 offset:32768
    v_mfma_f32_16x16x32_bf16 v[148:151], v[36:39], v[4:7], v[148:151]
    ds_read_b64_tr_b16 v[110:111], v251 offset:36864
    v_mfma_f32_16x16x32_bf16 v[148:151], v[52:55], v[20:23], v[148:151]
    ds_read_b64_tr_b16 v[112:113], v248 offset:40960
    v_mfma_f32_16x16x32_bf16 v[144:147], v[52:55], v[16:19], v[144:147]
    ds_read_b64_tr_b16 v[114:115], v248 offset:45056
    v_mfma_f32_16x16x32_bf16 v[144:147], v[36:39], v[0:3], v[144:147]
    ds_read_b128 v[80:83], v243 offset:33792
    v_mfma_f32_16x16x32_bf16 v[160:163], v[40:43], v[0:3], v[160:163]
    ds_read_b128 v[84:87], v243 offset:35840
    v_mfma_f32_16x16x32_bf16 v[160:163], v[56:59], v[16:19], v[160:163]
    v_mfma_f32_16x16x32_bf16 v[164:167], v[56:59], v[20:23], v[164:167]
    ds_read_b128 v[88:91], v243 offset:37888
    v_mfma_f32_16x16x32_bf16 v[164:167], v[40:43], v[4:7], v[164:167]
    ds_read_b128 v[92:95], v243 offset:39936
    v_mfma_f32_16x16x32_bf16 v[168:171], v[40:43], v[8:11], v[168:171]
    ds_read_b64_tr_b16 v[116:117], v249 offset:40960
    v_mfma_f32_16x16x32_bf16 v[168:171], v[56:59], v[24:27], v[168:171]
    ds_read_b64_tr_b16 v[118:119], v249 offset:45056
    v_mfma_f32_16x16x32_bf16 v[172:175], v[56:59], v[28:31], v[172:175]
    ds_read_b64_tr_b16 v[120:121], v250 offset:40960
    v_mfma_f32_16x16x32_bf16 v[172:175], v[40:43], v[12:15], v[172:175]
    ds_read_b64_tr_b16 v[122:123], v250 offset:45056
    v_mfma_f32_16x16x32_bf16 v[188:191], v[44:47], v[12:15], v[188:191]
    ds_read_b64_tr_b16 v[124:125], v251 offset:40960
    v_mfma_f32_16x16x32_bf16 v[188:191], v[60:63], v[28:31], v[188:191]
    ds_read_b64_tr_b16 v[126:127], v251 offset:45056
    v_mfma_f32_16x16x32_bf16 v[184:187], v[60:63], v[24:27], v[184:187]
    v_mfma_f32_16x16x32_bf16 v[184:187], v[44:47], v[8:11], v[184:187]
    v_mfma_f32_16x16x32_bf16 v[180:183], v[44:47], v[4:7], v[180:183]
    v_mfma_f32_16x16x32_bf16 v[180:183], v[60:63], v[20:23], v[180:183]
    v_mfma_f32_16x16x32_bf16 v[176:179], v[60:63], v[16:19], v[176:179]
    v_mfma_f32_16x16x32_bf16 v[176:179], v[44:47], v[0:3], v[176:179]
    s_waitcnt lgkmcnt(0)
    s_barrier
    .p2align 3
    v_mfma_f32_16x16x32_bf16 v[128:131], v[96:99], v[64:67], v[128:131]
    ds_read_b64_tr_b16 v[32:33], v244 offset:0
    v_mfma_f32_16x16x32_bf16 v[128:131], v[112:115], v[80:83], v[128:131]
    ds_read_b64_tr_b16 v[34:35], v244 offset:4096
    v_mfma_f32_16x16x32_bf16 v[132:135], v[112:115], v[84:87], v[132:135]
    ds_read_b128 v[0:3], v243 offset:0
    v_mfma_f32_16x16x32_bf16 v[132:135], v[96:99], v[68:71], v[132:135]
    ds_read_b128 v[4:7], v243 offset:2048
    v_mfma_f32_16x16x32_bf16 v[136:139], v[96:99], v[72:75], v[136:139]
    ds_read_b128 v[8:11], v243 offset:4096
    v_mfma_f32_16x16x32_bf16 v[136:139], v[112:115], v[88:91], v[136:139]
    ds_read_b128 v[12:15], v243 offset:6144
    v_mfma_f32_16x16x32_bf16 v[140:143], v[112:115], v[92:95], v[140:143]
    ds_read_b64_tr_b16 v[36:37], v245 offset:0
    v_mfma_f32_16x16x32_bf16 v[140:143], v[96:99], v[76:79], v[140:143]
    ds_read_b64_tr_b16 v[38:39], v245 offset:4096
    v_mfma_f32_16x16x32_bf16 v[156:159], v[100:103], v[76:79], v[156:159]
    v_mfma_f32_16x16x32_bf16 v[156:159], v[116:119], v[92:95], v[156:159]
    ds_read_b64_tr_b16 v[40:41], v246 offset:0
    v_mfma_f32_16x16x32_bf16 v[152:155], v[116:119], v[88:91], v[152:155]
    ds_read_b64_tr_b16 v[42:43], v246 offset:4096
    v_mfma_f32_16x16x32_bf16 v[152:155], v[100:103], v[72:75], v[152:155]
    ds_read_b64_tr_b16 v[44:45], v247 offset:0
    v_mfma_f32_16x16x32_bf16 v[148:151], v[100:103], v[68:71], v[148:151]
    ds_read_b64_tr_b16 v[46:47], v247 offset:4096
    v_mfma_f32_16x16x32_bf16 v[148:151], v[116:119], v[84:87], v[148:151]
    ds_read_b64_tr_b16 v[48:49], v244 offset:8192
    v_mfma_f32_16x16x32_bf16 v[144:147], v[116:119], v[80:83], v[144:147]
    ds_read_b64_tr_b16 v[50:51], v244 offset:12288
    v_mfma_f32_16x16x32_bf16 v[144:147], v[100:103], v[64:67], v[144:147]
    ds_read_b128 v[16:19], v243 offset:1024
    v_mfma_f32_16x16x32_bf16 v[160:163], v[104:107], v[64:67], v[160:163]
    ds_read_b128 v[20:23], v243 offset:3072
    v_mfma_f32_16x16x32_bf16 v[160:163], v[120:123], v[80:83], v[160:163]
    v_mfma_f32_16x16x32_bf16 v[164:167], v[120:123], v[84:87], v[164:167]
    ds_read_b128 v[24:27], v243 offset:5120
    v_mfma_f32_16x16x32_bf16 v[164:167], v[104:107], v[68:71], v[164:167]
    ds_read_b128 v[28:31], v243 offset:7168
    v_mfma_f32_16x16x32_bf16 v[168:171], v[104:107], v[72:75], v[168:171]
    ds_read_b64_tr_b16 v[52:53], v245 offset:8192
    v_mfma_f32_16x16x32_bf16 v[168:171], v[120:123], v[88:91], v[168:171]
    ds_read_b64_tr_b16 v[54:55], v245 offset:12288
    v_mfma_f32_16x16x32_bf16 v[172:175], v[120:123], v[92:95], v[172:175]
    ds_read_b64_tr_b16 v[56:57], v246 offset:8192
    v_mfma_f32_16x16x32_bf16 v[172:175], v[104:107], v[76:79], v[172:175]
    ds_read_b64_tr_b16 v[58:59], v246 offset:12288
    v_mfma_f32_16x16x32_bf16 v[188:191], v[108:111], v[76:79], v[188:191]
    ds_read_b64_tr_b16 v[60:61], v247 offset:8192
    v_mfma_f32_16x16x32_bf16 v[188:191], v[124:127], v[92:95], v[188:191]
    ds_read_b64_tr_b16 v[62:63], v247 offset:12288
    v_mfma_f32_16x16x32_bf16 v[184:187], v[124:127], v[88:91], v[184:187]
    v_mfma_f32_16x16x32_bf16 v[184:187], v[108:111], v[72:75], v[184:187]
    v_mfma_f32_16x16x32_bf16 v[180:183], v[108:111], v[68:71], v[180:183]
    v_mfma_f32_16x16x32_bf16 v[180:183], v[124:127], v[84:87], v[180:183]
    v_mfma_f32_16x16x32_bf16 v[176:179], v[124:127], v[80:83], v[176:179]
    v_mfma_f32_16x16x32_bf16 v[176:179], v[108:111], v[64:67], v[176:179]
    s_waitcnt lgkmcnt(0)
    s_barrier
    .p2align 3
    v_mfma_f32_16x16x32_bf16 v[128:131], v[32:35], v[0:3], v[128:131]
    ds_read_b64_tr_b16 v[96:97], v244 offset:16384
    v_mfma_f32_16x16x32_bf16 v[128:131], v[48:51], v[16:19], v[128:131]
    ds_read_b64_tr_b16 v[98:99], v244 offset:20480
    v_mfma_f32_16x16x32_bf16 v[132:135], v[48:51], v[20:23], v[132:135]
    ds_read_b128 v[64:67], v243 offset:16384
    v_mfma_f32_16x16x32_bf16 v[132:135], v[32:35], v[4:7], v[132:135]
    ds_read_b128 v[68:71], v243 offset:18432
    v_mfma_f32_16x16x32_bf16 v[136:139], v[32:35], v[8:11], v[136:139]
    ds_read_b128 v[72:75], v243 offset:20480
    v_mfma_f32_16x16x32_bf16 v[136:139], v[48:51], v[24:27], v[136:139]
    ds_read_b128 v[76:79], v243 offset:22528
    v_mfma_f32_16x16x32_bf16 v[140:143], v[48:51], v[28:31], v[140:143]
    ds_read_b64_tr_b16 v[100:101], v245 offset:16384
    v_mfma_f32_16x16x32_bf16 v[140:143], v[32:35], v[12:15], v[140:143]
    ds_read_b64_tr_b16 v[102:103], v245 offset:20480
    v_mfma_f32_16x16x32_bf16 v[156:159], v[36:39], v[12:15], v[156:159]
    v_mfma_f32_16x16x32_bf16 v[156:159], v[52:55], v[28:31], v[156:159]
    ds_read_b64_tr_b16 v[104:105], v246 offset:16384
    v_mfma_f32_16x16x32_bf16 v[152:155], v[52:55], v[24:27], v[152:155]
    ds_read_b64_tr_b16 v[106:107], v246 offset:20480
    v_mfma_f32_16x16x32_bf16 v[152:155], v[36:39], v[8:11], v[152:155]
    ds_read_b64_tr_b16 v[108:109], v247 offset:16384
    v_mfma_f32_16x16x32_bf16 v[148:151], v[36:39], v[4:7], v[148:151]
    ds_read_b64_tr_b16 v[110:111], v247 offset:20480
    v_mfma_f32_16x16x32_bf16 v[148:151], v[52:55], v[20:23], v[148:151]
    ds_read_b64_tr_b16 v[112:113], v244 offset:24576
    v_mfma_f32_16x16x32_bf16 v[144:147], v[52:55], v[16:19], v[144:147]
    ds_read_b64_tr_b16 v[114:115], v244 offset:28672
    v_mfma_f32_16x16x32_bf16 v[144:147], v[36:39], v[0:3], v[144:147]
    ds_read_b128 v[80:83], v243 offset:17408
    v_mfma_f32_16x16x32_bf16 v[160:163], v[40:43], v[0:3], v[160:163]
    ds_read_b128 v[84:87], v243 offset:19456
    v_mfma_f32_16x16x32_bf16 v[160:163], v[56:59], v[16:19], v[160:163]
    v_mfma_f32_16x16x32_bf16 v[164:167], v[56:59], v[20:23], v[164:167]
    ds_read_b128 v[88:91], v243 offset:21504
    v_mfma_f32_16x16x32_bf16 v[164:167], v[40:43], v[4:7], v[164:167]
    ds_read_b128 v[92:95], v243 offset:23552
    v_mfma_f32_16x16x32_bf16 v[168:171], v[40:43], v[8:11], v[168:171]
    ds_read_b64_tr_b16 v[116:117], v245 offset:24576
    v_mfma_f32_16x16x32_bf16 v[168:171], v[56:59], v[24:27], v[168:171]
    ds_read_b64_tr_b16 v[118:119], v245 offset:28672
    v_mfma_f32_16x16x32_bf16 v[172:175], v[56:59], v[28:31], v[172:175]
    ds_read_b64_tr_b16 v[120:121], v246 offset:24576
    v_mfma_f32_16x16x32_bf16 v[172:175], v[40:43], v[12:15], v[172:175]
    ds_read_b64_tr_b16 v[122:123], v246 offset:28672
    v_mfma_f32_16x16x32_bf16 v[188:191], v[44:47], v[12:15], v[188:191]
    ds_read_b64_tr_b16 v[124:125], v247 offset:24576
    v_mfma_f32_16x16x32_bf16 v[188:191], v[60:63], v[28:31], v[188:191]
    ds_read_b64_tr_b16 v[126:127], v247 offset:28672
    v_mfma_f32_16x16x32_bf16 v[184:187], v[60:63], v[24:27], v[184:187]
    v_mfma_f32_16x16x32_bf16 v[184:187], v[44:47], v[8:11], v[184:187]
    v_mfma_f32_16x16x32_bf16 v[180:183], v[44:47], v[4:7], v[180:183]
    v_mfma_f32_16x16x32_bf16 v[180:183], v[60:63], v[20:23], v[180:183]
    v_mfma_f32_16x16x32_bf16 v[176:179], v[60:63], v[16:19], v[176:179]
    v_mfma_f32_16x16x32_bf16 v[176:179], v[44:47], v[0:3], v[176:179]
    s_waitcnt lgkmcnt(0)
    s_barrier
    .p2align 3
    v_mfma_f32_16x16x32_bf16 v[128:131], v[96:99], v[64:67], v[128:131]
    ds_read_b64_tr_b16 v[32:33], v244 offset:32768
    v_mfma_f32_16x16x32_bf16 v[128:131], v[112:115], v[80:83], v[128:131]
    ds_read_b64_tr_b16 v[34:35], v244 offset:36864
    v_mfma_f32_16x16x32_bf16 v[132:135], v[112:115], v[84:87], v[132:135]
    ds_read_b128 v[0:3], v243 offset:32768
    v_mfma_f32_16x16x32_bf16 v[132:135], v[96:99], v[68:71], v[132:135]
    ds_read_b128 v[4:7], v243 offset:34816
    v_mfma_f32_16x16x32_bf16 v[136:139], v[96:99], v[72:75], v[136:139]
    ds_read_b128 v[8:11], v243 offset:36864
    v_mfma_f32_16x16x32_bf16 v[136:139], v[112:115], v[88:91], v[136:139]
    ds_read_b128 v[12:15], v243 offset:38912
    v_mfma_f32_16x16x32_bf16 v[140:143], v[112:115], v[92:95], v[140:143]
    ds_read_b64_tr_b16 v[36:37], v245 offset:32768
    v_mfma_f32_16x16x32_bf16 v[140:143], v[96:99], v[76:79], v[140:143]
    ds_read_b64_tr_b16 v[38:39], v245 offset:36864
    v_mfma_f32_16x16x32_bf16 v[156:159], v[100:103], v[76:79], v[156:159]
    v_mfma_f32_16x16x32_bf16 v[156:159], v[116:119], v[92:95], v[156:159]
    ds_read_b64_tr_b16 v[40:41], v246 offset:32768
    v_mfma_f32_16x16x32_bf16 v[152:155], v[116:119], v[88:91], v[152:155]
    ds_read_b64_tr_b16 v[42:43], v246 offset:36864
    v_mfma_f32_16x16x32_bf16 v[152:155], v[100:103], v[72:75], v[152:155]
    ds_read_b64_tr_b16 v[44:45], v247 offset:32768
    v_mfma_f32_16x16x32_bf16 v[148:151], v[100:103], v[68:71], v[148:151]
    ds_read_b64_tr_b16 v[46:47], v247 offset:36864
    v_mfma_f32_16x16x32_bf16 v[148:151], v[116:119], v[84:87], v[148:151]
    ds_read_b64_tr_b16 v[48:49], v244 offset:40960
    v_mfma_f32_16x16x32_bf16 v[144:147], v[116:119], v[80:83], v[144:147]
    ds_read_b64_tr_b16 v[50:51], v244 offset:45056
    v_mfma_f32_16x16x32_bf16 v[144:147], v[100:103], v[64:67], v[144:147]
    ds_read_b128 v[16:19], v243 offset:33792
    v_mfma_f32_16x16x32_bf16 v[160:163], v[104:107], v[64:67], v[160:163]
    ds_read_b128 v[20:23], v243 offset:35840
    v_mfma_f32_16x16x32_bf16 v[160:163], v[120:123], v[80:83], v[160:163]
    v_mfma_f32_16x16x32_bf16 v[164:167], v[120:123], v[84:87], v[164:167]
    ds_read_b128 v[24:27], v243 offset:37888
    v_mfma_f32_16x16x32_bf16 v[164:167], v[104:107], v[68:71], v[164:167]
    ds_read_b128 v[28:31], v243 offset:39936
    v_mfma_f32_16x16x32_bf16 v[168:171], v[104:107], v[72:75], v[168:171]
    ds_read_b64_tr_b16 v[52:53], v245 offset:40960
    v_mfma_f32_16x16x32_bf16 v[168:171], v[120:123], v[88:91], v[168:171]
    ds_read_b64_tr_b16 v[54:55], v245 offset:45056
    v_mfma_f32_16x16x32_bf16 v[172:175], v[120:123], v[92:95], v[172:175]
    ds_read_b64_tr_b16 v[56:57], v246 offset:40960
    v_mfma_f32_16x16x32_bf16 v[172:175], v[104:107], v[76:79], v[172:175]
    ds_read_b64_tr_b16 v[58:59], v246 offset:45056
    v_mfma_f32_16x16x32_bf16 v[188:191], v[108:111], v[76:79], v[188:191]
    ds_read_b64_tr_b16 v[60:61], v247 offset:40960
    v_mfma_f32_16x16x32_bf16 v[188:191], v[124:127], v[92:95], v[188:191]
    ds_read_b64_tr_b16 v[62:63], v247 offset:45056
    v_mfma_f32_16x16x32_bf16 v[184:187], v[124:127], v[88:91], v[184:187]
    v_mfma_f32_16x16x32_bf16 v[184:187], v[108:111], v[72:75], v[184:187]
    v_mfma_f32_16x16x32_bf16 v[180:183], v[108:111], v[68:71], v[180:183]
    v_mfma_f32_16x16x32_bf16 v[180:183], v[124:127], v[84:87], v[180:183]
    v_mfma_f32_16x16x32_bf16 v[176:179], v[124:127], v[80:83], v[176:179]
    v_mfma_f32_16x16x32_bf16 v[176:179], v[108:111], v[64:67], v[176:179]
    s_waitcnt lgkmcnt(0)
    s_barrier
    .p2align 3
    v_mfma_f32_16x16x32_bf16 v[128:131], v[32:35], v[0:3], v[128:131]
    ds_read_b64_tr_b16 v[96:97], v248 offset:0
    v_mfma_f32_16x16x32_bf16 v[128:131], v[48:51], v[16:19], v[128:131]
    ds_read_b64_tr_b16 v[98:99], v248 offset:4096
    v_mfma_f32_16x16x32_bf16 v[132:135], v[48:51], v[20:23], v[132:135]
    ds_read_b128 v[64:67], v243 offset:0
    v_mfma_f32_16x16x32_bf16 v[132:135], v[32:35], v[4:7], v[132:135]
    ds_read_b128 v[68:71], v243 offset:2048
    v_mfma_f32_16x16x32_bf16 v[136:139], v[32:35], v[8:11], v[136:139]
    ds_read_b128 v[72:75], v243 offset:4096
    v_mfma_f32_16x16x32_bf16 v[136:139], v[48:51], v[24:27], v[136:139]
    ds_read_b128 v[76:79], v243 offset:6144
    v_mfma_f32_16x16x32_bf16 v[140:143], v[48:51], v[28:31], v[140:143]
    ds_read_b64_tr_b16 v[100:101], v249 offset:0
    v_mfma_f32_16x16x32_bf16 v[140:143], v[32:35], v[12:15], v[140:143]
    ds_read_b64_tr_b16 v[102:103], v249 offset:4096
    v_mfma_f32_16x16x32_bf16 v[156:159], v[36:39], v[12:15], v[156:159]
    v_mfma_f32_16x16x32_bf16 v[156:159], v[52:55], v[28:31], v[156:159]
    ds_read_b64_tr_b16 v[104:105], v250 offset:0
    v_mfma_f32_16x16x32_bf16 v[152:155], v[52:55], v[24:27], v[152:155]
    ds_read_b64_tr_b16 v[106:107], v250 offset:4096
    v_mfma_f32_16x16x32_bf16 v[152:155], v[36:39], v[8:11], v[152:155]
    ds_read_b64_tr_b16 v[108:109], v251 offset:0
    v_mfma_f32_16x16x32_bf16 v[148:151], v[36:39], v[4:7], v[148:151]
    ds_read_b64_tr_b16 v[110:111], v251 offset:4096
    v_mfma_f32_16x16x32_bf16 v[148:151], v[52:55], v[20:23], v[148:151]
    ds_read_b64_tr_b16 v[112:113], v248 offset:8192
    v_mfma_f32_16x16x32_bf16 v[144:147], v[52:55], v[16:19], v[144:147]
    ds_read_b64_tr_b16 v[114:115], v248 offset:12288
    v_mfma_f32_16x16x32_bf16 v[144:147], v[36:39], v[0:3], v[144:147]
    ds_read_b128 v[80:83], v243 offset:1024
    v_mfma_f32_16x16x32_bf16 v[160:163], v[40:43], v[0:3], v[160:163]
    ds_read_b128 v[84:87], v243 offset:3072
    v_mfma_f32_16x16x32_bf16 v[160:163], v[56:59], v[16:19], v[160:163]
    v_mfma_f32_16x16x32_bf16 v[164:167], v[56:59], v[20:23], v[164:167]
    ds_read_b128 v[88:91], v243 offset:5120
    v_mfma_f32_16x16x32_bf16 v[164:167], v[40:43], v[4:7], v[164:167]
    ds_read_b128 v[92:95], v243 offset:7168
    v_mfma_f32_16x16x32_bf16 v[168:171], v[40:43], v[8:11], v[168:171]
    ds_read_b64_tr_b16 v[116:117], v249 offset:8192
    v_mfma_f32_16x16x32_bf16 v[168:171], v[56:59], v[24:27], v[168:171]
    ds_read_b64_tr_b16 v[118:119], v249 offset:12288
    v_mfma_f32_16x16x32_bf16 v[172:175], v[56:59], v[28:31], v[172:175]
    ds_read_b64_tr_b16 v[120:121], v250 offset:8192
    v_mfma_f32_16x16x32_bf16 v[172:175], v[40:43], v[12:15], v[172:175]
    ds_read_b64_tr_b16 v[122:123], v250 offset:12288
    v_mfma_f32_16x16x32_bf16 v[188:191], v[44:47], v[12:15], v[188:191]
    ds_read_b64_tr_b16 v[124:125], v251 offset:8192
    v_mfma_f32_16x16x32_bf16 v[188:191], v[60:63], v[28:31], v[188:191]
    ds_read_b64_tr_b16 v[126:127], v251 offset:12288
    v_mfma_f32_16x16x32_bf16 v[184:187], v[60:63], v[24:27], v[184:187]
    v_mfma_f32_16x16x32_bf16 v[184:187], v[44:47], v[8:11], v[184:187]
    v_mfma_f32_16x16x32_bf16 v[180:183], v[44:47], v[4:7], v[180:183]
    v_mfma_f32_16x16x32_bf16 v[180:183], v[60:63], v[20:23], v[180:183]
    s_sub_u32 s58, s58, 1
    s_cmp_lg_u32 s58, 0
    .p2align 3
    v_mfma_f32_16x16x32_bf16 v[176:179], v[60:63], v[16:19], v[176:179]
    v_mfma_f32_16x16x32_bf16 v[176:179], v[44:47], v[0:3], v[176:179]
    s_cbranch_scc1 loop_38
    s_waitcnt lgkmcnt(0)
    s_barrier
    .p2align 3
    v_mfma_f32_16x16x32_bf16 v[128:131], v[96:99], v[64:67], v[128:131]
    ds_read_b64_tr_b16 v[32:33], v248 offset:16384
    v_mfma_f32_16x16x32_bf16 v[128:131], v[112:115], v[80:83], v[128:131]
    ds_read_b64_tr_b16 v[34:35], v248 offset:20480
    v_mfma_f32_16x16x32_bf16 v[132:135], v[112:115], v[84:87], v[132:135]
    ds_read_b128 v[0:3], v243 offset:16384
    v_mfma_f32_16x16x32_bf16 v[132:135], v[96:99], v[68:71], v[132:135]
    ds_read_b128 v[4:7], v243 offset:18432
    v_mfma_f32_16x16x32_bf16 v[136:139], v[96:99], v[72:75], v[136:139]
    ds_read_b128 v[8:11], v243 offset:20480
    v_mfma_f32_16x16x32_bf16 v[136:139], v[112:115], v[88:91], v[136:139]
    ds_read_b128 v[12:15], v243 offset:22528
    v_mfma_f32_16x16x32_bf16 v[140:143], v[112:115], v[92:95], v[140:143]
    ds_read_b64_tr_b16 v[36:37], v249 offset:16384
    v_mfma_f32_16x16x32_bf16 v[140:143], v[96:99], v[76:79], v[140:143]
    ds_read_b64_tr_b16 v[38:39], v249 offset:20480
    v_mfma_f32_16x16x32_bf16 v[156:159], v[100:103], v[76:79], v[156:159]
    v_mfma_f32_16x16x32_bf16 v[156:159], v[116:119], v[92:95], v[156:159]
    ds_read_b64_tr_b16 v[40:41], v250 offset:16384
    v_mfma_f32_16x16x32_bf16 v[152:155], v[116:119], v[88:91], v[152:155]
    ds_read_b64_tr_b16 v[42:43], v250 offset:20480
    v_mfma_f32_16x16x32_bf16 v[152:155], v[100:103], v[72:75], v[152:155]
    ds_read_b64_tr_b16 v[44:45], v251 offset:16384
    v_mfma_f32_16x16x32_bf16 v[148:151], v[100:103], v[68:71], v[148:151]
    ds_read_b64_tr_b16 v[46:47], v251 offset:20480
    v_mfma_f32_16x16x32_bf16 v[148:151], v[116:119], v[84:87], v[148:151]
    ds_read_b64_tr_b16 v[48:49], v248 offset:24576
    v_mfma_f32_16x16x32_bf16 v[144:147], v[116:119], v[80:83], v[144:147]
    ds_read_b64_tr_b16 v[50:51], v248 offset:28672
    v_mfma_f32_16x16x32_bf16 v[144:147], v[100:103], v[64:67], v[144:147]
    ds_read_b128 v[16:19], v243 offset:17408
    v_mfma_f32_16x16x32_bf16 v[160:163], v[104:107], v[64:67], v[160:163]
    ds_read_b128 v[20:23], v243 offset:19456
    v_mfma_f32_16x16x32_bf16 v[160:163], v[120:123], v[80:83], v[160:163]
    v_mfma_f32_16x16x32_bf16 v[164:167], v[120:123], v[84:87], v[164:167]
    ds_read_b128 v[24:27], v243 offset:21504
    v_mfma_f32_16x16x32_bf16 v[164:167], v[104:107], v[68:71], v[164:167]
    ds_read_b128 v[28:31], v243 offset:23552
    v_mfma_f32_16x16x32_bf16 v[168:171], v[104:107], v[72:75], v[168:171]
    ds_read_b64_tr_b16 v[52:53], v249 offset:24576
    v_mfma_f32_16x16x32_bf16 v[168:171], v[120:123], v[88:91], v[168:171]
    ds_read_b64_tr_b16 v[54:55], v249 offset:28672
    v_mfma_f32_16x16x32_bf16 v[172:175], v[120:123], v[92:95], v[172:175]
    ds_read_b64_tr_b16 v[56:57], v250 offset:24576
    v_mfma_f32_16x16x32_bf16 v[172:175], v[104:107], v[76:79], v[172:175]
    ds_read_b64_tr_b16 v[58:59], v250 offset:28672
    v_mfma_f32_16x16x32_bf16 v[188:191], v[108:111], v[76:79], v[188:191]
    ds_read_b64_tr_b16 v[60:61], v251 offset:24576
    v_mfma_f32_16x16x32_bf16 v[188:191], v[124:127], v[92:95], v[188:191]
    ds_read_b64_tr_b16 v[62:63], v251 offset:28672
    v_mfma_f32_16x16x32_bf16 v[184:187], v[124:127], v[88:91], v[184:187]
    v_mfma_f32_16x16x32_bf16 v[184:187], v[108:111], v[72:75], v[184:187]
    v_mfma_f32_16x16x32_bf16 v[180:183], v[108:111], v[68:71], v[180:183]
    v_mfma_f32_16x16x32_bf16 v[180:183], v[124:127], v[84:87], v[180:183]
    v_mfma_f32_16x16x32_bf16 v[176:179], v[124:127], v[80:83], v[176:179]
    v_mfma_f32_16x16x32_bf16 v[176:179], v[108:111], v[64:67], v[176:179]
    s_waitcnt lgkmcnt(0)
    s_barrier
    .p2align 3
    v_mfma_f32_16x16x32_bf16 v[128:131], v[32:35], v[0:3], v[128:131]
    ds_read_b64_tr_b16 v[96:97], v248 offset:32768
    v_mfma_f32_16x16x32_bf16 v[128:131], v[48:51], v[16:19], v[128:131]
    ds_read_b64_tr_b16 v[98:99], v248 offset:36864
    v_mfma_f32_16x16x32_bf16 v[132:135], v[48:51], v[20:23], v[132:135]
    ds_read_b128 v[64:67], v243 offset:32768
    v_mfma_f32_16x16x32_bf16 v[132:135], v[32:35], v[4:7], v[132:135]
    ds_read_b128 v[68:71], v243 offset:34816
    v_mfma_f32_16x16x32_bf16 v[136:139], v[32:35], v[8:11], v[136:139]
    ds_read_b128 v[72:75], v243 offset:36864
    v_mfma_f32_16x16x32_bf16 v[136:139], v[48:51], v[24:27], v[136:139]
    ds_read_b128 v[76:79], v243 offset:38912
    v_mfma_f32_16x16x32_bf16 v[140:143], v[48:51], v[28:31], v[140:143]
    ds_read_b64_tr_b16 v[100:101], v249 offset:32768
    v_mfma_f32_16x16x32_bf16 v[140:143], v[32:35], v[12:15], v[140:143]
    ds_read_b64_tr_b16 v[102:103], v249 offset:36864
    v_mfma_f32_16x16x32_bf16 v[156:159], v[36:39], v[12:15], v[156:159]
    v_mfma_f32_16x16x32_bf16 v[156:159], v[52:55], v[28:31], v[156:159]
    ds_read_b64_tr_b16 v[104:105], v250 offset:32768
    v_mfma_f32_16x16x32_bf16 v[152:155], v[52:55], v[24:27], v[152:155]
    ds_read_b64_tr_b16 v[106:107], v250 offset:36864
    v_mfma_f32_16x16x32_bf16 v[152:155], v[36:39], v[8:11], v[152:155]
    ds_read_b64_tr_b16 v[108:109], v251 offset:32768
    v_mfma_f32_16x16x32_bf16 v[148:151], v[36:39], v[4:7], v[148:151]
    ds_read_b64_tr_b16 v[110:111], v251 offset:36864
    v_mfma_f32_16x16x32_bf16 v[148:151], v[52:55], v[20:23], v[148:151]
    ds_read_b64_tr_b16 v[112:113], v248 offset:40960
    v_mfma_f32_16x16x32_bf16 v[144:147], v[52:55], v[16:19], v[144:147]
    ds_read_b64_tr_b16 v[114:115], v248 offset:45056
    v_mfma_f32_16x16x32_bf16 v[144:147], v[36:39], v[0:3], v[144:147]
    ds_read_b128 v[80:83], v243 offset:33792
    v_mfma_f32_16x16x32_bf16 v[160:163], v[40:43], v[0:3], v[160:163]
    ds_read_b128 v[84:87], v243 offset:35840
    v_mfma_f32_16x16x32_bf16 v[160:163], v[56:59], v[16:19], v[160:163]
    v_mfma_f32_16x16x32_bf16 v[164:167], v[56:59], v[20:23], v[164:167]
    ds_read_b128 v[88:91], v243 offset:37888
    v_mfma_f32_16x16x32_bf16 v[164:167], v[40:43], v[4:7], v[164:167]
    ds_read_b128 v[92:95], v243 offset:39936
    v_mfma_f32_16x16x32_bf16 v[168:171], v[40:43], v[8:11], v[168:171]
    ds_read_b64_tr_b16 v[116:117], v249 offset:40960
    v_mfma_f32_16x16x32_bf16 v[168:171], v[56:59], v[24:27], v[168:171]
    ds_read_b64_tr_b16 v[118:119], v249 offset:45056
    v_mfma_f32_16x16x32_bf16 v[172:175], v[56:59], v[28:31], v[172:175]
    ds_read_b64_tr_b16 v[120:121], v250 offset:40960
    v_mfma_f32_16x16x32_bf16 v[172:175], v[40:43], v[12:15], v[172:175]
    ds_read_b64_tr_b16 v[122:123], v250 offset:45056
    v_mfma_f32_16x16x32_bf16 v[188:191], v[44:47], v[12:15], v[188:191]
    ds_read_b64_tr_b16 v[124:125], v251 offset:40960
    v_mfma_f32_16x16x32_bf16 v[188:191], v[60:63], v[28:31], v[188:191]
    ds_read_b64_tr_b16 v[126:127], v251 offset:45056
    v_mfma_f32_16x16x32_bf16 v[184:187], v[60:63], v[24:27], v[184:187]
    v_mfma_f32_16x16x32_bf16 v[184:187], v[44:47], v[8:11], v[184:187]
    v_mfma_f32_16x16x32_bf16 v[180:183], v[44:47], v[4:7], v[180:183]
    v_mfma_f32_16x16x32_bf16 v[180:183], v[60:63], v[20:23], v[180:183]
    v_mfma_f32_16x16x32_bf16 v[176:179], v[60:63], v[16:19], v[176:179]
    v_mfma_f32_16x16x32_bf16 v[176:179], v[44:47], v[0:3], v[176:179]
    s_waitcnt lgkmcnt(0)
    s_barrier
    .p2align 3
    v_mfma_f32_16x16x32_bf16 v[128:131], v[96:99], v[64:67], v[128:131]
    v_mfma_f32_16x16x32_bf16 v[128:131], v[112:115], v[80:83], v[128:131]
    v_mfma_f32_16x16x32_bf16 v[132:135], v[112:115], v[84:87], v[132:135]
    buffer_load_dwordx4 v[196:199], v254, s[4:7], s59 offen offset:0
    .p2align 3
    v_mfma_f32_16x16x32_bf16 v[132:135], v[96:99], v[68:71], v[132:135]
    v_mfma_f32_16x16x32_bf16 v[136:139], v[96:99], v[72:75], v[136:139]
    v_mfma_f32_16x16x32_bf16 v[136:139], v[112:115], v[88:91], v[136:139]
    v_mfma_f32_16x16x32_bf16 v[140:143], v[112:115], v[92:95], v[140:143]
    buffer_load_dwordx4 v[200:203], v254, s[4:7], s59 offen offset:2048
    .p2align 3
    v_mfma_f32_16x16x32_bf16 v[140:143], v[96:99], v[76:79], v[140:143]
    v_mfma_f32_16x16x32_bf16 v[156:159], v[100:103], v[76:79], v[156:159]
    v_mfma_f32_16x16x32_bf16 v[156:159], v[116:119], v[92:95], v[156:159]
    v_mfma_f32_16x16x32_bf16 v[152:155], v[116:119], v[88:91], v[152:155]
    buffer_load_dwordx4 v[204:207], v254, s[4:7], s60 offen offset:0
    .p2align 3
    v_mfma_f32_16x16x32_bf16 v[152:155], v[100:103], v[72:75], v[152:155]
    v_mfma_f32_16x16x32_bf16 v[148:151], v[100:103], v[68:71], v[148:151]
    v_mfma_f32_16x16x32_bf16 v[148:151], v[116:119], v[84:87], v[148:151]
    v_mfma_f32_16x16x32_bf16 v[144:147], v[116:119], v[80:83], v[144:147]
    buffer_load_dwordx4 v[208:211], v254, s[4:7], s60 offen offset:2048
    .p2align 3
    v_mfma_f32_16x16x32_bf16 v[144:147], v[100:103], v[64:67], v[144:147]
    v_mfma_f32_16x16x32_bf16 v[160:163], v[104:107], v[64:67], v[160:163]
    v_mfma_f32_16x16x32_bf16 v[160:163], v[120:123], v[80:83], v[160:163]
    v_mfma_f32_16x16x32_bf16 v[164:167], v[120:123], v[84:87], v[164:167]
    v_mfma_f32_16x16x32_bf16 v[164:167], v[104:107], v[68:71], v[164:167]
    v_mfma_f32_16x16x32_bf16 v[168:171], v[104:107], v[72:75], v[168:171]
    v_mfma_f32_16x16x32_bf16 v[168:171], v[120:123], v[88:91], v[168:171]
    v_mfma_f32_16x16x32_bf16 v[172:175], v[120:123], v[92:95], v[172:175]
    v_mfma_f32_16x16x32_bf16 v[172:175], v[104:107], v[76:79], v[172:175]
    v_mfma_f32_16x16x32_bf16 v[188:191], v[108:111], v[76:79], v[188:191]
    v_mfma_f32_16x16x32_bf16 v[188:191], v[124:127], v[92:95], v[188:191]
    v_mfma_f32_16x16x32_bf16 v[184:187], v[124:127], v[88:91], v[184:187]
    v_mfma_f32_16x16x32_bf16 v[184:187], v[108:111], v[72:75], v[184:187]
    v_mfma_f32_16x16x32_bf16 v[180:183], v[108:111], v[68:71], v[180:183]
    v_mfma_f32_16x16x32_bf16 v[180:183], v[124:127], v[84:87], v[180:183]
    v_mfma_f32_16x16x32_bf16 v[176:179], v[124:127], v[80:83], v[176:179]
    v_mfma_f32_16x16x32_bf16 v[176:179], v[108:111], v[64:67], v[176:179]
    s_nop 7
    v_cvt_pk_bf16_f32 v0, v160, v161
    v_cvt_pk_bf16_f32 v1, v162, v163
    v_cvt_pk_bf16_f32 v2, v176, v177
    v_cvt_pk_bf16_f32 v3, v178, v179
    v_min_u32 v0, -2, v0
    v_min_u32 v1, -2, v1
    v_min_u32 v2, -2, v2
    v_min_u32 v3, -2, v3
    buffer_store_dwordx4 v[0:3], v254, s[4:7], s88 offen offset:0 sc0 sc1
    v_cvt_pk_bf16_f32 v4, v164, v165
    v_cvt_pk_bf16_f32 v5, v166, v167
    v_cvt_pk_bf16_f32 v6, v180, v181
    v_cvt_pk_bf16_f32 v7, v182, v183
    v_min_u32 v4, -2, v4
    v_min_u32 v5, -2, v5
    v_min_u32 v6, -2, v6
    v_min_u32 v7, -2, v7
    buffer_store_dwordx4 v[4:7], v254, s[4:7], s88 offen offset:1024 sc0 sc1
    v_cvt_pk_bf16_f32 v8, v168, v169
    v_cvt_pk_bf16_f32 v9, v170, v171
    v_cvt_pk_bf16_f32 v10, v184, v185
    v_cvt_pk_bf16_f32 v11, v186, v187
    v_min_u32 v8, -2, v8
    v_min_u32 v9, -2, v9
    v_min_u32 v10, -2, v10
    v_min_u32 v11, -2, v11
    buffer_store_dwordx4 v[8:11], v254, s[4:7], s88 offen offset:2048 sc0 sc1
    v_cvt_pk_bf16_f32 v12, v172, v173
    v_cvt_pk_bf16_f32 v13, v174, v175
    v_cvt_pk_bf16_f32 v14, v188, v189
    v_cvt_pk_bf16_f32 v15, v190, v191
    v_min_u32 v12, -2, v12
    v_min_u32 v13, -2, v13
    v_min_u32 v14, -2, v14
    v_min_u32 v15, -2, v15
    buffer_store_dwordx4 v[12:15], v254, s[4:7], s88 offen offset:3072 sc0 sc1
    s_waitcnt vmcnt(4)
    v_lshlrev_b32 v160, 16, v196
    v_and_b32 v161, 0xffff0000, v196
    v_lshlrev_b32 v162, 16, v197
    v_and_b32 v163, 0xffff0000, v197
    v_pk_add_f32 v[128:129], v[128:129], v[160:161]
    v_pk_add_f32 v[130:131], v[130:131], v[162:163]
    v_lshlrev_b32 v164, 16, v198
    v_and_b32 v165, 0xffff0000, v198
    v_lshlrev_b32 v166, 16, v199
    v_and_b32 v167, 0xffff0000, v199
    v_pk_add_f32 v[144:145], v[144:145], v[164:165]
    v_pk_add_f32 v[146:147], v[146:147], v[166:167]
    v_lshlrev_b32 v168, 16, v200
    v_and_b32 v169, 0xffff0000, v200
    v_lshlrev_b32 v170, 16, v201
    v_and_b32 v171, 0xffff0000, v201
    v_pk_add_f32 v[132:133], v[132:133], v[168:169]
    v_pk_add_f32 v[134:135], v[134:135], v[170:171]
    v_lshlrev_b32 v172, 16, v202
    v_and_b32 v173, 0xffff0000, v202
    v_lshlrev_b32 v174, 16, v203
    v_and_b32 v175, 0xffff0000, v203
    v_pk_add_f32 v[148:149], v[148:149], v[172:173]
    v_pk_add_f32 v[150:151], v[150:151], v[174:175]
    v_lshlrev_b32 v160, 16, v204
    v_and_b32 v161, 0xffff0000, v204
    v_lshlrev_b32 v162, 16, v205
    v_and_b32 v163, 0xffff0000, v205
    v_pk_add_f32 v[136:137], v[136:137], v[160:161]
    v_pk_add_f32 v[138:139], v[138:139], v[162:163]
    v_lshlrev_b32 v164, 16, v206
    v_and_b32 v165, 0xffff0000, v206
    v_lshlrev_b32 v166, 16, v207
    v_and_b32 v167, 0xffff0000, v207
    v_pk_add_f32 v[152:153], v[152:153], v[164:165]
    v_pk_add_f32 v[154:155], v[154:155], v[166:167]
    v_lshlrev_b32 v168, 16, v208
    v_and_b32 v169, 0xffff0000, v208
    v_lshlrev_b32 v170, 16, v209
    v_and_b32 v171, 0xffff0000, v209
    v_pk_add_f32 v[140:141], v[140:141], v[168:169]
    v_pk_add_f32 v[142:143], v[142:143], v[170:171]
    v_lshlrev_b32 v172, 16, v210
    v_and_b32 v173, 0xffff0000, v210
    v_lshlrev_b32 v174, 16, v211
    v_and_b32 v175, 0xffff0000, v211
    v_pk_add_f32 v[156:157], v[156:157], v[172:173]
    v_pk_add_f32 v[158:159], v[158:159], v[174:175]
    s_mov_b32 s56, 262144
poll_39:
    buffer_load_dwordx4 v[16:19], v254, s[4:7], s89 offen offset:0 sc0 sc1
    buffer_load_dwordx4 v[20:23], v254, s[4:7], s89 offen offset:1024 sc0 sc1
    buffer_load_dwordx4 v[24:27], v254, s[4:7], s89 offen offset:2048 sc0 sc1
    buffer_load_dwordx4 v[28:31], v254, s[4:7], s89 offen offset:3072 sc0 sc1
    s_waitcnt vmcnt(0)
    v_max3_u32 v192, v16, v17, v18
    v_max3_u32 v193, v19, v20, v21
    v_max3_u32 v192, v192, v22, v23
    v_max3_u32 v193, v193, v24, v25
    v_max3_u32 v192, v192, v26, v27
    v_max3_u32 v193, v193, v28, v29
    v_max3_u32 v192, v192, v30, v31
    v_max_u32 v192, v192, v193
    v_cmp_eq_u32 vcc, -1, v192
    s_cbranch_vccz pd_40
    s_sub_u32 s56, s56, 1
    s_cmp_lg_u32 s56, 0
    s_cbranch_scc1 poll_39
pd_40:
    v_lshlrev_b32 v160, 16, v16
    v_and_b32 v161, 0xffff0000, v16
    v_lshlrev_b32 v162, 16, v17
    v_and_b32 v163, 0xffff0000, v17
    v_pk_add_f32 v[128:129], v[128:129], v[160:161]
    v_pk_add_f32 v[130:131], v[130:131], v[162:163]
    v_lshlrev_b32 v164, 16, v18
    v_and_b32 v165, 0xffff0000, v18
    v_lshlrev_b32 v166, 16, v19
    v_and_b32 v167, 0xffff0000, v19
    v_pk_add_f32 v[144:145], v[144:145], v[164:165]
    v_pk_add_f32 v[146:147], v[146:147], v[166:167]
    v_lshlrev_b32 v168, 16, v20
    v_and_b32 v169, 0xffff0000, v20
    v_lshlrev_b32 v170, 16, v21
    v_and_b32 v171, 0xffff0000, v21
    v_pk_add_f32 v[132:133], v[132:133], v[168:169]
    v_pk_add_f32 v[134:135], v[134:135], v[170:171]
    v_lshlrev_b32 v172, 16, v22
    v_and_b32 v173, 0xffff0000, v22
    v_lshlrev_b32 v174, 16, v23
    v_and_b32 v175, 0xffff0000, v23
    v_pk_add_f32 v[148:149], v[148:149], v[172:173]
    v_pk_add_f32 v[150:151], v[150:151], v[174:175]
    v_lshlrev_b32 v160, 16, v24
    v_and_b32 v161, 0xffff0000, v24
    v_lshlrev_b32 v162, 16, v25
    v_and_b32 v163, 0xffff0000, v25
    v_pk_add_f32 v[136:137], v[136:137], v[160:161]
    v_pk_add_f32 v[138:139], v[138:139], v[162:163]
    v_lshlrev_b32 v164, 16, v26
    v_and_b32 v165, 0xffff0000, v26
    v_lshlrev_b32 v166, 16, v27
    v_and_b32 v167, 0xffff0000, v27
    v_pk_add_f32 v[152:153], v[152:153], v[164:165]
    v_pk_add_f32 v[154:155], v[154:155], v[166:167]
    v_lshlrev_b32 v168, 16, v28
    v_and_b32 v169, 0xffff0000, v28
    v_lshlrev_b32 v170, 16, v29
    v_and_b32 v171, 0xffff0000, v29
    v_pk_add_f32 v[140:141], v[140:141], v[168:169]
    v_pk_add_f32 v[142:143], v[142:143], v[170:171]
    v_lshlrev_b32 v172, 16, v30
    v_and_b32 v173, 0xffff0000, v30
    v_lshlrev_b32 v174, 16, v31
    v_and_b32 v175, 0xffff0000, v31
    v_pk_add_f32 v[156:157], v[156:157], v[172:173]
    v_pk_add_f32 v[158:159], v[158:159], v[174:175]
    s_cmp_lg_u32 s46, 0
    s_cbranch_scc1 X_fin
    s_add_u32 s59, s1, s48
    s_add_u32 s60, s59, 4096
    v_cvt_pk_bf16_f32 v236, v128, v129
    v_cvt_pk_bf16_f32 v237, v130, v131
    v_cvt_pk_bf16_f32 v238, v144, v145
    v_cvt_pk_bf16_f32 v239, v146, v147
    buffer_store_dwordx4 v[236:239], v254, s[4:7], s59 offen offset:0 sc0 sc1
    v_cvt_pk_bf16_f32 v240, v132, v133
    v_cvt_pk_bf16_f32 v241, v134, v135
    v_cvt_pk_bf16_f32 v242, v148, v149
    v_cvt_pk_bf16_f32 v243, v150, v151
    buffer_store_dwordx4 v[240:243], v254, s[4:7], s59 offen offset:2048 sc0 sc1
    v_cvt_pk_bf16_f32 v244, v136, v137
    v_cvt_pk_bf16_f32 v245, v138, v139
    v_cvt_pk_bf16_f32 v246, v152, v153
    v_cvt_pk_bf16_f32 v247, v154, v155
    buffer_store_dwordx4 v[244:247], v254, s[4:7], s60 offen offset:0 sc0 sc1
    v_cvt_pk_bf16_f32 v248, v140, v141
    v_cvt_pk_bf16_f32 v249, v142, v143
    v_cvt_pk_bf16_f32 v250, v156, v157
    v_cvt_pk_bf16_f32 v251, v158, v159
    buffer_store_dwordx4 v[248:251], v254, s[4:7], s60 offen offset:2048 sc0 sc1
    v_mov_b32 v234, 0x3f803f80
    v_dot2_f32_bf16 v226, v236, v234, 0
    v_dot2_f32_bf16 v230, v236, v236, 0
    v_dot2_f32_bf16 v227, v240, v234, 0
    v_dot2_f32_bf16 v231, v240, v240, 0
    v_dot2_f32_bf16 v228, v244, v234, 0
    v_dot2_f32_bf16 v232, v244, v244, 0
    v_dot2_f32_bf16 v229, v248, v234, 0
    v_dot2_f32_bf16 v233, v248, v248, 0
    v_dot2_f32_bf16 v226, v237, v234, v226
    v_dot2_f32_bf16 v230, v237, v237, v230
    v_dot2_f32_bf16 v227, v241, v234, v227
    v_dot2_f32_bf16 v231, v241, v241, v231
    v_dot2_f32_bf16 v228, v245, v234, v228
    v_dot2_f32_bf16 v232, v245, v245, v232
    v_dot2_f32_bf16 v229, v249, v234, v229
    v_dot2_f32_bf16 v233, v249, v249, v233
    v_dot2_f32_bf16 v226, v238, v234, v226
    v_dot2_f32_bf16 v230, v238, v238, v230
    v_dot2_f32_bf16 v227, v242, v234, v227
    v_dot2_f32_bf16 v231, v242, v242, v231
    v_dot2_f32_bf16 v228, v246, v234, v228
    v_dot2_f32_bf16 v232, v246, v246, v232
    v_dot2_f32_bf16 v229, v250, v234, v229
    v_dot2_f32_bf16 v233, v250, v250, v233
    v_dot2_f32_bf16 v226, v239, v234, v226
    v_dot2_f32_bf16 v230, v239, v239, v230
    v_dot2_f32_bf16 v227, v243, v234, v227
    v_dot2_f32_bf16 v231, v243, v243, v231
    v_dot2_f32_bf16 v228, v247, v234, v228
    v_dot2_f32_bf16 v232, v247, v247, v232
    v_dot2_f32_bf16 v229, v251, v234, v229
    v_dot2_f32_bf16 v233, v251, v251, v233
    s_lshl_b32 s55, s42, 9
    s_add_u32 s55, s55, 155648
    s_nop 1
    v_permlane32_swap_b32 v226, v228
    v_permlane32_swap_b32 v227, v229
    v_permlane32_swap_b32 v230, v232
    v_permlane32_swap_b32 v231, v233
    v_add_f32 v226, v226, v228
    v_add_f32 v227, v227, v229
    v_add_f32 v230, v230, v232
    v_add_f32 v231, v231, v233
    v_lshrrev_b32 v234, 1, v254
    v_add_u32 v234, s55, v234
    v_permlane16_swap_b32 v226, v227
    v_permlane16_swap_b32 v230, v231
    v_add_f32 v226, v226, v227
    v_add_f32 v227, v230, v231
    ds_write_b64 v234, v[226:227]
    s_mov_b32 s46, 1
    s_add_u32 s47, s47, 262144
    s_add_u32 s49, s49, 524288
    s_add_u32 s50, s50, 917504
    s_add_u32 s52, s52, 65536
    s_add_u32 s54, s54, 32768
    s_add_u32 s0, s0, 32768
    s_branch X_layer
X_fin:
    v_and_b32 v192, 0xf0, v254
    v_lshlrev_b32 v192, 7, v192
    v_and_b32 v193, 0x100, v254
    v_lshrrev_b32 v193, 3, v193
    v_add_u32 v192, v192, v193
    v_and_b32 v193, 0x200, v254
    v_lshrrev_b32 v193, 5, v193
    v_add_u32 v192, v192, v193
    s_lshl_b32 s55, s40, 18
    s_lshl_b32 s56, s43, 17
    s_add_u32 s55, s55, s56
    s_lshl_b32 s56, s51, 7
    s_add_u32 s55, s55, s56
    s_lshl_b32 s56, s44, 6
    s_add_u32 s55, s55, s56
    v_cvt_pk_bf16_f32 v0, v128, v129
    v_cvt_pk_bf16_f32 v1, v130, v131
    v_cvt_pk_bf16_f32 v2, v144, v145
    v_cvt_pk_bf16_f32 v3, v146, v147
    s_nop 1
    v_permlane16_swap_b32 v0, v2
    v_permlane16_swap_b32 v1, v3
    buffer_store_dwordx4 v[0:3], v192, s[28:31], s55 offen sc0 sc1
    s_add_u32 s55, s55, 32768
    v_cvt_pk_bf16_f32 v4, v132, v133
    v_cvt_pk_bf16_f32 v5, v134, v135
    v_cvt_pk_bf16_f32 v6, v148, v149
    v_cvt_pk_bf16_f32 v7, v150, v151
    s_nop 1
    v_permlane16_swap_b32 v4, v6
    v_permlane16_swap_b32 v5, v7
    buffer_store_dwordx4 v[4:7], v192, s[28:31], s55 offen sc0 sc1
    s_add_u32 s55, s55, 32768
    v_cvt_pk_bf16_f32 v8, v136, v137
    v_cvt_pk_bf16_f32 v9, v138, v139
    v_cvt_pk_bf16_f32 v10, v152, v153
    v_cvt_pk_bf16_f32 v11, v154, v155
    s_nop 1
    v_permlane16_swap_b32 v8, v10
    v_permlane16_swap_b32 v9, v11
    buffer_store_dwordx4 v[8:11], v192, s[28:31], s55 offen sc0 sc1
    s_add_u32 s55, s55, 32768
    v_cvt_pk_bf16_f32 v12, v140, v141
    v_cvt_pk_bf16_f32 v13, v142, v143
    v_cvt_pk_bf16_f32 v14, v156, v157
    v_cvt_pk_bf16_f32 v15, v158, v159
    s_nop 1
    v_permlane16_swap_b32 v12, v14
    v_permlane16_swap_b32 v13, v15
    buffer_store_dwordx4 v[12:15], v192, s[28:31], s55 offen sc0 sc1
    s_add_u32 s55, s55, 32768
    s_endpgm
Y_first:
    s_setprio 1
    s_waitcnt vmcnt(27)
    s_barrier
    s_waitcnt vmcnt(24)
    s_barrier
    s_add_u32 m0, s61, 0
    s_mul_i32 s59, s93, 96
    buffer_load_dwordx4 v200, s[8:11], s59 offen lds
    v_lshrrev_b32 v224, 7, v254
    v_and_b32 v225, 0x70, v254
    v_and_b32 v226, 6, v224
    v_lshlrev_b32 v226, 4, v226
    v_xor_b32 v225, v225, v226
    v_mul_u32_u24 v224, 2048, v224
    v_add3_u32 v203, v224, v225, s64
    buffer_load_dwordx4 v201, s[8:11], s59 offen offset:1024 lds
    v_add_u32 v204, 15360, v203
    v_add_u32 v205, 30720, v203
    v_add_u32 v206, 46080, v203
    v_and_b32 v225, 0xf0, v254
    v_lshrrev_b32 v224, 8, v254
    v_lshlrev_b32 v226, 5, v224
    v_xor_b32 v225, v225, v226
    buffer_load_dwordx4 v202, s[8:11], s59 offen offset:2048 lds
    s_add_u32 s93, s93, 2048
    s_and_b32 s93, s93, 65535
    v_mul_u32_u24 v224, 7168, v224
    v_add_u32 v224, s65, v224
    v_add_u32 v207, v224, v225
    v_xor_b32 v225, 0x80, v225
    v_add_u32 v224, v224, v225
    v_add_u32 v208, 27648, v224
    v_add_u32 v209, 55296, v207
    v_add_u32 v210, 55296, v208
    s_waitcnt vmcnt(17)
    s_barrier
    s_add_u32 m0, s91, 98304
    s_mov_b64 exec, s[84:85]
    buffer_load_dwordx4 v221, s[36:39], s94 offen lds
    s_mov_b64 exec, -1
    v_lshrrev_b32 v224, 7, v254
    v_and_b32 v225, 0x70, v254
    v_and_b32 v226, 6, v224
    s_add_u32 m0, s62, 100352
    s_nop 0
    buffer_load_dwordx4 v217, s[36:39], s94 offen lds
    v_lshlrev_b32 v226, 4, v226
    v_xor_b32 v225, v225, v226
    v_mul_u32_u24 v224, 7168, v224
    buffer_load_dwordx4 v218, s[36:39], s94 offen offset:1024 lds
    v_add3_u32 v211, v224, v225, s66
    v_add_u32 v212, 56320, v211
    v_add_u32 v222, s67, v254
    v_and_b32 v225, 0xf0, v254
    s_add_u32 m0, s61, 16384
    s_mul_i32 s59, s93, 96
    buffer_load_dwordx4 v200, s[8:11], s59 offen lds
    v_lshrrev_b32 v224, 8, v254
    v_lshlrev_b32 v226, 5, v224
    v_xor_b32 v225, v225, v226
    buffer_load_dwordx4 v201, s[8:11], s59 offen offset:1024 lds
    v_mul_u32_u24 v224, 2048, v224
    v_add_u32 v213, v224, v225
    v_xor_b32 v225, 0x80, v225
    buffer_load_dwordx4 v202, s[8:11], s59 offen offset:2048 lds
    s_add_u32 s93, s93, 6144
    s_and_b32 s93, s93, 65535
    v_add_u32 v224, v224, v225
    v_add_u32 v214, 7168, v224
    v_add_u32 v215, 14336, v213
    v_add_u32 v216, 14336, v214
    s_waitcnt vmcnt(15)
    s_barrier
    s_add_u32 m0, s62, 100352
    s_nop 0
    buffer_load_dwordx4 v219, s[36:39], s94 offen offset:2048 lds
    s_lshr_b32 s55, s2, 1
    s_cmp_lt_u32 s55, 56
    s_cselect_b32 s72, s80, s82
    s_cselect_b32 s73, s81, s83
    s_cselect_b32 s56, 0, 56
    s_sub_u32 s55, s55, s56
    s_lshl_b32 s76, s55, 7
    s_and_b32 s55, s2, 1
    s_lshl_b32 s55, s55, 2
    s_add_u32 s55, s55, s42
    s_mul_i32 s55, s55, 917504
    s_add_u32 s76, s76, s55
    s_cmp_lt_u32 s2, 224
    s_cselect_b32 s76, s76, 2130706432
    v_lshrrev_b32 v96, 7, v254
    buffer_load_dwordx4 v220, s[36:39], s94 offen offset:3072 lds
    s_add_u32 s94, s94, 256
    s_and_b32 s94, s94, 2047
    v_mul_u32_u24 v96, 7168, v96
    v_and_b32 v224, 0x70, v254
    s_add_u32 m0, s61, 32768
    s_mul_i32 s59, s93, 96
    buffer_load_dwordx4 v200, s[8:11], s59 offen lds
    v_add_u32 v96, v96, v224
    v_lshrrev_b32 v97, 6, v254
    v_mul_u32_u24 v97, 7168, v97
    buffer_load_dwordx4 v201, s[8:11], s59 offen offset:1024 lds
    v_lshrrev_b32 v224, 3, v254
    v_and_b32 v224, 0x20, v224
    buffer_load_dwordx4 v202, s[8:11], s59 offen offset:2048 lds
    s_add_u32 s93, s93, 2048
    s_and_b32 s93, s93, 65535
    v_and_b32 v225, 0x30, v254
    v_xor_b32 v224, v224, v225
    v_add_u32 v97, v97, v224
    s_cmp_lg_u32 s42, 1
    s_cbranch_scc1 hs_41
    v_mov_b32 v252, 0
    v_mov_b32 v253, 1
    s_lshl_b32 s55, s2, 2
    s_add_u32 s55, s55, 71565312
    s_mov_b64 exec, 1
    buffer_store_dword v253, v252, s[4:7], s55 offen sc0 sc1
    s_mov_b64 exec, -1
hs_41:
    s_waitcnt vmcnt(17)
    s_barrier
    s_add_u32 m0, s91, 116736
    s_mov_b64 exec, s[84:85]
    buffer_load_dwordx4 v221, s[36:39], s94 offen lds
    s_mov_b64 exec, -1
    s_add_u32 m0, s62, 118784
    s_nop 0
    buffer_load_dwordx4 v217, s[36:39], s94 offen lds
    buffer_load_dwordx4 v218, s[36:39], s94 offen offset:1024 lds
    s_add_u32 m0, s61, 49152
    s_mul_i32 s59, s93, 96
    buffer_load_dwordx4 v200, s[8:11], s59 offen lds
    buffer_load_dwordx4 v201, s[8:11], s59 offen offset:1024 lds
    buffer_load_dwordx4 v202, s[8:11], s59 offen offset:2048 lds
    s_add_u32 s93, s93, 6144
    s_and_b32 s93, s93, 65535
    s_getreg_b32 s77, hwreg(HW_REG_XCC_ID, 0, 4)
    s_mul_i32 s55, s77, s77
    s_lshl_b32 s55, s55, 15
    s_lshl_b32 s77, s77, 6
    s_add_u32 s77, s77, s55
    s_add_u32 s77, s77, 1
    s_waitcnt vmcnt(20)
    s_barrier
    s_add_u32 m0, s62, 118784
    s_nop 0
    buffer_load_dwordx4 v219, s[36:39], s94 offen offset:2048 lds
    buffer_load_dwordx4 v220, s[36:39], s94 offen offset:3072 lds
    s_add_u32 s94, s94, 256
    s_and_b32 s94, s94, 2047
    s_add_u32 m0, s61, 65536
    s_mul_i32 s59, s93, 96
    buffer_load_dwordx4 v200, s[8:11], s59 offen lds
    buffer_load_dwordx4 v201, s[8:11], s59 offen offset:1024 lds
    buffer_load_dwordx4 v202, s[8:11], s59 offen offset:2048 lds
    s_add_u32 s93, s93, 2048
    s_and_b32 s93, s93, 65535
    s_waitcnt vmcnt(14)
    s_barrier
    s_add_u32 m0, s91, 135168
    s_mov_b64 exec, s[84:85]
    buffer_load_dwordx4 v221, s[36:39], s94 offen lds
    s_mov_b64 exec, -1
    s_add_u32 m0, s62, 137216
    s_nop 0
    buffer_load_dwordx4 v217, s[36:39], s94 offen lds
    buffer_load_dwordx4 v218, s[36:39], s94 offen offset:1024 lds
    s_add_u32 m0, s61, 81920
    s_mul_i32 s59, s93, 96
    buffer_load_dwordx4 v200, s[8:11], s59 offen lds
    buffer_load_dwordx4 v201, s[8:11], s59 offen offset:1024 lds
    buffer_load_dwordx4 v202, s[8:11], s59 offen offset:2048 lds
    s_add_u32 s93, s93, 6144
    s_and_b32 s93, s93, 65535
    s_barrier
    s_add_u32 m0, s62, 137216
    s_nop 0
    buffer_load_dwordx4 v219, s[36:39], s94 offen offset:2048 lds
    buffer_load_dwordx4 v220, s[36:39], s94 offen offset:3072 lds
    s_add_u32 s94, s94, 256
    s_and_b32 s94, s94, 2047
    v_lshrrev_b32 v99, 8, v254
    v_mul_u32_u24 v99, 7168, v99
    v_and_b32 v224, 0xf0, v254
    v_add_u32 v99, v99, v224
    s_mul_i32 s55, s2, 28672
    v_add_u32 v99, s55, v99
    s_add_u32 m0, s61, 0
    s_mul_i32 s59, s93, 96
    buffer_load_dwordx4 v200, s[8:11], s59 offen lds
    s_cmp_eq_u32 s44, 0
    s_movk_i32 s55, 1408
    s_cselect_b32 s55, s55, 4480
    buffer_load_dwordx4 v[104:107], v99, s[16:19], s55 offen
    buffer_load_dwordx4 v201, s[8:11], s59 offen offset:1024 lds
    s_cmp_eq_u32 s44, 0
    s_movk_i32 s55, 2432
    s_cselect_b32 s55, s55, 5376
    buffer_load_dwordx4 v[108:111], v99, s[16:19], s55 offen
    buffer_load_dwordx4 v202, s[8:11], s59 offen offset:2048 lds
    s_add_u32 s93, s93, 2048
    s_and_b32 s93, s93, 65535
    s_cmp_eq_u32 s44, 0
    s_movk_i32 s55, 3328
    s_cselect_b32 s55, s55, 6528
    buffer_load_dwordx4 v[112:115], v99, s[16:19], s55 offen
    s_waitcnt vmcnt(17)
    s_barrier
    s_add_u32 m0, s91, 98304
    s_mov_b64 exec, s[84:85]
    buffer_load_dwordx4 v221, s[36:39], s94 offen lds
    s_mov_b64 exec, -1
    s_add_u32 m0, s62, 100352
    s_nop 0
    buffer_load_dwordx4 v217, s[36:39], s94 offen lds
    buffer_load_dwordx4 v218, s[36:39], s94 offen offset:1024 lds
    s_add_u32 m0, s61, 16384
    s_mul_i32 s59, s93, 96
    buffer_load_dwordx4 v200, s[8:11], s59 offen lds
    buffer_load_dwordx4 v201, s[8:11], s59 offen offset:1024 lds
    buffer_load_dwordx4 v202, s[8:11], s59 offen offset:2048 lds
    s_add_u32 s93, s93, 6144
    s_and_b32 s93, s93, 65535
    s_barrier
    s_add_u32 m0, s62, 100352
    s_nop 0
    buffer_load_dwordx4 v219, s[36:39], s94 offen offset:2048 lds
    buffer_load_dwordx4 v220, s[36:39], s94 offen offset:3072 lds
    s_add_u32 s94, s94, 256
    s_and_b32 s94, s94, 2047
    s_lshr_b32 s55, s2, 3
    s_lshl_b32 s55, s55, 1
    s_add_u32 s55, s55, s44
    s_and_b32 s56, s2, 7
    s_lshl_b32 s78, s43, 3
    s_add_u32 s78, s78, s56
    s_lshl_b32 s78, s78, 7
    s_add_u32 s78, s78, s55
    s_lshl_b32 s78, s78, 10
    s_add_u32 s78, s78, 67108864
    s_mul_i32 s55, s55, 114688
    s_mul_i32 s56, s56, 896
    s_add_u32 s70, s55, s56
    s_add_u32 m0, s61, 32768
    s_mul_i32 s59, s93, 96
    buffer_load_dwordx4 v200, s[8:11], s59 offen lds
    buffer_load_dwordx4 v201, s[8:11], s59 offen offset:1024 lds
    buffer_load_dwordx4 v[64:67], v97, s[16:19], s70 offen offset:384
    buffer_load_dwordx4 v202, s[8:11], s59 offen offset:2048 lds
    s_add_u32 s93, s93, 2048
    s_and_b32 s93, s93, 65535
    buffer_load_dwordx4 v[68:71], v97, s[16:19], s70 offen offset:448
    s_waitcnt vmcnt(19)
    s_barrier
    s_add_u32 m0, s91, 116736
    s_mov_b64 exec, s[84:85]
    buffer_load_dwordx4 v221, s[36:39], s94 offen lds
    s_mov_b64 exec, -1
    s_add_u32 m0, s62, 118784
    s_nop 0
    buffer_load_dwordx4 v217, s[36:39], s94 offen lds
    buffer_load_dwordx4 v218, s[36:39], s94 offen offset:1024 lds
    s_add_u32 m0, s61, 49152
    s_mul_i32 s59, s93, 96
    buffer_load_dwordx4 v200, s[8:11], s59 offen lds
    buffer_load_dwordx4 v201, s[8:11], s59 offen offset:1024 lds
    buffer_load_dwordx4 v202, s[8:11], s59 offen offset:2048 lds
    s_add_u32 s93, s93, 10240
    s_and_b32 s93, s93, 65535
    s_barrier
    s_waitcnt vmcnt(19)
    s_add_u32 m0, s62, 118784
    s_nop 0
    buffer_load_dwordx4 v219, s[36:39], s94 offen offset:2048 lds
    buffer_load_dwordx4 v220, s[36:39], s94 offen offset:3072 lds
    s_add_u32 s94, s94, 384
    s_and_b32 s94, s94, 2047
    s_cmp_eq_u32 s44, 0
    s_movk_i32 s55, 1408
    s_cselect_b32 s55, s55, 4480
    s_lshl_b32 s56, s43, 23
    s_add_u32 s55, s55, s56
    s_add_u32 s55, s55, 83886336
    buffer_store_dwordx4 v[104:107], v99, s[4:7], s55 offen sc0 sc1
    s_add_u32 m0, s61, 65536
    s_mul_i32 s59, s93, 96
    buffer_load_dwordx4 v200, s[8:11], s59 offen lds
    buffer_load_dwordx4 v201, s[8:11], s59 offen offset:1024 lds
    s_cmp_eq_u32 s44, 0
    s_movk_i32 s55, 2432
    s_cselect_b32 s55, s55, 5376
    s_lshl_b32 s56, s43, 23
    s_add_u32 s55, s55, s56
    s_add_u32 s55, s55, 83886336
    buffer_store_dwordx4 v[108:111], v99, s[4:7], s55 offen sc0 sc1
    buffer_load_dwordx4 v202, s[8:11], s59 offen offset:2048 lds
    s_add_u32 s93, s93, 2048
    s_and_b32 s93, s93, 65535
    s_cmp_eq_u32 s44, 0
    s_movk_i32 s55, 3328
    s_cselect_b32 s55, s55, 6528
    s_lshl_b32 s56, s43, 23
    s_add_u32 s55, s55, s56
    s_add_u32 s55, s55, 83886336
    buffer_store_dwordx4 v[112:115], v99, s[4:7], s55 offen sc0 sc1
    buffer_load_dwordx4 v[0:3], v96, s[72:75], s76 offen
    s_add_u32 s76, s76, 57344
    s_waitcnt vmcnt(20)
    s_barrier
    s_add_u32 m0, s91, 135168
    s_mov_b64 exec, s[84:85]
    buffer_load_dwordx4 v221, s[36:39], s94 offen lds
    s_mov_b64 exec, -1
    s_add_u32 m0, s62, 137216
    s_nop 0
    buffer_load_dwordx4 v217, s[36:39], s94 offen lds
    buffer_load_dwordx4 v218, s[36:39], s94 offen offset:1024 lds
    s_add_u32 m0, s61, 81920
    s_mul_i32 s59, s93, 96
    buffer_load_dwordx4 v200, s[8:11], s59 offen lds
    buffer_load_dwordx4 v201, s[8:11], s59 offen offset:1024 lds
    buffer_load_dwordx4 v202, s[8:11], s59 offen offset:2048 lds
    s_add_u32 s93, s93, 6144
    s_and_b32 s93, s93, 65535
    buffer_load_dwordx4 v[4:7], v96, s[72:75], s76 offen
    s_add_u32 s76, s76, 57344
    s_barrier
    s_waitcnt vmcnt(22)
    s_add_u32 m0, s62, 137216
    s_nop 0
    buffer_load_dwordx4 v219, s[36:39], s94 offen offset:2048 lds
    buffer_load_dwordx4 v220, s[36:39], s94 offen offset:3072 lds
    s_add_u32 s94, s94, 256
    s_and_b32 s94, s94, 2047
    s_add_u32 m0, s61, 0
    s_mul_i32 s59, s93, 96
    buffer_load_dwordx4 v200, s[8:11], s59 offen lds
    buffer_store_dwordx4 v[64:67], v254, s[4:7], s78 offen sc0 sc1
    s_add_u32 s78, s78, 65536
    buffer_load_dwordx4 v201, s[8:11], s59 offen offset:1024 lds
    buffer_load_dwordx4 v202, s[8:11], s59 offen offset:2048 lds
    s_add_u32 s93, s93, 2048
    s_and_b32 s93, s93, 65535
    buffer_store_dwordx4 v[68:71], v254, s[4:7], s78 offen sc0 sc1
    s_add_u32 s78, s78, 65536
    buffer_load_dwordx4 v[8:11], v96, s[72:75], s76 offen
    s_add_u32 s76, s76, 57344
    s_waitcnt vmcnt(22)
    s_barrier
    v_lshlrev_b32 v227, 1, v254
    v_and_b32 v227, 0xff, v227
    buffer_load_dword v98, v227, s[32:35], 0 offen sc0 sc1
    s_add_u32 m0, s91, 98304
    s_mov_b64 exec, s[84:85]
    buffer_load_dwordx4 v221, s[36:39], s94 offen lds
    s_mov_b64 exec, -1
    s_add_u32 m0, s62, 100352
    s_nop 0
    buffer_load_dwordx4 v217, s[36:39], s94 offen lds
    buffer_load_dwordx4 v218, s[36:39], s94 offen offset:1024 lds
    s_add_u32 m0, s61, 16384
    s_mul_i32 s59, s93, 96
    buffer_load_dwordx4 v200, s[8:11], s59 offen lds
    buffer_load_dwordx4 v201, s[8:11], s59 offen offset:1024 lds
    buffer_load_dwordx4 v202, s[8:11], s59 offen offset:2048 lds
    s_add_u32 s93, s93, 6144
    s_and_b32 s93, s93, 65535
    buffer_load_dwordx4 v[12:15], v96, s[72:75], s76 offen
    s_add_u32 s76, s76, 57344
    s_barrier
    s_add_u32 m0, s62, 100352
    s_nop 0
    buffer_load_dwordx4 v219, s[36:39], s94 offen offset:2048 lds
    buffer_load_dwordx4 v220, s[36:39], s94 offen offset:3072 lds
    s_add_u32 s94, s94, 256
    s_and_b32 s94, s94, 2047
    s_add_u32 m0, s61, 32768
    s_mul_i32 s59, s93, 96
    buffer_load_dwordx4 v200, s[8:11], s59 offen lds
    buffer_load_dwordx4 v201, s[8:11], s59 offen offset:1024 lds
    buffer_load_dwordx4 v202, s[8:11], s59 offen offset:2048 lds
    s_add_u32 s93, s93, 2048
    s_and_b32 s93, s93, 65535
    buffer_load_dwordx4 v[16:19], v96, s[72:75], s76 offen
    s_add_u32 s76, s76, 57344
    s_waitcnt vmcnt(20)
    s_barrier
    s_add_u32 m0, s91, 116736
    s_mov_b64 exec, s[84:85]
    buffer_load_dwordx4 v221, s[36:39], s94 offen lds
    s_mov_b64 exec, -1
    s_add_u32 m0, s62, 118784
    s_nop 0
    buffer_load_dwordx4 v217, s[36:39], s94 offen lds
    buffer_load_dwordx4 v218, s[36:39], s94 offen offset:1024 lds
    s_add_u32 m0, s61, 49152
    s_mul_i32 s59, s93, 96
    buffer_load_dwordx4 v200, s[8:11], s59 offen lds
    buffer_load_dwordx4 v201, s[8:11], s59 offen offset:1024 lds
    buffer_load_dwordx4 v202, s[8:11], s59 offen offset:2048 lds
    s_add_u32 s93, s93, 6144
    s_and_b32 s93, s93, 65535
    buffer_load_dwordx4 v[20:23], v96, s[72:75], s76 offen
    s_add_u32 s76, s76, 57344
    s_barrier
    s_waitcnt vmcnt(20)
    s_mov_b32 s56, 262144
hs_42:
    v_and_b32 v225, 63, v98
    v_cmp_ne_u32 vcc, 32, v225
    s_cbranch_vccz hs_43
    buffer_load_dword v98, v227, s[32:35], 0 offen sc0 sc1
    s_waitcnt vmcnt(0)
    s_sub_u32 s56, s56, 1
    s_cmp_lg_u32 s56, 0
    s_cbranch_scc1 hs_42
hs_43:
    s_mov_b32 s55, 71565312
    buffer_load_dwordx4 v[72:75], v254, s[4:7], s55 offen sc0 sc1
    s_add_u32 m0, s62, 118784
    s_nop 0
    buffer_load_dwordx4 v219, s[36:39], s94 offen offset:2048 lds
    buffer_load_dwordx4 v220, s[36:39], s94 offen offset:3072 lds
    s_add_u32 s94, s94, 256
    s_and_b32 s94, s94, 2047
    s_add_u32 m0, s61, 65536
    s_mul_i32 s59, s93, 96
    buffer_load_dwordx4 v200, s[8:11], s59 offen lds
    buffer_load_dwordx4 v201, s[8:11], s59 offen offset:1024 lds
    buffer_load_dwordx4 v202, s[8:11], s59 offen offset:2048 lds
    s_add_u32 s93, s93, 2048
    s_and_b32 s93, s93, 65535
    s_and_b32 s55, s2, 7
    s_lshl_b32 s56, s77, 5
    v_readlane_b32 s55, v98, s55
    s_nop 3
    s_cmp_lg_u32 s55, s56
    s_cselect_b32 s45, 1, 0
    v_mov_b32 v224, 163712
    v_mov_b32 v225, s45
    ds_write_b32 v224, v225
    buffer_load_dwordx4 v[24:27], v96, s[72:75], s76 offen
    s_add_u32 s76, s76, 57344
    s_waitcnt vmcnt(18)
    s_barrier
    s_add_u32 m0, s91, 135168
    s_mov_b64 exec, s[84:85]
    buffer_load_dwordx4 v221, s[36:39], s94 offen lds
    s_mov_b64 exec, -1
    v_and_b32 v226, 0xf0, v254
    s_add_u32 m0, s62, 137216
    s_nop 0
    buffer_load_dwordx4 v217, s[36:39], s94 offen lds
    v_min_u32 v226, 0xb0, v226
    s_mul_i32 s55, s42, 192
    v_add_u32 v226, s55, v226
    buffer_load_dwordx4 v218, s[36:39], s94 offen offset:1024 lds
    v_lshrrev_b32 v224, 8, v226
    s_add_u32 m0, s61, 81920
    s_mul_i32 s59, s93, 96
    buffer_load_dwordx4 v200, s[8:11], s59 offen lds
    v_and_b32 v225, 0xff, v226
    v_lshl_add_u32 v224, v224, 12, v225
    buffer_load_dwordx4 v201, s[8:11], s59 offen offset:1024 lds
    v_lshrrev_b32 v225, 8, v254
    buffer_load_dwordx4 v202, s[8:11], s59 offen offset:2048 lds
    s_add_u32 s93, s93, 6144
    s_and_b32 s93, s93, 65535
    v_mul_u32_u24 v225, 12288, v225
    v_add_u32 v227, v224, v225
    buffer_load_dwordx4 v[28:31], v96, s[72:75], s76 offen
    s_add_u32 s76, s76, 57344
    s_barrier
    s_add_u32 m0, s62, 137216
    s_nop 0
    buffer_load_dwordx4 v219, s[36:39], s94 offen offset:2048 lds
    buffer_load_dwordx4 v220, s[36:39], s94 offen offset:3072 lds
    s_add_u32 s94, s94, 256
    s_and_b32 s94, s94, 2047
    s_add_u32 m0, s61, 0
    s_mul_i32 s59, s93, 96
    buffer_load_dwordx4 v200, s[8:11], s59 offen lds
    buffer_load_dwordx4 v201, s[8:11], s59 offen offset:1024 lds
    buffer_load_dwordx4 v202, s[8:11], s59 offen offset:2048 lds
    s_add_u32 s93, s93, 2048
    s_and_b32 s93, s93, 65535
    s_cmp_lg_u32 s42, 2
    s_cbranch_scc1 hs_44
    v_mov_b32 v252, 0
    v_mov_b32 v253, 1
    s_lshl_b32 s55, s2, 2
    s_add_u32 s55, s55, 71567360
    s_mov_b64 exec, 1
    buffer_store_dword v253, v252, s[4:7], s55 offen sc0 sc1
    s_mov_b64 exec, -1
hs_44:
    buffer_load_dwordx4 v[32:35], v96, s[72:75], s76 offen
    s_add_u32 s76, s76, 57344
    s_waitcnt vmcnt(17)
    s_barrier
    v_and_b32 v72, v72, v73
    v_and_b32 v74, v74, v75
    v_and_b32 v72, v72, v74
    v_cmp_ne_u32 vcc, 1, v72
    s_cbranch_vccz a4_45
    s_mov_b32 s55, 71565312
    s_mov_b32 s56, 262144
p4_46:
    buffer_load_dwordx4 v[72:75], v254, s[4:7], s55 offen sc0 sc1
    s_waitcnt vmcnt(0)
    v_and_b32 v72, v72, v73
    v_and_b32 v74, v74, v75
    v_and_b32 v72, v72, v74
    v_cmp_ne_u32 vcc, 1, v72
    s_cbranch_vccz p4_47
    s_sleep 1
    s_sub_u32 s56, s56, 1
    s_cmp_lg_u32 s56, 0
    s_cbranch_scc1 p4_46
p4_47:
a4_45:
    s_add_u32 m0, s91, 98304
    s_mov_b64 exec, s[84:85]
    buffer_load_dwordx4 v221, s[36:39], s94 offen lds
    s_mov_b64 exec, -1
    s_add_u32 m0, s62, 100352
    s_nop 0
    buffer_load_dwordx4 v217, s[36:39], s94 offen lds
    v_lshrrev_b32 v224, 1, v254
    s_lshl_b32 s55, s40, 10
    s_mul_i32 s56, s42, 288
    s_add_u32 s55, s55, s56
    s_add_u32 s55, s55, 70254464
    buffer_load_dwordx2 v[72:73], v224, s[4:7], s55 offen sc1
    s_lshl_b32 s70, s51, 8
    s_add_u32 s70, s70, 70516736
    buffer_load_dwordx4 v218, s[36:39], s94 offen offset:1024 lds
    s_add_u32 m0, s61, 16384
    s_mul_i32 s59, s93, 96
    buffer_load_dwordx4 v200, s[8:11], s59 offen lds
    buffer_load_dwordx4 v[76:79], v227, s[4:7], s70 offen sc1
    s_add_u32 s70, s70, 49152
    buffer_load_dwordx4 v201, s[8:11], s59 offen offset:1024 lds
    buffer_load_dwordx4 v202, s[8:11], s59 offen offset:2048 lds
    s_add_u32 s93, s93, 6144
    s_and_b32 s93, s93, 65535
    buffer_load_dwordx4 v[80:83], v227, s[4:7], s70 offen sc1
    s_add_u32 s70, s70, 49152
    buffer_load_dwordx4 v[36:39], v96, s[72:75], s76 offen
    s_add_u32 s76, s76, 57344
    s_barrier
    s_add_u32 m0, s62, 100352
    s_nop 0
    buffer_load_dwordx4 v219, s[36:39], s94 offen offset:2048 lds
    buffer_load_dwordx4 v220, s[36:39], s94 offen offset:3072 lds
    s_add_u32 s94, s94, 256
    s_and_b32 s94, s94, 2047
    s_add_u32 m0, s61, 32768
    s_mul_i32 s59, s93, 96
    buffer_load_dwordx4 v200, s[8:11], s59 offen lds
    buffer_load_dwordx4 v[84:87], v227, s[4:7], s70 offen sc1
    s_add_u32 s70, s70, 49152
    buffer_load_dwordx4 v201, s[8:11], s59 offen offset:1024 lds
    buffer_load_dwordx4 v202, s[8:11], s59 offen offset:2048 lds
    s_add_u32 s93, s93, 2048
    s_and_b32 s93, s93, 65535
    buffer_load_dwordx4 v[88:91], v227, s[4:7], s70 offen sc1
    s_add_u32 s70, s70, 49152
    buffer_load_dwordx4 v[40:43], v96, s[72:75], s76 offen
    s_add_u32 s76, s76, 57344
    s_waitcnt vmcnt(22)
    s_barrier
    s_add_u32 m0, s91, 116736
    s_mov_b64 exec, s[84:85]
    buffer_load_dwordx4 v221, s[36:39], s94 offen lds
    s_mov_b64 exec, -1
    s_add_u32 m0, s62, 118784
    s_nop 0
    buffer_load_dwordx4 v217, s[36:39], s94 offen lds
    buffer_load_dwordx4 v218, s[36:39], s94 offen offset:1024 lds
    s_add_u32 m0, s61, 49152
    s_mul_i32 s59, s93, 96
    buffer_load_dwordx4 v200, s[8:11], s59 offen lds
    buffer_load_dwordx4 v201, s[8:11], s59 offen offset:1024 lds
    buffer_load_dwordx4 v202, s[8:11], s59 offen offset:2048 lds
    s_add_u32 s93, s93, 6144
    s_and_b32 s93, s93, 65535
    buffer_load_dwordx4 v[44:47], v96, s[72:75], s76 offen
    s_add_u32 s76, s76, 57344
    s_barrier
    s_add_u32 m0, s62, 118784
    s_nop 0
    buffer_load_dwordx4 v219, s[36:39], s94 offen offset:2048 lds
    buffer_load_dwordx4 v220, s[36:39], s94 offen offset:3072 lds
    s_add_u32 s94, s94, 256
    s_and_b32 s94, s94, 2047
    s_add_u32 m0, s61, 65536
    s_mul_i32 s59, s93, 96
    buffer_load_dwordx4 v200, s[8:11], s59 offen lds
    buffer_load_dwordx4 v201, s[8:11], s59 offen offset:1024 lds
    buffer_load_dwordx4 v202, s[8:11], s59 offen offset:2048 lds
    s_add_u32 s93, s93, 2048
    s_and_b32 s93, s93, 65535
    buffer_load_dwordx4 v[48:51], v96, s[72:75], s76 offen
    s_add_u32 s76, s76, 57344
    s_waitcnt vmcnt(19)
    s_barrier
    s_add_u32 m0, s91, 135168
    s_mov_b64 exec, s[84:85]
    buffer_load_dwordx4 v221, s[36:39], s94 offen lds
    s_mov_b64 exec, -1
    s_or_b32 s55, s40, s42
    s_cmp_eq_u32 s55, 0
    s_cselect_b32 s70, 0xffff, 0
    s_mov_b32 s71, 0
    v_cndmask_b32 v72, v72, 0, s[70:71]
    v_cndmask_b32 v73, v73, 0, s[70:71]
    v_mul_f32 v72, 0x3a800000, v72
    v_mul_f32 v73, 0x3a800000, v73
    s_add_u32 m0, s62, 137216
    s_nop 0
    buffer_load_dwordx4 v217, s[36:39], s94 offen lds
    v_fma_f32 v73, -v72, v72, v73
    v_max_f32 v73, 0, v73
    v_cvt_pk_bf16_f32 v72, v72, v72
    buffer_load_dwordx4 v218, s[36:39], s94 offen offset:1024 lds
    v_lshlrev_b32 v72, 16, v72
    v_cvt_pk_bf16_f32 v73, v73, v73
    v_lshlrev_b32 v73, 16, v73
    s_add_u32 m0, s61, 81920
    s_mul_i32 s59, s93, 96
    buffer_load_dwordx4 v200, s[8:11], s59 offen lds
    v_add_f32 v73, 0x3727c5ac, v73
    v_cvt_pk_bf16_f32 v73, v73, v73
    v_lshlrev_b32 v73, 16, v73
    buffer_load_dwordx4 v201, s[8:11], s59 offen offset:1024 lds
    v_sqrt_f32 v73, v73
    s_nop 0
    v_cvt_pk_bf16_f32 v73, v73, v73
    buffer_load_dwordx4 v202, s[8:11], s59 offen offset:2048 lds
    s_add_u32 s93, s93, 6144
    s_and_b32 s93, s93, 65535
    v_lshlrev_b32 v73, 16, v73
    v_rcp_f32 v73, v73
    s_nop 0
    buffer_load_dwordx4 v[52:55], v96, s[72:75], s76 offen
    s_add_u32 s76, s76, 57344
    s_barrier
    s_waitcnt vmcnt(21)
    s_add_u32 m0, s62, 137216
    s_nop 0
    buffer_load_dwordx4 v219, s[36:39], s94 offen offset:2048 lds
    v_lshrrev_b32 v224, 2, v254
    s_mul_i32 s55, s42, 144
    s_add_u32 s55, s55, 159744
    v_add_u32 v224, s55, v224
    v_sub_f32 v72, 0, v72
    s_mov_b32 s70, -1
    s_mov_b32 s71, 0xf
    s_mov_b64 exec, s[70:71]
    ds_write_b32 v224, v72
    ds_write_b32 v224, v73 offset:576
    s_mov_b64 exec, -1
    v_add_f32 v76, v76, v80
    buffer_load_dwordx4 v220, s[36:39], s94 offen offset:3072 lds
    s_add_u32 s94, s94, 256
    s_and_b32 s94, s94, 2047
    v_add_f32 v77, v77, v81
    v_add_f32 v78, v78, v82
    v_add_f32 v79, v79, v83
    s_add_u32 m0, s61, 0
    s_mul_i32 s59, s93, 96
    buffer_load_dwordx4 v200, s[8:11], s59 offen lds
    v_add_f32 v84, v84, v88
    v_add_f32 v85, v85, v89
    buffer_load_dwordx4 v201, s[8:11], s59 offen offset:1024 lds
    v_add_f32 v86, v86, v90
    v_add_f32 v87, v87, v91
    v_add_f32 v76, v76, v84
    buffer_load_dwordx4 v202, s[8:11], s59 offen offset:2048 lds
    s_add_u32 s93, s93, 2048
    s_and_b32 s93, s93, 65535
    v_add_f32 v77, v77, v85
    v_add_f32 v78, v78, v86
    v_add_f32 v79, v79, v87
    buffer_load_dwordx4 v[56:59], v96, s[72:75], s76 offen
    s_add_u32 s76, s76, 57344
    s_waitcnt vmcnt(17)
    s_barrier
    s_add_u32 m0, s91, 98304
    s_mov_b64 exec, s[84:85]
    buffer_load_dwordx4 v221, s[36:39], s94 offen lds
    s_mov_b64 exec, -1
    v_mov_b32 v80, v76
    v_mov_b32 v81, v77
    v_mov_b32 v82, v78
    v_mov_b32 v83, v79
    s_add_u32 m0, s62, 100352
    s_nop 0
    buffer_load_dwordx4 v217, s[36:39], s94 offen lds
    s_nop 1
    v_permlane16_swap_b32 v76, v80
    v_permlane16_swap_b32 v77, v81
    v_permlane16_swap_b32 v78, v82
    v_permlane16_swap_b32 v79, v83
    buffer_load_dwordx4 v218, s[36:39], s94 offen offset:1024 lds
    v_add_f32 v76, v76, v80
    v_add_f32 v77, v77, v81
    v_add_f32 v78, v78, v82
    v_add_f32 v79, v79, v83
    v_mov_b32 v80, v76
    s_add_u32 m0, s61, 16384
    s_mul_i32 s59, s93, 96
    buffer_load_dwordx4 v200, s[8:11], s59 offen lds
    v_mov_b32 v81, v77
    v_mov_b32 v82, v78
    v_mov_b32 v83, v79
    s_nop 1
    buffer_load_dwordx4 v201, s[8:11], s59 offen offset:1024 lds
    v_permlane32_swap_b32 v76, v80
    v_permlane32_swap_b32 v77, v81
    v_permlane32_swap_b32 v78, v82
    v_permlane32_swap_b32 v79, v83
    v_add_f32 v76, v76, v80
    buffer_load_dwordx4 v202, s[8:11], s59 offen offset:2048 lds
    v_add_f32 v77, v77, v81
    v_add_f32 v78, v78, v82
    v_add_f32 v79, v79, v83
    v_add_u32 v226, 160896, v226
    ds_write_b128 v226, v[76:79]
    buffer_load_dwordx4 v[60:63], v96, s[72:75], s76 offen
    s_add_u32 s76, s76, 57344
    s_barrier
    s_add_u32 m0, s62, 100352
    s_nop 0
    buffer_load_dwordx4 v219, s[36:39], s94 offen offset:2048 lds
    buffer_load_dwordx4 v220, s[36:39], s94 offen offset:3072 lds
    s_lshl_b32 s93, s43, 1
    s_add_u32 s93, s51, s93
    s_and_b32 s93, s93, 15
    s_add_u32 m0, s62, 32768
    s_lshl_b32 s93, s93, 17
    buffer_load_dwordx4 v203, s[12:15], s93 offen lds
    buffer_load_dwordx4 v204, s[12:15], s93 offen offset:1024 lds
    buffer_load_dwordx4 v205, s[12:15], s93 offen offset:2048 lds
    buffer_load_dwordx4 v206, s[12:15], s93 offen offset:3072 lds
    s_add_u32 s93, s93, 524288
    s_and_b32 s93, s93, 2097151
    s_waitcnt vmcnt(17)
    s_barrier
    s_add_u32 m0, s62, 49152
    s_nop 0
    buffer_load_dwordx4 v203, s[12:15], s93 offen lds
    buffer_load_dwordx4 v204, s[12:15], s93 offen offset:1024 lds
    buffer_load_dwordx4 v205, s[12:15], s93 offen offset:2048 lds
    buffer_load_dwordx4 v206, s[12:15], s93 offen offset:3072 lds
    s_add_u32 s93, s93, 524288
    s_and_b32 s93, s93, 2097151
    s_barrier
    s_add_u32 m0, s62, 65536
    s_nop 0
    buffer_load_dwordx4 v203, s[12:15], s93 offen lds
    buffer_load_dwordx4 v204, s[12:15], s93 offen offset:1024 lds
    buffer_load_dwordx4 v205, s[12:15], s93 offen offset:2048 lds
    buffer_load_dwordx4 v206, s[12:15], s93 offen offset:3072 lds
    s_add_u32 s93, s93, 524288
    s_and_b32 s93, s93, 2097151
    s_waitcnt vmcnt(12)
    s_barrier
    s_add_u32 m0, s62, 81920
    s_nop 0
    buffer_load_dwordx4 v203, s[12:15], s93 offen lds
    buffer_load_dwordx4 v204, s[12:15], s93 offen offset:1024 lds
    buffer_load_dwordx4 v205, s[12:15], s93 offen offset:2048 lds
    buffer_load_dwordx4 v206, s[12:15], s93 offen offset:3072 lds
    s_add_u32 s93, s93, 655360
    s_and_b32 s93, s93, 2097151
    s_barrier
    s_add_u32 m0, s62, 0
    s_nop 0
    buffer_load_dwordx4 v203, s[12:15], s93 offen lds
    buffer_load_dwordx4 v204, s[12:15], s93 offen offset:1024 lds
    buffer_load_dwordx4 v205, s[12:15], s93 offen offset:2048 lds
    buffer_load_dwordx4 v206, s[12:15], s93 offen offset:3072 lds
    s_add_u32 s93, s93, 524288
    s_and_b32 s93, s93, 2097151
    s_waitcnt lgkmcnt(0)
    s_barrier
    s_add_u32 m0, s62, 16384
    s_nop 0
    buffer_load_dwordx4 v203, s[12:15], s93 offen lds
    buffer_load_dwordx4 v204, s[12:15], s93 offen offset:1024 lds
    buffer_load_dwordx4 v205, s[12:15], s93 offen offset:2048 lds
    buffer_load_dwordx4 v206, s[12:15], s93 offen offset:3072 lds
    s_add_u32 s93, s93, 524288
    s_and_b32 s93, s93, 2097151
    s_setprio 0
    s_branch Y_g2
Y_layer:
    s_mov_b32 s36, s4
    s_mov_b32 s37, s5
    s_mov_b32 s38, s6
    s_mov_b32 s39, s7
    s_add_u32 s88, s48, s62
    s_lshl_b32 s56, s43, 10
    s_add_u32 s89, s48, s56
    s_sub_u32 s89, s89, 4179968
    v_add_u32 v217, s88, v254
    s_lshl_b32 s94, s51, 14
    s_cmp_eq_u32 s40, 0
    s_cselect_b32 s89, 2130706432, s89
    s_sub_u32 s89, s89, s88
    v_add_u32 v221, s89, v217
    s_lshl_b32 s91, s43, 10
    s_cmp_eq_u32 s44, 0
    s_cselect_b32 s84, -1, 0
    s_not_b32 s85, s84
    s_add_u32 s59, s0, 4294967232
    s_add_u32 s60, s54, 8064
    s_and_b32 s55, s40, 3
    s_cselect_b32 s59, s59, s60
    s_cselect_b32 s60, 28, 60
    s_add_u32 s55, s0, 64
    s_cmp_eq_u32 s40, 0
    s_cselect_b32 s59, s55, s59
    s_cselect_b32 s60, 28, s60
    v_lshrrev_b32 v224, 2, v254
    v_and_b32 v224, 60, v224
    v_min_u32 v225, s60, v224
    v_add_u32 v225, s59, v225
    v_min_u32 v224, 28, v224
    v_add_u32 v224, s55, v224
    v_cmp_gt_u32 vcc, 256, v254
    v_lshlrev_b32 v226, 3, v254
    v_and_b32 v226, 0xfff, v226
    v_cndmask_b32 v224, v225, v224, vcc
    s_add_u32 s92, s88, s94
    s_barrier
    buffer_load_dword v251, v226, s[4:7], s92 offen sc0 sc1
    s_mov_b32 s56, 262144
poll_48:
    buffer_load_dword v225, v224, s[4:7], 0 offen sc0 sc1
    s_waitcnt vmcnt(0)
    v_cmp_ne_u32 vcc, 0x01010101, v225
    s_cbranch_vccz pd_49
    s_sleep 1
    s_sub_u32 s56, s56, 1
    s_cmp_lg_u32 s56, 0
    s_cbranch_scc1 poll_48
pd_49:
    s_add_u32 m0, s91, 98304
    s_mov_b64 exec, s[84:85]
    buffer_load_dwordx4 v221, s[36:39], s94 offen lds
    s_mov_b64 exec, -1
    s_add_u32 m0, s62, 100352
    s_nop 0
    buffer_load_dwordx4 v217, s[36:39], s94 offen lds
    buffer_load_dwordx4 v217, s[36:39], s94 offen offset:1024 lds
    buffer_load_dwordx4 v217, s[36:39], s94 offen offset:2048 lds
    buffer_load_dwordx4 v217, s[36:39], s94 offen offset:3072 lds
    s_add_u32 s94, s94, 32768
    s_and_b32 s94, s94, 262143
    s_add_u32 m0, s91, 116736
    s_mov_b64 exec, s[84:85]
    buffer_load_dwordx4 v221, s[36:39], s94 offen lds
    s_mov_b64 exec, -1
    s_add_u32 m0, s62, 118784
    s_nop 0
    buffer_load_dwordx4 v217, s[36:39], s94 offen lds
    buffer_load_dwordx4 v217, s[36:39], s94 offen offset:1024 lds
    buffer_load_dwordx4 v217, s[36:39], s94 offen offset:2048 lds
    buffer_load_dwordx4 v217, s[36:39], s94 offen offset:3072 lds
    s_add_u32 s94, s94, 32768
    s_and_b32 s94, s94, 262143
    s_add_u32 m0, s91, 135168
    s_mov_b64 exec, s[84:85]
    buffer_load_dwordx4 v221, s[36:39], s94 offen lds
    s_mov_b64 exec, -1
    s_add_u32 m0, s62, 137216
    s_nop 0
    buffer_load_dwordx4 v217, s[36:39], s94 offen lds
    buffer_load_dwordx4 v217, s[36:39], s94 offen offset:1024 lds
    buffer_load_dwordx4 v217, s[36:39], s94 offen offset:2048 lds
    buffer_load_dwordx4 v217, s[36:39], s94 offen offset:3072 lds
    s_add_u32 s94, s94, 32768
    s_and_b32 s94, s94, 262143
    s_setprio 1
    s_waitcnt vmcnt(10)
    s_barrier
    s_barrier
    s_add_u32 m0, s61, 0
    s_mul_i32 s59, s93, 96
    buffer_load_dwordx4 v200, s[8:11], s59 offen lds
    buffer_load_dwordx4 v201, s[8:11], s59 offen offset:1024 lds
    buffer_load_dwordx4 v202, s[8:11], s59 offen offset:2048 lds
    s_add_u32 s93, s93, 2048
    s_and_b32 s93, s93, 65535
    s_waitcnt vmcnt(8)
    s_barrier
    s_add_u32 m0, s91, 98304
    s_mov_b64 exec, s[84:85]
    buffer_load_dwordx4 v221, s[36:39], s94 offen lds
    s_mov_b64 exec, -1
    s_add_u32 m0, s62, 100352
    s_nop 0
    buffer_load_dwordx4 v217, s[36:39], s94 offen lds
    buffer_load_dwordx4 v217, s[36:39], s94 offen offset:1024 lds
    s_add_u32 m0, s61, 16384
    s_mul_i32 s59, s93, 96
    buffer_load_dwordx4 v200, s[8:11], s59 offen lds
    buffer_load_dwordx4 v201, s[8:11], s59 offen offset:1024 lds
    buffer_load_dwordx4 v202, s[8:11], s59 offen offset:2048 lds
    s_add_u32 s93, s93, 6144
    s_and_b32 s93, s93, 65535
    s_barrier
    s_add_u32 m0, s62, 100352
    s_nop 0
    buffer_load_dwordx4 v217, s[36:39], s94 offen offset:2048 lds
    buffer_load_dwordx4 v217, s[36:39], s94 offen offset:3072 lds
    s_add_u32 s94, s94, 32768
    s_and_b32 s94, s94, 262143
    s_add_u32 m0, s61, 32768
    s_mul_i32 s59, s93, 96
    buffer_load_dwordx4 v200, s[8:11], s59 offen lds
    buffer_load_dwordx4 v201, s[8:11], s59 offen offset:1024 lds
    buffer_load_dwordx4 v202, s[8:11], s59 offen offset:2048 lds
    s_add_u32 s93, s93, 2048
    s_and_b32 s93, s93, 65535
    s_cmp_lg_u32 s42, 0
    s_cbranch_scc1 wf_50
    s_lshl_b32 s55, s51, 2
    s_add_u32 s55, s55, s54
    v_mov_b32 v252, 14336
    v_mov_b32 v253, 0x01010101
    s_mov_b64 exec, 1
    buffer_store_dword v253, v252, s[4:7], s55 offen sc0 sc1
    s_mov_b64 exec, -1
wf_50:
    s_waitcnt vmcnt(14)
    s_barrier
    s_add_u32 m0, s91, 116736
    s_mov_b64 exec, s[84:85]
    buffer_load_dwordx4 v221, s[36:39], s94 offen lds
    s_mov_b64 exec, -1
    s_add_u32 m0, s62, 118784
    s_nop 0
    buffer_load_dwordx4 v217, s[36:39], s94 offen lds
    buffer_load_dwordx4 v217, s[36:39], s94 offen offset:1024 lds
    s_add_u32 m0, s61, 49152
    s_mul_i32 s59, s93, 96
    buffer_load_dwordx4 v200, s[8:11], s59 offen lds
    buffer_load_dwordx4 v201, s[8:11], s59 offen offset:1024 lds
    buffer_load_dwordx4 v202, s[8:11], s59 offen offset:2048 lds
    s_add_u32 s93, s93, 6144
    s_and_b32 s93, s93, 65535
    s_barrier
    s_add_u32 m0, s62, 118784
    s_nop 0
    buffer_load_dwordx4 v217, s[36:39], s94 offen offset:2048 lds
    buffer_load_dwordx4 v217, s[36:39], s94 offen offset:3072 lds
    s_add_u32 s94, s94, 32768
    s_and_b32 s94, s94, 262143
    s_add_u32 m0, s61, 65536
    s_mul_i32 s59, s93, 96
    buffer_load_dwordx4 v200, s[8:11], s59 offen lds
    buffer_load_dwordx4 v201, s[8:11], s59 offen offset:1024 lds
    buffer_load_dwordx4 v202, s[8:11], s59 offen offset:2048 lds
    s_add_u32 s93, s93, 2048
    s_and_b32 s93, s93, 65535
    s_waitcnt vmcnt(14)
    s_barrier
    s_add_u32 m0, s91, 135168
    s_mov_b64 exec, s[84:85]
    buffer_load_dwordx4 v221, s[36:39], s94 offen lds
    s_mov_b64 exec, -1
    s_add_u32 m0, s62, 137216
    s_nop 0
    buffer_load_dwordx4 v217, s[36:39], s94 offen lds
    buffer_load_dwordx4 v217, s[36:39], s94 offen offset:1024 lds
    s_add_u32 m0, s61, 81920
    s_mul_i32 s59, s93, 96
    buffer_load_dwordx4 v200, s[8:11], s59 offen lds
    buffer_load_dwordx4 v201, s[8:11], s59 offen offset:1024 lds
    buffer_load_dwordx4 v202, s[8:11], s59 offen offset:2048 lds
    s_add_u32 s93, s93, 6144
    s_and_b32 s93, s93, 65535
    s_barrier
    s_add_u32 m0, s62, 137216
    s_nop 0
    buffer_load_dwordx4 v217, s[36:39], s94 offen offset:2048 lds
    buffer_load_dwordx4 v217, s[36:39], s94 offen offset:3072 lds
    s_add_u32 s94, s94, 32768
    s_and_b32 s94, s94, 262143
    s_add_u32 m0, s61, 0
    s_mul_i32 s59, s93, 96
    buffer_load_dwordx4 v200, s[8:11], s59 offen lds
    buffer_load_dwordx4 v201, s[8:11], s59 offen offset:1024 lds
    buffer_load_dwordx4 v202, s[8:11], s59 offen offset:2048 lds
    s_add_u32 s93, s93, 2048
    s_and_b32 s93, s93, 65535
    s_waitcnt vmcnt(14)
    s_barrier
    v_lshrrev_b32 v224, 2, v254
    v_and_b32 v225, 64, v224
    v_and_b32 v224, 60, v224
    s_cmp_eq_u32 s40, 0
    s_cselect_b32 s55, 0, 2
    v_mul_lo_u32 v225, v225, s55
    v_sub_u32 v98, v224, v225
    v_add_u32 v98, 14336, v98
    buffer_load_dword v251, v98, s[4:7], s54 offen sc0 sc1
    s_add_u32 m0, s91, 98304
    s_mov_b64 exec, s[84:85]
    buffer_load_dwordx4 v221, s[36:39], s94 offen lds
    s_mov_b64 exec, -1
    s_add_u32 m0, s62, 100352
    s_nop 0
    buffer_load_dwordx4 v217, s[36:39], s94 offen lds
    buffer_load_dwordx4 v217, s[36:39], s94 offen offset:1024 lds
    s_add_u32 m0, s61, 16384
    s_mul_i32 s59, s93, 96
    buffer_load_dwordx4 v200, s[8:11], s59 offen lds
    buffer_load_dwordx4 v201, s[8:11], s59 offen offset:1024 lds
    buffer_load_dwordx4 v202, s[8:11], s59 offen offset:2048 lds
    s_add_u32 s93, s93, 6144
    s_and_b32 s93, s93, 65535
    s_barrier
    s_add_u32 m0, s62, 100352
    s_nop 0
    buffer_load_dwordx4 v217, s[36:39], s94 offen offset:2048 lds
    buffer_load_dwordx4 v217, s[36:39], s94 offen offset:3072 lds
    s_add_u32 s94, s94, 32768
    s_and_b32 s94, s94, 262143
    s_add_u32 m0, s61, 32768
    s_mul_i32 s59, s93, 96
    buffer_load_dwordx4 v200, s[8:11], s59 offen lds
    buffer_load_dwordx4 v201, s[8:11], s59 offen offset:1024 lds
    buffer_load_dwordx4 v202, s[8:11], s59 offen offset:2048 lds
    s_add_u32 s93, s93, 2048
    s_and_b32 s93, s93, 65535
    s_waitcnt vmcnt(15)
    s_barrier
    s_add_u32 m0, s91, 116736
    s_mov_b64 exec, s[84:85]
    buffer_load_dwordx4 v221, s[36:39], s94 offen lds
    s_mov_b64 exec, -1
    s_add_u32 m0, s62, 118784
    s_nop 0
    buffer_load_dwordx4 v217, s[36:39], s94 offen lds
    buffer_load_dwordx4 v217, s[36:39], s94 offen offset:1024 lds
    s_add_u32 m0, s61, 49152
    s_mul_i32 s59, s93, 96
    buffer_load_dwordx4 v200, s[8:11], s59 offen lds
    buffer_load_dwordx4 v201, s[8:11], s59 offen offset:1024 lds
    buffer_load_dwordx4 v202, s[8:11], s59 offen offset:2048 lds
    s_add_u32 s93, s93, 10240
    s_and_b32 s93, s93, 65535
    s_barrier
    s_waitcnt vmcnt(17)
    s_mov_b32 s56, 262144
poll_51:
    v_cmp_ne_u32 vcc, 0x01010101, v251
    s_cbranch_vccz pd_52
    buffer_load_dword v251, v98, s[4:7], s54 offen sc0 sc1
    s_waitcnt vmcnt(0)
    s_sub_u32 s56, s56, 1
    s_cmp_lg_u32 s56, 0
    s_cbranch_scc1 poll_51
pd_52:
    s_add_u32 m0, s62, 118784
    s_nop 0
    buffer_load_dwordx4 v217, s[36:39], s94 offen offset:2048 lds
    buffer_load_dwordx4 v217, s[36:39], s94 offen offset:3072 lds
    s_add_u32 s94, s94, 49152
    s_and_b32 s94, s94, 262143
    s_add_u32 m0, s61, 65536
    s_mul_i32 s59, s93, 96
    buffer_load_dwordx4 v200, s[8:11], s59 offen lds
    buffer_load_dwordx4 v201, s[8:11], s59 offen offset:1024 lds
    buffer_load_dwordx4 v202, s[8:11], s59 offen offset:2048 lds
    s_add_u32 s93, s93, 2048
    s_and_b32 s93, s93, 65535
    s_waitcnt vmcnt(14)
    s_barrier
    s_add_u32 m0, s91, 135168
    s_mov_b64 exec, s[84:85]
    buffer_load_dwordx4 v221, s[36:39], s94 offen lds
    s_mov_b64 exec, -1
    s_add_u32 m0, s62, 137216
    s_nop 0
    buffer_load_dwordx4 v217, s[36:39], s94 offen lds
    buffer_load_dwordx4 v217, s[36:39], s94 offen offset:1024 lds
    v_and_b32 v226, 0xf0, v254
    v_and_b32 v227, 0x300, v254
    v_lshl_add_u32 v227, v227, 2, v226
    s_lshl_b32 s78, s42, 8
    s_add_u32 s78, s78, s53
    s_add_u32 m0, s61, 81920
    s_mul_i32 s59, s93, 96
    buffer_load_dwordx4 v200, s[8:11], s59 offen lds
    buffer_load_dwordx4 v201, s[8:11], s59 offen offset:1024 lds
    buffer_load_dwordx4 v202, s[8:11], s59 offen offset:2048 lds
    s_add_u32 s93, s93, 6144
    s_and_b32 s93, s93, 65535
    buffer_load_dwordx4 v[0:3], v227, s[4:7], s78 offen
    s_add_u32 s78, s78, 4096
    s_barrier
    s_add_u32 m0, s62, 137216
    s_nop 0
    buffer_load_dwordx4 v217, s[36:39], s94 offen offset:2048 lds
    buffer_load_dwordx4 v217, s[36:39], s94 offen offset:3072 lds
    s_add_u32 s94, s94, 32768
    s_and_b32 s94, s94, 262143
    s_add_u32 m0, s61, 0
    s_mul_i32 s59, s93, 96
    buffer_load_dwordx4 v200, s[8:11], s59 offen lds
    buffer_load_dwordx4 v201, s[8:11], s59 offen offset:1024 lds
    buffer_load_dwordx4 v202, s[8:11], s59 offen offset:2048 lds
    s_add_u32 s93, s93, 2048
    s_and_b32 s93, s93, 65535
    buffer_load_dwordx4 v[4:7], v227, s[4:7], s78 offen
    s_add_u32 s78, s78, 4096
    s_waitcnt vmcnt(16)
    s_barrier
    s_add_u32 m0, s91, 98304
    s_mov_b64 exec, s[84:85]
    buffer_load_dwordx4 v221, s[36:39], s94 offen lds
    s_mov_b64 exec, -1
    s_add_u32 m0, s62, 100352
    s_nop 0
    buffer_load_dwordx4 v217, s[36:39], s94 offen lds
    buffer_load_dwordx4 v217, s[36:39], s94 offen offset:1024 lds
    s_add_u32 m0, s61, 16384
    s_mul_i32 s59, s93, 96
    buffer_load_dwordx4 v200, s[8:11], s59 offen lds
    buffer_load_dwordx4 v201, s[8:11], s59 offen offset:1024 lds
    buffer_load_dwordx4 v202, s[8:11], s59 offen offset:2048 lds
    s_add_u32 s93, s93, 6144
    s_and_b32 s93, s93, 65535
    buffer_load_dwordx4 v[8:11], v227, s[4:7], s78 offen
    s_add_u32 s78, s78, 4096
    s_barrier
    s_add_u32 m0, s62, 100352
    s_nop 0
    buffer_load_dwordx4 v217, s[36:39], s94 offen offset:2048 lds
    buffer_load_dwordx4 v217, s[36:39], s94 offen offset:3072 lds
    s_add_u32 s94, s94, 32768
    s_and_b32 s94, s94, 262143
    s_add_u32 m0, s61, 32768
    s_mul_i32 s59, s93, 96
    buffer_load_dwordx4 v200, s[8:11], s59 offen lds
    buffer_load_dwordx4 v201, s[8:11], s59 offen offset:1024 lds
    buffer_load_dwordx4 v202, s[8:11], s59 offen offset:2048 lds
    s_add_u32 s93, s93, 2048
    s_and_b32 s93, s93, 65535
    buffer_load_dwordx4 v[12:15], v227, s[4:7], s78 offen
    s_add_u32 s78, s78, 4096
    s_waitcnt vmcnt(17)
    s_barrier
    s_add_u32 m0, s91, 116736
    s_mov_b64 exec, s[84:85]
    buffer_load_dwordx4 v221, s[36:39], s94 offen lds
    s_mov_b64 exec, -1
    s_add_u32 m0, s62, 118784
    s_nop 0
    buffer_load_dwordx4 v217, s[36:39], s94 offen lds
    buffer_load_dwordx4 v217, s[36:39], s94 offen offset:1024 lds
    s_add_u32 m0, s61, 49152
    s_mul_i32 s59, s93, 96
    buffer_load_dwordx4 v200, s[8:11], s59 offen lds
    buffer_load_dwordx4 v201, s[8:11], s59 offen offset:1024 lds
    buffer_load_dwordx4 v202, s[8:11], s59 offen offset:2048 lds
    s_add_u32 s93, s93, 6144
    s_and_b32 s93, s93, 65535
    s_barrier
    s_add_u32 m0, s62, 118784
    s_nop 0
    buffer_load_dwordx4 v217, s[36:39], s94 offen offset:2048 lds
    buffer_load_dwordx4 v217, s[36:39], s94 offen offset:3072 lds
    s_add_u32 s94, s94, 32768
    s_and_b32 s94, s94, 262143
    v_lshrrev_b32 v224, 7, v254
    v_and_b32 v97, 0x70, v254
    v_lshl_add_u32 v224, v224, 10, v97
    s_sub_u32 s70, s53, 4193408
    s_cmp_eq_u32 s40, 0
    s_cselect_b32 s70, 2130706432, s70
    s_add_u32 m0, s61, 65536
    s_mul_i32 s59, s93, 96
    buffer_load_dwordx4 v200, s[8:11], s59 offen lds
    buffer_load_dwordx4 v201, s[8:11], s59 offen offset:1024 lds
    buffer_load_dwordx4 v[24:27], v224, s[4:7], s70 offen
    s_add_u32 s70, s70, 8192
    buffer_load_dwordx4 v202, s[8:11], s59 offen offset:2048 lds
    s_add_u32 s93, s93, 2048
    s_and_b32 s93, s93, 65535
    buffer_load_dwordx4 v[28:31], v224, s[4:7], s70 offen
    s_add_u32 s70, s70, 8192
    s_waitcnt vmcnt(17)
    s_barrier
    s_waitcnt vmcnt(13)
    s_add_u32 m0, s91, 135168
    s_mov_b64 exec, s[84:85]
    buffer_load_dwordx4 v221, s[36:39], s94 offen lds
    s_mov_b64 exec, -1
    v_add_f32 v0, v0, v4
    v_add_f32 v1, v1, v5
    v_add_f32 v2, v2, v6
    v_add_f32 v3, v3, v7
    s_add_u32 m0, s62, 137216
    s_nop 0
    buffer_load_dwordx4 v217, s[36:39], s94 offen lds
    v_add_f32 v8, v8, v12
    v_add_f32 v9, v9, v13
    v_add_f32 v10, v10, v14
    v_add_f32 v11, v11, v15
    buffer_load_dwordx4 v217, s[36:39], s94 offen offset:1024 lds
    v_add_f32 v16, v0, v8
    v_add_f32 v17, v1, v9
    v_add_f32 v18, v2, v10
    v_add_f32 v19, v3, v11
    s_add_u32 m0, s61, 81920
    s_mul_i32 s59, s93, 96
    buffer_load_dwordx4 v200, s[8:11], s59 offen lds
    v_mov_b32 v0, v16
    v_mov_b32 v1, v17
    v_mov_b32 v2, v18
    v_mov_b32 v3, v19
    buffer_load_dwordx4 v201, s[8:11], s59 offen offset:1024 lds
    s_nop 1
    v_permlane16_swap_b32 v16, v0
    v_permlane16_swap_b32 v17, v1
    v_permlane16_swap_b32 v18, v2
    buffer_load_dwordx4 v202, s[8:11], s59 offen offset:2048 lds
    s_add_u32 s93, s93, 6144
    s_and_b32 s93, s93, 65535
    v_permlane16_swap_b32 v19, v3
    v_add_f32 v16, v16, v0
    v_add_f32 v17, v17, v1
    v_add_f32 v18, v18, v2
    v_add_f32 v19, v19, v3
    s_barrier
    s_add_u32 m0, s62, 137216
    s_nop 0
    buffer_load_dwordx4 v217, s[36:39], s94 offen offset:2048 lds
    v_mov_b32 v0, v16
    v_mov_b32 v1, v17
    buffer_load_dwordx4 v217, s[36:39], s94 offen offset:3072 lds
    s_add_u32 s94, s94, 32768
    s_and_b32 s94, s94, 262143
    v_mov_b32 v2, v18
    v_mov_b32 v3, v19
    s_nop 1
    s_add_u32 m0, s61, 0
    s_mul_i32 s59, s93, 96
    buffer_load_dwordx4 v200, s[8:11], s59 offen lds
    v_permlane32_swap_b32 v16, v0
    v_permlane32_swap_b32 v17, v1
    buffer_load_dwordx4 v201, s[8:11], s59 offen offset:1024 lds
    v_permlane32_swap_b32 v18, v2
    v_permlane32_swap_b32 v19, v3
    v_add_f32 v16, v16, v0
    buffer_load_dwordx4 v202, s[8:11], s59 offen offset:2048 lds
    s_add_u32 s93, s93, 2048
    s_and_b32 s93, s93, 65535
    v_add_f32 v17, v17, v1
    v_add_f32 v18, v18, v2
    v_add_f32 v19, v19, v3
    s_waitcnt vmcnt(16)
    s_barrier
    s_add_u32 m0, s91, 98304
    s_mov_b64 exec, s[84:85]
    buffer_load_dwordx4 v221, s[36:39], s94 offen lds
    s_mov_b64 exec, -1
    v_mul_f32 v16, 0x3a800000, v16
    v_mul_f32 v17, 0x3a800000, v17
    s_add_u32 m0, s62, 100352
    s_nop 0
    buffer_load_dwordx4 v217, s[36:39], s94 offen lds
    v_fma_f32 v17, -v16, v16, v17
    v_max_f32 v17, 0, v17
    v_cvt_pk_bf16_f32 v16, v16, v16
    buffer_load_dwordx4 v217, s[36:39], s94 offen offset:1024 lds
    v_lshlrev_b32 v16, 16, v16
    v_cvt_pk_bf16_f32 v17, v17, v17
    v_lshlrev_b32 v17, 16, v17
    s_add_u32 m0, s61, 16384
    s_mul_i32 s59, s93, 96
    buffer_load_dwordx4 v200, s[8:11], s59 offen lds
    v_add_f32 v17, 0x3727c5ac, v17
    v_cvt_pk_bf16_f32 v17, v17, v17
    v_lshlrev_b32 v17, 16, v17
    buffer_load_dwordx4 v201, s[8:11], s59 offen offset:1024 lds
    v_sqrt_f32 v17, v17
    s_nop 0
    v_cvt_pk_bf16_f32 v17, v17, v17
    buffer_load_dwordx4 v202, s[8:11], s59 offen offset:2048 lds
    s_add_u32 s93, s93, 6144
    s_and_b32 s93, s93, 65535
    v_lshlrev_b32 v17, 16, v17
    v_rcp_f32 v17, v17
    s_nop 0
    s_barrier
    s_add_u32 m0, s62, 100352
    s_nop 0
    buffer_load_dwordx4 v217, s[36:39], s94 offen offset:2048 lds
    v_mul_f32 v18, 0x3a800000, v18
    v_mul_f32 v19, 0x3a800000, v19
    v_fma_f32 v19, -v18, v18, v19
    buffer_load_dwordx4 v217, s[36:39], s94 offen offset:3072 lds
    s_add_u32 s94, s94, 32768
    s_and_b32 s94, s94, 262143
    v_max_f32 v19, 0, v19
    v_cvt_pk_bf16_f32 v18, v18, v18
    v_lshlrev_b32 v18, 16, v18
    v_cvt_pk_bf16_f32 v19, v19, v19
    s_add_u32 m0, s61, 32768
    s_mul_i32 s59, s93, 96
    buffer_load_dwordx4 v200, s[8:11], s59 offen lds
    v_lshlrev_b32 v19, 16, v19
    v_add_f32 v19, 0x3727c5ac, v19
    v_cvt_pk_bf16_f32 v19, v19, v19
    buffer_load_dwordx4 v201, s[8:11], s59 offen offset:1024 lds
    v_lshlrev_b32 v19, 16, v19
    v_sqrt_f32 v19, v19
    s_nop 0
    v_cvt_pk_bf16_f32 v19, v19, v19
    buffer_load_dwordx4 v202, s[8:11], s59 offen offset:2048 lds
    s_add_u32 s93, s93, 2048
    s_and_b32 s93, s93, 65535
    v_lshlrev_b32 v19, 16, v19
    v_rcp_f32 v19, v19
    s_nop 0
    v_lshrrev_b32 v226, 1, v226
    s_lshl_b32 s55, s42, 7
    s_add_u32 s55, s55, 159808
    v_add_u32 v226, s55, v226
    v_sub_f32 v16, 0, v16
    v_sub_f32 v18, 0, v18
    ds_write2_b32 v226, v16, v18 offset0:0 offset1:1
    ds_write2_b32 v226, v17, v19 offset0:144 offset1:145
    s_waitcnt vmcnt(14)
    s_barrier
    s_add_u32 m0, s91, 116736
    s_mov_b64 exec, s[84:85]
    buffer_load_dwordx4 v221, s[36:39], s94 offen lds
    s_mov_b64 exec, -1
    v_add_f32 v24, v24, v28
    v_add_f32 v25, v25, v29
    v_add_f32 v26, v26, v30
    s_add_u32 m0, s62, 118784
    s_nop 0
    buffer_load_dwordx4 v217, s[36:39], s94 offen lds
    v_add_f32 v27, v27, v31
    s_nop 1
    v_add_f32_dpp v24, v24, v24 row_ror:8 row_mask:0xf bank_mask:0xf
    v_add_f32_dpp v25, v25, v25 row_ror:8 row_mask:0xf bank_mask:0xf
    buffer_load_dwordx4 v217, s[36:39], s94 offen offset:1024 lds
    v_add_f32_dpp v26, v26, v26 row_ror:8 row_mask:0xf bank_mask:0xf
    v_add_f32_dpp v27, v27, v27 row_ror:8 row_mask:0xf bank_mask:0xf
    v_mov_b32 v28, v24
    v_mov_b32 v29, v25
    s_add_u32 m0, s61, 49152
    s_mul_i32 s59, s93, 96
    buffer_load_dwordx4 v200, s[8:11], s59 offen lds
    v_mov_b32 v30, v26
    v_mov_b32 v31, v27
    s_nop 1
    buffer_load_dwordx4 v201, s[8:11], s59 offen offset:1024 lds
    v_permlane16_swap_b32 v24, v28
    v_permlane16_swap_b32 v25, v29
    v_permlane16_swap_b32 v26, v30
    v_permlane16_swap_b32 v27, v31
    buffer_load_dwordx4 v202, s[8:11], s59 offen offset:2048 lds
    s_add_u32 s93, s93, 6144
    s_and_b32 s93, s93, 65535
    v_add_f32 v24, v24, v28
    v_add_f32 v25, v25, v29
    v_add_f32 v26, v26, v30
    v_add_f32 v27, v27, v31
    s_barrier
    s_add_u32 m0, s62, 118784
    s_nop 0
    buffer_load_dwordx4 v217, s[36:39], s94 offen offset:2048 lds
    v_mov_b32 v28, v24
    v_mov_b32 v29, v25
    buffer_load_dwordx4 v217, s[36:39], s94 offen offset:3072 lds
    s_add_u32 s94, s94, 32768
    s_and_b32 s94, s94, 262143
    v_mov_b32 v30, v26
    v_mov_b32 v31, v27
    s_nop 1
    s_add_u32 m0, s61, 65536
    s_mul_i32 s59, s93, 96
    buffer_load_dwordx4 v200, s[8:11], s59 offen lds
    v_permlane32_swap_b32 v24, v28
    v_permlane32_swap_b32 v25, v29
    buffer_load_dwordx4 v201, s[8:11], s59 offen offset:1024 lds
    v_permlane32_swap_b32 v26, v30
    v_permlane32_swap_b32 v27, v31
    v_add_f32 v24, v24, v28
    buffer_load_dwordx4 v202, s[8:11], s59 offen offset:2048 lds
    s_add_u32 s93, s93, 2048
    s_and_b32 s93, s93, 65535
    v_add_f32 v25, v25, v29
    v_add_f32 v26, v26, v30
    v_add_f32 v27, v27, v31
    s_waitcnt vmcnt(14)
    s_barrier
    s_add_u32 m0, s91, 135168
    s_mov_b64 exec, s[84:85]
    buffer_load_dwordx4 v221, s[36:39], s94 offen lds
    s_mov_b64 exec, -1
    v_mul_f32 v24, 0x3a800000, v24
    v_mul_f32 v25, 0x3a800000, v25
    s_add_u32 m0, s62, 137216
    s_nop 0
    buffer_load_dwordx4 v217, s[36:39], s94 offen lds
    v_fma_f32 v25, -v24, v24, v25
    v_max_f32 v25, 0, v25
    v_cvt_pk_bf16_f32 v24, v24, v24
    buffer_load_dwordx4 v217, s[36:39], s94 offen offset:1024 lds
    v_lshlrev_b32 v24, 16, v24
    v_cvt_pk_bf16_f32 v25, v25, v25
    v_lshlrev_b32 v25, 16, v25
    s_add_u32 m0, s61, 81920
    s_mul_i32 s59, s93, 96
    buffer_load_dwordx4 v200, s[8:11], s59 offen lds
    v_add_f32 v25, 0x3727c5ac, v25
    v_cvt_pk_bf16_f32 v25, v25, v25
    v_lshlrev_b32 v25, 16, v25
    buffer_load_dwordx4 v201, s[8:11], s59 offen offset:1024 lds
    v_sqrt_f32 v25, v25
    s_nop 0
    v_cvt_pk_bf16_f32 v25, v25, v25
    buffer_load_dwordx4 v202, s[8:11], s59 offen offset:2048 lds
    s_add_u32 s93, s93, 6144
    s_and_b32 s93, s93, 65535
    v_lshlrev_b32 v25, 16, v25
    v_rcp_f32 v25, v25
    s_nop 0
    s_barrier
    s_add_u32 m0, s62, 137216
    s_nop 0
    buffer_load_dwordx4 v217, s[36:39], s94 offen offset:2048 lds
    v_mul_f32 v26, 0x3a800000, v26
    v_mul_f32 v27, 0x3a800000, v27
    v_fma_f32 v27, -v26, v26, v27
    v_max_f32 v27, 0, v27
    buffer_load_dwordx4 v217, s[36:39], s94 offen offset:3072 lds
    s_add_u32 s94, s94, 32768
    s_and_b32 s94, s94, 262143
    v_cvt_pk_bf16_f32 v26, v26, v26
    v_lshlrev_b32 v26, 16, v26
    v_cvt_pk_bf16_f32 v27, v27, v27
    v_lshlrev_b32 v27, 16, v27
    v_add_f32 v27, 0x3727c5ac, v27
    s_add_u32 m0, s61, 0
    s_mul_i32 s59, s93, 96
    buffer_load_dwordx4 v200, s[8:11], s59 offen lds
    v_cvt_pk_bf16_f32 v27, v27, v27
    v_lshlrev_b32 v27, 16, v27
    v_sqrt_f32 v27, v27
    s_nop 0
    buffer_load_dwordx4 v201, s[8:11], s59 offen offset:1024 lds
    v_cvt_pk_bf16_f32 v27, v27, v27
    v_lshlrev_b32 v27, 16, v27
    v_rcp_f32 v27, v27
    s_nop 0
    v_lshrrev_b32 v97, 1, v97
    buffer_load_dwordx4 v202, s[8:11], s59 offen offset:2048 lds
    s_add_u32 s93, s93, 2048
    s_and_b32 s93, s93, 65535
    v_add_u32 v97, 159744, v97
    v_sub_f32 v24, 0, v24
    v_sub_f32 v26, 0, v26
    ds_write2_b32 v97, v24, v26 offset0:0 offset1:1
    ds_write2_b32 v97, v25, v27 offset0:144 offset1:145
    s_waitcnt vmcnt(14)
    s_barrier
    s_add_u32 m0, s91, 98304
    s_mov_b64 exec, s[84:85]
    buffer_load_dwordx4 v221, s[36:39], s94 offen lds
    s_mov_b64 exec, -1
    s_add_u32 m0, s62, 100352
    s_nop 0
    buffer_load_dwordx4 v217, s[36:39], s94 offen lds
    buffer_load_dwordx4 v217, s[36:39], s94 offen offset:1024 lds
    s_add_u32 m0, s61, 16384
    s_mul_i32 s59, s93, 96
    buffer_load_dwordx4 v200, s[8:11], s59 offen lds
    buffer_load_dwordx4 v201, s[8:11], s59 offen offset:1024 lds
    buffer_load_dwordx4 v202, s[8:11], s59 offen offset:2048 lds
    s_barrier
    s_add_u32 m0, s62, 100352
    s_nop 0
    buffer_load_dwordx4 v217, s[36:39], s94 offen offset:2048 lds
    buffer_load_dwordx4 v217, s[36:39], s94 offen offset:3072 lds
    s_lshl_b32 s93, s43, 1
    s_add_u32 s93, s51, s93
    s_and_b32 s93, s93, 15
    s_add_u32 m0, s62, 32768
    s_lshl_b32 s93, s93, 17
    buffer_load_dwordx4 v203, s[12:15], s93 offen lds
    buffer_load_dwordx4 v204, s[12:15], s93 offen offset:1024 lds
    buffer_load_dwordx4 v205, s[12:15], s93 offen offset:2048 lds
    buffer_load_dwordx4 v206, s[12:15], s93 offen offset:3072 lds
    s_add_u32 s93, s93, 524288
    s_and_b32 s93, s93, 2097151
    s_waitcnt vmcnt(15)
    s_barrier
    s_add_u32 m0, s62, 49152
    s_nop 0
    buffer_load_dwordx4 v203, s[12:15], s93 offen lds
    buffer_load_dwordx4 v204, s[12:15], s93 offen offset:1024 lds
    buffer_load_dwordx4 v205, s[12:15], s93 offen offset:2048 lds
    buffer_load_dwordx4 v206, s[12:15], s93 offen offset:3072 lds
    s_add_u32 s93, s93, 524288
    s_and_b32 s93, s93, 2097151
    s_barrier
    s_add_u32 m0, s62, 65536
    s_nop 0
    buffer_load_dwordx4 v203, s[12:15], s93 offen lds
    buffer_load_dwordx4 v204, s[12:15], s93 offen offset:1024 lds
    buffer_load_dwordx4 v205, s[12:15], s93 offen offset:2048 lds
    buffer_load_dwordx4 v206, s[12:15], s93 offen offset:3072 lds
    s_add_u32 s93, s93, 524288
    s_and_b32 s93, s93, 2097151
    s_waitcnt vmcnt(12)
    s_barrier
    s_add_u32 m0, s62, 81920
    s_nop 0
    buffer_load_dwordx4 v203, s[12:15], s93 offen lds
    buffer_load_dwordx4 v204, s[12:15], s93 offen offset:1024 lds
    buffer_load_dwordx4 v205, s[12:15], s93 offen offset:2048 lds
    buffer_load_dwordx4 v206, s[12:15], s93 offen offset:3072 lds
    s_add_u32 s93, s93, 655360
    s_and_b32 s93, s93, 2097151
    s_barrier
    s_add_u32 m0, s62, 0
    s_nop 0
    buffer_load_dwordx4 v203, s[12:15], s93 offen lds
    buffer_load_dwordx4 v204, s[12:15], s93 offen offset:1024 lds
    buffer_load_dwordx4 v205, s[12:15], s93 offen offset:2048 lds
    buffer_load_dwordx4 v206, s[12:15], s93 offen offset:3072 lds
    s_add_u32 s93, s93, 524288
    s_and_b32 s93, s93, 2097151
    s_waitcnt lgkmcnt(0)
    s_barrier
    s_add_u32 m0, s62, 16384
    s_nop 0
    buffer_load_dwordx4 v203, s[12:15], s93 offen lds
    buffer_load_dwordx4 v204, s[12:15], s93 offen offset:1024 lds
    buffer_load_dwordx4 v205, s[12:15], s93 offen offset:2048 lds
    buffer_load_dwordx4 v206, s[12:15], s93 offen offset:3072 lds
    s_add_u32 s93, s93, 524288
    s_and_b32 s93, s93, 2097151
    s_setprio 0
Y_g2:
    v_lshlrev_b32 v224, 7, v254
    s_lshl_b32 s55, s44, 19
    s_add_u32 s55, s55, s93
    s_and_b32 s55, s55, 2097151
    s_add_u32 s55, s55, s63
    buffer_load_dword v251, v224, s[12:15], s55 offen
    v_mov_b32 v112, -1
    v_mov_b32 v113, -1
    v_mov_b32 v114, -1
    v_mov_b32 v115, -1
    s_lshl_b32 s94, s51, 14
    s_add_u32 s88, s47, s62
    v_add_u32 v217, s88, v254
    s_add_u32 s55, s88, s94
    s_add_u32 s55, s55, 1310720
    buffer_store_dwordx4 v[112:115], v254, s[4:7], s55 offen offset:0 sc0 sc1
    buffer_store_dwordx4 v[112:115], v254, s[4:7], s55 offen offset:1024 sc0 sc1
    buffer_store_dwordx4 v[112:115], v254, s[4:7], s55 offen offset:2048 sc0 sc1
    buffer_store_dwordx4 v[112:115], v254, s[4:7], s55 offen offset:3072 sc0 sc1
    s_cmp_lg_u32 s46, 0
    s_cbranch_scc1 cp_53
    s_mov_b32 s55, 71567360
    s_mov_b32 s56, 262144
p4_54:
    buffer_load_dwordx4 v[116:119], v254, s[4:7], s55 offen sc0 sc1
    s_waitcnt vmcnt(0)
    v_and_b32 v116, v116, v117
    v_and_b32 v118, v118, v119
    v_and_b32 v116, v116, v118
    v_cmp_ne_u32 vcc, 1, v116
    s_cbranch_vccz p4_55
    s_sleep 1
    s_sub_u32 s56, s56, 1
    s_cmp_lg_u32 s56, 0
    s_cbranch_scc1 p4_54
p4_55:
    s_lshl_b32 s60, s43, 23
    s_add_u32 s60, s60, 83886336
    s_add_u32 s55, s4, s60
    s_addc_u32 s56, s5, 0
    s_lshr_b32 s57, 5280, s41
    s_and_b32 s57, s57, 1
    s_cselect_b32 s28, s55, s16
    s_cselect_b32 s29, s56, s17
    s_mov_b32 s30, 7340032
    s_mov_b32 s31, 0x00020000
    s_lshl_b32 s60, s43, 23
    s_add_u32 s60, s60, 83886336
    s_add_u32 s55, s4, s60
    s_addc_u32 s56, s5, 0
    s_lshr_b32 s57, 16392, s41
    s_and_b32 s57, s57, 1
    s_cselect_b32 s24, s55, s16
    s_cselect_b32 s25, s56, s17
    s_mov_b32 s26, 7340032
    s_mov_b32 s27, 0x00020000
cp_53:
    s_barrier
    s_add_u32 m0, s62, 98304
    s_nop 0
    buffer_load_dwordx4 v217, s[4:7], s94 offen lds
    buffer_load_dwordx4 v217, s[4:7], s94 offen offset:1024 lds
    buffer_load_dwordx4 v217, s[4:7], s94 offen offset:2048 lds
    buffer_load_dwordx4 v217, s[4:7], s94 offen offset:3072 lds
    s_add_u32 s94, s94, 32768
    s_and_b32 s94, s94, 262143
    s_waitcnt vmcnt(0)
    s_barrier
    v_lshrrev_b32 v252, 2, v254
    v_min_u32 v252, 28, v252
    s_add_u32 s55, s0, 0
    s_mov_b32 s56, 262144
poll_56:
    buffer_load_dword v253, v252, s[4:7], s55 offen sc0 sc1
    s_waitcnt vmcnt(0)
    v_cmp_ne_u32 vcc, 0x01010101, v253
    s_cbranch_vccz pd_57
    s_sleep 1
    s_sub_u32 s56, s56, 1
    s_cmp_lg_u32 s56, 0
    s_cbranch_scc1 poll_56
pd_57:
    s_add_u32 m0, s62, 114688
    s_nop 0
    buffer_load_dwordx4 v217, s[4:7], s94 offen lds
    buffer_load_dwordx4 v217, s[4:7], s94 offen offset:1024 lds
    buffer_load_dwordx4 v217, s[4:7], s94 offen offset:2048 lds
    buffer_load_dwordx4 v217, s[4:7], s94 offen offset:3072 lds
    s_add_u32 s94, s94, 32768
    s_and_b32 s94, s94, 262143
    s_add_u32 m0, s62, 131072
    s_nop 0
    buffer_load_dwordx4 v217, s[4:7], s94 offen lds
    buffer_load_dwordx4 v217, s[4:7], s94 offen offset:1024 lds
    buffer_load_dwordx4 v217, s[4:7], s94 offen offset:2048 lds
    buffer_load_dwordx4 v217, s[4:7], s94 offen offset:3072 lds
    s_add_u32 s94, s94, 32768
    s_and_b32 s94, s94, 262143
    s_waitcnt vmcnt(4)
    s_barrier
    s_add_u32 m0, s62, 98304
    s_nop 0
    buffer_load_dwordx4 v217, s[4:7], s94 offen lds
    buffer_load_dwordx4 v217, s[4:7], s94 offen offset:1024 lds
    buffer_load_dwordx4 v217, s[4:7], s94 offen offset:2048 lds
    buffer_load_dwordx4 v217, s[4:7], s94 offen offset:3072 lds
    s_add_u32 s94, s94, 32768
    s_and_b32 s94, s94, 262143
    s_waitcnt vmcnt(4)
    s_barrier
    s_add_u32 m0, s62, 114688
    s_nop 0
    buffer_load_dwordx4 v217, s[4:7], s94 offen lds
    buffer_load_dwordx4 v217, s[4:7], s94 offen offset:1024 lds
    buffer_load_dwordx4 v217, s[4:7], s94 offen offset:2048 lds
    buffer_load_dwordx4 v217, s[4:7], s94 offen offset:3072 lds
    s_add_u32 s94, s94, 32768
    s_and_b32 s94, s94, 262143
    s_add_u32 m0, s62, 32768
    s_nop 0
    buffer_load_dwordx4 v203, s[12:15], s93 offen lds
    buffer_load_dwordx4 v204, s[12:15], s93 offen offset:1024 lds
    buffer_load_dwordx4 v205, s[12:15], s93 offen offset:2048 lds
    buffer_load_dwordx4 v206, s[12:15], s93 offen offset:3072 lds
    s_add_u32 s93, s93, 524288
    s_and_b32 s93, s93, 2097151
    s_waitcnt vmcnt(8)
    s_barrier
    s_add_u32 m0, s62, 131072
    s_nop 0
    buffer_load_dwordx4 v217, s[4:7], s94 offen lds
    buffer_load_dwordx4 v217, s[4:7], s94 offen offset:1024 lds
    buffer_load_dwordx4 v217, s[4:7], s94 offen offset:2048 lds
    buffer_load_dwordx4 v217, s[4:7], s94 offen offset:3072 lds
    s_add_u32 s94, s94, 32768
    s_and_b32 s94, s94, 262143
    s_waitcnt vmcnt(8)
    s_barrier
    v_lshrrev_b32 v252, 2, v254
    v_min_u32 v252, 60, v252
    s_add_u32 s55, s54, 0
    buffer_load_dword v251, v252, s[4:7], s55 offen sc0 sc1
    s_add_u32 m0, s62, 98304
    s_nop 0
    buffer_load_dwordx4 v217, s[4:7], s94 offen lds
    buffer_load_dwordx4 v217, s[4:7], s94 offen offset:1024 lds
    buffer_load_dwordx4 v217, s[4:7], s94 offen offset:2048 lds
    buffer_load_dwordx4 v217, s[4:7], s94 offen offset:3072 lds
    s_add_u32 s94, s94, 32768
    s_and_b32 s94, s94, 262143
    s_add_u32 m0, s62, 49152
    s_nop 0
    buffer_load_dwordx4 v203, s[12:15], s93 offen lds
    buffer_load_dwordx4 v204, s[12:15], s93 offen offset:1024 lds
    buffer_load_dwordx4 v205, s[12:15], s93 offen offset:2048 lds
    buffer_load_dwordx4 v206, s[12:15], s93 offen offset:3072 lds
    s_add_u32 s93, s93, 524288
    s_and_b32 s93, s93, 2097151
    s_waitcnt vmcnt(9)
    s_barrier
    s_add_u32 m0, s62, 114688
    s_nop 0
    buffer_load_dwordx4 v217, s[4:7], s94 offen lds
    buffer_load_dwordx4 v217, s[4:7], s94 offen offset:1024 lds
    buffer_load_dwordx4 v217, s[4:7], s94 offen offset:2048 lds
    buffer_load_dwordx4 v217, s[4:7], s94 offen offset:3072 lds
    s_add_u32 s94, s94, 49152
    s_and_b32 s94, s94, 262143
    s_waitcnt vmcnt(8)
    s_barrier
    v_cmp_ne_u32 vcc, 0x01010101, v251
    s_cbranch_vccz ap_58
    v_lshrrev_b32 v252, 2, v254
    v_min_u32 v252, 60, v252
    s_add_u32 s55, s54, 0
    s_mov_b32 s56, 262144
poll_59:
    buffer_load_dword v253, v252, s[4:7], s55 offen sc0 sc1
    s_waitcnt vmcnt(0)
    v_cmp_ne_u32 vcc, 0x01010101, v253
    s_cbranch_vccz pd_60
    s_sleep 1
    s_sub_u32 s56, s56, 1
    s_cmp_lg_u32 s56, 0
    s_cbranch_scc1 poll_59
pd_60:
ap_58:
    s_add_u32 m0, s62, 131072
    s_nop 0
    buffer_load_dwordx4 v217, s[4:7], s94 offen lds
    buffer_load_dwordx4 v217, s[4:7], s94 offen offset:1024 lds
    buffer_load_dwordx4 v217, s[4:7], s94 offen offset:2048 lds
    buffer_load_dwordx4 v217, s[4:7], s94 offen offset:3072 lds
    s_add_u32 s94, s94, 32768
    s_and_b32 s94, s94, 262143
    s_waitcnt vmcnt(4)
    s_barrier
    s_add_u32 m0, s62, 98304
    s_nop 0
    buffer_load_dwordx4 v217, s[4:7], s94 offen lds
    buffer_load_dwordx4 v217, s[4:7], s94 offen offset:1024 lds
    buffer_load_dwordx4 v217, s[4:7], s94 offen offset:2048 lds
    buffer_load_dwordx4 v217, s[4:7], s94 offen offset:3072 lds
    s_add_u32 s94, s94, 32768
    s_and_b32 s94, s94, 262143
    s_waitcnt vmcnt(4)
    s_barrier
    s_add_u32 m0, s62, 114688
    s_nop 0
    buffer_load_dwordx4 v217, s[4:7], s94 offen lds
    buffer_load_dwordx4 v217, s[4:7], s94 offen offset:1024 lds
    buffer_load_dwordx4 v217, s[4:7], s94 offen offset:2048 lds
    buffer_load_dwordx4 v217, s[4:7], s94 offen offset:3072 lds
    s_add_u32 s94, s94, 32768
    s_and_b32 s94, s94, 262143
    s_waitcnt vmcnt(4)
    s_barrier
    s_add_u32 m0, s62, 131072
    s_nop 0
    buffer_load_dwordx4 v217, s[4:7], s94 offen lds
    buffer_load_dwordx4 v217, s[4:7], s94 offen offset:1024 lds
    buffer_load_dwordx4 v217, s[4:7], s94 offen offset:2048 lds
    buffer_load_dwordx4 v217, s[4:7], s94 offen offset:3072 lds
    s_add_u32 s94, s94, 32768
    s_and_b32 s94, s94, 262143
    s_waitcnt vmcnt(4)
    s_barrier
    s_add_u32 m0, s62, 98304
    s_nop 0
    buffer_load_dwordx4 v217, s[4:7], s94 offen lds
    buffer_load_dwordx4 v217, s[4:7], s94 offen offset:1024 lds
    buffer_load_dwordx4 v217, s[4:7], s94 offen offset:2048 lds
    buffer_load_dwordx4 v217, s[4:7], s94 offen offset:3072 lds
    s_add_u32 s94, s94, 32768
    s_and_b32 s94, s94, 262143
    s_waitcnt vmcnt(4)
    s_barrier
    s_add_u32 m0, s62, 114688
    s_nop 0
    buffer_load_dwordx4 v217, s[4:7], s94 offen lds
    buffer_load_dwordx4 v217, s[4:7], s94 offen offset:1024 lds
    buffer_load_dwordx4 v217, s[4:7], s94 offen offset:2048 lds
    buffer_load_dwordx4 v217, s[4:7], s94 offen offset:3072 lds
    s_add_u32 s94, s94, 32768
    s_and_b32 s94, s94, 262143
    s_waitcnt vmcnt(4)
    s_barrier
    s_add_u32 m0, s62, 131072
    s_nop 0
    buffer_load_dwordx4 v217, s[4:7], s94 offen lds
    buffer_load_dwordx4 v217, s[4:7], s94 offen offset:1024 lds
    buffer_load_dwordx4 v217, s[4:7], s94 offen offset:2048 lds
    buffer_load_dwordx4 v217, s[4:7], s94 offen offset:3072 lds
    s_add_u32 s94, s94, 32768
    s_and_b32 s94, s94, 262143
    s_waitcnt vmcnt(4)
    s_barrier
    s_add_u32 m0, s62, 98304
    s_nop 0
    buffer_load_dwordx4 v217, s[4:7], s94 offen lds
    buffer_load_dwordx4 v217, s[4:7], s94 offen offset:1024 lds
    buffer_load_dwordx4 v217, s[4:7], s94 offen offset:2048 lds
    buffer_load_dwordx4 v217, s[4:7], s94 offen offset:3072 lds
    s_waitcnt vmcnt(4)
    s_barrier
    s_lshl_b32 s93, s51, 12
    s_add_u32 m0, s62, 65536
    s_mul_i32 s59, s93, 112
    buffer_load_dwordx4 v207, s[28:31], s59 offen lds
    buffer_load_dwordx4 v208, s[28:31], s59 offen offset:1024 lds
    buffer_load_dwordx4 v209, s[28:31], s59 offen offset:2048 lds
    buffer_load_dwordx4 v210, s[28:31], s59 offen offset:3072 lds
    s_add_u32 s93, s93, 2048
    s_and_b32 s93, s93, 65535
    s_waitcnt vmcnt(4)
    s_barrier
    s_add_u32 m0, s62, 81920
    s_mul_i32 s59, s93, 112
    buffer_load_dwordx4 v207, s[28:31], s59 offen lds
    buffer_load_dwordx4 v208, s[28:31], s59 offen offset:1024 lds
    buffer_load_dwordx4 v209, s[28:31], s59 offen offset:2048 lds
    buffer_load_dwordx4 v210, s[28:31], s59 offen offset:3072 lds
    s_add_u32 s93, s93, 6144
    s_and_b32 s93, s93, 65535
    s_barrier
    s_add_u32 m0, s62, 0
    s_mul_i32 s59, s93, 112
    buffer_load_dwordx4 v207, s[28:31], s59 offen lds
    buffer_load_dwordx4 v208, s[28:31], s59 offen offset:1024 lds
    buffer_load_dwordx4 v209, s[28:31], s59 offen offset:2048 lds
    buffer_load_dwordx4 v210, s[28:31], s59 offen offset:3072 lds
    s_add_u32 s93, s93, 2048
    s_and_b32 s93, s93, 65535
    s_add_u32 m0, s62, 16384
    s_mul_i32 s59, s93, 112
    buffer_load_dwordx4 v207, s[28:31], s59 offen lds
    buffer_load_dwordx4 v208, s[28:31], s59 offen offset:1024 lds
    buffer_load_dwordx4 v209, s[28:31], s59 offen offset:2048 lds
    buffer_load_dwordx4 v210, s[28:31], s59 offen offset:3072 lds
    s_add_u32 s93, s93, 6144
    s_and_b32 s93, s93, 65535
    s_cmp_lg_u32 s46, 0
    s_cbranch_scc1 jf_61
    v_mov_b32 v104, 0x3f80
    v_lshrrev_b32 v224, 4, v254
    v_and_b32 v225, 1, v224
    v_lshlrev_b32 v225, 4, v225
    v_lshlrev_b32 v225, v225, v104
    v_bfe_u32 v224, v224, 1, 3
    v_cmp_eq_u32 vcc, 0, v224
    s_nop 1
    v_cndmask_b32 v104, 0, v225, vcc
    v_cmp_eq_u32 vcc, 1, v224
    s_nop 1
    v_cndmask_b32 v105, 0, v225, vcc
    v_cmp_eq_u32 vcc, 2, v224
    s_nop 1
    v_cndmask_b32 v106, 0, v225, vcc
    v_cmp_eq_u32 vcc, 3, v224
    s_nop 1
    v_cndmask_b32 v107, 0, v225, vcc
    s_nop 1
    v_mfma_f32_16x16x32_bf16 v[100:103], v[104:107], v[0:3], 0
    v_mfma_f32_16x16x32_bf16 v[100:103], v[104:107], v[4:7], v[100:103]
    v_mfma_f32_16x16x32_bf16 v[100:103], v[104:107], v[8:11], v[100:103]
    v_mfma_f32_16x16x32_bf16 v[100:103], v[104:107], v[12:15], v[100:103]
    v_mfma_f32_16x16x32_bf16 v[100:103], v[104:107], v[16:19], v[100:103]
    v_mfma_f32_16x16x32_bf16 v[100:103], v[104:107], v[20:23], v[100:103]
    v_mfma_f32_16x16x32_bf16 v[100:103], v[104:107], v[24:27], v[100:103]
    v_mfma_f32_16x16x32_bf16 v[100:103], v[104:107], v[28:31], v[100:103]
    v_mfma_f32_16x16x32_bf16 v[100:103], v[104:107], v[32:35], v[100:103]
    v_mfma_f32_16x16x32_bf16 v[100:103], v[104:107], v[36:39], v[100:103]
    v_mfma_f32_16x16x32_bf16 v[100:103], v[104:107], v[40:43], v[100:103]
    v_mfma_f32_16x16x32_bf16 v[100:103], v[104:107], v[44:47], v[100:103]
    v_mfma_f32_16x16x32_bf16 v[100:103], v[104:107], v[48:51], v[100:103]
    v_mfma_f32_16x16x32_bf16 v[100:103], v[104:107], v[52:55], v[100:103]
    v_mfma_f32_16x16x32_bf16 v[100:103], v[104:107], v[56:59], v[100:103]
    v_mfma_f32_16x16x32_bf16 v[100:103], v[104:107], v[60:63], v[100:103]
    s_and_b32 s56, s2, 1
    s_lshl_b32 s56, s56, 2
    s_add_u32 s56, s56, s42
    s_mul_i32 s56, s56, 28672
    s_lshr_b32 s55, s2, 1
    s_lshl_b32 s55, s55, 8
    s_add_u32 s55, s55, s56
    s_add_u32 s55, s55, 70778880
    s_cmp_lt_u32 s2, 224
    s_cselect_b32 s55, s55, 2130706432
    v_and_b32 v224, 0x70, v254
    v_lshrrev_b32 v225, 4, v254
    v_and_b32 v225, 16, v225
    v_lshl_add_u32 v224, v224, 1, v225
    s_nop 2
    v_add_f32_dpp v100, v100, v100 row_ror:8 row_mask:0xf bank_mask:0xf
    v_add_f32_dpp v101, v101, v101 row_ror:8 row_mask:0xf bank_mask:0xf
    v_add_f32_dpp v102, v102, v102 row_ror:8 row_mask:0xf bank_mask:0xf
    v_add_f32_dpp v103, v103, v103 row_ror:8 row_mask:0xf bank_mask:0xf
    s_mov_b64 exec, 0x00ff00ff
    buffer_store_dwordx4 v[100:103], v224, s[4:7], s55 offen sc0 sc1
    s_mov_b64 exec, -1
jf_61:
    s_add_u32 s88, s49, s62
    s_lshl_b32 s94, s51, 14
    v_add_u32 v217, s88, v254
    s_and_b32 s55, s51, 1
    s_mul_i32 s55, s55, 458752
    s_add_u32 s95, s50, s55
    s_and_b32 s55, s41, 7
    s_lshl_b32 s55, s55, 14
    s_and_b32 s56, s1, 0x3fff
    s_add_u32 s55, s55, s56
    s_add_u32 s89, s55, s95
    s_and_b32 s55, s41, 6
    s_add_u32 s55, s55, 48
    s_lshl_b32 s55, s55, 13
    s_and_b32 s56, s41, 1
    s_lshl_b32 s56, s56, 10
    s_add_u32 s55, s55, s56
    s_add_u32 s55, s55, s62
    s_add_u32 s90, s55, s95
    s_barrier
    s_add_u32 m0, s62, 98304
    s_nop 0
    buffer_load_dwordx4 v217, s[4:7], s94 offen lds
    buffer_load_dwordx4 v217, s[4:7], s94 offen offset:1024 lds
    buffer_load_dwordx4 v217, s[4:7], s94 offen offset:2048 lds
    buffer_load_dwordx4 v217, s[4:7], s94 offen offset:3072 lds
    s_add_u32 s94, s94, 32768
    s_and_b32 s94, s94, 262143
    s_waitcnt vmcnt(0)
    s_barrier
    v_lshrrev_b32 v252, 2, v254
    v_min_u32 v252, 28, v252
    s_add_u32 s55, s0, 32
    buffer_load_dword v251, v252, s[4:7], s55 offen sc0 sc1
    s_setprio 1
    s_barrier
    s_waitcnt vmcnt(0)
    v_cmp_ne_u32 vcc, 0x01010101, v251
    s_cbranch_vccz ap_62
    v_lshrrev_b32 v252, 2, v254
    v_min_u32 v252, 28, v252
    s_add_u32 s55, s0, 32
    s_mov_b32 s56, 262144
poll_63:
    buffer_load_dword v253, v252, s[4:7], s55 offen sc0 sc1
    s_waitcnt vmcnt(0)
    v_cmp_ne_u32 vcc, 0x01010101, v253
    s_cbranch_vccz pd_64
    s_sleep 1
    s_sub_u32 s56, s56, 1
    s_cmp_lg_u32 s56, 0
    s_cbranch_scc1 poll_63
pd_64:
ap_62:
    s_add_u32 m0, s62, 114688
    s_nop 0
    buffer_load_dwordx4 v217, s[4:7], s94 offen lds
    buffer_load_dwordx4 v217, s[4:7], s94 offen offset:1024 lds
    buffer_load_dwordx4 v217, s[4:7], s94 offen offset:2048 lds
    buffer_load_dwordx4 v217, s[4:7], s94 offen offset:3072 lds
    s_add_u32 s94, s94, 32768
    s_and_b32 s94, s94, 262143
    s_add_u32 m0, s62, 131072
    s_nop 0
    buffer_load_dwordx4 v217, s[4:7], s94 offen lds
    buffer_load_dwordx4 v217, s[4:7], s94 offen offset:1024 lds
    buffer_load_dwordx4 v217, s[4:7], s94 offen offset:2048 lds
    buffer_load_dwordx4 v217, s[4:7], s94 offen offset:3072 lds
    s_add_u32 s94, s94, 32768
    s_and_b32 s94, s94, 262143
    s_add_u32 m0, s62, 32768
    s_mul_i32 s59, s93, 112
    buffer_load_dwordx4 v207, s[28:31], s59 offen lds
    buffer_load_dwordx4 v208, s[28:31], s59 offen offset:1024 lds
    buffer_load_dwordx4 v209, s[28:31], s59 offen offset:2048 lds
    buffer_load_dwordx4 v210, s[28:31], s59 offen offset:3072 lds
    s_add_u32 s93, s93, 2048
    s_and_b32 s93, s93, 65535
    s_waitcnt vmcnt(8)
    s_barrier
    s_add_u32 m0, s62, 98304
    s_nop 0
    buffer_load_dwordx4 v217, s[4:7], s94 offen lds
    buffer_load_dwordx4 v217, s[4:7], s94 offen offset:1024 lds
    s_add_u32 m0, s62, 49152
    s_mul_i32 s59, s93, 112
    buffer_load_dwordx4 v207, s[28:31], s59 offen lds
    buffer_load_dwordx4 v208, s[28:31], s59 offen offset:1024 lds
    buffer_load_dwordx4 v209, s[28:31], s59 offen offset:2048 lds
    buffer_load_dwordx4 v210, s[28:31], s59 offen offset:3072 lds
    s_add_u32 s93, s93, 6144
    s_and_b32 s93, s93, 65535
    s_add_u32 m0, s62, 65536
    s_mul_i32 s59, s93, 112
    buffer_load_dwordx4 v207, s[28:31], s59 offen lds
    s_barrier
    s_add_u32 m0, s62, 98304
    s_nop 0
    buffer_load_dwordx4 v217, s[4:7], s94 offen offset:2048 lds
    buffer_load_dwordx4 v217, s[4:7], s94 offen offset:3072 lds
    s_add_u32 s94, s94, 32768
    s_and_b32 s94, s94, 262143
    s_add_u32 m0, s62, 65536
    s_nop 0
    buffer_load_dwordx4 v208, s[28:31], s59 offen offset:1024 lds
    buffer_load_dwordx4 v209, s[28:31], s59 offen offset:2048 lds
    buffer_load_dwordx4 v210, s[28:31], s59 offen offset:3072 lds
    s_add_u32 s93, s93, 2048
    s_and_b32 s93, s93, 65535
    s_add_u32 m0, s62, 81920
    s_mul_i32 s59, s93, 112
    buffer_load_dwordx4 v207, s[28:31], s59 offen lds
    buffer_load_dwordx4 v208, s[28:31], s59 offen offset:1024 lds
    s_cmp_lg_u32 s42, 0
    s_cbranch_scc1 wf_65
    s_lshl_b32 s55, s51, 2
    s_add_u32 s55, s55, s54
    v_mov_b32 v252, 12288
    v_mov_b32 v253, 0x01010101
    s_mov_b64 exec, 1
    buffer_store_dword v253, v252, s[4:7], s55 offen sc0 sc1
    s_mov_b64 exec, -1
wf_65:
    s_xor_b32 s55, s42, 1
    s_or_b32 s55, s46, s55
    s_cbranch_scc1 cf_66
    v_mov_b32 v252, 0
    v_mov_b32 v253, 1
    s_lshl_b32 s55, s2, 2
    s_add_u32 s55, s55, 71566336
    s_mov_b64 exec, 1
    buffer_store_dword v253, v252, s[4:7], s55 offen sc0 sc1
    s_mov_b64 exec, -1
cf_66:
    s_waitcnt vmcnt(14)
    s_barrier
    s_add_u32 m0, s62, 114688
    s_nop 0
    buffer_load_dwordx4 v217, s[4:7], s94 offen lds
    buffer_load_dwordx4 v217, s[4:7], s94 offen offset:1024 lds
    s_add_u32 m0, s62, 81920
    s_nop 0
    buffer_load_dwordx4 v209, s[28:31], s59 offen offset:2048 lds
    buffer_load_dwordx4 v210, s[28:31], s59 offen offset:3072 lds
    s_add_u32 s93, s93, 6144
    s_and_b32 s93, s93, 65535
    s_add_u32 m0, s62, 0
    s_mul_i32 s59, s93, 112
    buffer_load_dwordx4 v207, s[28:31], s59 offen lds
    buffer_load_dwordx4 v208, s[28:31], s59 offen offset:1024 lds
    buffer_load_dwordx4 v209, s[28:31], s59 offen offset:2048 lds
    s_waitcnt vmcnt(15)
    s_barrier
    s_add_u32 m0, s62, 114688
    s_nop 0
    buffer_load_dwordx4 v217, s[4:7], s94 offen offset:2048 lds
    buffer_load_dwordx4 v217, s[4:7], s94 offen offset:3072 lds
    s_add_u32 s94, s94, 32768
    s_and_b32 s94, s94, 262143
    s_add_u32 m0, s62, 0
    s_nop 0
    buffer_load_dwordx4 v210, s[28:31], s59 offen offset:3072 lds
    s_add_u32 s93, s93, 2048
    s_and_b32 s93, s93, 65535
    s_add_u32 m0, s62, 16384
    s_mul_i32 s59, s93, 112
    buffer_load_dwordx4 v207, s[28:31], s59 offen lds
    buffer_load_dwordx4 v208, s[28:31], s59 offen offset:1024 lds
    buffer_load_dwordx4 v209, s[28:31], s59 offen offset:2048 lds
    buffer_load_dwordx4 v210, s[28:31], s59 offen offset:3072 lds
    s_add_u32 s93, s93, 6144
    s_and_b32 s93, s93, 65535
    s_lshl_b32 s55, s46, 4
    s_lshr_b32 s56, s40, 1
    s_add_u32 s55, s55, s56
    s_cmp_lg_u32 s55, 0
    s_cbranch_scc1 w2_67
    v_lshlrev_b32 v252, 3, v254
    s_lshl_b32 s55, s2, 2
    s_add_u32 s55, s55, s42
    s_lshl_b32 s55, s55, 13
    buffer_load_dword v250, v252, s[20:23], s55 offen
w2_67:
    s_waitcnt vmcnt(16)
    s_barrier
    s_add_u32 m0, s62, 131072
    s_nop 0
    buffer_load_dwordx4 v217, s[4:7], s94 offen lds
    buffer_load_dwordx4 v217, s[4:7], s94 offen offset:1024 lds
    s_add_u32 m0, s62, 32768
    s_mul_i32 s59, s93, 112
    buffer_load_dwordx4 v207, s[28:31], s59 offen lds
    buffer_load_dwordx4 v208, s[28:31], s59 offen offset:1024 lds
    buffer_load_dwordx4 v209, s[28:31], s59 offen offset:2048 lds
    buffer_load_dwordx4 v210, s[28:31], s59 offen offset:3072 lds
    s_add_u32 s93, s93, 2048
    s_and_b32 s93, s93, 65535
    s_add_u32 m0, s62, 49152
    s_mul_i32 s59, s93, 112
    buffer_load_dwordx4 v207, s[28:31], s59 offen lds
    s_waitcnt vmcnt(17)
    s_barrier
    v_lshrrev_b32 v252, 2, v254
    v_min_u32 v252, 60, v252
    s_add_u32 s55, s54, 12288
    buffer_load_dword v251, v252, s[4:7], s55 offen sc0 sc1
    s_add_u32 m0, s62, 131072
    s_nop 0
    buffer_load_dwordx4 v217, s[4:7], s94 offen offset:2048 lds
    buffer_load_dwordx4 v217, s[4:7], s94 offen offset:3072 lds
    s_add_u32 s94, s94, 32768
    s_and_b32 s94, s94, 262143
    s_add_u32 m0, s62, 49152
    s_nop 0
    buffer_load_dwordx4 v208, s[28:31], s59 offen offset:1024 lds
    buffer_load_dwordx4 v209, s[28:31], s59 offen offset:2048 lds
    buffer_load_dwordx4 v210, s[28:31], s59 offen offset:3072 lds
    s_add_u32 s93, s93, 6144
    s_and_b32 s93, s93, 65535
    s_add_u32 m0, s62, 65536
    s_mul_i32 s59, s93, 112
    buffer_load_dwordx4 v207, s[28:31], s59 offen lds
    buffer_load_dwordx4 v208, s[28:31], s59 offen offset:1024 lds
    s_lshl_b32 s55, s46, 4
    s_lshr_b32 s56, s40, 1
    s_add_u32 s55, s55, s56
    s_cmp_lg_u32 s55, 1
    s_cbranch_scc1 w2_68
    v_lshlrev_b32 v252, 3, v254
    s_lshl_b32 s55, s2, 2
    s_add_u32 s55, s55, s42
    s_lshl_b32 s55, s55, 13
    buffer_load_dword v250, v252, s[20:23], s55 offen
w2_68:
    s_waitcnt vmcnt(19)
    s_barrier
    s_add_u32 m0, s62, 98304
    s_nop 0
    buffer_load_dwordx4 v217, s[4:7], s94 offen lds
    buffer_load_dwordx4 v217, s[4:7], s94 offen offset:1024 lds
    s_add_u32 m0, s62, 65536
    s_nop 0
    buffer_load_dwordx4 v209, s[28:31], s59 offen offset:2048 lds
    buffer_load_dwordx4 v210, s[28:31], s59 offen offset:3072 lds
    s_add_u32 s93, s93, 2048
    s_and_b32 s93, s93, 65535
    s_add_u32 m0, s62, 81920
    s_mul_i32 s59, s93, 112
    buffer_load_dwordx4 v207, s[28:31], s59 offen lds
    buffer_load_dwordx4 v208, s[28:31], s59 offen offset:1024 lds
    buffer_load_dwordx4 v209, s[28:31], s59 offen offset:2048 lds
    s_waitcnt vmcnt(22)
    s_barrier
    s_add_u32 m0, s62, 98304
    s_nop 0
    buffer_load_dwordx4 v217, s[4:7], s94 offen offset:2048 lds
    buffer_load_dwordx4 v217, s[4:7], s94 offen offset:3072 lds
    s_add_u32 s94, s94, 32768
    s_and_b32 s94, s94, 262143
    s_add_u32 m0, s62, 81920
    s_nop 0
    buffer_load_dwordx4 v210, s[28:31], s59 offen offset:3072 lds
    s_add_u32 s93, s93, 6144
    s_and_b32 s93, s93, 65535
    s_add_u32 m0, s62, 0
    s_mul_i32 s59, s93, 112
    buffer_load_dwordx4 v207, s[28:31], s59 offen lds
    buffer_load_dwordx4 v208, s[28:31], s59 offen offset:1024 lds
    buffer_load_dwordx4 v209, s[28:31], s59 offen offset:2048 lds
    buffer_load_dwordx4 v210, s[28:31], s59 offen offset:3072 lds
    s_add_u32 s93, s93, 2048
    s_and_b32 s93, s93, 65535
    s_lshl_b32 s55, s46, 4
    s_lshr_b32 s56, s40, 1
    s_add_u32 s55, s55, s56
    s_cmp_lg_u32 s55, 2
    s_cbranch_scc1 w2_69
    v_lshlrev_b32 v252, 3, v254
    s_lshl_b32 s55, s2, 2
    s_add_u32 s55, s55, s42
    s_lshl_b32 s55, s55, 13
    buffer_load_dword v250, v252, s[20:23], s55 offen
w2_69:
    s_waitcnt vmcnt(19)
    s_barrier
    v_cmp_ne_u32 vcc, 0x01010101, v251
    s_cbranch_vccz ap_70
    v_lshrrev_b32 v252, 2, v254
    v_min_u32 v252, 60, v252
    s_add_u32 s55, s54, 12288
    s_mov_b32 s56, 262144
poll_71:
    buffer_load_dword v253, v252, s[4:7], s55 offen sc0 sc1
    s_waitcnt vmcnt(0)
    v_cmp_ne_u32 vcc, 0x01010101, v253
    s_cbranch_vccz pd_72
    s_sleep 1
    s_sub_u32 s56, s56, 1
    s_cmp_lg_u32 s56, 0
    s_cbranch_scc1 poll_71
pd_72:
ap_70:
    s_add_u32 m0, s62, 114688
    s_nop 0
    buffer_load_dwordx4 v217, s[4:7], s94 offen lds
    buffer_load_dwordx4 v217, s[4:7], s94 offen offset:1024 lds
    s_add_u32 m0, s62, 16384
    s_mul_i32 s59, s93, 112
    buffer_load_dwordx4 v207, s[28:31], s59 offen lds
    v_and_b32 v226, 0xf0, v254
    v_and_b32 v227, 0x300, v254
    v_lshl_add_u32 v227, v227, 2, v226
    s_lshl_b32 s78, s42, 8
    s_add_u32 s78, s78, s52
    buffer_load_dwordx4 v208, s[28:31], s59 offen offset:1024 lds
    buffer_load_dwordx4 v209, s[28:31], s59 offen offset:2048 lds
    buffer_load_dwordx4 v210, s[28:31], s59 offen offset:3072 lds
    s_add_u32 s93, s93, 10240
    s_and_b32 s93, s93, 65535
    buffer_load_dwordx4 v[96:99], v227, s[4:7], s78 offen
    s_add_u32 s78, s78, 4096
    s_waitcnt vmcnt(23)
    s_barrier
    s_mov_b32 s55, 71566336
    buffer_load_dwordx4 v[128:131], v254, s[4:7], s55 offen sc0 sc1
    s_add_u32 m0, s62, 114688
    s_nop 0
    buffer_load_dwordx4 v217, s[4:7], s94 offen offset:2048 lds
    buffer_load_dwordx4 v217, s[4:7], s94 offen offset:3072 lds
    s_add_u32 s94, s94, 49152
    s_and_b32 s94, s94, 262143
    s_add_u32 m0, s62, 32768
    s_mul_i32 s59, s93, 112
    buffer_load_dwordx4 v207, s[28:31], s59 offen lds
    buffer_load_dwordx4 v208, s[28:31], s59 offen offset:1024 lds
    buffer_load_dwordx4 v209, s[28:31], s59 offen offset:2048 lds
    buffer_load_dwordx4 v210, s[28:31], s59 offen offset:3072 lds
    s_add_u32 s93, s93, 2048
    s_and_b32 s93, s93, 65535
    buffer_load_dwordx4 v[100:103], v227, s[4:7], s78 offen
    s_add_u32 s78, s78, 4096
    s_lshl_b32 s55, s46, 4
    s_lshr_b32 s56, s40, 1
    s_add_u32 s55, s55, s56
    s_cmp_lg_u32 s55, 3
    s_cbranch_scc1 w2_73
    v_lshlrev_b32 v252, 3, v254
    s_lshl_b32 s55, s2, 2
    s_add_u32 s55, s55, s42
    s_lshl_b32 s55, s55, 13
    buffer_load_dword v250, v252, s[20:23], s55 offen
w2_73:
    s_waitcnt vmcnt(20)
    s_barrier
    s_add_u32 m0, s62, 131072
    s_nop 0
    buffer_load_dwordx4 v217, s[4:7], s94 offen lds
    buffer_load_dwordx4 v217, s[4:7], s94 offen offset:1024 lds
    s_add_u32 m0, s62, 49152
    s_mul_i32 s59, s93, 112
    buffer_load_dwordx4 v207, s[28:31], s59 offen lds
    buffer_load_dwordx4 v208, s[28:31], s59 offen offset:1024 lds
    buffer_load_dwordx4 v209, s[28:31], s59 offen offset:2048 lds
    buffer_load_dwordx4 v210, s[28:31], s59 offen offset:3072 lds
    s_add_u32 s93, s93, 6144
    s_and_b32 s93, s93, 65535
    buffer_load_dwordx4 v[104:107], v227, s[4:7], s78 offen
    s_add_u32 s78, s78, 4096
    s_waitcnt vmcnt(26)
    s_barrier
    s_add_u32 m0, s62, 131072
    s_nop 0
    buffer_load_dwordx4 v217, s[4:7], s94 offen offset:2048 lds
    buffer_load_dwordx4 v217, s[4:7], s94 offen offset:3072 lds
    s_add_u32 s94, s94, 32768
    s_and_b32 s94, s94, 262143
    s_add_u32 m0, s62, 65536
    s_mul_i32 s59, s93, 112
    buffer_load_dwordx4 v207, s[28:31], s59 offen lds
    buffer_load_dwordx4 v208, s[28:31], s59 offen offset:1024 lds
    buffer_load_dwordx4 v209, s[28:31], s59 offen offset:2048 lds
    buffer_load_dwordx4 v210, s[28:31], s59 offen offset:3072 lds
    s_add_u32 s93, s93, 2048
    s_and_b32 s93, s93, 65535
    buffer_load_dwordx4 v[108:111], v227, s[4:7], s78 offen
    s_add_u32 s78, s78, 4096
    s_lshl_b32 s55, s46, 4
    s_lshr_b32 s56, s40, 1
    s_add_u32 s55, s55, s56
    s_cmp_lg_u32 s55, 4
    s_cbranch_scc1 w2_74
    v_lshlrev_b32 v252, 3, v254
    s_lshl_b32 s55, s2, 2
    s_add_u32 s55, s55, s42
    s_lshl_b32 s55, s55, 13
    buffer_load_dword v250, v252, s[20:23], s55 offen
w2_74:
    s_waitcnt vmcnt(19)
    s_barrier
    s_cmp_eq_u32 s46, 1
    s_cbranch_scc1 a4_75
    v_and_b32 v128, v128, v129
    v_and_b32 v130, v130, v131
    v_and_b32 v128, v128, v130
    v_cmp_ne_u32 vcc, 1, v128
    s_cbranch_vccz a4_75
    s_mov_b32 s55, 71566336
    s_mov_b32 s56, 262144
p4_76:
    buffer_load_dwordx4 v[128:131], v254, s[4:7], s55 offen sc0 sc1
    s_waitcnt vmcnt(0)
    v_and_b32 v128, v128, v129
    v_and_b32 v130, v130, v131
    v_and_b32 v128, v128, v130
    v_cmp_ne_u32 vcc, 1, v128
    s_cbranch_vccz p4_77
    s_sleep 1
    s_sub_u32 s56, s56, 1
    s_cmp_lg_u32 s56, 0
    s_cbranch_scc1 p4_76
p4_77:
a4_75:
    s_cmp_lg_u32 s46, 0
    s_cbranch_scc1 cs_78
    s_and_b32 s55, s41, 1
    s_mul_i32 s56, s55, 384
    s_xor_b32 s55, s55, 1
    s_lshl_b32 s55, s55, 9
    s_cmp_eq_u32 s44, 0
    s_cselect_b32 s55, s56, s55
    s_mul_i32 s56, s41, 896
    s_add_u32 s55, s55, s56
    s_mul_i32 s56, s43, 14336
    s_add_u32 s55, s55, s56
    s_add_u32 s55, s55, 70778880
    v_lshrrev_b32 v224, 9, v254
    v_mul_u32_u24 v224, 28672, v224
    v_and_b32 v225, 0x1f0, v254
    v_add_u32 v224, v224, v225
    buffer_load_dwordx4 v[128:131], v224, s[4:7], s55 offen sc1
    s_add_u32 s55, s55, 57344
    buffer_load_dwordx4 v[132:135], v224, s[4:7], s55 offen sc1
    s_add_u32 s55, s55, 57344
    buffer_load_dwordx4 v[136:139], v224, s[4:7], s55 offen sc1
    s_add_u32 s55, s55, 57344
    buffer_load_dwordx4 v[140:143], v224, s[4:7], s55 offen sc1
    s_add_u32 s55, s55, 57344
cs_78:
    s_add_u32 m0, s62, 98304
    s_nop 0
    buffer_load_dwordx4 v217, s[4:7], s94 offen lds
    buffer_load_dwordx4 v217, s[4:7], s94 offen offset:1024 lds
    s_add_u32 m0, s62, 81920
    s_mul_i32 s59, s93, 112
    buffer_load_dwordx4 v207, s[28:31], s59 offen lds
    buffer_load_dwordx4 v208, s[28:31], s59 offen offset:1024 lds
    buffer_load_dwordx4 v209, s[28:31], s59 offen offset:2048 lds
    buffer_load_dwordx4 v210, s[28:31], s59 offen offset:3072 lds
    s_add_u32 s93, s93, 6144
    s_and_b32 s93, s93, 65535
    s_barrier
    s_add_u32 m0, s62, 98304
    s_nop 0
    buffer_load_dwordx4 v217, s[4:7], s94 offen offset:2048 lds
    buffer_load_dwordx4 v217, s[4:7], s94 offen offset:3072 lds
    s_add_u32 s94, s94, 32768
    s_and_b32 s94, s94, 262143
    s_add_u32 m0, s62, 0
    s_mul_i32 s59, s93, 112
    buffer_load_dwordx4 v207, s[28:31], s59 offen lds
    buffer_load_dwordx4 v208, s[28:31], s59 offen offset:1024 lds
    buffer_load_dwordx4 v209, s[28:31], s59 offen offset:2048 lds
    buffer_load_dwordx4 v210, s[28:31], s59 offen offset:3072 lds
    s_add_u32 s93, s93, 2048
    s_and_b32 s93, s93, 65535
    s_lshl_b32 s55, s46, 4
    s_lshr_b32 s56, s40, 1
    s_add_u32 s55, s55, s56
    s_cmp_lg_u32 s55, 5
    s_cbranch_scc1 w2_79
    v_lshlrev_b32 v252, 3, v254
    s_lshl_b32 s55, s2, 2
    s_add_u32 s55, s55, s42
    s_lshl_b32 s55, s55, 13
    buffer_load_dword v250, v252, s[20:23], s55 offen
w2_79:
    s_waitcnt vmcnt(17)
    s_barrier
    s_waitcnt vmcnt(12)
    s_add_u32 m0, s62, 114688
    s_nop 0
    buffer_load_dwordx4 v217, s[4:7], s94 offen lds
    v_add_f32 v96, v96, v100
    v_add_f32 v97, v97, v101
    v_add_f32 v98, v98, v102
    v_add_f32 v99, v99, v103
    buffer_load_dwordx4 v217, s[4:7], s94 offen offset:1024 lds
    v_add_f32 v104, v104, v108
    v_add_f32 v105, v105, v109
    v_add_f32 v106, v106, v110
    v_add_f32 v107, v107, v111
    s_add_u32 m0, s62, 16384
    s_mul_i32 s59, s93, 112
    buffer_load_dwordx4 v207, s[28:31], s59 offen lds
    v_add_f32 v192, v96, v104
    v_add_f32 v193, v97, v105
    v_add_f32 v194, v98, v106
    v_add_f32 v195, v99, v107
    buffer_load_dwordx4 v208, s[28:31], s59 offen offset:1024 lds
    v_mov_b32 v96, v192
    v_mov_b32 v97, v193
    v_mov_b32 v98, v194
    v_mov_b32 v99, v195
    buffer_load_dwordx4 v209, s[28:31], s59 offen offset:2048 lds
    s_nop 1
    v_permlane16_swap_b32 v192, v96
    v_permlane16_swap_b32 v193, v97
    v_permlane16_swap_b32 v194, v98
    buffer_load_dwordx4 v210, s[28:31], s59 offen offset:3072 lds
    s_add_u32 s93, s93, 6144
    s_and_b32 s93, s93, 65535
    v_permlane16_swap_b32 v195, v99
    v_add_f32 v192, v192, v96
    v_add_f32 v193, v193, v97
    v_add_f32 v194, v194, v98
    v_add_f32 v195, v195, v99
    s_barrier
    s_add_u32 m0, s62, 114688
    s_nop 0
    buffer_load_dwordx4 v217, s[4:7], s94 offen offset:2048 lds
    v_mov_b32 v96, v192
    v_mov_b32 v97, v193
    buffer_load_dwordx4 v217, s[4:7], s94 offen offset:3072 lds
    s_add_u32 s94, s94, 32768
    s_and_b32 s94, s94, 262143
    v_mov_b32 v98, v194
    v_mov_b32 v99, v195
    s_add_u32 m0, s62, 32768
    s_mul_i32 s59, s93, 112
    buffer_load_dwordx4 v207, s[28:31], s59 offen lds
    s_nop 1
    v_permlane32_swap_b32 v192, v96
    buffer_load_dwordx4 v208, s[28:31], s59 offen offset:1024 lds
    v_permlane32_swap_b32 v193, v97
    v_permlane32_swap_b32 v194, v98
    buffer_load_dwordx4 v209, s[28:31], s59 offen offset:2048 lds
    v_permlane32_swap_b32 v195, v99
    v_add_f32 v192, v192, v96
    buffer_load_dwordx4 v210, s[28:31], s59 offen offset:3072 lds
    s_add_u32 s93, s93, 2048
    s_and_b32 s93, s93, 65535
    v_add_f32 v193, v193, v97
    v_add_f32 v194, v194, v98
    v_add_f32 v195, v195, v99
    s_lshl_b32 s55, s46, 4
    s_lshr_b32 s56, s40, 1
    s_add_u32 s55, s55, s56
    s_cmp_lg_u32 s55, 6
    s_cbranch_scc1 w2_80
    v_lshlrev_b32 v252, 3, v254
    s_lshl_b32 s55, s2, 2
    s_add_u32 s55, s55, s42
    s_lshl_b32 s55, s55, 13
    buffer_load_dword v250, v252, s[20:23], s55 offen
w2_80:
    s_waitcnt vmcnt(16)
    s_barrier
    s_cmp_lg_u32 s46, 0
    s_cbranch_scc1 cs_81
    v_add_f32 v128, v128, v132
    v_add_f32 v136, v136, v140
    v_add_f32 v129, v129, v133
    v_add_f32 v137, v137, v141
    v_add_f32 v130, v130, v134
    v_add_f32 v138, v138, v142
    v_add_f32 v131, v131, v135
    v_add_f32 v139, v139, v143
    v_add_f32 v128, v128, v136
    v_add_f32 v129, v129, v137
    v_add_f32 v130, v130, v138
    v_add_f32 v131, v131, v139
    v_mov_b32 v132, v128
    v_mov_b32 v133, v129
    v_mov_b32 v134, v130
    v_mov_b32 v135, v131
    s_nop 1
    v_permlane32_swap_b32 v128, v132
    v_permlane32_swap_b32 v129, v133
    v_permlane32_swap_b32 v130, v134
    v_permlane32_swap_b32 v131, v135
    v_add_f32 v128, v128, v132
    v_add_f32 v129, v129, v133
    v_add_f32 v130, v130, v134
    v_add_f32 v131, v131, v135
    s_lshl_b32 s55, s42, 9
    s_add_u32 s55, s55, 161664
    v_and_b32 v225, 0x1f0, v254
    v_add_u32 v224, s55, v225
    ds_write_b128 v224, v[128:131]
cs_81:
    s_add_u32 m0, s62, 131072
    s_nop 0
    buffer_load_dwordx4 v217, s[4:7], s94 offen lds
    v_mul_f32 v192, 0x3a800000, v192
    v_mul_f32 v193, 0x3a800000, v193
    buffer_load_dwordx4 v217, s[4:7], s94 offen offset:1024 lds
    v_fma_f32 v193, -v192, v192, v193
    v_max_f32 v193, 0, v193
    v_cvt_pk_bf16_f32 v192, v192, v192
    s_add_u32 m0, s62, 49152
    s_mul_i32 s59, s93, 112
    buffer_load_dwordx4 v207, s[28:31], s59 offen lds
    v_lshlrev_b32 v192, 16, v192
    v_cvt_pk_bf16_f32 v193, v193, v193
    v_lshlrev_b32 v193, 16, v193
    buffer_load_dwordx4 v208, s[28:31], s59 offen offset:1024 lds
    v_add_f32 v193, 0x3727c5ac, v193
    v_cvt_pk_bf16_f32 v193, v193, v193
    v_lshlrev_b32 v193, 16, v193
    buffer_load_dwordx4 v209, s[28:31], s59 offen offset:2048 lds
    v_sqrt_f32 v193, v193
    s_nop 0
    v_cvt_pk_bf16_f32 v193, v193, v193
    buffer_load_dwordx4 v210, s[28:31], s59 offen offset:3072 lds
    s_add_u32 s93, s93, 6144
    s_and_b32 s93, s93, 65535
    v_lshlrev_b32 v193, 16, v193
    v_rcp_f32 v193, v193
    s_nop 0
    s_barrier
    s_add_u32 m0, s62, 131072
    s_nop 0
    buffer_load_dwordx4 v217, s[4:7], s94 offen offset:2048 lds
    v_mul_f32 v194, 0x3a800000, v194
    v_mul_f32 v195, 0x3a800000, v195
    v_fma_f32 v195, -v194, v194, v195
    buffer_load_dwordx4 v217, s[4:7], s94 offen offset:3072 lds
    s_add_u32 s94, s94, 32768
    s_and_b32 s94, s94, 262143
    v_max_f32 v195, 0, v195
    v_cvt_pk_bf16_f32 v194, v194, v194
    v_lshlrev_b32 v194, 16, v194
    s_add_u32 m0, s62, 65536
    s_mul_i32 s59, s93, 112
    buffer_load_dwordx4 v207, s[28:31], s59 offen lds
    v_cvt_pk_bf16_f32 v195, v195, v195
    v_lshlrev_b32 v195, 16, v195
    v_add_f32 v195, 0x3727c5ac, v195
    buffer_load_dwordx4 v208, s[28:31], s59 offen offset:1024 lds
    v_cvt_pk_bf16_f32 v195, v195, v195
    v_lshlrev_b32 v195, 16, v195
    v_sqrt_f32 v195, v195
    buffer_load_dwordx4 v209, s[28:31], s59 offen offset:2048 lds
    s_nop 0
    v_cvt_pk_bf16_f32 v195, v195, v195
    v_lshlrev_b32 v195, 16, v195
    buffer_load_dwordx4 v210, s[28:31], s59 offen offset:3072 lds
    s_add_u32 s93, s93, 2048
    s_and_b32 s93, s93, 65535
    v_rcp_f32 v195, v195
    s_nop 0
    s_lshl_b32 s55, s42, 8
    s_add_u32 s55, s55, 159744
    v_add_u32 v226, s55, v226
    ds_write_b128 v226, v[192:195]
    s_lshl_b32 s55, s46, 4
    s_lshr_b32 s56, s40, 1
    s_add_u32 s55, s55, s56
    s_cmp_lg_u32 s55, 7
    s_cbranch_scc1 w2_82
    v_lshlrev_b32 v252, 3, v254
    s_lshl_b32 s55, s2, 2
    s_add_u32 s55, s55, s42
    s_lshl_b32 s55, s55, 13
    buffer_load_dword v250, v252, s[20:23], s55 offen
w2_82:
    s_waitcnt vmcnt(16)
    s_barrier
    s_add_u32 m0, s62, 98304
    s_nop 0
    buffer_load_dwordx4 v217, s[4:7], s94 offen lds
    buffer_load_dwordx4 v217, s[4:7], s94 offen offset:1024 lds
    s_add_u32 m0, s62, 81920
    s_mul_i32 s59, s93, 112
    buffer_load_dwordx4 v207, s[28:31], s59 offen lds
    buffer_load_dwordx4 v208, s[28:31], s59 offen offset:1024 lds
    buffer_load_dwordx4 v209, s[28:31], s59 offen offset:2048 lds
    buffer_load_dwordx4 v210, s[28:31], s59 offen offset:3072 lds
    s_add_u32 s93, s93, 6144
    s_and_b32 s93, s93, 65535
    s_barrier
    s_add_u32 m0, s62, 98304
    s_nop 0
    buffer_load_dwordx4 v217, s[4:7], s94 offen offset:2048 lds
    s_lshl_b32 s55, s43, 13
    s_add_u32 s55, s55, 98304
    v_add_u32 v176, s55, v254
    v_lshrrev_b32 v224, 6, v254
    v_lshrrev_b32 v225, 1, v224
    buffer_load_dwordx4 v217, s[4:7], s94 offen offset:3072 lds
    s_add_u32 s94, s94, 32768
    s_and_b32 s94, s94, 262143
    v_and_b32 v225, 3, v225
    s_lshl_b32 s55, s44, 1
    v_xor_b32 v225, s55, v225
    v_lshlrev_b32 v225, 5, v225
    v_lshl_add_u32 v225, v224, 7, v225
    s_add_u32 m0, s62, 0
    s_mul_i32 s59, s93, 112
    buffer_load_dwordx4 v207, s[28:31], s59 offen lds
    v_and_b32 v180, 0x30, v254
    v_lshrrev_b32 v180, 1, v180
    v_add_u32 v177, v225, v180
    buffer_load_dwordx4 v208, s[28:31], s59 offen offset:1024 lds
    v_xor_b32 v178, 32, v177
    v_lshrrev_b32 v225, 2, v224
    v_and_b32 v225, 1, v225
    v_xor_b32 v225, s44, v225
    buffer_load_dwordx4 v209, s[28:31], s59 offen offset:2048 lds
    v_lshlrev_b32 v225, 5, v225
    v_lshl_add_u32 v225, v224, 6, v225
    v_add_u32 v225, v225, v180
    buffer_load_dwordx4 v210, s[28:31], s59 offen offset:3072 lds
    s_add_u32 s93, s93, 2048
    s_and_b32 s93, s93, 65535
    v_add_u32 v179, 2048, v225
    v_add_u32 v180, 49152, v177
    v_add_u32 v181, 49152, v178
    v_add_u32 v182, 49152, v179
    s_waitcnt vmcnt(16)
    s_barrier
    s_cmp_lg_u32 s46, 0
    s_cbranch_scc1 cp_83
    s_lshl_b32 s55, s2, 2
    s_add_u32 s55, s55, s42
    s_lshl_b32 s55, s55, 13
    v_and_b32 v252, 0x300, v254
    v_and_b32 v250, 0xf0, v254
    v_lshl_add_u32 v249, v252, 3, v250
    buffer_load_dwordx4 v[240:243], v249, s[20:23], s55 offen offset:256
    buffer_load_dwordx4 v[244:247], v249, s[20:23], s55 offen offset:1280
cp_83:
    s_add_u32 m0, s62, 114688
    s_nop 0
    buffer_load_dwordx4 v217, s[4:7], s94 offen lds
    buffer_load_dwordx4 v217, s[4:7], s94 offen offset:1024 lds
    s_add_u32 m0, s62, 16384
    s_mul_i32 s59, s93, 112
    buffer_load_dwordx4 v207, s[28:31], s59 offen lds
    buffer_load_dwordx4 v208, s[28:31], s59 offen offset:1024 lds
    buffer_load_dwordx4 v209, s[28:31], s59 offen offset:2048 lds
    buffer_load_dwordx4 v210, s[28:31], s59 offen offset:3072 lds
    s_add_u32 s93, s93, 6144
    s_and_b32 s93, s93, 65535
    s_waitcnt lgkmcnt(0)
    s_barrier
    s_add_u32 m0, s62, 114688
    s_nop 0
    buffer_load_dwordx4 v217, s[4:7], s94 offen offset:2048 lds
    s_lshl_b32 s55, s43, 9
    s_add_u32 s55, s55, 159744
    v_and_b32 v224, 0xf0, v254
    v_lshrrev_b32 v224, 1, v224
    v_add_u32 v224, s55, v224
    ds_read_b64 v[96:97], v224 offset:0
    ds_read_b64 v[98:99], v224 offset:128
    buffer_load_dwordx4 v217, s[4:7], s94 offen offset:3072 lds
    s_add_u32 s94, s94, 32768
    s_and_b32 s94, s94, 262143
    ds_read_b64 v[100:101], v224 offset:256
    ds_read_b64 v[102:103], v224 offset:384
    s_waitcnt lgkmcnt(0)
    s_add_u32 m0, s62, 32768
    s_mul_i32 s59, s93, 112
    buffer_load_dwordx4 v207, s[28:31], s59 offen lds
    v_sub_f32 v196, 0, v96
    v_mul_f32 v184, 0xbfb8aa3b, v97
    v_mul_f32 v188, v97, v97
    v_sub_f32 v197, 0, v98
    buffer_load_dwordx4 v208, s[28:31], s59 offen offset:1024 lds
    v_mul_f32 v185, 0xbfb8aa3b, v99
    v_mul_f32 v189, v99, v99
    v_sub_f32 v198, 0, v100
    buffer_load_dwordx4 v209, s[28:31], s59 offen offset:2048 lds
    v_mul_f32 v186, 0xbfb8aa3b, v101
    v_mul_f32 v190, v101, v101
    v_sub_f32 v199, 0, v102
    buffer_load_dwordx4 v210, s[28:31], s59 offen offset:3072 lds
    s_add_u32 s93, s93, 2048
    s_and_b32 s93, s93, 65535
    v_mul_f32 v187, 0xbfb8aa3b, v103
    v_mul_f32 v191, v103, v103
    v_rcp_f32 v188, v188
    v_rcp_f32 v189, v189
    s_waitcnt vmcnt(16)
    s_barrier
    s_add_u32 m0, s62, 131072
    s_nop 0
    buffer_load_dwordx4 v217, s[4:7], s94 offen lds
    v_rcp_f32 v190, v190
    v_rcp_f32 v191, v191
    s_nop 0
    buffer_load_dwordx4 v217, s[4:7], s94 offen offset:1024 lds
    v_lshrrev_b32 v224, 8, v254
    v_lshlrev_b32 v224, 4, v224
    v_add_u32 v224, 162688, v224
    s_and_b32 s56, s41, 1
    s_add_u32 s55, s56, s44
    s_lshl_b32 s55, s55, 7
    v_add_u32 v225, s55, v224
    s_xor_b32 s56, s56, 1
    s_lshl_b32 s56, s56, 2
    s_add_u32 s56, s56, s44
    s_lshl_b32 s56, s56, 6
    v_add_u32 v224, s56, v224
    s_add_u32 m0, s62, 49152
    s_mul_i32 s59, s93, 112
    buffer_load_dwordx4 v207, s[28:31], s59 offen lds
    ds_read_b128 v[96:99], v225 offset:0
    ds_read_b128 v[100:103], v225 offset:64
    ds_read_b128 v[104:107], v224 offset:0
    buffer_load_dwordx4 v208, s[28:31], s59 offen offset:1024 lds
    ds_read_b128 v[108:111], v225 offset:512
    ds_read_b128 v[112:115], v225 offset:576
    ds_read_b128 v[116:119], v224 offset:512
    s_waitcnt lgkmcnt(0)
    buffer_load_dwordx4 v209, s[28:31], s59 offen offset:2048 lds
    v_mul_f32 v0, v196, v96
    v_mul_f32 v1, v196, v97
    v_mul_f32 v2, v196, v98
    buffer_load_dwordx4 v210, s[28:31], s59 offen offset:3072 lds
    s_add_u32 s93, s93, 6144
    s_and_b32 s93, s93, 65535
    v_mul_f32 v3, v196, v99
    v_mul_f32 v4, v197, v96
    v_mul_f32 v5, v197, v97
    v_mul_f32 v6, v197, v98
    s_barrier
    s_add_u32 m0, s62, 131072
    s_nop 0
    buffer_load_dwordx4 v217, s[4:7], s94 offen offset:2048 lds
    v_mul_f32 v7, v197, v99
    v_mul_f32 v8, v198, v96
    v_mul_f32 v9, v198, v97
    v_mul_f32 v10, v198, v98
    buffer_load_dwordx4 v217, s[4:7], s94 offen offset:3072 lds
    s_add_u32 s94, s94, 32768
    s_and_b32 s94, s94, 262143
    v_mul_f32 v11, v198, v99
    v_mul_f32 v12, v199, v96
    v_mul_f32 v13, v199, v97
    v_mul_f32 v14, v199, v98
    s_add_u32 m0, s62, 65536
    s_mul_i32 s59, s93, 112
    buffer_load_dwordx4 v207, s[28:31], s59 offen lds
    v_mul_f32 v15, v199, v99
    v_mul_f32 v16, v196, v100
    v_mul_f32 v17, v196, v101
    v_mul_f32 v18, v196, v102
    buffer_load_dwordx4 v208, s[28:31], s59 offen offset:1024 lds
    v_mul_f32 v19, v196, v103
    v_mul_f32 v20, v197, v100
    v_mul_f32 v21, v197, v101
    v_mul_f32 v22, v197, v102
    buffer_load_dwordx4 v209, s[28:31], s59 offen offset:2048 lds
    v_mul_f32 v23, v197, v103
    v_mul_f32 v24, v198, v100
    v_mul_f32 v25, v198, v101
    v_mul_f32 v26, v198, v102
    buffer_load_dwordx4 v210, s[28:31], s59 offen offset:3072 lds
    s_add_u32 s93, s93, 2048
    s_and_b32 s93, s93, 65535
    v_mul_f32 v27, v198, v103
    v_mul_f32 v28, v199, v100
    v_mul_f32 v29, v199, v101
    v_mul_f32 v30, v199, v102
    s_waitcnt vmcnt(16)
    s_barrier
    s_add_u32 m0, s62, 98304
    s_nop 0
    buffer_load_dwordx4 v217, s[4:7], s94 offen lds
    v_mul_f32 v31, v199, v103
    v_mul_f32 v32, v196, v104
    v_mul_f32 v33, v196, v105
    v_mul_f32 v34, v196, v106
    buffer_load_dwordx4 v217, s[4:7], s94 offen offset:1024 lds
    v_mul_f32 v35, v196, v107
    v_mul_f32 v36, v197, v104
    v_mul_f32 v37, v197, v105
    v_mul_f32 v38, v197, v106
    s_add_u32 m0, s62, 81920
    s_mul_i32 s59, s93, 112
    buffer_load_dwordx4 v207, s[28:31], s59 offen lds
    v_mul_f32 v39, v197, v107
    v_mul_f32 v40, v198, v104
    v_mul_f32 v41, v198, v105
    v_mul_f32 v42, v198, v106
    buffer_load_dwordx4 v208, s[28:31], s59 offen offset:1024 lds
    v_mul_f32 v43, v198, v107
    v_mul_f32 v44, v199, v104
    v_mul_f32 v45, v199, v105
    v_mul_f32 v46, v199, v106
    buffer_load_dwordx4 v209, s[28:31], s59 offen offset:2048 lds
    v_mul_f32 v47, v199, v107
    v_mul_f32 v48, v196, v108
    v_mul_f32 v49, v196, v109
    v_mul_f32 v50, v196, v110
    buffer_load_dwordx4 v210, s[28:31], s59 offen offset:3072 lds
    v_mul_f32 v51, v196, v111
    v_mul_f32 v52, v197, v108
    v_mul_f32 v53, v197, v109
    v_mul_f32 v54, v197, v110
    s_barrier
    s_add_u32 m0, s62, 98304
    s_nop 0
    buffer_load_dwordx4 v217, s[4:7], s94 offen offset:2048 lds
    v_mul_f32 v55, v197, v111
    v_mul_f32 v56, v198, v108
    v_mul_f32 v57, v198, v109
    v_mul_f32 v58, v198, v110
    buffer_load_dwordx4 v217, s[4:7], s94 offen offset:3072 lds
    v_mul_f32 v59, v198, v111
    v_mul_f32 v60, v199, v108
    v_mul_f32 v61, v199, v109
    v_mul_f32 v62, v199, v110
    v_mul_f32 v63, v199, v111
    s_add_u32 s93, s51, 11
    s_and_b32 s93, s93, 15
    s_lshl_b32 s93, s93, 12
    s_add_u32 m0, s61, 0
    s_mul_i32 s59, s93, 112
    buffer_load_dwordx4 v211, s[24:27], s59 offen lds
    v_mul_f32 v64, v196, v112
    v_mul_f32 v65, v196, v113
    v_mul_f32 v66, v196, v114
    v_mul_f32 v67, v196, v115
    v_mul_f32 v68, v197, v112
    buffer_load_dwordx4 v212, s[24:27], s59 offen offset:1024 lds
    v_mul_f32 v69, v197, v113
    v_mul_f32 v70, v197, v114
    v_mul_f32 v71, v197, v115
    v_mul_f32 v72, v198, v112
    v_mul_f32 v73, v198, v113
    buffer_load_dwordx4 v222, s[4:7], s93 offen offset:2048 lds
    s_add_u32 s93, s93, 2048
    s_and_b32 s93, s93, 65535
    v_mul_f32 v74, v198, v114
    v_mul_f32 v75, v198, v115
    v_mul_f32 v76, v199, v112
    v_mul_f32 v77, v199, v113
    v_mul_f32 v78, v199, v114
    s_cmp_lg_u32 s46, 0
    s_cbranch_scc1 cp_84
    s_lshl_b32 s55, s2, 2
    s_add_u32 s55, s55, s42
    s_lshl_b32 s55, s55, 13
    s_add_u32 s55, s55, 100663552
    s_cmp_lt_u32 s2, 224
    s_cselect_b32 s55, s55, 2130706432
    buffer_store_dwordx4 v[240:243], v249, s[4:7], s55 offen offset:256 sc0 sc1
    buffer_store_dwordx4 v[244:247], v249, s[4:7], s55 offen offset:1280 sc0 sc1
    s_add_u32 s55, s4, 100663552
    s_addc_u32 s56, s5, 0
    s_lshr_b32 s57, 3084, s51
    s_and_b32 s57, s57, 1
    s_cselect_b32 s20, s55, s20
    s_cselect_b32 s21, s56, s21
cp_84:
    s_waitcnt vmcnt(15)
    s_barrier
    s_add_u32 m0, s61, 16384
    s_mul_i32 s59, s93, 112
    buffer_load_dwordx4 v211, s[24:27], s59 offen lds
    v_mul_f32 v79, v199, v115
    v_mul_f32 v80, v196, v116
    v_mul_f32 v81, v196, v117
    v_mul_f32 v82, v196, v118
    v_mul_f32 v83, v196, v119
    buffer_load_dwordx4 v212, s[24:27], s59 offen offset:1024 lds
    v_mul_f32 v84, v197, v116
    v_mul_f32 v85, v197, v117
    v_mul_f32 v86, v197, v118
    v_mul_f32 v87, v197, v119
    v_mul_f32 v88, v198, v116
    v_mul_f32 v89, v198, v117
    buffer_load_dwordx4 v222, s[4:7], s93 offen offset:2048 lds
    s_add_u32 s93, s93, 6144
    s_and_b32 s93, s93, 65535
    v_mul_f32 v90, v198, v118
    v_mul_f32 v91, v198, v119
    v_mul_f32 v92, v199, v116
    v_mul_f32 v93, v199, v117
    v_mul_f32 v94, v199, v118
    v_mul_f32 v95, v199, v119
    s_barrier
    s_add_u32 m0, s61, 32768
    s_mul_i32 s59, s93, 112
    buffer_load_dwordx4 v211, s[24:27], s59 offen lds
    buffer_load_dwordx4 v212, s[24:27], s59 offen offset:1024 lds
    buffer_load_dwordx4 v222, s[4:7], s93 offen offset:2048 lds
    s_add_u32 s93, s93, 2048
    s_and_b32 s93, s93, 65535
    s_waitcnt vmcnt(9)
    s_barrier
    s_add_u32 m0, s61, 49152
    s_mul_i32 s59, s93, 112
    buffer_load_dwordx4 v211, s[24:27], s59 offen lds
    buffer_load_dwordx4 v212, s[24:27], s59 offen offset:1024 lds
    buffer_load_dwordx4 v222, s[4:7], s93 offen offset:2048 lds
    s_add_u32 s93, s93, 6144
    s_and_b32 s93, s93, 65535
    s_barrier
    s_add_u32 m0, s61, 65536
    s_mul_i32 s59, s93, 112
    buffer_load_dwordx4 v211, s[24:27], s59 offen lds
    buffer_load_dwordx4 v212, s[24:27], s59 offen offset:1024 lds
    buffer_load_dwordx4 v222, s[4:7], s93 offen offset:2048 lds
    s_add_u32 s93, s93, 2048
    s_and_b32 s93, s93, 65535
    s_waitcnt vmcnt(12)
    s_barrier
    s_add_u32 m0, s61, 81920
    s_mul_i32 s59, s93, 112
    buffer_load_dwordx4 v211, s[24:27], s59 offen lds
    buffer_load_dwordx4 v212, s[24:27], s59 offen offset:1024 lds
    buffer_load_dwordx4 v222, s[4:7], s93 offen offset:2048 lds
    s_add_u32 s93, s93, 2048
    s_and_b32 s93, s93, 65535
    s_setprio 0
    ds_read_b64_tr_b16 v[128:129], v177 offset:0
    ds_read_b64_tr_b16 v[130:131], v177 offset:3072
    ds_read_b128 v[96:99], v176 offset:16384
    ds_read_b128 v[100:103], v176 offset:18432
    ds_read_b128 v[104:107], v176 offset:20480
    ds_read_b128 v[108:111], v176 offset:22528
    ds_read_b64_tr_b16 v[140:141], v177 offset:6144
    ds_read_b64_tr_b16 v[142:143], v177 offset:9216
    ds_read_b64_tr_b16 v[132:133], v178 offset:0
    ds_read_b64_tr_b16 v[134:135], v178 offset:3072
    ds_read_b64_tr_b16 v[144:145], v178 offset:6144
    ds_read_b64_tr_b16 v[146:147], v178 offset:9216
    ds_read_b64_tr_b16 v[136:137], v179 offset:0
    ds_read_b64_tr_b16 v[138:139], v179 offset:3072
    ds_read_b64_tr_b16 v[148:149], v179 offset:6144
    ds_read_b64_tr_b16 v[150:151], v179 offset:9216
    s_add_u32 s88, s95, s62
    v_add_u32 v217, s88, v254
    s_mov_b32 s58, 5
    s_waitcnt vmcnt(12) lgkmcnt(0)
    s_barrier
    .p2align 3
    v_mfma_f32_16x16x32_bf16 v[0:3], v[128:131], v[96:99], v[0:3]
    ds_read_b64_tr_b16 v[152:153], v177 offset:16384
    v_mfma_f32_16x16x32_bf16 v[4:7], v[128:131], v[100:103], v[4:7]
    ds_read_b64_tr_b16 v[154:155], v177 offset:19456
    v_mfma_f32_16x16x32_bf16 v[8:11], v[128:131], v[104:107], v[8:11]
    ds_read_b128 v[112:115], v176 offset:17408
    v_mfma_f32_16x16x32_bf16 v[12:15], v[128:131], v[108:111], v[12:15]
    ds_read_b128 v[116:119], v176 offset:19456
    v_mfma_f32_16x16x32_bf16 v[60:63], v[140:143], v[108:111], v[60:63]
    ds_read_b128 v[120:123], v176 offset:21504
    v_mfma_f32_16x16x32_bf16 v[56:59], v[140:143], v[104:107], v[56:59]
    ds_read_b128 v[124:127], v176 offset:23552
    v_mfma_f32_16x16x32_bf16 v[52:55], v[140:143], v[100:103], v[52:55]
    ds_read_b64_tr_b16 v[164:165], v177 offset:22528
    v_mfma_f32_16x16x32_bf16 v[48:51], v[140:143], v[96:99], v[48:51]
    ds_read_b64_tr_b16 v[166:167], v177 offset:25600
    v_mfma_f32_16x16x32_bf16 v[16:19], v[132:135], v[96:99], v[16:19]
    v_mfma_f32_16x16x32_bf16 v[20:23], v[132:135], v[100:103], v[20:23]
    ds_read_b64_tr_b16 v[156:157], v178 offset:16384
    v_mfma_f32_16x16x32_bf16 v[24:27], v[132:135], v[104:107], v[24:27]
    ds_read_b64_tr_b16 v[158:159], v178 offset:19456
    v_mfma_f32_16x16x32_bf16 v[28:31], v[132:135], v[108:111], v[28:31]
    ds_read_b64_tr_b16 v[168:169], v178 offset:22528
    v_mfma_f32_16x16x32_bf16 v[76:79], v[144:147], v[108:111], v[76:79]
    ds_read_b64_tr_b16 v[170:171], v178 offset:25600
    v_mfma_f32_16x16x32_bf16 v[72:75], v[144:147], v[104:107], v[72:75]
    ds_read_b64_tr_b16 v[160:161], v179 offset:16384
    v_mfma_f32_16x16x32_bf16 v[68:71], v[144:147], v[100:103], v[68:71]
    ds_read_b64_tr_b16 v[162:163], v179 offset:19456
    v_mfma_f32_16x16x32_bf16 v[64:67], v[144:147], v[96:99], v[64:67]
    ds_read_b64_tr_b16 v[172:173], v179 offset:22528
    v_mfma_f32_16x16x32_bf16 v[32:35], v[136:139], v[96:99], v[32:35]
    ds_read_b64_tr_b16 v[174:175], v179 offset:25600
    v_mfma_f32_16x16x32_bf16 v[36:39], v[136:139], v[100:103], v[36:39]
    v_mfma_f32_16x16x32_bf16 v[40:43], v[136:139], v[104:107], v[40:43]
    v_mfma_f32_16x16x32_bf16 v[44:47], v[136:139], v[108:111], v[44:47]
    v_mfma_f32_16x16x32_bf16 v[92:95], v[148:151], v[108:111], v[92:95]
    v_mfma_f32_16x16x32_bf16 v[88:91], v[148:151], v[104:107], v[88:91]
    v_mfma_f32_16x16x32_bf16 v[84:87], v[148:151], v[100:103], v[84:87]
    v_mfma_f32_16x16x32_bf16 v[80:83], v[148:151], v[96:99], v[80:83]
    .p2align 3
loop_85:
    s_waitcnt vmcnt(9) lgkmcnt(0)
    s_barrier
    .p2align 3
    v_mfma_f32_16x16x32_bf16 v[0:3], v[152:155], v[112:115], v[0:3]
    ds_read_b64_tr_b16 v[128:129], v177 offset:32768
    v_mfma_f32_16x16x32_bf16 v[4:7], v[152:155], v[116:119], v[4:7]
    ds_read_b64_tr_b16 v[130:131], v177 offset:35840
    v_mfma_f32_16x16x32_bf16 v[8:11], v[152:155], v[120:123], v[8:11]
    ds_read_b128 v[96:99], v176 offset:32768
    v_mfma_f32_16x16x32_bf16 v[12:15], v[152:155], v[124:127], v[12:15]
    ds_read_b128 v[100:103], v176 offset:34816
    v_mfma_f32_16x16x32_bf16 v[60:63], v[164:167], v[124:127], v[60:63]
    ds_read_b128 v[104:107], v176 offset:36864
    v_mfma_f32_16x16x32_bf16 v[56:59], v[164:167], v[120:123], v[56:59]
    ds_read_b128 v[108:111], v176 offset:38912
    v_mfma_f32_16x16x32_bf16 v[52:55], v[164:167], v[116:119], v[52:55]
    ds_read_b64_tr_b16 v[140:141], v177 offset:38912
    v_mfma_f32_16x16x32_bf16 v[48:51], v[164:167], v[112:115], v[48:51]
    ds_read_b64_tr_b16 v[142:143], v177 offset:41984
    v_mfma_f32_16x16x32_bf16 v[16:19], v[156:159], v[112:115], v[16:19]
    v_mfma_f32_16x16x32_bf16 v[20:23], v[156:159], v[116:119], v[20:23]
    ds_read_b64_tr_b16 v[132:133], v178 offset:32768
    v_mfma_f32_16x16x32_bf16 v[24:27], v[156:159], v[120:123], v[24:27]
    ds_read_b64_tr_b16 v[134:135], v178 offset:35840
    v_mfma_f32_16x16x32_bf16 v[28:31], v[156:159], v[124:127], v[28:31]
    ds_read_b64_tr_b16 v[144:145], v178 offset:38912
    v_mfma_f32_16x16x32_bf16 v[76:79], v[168:171], v[124:127], v[76:79]
    ds_read_b64_tr_b16 v[146:147], v178 offset:41984
    v_mfma_f32_16x16x32_bf16 v[72:75], v[168:171], v[120:123], v[72:75]
    ds_read_b64_tr_b16 v[136:137], v179 offset:32768
    v_mfma_f32_16x16x32_bf16 v[68:71], v[168:171], v[116:119], v[68:71]
    ds_read_b64_tr_b16 v[138:139], v179 offset:35840
    v_mfma_f32_16x16x32_bf16 v[64:67], v[168:171], v[112:115], v[64:67]
    ds_read_b64_tr_b16 v[148:149], v179 offset:38912
    v_mfma_f32_16x16x32_bf16 v[32:35], v[160:163], v[112:115], v[32:35]
    ds_read_b64_tr_b16 v[150:151], v179 offset:41984
    v_mfma_f32_16x16x32_bf16 v[36:39], v[160:163], v[116:119], v[36:39]
    v_mfma_f32_16x16x32_bf16 v[40:43], v[160:163], v[120:123], v[40:43]
    v_mfma_f32_16x16x32_bf16 v[44:47], v[160:163], v[124:127], v[44:47]
    v_mfma_f32_16x16x32_bf16 v[92:95], v[172:175], v[124:127], v[92:95]
    v_mfma_f32_16x16x32_bf16 v[88:91], v[172:175], v[120:123], v[88:91]
    v_mfma_f32_16x16x32_bf16 v[84:87], v[172:175], v[116:119], v[84:87]
    v_mfma_f32_16x16x32_bf16 v[80:83], v[172:175], v[112:115], v[80:83]
    s_waitcnt vmcnt(6) lgkmcnt(0)
    s_barrier
    .p2align 3
    v_mfma_f32_16x16x32_bf16 v[0:3], v[128:131], v[96:99], v[0:3]
    ds_read_b64_tr_b16 v[152:153], v180 offset:0
    v_mfma_f32_16x16x32_bf16 v[4:7], v[128:131], v[100:103], v[4:7]
    ds_read_b64_tr_b16 v[154:155], v180 offset:3072
    v_mfma_f32_16x16x32_bf16 v[8:11], v[128:131], v[104:107], v[8:11]
    ds_read_b128 v[112:115], v176 offset:33792
    v_mfma_f32_16x16x32_bf16 v[12:15], v[128:131], v[108:111], v[12:15]
    ds_read_b128 v[116:119], v176 offset:35840
    v_mfma_f32_16x16x32_bf16 v[60:63], v[140:143], v[108:111], v[60:63]
    ds_read_b128 v[120:123], v176 offset:37888
    v_mfma_f32_16x16x32_bf16 v[56:59], v[140:143], v[104:107], v[56:59]
    ds_read_b128 v[124:127], v176 offset:39936
    v_mfma_f32_16x16x32_bf16 v[52:55], v[140:143], v[100:103], v[52:55]
    ds_read_b64_tr_b16 v[164:165], v180 offset:6144
    v_mfma_f32_16x16x32_bf16 v[48:51], v[140:143], v[96:99], v[48:51]
    ds_read_b64_tr_b16 v[166:167], v180 offset:9216
    v_mfma_f32_16x16x32_bf16 v[16:19], v[132:135], v[96:99], v[16:19]
    v_mfma_f32_16x16x32_bf16 v[20:23], v[132:135], v[100:103], v[20:23]
    ds_read_b64_tr_b16 v[156:157], v181 offset:0
    v_mfma_f32_16x16x32_bf16 v[24:27], v[132:135], v[104:107], v[24:27]
    ds_read_b64_tr_b16 v[158:159], v181 offset:3072
    v_mfma_f32_16x16x32_bf16 v[28:31], v[132:135], v[108:111], v[28:31]
    ds_read_b64_tr_b16 v[168:169], v181 offset:6144
    v_mfma_f32_16x16x32_bf16 v[76:79], v[144:147], v[108:111], v[76:79]
    ds_read_b64_tr_b16 v[170:171], v181 offset:9216
    v_mfma_f32_16x16x32_bf16 v[72:75], v[144:147], v[104:107], v[72:75]
    ds_read_b64_tr_b16 v[160:161], v182 offset:0
    v_mfma_f32_16x16x32_bf16 v[68:71], v[144:147], v[100:103], v[68:71]
    ds_read_b64_tr_b16 v[162:163], v182 offset:3072
    v_mfma_f32_16x16x32_bf16 v[64:67], v[144:147], v[96:99], v[64:67]
    ds_read_b64_tr_b16 v[172:173], v182 offset:6144
    v_mfma_f32_16x16x32_bf16 v[32:35], v[136:139], v[96:99], v[32:35]
    ds_read_b64_tr_b16 v[174:175], v182 offset:9216
    v_mfma_f32_16x16x32_bf16 v[36:39], v[136:139], v[100:103], v[36:39]
    v_mfma_f32_16x16x32_bf16 v[40:43], v[136:139], v[104:107], v[40:43]
    v_mfma_f32_16x16x32_bf16 v[44:47], v[136:139], v[108:111], v[44:47]
    v_mfma_f32_16x16x32_bf16 v[92:95], v[148:151], v[108:111], v[92:95]
    v_mfma_f32_16x16x32_bf16 v[88:91], v[148:151], v[104:107], v[88:91]
    v_mfma_f32_16x16x32_bf16 v[84:87], v[148:151], v[100:103], v[84:87]
    v_mfma_f32_16x16x32_bf16 v[80:83], v[148:151], v[96:99], v[80:83]
    s_waitcnt vmcnt(3) lgkmcnt(0)
    s_barrier
    .p2align 3
    v_mfma_f32_16x16x32_bf16 v[0:3], v[152:155], v[112:115], v[0:3]
    ds_read_b64_tr_b16 v[128:129], v180 offset:16384
    v_mfma_f32_16x16x32_bf16 v[4:7], v[152:155], v[116:119], v[4:7]
    ds_read_b64_tr_b16 v[130:131], v180 offset:19456
    v_mfma_f32_16x16x32_bf16 v[8:11], v[152:155], v[120:123], v[8:11]
    ds_read_b128 v[96:99], v176 offset:0
    v_mfma_f32_16x16x32_bf16 v[12:15], v[152:155], v[124:127], v[12:15]
    ds_read_b128 v[100:103], v176 offset:2048
    v_mfma_f32_16x16x32_bf16 v[60:63], v[164:167], v[124:127], v[60:63]
    ds_read_b128 v[104:107], v176 offset:4096
    v_mfma_f32_16x16x32_bf16 v[56:59], v[164:167], v[120:123], v[56:59]
    ds_read_b128 v[108:111], v176 offset:6144
    v_mfma_f32_16x16x32_bf16 v[52:55], v[164:167], v[116:119], v[52:55]
    ds_read_b64_tr_b16 v[140:141], v180 offset:22528
    v_mfma_f32_16x16x32_bf16 v[48:51], v[164:167], v[112:115], v[48:51]
    ds_read_b64_tr_b16 v[142:143], v180 offset:25600
    v_mfma_f32_16x16x32_bf16 v[16:19], v[156:159], v[112:115], v[16:19]
    v_mfma_f32_16x16x32_bf16 v[20:23], v[156:159], v[116:119], v[20:23]
    ds_read_b64_tr_b16 v[132:133], v181 offset:16384
    v_mfma_f32_16x16x32_bf16 v[24:27], v[156:159], v[120:123], v[24:27]
    ds_read_b64_tr_b16 v[134:135], v181 offset:19456
    v_mfma_f32_16x16x32_bf16 v[28:31], v[156:159], v[124:127], v[28:31]
    ds_read_b64_tr_b16 v[144:145], v181 offset:22528
    v_mfma_f32_16x16x32_bf16 v[76:79], v[168:171], v[124:127], v[76:79]
    ds_read_b64_tr_b16 v[146:147], v181 offset:25600
    v_mfma_f32_16x16x32_bf16 v[72:75], v[168:171], v[120:123], v[72:75]
    ds_read_b64_tr_b16 v[136:137], v182 offset:16384
    v_mfma_f32_16x16x32_bf16 v[68:71], v[168:171], v[116:119], v[68:71]
    ds_read_b64_tr_b16 v[138:139], v182 offset:19456
    v_mfma_f32_16x16x32_bf16 v[64:67], v[168:171], v[112:115], v[64:67]
    ds_read_b64_tr_b16 v[148:149], v182 offset:22528
    v_mfma_f32_16x16x32_bf16 v[32:35], v[160:163], v[112:115], v[32:35]
    ds_read_b64_tr_b16 v[150:151], v182 offset:25600
    v_mfma_f32_16x16x32_bf16 v[36:39], v[160:163], v[116:119], v[36:39]
    v_mfma_f32_16x16x32_bf16 v[40:43], v[160:163], v[120:123], v[40:43]
    v_mfma_f32_16x16x32_bf16 v[44:47], v[160:163], v[124:127], v[44:47]
    v_mfma_f32_16x16x32_bf16 v[92:95], v[172:175], v[124:127], v[92:95]
    v_mfma_f32_16x16x32_bf16 v[88:91], v[172:175], v[120:123], v[88:91]
    v_mfma_f32_16x16x32_bf16 v[84:87], v[172:175], v[116:119], v[84:87]
    v_mfma_f32_16x16x32_bf16 v[80:83], v[172:175], v[112:115], v[80:83]
    s_waitcnt vmcnt(0) lgkmcnt(0)
    s_barrier
    .p2align 3
    v_mfma_f32_16x16x32_bf16 v[0:3], v[128:131], v[96:99], v[0:3]
    ds_read_b64_tr_b16 v[152:153], v180 offset:32768
    v_mfma_f32_16x16x32_bf16 v[4:7], v[128:131], v[100:103], v[4:7]
    ds_read_b64_tr_b16 v[154:155], v180 offset:35840
    v_mfma_f32_16x16x32_bf16 v[8:11], v[128:131], v[104:107], v[8:11]
    ds_read_b128 v[112:115], v176 offset:1024
    v_mfma_f32_16x16x32_bf16 v[12:15], v[128:131], v[108:111], v[12:15]
    ds_read_b128 v[116:119], v176 offset:3072
    v_mfma_f32_16x16x32_bf16 v[60:63], v[140:143], v[108:111], v[60:63]
    ds_read_b128 v[120:123], v176 offset:5120
    v_mfma_f32_16x16x32_bf16 v[56:59], v[140:143], v[104:107], v[56:59]
    ds_read_b128 v[124:127], v176 offset:7168
    v_mfma_f32_16x16x32_bf16 v[52:55], v[140:143], v[100:103], v[52:55]
    ds_read_b64_tr_b16 v[164:165], v180 offset:38912
    v_mfma_f32_16x16x32_bf16 v[48:51], v[140:143], v[96:99], v[48:51]
    ds_read_b64_tr_b16 v[166:167], v180 offset:41984
    v_mfma_f32_16x16x32_bf16 v[16:19], v[132:135], v[96:99], v[16:19]
    v_mfma_f32_16x16x32_bf16 v[20:23], v[132:135], v[100:103], v[20:23]
    ds_read_b64_tr_b16 v[156:157], v181 offset:32768
    v_mfma_f32_16x16x32_bf16 v[24:27], v[132:135], v[104:107], v[24:27]
    ds_read_b64_tr_b16 v[158:159], v181 offset:35840
    v_mfma_f32_16x16x32_bf16 v[28:31], v[132:135], v[108:111], v[28:31]
    ds_read_b64_tr_b16 v[168:169], v181 offset:38912
    v_mfma_f32_16x16x32_bf16 v[76:79], v[144:147], v[108:111], v[76:79]
    ds_read_b64_tr_b16 v[170:171], v181 offset:41984
    v_mfma_f32_16x16x32_bf16 v[72:75], v[144:147], v[104:107], v[72:75]
    ds_read_b64_tr_b16 v[160:161], v182 offset:32768
    v_mfma_f32_16x16x32_bf16 v[68:71], v[144:147], v[100:103], v[68:71]
    ds_read_b64_tr_b16 v[162:163], v182 offset:35840
    v_mfma_f32_16x16x32_bf16 v[64:67], v[144:147], v[96:99], v[64:67]
    ds_read_b64_tr_b16 v[172:173], v182 offset:38912
    v_mfma_f32_16x16x32_bf16 v[32:35], v[136:139], v[96:99], v[32:35]
    ds_read_b64_tr_b16 v[174:175], v182 offset:41984
    v_mfma_f32_16x16x32_bf16 v[36:39], v[136:139], v[100:103], v[36:39]
    v_mfma_f32_16x16x32_bf16 v[40:43], v[136:139], v[104:107], v[40:43]
    v_mfma_f32_16x16x32_bf16 v[44:47], v[136:139], v[108:111], v[44:47]
    v_mfma_f32_16x16x32_bf16 v[92:95], v[148:151], v[108:111], v[92:95]
    v_mfma_f32_16x16x32_bf16 v[88:91], v[148:151], v[104:107], v[88:91]
    v_mfma_f32_16x16x32_bf16 v[84:87], v[148:151], v[100:103], v[84:87]
    v_mfma_f32_16x16x32_bf16 v[80:83], v[148:151], v[96:99], v[80:83]
    s_waitcnt lgkmcnt(0)
    s_barrier
    .p2align 3
    v_mfma_f32_16x16x32_bf16 v[0:3], v[152:155], v[112:115], v[0:3]
    ds_read_b64_tr_b16 v[128:129], v177 offset:0
    v_mfma_f32_16x16x32_bf16 v[4:7], v[152:155], v[116:119], v[4:7]
    ds_read_b64_tr_b16 v[130:131], v177 offset:3072
    v_mfma_f32_16x16x32_bf16 v[8:11], v[152:155], v[120:123], v[8:11]
    ds_read_b128 v[96:99], v176 offset:16384
    v_mfma_f32_16x16x32_bf16 v[12:15], v[152:155], v[124:127], v[12:15]
    ds_read_b128 v[100:103], v176 offset:18432
    v_mfma_f32_16x16x32_bf16 v[60:63], v[164:167], v[124:127], v[60:63]
    ds_read_b128 v[104:107], v176 offset:20480
    v_mfma_f32_16x16x32_bf16 v[56:59], v[164:167], v[120:123], v[56:59]
    ds_read_b128 v[108:111], v176 offset:22528
    v_mfma_f32_16x16x32_bf16 v[52:55], v[164:167], v[116:119], v[52:55]
    ds_read_b64_tr_b16 v[140:141], v177 offset:6144
    v_mfma_f32_16x16x32_bf16 v[48:51], v[164:167], v[112:115], v[48:51]
    ds_read_b64_tr_b16 v[142:143], v177 offset:9216
    v_mfma_f32_16x16x32_bf16 v[16:19], v[156:159], v[112:115], v[16:19]
    v_mfma_f32_16x16x32_bf16 v[20:23], v[156:159], v[116:119], v[20:23]
    ds_read_b64_tr_b16 v[132:133], v178 offset:0
    v_mfma_f32_16x16x32_bf16 v[24:27], v[156:159], v[120:123], v[24:27]
    ds_read_b64_tr_b16 v[134:135], v178 offset:3072
    v_mfma_f32_16x16x32_bf16 v[28:31], v[156:159], v[124:127], v[28:31]
    ds_read_b64_tr_b16 v[144:145], v178 offset:6144
    v_mfma_f32_16x16x32_bf16 v[76:79], v[168:171], v[124:127], v[76:79]
    ds_read_b64_tr_b16 v[146:147], v178 offset:9216
    v_mfma_f32_16x16x32_bf16 v[72:75], v[168:171], v[120:123], v[72:75]
    ds_read_b64_tr_b16 v[136:137], v179 offset:0
    v_mfma_f32_16x16x32_bf16 v[68:71], v[168:171], v[116:119], v[68:71]
    ds_read_b64_tr_b16 v[138:139], v179 offset:3072
    v_mfma_f32_16x16x32_bf16 v[64:67], v[168:171], v[112:115], v[64:67]
    ds_read_b64_tr_b16 v[148:149], v179 offset:6144
    v_mfma_f32_16x16x32_bf16 v[32:35], v[160:163], v[112:115], v[32:35]
    ds_read_b64_tr_b16 v[150:151], v179 offset:9216
    v_mfma_f32_16x16x32_bf16 v[36:39], v[160:163], v[116:119], v[36:39]
    v_mfma_f32_16x16x32_bf16 v[40:43], v[160:163], v[120:123], v[40:43]
    v_mfma_f32_16x16x32_bf16 v[44:47], v[160:163], v[124:127], v[44:47]
    v_mfma_f32_16x16x32_bf16 v[92:95], v[172:175], v[124:127], v[92:95]
    v_mfma_f32_16x16x32_bf16 v[88:91], v[172:175], v[120:123], v[88:91]
    v_mfma_f32_16x16x32_bf16 v[84:87], v[172:175], v[116:119], v[84:87]
    v_mfma_f32_16x16x32_bf16 v[80:83], v[172:175], v[112:115], v[80:83]
    s_waitcnt lgkmcnt(0)
    s_barrier
    .p2align 3
    v_mfma_f32_16x16x32_bf16 v[0:3], v[128:131], v[96:99], v[0:3]
    ds_read_b64_tr_b16 v[152:153], v177 offset:16384
    v_mfma_f32_16x16x32_bf16 v[4:7], v[128:131], v[100:103], v[4:7]
    ds_read_b64_tr_b16 v[154:155], v177 offset:19456
    v_mfma_f32_16x16x32_bf16 v[8:11], v[128:131], v[104:107], v[8:11]
    ds_read_b128 v[112:115], v176 offset:17408
    v_mfma_f32_16x16x32_bf16 v[12:15], v[128:131], v[108:111], v[12:15]
    ds_read_b128 v[116:119], v176 offset:19456
    v_mfma_f32_16x16x32_bf16 v[60:63], v[140:143], v[108:111], v[60:63]
    ds_read_b128 v[120:123], v176 offset:21504
    v_mfma_f32_16x16x32_bf16 v[56:59], v[140:143], v[104:107], v[56:59]
    ds_read_b128 v[124:127], v176 offset:23552
    v_mfma_f32_16x16x32_bf16 v[52:55], v[140:143], v[100:103], v[52:55]
    ds_read_b64_tr_b16 v[164:165], v177 offset:22528
    v_mfma_f32_16x16x32_bf16 v[48:51], v[140:143], v[96:99], v[48:51]
    ds_read_b64_tr_b16 v[166:167], v177 offset:25600
    v_mfma_f32_16x16x32_bf16 v[16:19], v[132:135], v[96:99], v[16:19]
    v_mfma_f32_16x16x32_bf16 v[20:23], v[132:135], v[100:103], v[20:23]
    ds_read_b64_tr_b16 v[156:157], v178 offset:16384
    v_mfma_f32_16x16x32_bf16 v[24:27], v[132:135], v[104:107], v[24:27]
    ds_read_b64_tr_b16 v[158:159], v178 offset:19456
    v_mfma_f32_16x16x32_bf16 v[28:31], v[132:135], v[108:111], v[28:31]
    ds_read_b64_tr_b16 v[168:169], v178 offset:22528
    v_mfma_f32_16x16x32_bf16 v[76:79], v[144:147], v[108:111], v[76:79]
    ds_read_b64_tr_b16 v[170:171], v178 offset:25600
    v_mfma_f32_16x16x32_bf16 v[72:75], v[144:147], v[104:107], v[72:75]
    ds_read_b64_tr_b16 v[160:161], v179 offset:16384
    v_mfma_f32_16x16x32_bf16 v[68:71], v[144:147], v[100:103], v[68:71]
    ds_read_b64_tr_b16 v[162:163], v179 offset:19456
    v_mfma_f32_16x16x32_bf16 v[64:67], v[144:147], v[96:99], v[64:67]
    ds_read_b64_tr_b16 v[172:173], v179 offset:22528
    v_mfma_f32_16x16x32_bf16 v[32:35], v[136:139], v[96:99], v[32:35]
    ds_read_b64_tr_b16 v[174:175], v179 offset:25600
    v_mfma_f32_16x16x32_bf16 v[36:39], v[136:139], v[100:103], v[36:39]
    v_mfma_f32_16x16x32_bf16 v[40:43], v[136:139], v[104:107], v[40:43]
    v_mfma_f32_16x16x32_bf16 v[44:47], v[136:139], v[108:111], v[44:47]
    v_mfma_f32_16x16x32_bf16 v[92:95], v[148:151], v[108:111], v[92:95]
    s_sub_u32 s58, s58, 1
    s_cmp_lg_u32 s58, 0
    .p2align 3
    v_mfma_f32_16x16x32_bf16 v[88:91], v[148:151], v[104:107], v[88:91]
    v_mfma_f32_16x16x32_bf16 v[84:87], v[148:151], v[100:103], v[84:87]
    v_mfma_f32_16x16x32_bf16 v[80:83], v[148:151], v[96:99], v[80:83]
    s_cbranch_scc1 loop_85
    s_waitcnt lgkmcnt(0)
    s_barrier
    .p2align 3
    v_mfma_f32_16x16x32_bf16 v[0:3], v[152:155], v[112:115], v[0:3]
    v_mfma_f32_16x16x32_bf16 v[4:7], v[152:155], v[116:119], v[4:7]
    v_mfma_f32_16x16x32_bf16 v[8:11], v[152:155], v[120:123], v[8:11]
    v_mfma_f32_16x16x32_bf16 v[12:15], v[152:155], v[124:127], v[12:15]
    v_mfma_f32_16x16x32_bf16 v[60:63], v[164:167], v[124:127], v[60:63]
    v_mfma_f32_16x16x32_bf16 v[56:59], v[164:167], v[120:123], v[56:59]
    v_mfma_f32_16x16x32_bf16 v[52:55], v[164:167], v[116:119], v[52:55]
    v_mfma_f32_16x16x32_bf16 v[48:51], v[164:167], v[112:115], v[48:51]
    v_mfma_f32_16x16x32_bf16 v[16:19], v[156:159], v[112:115], v[16:19]
    v_mfma_f32_16x16x32_bf16 v[20:23], v[156:159], v[116:119], v[20:23]
    v_mfma_f32_16x16x32_bf16 v[24:27], v[156:159], v[120:123], v[24:27]
    v_mfma_f32_16x16x32_bf16 v[28:31], v[156:159], v[124:127], v[28:31]
    v_mfma_f32_16x16x32_bf16 v[76:79], v[168:171], v[124:127], v[76:79]
    v_mfma_f32_16x16x32_bf16 v[72:75], v[168:171], v[120:123], v[72:75]
    v_mfma_f32_16x16x32_bf16 v[68:71], v[168:171], v[116:119], v[68:71]
    v_mfma_f32_16x16x32_bf16 v[64:67], v[168:171], v[112:115], v[64:67]
    v_mfma_f32_16x16x32_bf16 v[32:35], v[160:163], v[112:115], v[32:35]
    v_mfma_f32_16x16x32_bf16 v[36:39], v[160:163], v[116:119], v[36:39]
    v_mfma_f32_16x16x32_bf16 v[40:43], v[160:163], v[120:123], v[40:43]
    v_mfma_f32_16x16x32_bf16 v[44:47], v[160:163], v[124:127], v[44:47]
    v_mfma_f32_16x16x32_bf16 v[92:95], v[172:175], v[124:127], v[92:95]
    v_mfma_f32_16x16x32_bf16 v[88:91], v[172:175], v[120:123], v[88:91]
    v_mfma_f32_16x16x32_bf16 v[84:87], v[172:175], v[116:119], v[84:87]
    v_mfma_f32_16x16x32_bf16 v[80:83], v[172:175], v[112:115], v[80:83]
    s_setprio 1
    s_barrier
    s_add_u32 m0, s62, 131072
    s_mov_b32 s92, 49152
    buffer_load_dwordx4 v217, s[4:7], s92 offen lds
    s_nop 7
    v_mul_f32 v96, v184, v0
    v_mul_f32 v97, v184, v1
    buffer_load_dwordx4 v217, s[4:7], s92 offen offset:1024 lds
    v_mul_f32 v98, v184, v2
    v_mul_f32 v99, v184, v3
    v_exp_f32 v96, v96
    v_exp_f32 v97, v97
    buffer_load_dwordx4 v217, s[4:7], s92 offen offset:2048 lds
    v_exp_f32 v98, v98
    v_exp_f32 v99, v99
    v_mul_f32 v0, v0, v48
    v_mul_f32 v1, v1, v49
    buffer_load_dwordx4 v217, s[4:7], s92 offen offset:3072 lds
    v_mul_f32 v2, v2, v50
    v_mul_f32 v3, v3, v51
    v_fma_f32 v96, v96, v188, v188
    v_fma_f32 v97, v97, v188, v188
    s_add_u32 m0, s62, 16384
    s_add_u32 s59, s68, 2490368
    buffer_load_dwordx4 v213, s[20:23], s59 offen lds
    v_fma_f32 v98, v98, v188, v188
    v_fma_f32 v99, v99, v188, v188
    v_rcp_f32 v96, v96
    v_rcp_f32 v97, v97
    buffer_load_dwordx4 v214, s[20:23], s59 offen offset:1024 lds
    v_rcp_f32 v98, v98
    v_rcp_f32 v99, v99
    v_mul_f32 v0, v0, v96
    v_mul_f32 v1, v1, v97
    buffer_load_dwordx4 v215, s[20:23], s59 offen offset:2048 lds
    v_mul_f32 v2, v2, v98
    v_mul_f32 v3, v3, v99
    v_cvt_pk_bf16_f32 v100, v0, v1
    v_cvt_pk_bf16_f32 v101, v2, v3
    buffer_load_dwordx4 v216, s[20:23], s59 offen offset:3072 lds
    v_mul_f32 v96, v184, v16
    v_mul_f32 v97, v184, v17
    v_mul_f32 v98, v184, v18
    v_mul_f32 v99, v184, v19
    s_barrier
    s_add_u32 m0, s62, 98304
    s_mov_b32 s92, 65536
    buffer_load_dwordx4 v217, s[4:7], s92 offen lds
    v_exp_f32 v96, v96
    v_exp_f32 v97, v97
    v_exp_f32 v98, v98
    buffer_load_dwordx4 v217, s[4:7], s92 offen offset:1024 lds
    v_exp_f32 v99, v99
    v_mul_f32 v16, v16, v64
    v_mul_f32 v17, v17, v65
    v_mul_f32 v18, v18, v66
    buffer_load_dwordx4 v217, s[4:7], s92 offen offset:2048 lds
    v_mul_f32 v19, v19, v67
    v_fma_f32 v96, v96, v188, v188
    v_fma_f32 v97, v97, v188, v188
    buffer_load_dwordx4 v217, s[4:7], s92 offen offset:3072 lds
    v_fma_f32 v98, v98, v188, v188
    v_fma_f32 v99, v99, v188, v188
    v_rcp_f32 v96, v96
    v_rcp_f32 v97, v97
    s_add_u32 m0, s62, 32768
    s_add_u32 s59, s68, 2752512
    buffer_load_dwordx4 v213, s[20:23], s59 offen lds
    v_rcp_f32 v98, v98
    v_rcp_f32 v99, v99
    v_mul_f32 v16, v16, v96
    buffer_load_dwordx4 v214, s[20:23], s59 offen offset:1024 lds
    v_mul_f32 v17, v17, v97
    v_mul_f32 v18, v18, v98
    v_mul_f32 v19, v19, v99
    v_cvt_pk_bf16_f32 v102, v16, v17
    buffer_load_dwordx4 v215, s[20:23], s59 offen offset:2048 lds
    v_cvt_pk_bf16_f32 v103, v18, v19
    s_add_u32 s55, s89, 262144
    buffer_store_dwordx4 v[100:103], v254, s[4:7], s55 offen sc0 sc1
    v_mul_f32 v96, v185, v4
    buffer_load_dwordx4 v216, s[20:23], s59 offen offset:3072 lds
    v_mul_f32 v97, v185, v5
    v_mul_f32 v98, v185, v6
    v_mul_f32 v99, v185, v7
    v_exp_f32 v96, v96
    s_waitcnt vmcnt(13)
    s_barrier
    s_add_u32 m0, s62, 114688
    s_mov_b32 s92, 81920
    buffer_load_dwordx4 v217, s[4:7], s92 offen lds
    v_exp_f32 v97, v97
    v_exp_f32 v98, v98
    v_exp_f32 v99, v99
    buffer_load_dwordx4 v217, s[4:7], s92 offen offset:1024 lds
    v_mul_f32 v4, v4, v52
    v_mul_f32 v5, v5, v53
    v_mul_f32 v6, v6, v54
    v_mul_f32 v7, v7, v55
    buffer_load_dwordx4 v217, s[4:7], s92 offen offset:2048 lds
    v_fma_f32 v96, v96, v189, v189
    v_fma_f32 v97, v97, v189, v189
    v_fma_f32 v98, v98, v189, v189
    buffer_load_dwordx4 v217, s[4:7], s92 offen offset:3072 lds
    v_fma_f32 v99, v99, v189, v189
    v_rcp_f32 v96, v96
    v_rcp_f32 v97, v97
    v_rcp_f32 v98, v98
    s_add_u32 m0, s62, 49152
    s_add_u32 s59, s68, 3407872
    buffer_load_dwordx4 v213, s[20:23], s59 offen lds
    v_rcp_f32 v99, v99
    v_mul_f32 v4, v4, v96
    v_mul_f32 v5, v5, v97
    v_mul_f32 v6, v6, v98
    buffer_load_dwordx4 v214, s[20:23], s59 offen offset:1024 lds
    v_mul_f32 v7, v7, v99
    v_cvt_pk_bf16_f32 v104, v4, v5
    v_cvt_pk_bf16_f32 v105, v6, v7
    buffer_load_dwordx4 v215, s[20:23], s59 offen offset:2048 lds
    v_mul_f32 v96, v185, v20
    v_mul_f32 v97, v185, v21
    v_mul_f32 v98, v185, v22
    v_mul_f32 v99, v185, v23
    buffer_load_dwordx4 v216, s[20:23], s59 offen offset:3072 lds
    v_exp_f32 v96, v96
    v_exp_f32 v97, v97
    v_exp_f32 v98, v98
    v_exp_f32 v99, v99
    s_waitcnt vmcnt(13)
    s_barrier
    s_add_u32 m0, s62, 131072
    s_mov_b32 s92, 98304
    buffer_load_dwordx4 v217, s[4:7], s92 offen lds
    v_mul_f32 v20, v20, v68
    v_mul_f32 v21, v21, v69
    v_mul_f32 v22, v22, v70
    buffer_load_dwordx4 v217, s[4:7], s92 offen offset:1024 lds
    v_mul_f32 v23, v23, v71
    v_fma_f32 v96, v96, v189, v189
    v_fma_f32 v97, v97, v189, v189
    v_fma_f32 v98, v98, v189, v189
    buffer_load_dwordx4 v217, s[4:7], s92 offen offset:2048 lds
    v_fma_f32 v99, v99, v189, v189
    v_rcp_f32 v96, v96
    v_rcp_f32 v97, v97
    buffer_load_dwordx4 v217, s[4:7], s92 offen offset:3072 lds
    v_rcp_f32 v98, v98
    v_rcp_f32 v99, v99
    v_mul_f32 v20, v20, v96
    v_mul_f32 v21, v21, v97
    s_add_u32 m0, s62, 65536
    s_add_u32 s59, s68, 65536
    buffer_load_dwordx4 v213, s[20:23], s59 offen lds
    v_mul_f32 v22, v22, v98
    v_mul_f32 v23, v23, v99
    v_cvt_pk_bf16_f32 v106, v20, v21
    v_cvt_pk_bf16_f32 v107, v22, v23
    buffer_load_dwordx4 v214, s[20:23], s59 offen offset:1024 lds
    s_add_u32 s55, s89, 264192
    buffer_store_dwordx4 v[104:107], v254, s[4:7], s55 offen sc0 sc1
    v_mul_f32 v96, v186, v8
    v_mul_f32 v97, v186, v9
    buffer_load_dwordx4 v215, s[20:23], s59 offen offset:2048 lds
    v_mul_f32 v98, v186, v10
    v_mul_f32 v99, v186, v11
    v_exp_f32 v96, v96
    v_exp_f32 v97, v97
    buffer_load_dwordx4 v216, s[20:23], s59 offen offset:3072 lds
    v_exp_f32 v98, v98
    v_exp_f32 v99, v99
    v_mul_f32 v8, v8, v56
    v_mul_f32 v9, v9, v57
    s_waitcnt vmcnt(13)
    s_barrier
    v_lshrrev_b32 v252, 2, v254
    v_min_u32 v252, 28, v252
    s_add_u32 s55, s0, 2080
    buffer_load_dword v251, v252, s[4:7], s55 offen sc0 sc1
    s_add_u32 m0, s62, 98304
    s_mov_b32 s92, 114688
    buffer_load_dwordx4 v217, s[4:7], s92 offen lds
    v_mul_f32 v10, v10, v58
    v_mul_f32 v11, v11, v59
    v_fma_f32 v96, v96, v190, v190
    v_fma_f32 v97, v97, v190, v190
    buffer_load_dwordx4 v217, s[4:7], s92 offen offset:1024 lds
    v_fma_f32 v98, v98, v190, v190
    v_fma_f32 v99, v99, v190, v190
    v_rcp_f32 v96, v96
    v_rcp_f32 v97, v97
    buffer_load_dwordx4 v217, s[4:7], s92 offen offset:2048 lds
    v_rcp_f32 v98, v98
    v_rcp_f32 v99, v99
    v_mul_f32 v8, v8, v96
    v_mul_f32 v9, v9, v97
    buffer_load_dwordx4 v217, s[4:7], s92 offen offset:3072 lds
    v_mul_f32 v10, v10, v98
    v_mul_f32 v11, v11, v99
    v_cvt_pk_bf16_f32 v100, v8, v9
    v_cvt_pk_bf16_f32 v101, v10, v11
    s_add_u32 m0, s62, 81920
    s_add_u32 s59, s68, 720896
    buffer_load_dwordx4 v213, s[20:23], s59 offen lds
    v_mul_f32 v96, v186, v24
    v_mul_f32 v97, v186, v25
    v_mul_f32 v98, v186, v26
    v_mul_f32 v99, v186, v27
    buffer_load_dwordx4 v214, s[20:23], s59 offen offset:1024 lds
    v_exp_f32 v96, v96
    v_exp_f32 v97, v97
    v_exp_f32 v98, v98
    v_exp_f32 v99, v99
    buffer_load_dwordx4 v215, s[20:23], s59 offen offset:2048 lds
    v_mul_f32 v24, v24, v72
    v_mul_f32 v25, v25, v73
    v_mul_f32 v26, v26, v74
    v_mul_f32 v27, v27, v75
    buffer_load_dwordx4 v216, s[20:23], s59 offen offset:3072 lds
    v_fma_f32 v96, v96, v190, v190
    v_fma_f32 v97, v97, v190, v190
    v_fma_f32 v98, v98, v190, v190
    v_fma_f32 v99, v99, v190, v190
    s_waitcnt vmcnt(14)
    s_barrier
    s_waitcnt vmcnt(8)
    v_cmp_ne_u32 vcc, 0x01010101, v251
    s_cbranch_vccz ap_86
    v_lshrrev_b32 v252, 2, v254
    v_min_u32 v252, 28, v252
    s_add_u32 s55, s0, 2080
    s_mov_b32 s56, 262144
poll_87:
    buffer_load_dword v253, v252, s[4:7], s55 offen sc0 sc1
    s_waitcnt vmcnt(0)
    v_cmp_ne_u32 vcc, 0x01010101, v253
    s_cbranch_vccz pd_88
    s_sleep 1
    s_sub_u32 s56, s56, 1
    s_cmp_lg_u32 s56, 0
    s_cbranch_scc1 poll_87
pd_88:
ap_86:
    s_add_u32 m0, s62, 114688
    s_mov_b32 s92, 131072
    buffer_load_dwordx4 v217, s[4:7], s92 offen lds
    v_rcp_f32 v96, v96
    v_rcp_f32 v97, v97
    v_rcp_f32 v98, v98
    buffer_load_dwordx4 v217, s[4:7], s92 offen offset:1024 lds
    v_rcp_f32 v99, v99
    v_mul_f32 v24, v24, v96
    v_mul_f32 v25, v25, v97
    v_mul_f32 v26, v26, v98
    buffer_load_dwordx4 v217, s[4:7], s92 offen offset:2048 lds
    v_mul_f32 v27, v27, v99
    v_cvt_pk_bf16_f32 v102, v24, v25
    v_cvt_pk_bf16_f32 v103, v26, v27
    buffer_load_dwordx4 v217, s[4:7], s92 offen offset:3072 lds
    s_add_u32 s55, s89, 266240
    buffer_store_dwordx4 v[100:103], v254, s[4:7], s55 offen sc0 sc1
    v_mul_f32 v96, v187, v12
    v_mul_f32 v97, v187, v13
    v_mul_f32 v98, v187, v14
    s_add_u32 m0, s62, 0
    s_add_u32 s59, s68, 983040
    buffer_load_dwordx4 v213, s[20:23], s59 offen lds
    v_mul_f32 v99, v187, v15
    v_exp_f32 v96, v96
    v_exp_f32 v97, v97
    buffer_load_dwordx4 v214, s[20:23], s59 offen offset:1024 lds
    v_exp_f32 v98, v98
    v_exp_f32 v99, v99
    v_mul_f32 v12, v12, v60
    v_mul_f32 v13, v13, v61
    buffer_load_dwordx4 v215, s[20:23], s59 offen offset:2048 lds
    v_mul_f32 v14, v14, v62
    v_mul_f32 v15, v15, v63
    v_fma_f32 v96, v96, v191, v191
    buffer_load_dwordx4 v216, s[20:23], s59 offen offset:3072 lds
    v_fma_f32 v97, v97, v191, v191
    v_fma_f32 v98, v98, v191, v191
    v_fma_f32 v99, v99, v191, v191
    v_rcp_f32 v96, v96
    s_waitcnt vmcnt(13)
    s_barrier
    s_add_u32 m0, s62, 131072
    s_mov_b32 s92, 147456
    buffer_load_dwordx4 v217, s[4:7], s92 offen lds
    v_rcp_f32 v97, v97
    v_rcp_f32 v98, v98
    v_rcp_f32 v99, v99
    buffer_load_dwordx4 v217, s[4:7], s92 offen offset:1024 lds
    v_mul_f32 v12, v12, v96
    v_mul_f32 v13, v13, v97
    v_mul_f32 v14, v14, v98
    v_mul_f32 v15, v15, v99
    buffer_load_dwordx4 v217, s[4:7], s92 offen offset:2048 lds
    v_cvt_pk_bf16_f32 v104, v12, v13
    v_cvt_pk_bf16_f32 v105, v14, v15
    v_mul_f32 v96, v187, v28
    buffer_load_dwordx4 v217, s[4:7], s92 offen offset:3072 lds
    v_mul_f32 v97, v187, v29
    v_mul_f32 v98, v187, v30
    v_mul_f32 v99, v187, v31
    v_exp_f32 v96, v96
    s_add_u32 m0, s62, 16384
    s_add_u32 s59, s68, 1638400
    buffer_load_dwordx4 v213, s[20:23], s59 offen lds
    v_exp_f32 v97, v97
    v_exp_f32 v98, v98
    v_exp_f32 v99, v99
    v_mul_f32 v28, v28, v76
    buffer_load_dwordx4 v214, s[20:23], s59 offen offset:1024 lds
    v_mul_f32 v29, v29, v77
    v_mul_f32 v30, v30, v78
    v_mul_f32 v31, v31, v79
    buffer_load_dwordx4 v215, s[20:23], s59 offen offset:2048 lds
    v_fma_f32 v96, v96, v191, v191
    v_fma_f32 v97, v97, v191, v191
    v_fma_f32 v98, v98, v191, v191
    v_fma_f32 v99, v99, v191, v191
    buffer_load_dwordx4 v216, s[20:23], s59 offen offset:3072 lds
    v_rcp_f32 v96, v96
    v_rcp_f32 v97, v97
    v_rcp_f32 v98, v98
    v_rcp_f32 v99, v99
    s_waitcnt vmcnt(13)
    s_barrier
    s_add_u32 m0, s62, 98304
    s_mov_b32 s92, 163840
    buffer_load_dwordx4 v217, s[4:7], s92 offen lds
    v_mul_f32 v28, v28, v96
    v_mul_f32 v29, v29, v97
    v_mul_f32 v30, v30, v98
    buffer_load_dwordx4 v217, s[4:7], s92 offen offset:1024 lds
    v_mul_f32 v31, v31, v99
    v_cvt_pk_bf16_f32 v106, v28, v29
    v_cvt_pk_bf16_f32 v107, v30, v31
    buffer_load_dwordx4 v217, s[4:7], s92 offen offset:2048 lds
    s_add_u32 s55, s89, 268288
    buffer_store_dwordx4 v[104:107], v254, s[4:7], s55 offen sc0 sc1
    s_lshl_b32 s55, s43, 12
    s_lshl_b32 s56, s44, 3
    s_add_u32 s55, s55, s56
    s_add_u32 s55, s55, 147456
    v_add_u32 v120, s55, v254
    v_mul_f32 v96, v184, v32
    buffer_load_dwordx4 v217, s[4:7], s92 offen offset:3072 lds
    v_mul_f32 v97, v184, v33
    v_mul_f32 v98, v184, v34
    v_mul_f32 v99, v184, v35
    s_add_u32 m0, s62, 32768
    s_add_u32 s59, s68, 1900544
    buffer_load_dwordx4 v213, s[20:23], s59 offen lds
    v_exp_f32 v96, v96
    v_exp_f32 v97, v97
    v_exp_f32 v98, v98
    buffer_load_dwordx4 v214, s[20:23], s59 offen offset:1024 lds
    v_exp_f32 v99, v99
    v_mul_f32 v32, v32, v80
    v_mul_f32 v33, v33, v81
    buffer_load_dwordx4 v215, s[20:23], s59 offen offset:2048 lds
    v_mul_f32 v34, v34, v82
    v_mul_f32 v35, v35, v83
    v_fma_f32 v96, v96, v188, v188
    buffer_load_dwordx4 v216, s[20:23], s59 offen offset:3072 lds
    v_fma_f32 v97, v97, v188, v188
    v_fma_f32 v98, v98, v188, v188
    v_fma_f32 v99, v99, v188, v188
    v_rcp_f32 v96, v96
    s_waitcnt vmcnt(13)
    s_barrier
    s_add_u32 m0, s62, 114688
    s_mov_b32 s92, 180224
    buffer_load_dwordx4 v217, s[4:7], s92 offen lds
    v_rcp_f32 v97, v97
    v_rcp_f32 v98, v98
    v_rcp_f32 v99, v99
    buffer_load_dwordx4 v217, s[4:7], s92 offen offset:1024 lds
    v_mul_f32 v32, v32, v96
    v_mul_f32 v33, v33, v97
    v_mul_f32 v34, v34, v98
    v_mul_f32 v35, v35, v99
    buffer_load_dwordx4 v217, s[4:7], s92 offen offset:2048 lds
    v_cvt_pk_bf16_f32 v108, v32, v33
    v_cvt_pk_bf16_f32 v109, v34, v35
    ds_write_b64 v120, v[108:109] offset:0
    buffer_load_dwordx4 v217, s[4:7], s92 offen offset:3072 lds
    v_mul_f32 v96, v185, v36
    v_mul_f32 v97, v185, v37
    v_mul_f32 v98, v185, v38
    v_mul_f32 v99, v185, v39
    s_add_u32 m0, s62, 49152
    s_add_u32 s59, s68, 2555904
    buffer_load_dwordx4 v213, s[20:23], s59 offen lds
    v_exp_f32 v96, v96
    v_exp_f32 v97, v97
    v_exp_f32 v98, v98
    v_exp_f32 v99, v99
    buffer_load_dwordx4 v214, s[20:23], s59 offen offset:1024 lds
    v_mul_f32 v36, v36, v84
    v_mul_f32 v37, v37, v85
    v_mul_f32 v38, v38, v86
    buffer_load_dwordx4 v215, s[20:23], s59 offen offset:2048 lds
    v_mul_f32 v39, v39, v87
    v_fma_f32 v96, v96, v189, v189
    v_fma_f32 v97, v97, v189, v189
    v_fma_f32 v98, v98, v189, v189
    buffer_load_dwordx4 v216, s[20:23], s59 offen offset:3072 lds
    v_fma_f32 v99, v99, v189, v189
    v_rcp_f32 v96, v96
    v_rcp_f32 v97, v97
    v_rcp_f32 v98, v98
    s_waitcnt vmcnt(12)
    s_barrier
    s_cmp_lg_u32 s42, 0
    s_cbranch_scc1 wf_89
    s_lshr_b32 s55, s2, 5
    s_lshl_b32 s55, s55, 2
    s_add_u32 s55, s55, s0
    v_mov_b32 v252, 2112
    v_mov_b32 v253, 0x01010101
    s_mov_b64 exec, 1
    s_cmp_eq_u32 s45, 0
    s_cbranch_scc1 st_90
    buffer_store_dword v253, v252, s[4:7], s55 offen sc0 sc1
    s_branch st_91
st_90:
    buffer_store_dword v253, v252, s[4:7], s55 offen
st_91:
    s_mov_b64 exec, -1
wf_89:
    s_add_u32 m0, s62, 131072
    s_mov_b32 s92, 196608
    buffer_load_dwordx4 v217, s[4:7], s92 offen lds
    v_rcp_f32 v99, v99
    v_mul_f32 v36, v36, v96
    v_mul_f32 v37, v37, v97
    buffer_load_dwordx4 v217, s[4:7], s92 offen offset:1024 lds
    v_mul_f32 v38, v38, v98
    v_mul_f32 v39, v39, v99
    v_cvt_pk_bf16_f32 v110, v36, v37
    v_cvt_pk_bf16_f32 v111, v38, v39
    buffer_load_dwordx4 v217, s[4:7], s92 offen offset:2048 lds
    ds_write_b64 v120, v[110:111] offset:1024
    v_mul_f32 v96, v186, v40
    v_mul_f32 v97, v186, v41
    v_mul_f32 v98, v186, v42
    buffer_load_dwordx4 v217, s[4:7], s92 offen offset:3072 lds
    v_mul_f32 v99, v186, v43
    v_exp_f32 v96, v96
    v_exp_f32 v97, v97
    v_exp_f32 v98, v98
    s_add_u32 m0, s62, 65536
    s_add_u32 s59, s68, 2818048
    buffer_load_dwordx4 v213, s[20:23], s59 offen lds
    v_exp_f32 v99, v99
    v_mul_f32 v40, v40, v88
    v_mul_f32 v41, v41, v89
    v_mul_f32 v42, v42, v90
    buffer_load_dwordx4 v214, s[20:23], s59 offen offset:1024 lds
    v_mul_f32 v43, v43, v91
    v_fma_f32 v96, v96, v190, v190
    v_fma_f32 v97, v97, v190, v190
    v_fma_f32 v98, v98, v190, v190
    buffer_load_dwordx4 v215, s[20:23], s59 offen offset:2048 lds
    v_fma_f32 v99, v99, v190, v190
    v_rcp_f32 v96, v96
    v_rcp_f32 v97, v97
    v_rcp_f32 v98, v98
    buffer_load_dwordx4 v216, s[20:23], s59 offen offset:3072 lds
    v_rcp_f32 v99, v99
    v_mul_f32 v40, v40, v96
    v_mul_f32 v41, v41, v97
    v_mul_f32 v42, v42, v98
    s_waitcnt vmcnt(12)
    s_barrier
    s_add_u32 m0, s62, 98304
    s_mov_b32 s92, 212992
    buffer_load_dwordx4 v217, s[4:7], s92 offen lds
    v_mul_f32 v43, v43, v99
    v_cvt_pk_bf16_f32 v112, v40, v41
    v_cvt_pk_bf16_f32 v113, v42, v43
    ds_write_b64 v120, v[112:113] offset:2048
    buffer_load_dwordx4 v217, s[4:7], s92 offen offset:1024 lds
    v_mul_f32 v96, v187, v44
    v_mul_f32 v97, v187, v45
    v_mul_f32 v98, v187, v46
    v_mul_f32 v99, v187, v47
    buffer_load_dwordx4 v217, s[4:7], s92 offen offset:2048 lds
    v_exp_f32 v96, v96
    v_exp_f32 v97, v97
    v_exp_f32 v98, v98
    v_exp_f32 v99, v99
    buffer_load_dwordx4 v217, s[4:7], s92 offen offset:3072 lds
    v_mul_f32 v44, v44, v92
    v_mul_f32 v45, v45, v93
    v_mul_f32 v46, v46, v94
    v_mul_f32 v47, v47, v95
    s_add_u32 m0, s62, 81920
    s_add_u32 s59, s68, 3473408
    buffer_load_dwordx4 v213, s[20:23], s59 offen lds
    v_fma_f32 v96, v96, v191, v191
    v_fma_f32 v97, v97, v191, v191
    v_fma_f32 v98, v98, v191, v191
    v_fma_f32 v99, v99, v191, v191
    buffer_load_dwordx4 v214, s[20:23], s59 offen offset:1024 lds
    v_rcp_f32 v96, v96
    v_rcp_f32 v97, v97
    v_rcp_f32 v98, v98
    v_rcp_f32 v99, v99
    buffer_load_dwordx4 v215, s[20:23], s59 offen offset:2048 lds
    v_mul_f32 v44, v44, v96
    v_mul_f32 v45, v45, v97
    v_mul_f32 v46, v46, v98
    v_mul_f32 v47, v47, v99
    buffer_load_dwordx4 v216, s[20:23], s59 offen offset:3072 lds
    v_cvt_pk_bf16_f32 v114, v44, v45
    v_cvt_pk_bf16_f32 v115, v46, v47
    ds_write_b64 v120, v[114:115] offset:3072
    s_lshr_b32 s55, s62, 1
    s_add_u32 s55, s55, 147456
    v_add_u32 v121, s55, v254
    s_waitcnt vmcnt(12) lgkmcnt(0)
    s_barrier
    s_add_u32 m0, s62, 114688
    s_mov_b32 s92, 229376
    buffer_load_dwordx4 v217, s[4:7], s92 offen lds
    ds_read_b128 v[100:103], v121 offset:0
    ds_read_b128 v[104:107], v121 offset:1024
    buffer_load_dwordx4 v217, s[4:7], s92 offen offset:1024 lds
    s_waitcnt lgkmcnt(0)
    buffer_store_dwordx4 v[100:103], v254, s[4:7], s90 offen offset:0 sc0 sc1
    buffer_load_dwordx4 v217, s[4:7], s92 offen offset:2048 lds
    buffer_store_dwordx4 v[104:107], v254, s[4:7], s90 offen offset:2048 sc0 sc1
    s_cmp_eq_u32 s46, 0
    s_cselect_b32 s63, s63, 2130706432
    buffer_load_dwordx4 v217, s[4:7], s92 offen offset:3072 lds
    v_lshrrev_b32 v224, 7, v254
    v_and_b32 v225, 0x70, v254
    s_add_u32 m0, s62, 0
    s_add_u32 s59, s69, 262144
    buffer_load_dwordx4 v213, s[20:23], s59 offen lds
    v_and_b32 v226, 6, v224
    v_lshlrev_b32 v226, 4, v226
    buffer_load_dwordx4 v214, s[20:23], s59 offen offset:1024 lds
    v_xor_b32 v225, v225, v226
    v_mul_u32_u24 v224, 6144, v224
    buffer_load_dwordx4 v215, s[20:23], s59 offen offset:2048 lds
    v_add3_u32 v224, v224, v225, s63
    s_lshr_b32 s55, s61, 10
    s_add_u32 s55, s55, 0
    s_and_b32 s56, s55, 3
    s_lshl_b32 s56, s56, 3
    s_mul_i32 s56, s56, 6144
    s_lshr_b32 s55, s55, 2
    s_lshl_b32 s55, s55, 11
    s_add_u32 s55, s55, s56
    s_sub_u32 s55, s55, 0
    v_add_u32 v200, s55, v224
    buffer_load_dwordx4 v216, s[20:23], s59 offen offset:3072 lds
    s_lshr_b32 s55, s61, 10
    s_add_u32 s55, s55, 1
    s_and_b32 s56, s55, 3
    s_lshl_b32 s56, s56, 3
    s_mul_i32 s56, s56, 6144
    s_lshr_b32 s55, s55, 2
    s_lshl_b32 s55, s55, 11
    s_add_u32 s55, s55, s56
    s_sub_u32 s55, s55, 1024
    v_add_u32 v201, s55, v224
    s_lshr_b32 s55, s61, 10
    s_add_u32 s55, s55, 2
    s_and_b32 s56, s55, 3
    s_lshl_b32 s56, s56, 3
    s_mul_i32 s56, s56, 6144
    s_lshr_b32 s55, s55, 2
    s_lshl_b32 s55, s55, 11
    s_add_u32 s55, s55, s56
    s_sub_u32 s55, s55, 2048
    v_add_u32 v202, s55, v224
    s_waitcnt vmcnt(14)
    s_barrier
    v_lshrrev_b32 v252, 2, v254
    v_min_u32 v252, 28, v252
    s_add_u32 s55, s0, 2112
    buffer_load_dword v251, v252, s[4:7], s55 offen sc0 sc1
    s_add_u32 m0, s62, 131072
    s_mov_b32 s92, 245760
    buffer_load_dwordx4 v217, s[4:7], s92 offen lds
    buffer_load_dwordx4 v217, s[4:7], s92 offen offset:1024 lds
    buffer_load_dwordx4 v217, s[4:7], s92 offen offset:2048 lds
    buffer_load_dwordx4 v217, s[4:7], s92 offen offset:3072 lds
    s_add_u32 m0, s62, 16384
    s_add_u32 s59, s69, 524288
    buffer_load_dwordx4 v213, s[20:23], s59 offen lds
    buffer_load_dwordx4 v214, s[20:23], s59 offen offset:1024 lds
    buffer_load_dwordx4 v215, s[20:23], s59 offen offset:2048 lds
    buffer_load_dwordx4 v216, s[20:23], s59 offen offset:3072 lds
    s_waitcnt vmcnt(13)
    s_barrier
    s_cmp_lg_u32 s42, 1
    s_cbranch_scc1 wf_92
    s_lshr_b32 s55, s2, 5
    s_lshl_b32 s55, s55, 2
    s_add_u32 s55, s55, s0
    v_mov_b32 v252, 2144
    v_mov_b32 v253, 0x01010101
    s_mov_b64 exec, 1
    s_cmp_eq_u32 s45, 0
    s_cbranch_scc1 st_93
    buffer_store_dword v253, v252, s[4:7], s55 offen sc0 sc1
    s_branch st_94
st_93:
    buffer_store_dword v253, v252, s[4:7], s55 offen
st_94:
    s_mov_b64 exec, -1
wf_92:
    s_waitcnt vmcnt(8)
    v_cmp_ne_u32 vcc, 0x01010101, v251
    s_cbranch_vccz ap_95
    v_lshrrev_b32 v252, 2, v254
    v_min_u32 v252, 28, v252
    s_add_u32 s55, s0, 2112
    s_mov_b32 s56, 262144
poll_96:
    buffer_load_dword v253, v252, s[4:7], s55 offen sc0 sc1
    s_waitcnt vmcnt(0)
    v_cmp_ne_u32 vcc, 0x01010101, v253
    s_cbranch_vccz pd_97
    s_sleep 1
    s_sub_u32 s56, s56, 1
    s_cmp_lg_u32 s56, 0
    s_cbranch_scc1 poll_96
pd_97:
ap_95:
    s_add_u32 m0, s62, 98304
    s_mov_b32 s92, 262144
    buffer_load_dwordx4 v217, s[4:7], s92 offen lds
    buffer_load_dwordx4 v217, s[4:7], s92 offen offset:1024 lds
    buffer_load_dwordx4 v217, s[4:7], s92 offen offset:2048 lds
    buffer_load_dwordx4 v217, s[4:7], s92 offen offset:3072 lds
    s_add_u32 m0, s62, 32768
    s_add_u32 s59, s69, 1179648
    buffer_load_dwordx4 v213, s[20:23], s59 offen lds
    buffer_load_dwordx4 v214, s[20:23], s59 offen offset:1024 lds
    buffer_load_dwordx4 v215, s[20:23], s59 offen offset:2048 lds
    buffer_load_dwordx4 v216, s[20:23], s59 offen offset:3072 lds
    s_waitcnt vmcnt(12)
    s_barrier
    s_add_u32 m0, s62, 114688
    s_mov_b32 s92, 278528
    buffer_load_dwordx4 v217, s[4:7], s92 offen lds
    buffer_load_dwordx4 v217, s[4:7], s92 offen offset:1024 lds
    buffer_load_dwordx4 v217, s[4:7], s92 offen offset:2048 lds
    buffer_load_dwordx4 v217, s[4:7], s92 offen offset:3072 lds
    s_add_u32 m0, s62, 49152
    s_add_u32 s59, s69, 1441792
    buffer_load_dwordx4 v213, s[20:23], s59 offen lds
    buffer_load_dwordx4 v214, s[20:23], s59 offen offset:1024 lds
    buffer_load_dwordx4 v215, s[20:23], s59 offen offset:2048 lds
    buffer_load_dwordx4 v216, s[20:23], s59 offen offset:3072 lds
    s_waitcnt vmcnt(12)
    s_barrier
    s_add_u32 m0, s62, 131072
    s_mov_b32 s92, 294912
    buffer_load_dwordx4 v217, s[4:7], s92 offen lds
    buffer_load_dwordx4 v217, s[4:7], s92 offen offset:1024 lds
    buffer_load_dwordx4 v217, s[4:7], s92 offen offset:2048 lds
    buffer_load_dwordx4 v217, s[4:7], s92 offen offset:3072 lds
    s_add_u32 m0, s62, 65536
    s_add_u32 s59, s69, 2097152
    buffer_load_dwordx4 v213, s[20:23], s59 offen lds
    buffer_load_dwordx4 v214, s[20:23], s59 offen offset:1024 lds
    buffer_load_dwordx4 v215, s[20:23], s59 offen offset:2048 lds
    buffer_load_dwordx4 v216, s[20:23], s59 offen offset:3072 lds
    s_waitcnt vmcnt(12)
    s_barrier
    s_add_u32 m0, s62, 98304
    s_mov_b32 s92, 311296
    buffer_load_dwordx4 v217, s[4:7], s92 offen lds
    buffer_load_dwordx4 v217, s[4:7], s92 offen offset:1024 lds
    buffer_load_dwordx4 v217, s[4:7], s92 offen offset:2048 lds
    buffer_load_dwordx4 v217, s[4:7], s92 offen offset:3072 lds
    s_add_u32 m0, s62, 81920
    s_add_u32 s59, s69, 2359296
    buffer_load_dwordx4 v213, s[20:23], s59 offen lds
    buffer_load_dwordx4 v214, s[20:23], s59 offen offset:1024 lds
    buffer_load_dwordx4 v215, s[20:23], s59 offen offset:2048 lds
    buffer_load_dwordx4 v216, s[20:23], s59 offen offset:3072 lds
    s_waitcnt vmcnt(12)
    s_barrier
    s_add_u32 m0, s62, 114688
    s_mov_b32 s92, 327680
    buffer_load_dwordx4 v217, s[4:7], s92 offen lds
    buffer_load_dwordx4 v217, s[4:7], s92 offen offset:1024 lds
    buffer_load_dwordx4 v217, s[4:7], s92 offen offset:2048 lds
    buffer_load_dwordx4 v217, s[4:7], s92 offen offset:3072 lds
    s_add_u32 m0, s62, 0
    s_add_u32 s59, s69, 3014656
    buffer_load_dwordx4 v213, s[20:23], s59 offen lds
    buffer_load_dwordx4 v214, s[20:23], s59 offen offset:1024 lds
    buffer_load_dwordx4 v215, s[20:23], s59 offen offset:2048 lds
    buffer_load_dwordx4 v216, s[20:23], s59 offen offset:3072 lds
    s_waitcnt vmcnt(12)
    s_barrier
    s_add_u32 m0, s62, 131072
    s_mov_b32 s92, 344064
    buffer_load_dwordx4 v217, s[4:7], s92 offen lds
    buffer_load_dwordx4 v217, s[4:7], s92 offen offset:1024 lds
    buffer_load_dwordx4 v217, s[4:7], s92 offen offset:2048 lds
    buffer_load_dwordx4 v217, s[4:7], s92 offen offset:3072 lds
    s_add_u32 m0, s62, 16384
    s_add_u32 s59, s69, 3276800
    buffer_load_dwordx4 v213, s[20:23], s59 offen lds
    buffer_load_dwordx4 v214, s[20:23], s59 offen offset:1024 lds
    buffer_load_dwordx4 v215, s[20:23], s59 offen offset:2048 lds
    buffer_load_dwordx4 v216, s[20:23], s59 offen offset:3072 lds
    s_waitcnt vmcnt(12)
    s_barrier
    s_add_u32 m0, s62, 98304
    s_mov_b32 s92, 360448
    buffer_load_dwordx4 v217, s[4:7], s92 offen lds
    buffer_load_dwordx4 v217, s[4:7], s92 offen offset:1024 lds
    buffer_load_dwordx4 v217, s[4:7], s92 offen offset:2048 lds
    buffer_load_dwordx4 v217, s[4:7], s92 offen offset:3072 lds
    s_add_u32 m0, s62, 32768
    s_add_u32 s59, s69, 393216
    buffer_load_dwordx4 v213, s[20:23], s59 offen lds
    buffer_load_dwordx4 v214, s[20:23], s59 offen offset:1024 lds
    buffer_load_dwordx4 v215, s[20:23], s59 offen offset:2048 lds
    buffer_load_dwordx4 v216, s[20:23], s59 offen offset:3072 lds
    s_waitcnt vmcnt(12)
    s_barrier
    v_lshrrev_b32 v252, 2, v254
    v_min_u32 v252, 28, v252
    s_add_u32 s55, s0, 2144
    buffer_load_dword v251, v252, s[4:7], s55 offen sc0 sc1
    s_add_u32 m0, s62, 114688
    s_mov_b32 s92, 376832
    buffer_load_dwordx4 v217, s[4:7], s92 offen lds
    buffer_load_dwordx4 v217, s[4:7], s92 offen offset:1024 lds
    buffer_load_dwordx4 v217, s[4:7], s92 offen offset:2048 lds
    buffer_load_dwordx4 v217, s[4:7], s92 offen offset:3072 lds
    s_add_u32 m0, s62, 49152
    s_add_u32 s59, s69, 1310720
    buffer_load_dwordx4 v213, s[20:23], s59 offen lds
    buffer_load_dwordx4 v214, s[20:23], s59 offen offset:1024 lds
    buffer_load_dwordx4 v215, s[20:23], s59 offen offset:2048 lds
    buffer_load_dwordx4 v216, s[20:23], s59 offen offset:3072 lds
    s_waitcnt vmcnt(13)
    s_barrier
    s_waitcnt vmcnt(8)
    v_cmp_ne_u32 vcc, 0x01010101, v251
    s_cbranch_vccz ap_98
    v_lshrrev_b32 v252, 2, v254
    v_min_u32 v252, 28, v252
    s_add_u32 s55, s0, 2144
    s_mov_b32 s56, 262144
poll_99:
    buffer_load_dword v253, v252, s[4:7], s55 offen sc0 sc1
    s_waitcnt vmcnt(0)
    v_cmp_ne_u32 vcc, 0x01010101, v253
    s_cbranch_vccz pd_100
    s_sleep 1
    s_sub_u32 s56, s56, 1
    s_cmp_lg_u32 s56, 0
    s_cbranch_scc1 poll_99
pd_100:
ap_98:
    s_add_u32 m0, s62, 131072
    s_mov_b32 s92, 393216
    buffer_load_dwordx4 v217, s[4:7], s92 offen lds
    buffer_load_dwordx4 v217, s[4:7], s92 offen offset:1024 lds
    buffer_load_dwordx4 v217, s[4:7], s92 offen offset:2048 lds
    buffer_load_dwordx4 v217, s[4:7], s92 offen offset:3072 lds
    s_add_u32 m0, s62, 65536
    s_add_u32 s59, s69, 2228224
    buffer_load_dwordx4 v213, s[20:23], s59 offen lds
    buffer_load_dwordx4 v214, s[20:23], s59 offen offset:1024 lds
    buffer_load_dwordx4 v215, s[20:23], s59 offen offset:2048 lds
    buffer_load_dwordx4 v216, s[20:23], s59 offen offset:3072 lds
    s_waitcnt vmcnt(12)
    s_barrier
    s_add_u32 m0, s62, 98304
    s_mov_b32 s92, 409600
    buffer_load_dwordx4 v217, s[4:7], s92 offen lds
    buffer_load_dwordx4 v217, s[4:7], s92 offen offset:1024 lds
    buffer_load_dwordx4 v217, s[4:7], s92 offen offset:2048 lds
    buffer_load_dwordx4 v217, s[4:7], s92 offen offset:3072 lds
    s_add_u32 m0, s62, 81920
    s_add_u32 s59, s69, 3145728
    buffer_load_dwordx4 v213, s[20:23], s59 offen lds
    buffer_load_dwordx4 v214, s[20:23], s59 offen offset:1024 lds
    buffer_load_dwordx4 v215, s[20:23], s59 offen offset:2048 lds
    buffer_load_dwordx4 v216, s[20:23], s59 offen offset:3072 lds
    s_waitcnt vmcnt(12)
    s_barrier
    s_add_u32 m0, s62, 114688
    s_mov_b32 s92, 425984
    buffer_load_dwordx4 v217, s[4:7], s92 offen lds
    buffer_load_dwordx4 v217, s[4:7], s92 offen offset:1024 lds
    buffer_load_dwordx4 v217, s[4:7], s92 offen offset:2048 lds
    buffer_load_dwordx4 v217, s[4:7], s92 offen offset:3072 lds
    s_lshl_b32 s93, s51, 12
    s_add_u32 m0, s61, 0
    s_mul_i32 s59, s93, 96
    buffer_load_dwordx4 v200, s[8:11], s59 offen lds
    buffer_load_dwordx4 v201, s[8:11], s59 offen offset:1024 lds
    buffer_load_dwordx4 v202, s[8:11], s59 offen offset:2048 lds
    s_add_u32 s93, s93, 2048
    s_and_b32 s93, s93, 65535
    s_waitcnt vmcnt(11)
    s_barrier
    s_add_u32 m0, s62, 131072
    s_mov_b32 s92, 442368
    buffer_load_dwordx4 v217, s[4:7], s92 offen lds
    buffer_load_dwordx4 v217, s[4:7], s92 offen offset:1024 lds
    buffer_load_dwordx4 v217, s[4:7], s92 offen offset:2048 lds
    buffer_load_dwordx4 v217, s[4:7], s92 offen offset:3072 lds
    s_add_u32 m0, s61, 16384
    s_mul_i32 s59, s93, 96
    buffer_load_dwordx4 v200, s[8:11], s59 offen lds
    buffer_load_dwordx4 v201, s[8:11], s59 offen offset:1024 lds
    buffer_load_dwordx4 v202, s[8:11], s59 offen offset:2048 lds
    s_add_u32 s93, s93, 6144
    s_and_b32 s93, s93, 65535
    s_waitcnt vmcnt(10)
    s_barrier
    s_add_u32 m0, s61, 32768
    s_mul_i32 s59, s93, 96
    buffer_load_dwordx4 v200, s[8:11], s59 offen lds
    buffer_load_dwordx4 v201, s[8:11], s59 offen offset:1024 lds
    buffer_load_dwordx4 v202, s[8:11], s59 offen offset:2048 lds
    s_add_u32 s93, s93, 2048
    s_and_b32 s93, s93, 65535
    s_add_u32 m0, s61, 49152
    s_mul_i32 s59, s93, 96
    buffer_load_dwordx4 v200, s[8:11], s59 offen lds
    buffer_load_dwordx4 v201, s[8:11], s59 offen offset:1024 lds
    buffer_load_dwordx4 v202, s[8:11], s59 offen offset:2048 lds
    s_add_u32 s93, s93, 6144
    s_and_b32 s93, s93, 65535
    s_waitcnt vmcnt(9)
    s_barrier
    s_add_u32 m0, s61, 65536
    s_mul_i32 s59, s93, 96
    buffer_load_dwordx4 v200, s[8:11], s59 offen lds
    buffer_load_dwordx4 v201, s[8:11], s59 offen offset:1024 lds
    buffer_load_dwordx4 v202, s[8:11], s59 offen offset:2048 lds
    s_add_u32 s93, s93, 2048
    s_and_b32 s93, s93, 65535
    s_barrier
    s_add_u32 m0, s61, 81920
    s_mul_i32 s59, s93, 96
    buffer_load_dwordx4 v200, s[8:11], s59 offen lds
    buffer_load_dwordx4 v201, s[8:11], s59 offen offset:1024 lds
    buffer_load_dwordx4 v202, s[8:11], s59 offen offset:2048 lds
    s_add_u32 s93, s93, 6144
    s_and_b32 s93, s93, 65535
    s_setprio 0
    s_cmp_lg_u32 s46, 0
    s_cbranch_scc1 K_end
    s_mov_b32 s46, 1
    s_add_u32 s47, s47, 262144
    s_add_u32 s49, s49, 524288
    s_add_u32 s50, s50, 917504
    s_add_u32 s52, s52, 65536
    s_add_u32 s54, s54, 32768
    s_add_u32 s0, s0, 32768
    s_branch Y_layer
K_end:
    s_endpgm

.section .rodata,"a"
.p2align 6
.amdhsa_kernel interleave_layers__sliding_local_dilated__glu_gated_swiglu__prompt_kernel
  .amdhsa_next_free_vgpr 256
  .amdhsa_next_free_sgpr 102
  .amdhsa_accum_offset 256
  .amdhsa_group_segment_fixed_size 0
  .amdhsa_kernarg_size 80
  .amdhsa_user_sgpr_count 2
  .amdhsa_user_sgpr_kernarg_segment_ptr 1
  .amdhsa_system_sgpr_workgroup_id_x 1
.end_amdhsa_kernel
```

```asm
; @launch grid=(256,1,1) block=(512,1,1) lds=163840
.amdgcn_target "amdgcn-amd-amdhsa--gfx950"
.text
.globl interleave_layers__sliding_local_dilated__glu_gated_swiglu__prompt_kernel
.p2align 8
.type interleave_layers__sliding_local_dilated__glu_gated_swiglu__prompt_kernel,@function
interleave_layers__sliding_local_dilated__glu_gated_swiglu__prompt_kernel:
    s_cmp_ge_u32 s2, 256
    s_cbranch_scc0 K_go
    s_endpgm
K_go:
    s_load_dwordx4 s[72:75], s[0:1], 0
    s_load_dwordx2 s[76:77], s[0:1], 16
    s_load_dwordx8 s[80:87], s[0:1], 32
    s_load_dwordx4 s[88:91], s[0:1], 64
    v_lshrrev_b32 v1, 6, v0
    v_and_b32 v254, 63, v0
    v_readfirstlane_b32 s3, v1
    v_lshlrev_b32 v254, 4, v254
    s_and_b32 s55, s2, 6
    s_lshl_b32 s55, s55, 1
    s_lshr_b32 s56, s2, 3
    s_and_b32 s56, s56, 3
    s_add_u32 s40, s55, s56
    s_and_b32 s55, s2, 1
    s_lshr_b32 s56, s2, 5
    s_lshl_b32 s41, s55, 3
    s_add_u32 s41, s41, s56
    s_lshl_b32 s51, s56, 1
    s_add_u32 s51, s51, s55
    s_and_b32 s42, s3, 3
    s_and_b32 s43, s3, 1
    s_lshr_b32 s44, s42, 1
    s_lshl_b32 s55, s43, 1
    s_add_u32 s55, s55, s44
    s_mul_i32 s61, s55, 3072
    s_lshl_b32 s62, s55, 12
    s_mov_b32 s45, 1
    s_mov_b32 s46, 0
    s_lshl_b32 s47, s40, 22
    s_add_u32 s49, s47, 524288
    s_add_u32 s48, s47, 786432
    s_add_u32 s50, s47, 2097152
    s_add_u32 s52, s47, 1835008
    s_add_u32 s53, s52, 32768
    s_lshl_b32 s54, s40, 7
    s_add_u32 s54, s54, 71303168
    s_lshl_b32 s63, s51, 7
    s_lshl_b32 s55, s44, 16
    s_add_u32 s64, s63, s55
    s_mul_i32 s55, s44, 114688
    s_mul_i32 s56, s41, 448
    s_add_u32 s55, s55, s56
    s_and_b32 s56, s41, 1
    s_mul_i32 s56, s56, 192
    s_add_u32 s65, s55, s56
    s_sub_u32 s66, s55, s56
    s_add_u32 s66, s66, 256
    s_lshl_b32 s55, s43, 4
    s_add_u32 s55, s55, s41
    s_lshl_b32 s55, s55, 6
    s_add_u32 s55, s55, s44
    s_lshl_b32 s55, s55, 10
    s_add_u32 s67, s55, 67106816
    s_and_b32 s55, s51, 1
    s_mul_i32 s55, s55, 3670016
    s_lshr_b32 s56, s51, 1
    s_lshl_b32 s56, s56, 8
    s_add_u32 s55, s55, s56
    s_lshl_b32 s56, s44, 15
    s_add_u32 s55, s55, s56
    s_lshl_b32 s56, s43, 16
    s_add_u32 s69, s55, s56
    s_add_u32 s68, s69, s56
    s_waitcnt lgkmcnt(0)
    s_mov_b32 s8, s74
    s_mov_b32 s9, s75
    s_mov_b32 s10, 6291456
    s_mov_b32 s11, 0x00020000
    s_mov_b32 s36, s72
    s_mov_b32 s37, s73
    s_mov_b32 s38, 4194304
    s_mov_b32 s39, 0x00020000
    s_mov_b32 s4, s90
    s_mov_b32 s5, s91
    s_mov_b32 s6, 268435456
    s_mov_b32 s7, 0x00020000
    s_mov_b32 s24, s72
    s_mov_b32 s25, s73
    s_mov_b32 s26, 4194304
    s_mov_b32 s27, 0x00020000
    s_mov_b32 s12, s76
    s_mov_b32 s13, s77
    s_mov_b32 s14, 2097152
    s_mov_b32 s15, 0x00020000
    s_cmp_eq_u32 s43, 0
    s_cselect_b32 s16, s80, s82
    s_cselect_b32 s17, s81, s83
    s_mov_b32 s18, 7340032
    s_mov_b32 s19, 0x00020000
    s_mov_b32 s20, s84
    s_mov_b32 s21, s85
    s_mov_b32 s22, 7340032
    s_mov_b32 s23, 0x00020000
    s_mov_b32 s28, s86
    s_mov_b32 s29, s87
    s_mov_b32 s30, 4194304
    s_mov_b32 s31, 0x00020000
    s_mov_b32 s32, s88
    s_mov_b32 s33, s89
    s_mov_b32 s34, 256
    s_mov_b32 s35, 0x00020000
    s_and_b32 s55, s2, 1
    s_lshl_b32 s55, s55, 13
    s_add_u32 s55, s55, 16384
    s_add_u32 s0, s54, s55
    s_lshl_b32 s55, s51, 14
    s_lshl_b32 s56, s43, 13
    s_add_u32 s55, s55, s56
    s_lshl_b32 s56, s44, 10
    s_add_u32 s1, s55, s56
    s_cmp_lt_u32 s3, 4
    s_cbranch_scc1 X_start
    v_lshrrev_b32 v224, 7, v254
    v_and_b32 v225, 0x70, v254
    v_and_b32 v226, 6, v224
    v_lshlrev_b32 v226, 4, v226
    v_xor_b32 v225, v225, v226
    v_and_b32 v226, 4, v224
    v_add_u32 v224, v224, v226
    v_mul_u32_u24 v224, 6144, v224
    v_add3_u32 v224, v224, v225, s63
    s_lshr_b32 s55, s61, 10
    s_add_u32 s55, s55, 0
    s_and_b32 s56, s55, 3
    s_and_b32 s57, s56, 1
    s_lshl_b32 s57, s57, 4
    s_and_b32 s56, s56, 2
    s_lshl_b32 s56, s56, 1
    s_add_u32 s56, s56, s57
    s_mul_i32 s56, s56, 6144
    s_lshr_b32 s55, s55, 2
    s_lshl_b32 s55, s55, 11
    s_add_u32 s55, s55, s56
    s_sub_u32 s55, s55, 0
    v_add_u32 v200, s55, v224
    s_lshr_b32 s55, s61, 10
    s_add_u32 s55, s55, 1
    s_and_b32 s56, s55, 3
    s_and_b32 s57, s56, 1
    s_lshl_b32 s57, s57, 4
    s_and_b32 s56, s56, 2
    s_lshl_b32 s56, s56, 1
    s_add_u32 s56, s56, s57
    s_mul_i32 s56, s56, 6144
    s_lshr_b32 s55, s55, 2
    s_lshl_b32 s55, s55, 11
    s_add_u32 s55, s55, s56
    s_sub_u32 s55, s55, 1024
    v_add_u32 v201, s55, v224
    s_lshr_b32 s55, s61, 10
    s_add_u32 s55, s55, 2
    s_and_b32 s56, s55, 3
    s_and_b32 s57, s56, 1
    s_lshl_b32 s57, s57, 4
    s_and_b32 s56, s56, 2
    s_lshl_b32 s56, s56, 1
    s_add_u32 s56, s56, s57
    s_mul_i32 s56, s56, 6144
    s_lshr_b32 s55, s55, 2
    s_lshl_b32 s55, s55, 11
    s_add_u32 s55, s55, s56
    s_sub_u32 s55, s55, 2048
    v_add_u32 v202, s55, v224
    s_and_b32 s55, s40, 4
    s_lshl_b32 s55, s55, 1
    s_lshr_b32 s56, s40, 3
    s_add_u32 s55, s55, s56
    s_add_u32 s92, s55, s51
    s_and_b32 s92, s92, 15
    s_lshl_b32 s93, s92, 12
    s_add_u32 m0, s61, 0
    s_mul_i32 s59, s93, 96
    buffer_load_dwordx4 v200, s[8:11], s59 offen lds
    buffer_load_dwordx4 v201, s[8:11], s59 offen offset:1024 lds
    buffer_load_dwordx4 v202, s[8:11], s59 offen offset:2048 lds
    s_add_u32 s93, s93, 2048
    s_and_b32 s93, s93, 65535
    s_lshl_b32 s55, s40, 18
    s_lshl_b32 s56, s62, 4
    s_add_u32 s88, s55, s56
    s_lshl_b32 s56, s43, 14
    s_add_u32 s89, s55, s56
    s_sub_u32 s89, s89, 32768
    v_lshrrev_b32 v224, 7, v254
    v_and_b32 v225, 0x70, v254
    v_and_b32 v226, 6, v224
    v_lshlrev_b32 v226, 4, v226
    v_xor_b32 v225, v225, v226
    v_mul_u32_u24 v224, 2048, v224
    v_add3_u32 v217, v224, v225, s88
    v_add_u32 v218, 15360, v217
    v_add_u32 v219, 30720, v217
    v_add_u32 v220, 46080, v217
    s_lshl_b32 s94, s92, 7
    s_cmp_eq_u32 s40, 0
    s_cselect_b32 s89, 2130706432, s89
    s_sub_u32 s89, s89, s88
    v_add_u32 v221, s89, v217
    s_lshl_b32 s91, s43, 10
    s_cmp_eq_u32 s44, 0
    s_cselect_b32 s84, -1, 0
    s_not_b32 s85, s84
    s_add_u32 m0, s91, 98304
    s_mov_b64 exec, s[84:85]
    buffer_load_dwordx4 v221, s[36:39], s94 offen lds
    s_mov_b64 exec, -1
    s_add_u32 m0, s62, 100352
    s_nop 0
    buffer_load_dwordx4 v217, s[36:39], s94 offen lds
    buffer_load_dwordx4 v218, s[36:39], s94 offen offset:1024 lds
    buffer_load_dwordx4 v219, s[36:39], s94 offen offset:2048 lds
    buffer_load_dwordx4 v220, s[36:39], s94 offen offset:3072 lds
    s_add_u32 s94, s94, 256
    s_and_b32 s94, s94, 2047
    s_add_u32 m0, s61, 16384
    s_mul_i32 s59, s93, 96
    buffer_load_dwordx4 v200, s[8:11], s59 offen lds
    buffer_load_dwordx4 v201, s[8:11], s59 offen offset:1024 lds
    buffer_load_dwordx4 v202, s[8:11], s59 offen offset:2048 lds
    s_add_u32 s93, s93, 6144
    s_and_b32 s93, s93, 65535
    s_cmp_lt_u32 s2, 128
    s_cselect_b32 s72, s80, s82
    s_cselect_b32 s73, s81, s83
    s_mov_b32 s74, 7340032
    s_mov_b32 s75, 0x00020000
    s_and_b32 s55, s2, 127
    s_mul_i32 s55, s55, 57344
    s_lshl_b32 s56, s42, 14
    s_add_u32 s55, s55, s56
    v_lshlrev_b32 v227, 3, v254
    buffer_load_dword v251, v227, s[72:75], s55 offen
    s_cmp_eq_u32 s42, 3
    s_cbranch_scc1 t_1
    s_add_u32 s55, s55, 8192
    buffer_load_dword v251, v227, s[72:75], s55 offen
    s_branch t_2
t_1:
    s_lshl_b32 s55, s2, 13
    buffer_load_dword v251, v227, s[12:15], s55 offen
t_2:
    s_add_u32 m0, s91, 116736
    s_mov_b64 exec, s[84:85]
    buffer_load_dwordx4 v221, s[36:39], s94 offen lds
    s_mov_b64 exec, -1
    s_add_u32 m0, s62, 118784
    s_nop 0
    buffer_load_dwordx4 v217, s[36:39], s94 offen lds
    buffer_load_dwordx4 v218, s[36:39], s94 offen offset:1024 lds
    buffer_load_dwordx4 v219, s[36:39], s94 offen offset:2048 lds
    buffer_load_dwordx4 v220, s[36:39], s94 offen offset:3072 lds
    s_add_u32 s94, s94, 256
    s_and_b32 s94, s94, 2047
    s_add_u32 m0, s61, 32768
    s_mul_i32 s59, s93, 96
    buffer_load_dwordx4 v200, s[8:11], s59 offen lds
    buffer_load_dwordx4 v201, s[8:11], s59 offen offset:1024 lds
    buffer_load_dwordx4 v202, s[8:11], s59 offen offset:2048 lds
    s_add_u32 s93, s93, 2048
    s_and_b32 s93, s93, 65535
    s_add_u32 m0, s91, 135168
    s_mov_b64 exec, s[84:85]
    buffer_load_dwordx4 v221, s[36:39], s94 offen lds
    s_mov_b64 exec, -1
    s_add_u32 m0, s62, 137216
    s_nop 0
    buffer_load_dwordx4 v217, s[36:39], s94 offen lds
    buffer_load_dwordx4 v218, s[36:39], s94 offen offset:1024 lds
    buffer_load_dwordx4 v219, s[36:39], s94 offen offset:2048 lds
    buffer_load_dwordx4 v220, s[36:39], s94 offen offset:3072 lds
    s_add_u32 s94, s94, 256
    s_and_b32 s94, s94, 2047
    s_add_u32 m0, s61, 49152
    s_mul_i32 s59, s93, 96
    buffer_load_dwordx4 v200, s[8:11], s59 offen lds
    buffer_load_dwordx4 v201, s[8:11], s59 offen offset:1024 lds
    buffer_load_dwordx4 v202, s[8:11], s59 offen offset:2048 lds
    s_add_u32 s93, s93, 6144
    s_and_b32 s93, s93, 65535
    s_add_u32 m0, s61, 65536
    s_mul_i32 s59, s93, 96
    buffer_load_dwordx4 v200, s[8:11], s59 offen lds
    buffer_load_dwordx4 v201, s[8:11], s59 offen offset:1024 lds
    buffer_load_dwordx4 v202, s[8:11], s59 offen offset:2048 lds
    s_add_u32 s93, s93, 2048
    s_and_b32 s93, s93, 65535
    s_add_u32 m0, s61, 81920
    s_mul_i32 s59, s93, 96
    buffer_load_dwordx4 v200, s[8:11], s59 offen lds
    buffer_load_dwordx4 v201, s[8:11], s59 offen offset:1024 lds
    buffer_load_dwordx4 v202, s[8:11], s59 offen offset:2048 lds
    s_add_u32 s93, s93, 6144
    s_and_b32 s93, s93, 65535
    s_branch Y_first
X_start:
    s_cmp_lg_u32 s42, 0
    s_cbranch_scc1 xz_5
    v_mov_b32 v103, 0
    v_lshrrev_b32 v100, 2, v254
    s_lshl_b32 s55, s2, 8
    s_add_u32 s55, s55, 71303168
    buffer_store_dword v103, v100, s[4:7], s55 offen sc0 sc1
    v_lshlrev_b32 v100, 6, v254
    s_lshl_b32 s55, s2, 2
    s_add_u32 s55, s55, 71565312
    s_mov_b64 exec, 15
    buffer_store_dword v103, v100, s[4:7], s55 offen sc0 sc1
    s_mov_b64 exec, -1
xz_5:
    s_getpc_b64 s[72:73]
K_pc:
    s_mov_b32 s74, K_end-K_pc
    s_mov_b32 s75, 0x00020000
    s_lshr_b32 s55, s2, 3
    s_lshl_b32 s55, s55, 2
    s_add_u32 s55, s55, s42
    s_lshl_b32 s55, s55, 10
    v_lshlrev_b32 v100, 3, v254
    s_mov_b64 exec, 0xff
    buffer_load_dword v235, v100, s[72:75], s55 offen
    s_mov_b64 exec, -1
    s_cmp_lg_u32 s42, 0
    s_cbranch_scc1 xz_6
    s_getreg_b32 s59, hwreg(HW_REG_XCC_ID, 0, 4)
    s_mul_i32 s55, s59, s59
    s_lshl_b32 s55, s55, 15
    s_lshl_b32 s59, s59, 6
    s_add_u32 s59, s59, s55
    s_add_u32 s59, s59, 1
    v_mov_b32 v253, s59
    s_and_b32 s55, s2, 7
    s_lshl_b32 s55, s55, 5
    v_mov_b32 v252, 0
    s_waitcnt vmcnt(1)
    s_mov_b64 exec, 1
    buffer_atomic_add v253, v252, s[32:35], s55 offen sc1
    s_mov_b64 exec, -1
xz_6:
X_layer:
    v_lshrrev_b32 v206, 4, v254
    v_lshrrev_b32 v207, 8, v254
    v_and_b32 v208, 15, v206
    s_lshl_b32 s55, s43, 13
    s_add_u32 s55, s55, 98304
    s_cmp_lg_u32 s46, 0
    s_cbranch_scc1 g1_7
    v_and_b32 v210, 6, v208
    v_xor_b32 v210, v210, v207
    v_lshlrev_b32 v210, 4, v210
    v_lshl_add_u32 v200, v208, 7, v210
    v_xor_b32 v201, 64, v200
    s_branch g1_8
g1_7:
    v_mov_b32 v200, v254
    v_add_u32 v201, 1024, v254
g1_8:
    v_add_u32 v200, s55, v200
    v_add_u32 v201, s55, v201
    v_lshrrev_b32 v209, 6, v254
    v_lshrrev_b32 v210, 1, v209
    v_and_b32 v210, 3, v210
    s_lshl_b32 s55, s44, 1
    v_xor_b32 v210, s55, v210
    v_lshlrev_b32 v209, 7, v209
    v_lshl_add_u32 v209, v210, 5, v209
    v_and_b32 v210, 0x30, v254
    v_lshrrev_b32 v210, 1, v210
    v_add_u32 v202, v209, v210
    v_xor_b32 v203, 32, v202
    v_add_u32 v204, 49152, v202
    v_add_u32 v205, 49152, v203
    s_add_u32 s88, s1, s47
    v_lshlrev_b32 v209, 2, v207
    v_sub_u32 v209, v208, v209
    v_cmp_le_i32 s[72:73], 0, v209
    v_cmp_le_i32 s[74:75], 1, v209
    v_cmp_le_i32 s[76:77], 2, v209
    v_cmp_le_i32 s[78:79], 3, v209
    v_and_b32 v210, 1, v208
    v_cmp_eq_u32 s[80:81], 1, v210
    v_sub_u32 v209, v209, v210
    v_mov_b32 v212, 0x0c0c0c0c
    v_mov_b32 v210, 0xc0c0100
    v_mov_b32 v211, 0x1000c0c
    v_cmp_le_i32 vcc, 0, v209
    v_cndmask_b32 v210, v210, v211, s[80:81]
    s_not_b64 s[82:83], vcc
    v_cndmask_b32 v214, v210, v212, vcc
    v_cndmask_b32 v216, v212, v210, vcc
    v_mov_b32 v210, 0xc0c0302
    v_mov_b32 v211, 0x3020c0c
    v_cmp_le_i32 vcc, 2, v209
    v_cndmask_b32 v210, v210, v211, s[80:81]
    s_not_b64 s[84:85], vcc
    v_cndmask_b32 v215, v210, v212, vcc
    v_cndmask_b32 v217, v212, v210, vcc
    s_or_b32 s55, s40, s43
    s_cmp_eq_u32 s55, 0
    s_cselect_b64 s[82:83], s[82:83], 0
    s_cselect_b64 s[84:85], s[84:85], 0
    s_lshl_b32 s55, s43, 8
    s_add_u32 s55, s55, 159744
    v_lshlrev_b32 v218, 2, v208
    v_add_u32 v218, s55, v218
    v_lshlrev_b32 v219, 4, v207
    v_add_u32 v219, s55, v219
    s_lshl_b32 s55, s44, 7
    s_add_u32 s55, s55, 160896
    v_lshlrev_b32 v220, 4, v207
    v_add_u32 v220, s55, v220
    v_lshlrev_b32 v221, 2, v208
    v_add_u32 v221, s55, v221
    v_mov_b32 v222, 0x3f803f80
    v_mov_b32 v223, 0x3f803f80
    v_mov_b32 v224, 0x3f803f80
    v_mov_b32 v225, 0x3f803f80
    v_mov_b32 v213, 163712
    v_and_b32 v206, 0xf0, v254
    v_lshlrev_b32 v206, 7, v206
    v_and_b32 v210, 0x100, v254
    v_lshrrev_b32 v210, 3, v210
    v_add_u32 v206, v206, v210
    v_and_b32 v210, 0x200, v254
    v_lshrrev_b32 v210, 5, v210
    v_add_u32 v206, v206, v210
    s_lshl_b32 s92, s40, 18
    s_lshl_b32 s56, s43, 17
    s_add_u32 s92, s92, s56
    s_lshl_b32 s56, s51, 7
    s_add_u32 s92, s92, s56
    s_lshl_b32 s56, s44, 6
    s_add_u32 s92, s92, s56
    s_cmp_eq_u32 s46, 0
    s_cbranch_scc1 g1_9
    s_waitcnt vmcnt(0) lgkmcnt(0)
    s_barrier
    s_cmp_lg_u32 s42, 2
    s_cbranch_scc1 wf_10
    s_lshr_b32 s55, s2, 5
    s_lshl_b32 s55, s55, 2
    s_add_u32 s55, s55, s0
    v_mov_b32 v252, 64
    v_mov_b32 v253, 0x01010101
    s_mov_b64 exec, 1
    s_cmp_eq_u32 s45, 0
    s_cbranch_scc1 st_11
    buffer_store_dword v253, v252, s[4:7], s55 offen sc0 sc1
    s_branch st_12
st_11:
    buffer_store_dword v253, v252, s[4:7], s55 offen
st_12:
    s_mov_b64 exec, -1
wf_10:
    s_cmp_lg_u32 s42, 3
    s_cbranch_scc1 wf_13
    s_lshl_b32 s55, s51, 2
    s_add_u32 s55, s55, s54
    v_mov_b32 v252, 8192
    v_mov_b32 v253, 0x01010101
    s_mov_b64 exec, 1
    buffer_store_dword v253, v252, s[4:7], s55 offen sc0 sc1
    s_mov_b64 exec, -1
wf_13:
    s_cmp_lg_u32 s42, 0
    s_cbranch_scc1 so_14
    v_add_u32 v234, 155648, v254
    ds_read_b128 v[226:229], v234
    ds_read_b128 v[230:233], v234 offset:1024
    s_lshl_b32 s55, s51, 10
    s_add_u32 s55, s55, s53
    s_waitcnt lgkmcnt(0)
    v_add_f32 v226, v226, v230
    v_add_f32 v227, v227, v231
    v_add_f32 v228, v228, v232
    v_add_f32 v229, v229, v233
    buffer_store_dwordx4 v[226:229], v254, s[4:7], s55 offen sc0 sc1
so_14:
g1_9:
    s_barrier
    ds_read_b64_tr_b16 v[152:153], v202 offset:0
    ds_read_b64_tr_b16 v[154:155], v202 offset:2048
    ds_read_b128 v[116:119], v200 offset:2048
    ds_read_b128 v[120:123], v200 offset:4096
    ds_read_b128 v[124:127], v200 offset:6144
    ds_read_b128 v[128:131], v200 offset:8192
    ds_read_b64_tr_b16 v[156:157], v203 offset:0
    ds_read_b64_tr_b16 v[158:159], v203 offset:2048
    ds_read_b64_tr_b16 v[160:161], v202 offset:4096
    ds_read_b64_tr_b16 v[162:163], v202 offset:6144
    ds_read_b128 v[112:115], v200 offset:0
    ds_read_b64_tr_b16 v[164:165], v203 offset:4096
    ds_read_b64_tr_b16 v[166:167], v203 offset:6144
    ds_read_b64_tr_b16 v[168:169], v202 offset:8192
    ds_read_b64_tr_b16 v[170:171], v202 offset:10240
    ds_read_b64_tr_b16 v[172:173], v203 offset:8192
    ds_read_b64_tr_b16 v[174:175], v203 offset:10240
    s_mov_b32 s58, 5
    s_waitcnt lgkmcnt(0)
    s_barrier
    .p2align 3
    v_mfma_f32_16x16x32_bf16 v[0:3], v[152:155], v[116:119], 0
    ds_read_b64_tr_b16 v[176:177], v202 offset:16384
    v_mfma_f32_16x16x32_bf16 v[8:11], v[152:155], v[120:123], 0
    ds_read_b64_tr_b16 v[178:179], v202 offset:18432
    v_mfma_f32_16x16x32_bf16 v[16:19], v[152:155], v[124:127], 0
    ds_read_b128 v[136:139], v201 offset:2048
    v_mfma_f32_16x16x32_bf16 v[24:27], v[152:155], v[128:131], 0
    ds_read_b128 v[140:143], v201 offset:4096
    v_mfma_f32_16x16x32_bf16 v[28:31], v[156:159], v[128:131], 0
    ds_read_b128 v[144:147], v201 offset:6144
    v_mfma_f32_16x16x32_bf16 v[20:23], v[156:159], v[124:127], 0
    v_mfma_f32_16x16x32_bf16 v[12:15], v[156:159], v[120:123], 0
    ds_read_b128 v[148:151], v201 offset:8192
    v_mfma_f32_16x16x32_bf16 v[4:7], v[156:159], v[116:119], 0
    ds_read_b64_tr_b16 v[180:181], v203 offset:16384
    v_mfma_f32_16x16x32_bf16 v[40:43], v[160:163], v[116:119], 0
    ds_read_b64_tr_b16 v[182:183], v203 offset:18432
    v_mfma_f32_16x16x32_bf16 v[48:51], v[160:163], v[120:123], 0
    ds_read_b64_tr_b16 v[184:185], v202 offset:20480
    v_mfma_f32_16x16x32_bf16 v[56:59], v[160:163], v[124:127], 0
    v_mfma_f32_16x16x32_bf16 v[64:67], v[160:163], v[128:131], 0
    ds_read_b64_tr_b16 v[186:187], v202 offset:22528
    v_mfma_f32_16x16x32_bf16 v[32:35], v[160:163], v[112:115], 0
    ds_read_b128 v[132:135], v201 offset:0
    v_mfma_f32_16x16x32_bf16 v[36:39], v[164:167], v[112:115], 0
    ds_read_b64_tr_b16 v[188:189], v203 offset:20480
    v_mfma_f32_16x16x32_bf16 v[68:71], v[164:167], v[128:131], 0
    ds_read_b64_tr_b16 v[190:191], v203 offset:22528
    v_mfma_f32_16x16x32_bf16 v[60:63], v[164:167], v[124:127], 0
    v_mfma_f32_16x16x32_bf16 v[52:55], v[164:167], v[120:123], 0
    ds_read_b64_tr_b16 v[192:193], v202 offset:24576
    v_mfma_f32_16x16x32_bf16 v[44:47], v[164:167], v[116:119], 0
    ds_read_b64_tr_b16 v[194:195], v202 offset:26624
    v_mfma_f32_16x16x32_bf16 v[72:75], v[112:115], v[168:171], 0
    ds_read_b64_tr_b16 v[196:197], v203 offset:24576
    v_mfma_f32_16x16x32_bf16 v[80:83], v[116:119], v[168:171], 0
    ds_read_b64_tr_b16 v[198:199], v203 offset:26624
    v_mfma_f32_16x16x32_bf16 v[88:91], v[120:123], v[168:171], 0
    v_mfma_f32_16x16x32_bf16 v[96:99], v[124:127], v[168:171], 0
    v_mfma_f32_16x16x32_bf16 v[104:107], v[128:131], v[168:171], 0
    v_mfma_f32_16x16x32_bf16 v[108:111], v[128:131], v[172:175], 0
    v_mfma_f32_16x16x32_bf16 v[100:103], v[124:127], v[172:175], 0
    v_mfma_f32_16x16x32_bf16 v[92:95], v[120:123], v[172:175], 0
    v_mfma_f32_16x16x32_bf16 v[84:87], v[116:119], v[172:175], 0
    v_mfma_f32_16x16x32_bf16 v[76:79], v[112:115], v[172:175], 0
    .p2align 3
loop_15:
    s_waitcnt lgkmcnt(0)
    s_barrier
    .p2align 3
    v_mfma_f32_16x16x32_bf16 v[0:3], v[176:179], v[136:139], v[0:3]
    ds_read_b64_tr_b16 v[152:153], v202 offset:32768
    v_mfma_f32_16x16x32_bf16 v[8:11], v[176:179], v[140:143], v[8:11]
    ds_read_b64_tr_b16 v[154:155], v202 offset:34816
    v_mfma_f32_16x16x32_bf16 v[16:19], v[176:179], v[144:147], v[16:19]
    ds_read_b128 v[116:119], v200 offset:20480
    v_mfma_f32_16x16x32_bf16 v[24:27], v[176:179], v[148:151], v[24:27]
    ds_read_b128 v[120:123], v200 offset:22528
    v_mfma_f32_16x16x32_bf16 v[28:31], v[180:183], v[148:151], v[28:31]
    ds_read_b128 v[124:127], v200 offset:24576
    v_mfma_f32_16x16x32_bf16 v[20:23], v[180:183], v[144:147], v[20:23]
    v_mfma_f32_16x16x32_bf16 v[12:15], v[180:183], v[140:143], v[12:15]
    ds_read_b128 v[128:131], v200 offset:26624
    v_mfma_f32_16x16x32_bf16 v[4:7], v[180:183], v[136:139], v[4:7]
    ds_read_b64_tr_b16 v[156:157], v203 offset:32768
    v_mfma_f32_16x16x32_bf16 v[40:43], v[184:187], v[136:139], v[40:43]
    ds_read_b64_tr_b16 v[158:159], v203 offset:34816
    v_mfma_f32_16x16x32_bf16 v[48:51], v[184:187], v[140:143], v[48:51]
    ds_read_b64_tr_b16 v[160:161], v202 offset:36864
    v_mfma_f32_16x16x32_bf16 v[56:59], v[184:187], v[144:147], v[56:59]
    v_mfma_f32_16x16x32_bf16 v[64:67], v[184:187], v[148:151], v[64:67]
    ds_read_b64_tr_b16 v[162:163], v202 offset:38912
    v_mfma_f32_16x16x32_bf16 v[32:35], v[184:187], v[132:135], v[32:35]
    ds_read_b128 v[112:115], v200 offset:18432
    v_mfma_f32_16x16x32_bf16 v[36:39], v[188:191], v[132:135], v[36:39]
    ds_read_b64_tr_b16 v[164:165], v203 offset:36864
    v_mfma_f32_16x16x32_bf16 v[68:71], v[188:191], v[148:151], v[68:71]
    ds_read_b64_tr_b16 v[166:167], v203 offset:38912
    v_mfma_f32_16x16x32_bf16 v[60:63], v[188:191], v[144:147], v[60:63]
    v_mfma_f32_16x16x32_bf16 v[52:55], v[188:191], v[140:143], v[52:55]
    ds_read_b64_tr_b16 v[168:169], v202 offset:40960
    v_mfma_f32_16x16x32_bf16 v[44:47], v[188:191], v[136:139], v[44:47]
    ds_read_b64_tr_b16 v[170:171], v202 offset:43008
    v_mfma_f32_16x16x32_bf16 v[72:75], v[132:135], v[192:195], v[72:75]
    ds_read_b64_tr_b16 v[172:173], v203 offset:40960
    v_mfma_f32_16x16x32_bf16 v[80:83], v[136:139], v[192:195], v[80:83]
    ds_read_b64_tr_b16 v[174:175], v203 offset:43008
    v_mfma_f32_16x16x32_bf16 v[88:91], v[140:143], v[192:195], v[88:91]
    v_mfma_f32_16x16x32_bf16 v[96:99], v[144:147], v[192:195], v[96:99]
    v_mfma_f32_16x16x32_bf16 v[104:107], v[148:151], v[192:195], v[104:107]
    v_mfma_f32_16x16x32_bf16 v[108:111], v[148:151], v[196:199], v[108:111]
    v_mfma_f32_16x16x32_bf16 v[100:103], v[144:147], v[196:199], v[100:103]
    v_mfma_f32_16x16x32_bf16 v[92:95], v[140:143], v[196:199], v[92:95]
    v_mfma_f32_16x16x32_bf16 v[84:87], v[136:139], v[196:199], v[84:87]
    v_mfma_f32_16x16x32_bf16 v[76:79], v[132:135], v[196:199], v[76:79]
    s_waitcnt vmcnt(0) lgkmcnt(0)
    s_barrier
    .p2align 3
    v_mfma_f32_16x16x32_bf16 v[0:3], v[152:155], v[116:119], v[0:3]
    ds_read_b64_tr_b16 v[176:177], v204 offset:0
    v_mfma_f32_16x16x32_bf16 v[8:11], v[152:155], v[120:123], v[8:11]
    ds_read_b64_tr_b16 v[178:179], v204 offset:2048
    v_mfma_f32_16x16x32_bf16 v[16:19], v[152:155], v[124:127], v[16:19]
    ds_read_b128 v[136:139], v201 offset:20480
    v_mfma_f32_16x16x32_bf16 v[24:27], v[152:155], v[128:131], v[24:27]
    ds_read_b128 v[140:143], v201 offset:22528
    v_mfma_f32_16x16x32_bf16 v[28:31], v[156:159], v[128:131], v[28:31]
    ds_read_b128 v[144:147], v201 offset:24576
    v_mfma_f32_16x16x32_bf16 v[20:23], v[156:159], v[124:127], v[20:23]
    v_mfma_f32_16x16x32_bf16 v[12:15], v[156:159], v[120:123], v[12:15]
    ds_read_b128 v[148:151], v201 offset:26624
    v_mfma_f32_16x16x32_bf16 v[4:7], v[156:159], v[116:119], v[4:7]
    ds_read_b64_tr_b16 v[180:181], v205 offset:0
    v_mfma_f32_16x16x32_bf16 v[40:43], v[160:163], v[116:119], v[40:43]
    ds_read_b64_tr_b16 v[182:183], v205 offset:2048
    v_mfma_f32_16x16x32_bf16 v[48:51], v[160:163], v[120:123], v[48:51]
    ds_read_b64_tr_b16 v[184:185], v204 offset:4096
    v_mfma_f32_16x16x32_bf16 v[56:59], v[160:163], v[124:127], v[56:59]
    v_mfma_f32_16x16x32_bf16 v[64:67], v[160:163], v[128:131], v[64:67]
    ds_read_b64_tr_b16 v[186:187], v204 offset:6144
    v_mfma_f32_16x16x32_bf16 v[32:35], v[160:163], v[112:115], v[32:35]
    ds_read_b128 v[132:135], v201 offset:18432
    v_mfma_f32_16x16x32_bf16 v[36:39], v[164:167], v[112:115], v[36:39]
    ds_read_b64_tr_b16 v[188:189], v205 offset:4096
    v_mfma_f32_16x16x32_bf16 v[68:71], v[164:167], v[128:131], v[68:71]
    ds_read_b64_tr_b16 v[190:191], v205 offset:6144
    v_mfma_f32_16x16x32_bf16 v[60:63], v[164:167], v[124:127], v[60:63]
    v_mfma_f32_16x16x32_bf16 v[52:55], v[164:167], v[120:123], v[52:55]
    ds_read_b64_tr_b16 v[192:193], v204 offset:8192
    v_mfma_f32_16x16x32_bf16 v[44:47], v[164:167], v[116:119], v[44:47]
    ds_read_b64_tr_b16 v[194:195], v204 offset:10240
    v_mfma_f32_16x16x32_bf16 v[72:75], v[112:115], v[168:171], v[72:75]
    ds_read_b64_tr_b16 v[196:197], v205 offset:8192
    v_mfma_f32_16x16x32_bf16 v[80:83], v[116:119], v[168:171], v[80:83]
    ds_read_b64_tr_b16 v[198:199], v205 offset:10240
    v_mfma_f32_16x16x32_bf16 v[88:91], v[120:123], v[168:171], v[88:91]
    v_mfma_f32_16x16x32_bf16 v[96:99], v[124:127], v[168:171], v[96:99]
    v_mfma_f32_16x16x32_bf16 v[104:107], v[128:131], v[168:171], v[104:107]
    v_mfma_f32_16x16x32_bf16 v[108:111], v[128:131], v[172:175], v[108:111]
    v_mfma_f32_16x16x32_bf16 v[100:103], v[124:127], v[172:175], v[100:103]
    v_mfma_f32_16x16x32_bf16 v[92:95], v[120:123], v[172:175], v[92:95]
    v_mfma_f32_16x16x32_bf16 v[84:87], v[116:119], v[172:175], v[84:87]
    v_mfma_f32_16x16x32_bf16 v[76:79], v[112:115], v[172:175], v[76:79]
    s_waitcnt lgkmcnt(0)
    s_barrier
    .p2align 3
    v_mfma_f32_16x16x32_bf16 v[0:3], v[176:179], v[136:139], v[0:3]
    ds_read_b64_tr_b16 v[152:153], v204 offset:16384
    v_mfma_f32_16x16x32_bf16 v[8:11], v[176:179], v[140:143], v[8:11]
    ds_read_b64_tr_b16 v[154:155], v204 offset:18432
    v_mfma_f32_16x16x32_bf16 v[16:19], v[176:179], v[144:147], v[16:19]
    ds_read_b128 v[116:119], v200 offset:38912
    v_mfma_f32_16x16x32_bf16 v[24:27], v[176:179], v[148:151], v[24:27]
    ds_read_b128 v[120:123], v200 offset:40960
    v_mfma_f32_16x16x32_bf16 v[28:31], v[180:183], v[148:151], v[28:31]
    ds_read_b128 v[124:127], v200 offset:43008
    v_mfma_f32_16x16x32_bf16 v[20:23], v[180:183], v[144:147], v[20:23]
    v_mfma_f32_16x16x32_bf16 v[12:15], v[180:183], v[140:143], v[12:15]
    ds_read_b128 v[128:131], v200 offset:45056
    v_mfma_f32_16x16x32_bf16 v[4:7], v[180:183], v[136:139], v[4:7]
    ds_read_b64_tr_b16 v[156:157], v205 offset:16384
    v_mfma_f32_16x16x32_bf16 v[40:43], v[184:187], v[136:139], v[40:43]
    ds_read_b64_tr_b16 v[158:159], v205 offset:18432
    v_mfma_f32_16x16x32_bf16 v[48:51], v[184:187], v[140:143], v[48:51]
    ds_read_b64_tr_b16 v[160:161], v204 offset:20480
    v_mfma_f32_16x16x32_bf16 v[56:59], v[184:187], v[144:147], v[56:59]
    v_mfma_f32_16x16x32_bf16 v[64:67], v[184:187], v[148:151], v[64:67]
    ds_read_b64_tr_b16 v[162:163], v204 offset:22528
    v_mfma_f32_16x16x32_bf16 v[32:35], v[184:187], v[132:135], v[32:35]
    ds_read_b128 v[112:115], v200 offset:36864
    v_mfma_f32_16x16x32_bf16 v[36:39], v[188:191], v[132:135], v[36:39]
    ds_read_b64_tr_b16 v[164:165], v205 offset:20480
    v_mfma_f32_16x16x32_bf16 v[68:71], v[188:191], v[148:151], v[68:71]
    ds_read_b64_tr_b16 v[166:167], v205 offset:22528
    v_mfma_f32_16x16x32_bf16 v[60:63], v[188:191], v[144:147], v[60:63]
    v_mfma_f32_16x16x32_bf16 v[52:55], v[188:191], v[140:143], v[52:55]
    ds_read_b64_tr_b16 v[168:169], v204 offset:24576
    v_mfma_f32_16x16x32_bf16 v[44:47], v[188:191], v[136:139], v[44:47]
    ds_read_b64_tr_b16 v[170:171], v204 offset:26624
    v_mfma_f32_16x16x32_bf16 v[72:75], v[132:135], v[192:195], v[72:75]
    ds_read_b64_tr_b16 v[172:173], v205 offset:24576
    v_mfma_f32_16x16x32_bf16 v[80:83], v[136:139], v[192:195], v[80:83]
    ds_read_b64_tr_b16 v[174:175], v205 offset:26624
    v_mfma_f32_16x16x32_bf16 v[88:91], v[140:143], v[192:195], v[88:91]
    v_mfma_f32_16x16x32_bf16 v[96:99], v[144:147], v[192:195], v[96:99]
    v_mfma_f32_16x16x32_bf16 v[104:107], v[148:151], v[192:195], v[104:107]
    v_mfma_f32_16x16x32_bf16 v[108:111], v[148:151], v[196:199], v[108:111]
    v_mfma_f32_16x16x32_bf16 v[100:103], v[144:147], v[196:199], v[100:103]
    v_mfma_f32_16x16x32_bf16 v[92:95], v[140:143], v[196:199], v[92:95]
    v_mfma_f32_16x16x32_bf16 v[84:87], v[136:139], v[196:199], v[84:87]
    v_mfma_f32_16x16x32_bf16 v[76:79], v[132:135], v[196:199], v[76:79]
    s_waitcnt lgkmcnt(0)
    s_barrier
    .p2align 3
    v_mfma_f32_16x16x32_bf16 v[0:3], v[152:155], v[116:119], v[0:3]
    ds_read_b64_tr_b16 v[176:177], v204 offset:32768
    v_mfma_f32_16x16x32_bf16 v[8:11], v[152:155], v[120:123], v[8:11]
    ds_read_b64_tr_b16 v[178:179], v204 offset:34816
    v_mfma_f32_16x16x32_bf16 v[16:19], v[152:155], v[124:127], v[16:19]
    ds_read_b128 v[136:139], v201 offset:38912
    v_mfma_f32_16x16x32_bf16 v[24:27], v[152:155], v[128:131], v[24:27]
    ds_read_b128 v[140:143], v201 offset:40960
    v_mfma_f32_16x16x32_bf16 v[28:31], v[156:159], v[128:131], v[28:31]
    ds_read_b128 v[144:147], v201 offset:43008
    v_mfma_f32_16x16x32_bf16 v[20:23], v[156:159], v[124:127], v[20:23]
    v_mfma_f32_16x16x32_bf16 v[12:15], v[156:159], v[120:123], v[12:15]
    ds_read_b128 v[148:151], v201 offset:45056
    v_mfma_f32_16x16x32_bf16 v[4:7], v[156:159], v[116:119], v[4:7]
    ds_read_b64_tr_b16 v[180:181], v205 offset:32768
    v_mfma_f32_16x16x32_bf16 v[40:43], v[160:163], v[116:119], v[40:43]
    ds_read_b64_tr_b16 v[182:183], v205 offset:34816
    v_mfma_f32_16x16x32_bf16 v[48:51], v[160:163], v[120:123], v[48:51]
    ds_read_b64_tr_b16 v[184:185], v204 offset:36864
    v_mfma_f32_16x16x32_bf16 v[56:59], v[160:163], v[124:127], v[56:59]
    v_mfma_f32_16x16x32_bf16 v[64:67], v[160:163], v[128:131], v[64:67]
    ds_read_b64_tr_b16 v[186:187], v204 offset:38912
    v_mfma_f32_16x16x32_bf16 v[32:35], v[160:163], v[112:115], v[32:35]
    ds_read_b128 v[132:135], v201 offset:36864
    v_mfma_f32_16x16x32_bf16 v[36:39], v[164:167], v[112:115], v[36:39]
    ds_read_b64_tr_b16 v[188:189], v205 offset:36864
    v_mfma_f32_16x16x32_bf16 v[68:71], v[164:167], v[128:131], v[68:71]
    ds_read_b64_tr_b16 v[190:191], v205 offset:38912
    v_mfma_f32_16x16x32_bf16 v[60:63], v[164:167], v[124:127], v[60:63]
    v_mfma_f32_16x16x32_bf16 v[52:55], v[164:167], v[120:123], v[52:55]
    ds_read_b64_tr_b16 v[192:193], v204 offset:40960
    v_mfma_f32_16x16x32_bf16 v[44:47], v[164:167], v[116:119], v[44:47]
    ds_read_b64_tr_b16 v[194:195], v204 offset:43008
    v_mfma_f32_16x16x32_bf16 v[72:75], v[112:115], v[168:171], v[72:75]
    ds_read_b64_tr_b16 v[196:197], v205 offset:40960
    v_mfma_f32_16x16x32_bf16 v[80:83], v[116:119], v[168:171], v[80:83]
    ds_read_b64_tr_b16 v[198:199], v205 offset:43008
    v_mfma_f32_16x16x32_bf16 v[88:91], v[120:123], v[168:171], v[88:91]
    v_mfma_f32_16x16x32_bf16 v[96:99], v[124:127], v[168:171], v[96:99]
    v_mfma_f32_16x16x32_bf16 v[104:107], v[128:131], v[168:171], v[104:107]
    v_mfma_f32_16x16x32_bf16 v[108:111], v[128:131], v[172:175], v[108:111]
    v_mfma_f32_16x16x32_bf16 v[100:103], v[124:127], v[172:175], v[100:103]
    v_mfma_f32_16x16x32_bf16 v[92:95], v[120:123], v[172:175], v[92:95]
    v_mfma_f32_16x16x32_bf16 v[84:87], v[116:119], v[172:175], v[84:87]
    v_mfma_f32_16x16x32_bf16 v[76:79], v[112:115], v[172:175], v[76:79]
    s_waitcnt lgkmcnt(0)
    s_barrier
    .p2align 3
    v_mfma_f32_16x16x32_bf16 v[0:3], v[176:179], v[136:139], v[0:3]
    ds_read_b64_tr_b16 v[152:153], v202 offset:0
    v_mfma_f32_16x16x32_bf16 v[8:11], v[176:179], v[140:143], v[8:11]
    ds_read_b64_tr_b16 v[154:155], v202 offset:2048
    v_mfma_f32_16x16x32_bf16 v[16:19], v[176:179], v[144:147], v[16:19]
    ds_read_b128 v[116:119], v200 offset:2048
    v_mfma_f32_16x16x32_bf16 v[24:27], v[176:179], v[148:151], v[24:27]
    ds_read_b128 v[120:123], v200 offset:4096
    v_mfma_f32_16x16x32_bf16 v[28:31], v[180:183], v[148:151], v[28:31]
    ds_read_b128 v[124:127], v200 offset:6144
    v_mfma_f32_16x16x32_bf16 v[20:23], v[180:183], v[144:147], v[20:23]
    v_mfma_f32_16x16x32_bf16 v[12:15], v[180:183], v[140:143], v[12:15]
    ds_read_b128 v[128:131], v200 offset:8192
    v_mfma_f32_16x16x32_bf16 v[4:7], v[180:183], v[136:139], v[4:7]
    ds_read_b64_tr_b16 v[156:157], v203 offset:0
    v_mfma_f32_16x16x32_bf16 v[40:43], v[184:187], v[136:139], v[40:43]
    ds_read_b64_tr_b16 v[158:159], v203 offset:2048
    v_mfma_f32_16x16x32_bf16 v[48:51], v[184:187], v[140:143], v[48:51]
    ds_read_b64_tr_b16 v[160:161], v202 offset:4096
    v_mfma_f32_16x16x32_bf16 v[56:59], v[184:187], v[144:147], v[56:59]
    v_mfma_f32_16x16x32_bf16 v[64:67], v[184:187], v[148:151], v[64:67]
    ds_read_b64_tr_b16 v[162:163], v202 offset:6144
    v_mfma_f32_16x16x32_bf16 v[32:35], v[184:187], v[132:135], v[32:35]
    ds_read_b128 v[112:115], v200 offset:0
    v_mfma_f32_16x16x32_bf16 v[36:39], v[188:191], v[132:135], v[36:39]
    ds_read_b64_tr_b16 v[164:165], v203 offset:4096
    v_mfma_f32_16x16x32_bf16 v[68:71], v[188:191], v[148:151], v[68:71]
    ds_read_b64_tr_b16 v[166:167], v203 offset:6144
    v_mfma_f32_16x16x32_bf16 v[60:63], v[188:191], v[144:147], v[60:63]
    v_mfma_f32_16x16x32_bf16 v[52:55], v[188:191], v[140:143], v[52:55]
    ds_read_b64_tr_b16 v[168:169], v202 offset:8192
    v_mfma_f32_16x16x32_bf16 v[44:47], v[188:191], v[136:139], v[44:47]
    ds_read_b64_tr_b16 v[170:171], v202 offset:10240
    v_mfma_f32_16x16x32_bf16 v[72:75], v[132:135], v[192:195], v[72:75]
    ds_read_b64_tr_b16 v[172:173], v203 offset:8192
    v_mfma_f32_16x16x32_bf16 v[80:83], v[136:139], v[192:195], v[80:83]
    ds_read_b64_tr_b16 v[174:175], v203 offset:10240
    v_mfma_f32_16x16x32_bf16 v[88:91], v[140:143], v[192:195], v[88:91]
    v_mfma_f32_16x16x32_bf16 v[96:99], v[144:147], v[192:195], v[96:99]
    v_mfma_f32_16x16x32_bf16 v[104:107], v[148:151], v[192:195], v[104:107]
    v_mfma_f32_16x16x32_bf16 v[108:111], v[148:151], v[196:199], v[108:111]
    v_mfma_f32_16x16x32_bf16 v[100:103], v[144:147], v[196:199], v[100:103]
    v_mfma_f32_16x16x32_bf16 v[92:95], v[140:143], v[196:199], v[92:95]
    v_mfma_f32_16x16x32_bf16 v[84:87], v[136:139], v[196:199], v[84:87]
    v_mfma_f32_16x16x32_bf16 v[76:79], v[132:135], v[196:199], v[76:79]
    s_waitcnt lgkmcnt(0)
    s_barrier
    .p2align 3
    v_mfma_f32_16x16x32_bf16 v[0:3], v[152:155], v[116:119], v[0:3]
    ds_read_b64_tr_b16 v[176:177], v202 offset:16384
    v_mfma_f32_16x16x32_bf16 v[8:11], v[152:155], v[120:123], v[8:11]
    ds_read_b64_tr_b16 v[178:179], v202 offset:18432
    v_mfma_f32_16x16x32_bf16 v[16:19], v[152:155], v[124:127], v[16:19]
    ds_read_b128 v[136:139], v201 offset:2048
    v_mfma_f32_16x16x32_bf16 v[24:27], v[152:155], v[128:131], v[24:27]
    ds_read_b128 v[140:143], v201 offset:4096
    v_mfma_f32_16x16x32_bf16 v[28:31], v[156:159], v[128:131], v[28:31]
    ds_read_b128 v[144:147], v201 offset:6144
    v_mfma_f32_16x16x32_bf16 v[20:23], v[156:159], v[124:127], v[20:23]
    v_mfma_f32_16x16x32_bf16 v[12:15], v[156:159], v[120:123], v[12:15]
    ds_read_b128 v[148:151], v201 offset:8192
    v_mfma_f32_16x16x32_bf16 v[4:7], v[156:159], v[116:119], v[4:7]
    ds_read_b64_tr_b16 v[180:181], v203 offset:16384
    v_mfma_f32_16x16x32_bf16 v[40:43], v[160:163], v[116:119], v[40:43]
    ds_read_b64_tr_b16 v[182:183], v203 offset:18432
    v_mfma_f32_16x16x32_bf16 v[48:51], v[160:163], v[120:123], v[48:51]
    ds_read_b64_tr_b16 v[184:185], v202 offset:20480
    v_mfma_f32_16x16x32_bf16 v[56:59], v[160:163], v[124:127], v[56:59]
    v_mfma_f32_16x16x32_bf16 v[64:67], v[160:163], v[128:131], v[64:67]
    ds_read_b64_tr_b16 v[186:187], v202 offset:22528
    v_mfma_f32_16x16x32_bf16 v[32:35], v[160:163], v[112:115], v[32:35]
    ds_read_b128 v[132:135], v201 offset:0
    v_mfma_f32_16x16x32_bf16 v[36:39], v[164:167], v[112:115], v[36:39]
    ds_read_b64_tr_b16 v[188:189], v203 offset:20480
    v_mfma_f32_16x16x32_bf16 v[68:71], v[164:167], v[128:131], v[68:71]
    ds_read_b64_tr_b16 v[190:191], v203 offset:22528
    v_mfma_f32_16x16x32_bf16 v[60:63], v[164:167], v[124:127], v[60:63]
    v_mfma_f32_16x16x32_bf16 v[52:55], v[164:167], v[120:123], v[52:55]
    ds_read_b64_tr_b16 v[192:193], v202 offset:24576
    v_mfma_f32_16x16x32_bf16 v[44:47], v[164:167], v[116:119], v[44:47]
    ds_read_b64_tr_b16 v[194:195], v202 offset:26624
    v_mfma_f32_16x16x32_bf16 v[72:75], v[112:115], v[168:171], v[72:75]
    ds_read_b64_tr_b16 v[196:197], v203 offset:24576
    v_mfma_f32_16x16x32_bf16 v[80:83], v[116:119], v[168:171], v[80:83]
    ds_read_b64_tr_b16 v[198:199], v203 offset:26624
    v_mfma_f32_16x16x32_bf16 v[88:91], v[120:123], v[168:171], v[88:91]
    v_mfma_f32_16x16x32_bf16 v[96:99], v[124:127], v[168:171], v[96:99]
    v_mfma_f32_16x16x32_bf16 v[104:107], v[128:131], v[168:171], v[104:107]
    v_mfma_f32_16x16x32_bf16 v[108:111], v[128:131], v[172:175], v[108:111]
    v_mfma_f32_16x16x32_bf16 v[100:103], v[124:127], v[172:175], v[100:103]
    s_sub_u32 s58, s58, 1
    s_cmp_lg_u32 s58, 0
    .p2align 3
    v_mfma_f32_16x16x32_bf16 v[92:95], v[120:123], v[172:175], v[92:95]
    v_mfma_f32_16x16x32_bf16 v[84:87], v[116:119], v[172:175], v[84:87]
    v_mfma_f32_16x16x32_bf16 v[76:79], v[112:115], v[172:175], v[76:79]
    s_cbranch_scc1 loop_15
    s_waitcnt lgkmcnt(0)
    s_barrier
    .p2align 3
    v_mfma_f32_16x16x32_bf16 v[0:3], v[176:179], v[136:139], v[0:3]
    ds_read_b128 v[152:155], v220 offset:0
    v_mfma_f32_16x16x32_bf16 v[8:11], v[176:179], v[140:143], v[8:11]
    ds_read_b128 v[156:159], v220 offset:64
    v_mfma_f32_16x16x32_bf16 v[16:19], v[176:179], v[144:147], v[16:19]
    ds_read_b128 v[160:163], v220 offset:256
    v_mfma_f32_16x16x32_bf16 v[24:27], v[176:179], v[148:151], v[24:27]
    ds_read_b128 v[164:167], v220 offset:320
    v_mfma_f32_16x16x32_bf16 v[28:31], v[180:183], v[148:151], v[28:31]
    ds_read_b32 v112, v218 offset:0
    v_mfma_f32_16x16x32_bf16 v[20:23], v[180:183], v[144:147], v[20:23]
    v_mfma_f32_16x16x32_bf16 v[12:15], v[180:183], v[140:143], v[12:15]
    ds_read_b32 v113, v218 offset:64
    v_mfma_f32_16x16x32_bf16 v[4:7], v[180:183], v[136:139], v[4:7]
    ds_read_b32 v114, v218 offset:128
    v_mfma_f32_16x16x32_bf16 v[40:43], v[184:187], v[136:139], v[40:43]
    ds_read_b32 v115, v218 offset:192
    v_mfma_f32_16x16x32_bf16 v[48:51], v[184:187], v[140:143], v[48:51]
    ds_read_b32 v116, v218 offset:256
    v_mfma_f32_16x16x32_bf16 v[56:59], v[184:187], v[144:147], v[56:59]
    v_mfma_f32_16x16x32_bf16 v[64:67], v[184:187], v[148:151], v[64:67]
    ds_read_b32 v118, v218 offset:576
    v_mfma_f32_16x16x32_bf16 v[32:35], v[184:187], v[132:135], v[32:35]
    ds_read_b32 v119, v218 offset:640
    v_mfma_f32_16x16x32_bf16 v[36:39], v[188:191], v[132:135], v[36:39]
    ds_read_b32 v120, v218 offset:704
    v_mfma_f32_16x16x32_bf16 v[68:71], v[188:191], v[148:151], v[68:71]
    ds_read_b32 v121, v218 offset:768
    v_mfma_f32_16x16x32_bf16 v[60:63], v[188:191], v[144:147], v[60:63]
    v_mfma_f32_16x16x32_bf16 v[52:55], v[188:191], v[140:143], v[52:55]
    ds_read_b32 v122, v218 offset:832
    v_mfma_f32_16x16x32_bf16 v[44:47], v[188:191], v[136:139], v[44:47]
    ds_read_b32 v168, v221 offset:512
    v_mfma_f32_16x16x32_bf16 v[72:75], v[132:135], v[192:195], v[72:75]
    ds_read_b32 v169, v221 offset:576
    v_mfma_f32_16x16x32_bf16 v[80:83], v[136:139], v[192:195], v[80:83]
    ds_read_b32 v170, v213
    v_mfma_f32_16x16x32_bf16 v[88:91], v[140:143], v[192:195], v[88:91]
    v_mfma_f32_16x16x32_bf16 v[96:99], v[144:147], v[192:195], v[96:99]
    v_mfma_f32_16x16x32_bf16 v[104:107], v[148:151], v[192:195], v[104:107]
    v_mfma_f32_16x16x32_bf16 v[108:111], v[148:151], v[196:199], v[108:111]
    v_mfma_f32_16x16x32_bf16 v[100:103], v[144:147], v[196:199], v[100:103]
    v_mfma_f32_16x16x32_bf16 v[92:95], v[140:143], v[196:199], v[92:95]
    s_cmp_lg_u32 s46, 0
    s_cbranch_scc1 g1_16
    buffer_load_dwordx4 v[236:239], v206, s[24:27], s92 offen
    s_add_u32 s92, s92, 32768
    buffer_load_dwordx4 v[240:243], v206, s[24:27], s92 offen
    s_add_u32 s92, s92, 32768
    buffer_load_dwordx4 v[244:247], v206, s[24:27], s92 offen
    s_add_u32 s92, s92, 32768
    buffer_load_dwordx4 v[248:251], v206, s[24:27], s92 offen
    s_add_u32 s92, s92, 32768
g1_16:
    .p2align 3
    v_mfma_f32_16x16x32_bf16 v[84:87], v[136:139], v[196:199], v[84:87]
    v_mfma_f32_16x16x32_bf16 v[76:79], v[132:135], v[196:199], v[76:79]
    s_waitcnt lgkmcnt(0)
    .p2align 3
    ds_read_b128 v[132:135], v219 offset:0
    ds_read_b128 v[176:179], v219 offset:576
    ds_read_b128 v[136:139], v219 offset:64
    ds_read_b128 v[180:183], v219 offset:640
    ds_read_b128 v[140:143], v219 offset:128
    ds_read_b128 v[184:187], v219 offset:704
    ds_read_b128 v[144:147], v219 offset:192
    ds_read_b128 v[188:191], v219 offset:768
    ds_read_b128 v[148:151], v219 offset:256
    ds_read_b128 v[192:195], v219 offset:832
    v_pk_fma_f32 v[0:1], v[112:113], v[152:153], v[0:1] op_sel:[1,0,0] op_sel_hi:[1,1,1]
    v_pk_fma_f32 v[2:3], v[112:113], v[154:155], v[2:3] op_sel:[1,0,0] op_sel_hi:[1,1,1]
    v_pk_fma_f32 v[4:5], v[112:113], v[156:157], v[4:5] op_sel:[1,0,0] op_sel_hi:[1,1,1]
    v_pk_fma_f32 v[6:7], v[112:113], v[158:159], v[6:7] op_sel:[1,0,0] op_sel_hi:[1,1,1]
    v_pk_fma_f32 v[8:9], v[114:115], v[152:153], v[8:9] op_sel:[0,0,0] op_sel_hi:[0,1,1]
    v_pk_fma_f32 v[10:11], v[114:115], v[154:155], v[10:11] op_sel:[0,0,0] op_sel_hi:[0,1,1]
    v_pk_fma_f32 v[12:13], v[114:115], v[156:157], v[12:13] op_sel:[0,0,0] op_sel_hi:[0,1,1]
    v_pk_fma_f32 v[14:15], v[114:115], v[158:159], v[14:15] op_sel:[0,0,0] op_sel_hi:[0,1,1]
    v_pk_fma_f32 v[16:17], v[114:115], v[152:153], v[16:17] op_sel:[1,0,0] op_sel_hi:[1,1,1]
    v_pk_fma_f32 v[18:19], v[114:115], v[154:155], v[18:19] op_sel:[1,0,0] op_sel_hi:[1,1,1]
    v_pk_fma_f32 v[20:21], v[114:115], v[156:157], v[20:21] op_sel:[1,0,0] op_sel_hi:[1,1,1]
    v_pk_fma_f32 v[22:23], v[114:115], v[158:159], v[22:23] op_sel:[1,0,0] op_sel_hi:[1,1,1]
    v_pk_fma_f32 v[24:25], v[116:117], v[152:153], v[24:25] op_sel:[0,0,0] op_sel_hi:[0,1,1]
    v_pk_fma_f32 v[26:27], v[116:117], v[154:155], v[26:27] op_sel:[0,0,0] op_sel_hi:[0,1,1]
    v_pk_fma_f32 v[28:29], v[116:117], v[156:157], v[28:29] op_sel:[0,0,0] op_sel_hi:[0,1,1]
    v_pk_fma_f32 v[30:31], v[116:117], v[158:159], v[30:31] op_sel:[0,0,0] op_sel_hi:[0,1,1]
    v_pk_fma_f32 v[32:33], v[112:113], v[160:161], v[32:33] op_sel:[0,0,0] op_sel_hi:[0,1,1]
    v_pk_fma_f32 v[34:35], v[112:113], v[162:163], v[34:35] op_sel:[0,0,0] op_sel_hi:[0,1,1]
    v_pk_fma_f32 v[36:37], v[112:113], v[164:165], v[36:37] op_sel:[0,0,0] op_sel_hi:[0,1,1]
    v_pk_fma_f32 v[38:39], v[112:113], v[166:167], v[38:39] op_sel:[0,0,0] op_sel_hi:[0,1,1]
    v_pk_fma_f32 v[40:41], v[112:113], v[160:161], v[40:41] op_sel:[1,0,0] op_sel_hi:[1,1,1]
    v_pk_fma_f32 v[42:43], v[112:113], v[162:163], v[42:43] op_sel:[1,0,0] op_sel_hi:[1,1,1]
    v_pk_fma_f32 v[44:45], v[112:113], v[164:165], v[44:45] op_sel:[1,0,0] op_sel_hi:[1,1,1]
    v_pk_fma_f32 v[46:47], v[112:113], v[166:167], v[46:47] op_sel:[1,0,0] op_sel_hi:[1,1,1]
    v_pk_fma_f32 v[48:49], v[114:115], v[160:161], v[48:49] op_sel:[0,0,0] op_sel_hi:[0,1,1]
    v_pk_fma_f32 v[50:51], v[114:115], v[162:163], v[50:51] op_sel:[0,0,0] op_sel_hi:[0,1,1]
    v_pk_fma_f32 v[52:53], v[114:115], v[164:165], v[52:53] op_sel:[0,0,0] op_sel_hi:[0,1,1]
    v_pk_fma_f32 v[54:55], v[114:115], v[166:167], v[54:55] op_sel:[0,0,0] op_sel_hi:[0,1,1]
    v_pk_fma_f32 v[56:57], v[114:115], v[160:161], v[56:57] op_sel:[1,0,0] op_sel_hi:[1,1,1]
    v_pk_fma_f32 v[58:59], v[114:115], v[162:163], v[58:59] op_sel:[1,0,0] op_sel_hi:[1,1,1]
    v_pk_fma_f32 v[60:61], v[114:115], v[164:165], v[60:61] op_sel:[1,0,0] op_sel_hi:[1,1,1]
    v_pk_fma_f32 v[62:63], v[114:115], v[166:167], v[62:63] op_sel:[1,0,0] op_sel_hi:[1,1,1]
    v_pk_fma_f32 v[64:65], v[116:117], v[160:161], v[64:65] op_sel:[0,0,0] op_sel_hi:[0,1,1]
    v_pk_fma_f32 v[66:67], v[116:117], v[162:163], v[66:67] op_sel:[0,0,0] op_sel_hi:[0,1,1]
    v_pk_fma_f32 v[68:69], v[116:117], v[164:165], v[68:69] op_sel:[0,0,0] op_sel_hi:[0,1,1]
    v_pk_fma_f32 v[70:71], v[116:117], v[166:167], v[70:71] op_sel:[0,0,0] op_sel_hi:[0,1,1]
    v_cvt_pk_bf16_f32 v0, v0, v1
    v_cvt_pk_bf16_f32 v1, v2, v3
    v_cvt_pk_bf16_f32 v2, v4, v5
    v_cvt_pk_bf16_f32 v3, v6, v7
    v_cvt_pk_bf16_f32 v8, v8, v9
    v_cvt_pk_bf16_f32 v9, v10, v11
    v_cvt_pk_bf16_f32 v10, v12, v13
    v_cvt_pk_bf16_f32 v11, v14, v15
    v_cvt_pk_bf16_f32 v16, v16, v17
    v_cvt_pk_bf16_f32 v17, v18, v19
    v_cvt_pk_bf16_f32 v18, v20, v21
    v_cvt_pk_bf16_f32 v19, v22, v23
    v_cvt_pk_bf16_f32 v24, v24, v25
    v_cvt_pk_bf16_f32 v25, v26, v27
    v_cvt_pk_bf16_f32 v26, v28, v29
    v_cvt_pk_bf16_f32 v27, v30, v31
    v_pk_mul_f32 v[32:33], v[118:119], v[32:33] op_sel:[0,0] op_sel_hi:[0,1]
    v_pk_mul_f32 v[34:35], v[118:119], v[34:35] op_sel:[0,0] op_sel_hi:[0,1]
    v_pk_mul_f32 v[36:37], v[118:119], v[36:37] op_sel:[0,0] op_sel_hi:[0,1]
    v_pk_mul_f32 v[38:39], v[118:119], v[38:39] op_sel:[0,0] op_sel_hi:[0,1]
    v_pk_mul_f32 v[40:41], v[118:119], v[40:41] op_sel:[1,0] op_sel_hi:[1,1]
    v_pk_mul_f32 v[42:43], v[118:119], v[42:43] op_sel:[1,0] op_sel_hi:[1,1]
    v_pk_mul_f32 v[44:45], v[118:119], v[44:45] op_sel:[1,0] op_sel_hi:[1,1]
    v_pk_mul_f32 v[46:47], v[118:119], v[46:47] op_sel:[1,0] op_sel_hi:[1,1]
    v_pk_mul_f32 v[48:49], v[120:121], v[48:49] op_sel:[0,0] op_sel_hi:[0,1]
    v_pk_mul_f32 v[50:51], v[120:121], v[50:51] op_sel:[0,0] op_sel_hi:[0,1]
    v_pk_mul_f32 v[52:53], v[120:121], v[52:53] op_sel:[0,0] op_sel_hi:[0,1]
    v_pk_mul_f32 v[54:55], v[120:121], v[54:55] op_sel:[0,0] op_sel_hi:[0,1]
    v_pk_mul_f32 v[56:57], v[120:121], v[56:57] op_sel:[1,0] op_sel_hi:[1,1]
    v_pk_mul_f32 v[58:59], v[120:121], v[58:59] op_sel:[1,0] op_sel_hi:[1,1]
    v_pk_mul_f32 v[60:61], v[120:121], v[60:61] op_sel:[1,0] op_sel_hi:[1,1]
    v_pk_mul_f32 v[62:63], v[120:121], v[62:63] op_sel:[1,0] op_sel_hi:[1,1]
    v_pk_mul_f32 v[64:65], v[122:123], v[64:65] op_sel:[0,0] op_sel_hi:[0,1]
    v_pk_mul_f32 v[66:67], v[122:123], v[66:67] op_sel:[0,0] op_sel_hi:[0,1]
    v_pk_mul_f32 v[68:69], v[122:123], v[68:69] op_sel:[0,0] op_sel_hi:[0,1]
    v_pk_mul_f32 v[70:71], v[122:123], v[70:71] op_sel:[0,0] op_sel_hi:[0,1]
    v_cvt_pk_bf16_f32 v32, v32, v33
    v_cvt_pk_bf16_f32 v33, v34, v35
    v_cvt_pk_bf16_f32 v34, v36, v37
    v_cvt_pk_bf16_f32 v35, v38, v39
    v_cvt_pk_bf16_f32 v40, v40, v41
    v_cvt_pk_bf16_f32 v41, v42, v43
    v_cvt_pk_bf16_f32 v42, v44, v45
    v_cvt_pk_bf16_f32 v43, v46, v47
    v_cvt_pk_bf16_f32 v48, v48, v49
    v_cvt_pk_bf16_f32 v49, v50, v51
    v_cvt_pk_bf16_f32 v50, v52, v53
    v_cvt_pk_bf16_f32 v51, v54, v55
    v_cvt_pk_bf16_f32 v56, v56, v57
    v_cvt_pk_bf16_f32 v57, v58, v59
    v_cvt_pk_bf16_f32 v58, v60, v61
    v_cvt_pk_bf16_f32 v59, v62, v63
    v_cvt_pk_bf16_f32 v64, v64, v65
    v_cvt_pk_bf16_f32 v65, v66, v67
    v_cvt_pk_bf16_f32 v66, v68, v69
    v_cvt_pk_bf16_f32 v67, v70, v71
    v_readfirstlane_b32 s45, v170
    s_waitcnt lgkmcnt(0)
    v_mfma_f32_16x16x32_bf16 v[4:7], v[40:43], v[0:3], 0
    v_mfma_f32_16x16x32_bf16 v[44:47], v[32:35], v[0:3], 0
    v_mfma_f32_16x16x32_bf16 v[12:15], v[48:51], v[8:11], 0
    v_mfma_f32_16x16x32_bf16 v[52:55], v[40:43], v[8:11], 0
    v_mfma_f32_16x16x32_bf16 v[20:23], v[56:59], v[16:19], 0
    v_mfma_f32_16x16x32_bf16 v[60:63], v[48:51], v[16:19], 0
    v_mfma_f32_16x16x32_bf16 v[28:31], v[64:67], v[24:27], 0
    v_mfma_f32_16x16x32_bf16 v[68:71], v[56:59], v[24:27], 0
    v_pk_fma_f32 v[72:73], v[132:133], v[168:169], v[72:73] op_sel:[0,0,0] op_sel_hi:[1,0,1]
    v_pk_fma_f32 v[74:75], v[134:135], v[168:169], v[74:75] op_sel:[0,0,0] op_sel_hi:[1,0,1]
    v_pk_fma_f32 v[76:77], v[132:133], v[168:169], v[76:77] op_sel:[0,1,0] op_sel_hi:[1,1,1]
    v_pk_fma_f32 v[78:79], v[134:135], v[168:169], v[78:79] op_sel:[0,1,0] op_sel_hi:[1,1,1]
    v_pk_fma_f32 v[80:81], v[136:137], v[168:169], v[80:81] op_sel:[0,0,0] op_sel_hi:[1,0,1]
    v_pk_fma_f32 v[82:83], v[138:139], v[168:169], v[82:83] op_sel:[0,0,0] op_sel_hi:[1,0,1]
    v_pk_fma_f32 v[84:85], v[136:137], v[168:169], v[84:85] op_sel:[0,1,0] op_sel_hi:[1,1,1]
    v_pk_fma_f32 v[86:87], v[138:139], v[168:169], v[86:87] op_sel:[0,1,0] op_sel_hi:[1,1,1]
    v_pk_fma_f32 v[88:89], v[140:141], v[168:169], v[88:89] op_sel:[0,0,0] op_sel_hi:[1,0,1]
    v_pk_fma_f32 v[90:91], v[142:143], v[168:169], v[90:91] op_sel:[0,0,0] op_sel_hi:[1,0,1]
    v_pk_fma_f32 v[92:93], v[140:141], v[168:169], v[92:93] op_sel:[0,1,0] op_sel_hi:[1,1,1]
    v_pk_fma_f32 v[94:95], v[142:143], v[168:169], v[94:95] op_sel:[0,1,0] op_sel_hi:[1,1,1]
    v_pk_fma_f32 v[96:97], v[144:145], v[168:169], v[96:97] op_sel:[0,0,0] op_sel_hi:[1,0,1]
    v_pk_fma_f32 v[98:99], v[146:147], v[168:169], v[98:99] op_sel:[0,0,0] op_sel_hi:[1,0,1]
    v_pk_fma_f32 v[100:101], v[144:145], v[168:169], v[100:101] op_sel:[0,1,0] op_sel_hi:[1,1,1]
    v_pk_fma_f32 v[102:103], v[146:147], v[168:169], v[102:103] op_sel:[0,1,0] op_sel_hi:[1,1,1]
    v_pk_fma_f32 v[104:105], v[148:149], v[168:169], v[104:105] op_sel:[0,0,0] op_sel_hi:[1,0,1]
    v_pk_fma_f32 v[106:107], v[150:151], v[168:169], v[106:107] op_sel:[0,0,0] op_sel_hi:[1,0,1]
    v_pk_fma_f32 v[108:109], v[148:149], v[168:169], v[108:109] op_sel:[0,1,0] op_sel_hi:[1,1,1]
    v_pk_fma_f32 v[110:111], v[150:151], v[168:169], v[110:111] op_sel:[0,1,0] op_sel_hi:[1,1,1]
    v_cndmask_b32 v44, v44, v4, s[72:73]
    v_cndmask_b32 v45, v45, v5, s[74:75]
    v_cndmask_b32 v46, v46, v6, s[76:77]
    v_cndmask_b32 v47, v47, v7, s[78:79]
    v_cndmask_b32 v52, v52, v12, s[72:73]
    v_cndmask_b32 v53, v53, v13, s[74:75]
    v_cndmask_b32 v54, v54, v14, s[76:77]
    v_cndmask_b32 v55, v55, v15, s[78:79]
    v_cndmask_b32 v60, v60, v20, s[72:73]
    v_cndmask_b32 v61, v61, v21, s[74:75]
    v_cndmask_b32 v62, v62, v22, s[76:77]
    v_cndmask_b32 v63, v63, v23, s[78:79]
    v_cndmask_b32 v68, v68, v28, s[72:73]
    v_cndmask_b32 v69, v69, v29, s[74:75]
    v_cndmask_b32 v70, v70, v30, s[76:77]
    v_cndmask_b32 v71, v71, v31, s[78:79]
    v_cndmask_b32 v44, v44, v45, s[80:81]
    v_cndmask_b32 v45, v46, v47, s[80:81]
    v_cndmask_b32 v52, v52, v53, s[80:81]
    v_cndmask_b32 v53, v54, v55, s[80:81]
    v_cndmask_b32 v60, v60, v61, s[80:81]
    v_cndmask_b32 v61, v62, v63, s[80:81]
    v_cndmask_b32 v68, v68, v69, s[80:81]
    v_cndmask_b32 v69, v70, v71, s[80:81]
    v_mov_b32 v209, 0xf149f2ca
    v_cndmask_b32 v44, v44, v209, s[82:83]
    v_cndmask_b32 v45, v45, v209, s[84:85]
    v_max_f32 v46, v44, v45
    v_max_f32 v54, v52, v53
    v_max_f32 v62, v60, v61
    v_max_f32 v70, v68, v69
    v_pk_mul_f32 v[72:73], v[176:177], v[72:73] op_sel:[0,0] op_sel_hi:[1,1]
    v_pk_mul_f32 v[74:75], v[178:179], v[74:75] op_sel:[0,0] op_sel_hi:[1,1]
    v_permlane32_swap_b32 v46, v62
    v_permlane32_swap_b32 v54, v70
    v_max_f32 v46, v46, v62
    v_max_f32 v54, v54, v70
    v_pk_mul_f32 v[76:77], v[176:177], v[76:77] op_sel:[0,0] op_sel_hi:[1,1]
    v_pk_mul_f32 v[78:79], v[178:179], v[78:79] op_sel:[0,0] op_sel_hi:[1,1]
    v_permlane16_swap_b32 v46, v54
    v_max_f32 v46, v46, v54
    v_mov_b32 v54, v46
    v_pk_mul_f32 v[80:81], v[180:181], v[80:81] op_sel:[0,0] op_sel_hi:[1,1]
    v_pk_mul_f32 v[82:83], v[182:183], v[82:83] op_sel:[0,0] op_sel_hi:[1,1]
    v_permlane16_swap_b32 v46, v54
    v_mov_b32 v62, v46
    v_mov_b32 v70, v54
    v_pk_mul_f32 v[84:85], v[180:181], v[84:85] op_sel:[0,0] op_sel_hi:[1,1]
    v_pk_mul_f32 v[86:87], v[182:183], v[86:87] op_sel:[0,0] op_sel_hi:[1,1]
    v_permlane32_swap_b32 v46, v62
    v_permlane32_swap_b32 v54, v70
    v_mul_f32 v119, 0x3e8293ee, v119
    v_mul_f32 v120, 0x3e8293ee, v120
    v_mul_f32 v121, 0x3e8293ee, v121
    v_mul_f32 v122, 0x3e8293ee, v122
    v_sub_f32 v44, v44, v46
    v_sub_f32 v45, v45, v46
    v_sub_f32 v52, v52, v54
    v_sub_f32 v53, v53, v54
    v_sub_f32 v60, v60, v62
    v_sub_f32 v61, v61, v62
    v_sub_f32 v68, v68, v70
    v_sub_f32 v69, v69, v70
    v_mul_f32 v44, v119, v44
    v_mul_f32 v45, v119, v45
    v_mul_f32 v52, v120, v52
    v_mul_f32 v53, v120, v53
    v_mul_f32 v60, v121, v60
    v_mul_f32 v61, v121, v61
    v_mul_f32 v68, v122, v68
    v_mul_f32 v69, v122, v69
    v_exp_f32 v44, v44
    v_exp_f32 v45, v45
    v_exp_f32 v52, v52
    v_exp_f32 v53, v53
    v_exp_f32 v60, v60
    v_exp_f32 v61, v61
    v_exp_f32 v68, v68
    v_exp_f32 v69, v69
    .p2align 3
    v_pk_mul_f32 v[88:89], v[184:185], v[88:89] op_sel:[0,0] op_sel_hi:[1,1]
    v_pk_mul_f32 v[90:91], v[186:187], v[90:91] op_sel:[0,0] op_sel_hi:[1,1]
    v_pk_mul_f32 v[92:93], v[184:185], v[92:93] op_sel:[0,0] op_sel_hi:[1,1]
    v_pk_mul_f32 v[94:95], v[186:187], v[94:95] op_sel:[0,0] op_sel_hi:[1,1]
    v_pk_mul_f32 v[96:97], v[188:189], v[96:97] op_sel:[0,0] op_sel_hi:[1,1]
    v_pk_mul_f32 v[98:99], v[190:191], v[98:99] op_sel:[0,0] op_sel_hi:[1,1]
    v_pk_mul_f32 v[100:101], v[188:189], v[100:101] op_sel:[0,0] op_sel_hi:[1,1]
    v_pk_mul_f32 v[102:103], v[190:191], v[102:103] op_sel:[0,0] op_sel_hi:[1,1]
    v_pk_mul_f32 v[104:105], v[192:193], v[104:105] op_sel:[0,0] op_sel_hi:[1,1]
    v_pk_mul_f32 v[106:107], v[194:195], v[106:107] op_sel:[0,0] op_sel_hi:[1,1]
    v_pk_mul_f32 v[108:109], v[192:193], v[108:109] op_sel:[0,0] op_sel_hi:[1,1]
    v_pk_mul_f32 v[110:111], v[194:195], v[110:111] op_sel:[0,0] op_sel_hi:[1,1]
    v_cvt_pk_bf16_f32 v44, v44, v45
    v_cvt_pk_bf16_f32 v52, v52, v53
    v_cvt_pk_bf16_f32 v60, v60, v61
    v_cvt_pk_bf16_f32 v68, v68, v69
    v_cvt_pk_bf16_f32 v226, v72, v73
    v_cvt_pk_bf16_f32 v227, v74, v75
    v_cvt_pk_bf16_f32 v152, v76, v77
    v_cvt_pk_bf16_f32 v153, v78, v79
    v_cvt_pk_bf16_f32 v228, v80, v81
    v_cvt_pk_bf16_f32 v229, v82, v83
    v_cvt_pk_bf16_f32 v154, v84, v85
    v_cvt_pk_bf16_f32 v155, v86, v87
    v_cvt_pk_bf16_f32 v230, v88, v89
    v_cvt_pk_bf16_f32 v231, v90, v91
    v_cvt_pk_bf16_f32 v156, v92, v93
    v_cvt_pk_bf16_f32 v157, v94, v95
    v_cvt_pk_bf16_f32 v232, v96, v97
    v_cvt_pk_bf16_f32 v233, v98, v99
    v_cvt_pk_bf16_f32 v158, v100, v101
    v_cvt_pk_bf16_f32 v159, v102, v103
    v_cvt_pk_bf16_f32 v234, v104, v105
    v_cvt_pk_bf16_f32 v235, v106, v107
    v_cvt_pk_bf16_f32 v160, v108, v109
    v_cvt_pk_bf16_f32 v161, v110, v111
    v_perm_b32 v4, v44, v44, v214
    v_perm_b32 v5, v44, v44, v215
    v_perm_b32 v6, v44, v44, v216
    v_perm_b32 v7, v44, v44, v217
    v_perm_b32 v12, v52, v52, v214
    v_perm_b32 v13, v52, v52, v215
    v_perm_b32 v14, v52, v52, v216
    v_perm_b32 v15, v52, v52, v217
    v_perm_b32 v20, v60, v60, v214
    v_perm_b32 v21, v60, v60, v215
    v_perm_b32 v22, v60, v60, v216
    v_perm_b32 v23, v60, v60, v217
    v_perm_b32 v28, v68, v68, v214
    v_perm_b32 v29, v68, v68, v215
    v_perm_b32 v30, v68, v68, v216
    v_perm_b32 v31, v68, v68, v217
    s_add_u32 s55, s88, 4096
    v_mfma_f32_16x16x32_bf16 v[0:3], v[222:225], v[4:7], 0
    v_mfma_f32_16x16x32_bf16 v[8:11], v[222:225], v[12:15], 0
    v_mfma_f32_16x16x32_bf16 v[16:19], v[222:225], v[20:23], 0
    v_mfma_f32_16x16x32_bf16 v[24:27], v[222:225], v[28:31], 0
    v_mfma_f32_16x16x32_bf16 v[72:75], v[226:229], v[4:7], 0
    v_mfma_f32_16x16x32_bf16 v[76:79], v[152:155], v[4:7], 0
    v_mfma_f32_16x16x32_bf16 v[80:83], v[228:231], v[12:15], 0
    v_mfma_f32_16x16x32_bf16 v[84:87], v[154:157], v[12:15], 0
    v_mfma_f32_16x16x32_bf16 v[88:91], v[230:233], v[20:23], 0
    v_mfma_f32_16x16x32_bf16 v[92:95], v[156:159], v[20:23], 0
    v_mfma_f32_16x16x32_bf16 v[96:99], v[232:235], v[28:31], 0
    v_mfma_f32_16x16x32_bf16 v[100:103], v[158:161], v[28:31], 0
    v_rcp_f32 v0, v0
    v_rcp_f32 v8, v8
    v_rcp_f32 v16, v16
    v_rcp_f32 v24, v24
    v_pk_mul_f32 v[72:73], v[0:1], v[72:73] op_sel:[0,0] op_sel_hi:[0,1]
    v_pk_mul_f32 v[74:75], v[0:1], v[74:75] op_sel:[0,0] op_sel_hi:[0,1]
    v_pk_mul_f32 v[76:77], v[0:1], v[76:77] op_sel:[0,0] op_sel_hi:[0,1]
    v_pk_mul_f32 v[78:79], v[0:1], v[78:79] op_sel:[0,0] op_sel_hi:[0,1]
    v_cvt_pk_bf16_f32 v72, v72, v73
    v_cvt_pk_bf16_f32 v73, v74, v75
    v_cvt_pk_bf16_f32 v74, v76, v77
    v_cvt_pk_bf16_f32 v75, v78, v79
    buffer_store_dwordx4 v[72:75], v254, s[4:7], s88 offen offset:0 sc0 sc1
    v_pk_mul_f32 v[80:81], v[8:9], v[80:81] op_sel:[0,0] op_sel_hi:[0,1]
    v_pk_mul_f32 v[82:83], v[8:9], v[82:83] op_sel:[0,0] op_sel_hi:[0,1]
    v_pk_mul_f32 v[84:85], v[8:9], v[84:85] op_sel:[0,0] op_sel_hi:[0,1]
    v_pk_mul_f32 v[86:87], v[8:9], v[86:87] op_sel:[0,0] op_sel_hi:[0,1]
    v_cvt_pk_bf16_f32 v80, v80, v81
    v_cvt_pk_bf16_f32 v81, v82, v83
    v_cvt_pk_bf16_f32 v82, v84, v85
    v_cvt_pk_bf16_f32 v83, v86, v87
    buffer_store_dwordx4 v[80:83], v254, s[4:7], s88 offen offset:2048 sc0 sc1
    v_pk_mul_f32 v[88:89], v[16:17], v[88:89] op_sel:[0,0] op_sel_hi:[0,1]
    v_pk_mul_f32 v[90:91], v[16:17], v[90:91] op_sel:[0,0] op_sel_hi:[0,1]
    v_pk_mul_f32 v[92:93], v[16:17], v[92:93] op_sel:[0,0] op_sel_hi:[0,1]
    v_pk_mul_f32 v[94:95], v[16:17], v[94:95] op_sel:[0,0] op_sel_hi:[0,1]
    v_cvt_pk_bf16_f32 v88, v88, v89
    v_cvt_pk_bf16_f32 v89, v90, v91
    v_cvt_pk_bf16_f32 v90, v92, v93
    v_cvt_pk_bf16_f32 v91, v94, v95
    buffer_store_dwordx4 v[88:91], v254, s[4:7], s55 offen offset:0 sc0 sc1
    s_nop 1
    v_pk_mul_f32 v[96:97], v[24:25], v[96:97] op_sel:[0,0] op_sel_hi:[0,1]
    v_pk_mul_f32 v[98:99], v[24:25], v[98:99] op_sel:[0,0] op_sel_hi:[0,1]
    v_pk_mul_f32 v[100:101], v[24:25], v[100:101] op_sel:[0,0] op_sel_hi:[0,1]
    v_pk_mul_f32 v[102:103], v[24:25], v[102:103] op_sel:[0,0] op_sel_hi:[0,1]
    v_cvt_pk_bf16_f32 v96, v96, v97
    v_cvt_pk_bf16_f32 v97, v98, v99
    v_cvt_pk_bf16_f32 v98, v100, v101
    v_cvt_pk_bf16_f32 v99, v102, v103
    buffer_store_dwordx4 v[96:99], v254, s[4:7], s55 offen offset:2048 sc0 sc1
    s_lshl_b32 s55, s43, 13
    s_add_u32 s55, s55, 98304
    v_add_u32 v136, s55, v254
    v_lshrrev_b32 v152, 6, v254
    v_lshrrev_b32 v153, 1, v152
    v_and_b32 v153, 3, v153
    s_lshl_b32 s55, s44, 1
    v_xor_b32 v153, s55, v153
    v_lshlrev_b32 v152, 7, v152
    v_lshl_add_u32 v152, v153, 5, v152
    v_and_b32 v153, 0x30, v254
    v_lshrrev_b32 v153, 1, v153
    v_add_u32 v137, v152, v153
    v_xor_b32 v138, 32, v137
    v_add_u32 v139, 49152, v137
    v_add_u32 v140, 49152, v138
    s_cmp_lg_u32 s46, 0
    s_cbranch_scc1 g2_17
    s_waitcnt vmcnt(4)
    v_permlane16_swap_b32 v236, v238
    v_permlane16_swap_b32 v237, v239
    v_permlane16_swap_b32 v240, v242
    v_permlane16_swap_b32 v241, v243
    v_permlane16_swap_b32 v244, v246
    v_permlane16_swap_b32 v245, v247
    v_permlane16_swap_b32 v248, v250
    v_permlane16_swap_b32 v249, v251
g2_17:
    v_lshlrev_b32 v0, 16, v236
    v_and_b32 v1, 0xffff0000, v236
    v_lshlrev_b32 v2, 16, v237
    v_and_b32 v3, 0xffff0000, v237
    v_lshlrev_b32 v16, 16, v238
    v_and_b32 v17, 0xffff0000, v238
    v_lshlrev_b32 v18, 16, v239
    v_and_b32 v19, 0xffff0000, v239
    v_lshlrev_b32 v4, 16, v240
    v_and_b32 v5, 0xffff0000, v240
    v_lshlrev_b32 v6, 16, v241
    v_and_b32 v7, 0xffff0000, v241
    v_lshlrev_b32 v20, 16, v242
    v_and_b32 v21, 0xffff0000, v242
    v_lshlrev_b32 v22, 16, v243
    v_and_b32 v23, 0xffff0000, v243
    v_lshlrev_b32 v8, 16, v244
    v_and_b32 v9, 0xffff0000, v244
    v_lshlrev_b32 v10, 16, v245
    v_and_b32 v11, 0xffff0000, v245
    v_lshlrev_b32 v24, 16, v246
    v_and_b32 v25, 0xffff0000, v246
    v_lshlrev_b32 v26, 16, v247
    v_and_b32 v27, 0xffff0000, v247
    v_lshlrev_b32 v12, 16, v248
    v_and_b32 v13, 0xffff0000, v248
    v_lshlrev_b32 v14, 16, v249
    v_and_b32 v15, 0xffff0000, v249
    v_lshlrev_b32 v28, 16, v250
    v_and_b32 v29, 0xffff0000, v250
    v_lshlrev_b32 v30, 16, v251
    v_and_b32 v31, 0xffff0000, v251
    s_waitcnt vmcnt(0)
    s_barrier
    s_cmp_lg_u32 s42, 2
    s_cbranch_scc1 wf_18
    s_lshr_b32 s55, s2, 5
    s_lshl_b32 s55, s55, 2
    s_add_u32 s55, s55, s0
    v_mov_b32 v252, 0
    v_mov_b32 v253, 0x01010101
    s_mov_b64 exec, 1
    s_cmp_eq_u32 s45, 0
    s_cbranch_scc1 st_19
    buffer_store_dword v253, v252, s[4:7], s55 offen sc0 sc1
    s_branch st_20
st_19:
    buffer_store_dword v253, v252, s[4:7], s55 offen
st_20:
    s_mov_b64 exec, -1
wf_18:
    s_cmp_lg_u32 s42, 3
    s_cbranch_scc1 wf_21
    s_lshl_b32 s55, s51, 2
    s_add_u32 s55, s55, s54
    v_mov_b32 v252, 0
    v_mov_b32 v253, 0x01010101
    s_mov_b64 exec, 1
    buffer_store_dword v253, v252, s[4:7], s55 offen sc0 sc1
    s_mov_b64 exec, -1
wf_21:
    s_barrier
    ds_read_b64_tr_b16 v[104:105], v137 offset:32768
    ds_read_b64_tr_b16 v[106:107], v137 offset:34816
    ds_read_b128 v[32:35], v136 offset:0
    ds_read_b128 v[36:39], v136 offset:2048
    ds_read_b128 v[40:43], v136 offset:4096
    ds_read_b128 v[44:47], v136 offset:6144
    ds_read_b64_tr_b16 v[108:109], v138 offset:32768
    ds_read_b64_tr_b16 v[110:111], v138 offset:34816
    ds_read_b64_tr_b16 v[112:113], v137 offset:36864
    ds_read_b64_tr_b16 v[114:115], v137 offset:38912
    ds_read_b128 v[48:51], v136 offset:1024
    ds_read_b128 v[52:55], v136 offset:3072
    ds_read_b128 v[56:59], v136 offset:5120
    ds_read_b128 v[60:63], v136 offset:7168
    ds_read_b64_tr_b16 v[116:117], v138 offset:36864
    ds_read_b64_tr_b16 v[118:119], v138 offset:38912
    s_waitcnt lgkmcnt(0)
    s_barrier
    .p2align 3
    v_mfma_f32_16x16x32_bf16 v[0:3], v[104:107], v[32:35], v[0:3]
    ds_read_b64_tr_b16 v[120:121], v137 offset:40960
    ds_read_b64_tr_b16 v[122:123], v137 offset:43008
    v_mfma_f32_16x16x32_bf16 v[0:3], v[112:115], v[48:51], v[0:3]
    ds_read_b128 v[64:67], v136 offset:16384
    v_mfma_f32_16x16x32_bf16 v[4:7], v[112:115], v[52:55], v[4:7]
    ds_read_b128 v[68:71], v136 offset:18432
    v_mfma_f32_16x16x32_bf16 v[4:7], v[104:107], v[36:39], v[4:7]
    ds_read_b128 v[72:75], v136 offset:20480
    ds_read_b128 v[76:79], v136 offset:22528
    v_mfma_f32_16x16x32_bf16 v[8:11], v[104:107], v[40:43], v[8:11]
    ds_read_b64_tr_b16 v[124:125], v138 offset:40960
    v_mfma_f32_16x16x32_bf16 v[8:11], v[112:115], v[56:59], v[8:11]
    ds_read_b64_tr_b16 v[126:127], v138 offset:43008
    v_mfma_f32_16x16x32_bf16 v[12:15], v[112:115], v[60:63], v[12:15]
    ds_read_b64_tr_b16 v[128:129], v137 offset:45056
    ds_read_b64_tr_b16 v[130:131], v137 offset:47104
    v_mfma_f32_16x16x32_bf16 v[12:15], v[104:107], v[44:47], v[12:15]
    ds_read_b128 v[80:83], v136 offset:17408
    v_mfma_f32_16x16x32_bf16 v[28:31], v[108:111], v[44:47], v[28:31]
    ds_read_b128 v[84:87], v136 offset:19456
    v_mfma_f32_16x16x32_bf16 v[28:31], v[116:119], v[60:63], v[28:31]
    ds_read_b128 v[88:91], v136 offset:21504
    ds_read_b128 v[92:95], v136 offset:23552
    v_mfma_f32_16x16x32_bf16 v[24:27], v[116:119], v[56:59], v[24:27]
    ds_read_b64_tr_b16 v[132:133], v138 offset:45056
    v_mfma_f32_16x16x32_bf16 v[24:27], v[108:111], v[40:43], v[24:27]
    ds_read_b64_tr_b16 v[134:135], v138 offset:47104
    v_mfma_f32_16x16x32_bf16 v[20:23], v[108:111], v[36:39], v[20:23]
    v_mfma_f32_16x16x32_bf16 v[20:23], v[116:119], v[52:55], v[20:23]
    v_mfma_f32_16x16x32_bf16 v[16:19], v[116:119], v[48:51], v[16:19]
    v_mfma_f32_16x16x32_bf16 v[16:19], v[108:111], v[32:35], v[16:19]
    s_waitcnt lgkmcnt(0)
    s_barrier
    .p2align 3
    v_mfma_f32_16x16x32_bf16 v[0:3], v[120:123], v[64:67], v[0:3]
    ds_read_b64_tr_b16 v[104:105], v139 offset:0
    ds_read_b64_tr_b16 v[106:107], v139 offset:2048
    v_mfma_f32_16x16x32_bf16 v[0:3], v[128:131], v[80:83], v[0:3]
    ds_read_b128 v[32:35], v136 offset:32768
    v_mfma_f32_16x16x32_bf16 v[4:7], v[128:131], v[84:87], v[4:7]
    ds_read_b128 v[36:39], v136 offset:34816
    v_mfma_f32_16x16x32_bf16 v[4:7], v[120:123], v[68:71], v[4:7]
    ds_read_b128 v[40:43], v136 offset:36864
    ds_read_b128 v[44:47], v136 offset:38912
    v_mfma_f32_16x16x32_bf16 v[8:11], v[120:123], v[72:75], v[8:11]
    ds_read_b64_tr_b16 v[108:109], v140 offset:0
    v_mfma_f32_16x16x32_bf16 v[8:11], v[128:131], v[88:91], v[8:11]
    ds_read_b64_tr_b16 v[110:111], v140 offset:2048
    v_mfma_f32_16x16x32_bf16 v[12:15], v[128:131], v[92:95], v[12:15]
    ds_read_b64_tr_b16 v[112:113], v139 offset:4096
    ds_read_b64_tr_b16 v[114:115], v139 offset:6144
    v_mfma_f32_16x16x32_bf16 v[12:15], v[120:123], v[76:79], v[12:15]
    ds_read_b128 v[48:51], v136 offset:33792
    v_mfma_f32_16x16x32_bf16 v[28:31], v[124:127], v[76:79], v[28:31]
    ds_read_b128 v[52:55], v136 offset:35840
    v_mfma_f32_16x16x32_bf16 v[28:31], v[132:135], v[92:95], v[28:31]
    ds_read_b128 v[56:59], v136 offset:37888
    ds_read_b128 v[60:63], v136 offset:39936
    v_mfma_f32_16x16x32_bf16 v[24:27], v[132:135], v[88:91], v[24:27]
    ds_read_b64_tr_b16 v[116:117], v140 offset:4096
    v_mfma_f32_16x16x32_bf16 v[24:27], v[124:127], v[72:75], v[24:27]
    ds_read_b64_tr_b16 v[118:119], v140 offset:6144
    v_mfma_f32_16x16x32_bf16 v[20:23], v[124:127], v[68:71], v[20:23]
    v_mfma_f32_16x16x32_bf16 v[20:23], v[132:135], v[84:87], v[20:23]
    v_mfma_f32_16x16x32_bf16 v[16:19], v[132:135], v[80:83], v[16:19]
    v_mfma_f32_16x16x32_bf16 v[16:19], v[124:127], v[64:67], v[16:19]
    s_waitcnt lgkmcnt(0)
    s_barrier
    .p2align 3
    v_mfma_f32_16x16x32_bf16 v[0:3], v[104:107], v[32:35], v[0:3]
    ds_read_b64_tr_b16 v[120:121], v139 offset:8192
    ds_read_b64_tr_b16 v[122:123], v139 offset:10240
    v_mfma_f32_16x16x32_bf16 v[0:3], v[112:115], v[48:51], v[0:3]
    ds_read_b128 v[64:67], v136 offset:0
    v_mfma_f32_16x16x32_bf16 v[4:7], v[112:115], v[52:55], v[4:7]
    ds_read_b128 v[68:71], v136 offset:2048
    v_mfma_f32_16x16x32_bf16 v[4:7], v[104:107], v[36:39], v[4:7]
    ds_read_b128 v[72:75], v136 offset:4096
    ds_read_b128 v[76:79], v136 offset:6144
    v_mfma_f32_16x16x32_bf16 v[8:11], v[104:107], v[40:43], v[8:11]
    ds_read_b64_tr_b16 v[124:125], v140 offset:8192
    v_mfma_f32_16x16x32_bf16 v[8:11], v[112:115], v[56:59], v[8:11]
    ds_read_b64_tr_b16 v[126:127], v140 offset:10240
    v_mfma_f32_16x16x32_bf16 v[12:15], v[112:115], v[60:63], v[12:15]
    ds_read_b64_tr_b16 v[128:129], v139 offset:12288
    ds_read_b64_tr_b16 v[130:131], v139 offset:14336
    v_mfma_f32_16x16x32_bf16 v[12:15], v[104:107], v[44:47], v[12:15]
    ds_read_b128 v[80:83], v136 offset:1024
    v_mfma_f32_16x16x32_bf16 v[28:31], v[108:111], v[44:47], v[28:31]
    ds_read_b128 v[84:87], v136 offset:3072
    v_mfma_f32_16x16x32_bf16 v[28:31], v[116:119], v[60:63], v[28:31]
    ds_read_b128 v[88:91], v136 offset:5120
    ds_read_b128 v[92:95], v136 offset:7168
    v_mfma_f32_16x16x32_bf16 v[24:27], v[116:119], v[56:59], v[24:27]
    ds_read_b64_tr_b16 v[132:133], v140 offset:12288
    v_mfma_f32_16x16x32_bf16 v[24:27], v[108:111], v[40:43], v[24:27]
    ds_read_b64_tr_b16 v[134:135], v140 offset:14336
    v_mfma_f32_16x16x32_bf16 v[20:23], v[108:111], v[36:39], v[20:23]
    v_mfma_f32_16x16x32_bf16 v[20:23], v[116:119], v[52:55], v[20:23]
    v_mfma_f32_16x16x32_bf16 v[16:19], v[116:119], v[48:51], v[16:19]
    v_mfma_f32_16x16x32_bf16 v[16:19], v[108:111], v[32:35], v[16:19]
    s_waitcnt lgkmcnt(0)
    s_barrier
    .p2align 3
    v_mfma_f32_16x16x32_bf16 v[0:3], v[120:123], v[64:67], v[0:3]
    ds_read_b64_tr_b16 v[104:105], v139 offset:16384
    ds_read_b64_tr_b16 v[106:107], v139 offset:18432
    v_mfma_f32_16x16x32_bf16 v[0:3], v[128:131], v[80:83], v[0:3]
    ds_read_b128 v[32:35], v136 offset:16384
    v_mfma_f32_16x16x32_bf16 v[4:7], v[128:131], v[84:87], v[4:7]
    ds_read_b128 v[36:39], v136 offset:18432
    v_mfma_f32_16x16x32_bf16 v[4:7], v[120:123], v[68:71], v[4:7]
    ds_read_b128 v[40:43], v136 offset:20480
    ds_read_b128 v[44:47], v136 offset:22528
    v_mfma_f32_16x16x32_bf16 v[8:11], v[120:123], v[72:75], v[8:11]
    ds_read_b64_tr_b16 v[108:109], v140 offset:16384
    v_mfma_f32_16x16x32_bf16 v[8:11], v[128:131], v[88:91], v[8:11]
    ds_read_b64_tr_b16 v[110:111], v140 offset:18432
    v_mfma_f32_16x16x32_bf16 v[12:15], v[128:131], v[92:95], v[12:15]
    ds_read_b64_tr_b16 v[112:113], v139 offset:20480
    ds_read_b64_tr_b16 v[114:115], v139 offset:22528
    v_mfma_f32_16x16x32_bf16 v[12:15], v[120:123], v[76:79], v[12:15]
    ds_read_b128 v[48:51], v136 offset:17408
    v_mfma_f32_16x16x32_bf16 v[28:31], v[124:127], v[76:79], v[28:31]
    ds_read_b128 v[52:55], v136 offset:19456
    v_mfma_f32_16x16x32_bf16 v[28:31], v[132:135], v[92:95], v[28:31]
    ds_read_b128 v[56:59], v136 offset:21504
    ds_read_b128 v[60:63], v136 offset:23552
    v_mfma_f32_16x16x32_bf16 v[24:27], v[132:135], v[88:91], v[24:27]
    ds_read_b64_tr_b16 v[116:117], v140 offset:20480
    v_mfma_f32_16x16x32_bf16 v[24:27], v[124:127], v[72:75], v[24:27]
    ds_read_b64_tr_b16 v[118:119], v140 offset:22528
    v_mfma_f32_16x16x32_bf16 v[20:23], v[124:127], v[68:71], v[20:23]
    v_mfma_f32_16x16x32_bf16 v[20:23], v[132:135], v[84:87], v[20:23]
    v_mfma_f32_16x16x32_bf16 v[16:19], v[132:135], v[80:83], v[16:19]
    v_mfma_f32_16x16x32_bf16 v[16:19], v[124:127], v[64:67], v[16:19]
    s_waitcnt lgkmcnt(0)
    s_barrier
    .p2align 3
    v_mfma_f32_16x16x32_bf16 v[0:3], v[104:107], v[32:35], v[0:3]
    ds_read_b64_tr_b16 v[120:121], v139 offset:24576
    ds_read_b64_tr_b16 v[122:123], v139 offset:26624
    v_mfma_f32_16x16x32_bf16 v[0:3], v[112:115], v[48:51], v[0:3]
    ds_read_b128 v[64:67], v136 offset:32768
    v_mfma_f32_16x16x32_bf16 v[4:7], v[112:115], v[52:55], v[4:7]
    ds_read_b128 v[68:71], v136 offset:34816
    v_mfma_f32_16x16x32_bf16 v[4:7], v[104:107], v[36:39], v[4:7]
    ds_read_b128 v[72:75], v136 offset:36864
    ds_read_b128 v[76:79], v136 offset:38912
    v_mfma_f32_16x16x32_bf16 v[8:11], v[104:107], v[40:43], v[8:11]
    ds_read_b64_tr_b16 v[124:125], v140 offset:24576
    v_mfma_f32_16x16x32_bf16 v[8:11], v[112:115], v[56:59], v[8:11]
    ds_read_b64_tr_b16 v[126:127], v140 offset:26624
    v_mfma_f32_16x16x32_bf16 v[12:15], v[112:115], v[60:63], v[12:15]
    ds_read_b64_tr_b16 v[128:129], v139 offset:28672
    ds_read_b64_tr_b16 v[130:131], v139 offset:30720
    v_mfma_f32_16x16x32_bf16 v[12:15], v[104:107], v[44:47], v[12:15]
    ds_read_b128 v[80:83], v136 offset:33792
    v_mfma_f32_16x16x32_bf16 v[28:31], v[108:111], v[44:47], v[28:31]
    ds_read_b128 v[84:87], v136 offset:35840
    v_mfma_f32_16x16x32_bf16 v[28:31], v[116:119], v[60:63], v[28:31]
    ds_read_b128 v[88:91], v136 offset:37888
    ds_read_b128 v[92:95], v136 offset:39936
    v_mfma_f32_16x16x32_bf16 v[24:27], v[116:119], v[56:59], v[24:27]
    ds_read_b64_tr_b16 v[132:133], v140 offset:28672
    v_mfma_f32_16x16x32_bf16 v[24:27], v[108:111], v[40:43], v[24:27]
    ds_read_b64_tr_b16 v[134:135], v140 offset:30720
    v_mfma_f32_16x16x32_bf16 v[20:23], v[108:111], v[36:39], v[20:23]
    v_mfma_f32_16x16x32_bf16 v[20:23], v[116:119], v[52:55], v[20:23]
    v_mfma_f32_16x16x32_bf16 v[16:19], v[116:119], v[48:51], v[16:19]
    v_mfma_f32_16x16x32_bf16 v[16:19], v[108:111], v[32:35], v[16:19]
    s_waitcnt lgkmcnt(0)
    s_barrier
    .p2align 3
    v_mfma_f32_16x16x32_bf16 v[0:3], v[120:123], v[64:67], v[0:3]
    ds_read_b64_tr_b16 v[104:105], v139 offset:32768
    ds_read_b64_tr_b16 v[106:107], v139 offset:34816
    v_mfma_f32_16x16x32_bf16 v[0:3], v[128:131], v[80:83], v[0:3]
    ds_read_b128 v[32:35], v136 offset:0
    v_mfma_f32_16x16x32_bf16 v[4:7], v[128:131], v[84:87], v[4:7]
    ds_read_b128 v[36:39], v136 offset:2048
    v_mfma_f32_16x16x32_bf16 v[4:7], v[120:123], v[68:71], v[4:7]
    ds_read_b128 v[40:43], v136 offset:4096
    ds_read_b128 v[44:47], v136 offset:6144
    v_mfma_f32_16x16x32_bf16 v[8:11], v[120:123], v[72:75], v[8:11]
    ds_read_b64_tr_b16 v[108:109], v140 offset:32768
    v_mfma_f32_16x16x32_bf16 v[8:11], v[128:131], v[88:91], v[8:11]
    ds_read_b64_tr_b16 v[110:111], v140 offset:34816
    v_mfma_f32_16x16x32_bf16 v[12:15], v[128:131], v[92:95], v[12:15]
    ds_read_b64_tr_b16 v[112:113], v139 offset:36864
    ds_read_b64_tr_b16 v[114:115], v139 offset:38912
    v_mfma_f32_16x16x32_bf16 v[12:15], v[120:123], v[76:79], v[12:15]
    ds_read_b128 v[48:51], v136 offset:1024
    v_mfma_f32_16x16x32_bf16 v[28:31], v[124:127], v[76:79], v[28:31]
    ds_read_b128 v[52:55], v136 offset:3072
    v_mfma_f32_16x16x32_bf16 v[28:31], v[132:135], v[92:95], v[28:31]
    ds_read_b128 v[56:59], v136 offset:5120
    ds_read_b128 v[60:63], v136 offset:7168
    v_mfma_f32_16x16x32_bf16 v[24:27], v[132:135], v[88:91], v[24:27]
    ds_read_b64_tr_b16 v[116:117], v140 offset:36864
    v_mfma_f32_16x16x32_bf16 v[24:27], v[124:127], v[72:75], v[24:27]
    ds_read_b64_tr_b16 v[118:119], v140 offset:38912
    v_mfma_f32_16x16x32_bf16 v[20:23], v[124:127], v[68:71], v[20:23]
    v_mfma_f32_16x16x32_bf16 v[20:23], v[132:135], v[84:87], v[20:23]
    v_mfma_f32_16x16x32_bf16 v[16:19], v[132:135], v[80:83], v[16:19]
    v_mfma_f32_16x16x32_bf16 v[16:19], v[124:127], v[64:67], v[16:19]
    s_waitcnt lgkmcnt(0)
    s_barrier
    .p2align 3
    v_mfma_f32_16x16x32_bf16 v[0:3], v[104:107], v[32:35], v[0:3]
    ds_read_b64_tr_b16 v[120:121], v139 offset:40960
    ds_read_b64_tr_b16 v[122:123], v139 offset:43008
    v_mfma_f32_16x16x32_bf16 v[0:3], v[112:115], v[48:51], v[0:3]
    ds_read_b128 v[64:67], v136 offset:16384
    v_mfma_f32_16x16x32_bf16 v[4:7], v[112:115], v[52:55], v[4:7]
    ds_read_b128 v[68:71], v136 offset:18432
    v_mfma_f32_16x16x32_bf16 v[4:7], v[104:107], v[36:39], v[4:7]
    ds_read_b128 v[72:75], v136 offset:20480
    ds_read_b128 v[76:79], v136 offset:22528
    v_mfma_f32_16x16x32_bf16 v[8:11], v[104:107], v[40:43], v[8:11]
    ds_read_b64_tr_b16 v[124:125], v140 offset:40960
    v_mfma_f32_16x16x32_bf16 v[8:11], v[112:115], v[56:59], v[8:11]
    ds_read_b64_tr_b16 v[126:127], v140 offset:43008
    v_mfma_f32_16x16x32_bf16 v[12:15], v[112:115], v[60:63], v[12:15]
    ds_read_b64_tr_b16 v[128:129], v139 offset:45056
    ds_read_b64_tr_b16 v[130:131], v139 offset:47104
    v_mfma_f32_16x16x32_bf16 v[12:15], v[104:107], v[44:47], v[12:15]
    ds_read_b128 v[80:83], v136 offset:17408
    v_mfma_f32_16x16x32_bf16 v[28:31], v[108:111], v[44:47], v[28:31]
    ds_read_b128 v[84:87], v136 offset:19456
    v_mfma_f32_16x16x32_bf16 v[28:31], v[116:119], v[60:63], v[28:31]
    ds_read_b128 v[88:91], v136 offset:21504
    ds_read_b128 v[92:95], v136 offset:23552
    v_mfma_f32_16x16x32_bf16 v[24:27], v[116:119], v[56:59], v[24:27]
    ds_read_b64_tr_b16 v[132:133], v140 offset:45056
    v_mfma_f32_16x16x32_bf16 v[24:27], v[108:111], v[40:43], v[24:27]
    ds_read_b64_tr_b16 v[134:135], v140 offset:47104
    v_mfma_f32_16x16x32_bf16 v[20:23], v[108:111], v[36:39], v[20:23]
    v_mfma_f32_16x16x32_bf16 v[20:23], v[116:119], v[52:55], v[20:23]
    v_mfma_f32_16x16x32_bf16 v[16:19], v[116:119], v[48:51], v[16:19]
    v_mfma_f32_16x16x32_bf16 v[16:19], v[108:111], v[32:35], v[16:19]
    s_waitcnt lgkmcnt(0)
    s_barrier
    .p2align 3
    v_mfma_f32_16x16x32_bf16 v[0:3], v[120:123], v[64:67], v[0:3]
    ds_read_b64_tr_b16 v[104:105], v137 offset:0
    ds_read_b64_tr_b16 v[106:107], v137 offset:2048
    v_mfma_f32_16x16x32_bf16 v[0:3], v[128:131], v[80:83], v[0:3]
    ds_read_b128 v[32:35], v136 offset:32768
    v_mfma_f32_16x16x32_bf16 v[4:7], v[128:131], v[84:87], v[4:7]
    ds_read_b128 v[36:39], v136 offset:34816
    v_mfma_f32_16x16x32_bf16 v[4:7], v[120:123], v[68:71], v[4:7]
    ds_read_b128 v[40:43], v136 offset:36864
    ds_read_b128 v[44:47], v136 offset:38912
    v_mfma_f32_16x16x32_bf16 v[8:11], v[120:123], v[72:75], v[8:11]
    ds_read_b64_tr_b16 v[108:109], v138 offset:0
    v_mfma_f32_16x16x32_bf16 v[8:11], v[128:131], v[88:91], v[8:11]
    ds_read_b64_tr_b16 v[110:111], v138 offset:2048
    v_mfma_f32_16x16x32_bf16 v[12:15], v[128:131], v[92:95], v[12:15]
    ds_read_b64_tr_b16 v[112:113], v137 offset:4096
    ds_read_b64_tr_b16 v[114:115], v137 offset:6144
    v_mfma_f32_16x16x32_bf16 v[12:15], v[120:123], v[76:79], v[12:15]
    ds_read_b128 v[48:51], v136 offset:33792
    v_mfma_f32_16x16x32_bf16 v[28:31], v[124:127], v[76:79], v[28:31]
    ds_read_b128 v[52:55], v136 offset:35840
    v_mfma_f32_16x16x32_bf16 v[28:31], v[132:135], v[92:95], v[28:31]
    ds_read_b128 v[56:59], v136 offset:37888
    ds_read_b128 v[60:63], v136 offset:39936
    v_mfma_f32_16x16x32_bf16 v[24:27], v[132:135], v[88:91], v[24:27]
    ds_read_b64_tr_b16 v[116:117], v138 offset:4096
    v_mfma_f32_16x16x32_bf16 v[24:27], v[124:127], v[72:75], v[24:27]
    ds_read_b64_tr_b16 v[118:119], v138 offset:6144
    v_mfma_f32_16x16x32_bf16 v[20:23], v[124:127], v[68:71], v[20:23]
    v_mfma_f32_16x16x32_bf16 v[20:23], v[132:135], v[84:87], v[20:23]
    v_mfma_f32_16x16x32_bf16 v[16:19], v[132:135], v[80:83], v[16:19]
    v_mfma_f32_16x16x32_bf16 v[16:19], v[124:127], v[64:67], v[16:19]
    s_waitcnt lgkmcnt(0)
    s_barrier
    .p2align 3
    v_mfma_f32_16x16x32_bf16 v[0:3], v[104:107], v[32:35], v[0:3]
    ds_read_b64_tr_b16 v[120:121], v137 offset:8192
    ds_read_b64_tr_b16 v[122:123], v137 offset:10240
    v_mfma_f32_16x16x32_bf16 v[0:3], v[112:115], v[48:51], v[0:3]
    ds_read_b128 v[64:67], v136 offset:0
    v_mfma_f32_16x16x32_bf16 v[4:7], v[112:115], v[52:55], v[4:7]
    ds_read_b128 v[68:71], v136 offset:2048
    v_mfma_f32_16x16x32_bf16 v[4:7], v[104:107], v[36:39], v[4:7]
    ds_read_b128 v[72:75], v136 offset:4096
    ds_read_b128 v[76:79], v136 offset:6144
    v_mfma_f32_16x16x32_bf16 v[8:11], v[104:107], v[40:43], v[8:11]
    ds_read_b64_tr_b16 v[124:125], v138 offset:8192
    v_mfma_f32_16x16x32_bf16 v[8:11], v[112:115], v[56:59], v[8:11]
    ds_read_b64_tr_b16 v[126:127], v138 offset:10240
    v_mfma_f32_16x16x32_bf16 v[12:15], v[112:115], v[60:63], v[12:15]
    ds_read_b64_tr_b16 v[128:129], v137 offset:12288
    ds_read_b64_tr_b16 v[130:131], v137 offset:14336
    v_mfma_f32_16x16x32_bf16 v[12:15], v[104:107], v[44:47], v[12:15]
    ds_read_b128 v[80:83], v136 offset:1024
    v_mfma_f32_16x16x32_bf16 v[28:31], v[108:111], v[44:47], v[28:31]
    ds_read_b128 v[84:87], v136 offset:3072
    v_mfma_f32_16x16x32_bf16 v[28:31], v[116:119], v[60:63], v[28:31]
    ds_read_b128 v[88:91], v136 offset:5120
    ds_read_b128 v[92:95], v136 offset:7168
    v_mfma_f32_16x16x32_bf16 v[24:27], v[116:119], v[56:59], v[24:27]
    ds_read_b64_tr_b16 v[132:133], v138 offset:12288
    v_mfma_f32_16x16x32_bf16 v[24:27], v[108:111], v[40:43], v[24:27]
    ds_read_b64_tr_b16 v[134:135], v138 offset:14336
    v_mfma_f32_16x16x32_bf16 v[20:23], v[108:111], v[36:39], v[20:23]
    v_mfma_f32_16x16x32_bf16 v[20:23], v[116:119], v[52:55], v[20:23]
    v_mfma_f32_16x16x32_bf16 v[16:19], v[116:119], v[48:51], v[16:19]
    v_mfma_f32_16x16x32_bf16 v[16:19], v[108:111], v[32:35], v[16:19]
    s_waitcnt lgkmcnt(0)
    s_barrier
    .p2align 3
    v_mfma_f32_16x16x32_bf16 v[0:3], v[120:123], v[64:67], v[0:3]
    ds_read_b64_tr_b16 v[104:105], v137 offset:16384
    ds_read_b64_tr_b16 v[106:107], v137 offset:18432
    v_mfma_f32_16x16x32_bf16 v[0:3], v[128:131], v[80:83], v[0:3]
    ds_read_b128 v[32:35], v136 offset:16384
    v_mfma_f32_16x16x32_bf16 v[4:7], v[128:131], v[84:87], v[4:7]
    ds_read_b128 v[36:39], v136 offset:18432
    v_mfma_f32_16x16x32_bf16 v[4:7], v[120:123], v[68:71], v[4:7]
    ds_read_b128 v[40:43], v136 offset:20480
    ds_read_b128 v[44:47], v136 offset:22528
    v_mfma_f32_16x16x32_bf16 v[8:11], v[120:123], v[72:75], v[8:11]
    ds_read_b64_tr_b16 v[108:109], v138 offset:16384
    v_mfma_f32_16x16x32_bf16 v[8:11], v[128:131], v[88:91], v[8:11]
    ds_read_b64_tr_b16 v[110:111], v138 offset:18432
    v_mfma_f32_16x16x32_bf16 v[12:15], v[128:131], v[92:95], v[12:15]
    ds_read_b64_tr_b16 v[112:113], v137 offset:20480
    ds_read_b64_tr_b16 v[114:115], v137 offset:22528
    v_mfma_f32_16x16x32_bf16 v[12:15], v[120:123], v[76:79], v[12:15]
    ds_read_b128 v[48:51], v136 offset:17408
    v_mfma_f32_16x16x32_bf16 v[28:31], v[124:127], v[76:79], v[28:31]
    ds_read_b128 v[52:55], v136 offset:19456
    v_mfma_f32_16x16x32_bf16 v[28:31], v[132:135], v[92:95], v[28:31]
    ds_read_b128 v[56:59], v136 offset:21504
    ds_read_b128 v[60:63], v136 offset:23552
    v_mfma_f32_16x16x32_bf16 v[24:27], v[132:135], v[88:91], v[24:27]
    ds_read_b64_tr_b16 v[116:117], v138 offset:20480
    v_mfma_f32_16x16x32_bf16 v[24:27], v[124:127], v[72:75], v[24:27]
    ds_read_b64_tr_b16 v[118:119], v138 offset:22528
    v_mfma_f32_16x16x32_bf16 v[20:23], v[124:127], v[68:71], v[20:23]
    v_mfma_f32_16x16x32_bf16 v[20:23], v[132:135], v[84:87], v[20:23]
    v_mfma_f32_16x16x32_bf16 v[16:19], v[132:135], v[80:83], v[16:19]
    v_mfma_f32_16x16x32_bf16 v[16:19], v[124:127], v[64:67], v[16:19]
    s_waitcnt lgkmcnt(0)
    s_barrier
    .p2align 3
    v_mfma_f32_16x16x32_bf16 v[0:3], v[104:107], v[32:35], v[0:3]
    ds_read_b64_tr_b16 v[120:121], v137 offset:24576
    ds_read_b64_tr_b16 v[122:123], v137 offset:26624
    v_mfma_f32_16x16x32_bf16 v[0:3], v[112:115], v[48:51], v[0:3]
    ds_read_b128 v[64:67], v136 offset:32768
    v_mfma_f32_16x16x32_bf16 v[4:7], v[112:115], v[52:55], v[4:7]
    ds_read_b128 v[68:71], v136 offset:34816
    v_mfma_f32_16x16x32_bf16 v[4:7], v[104:107], v[36:39], v[4:7]
    ds_read_b128 v[72:75], v136 offset:36864
    ds_read_b128 v[76:79], v136 offset:38912
    v_mfma_f32_16x16x32_bf16 v[8:11], v[104:107], v[40:43], v[8:11]
    ds_read_b64_tr_b16 v[124:125], v138 offset:24576
    v_mfma_f32_16x16x32_bf16 v[8:11], v[112:115], v[56:59], v[8:11]
    ds_read_b64_tr_b16 v[126:127], v138 offset:26624
    v_mfma_f32_16x16x32_bf16 v[12:15], v[112:115], v[60:63], v[12:15]
    ds_read_b64_tr_b16 v[128:129], v137 offset:28672
    ds_read_b64_tr_b16 v[130:131], v137 offset:30720
    v_mfma_f32_16x16x32_bf16 v[12:15], v[104:107], v[44:47], v[12:15]
    ds_read_b128 v[80:83], v136 offset:33792
    v_mfma_f32_16x16x32_bf16 v[28:31], v[108:111], v[44:47], v[28:31]
    ds_read_b128 v[84:87], v136 offset:35840
    v_mfma_f32_16x16x32_bf16 v[28:31], v[116:119], v[60:63], v[28:31]
    ds_read_b128 v[88:91], v136 offset:37888
    ds_read_b128 v[92:95], v136 offset:39936
    v_mfma_f32_16x16x32_bf16 v[24:27], v[116:119], v[56:59], v[24:27]
    ds_read_b64_tr_b16 v[132:133], v138 offset:28672
    v_mfma_f32_16x16x32_bf16 v[24:27], v[108:111], v[40:43], v[24:27]
    ds_read_b64_tr_b16 v[134:135], v138 offset:30720
    v_mfma_f32_16x16x32_bf16 v[20:23], v[108:111], v[36:39], v[20:23]
    v_mfma_f32_16x16x32_bf16 v[20:23], v[116:119], v[52:55], v[20:23]
    v_mfma_f32_16x16x32_bf16 v[16:19], v[116:119], v[48:51], v[16:19]
    v_mfma_f32_16x16x32_bf16 v[16:19], v[108:111], v[32:35], v[16:19]
    s_waitcnt lgkmcnt(0)
    s_barrier
    .p2align 3
    v_mfma_f32_16x16x32_bf16 v[0:3], v[120:123], v[64:67], v[0:3]
    ds_read_b64_tr_b16 v[104:105], v137 offset:32768
    ds_read_b64_tr_b16 v[106:107], v137 offset:34816
    v_mfma_f32_16x16x32_bf16 v[0:3], v[128:131], v[80:83], v[0:3]
    ds_read_b128 v[32:35], v136 offset:0
    v_mfma_f32_16x16x32_bf16 v[4:7], v[128:131], v[84:87], v[4:7]
    ds_read_b128 v[36:39], v136 offset:2048
    v_mfma_f32_16x16x32_bf16 v[4:7], v[120:123], v[68:71], v[4:7]
    ds_read_b128 v[40:43], v136 offset:4096
    ds_read_b128 v[44:47], v136 offset:6144
    v_mfma_f32_16x16x32_bf16 v[8:11], v[120:123], v[72:75], v[8:11]
    ds_read_b64_tr_b16 v[108:109], v138 offset:32768
    v_mfma_f32_16x16x32_bf16 v[8:11], v[128:131], v[88:91], v[8:11]
    ds_read_b64_tr_b16 v[110:111], v138 offset:34816
    v_mfma_f32_16x16x32_bf16 v[12:15], v[128:131], v[92:95], v[12:15]
    ds_read_b64_tr_b16 v[112:113], v137 offset:36864
    ds_read_b64_tr_b16 v[114:115], v137 offset:38912
    v_mfma_f32_16x16x32_bf16 v[12:15], v[120:123], v[76:79], v[12:15]
    ds_read_b128 v[48:51], v136 offset:1024
    v_mfma_f32_16x16x32_bf16 v[28:31], v[124:127], v[76:79], v[28:31]
    ds_read_b128 v[52:55], v136 offset:3072
    v_mfma_f32_16x16x32_bf16 v[28:31], v[132:135], v[92:95], v[28:31]
    ds_read_b128 v[56:59], v136 offset:5120
    ds_read_b128 v[60:63], v136 offset:7168
    v_mfma_f32_16x16x32_bf16 v[24:27], v[132:135], v[88:91], v[24:27]
    ds_read_b64_tr_b16 v[116:117], v138 offset:36864
    v_mfma_f32_16x16x32_bf16 v[24:27], v[124:127], v[72:75], v[24:27]
    ds_read_b64_tr_b16 v[118:119], v138 offset:38912
    v_mfma_f32_16x16x32_bf16 v[20:23], v[124:127], v[68:71], v[20:23]
    v_mfma_f32_16x16x32_bf16 v[20:23], v[132:135], v[84:87], v[20:23]
    v_mfma_f32_16x16x32_bf16 v[16:19], v[132:135], v[80:83], v[16:19]
    v_mfma_f32_16x16x32_bf16 v[16:19], v[124:127], v[64:67], v[16:19]
    s_waitcnt lgkmcnt(0)
    s_barrier
    .p2align 3
    v_mfma_f32_16x16x32_bf16 v[0:3], v[104:107], v[32:35], v[0:3]
    ds_read_b64_tr_b16 v[120:121], v137 offset:40960
    ds_read_b64_tr_b16 v[122:123], v137 offset:43008
    v_mfma_f32_16x16x32_bf16 v[0:3], v[112:115], v[48:51], v[0:3]
    ds_read_b128 v[64:67], v136 offset:16384
    v_mfma_f32_16x16x32_bf16 v[4:7], v[112:115], v[52:55], v[4:7]
    ds_read_b128 v[68:71], v136 offset:18432
    v_mfma_f32_16x16x32_bf16 v[4:7], v[104:107], v[36:39], v[4:7]
    ds_read_b128 v[72:75], v136 offset:20480
    ds_read_b128 v[76:79], v136 offset:22528
    v_mfma_f32_16x16x32_bf16 v[8:11], v[104:107], v[40:43], v[8:11]
    ds_read_b64_tr_b16 v[124:125], v138 offset:40960
    v_mfma_f32_16x16x32_bf16 v[8:11], v[112:115], v[56:59], v[8:11]
    ds_read_b64_tr_b16 v[126:127], v138 offset:43008
    v_mfma_f32_16x16x32_bf16 v[12:15], v[112:115], v[60:63], v[12:15]
    ds_read_b64_tr_b16 v[128:129], v137 offset:45056
    ds_read_b64_tr_b16 v[130:131], v137 offset:47104
    v_mfma_f32_16x16x32_bf16 v[12:15], v[104:107], v[44:47], v[12:15]
    ds_read_b128 v[80:83], v136 offset:17408
    v_mfma_f32_16x16x32_bf16 v[28:31], v[108:111], v[44:47], v[28:31]
    ds_read_b128 v[84:87], v136 offset:19456
    v_mfma_f32_16x16x32_bf16 v[28:31], v[116:119], v[60:63], v[28:31]
    ds_read_b128 v[88:91], v136 offset:21504
    ds_read_b128 v[92:95], v136 offset:23552
    v_mfma_f32_16x16x32_bf16 v[24:27], v[116:119], v[56:59], v[24:27]
    ds_read_b64_tr_b16 v[132:133], v138 offset:45056
    v_mfma_f32_16x16x32_bf16 v[24:27], v[108:111], v[40:43], v[24:27]
    ds_read_b64_tr_b16 v[134:135], v138 offset:47104
    v_mfma_f32_16x16x32_bf16 v[20:23], v[108:111], v[36:39], v[20:23]
    v_mfma_f32_16x16x32_bf16 v[20:23], v[116:119], v[52:55], v[20:23]
    v_mfma_f32_16x16x32_bf16 v[16:19], v[116:119], v[48:51], v[16:19]
    v_mfma_f32_16x16x32_bf16 v[16:19], v[108:111], v[32:35], v[16:19]
    s_waitcnt lgkmcnt(0)
    s_barrier
    .p2align 3
    v_mfma_f32_16x16x32_bf16 v[0:3], v[120:123], v[64:67], v[0:3]
    ds_read_b64_tr_b16 v[104:105], v139 offset:0
    ds_read_b64_tr_b16 v[106:107], v139 offset:2048
    v_mfma_f32_16x16x32_bf16 v[0:3], v[128:131], v[80:83], v[0:3]
    ds_read_b128 v[32:35], v136 offset:32768
    v_mfma_f32_16x16x32_bf16 v[4:7], v[128:131], v[84:87], v[4:7]
    ds_read_b128 v[36:39], v136 offset:34816
    v_mfma_f32_16x16x32_bf16 v[4:7], v[120:123], v[68:71], v[4:7]
    ds_read_b128 v[40:43], v136 offset:36864
    ds_read_b128 v[44:47], v136 offset:38912
    v_mfma_f32_16x16x32_bf16 v[8:11], v[120:123], v[72:75], v[8:11]
    ds_read_b64_tr_b16 v[108:109], v140 offset:0
    v_mfma_f32_16x16x32_bf16 v[8:11], v[128:131], v[88:91], v[8:11]
    ds_read_b64_tr_b16 v[110:111], v140 offset:2048
    v_mfma_f32_16x16x32_bf16 v[12:15], v[128:131], v[92:95], v[12:15]
    ds_read_b64_tr_b16 v[112:113], v139 offset:4096
    ds_read_b64_tr_b16 v[114:115], v139 offset:6144
    v_mfma_f32_16x16x32_bf16 v[12:15], v[120:123], v[76:79], v[12:15]
    ds_read_b128 v[48:51], v136 offset:33792
    v_mfma_f32_16x16x32_bf16 v[28:31], v[124:127], v[76:79], v[28:31]
    ds_read_b128 v[52:55], v136 offset:35840
    v_mfma_f32_16x16x32_bf16 v[28:31], v[132:135], v[92:95], v[28:31]
    ds_read_b128 v[56:59], v136 offset:37888
    ds_read_b128 v[60:63], v136 offset:39936
    v_mfma_f32_16x16x32_bf16 v[24:27], v[132:135], v[88:91], v[24:27]
    ds_read_b64_tr_b16 v[116:117], v140 offset:4096
    v_mfma_f32_16x16x32_bf16 v[24:27], v[124:127], v[72:75], v[24:27]
    ds_read_b64_tr_b16 v[118:119], v140 offset:6144
    v_mfma_f32_16x16x32_bf16 v[20:23], v[124:127], v[68:71], v[20:23]
    v_mfma_f32_16x16x32_bf16 v[20:23], v[132:135], v[84:87], v[20:23]
    v_mfma_f32_16x16x32_bf16 v[16:19], v[132:135], v[80:83], v[16:19]
    v_mfma_f32_16x16x32_bf16 v[16:19], v[124:127], v[64:67], v[16:19]
    s_waitcnt lgkmcnt(0)
    s_barrier
    .p2align 3
    v_mfma_f32_16x16x32_bf16 v[0:3], v[104:107], v[32:35], v[0:3]
    ds_read_b64_tr_b16 v[120:121], v139 offset:8192
    ds_read_b64_tr_b16 v[122:123], v139 offset:10240
    v_mfma_f32_16x16x32_bf16 v[0:3], v[112:115], v[48:51], v[0:3]
    ds_read_b128 v[64:67], v136 offset:0
    v_mfma_f32_16x16x32_bf16 v[4:7], v[112:115], v[52:55], v[4:7]
    ds_read_b128 v[68:71], v136 offset:2048
    v_mfma_f32_16x16x32_bf16 v[4:7], v[104:107], v[36:39], v[4:7]
    ds_read_b128 v[72:75], v136 offset:4096
    ds_read_b128 v[76:79], v136 offset:6144
    v_mfma_f32_16x16x32_bf16 v[8:11], v[104:107], v[40:43], v[8:11]
    ds_read_b64_tr_b16 v[124:125], v140 offset:8192
    v_mfma_f32_16x16x32_bf16 v[8:11], v[112:115], v[56:59], v[8:11]
    ds_read_b64_tr_b16 v[126:127], v140 offset:10240
    v_mfma_f32_16x16x32_bf16 v[12:15], v[112:115], v[60:63], v[12:15]
    ds_read_b64_tr_b16 v[128:129], v139 offset:12288
    ds_read_b64_tr_b16 v[130:131], v139 offset:14336
    v_mfma_f32_16x16x32_bf16 v[12:15], v[104:107], v[44:47], v[12:15]
    ds_read_b128 v[80:83], v136 offset:1024
    v_mfma_f32_16x16x32_bf16 v[28:31], v[108:111], v[44:47], v[28:31]
    ds_read_b128 v[84:87], v136 offset:3072
    v_mfma_f32_16x16x32_bf16 v[28:31], v[116:119], v[60:63], v[28:31]
    ds_read_b128 v[88:91], v136 offset:5120
    ds_read_b128 v[92:95], v136 offset:7168
    v_mfma_f32_16x16x32_bf16 v[24:27], v[116:119], v[56:59], v[24:27]
    ds_read_b64_tr_b16 v[132:133], v140 offset:12288
    v_mfma_f32_16x16x32_bf16 v[24:27], v[108:111], v[40:43], v[24:27]
    ds_read_b64_tr_b16 v[134:135], v140 offset:14336
    v_mfma_f32_16x16x32_bf16 v[20:23], v[108:111], v[36:39], v[20:23]
    v_mfma_f32_16x16x32_bf16 v[20:23], v[116:119], v[52:55], v[20:23]
    v_mfma_f32_16x16x32_bf16 v[16:19], v[116:119], v[48:51], v[16:19]
    v_mfma_f32_16x16x32_bf16 v[16:19], v[108:111], v[32:35], v[16:19]
    s_waitcnt lgkmcnt(0)
    s_barrier
    .p2align 3
    v_mfma_f32_16x16x32_bf16 v[0:3], v[120:123], v[64:67], v[0:3]
    v_mfma_f32_16x16x32_bf16 v[0:3], v[128:131], v[80:83], v[0:3]
    v_mfma_f32_16x16x32_bf16 v[4:7], v[128:131], v[84:87], v[4:7]
    v_mfma_f32_16x16x32_bf16 v[4:7], v[120:123], v[68:71], v[4:7]
    v_mfma_f32_16x16x32_bf16 v[8:11], v[120:123], v[72:75], v[8:11]
    v_mfma_f32_16x16x32_bf16 v[8:11], v[128:131], v[88:91], v[8:11]
    v_mfma_f32_16x16x32_bf16 v[12:15], v[128:131], v[92:95], v[12:15]
    v_mfma_f32_16x16x32_bf16 v[12:15], v[120:123], v[76:79], v[12:15]
    v_mfma_f32_16x16x32_bf16 v[28:31], v[124:127], v[76:79], v[28:31]
    v_mfma_f32_16x16x32_bf16 v[28:31], v[132:135], v[92:95], v[28:31]
    v_mfma_f32_16x16x32_bf16 v[24:27], v[132:135], v[88:91], v[24:27]
    v_mfma_f32_16x16x32_bf16 v[24:27], v[124:127], v[72:75], v[24:27]
    v_mfma_f32_16x16x32_bf16 v[20:23], v[124:127], v[68:71], v[20:23]
    v_mfma_f32_16x16x32_bf16 v[20:23], v[132:135], v[84:87], v[20:23]
    v_mfma_f32_16x16x32_bf16 v[16:19], v[132:135], v[80:83], v[16:19]
    v_mfma_f32_16x16x32_bf16 v[16:19], v[124:127], v[64:67], v[16:19]
    s_nop 7
    s_add_u32 s59, s1, s49
    s_add_u32 s60, s59, 4096
    v_cvt_pk_bf16_f32 v32, v0, v1
    v_cvt_pk_bf16_f32 v33, v2, v3
    v_cvt_pk_bf16_f32 v34, v16, v17
    v_cvt_pk_bf16_f32 v35, v18, v19
    buffer_store_dwordx4 v[32:35], v254, s[4:7], s59 offen offset:0 sc0 sc1
    v_cvt_pk_bf16_f32 v36, v4, v5
    v_cvt_pk_bf16_f32 v37, v6, v7
    v_cvt_pk_bf16_f32 v38, v20, v21
    v_cvt_pk_bf16_f32 v39, v22, v23
    buffer_store_dwordx4 v[36:39], v254, s[4:7], s59 offen offset:2048 sc0 sc1
    v_cvt_pk_bf16_f32 v40, v8, v9
    v_cvt_pk_bf16_f32 v41, v10, v11
    v_cvt_pk_bf16_f32 v42, v24, v25
    v_cvt_pk_bf16_f32 v43, v26, v27
    buffer_store_dwordx4 v[40:43], v254, s[4:7], s60 offen offset:0 sc0 sc1
    v_cvt_pk_bf16_f32 v44, v12, v13
    v_cvt_pk_bf16_f32 v45, v14, v15
    v_cvt_pk_bf16_f32 v46, v28, v29
    v_cvt_pk_bf16_f32 v47, v30, v31
    buffer_store_dwordx4 v[44:47], v254, s[4:7], s60 offen offset:2048 sc0 sc1
    v_mov_b32 v56, 0x3f803f80
    v_dot2_f32_bf16 v48, v32, v56, 0
    v_dot2_f32_bf16 v52, v32, v32, 0
    v_dot2_f32_bf16 v49, v36, v56, 0
    v_dot2_f32_bf16 v53, v36, v36, 0
    v_dot2_f32_bf16 v50, v40, v56, 0
    v_dot2_f32_bf16 v54, v40, v40, 0
    v_dot2_f32_bf16 v51, v44, v56, 0
    v_dot2_f32_bf16 v55, v44, v44, 0
    v_dot2_f32_bf16 v48, v33, v56, v48
    v_dot2_f32_bf16 v52, v33, v33, v52
    v_dot2_f32_bf16 v49, v37, v56, v49
    v_dot2_f32_bf16 v53, v37, v37, v53
    v_dot2_f32_bf16 v50, v41, v56, v50
    v_dot2_f32_bf16 v54, v41, v41, v54
    v_dot2_f32_bf16 v51, v45, v56, v51
    v_dot2_f32_bf16 v55, v45, v45, v55
    v_dot2_f32_bf16 v48, v34, v56, v48
    v_dot2_f32_bf16 v52, v34, v34, v52
    v_dot2_f32_bf16 v49, v38, v56, v49
    v_dot2_f32_bf16 v53, v38, v38, v53
    v_dot2_f32_bf16 v50, v42, v56, v50
    v_dot2_f32_bf16 v54, v42, v42, v54
    v_dot2_f32_bf16 v51, v46, v56, v51
    v_dot2_f32_bf16 v55, v46, v46, v55
    v_dot2_f32_bf16 v48, v35, v56, v48
    v_dot2_f32_bf16 v52, v35, v35, v52
    v_dot2_f32_bf16 v49, v39, v56, v49
    v_dot2_f32_bf16 v53, v39, v39, v53
    v_dot2_f32_bf16 v50, v43, v56, v50
    v_dot2_f32_bf16 v54, v43, v43, v54
    v_dot2_f32_bf16 v51, v47, v56, v51
    v_dot2_f32_bf16 v55, v47, v47, v55
    s_lshl_b32 s55, s42, 9
    s_add_u32 s55, s55, 155648
    s_nop 1
    v_permlane32_swap_b32 v48, v50
    v_permlane32_swap_b32 v49, v51
    v_permlane32_swap_b32 v52, v54
    v_permlane32_swap_b32 v53, v55
    v_add_f32 v48, v48, v50
    v_add_f32 v49, v49, v51
    v_add_f32 v52, v52, v54
    v_add_f32 v53, v53, v55
    v_lshrrev_b32 v56, 1, v254
    v_add_u32 v56, s55, v56
    v_permlane16_swap_b32 v48, v49
    v_permlane16_swap_b32 v52, v53
    v_add_f32 v48, v48, v49
    v_add_f32 v49, v52, v53
    ds_write_b64 v56, v[48:49]
    s_lshl_b32 s55, s43, 13
    s_add_u32 s55, s55, 98304
    v_add_u32 v224, s55, v254
    s_lshl_b32 s56, s44, 2
    v_lshrrev_b32 v233, 6, v254
    v_and_b32 v234, 7, v233
    v_xor_b32 v234, s56, v234
    v_lshlrev_b32 v233, 8, v233
    v_lshl_add_u32 v233, v234, 5, v233
    v_and_b32 v234, 0x30, v254
    v_lshrrev_b32 v234, 1, v234
    v_add_u32 v233, v233, v234
    v_xor_b32 v225, 0, v233
    v_xor_b32 v226, 32, v233
    v_xor_b32 v227, 64, v233
    v_xor_b32 v228, 96, v233
    v_add_u32 v229, 49152, v225
    v_add_u32 v230, 49152, v226
    v_add_u32 v231, 49152, v227
    v_add_u32 v232, 49152, v228
    v_lshrrev_b32 v233, 7, v254
    v_and_b32 v234, 0x70, v254
    v_and_b32 v235, 6, v233
    v_lshlrev_b32 v235, 4, v235
    v_xor_b32 v234, v234, v235
    v_mul_u32_u24 v233, 7168, v233
    v_add3_u32 v236, v233, v234, s66
    v_add_u32 v237, 56320, v236
    v_add_u32 v242, s67, v254
    v_and_b32 v234, 0xf0, v254
    v_lshrrev_b32 v233, 8, v254
    v_lshlrev_b32 v235, 5, v233
    v_xor_b32 v234, v234, v235
    v_mul_u32_u24 v233, 2048, v233
    v_add_u32 v238, v233, v234
    v_xor_b32 v234, 0x80, v234
    v_add_u32 v233, v233, v234
    v_add_u32 v239, 7168, v233
    v_add_u32 v240, 14336, v238
    v_add_u32 v241, 14336, v239
    v_mov_b32 v243, v224
    s_and_b32 s56, s51, 1
    s_lshl_b32 s56, s56, 2
    s_lshl_b32 s55, s44, 1
    s_add_u32 s56, s56, s55
    v_lshrrev_b32 v233, 6, v254
    v_and_b32 v234, 7, v233
    v_xor_b32 v234, s56, v234
    v_lshlrev_b32 v233, 8, v233
    v_lshl_add_u32 v233, v234, 5, v233
    v_and_b32 v234, 0x30, v254
    v_lshrrev_b32 v234, 1, v234
    v_add_u32 v233, v233, v234
    v_xor_b32 v244, 0, v233
    v_xor_b32 v245, 32, v233
    v_xor_b32 v246, 128, v233
    v_xor_b32 v247, 160, v233
    v_add_u32 v248, 49152, v244
    v_add_u32 v249, 49152, v245
    v_add_u32 v250, 49152, v246
    v_add_u32 v251, 49152, v247
    s_and_b32 s55, s51, 1
    s_mul_i32 s55, s55, 458752
    s_add_u32 s95, s50, s55
    s_and_b32 s55, s41, 7
    s_lshl_b32 s55, s55, 14
    s_and_b32 s56, s1, 0x3fff
    s_add_u32 s55, s55, s56
    s_add_u32 s89, s55, s95
    s_and_b32 s55, s41, 6
    s_add_u32 s55, s55, 48
    s_lshl_b32 s55, s55, 13
    s_and_b32 s56, s41, 1
    s_lshl_b32 s56, s56, 10
    s_add_u32 s55, s55, s56
    s_add_u32 s55, s55, s62
    s_add_u32 s90, s55, s95
    s_lshl_b32 s60, s43, 23
    s_add_u32 s60, s60, 83886336
    s_add_u32 s55, s4, s60
    s_addc_u32 s56, s5, 0
    s_lshr_b32 s57, 16392, s41
    s_and_b32 s57, s57, 1
    s_cselect_b32 s24, s55, s16
    s_cselect_b32 s25, s56, s17
    s_mov_b32 s26, 7340032
    s_mov_b32 s27, 0x00020000
    s_add_u32 s55, s4, 100663552
    s_addc_u32 s56, s5, 0
    s_lshr_b32 s57, 3084, s51
    s_and_b32 s57, s57, 1
    s_cselect_b32 s20, s55, s20
    s_cselect_b32 s21, s56, s21
    s_add_u32 s88, s49, s62
    s_lshl_b32 s94, s51, 14
    s_waitcnt vmcnt(0) lgkmcnt(0)
    s_barrier
    s_cmp_lg_u32 s42, 2
    s_cbranch_scc1 wf_22
    s_lshr_b32 s55, s2, 5
    s_lshl_b32 s55, s55, 2
    s_add_u32 s55, s55, s0
    v_mov_b32 v252, 32
    v_mov_b32 v253, 0x01010101
    s_mov_b64 exec, 1
    s_cmp_eq_u32 s45, 0
    s_cbranch_scc1 st_23
    buffer_store_dword v253, v252, s[4:7], s55 offen sc0 sc1
    s_branch st_24
st_23:
    buffer_store_dword v253, v252, s[4:7], s55 offen
st_24:
    s_mov_b64 exec, -1
wf_22:
    s_cmp_lg_u32 s42, 0
    s_cbranch_scc1 so_25
    v_add_u32 v216, 155648, v254
    ds_read_b128 v[208:211], v216
    ds_read_b128 v[212:215], v216 offset:1024
    s_lshl_b32 s55, s51, 10
    s_add_u32 s55, s55, s52
    s_waitcnt lgkmcnt(0)
    v_add_f32 v208, v208, v212
    v_add_f32 v209, v209, v213
    v_add_f32 v210, v210, v214
    v_add_f32 v211, v211, v215
    buffer_store_dwordx4 v[208:211], v254, s[4:7], s55 offen sc0 sc1
so_25:
    s_barrier
    ds_read_b64_tr_b16 v[160:161], v229 offset:16384
    ds_read_b64_tr_b16 v[162:163], v229 offset:20480
    ds_read_b128 v[128:131], v224 offset:0
    ds_read_b128 v[132:135], v224 offset:2048
    ds_read_b128 v[136:139], v224 offset:4096
    ds_read_b128 v[140:143], v224 offset:6144
    ds_read_b64_tr_b16 v[176:177], v229 offset:24576
    ds_read_b64_tr_b16 v[178:179], v229 offset:28672
    ds_read_b64_tr_b16 v[164:165], v230 offset:16384
    ds_read_b64_tr_b16 v[166:167], v230 offset:20480
    ds_read_b64_tr_b16 v[180:181], v230 offset:24576
    ds_read_b64_tr_b16 v[182:183], v230 offset:28672
    ds_read_b64_tr_b16 v[168:169], v231 offset:16384
    ds_read_b64_tr_b16 v[170:171], v231 offset:20480
    ds_read_b64_tr_b16 v[184:185], v231 offset:24576
    ds_read_b64_tr_b16 v[186:187], v231 offset:28672
    ds_read_b64_tr_b16 v[172:173], v232 offset:16384
    ds_read_b64_tr_b16 v[174:175], v232 offset:20480
    ds_read_b64_tr_b16 v[188:189], v232 offset:24576
    ds_read_b64_tr_b16 v[190:191], v232 offset:28672
    s_mov_b32 s58, 5
    s_waitcnt lgkmcnt(0)
    s_barrier
    .p2align 3
    v_mfma_f32_16x16x32_bf16 v[0:3], v[160:163], v[128:131], 0
    ds_read_b64_tr_b16 v[192:193], v229 offset:32768
    v_mfma_f32_16x16x32_bf16 v[4:7], v[160:163], v[132:135], 0
    ds_read_b64_tr_b16 v[194:195], v229 offset:36864
    v_mfma_f32_16x16x32_bf16 v[8:11], v[160:163], v[136:139], 0
    ds_read_b128 v[144:147], v224 offset:1024
    v_mfma_f32_16x16x32_bf16 v[12:15], v[160:163], v[140:143], 0
    ds_read_b128 v[148:151], v224 offset:3072
    v_mfma_f32_16x16x32_bf16 v[76:79], v[176:179], v[140:143], 0
    ds_read_b128 v[152:155], v224 offset:5120
    v_mfma_f32_16x16x32_bf16 v[72:75], v[176:179], v[136:139], 0
    v_mfma_f32_16x16x32_bf16 v[68:71], v[176:179], v[132:135], 0
    ds_read_b128 v[156:159], v224 offset:7168
    v_mfma_f32_16x16x32_bf16 v[64:67], v[176:179], v[128:131], 0
    ds_read_b64_tr_b16 v[208:209], v229 offset:40960
    v_mfma_f32_16x16x32_bf16 v[16:19], v[164:167], v[128:131], 0
    ds_read_b64_tr_b16 v[210:211], v229 offset:45056
    v_mfma_f32_16x16x32_bf16 v[20:23], v[164:167], v[132:135], 0
    ds_read_b64_tr_b16 v[196:197], v230 offset:32768
    v_mfma_f32_16x16x32_bf16 v[24:27], v[164:167], v[136:139], 0
    ds_read_b64_tr_b16 v[198:199], v230 offset:36864
    v_mfma_f32_16x16x32_bf16 v[28:31], v[164:167], v[140:143], 0
    v_mfma_f32_16x16x32_bf16 v[92:95], v[180:183], v[140:143], 0
    ds_read_b64_tr_b16 v[212:213], v230 offset:40960
    v_mfma_f32_16x16x32_bf16 v[88:91], v[180:183], v[136:139], 0
    ds_read_b64_tr_b16 v[214:215], v230 offset:45056
    v_mfma_f32_16x16x32_bf16 v[84:87], v[180:183], v[132:135], 0
    ds_read_b64_tr_b16 v[200:201], v231 offset:32768
    v_mfma_f32_16x16x32_bf16 v[80:83], v[180:183], v[128:131], 0
    ds_read_b64_tr_b16 v[202:203], v231 offset:36864
    v_mfma_f32_16x16x32_bf16 v[32:35], v[168:171], v[128:131], 0
    ds_read_b64_tr_b16 v[216:217], v231 offset:40960
    v_mfma_f32_16x16x32_bf16 v[36:39], v[168:171], v[132:135], 0
    v_mfma_f32_16x16x32_bf16 v[40:43], v[168:171], v[136:139], 0
    ds_read_b64_tr_b16 v[218:219], v231 offset:45056
    v_mfma_f32_16x16x32_bf16 v[44:47], v[168:171], v[140:143], 0
    ds_read_b64_tr_b16 v[204:205], v232 offset:32768
    v_mfma_f32_16x16x32_bf16 v[108:111], v[184:187], v[140:143], 0
    ds_read_b64_tr_b16 v[206:207], v232 offset:36864
    v_mfma_f32_16x16x32_bf16 v[104:107], v[184:187], v[136:139], 0
    ds_read_b64_tr_b16 v[220:221], v232 offset:40960
    v_mfma_f32_16x16x32_bf16 v[100:103], v[184:187], v[132:135], 0
    ds_read_b64_tr_b16 v[222:223], v232 offset:45056
    v_mfma_f32_16x16x32_bf16 v[96:99], v[184:187], v[128:131], 0
    v_mfma_f32_16x16x32_bf16 v[48:51], v[172:175], v[128:131], 0
    v_mfma_f32_16x16x32_bf16 v[52:55], v[172:175], v[132:135], 0
    v_mfma_f32_16x16x32_bf16 v[56:59], v[172:175], v[136:139], 0
    v_mfma_f32_16x16x32_bf16 v[60:63], v[172:175], v[140:143], 0
    v_mfma_f32_16x16x32_bf16 v[124:127], v[188:191], v[140:143], 0
    v_mfma_f32_16x16x32_bf16 v[120:123], v[188:191], v[136:139], 0
    v_mfma_f32_16x16x32_bf16 v[116:119], v[188:191], v[132:135], 0
    v_mfma_f32_16x16x32_bf16 v[112:115], v[188:191], v[128:131], 0
    .p2align 3
loop_26:
    s_waitcnt lgkmcnt(0)
    s_barrier
    .p2align 3
    v_mfma_f32_16x16x32_bf16 v[0:3], v[192:195], v[144:147], v[0:3]
    ds_read_b64_tr_b16 v[160:161], v225 offset:0
    v_mfma_f32_16x16x32_bf16 v[4:7], v[192:195], v[148:151], v[4:7]
    ds_read_b64_tr_b16 v[162:163], v225 offset:4096
    v_mfma_f32_16x16x32_bf16 v[8:11], v[192:195], v[152:155], v[8:11]
    ds_read_b128 v[128:131], v224 offset:16384
    v_mfma_f32_16x16x32_bf16 v[12:15], v[192:195], v[156:159], v[12:15]
    ds_read_b128 v[132:135], v224 offset:18432
    v_mfma_f32_16x16x32_bf16 v[76:79], v[208:211], v[156:159], v[76:79]
    ds_read_b128 v[136:139], v224 offset:20480
    v_mfma_f32_16x16x32_bf16 v[72:75], v[208:211], v[152:155], v[72:75]
    v_mfma_f32_16x16x32_bf16 v[68:71], v[208:211], v[148:151], v[68:71]
    ds_read_b128 v[140:143], v224 offset:22528
    v_mfma_f32_16x16x32_bf16 v[64:67], v[208:211], v[144:147], v[64:67]
    ds_read_b64_tr_b16 v[176:177], v225 offset:8192
    v_mfma_f32_16x16x32_bf16 v[16:19], v[196:199], v[144:147], v[16:19]
    ds_read_b64_tr_b16 v[178:179], v225 offset:12288
    v_mfma_f32_16x16x32_bf16 v[20:23], v[196:199], v[148:151], v[20:23]
    ds_read_b64_tr_b16 v[164:165], v226 offset:0
    v_mfma_f32_16x16x32_bf16 v[24:27], v[196:199], v[152:155], v[24:27]
    ds_read_b64_tr_b16 v[166:167], v226 offset:4096
    v_mfma_f32_16x16x32_bf16 v[28:31], v[196:199], v[156:159], v[28:31]
    v_mfma_f32_16x16x32_bf16 v[92:95], v[212:215], v[156:159], v[92:95]
    ds_read_b64_tr_b16 v[180:181], v226 offset:8192
    v_mfma_f32_16x16x32_bf16 v[88:91], v[212:215], v[152:155], v[88:91]
    ds_read_b64_tr_b16 v[182:183], v226 offset:12288
    v_mfma_f32_16x16x32_bf16 v[84:87], v[212:215], v[148:151], v[84:87]
    ds_read_b64_tr_b16 v[168:169], v227 offset:0
    v_mfma_f32_16x16x32_bf16 v[80:83], v[212:215], v[144:147], v[80:83]
    ds_read_b64_tr_b16 v[170:171], v227 offset:4096
    v_mfma_f32_16x16x32_bf16 v[32:35], v[200:203], v[144:147], v[32:35]
    ds_read_b64_tr_b16 v[184:185], v227 offset:8192
    v_mfma_f32_16x16x32_bf16 v[36:39], v[200:203], v[148:151], v[36:39]
    v_mfma_f32_16x16x32_bf16 v[40:43], v[200:203], v[152:155], v[40:43]
    ds_read_b64_tr_b16 v[186:187], v227 offset:12288
    v_mfma_f32_16x16x32_bf16 v[44:47], v[200:203], v[156:159], v[44:47]
    ds_read_b64_tr_b16 v[172:173], v228 offset:0
    v_mfma_f32_16x16x32_bf16 v[108:111], v[216:219], v[156:159], v[108:111]
    ds_read_b64_tr_b16 v[174:175], v228 offset:4096
    v_mfma_f32_16x16x32_bf16 v[104:107], v[216:219], v[152:155], v[104:107]
    ds_read_b64_tr_b16 v[188:189], v228 offset:8192
    v_mfma_f32_16x16x32_bf16 v[100:103], v[216:219], v[148:151], v[100:103]
    ds_read_b64_tr_b16 v[190:191], v228 offset:12288
    v_mfma_f32_16x16x32_bf16 v[96:99], v[216:219], v[144:147], v[96:99]
    v_mfma_f32_16x16x32_bf16 v[48:51], v[204:207], v[144:147], v[48:51]
    v_mfma_f32_16x16x32_bf16 v[52:55], v[204:207], v[148:151], v[52:55]
    v_mfma_f32_16x16x32_bf16 v[56:59], v[204:207], v[152:155], v[56:59]
    v_mfma_f32_16x16x32_bf16 v[60:63], v[204:207], v[156:159], v[60:63]
    v_mfma_f32_16x16x32_bf16 v[124:127], v[220:223], v[156:159], v[124:127]
    v_mfma_f32_16x16x32_bf16 v[120:123], v[220:223], v[152:155], v[120:123]
    v_mfma_f32_16x16x32_bf16 v[116:119], v[220:223], v[148:151], v[116:119]
    v_mfma_f32_16x16x32_bf16 v[112:115], v[220:223], v[144:147], v[112:115]
    s_waitcnt vmcnt(0) lgkmcnt(0)
    s_barrier
    .p2align 3
    v_mfma_f32_16x16x32_bf16 v[0:3], v[160:163], v[128:131], v[0:3]
    ds_read_b64_tr_b16 v[192:193], v225 offset:16384
    v_mfma_f32_16x16x32_bf16 v[4:7], v[160:163], v[132:135], v[4:7]
    ds_read_b64_tr_b16 v[194:195], v225 offset:20480
    v_mfma_f32_16x16x32_bf16 v[8:11], v[160:163], v[136:139], v[8:11]
    ds_read_b128 v[144:147], v224 offset:17408
    v_mfma_f32_16x16x32_bf16 v[12:15], v[160:163], v[140:143], v[12:15]
    ds_read_b128 v[148:151], v224 offset:19456
    v_mfma_f32_16x16x32_bf16 v[76:79], v[176:179], v[140:143], v[76:79]
    ds_read_b128 v[152:155], v224 offset:21504
    v_mfma_f32_16x16x32_bf16 v[72:75], v[176:179], v[136:139], v[72:75]
    v_mfma_f32_16x16x32_bf16 v[68:71], v[176:179], v[132:135], v[68:71]
    ds_read_b128 v[156:159], v224 offset:23552
    v_mfma_f32_16x16x32_bf16 v[64:67], v[176:179], v[128:131], v[64:67]
    ds_read_b64_tr_b16 v[208:209], v225 offset:24576
    v_mfma_f32_16x16x32_bf16 v[16:19], v[164:167], v[128:131], v[16:19]
    ds_read_b64_tr_b16 v[210:211], v225 offset:28672
    v_mfma_f32_16x16x32_bf16 v[20:23], v[164:167], v[132:135], v[20:23]
    ds_read_b64_tr_b16 v[196:197], v226 offset:16384
    v_mfma_f32_16x16x32_bf16 v[24:27], v[164:167], v[136:139], v[24:27]
    ds_read_b64_tr_b16 v[198:199], v226 offset:20480
    v_mfma_f32_16x16x32_bf16 v[28:31], v[164:167], v[140:143], v[28:31]
    v_mfma_f32_16x16x32_bf16 v[92:95], v[180:183], v[140:143], v[92:95]
    ds_read_b64_tr_b16 v[212:213], v226 offset:24576
    v_mfma_f32_16x16x32_bf16 v[88:91], v[180:183], v[136:139], v[88:91]
    ds_read_b64_tr_b16 v[214:215], v226 offset:28672
    v_mfma_f32_16x16x32_bf16 v[84:87], v[180:183], v[132:135], v[84:87]
    ds_read_b64_tr_b16 v[200:201], v227 offset:16384
    v_mfma_f32_16x16x32_bf16 v[80:83], v[180:183], v[128:131], v[80:83]
    ds_read_b64_tr_b16 v[202:203], v227 offset:20480
    v_mfma_f32_16x16x32_bf16 v[32:35], v[168:171], v[128:131], v[32:35]
    ds_read_b64_tr_b16 v[216:217], v227 offset:24576
    v_mfma_f32_16x16x32_bf16 v[36:39], v[168:171], v[132:135], v[36:39]
    v_mfma_f32_16x16x32_bf16 v[40:43], v[168:171], v[136:139], v[40:43]
    ds_read_b64_tr_b16 v[218:219], v227 offset:28672
    v_mfma_f32_16x16x32_bf16 v[44:47], v[168:171], v[140:143], v[44:47]
    ds_read_b64_tr_b16 v[204:205], v228 offset:16384
    v_mfma_f32_16x16x32_bf16 v[108:111], v[184:187], v[140:143], v[108:111]
    ds_read_b64_tr_b16 v[206:207], v228 offset:20480
    v_mfma_f32_16x16x32_bf16 v[104:107], v[184:187], v[136:139], v[104:107]
    ds_read_b64_tr_b16 v[220:221], v228 offset:24576
    v_mfma_f32_16x16x32_bf16 v[100:103], v[184:187], v[132:135], v[100:103]
    ds_read_b64_tr_b16 v[222:223], v228 offset:28672
    v_mfma_f32_16x16x32_bf16 v[96:99], v[184:187], v[128:131], v[96:99]
    v_mfma_f32_16x16x32_bf16 v[48:51], v[172:175], v[128:131], v[48:51]
    v_mfma_f32_16x16x32_bf16 v[52:55], v[172:175], v[132:135], v[52:55]
    v_mfma_f32_16x16x32_bf16 v[56:59], v[172:175], v[136:139], v[56:59]
    v_mfma_f32_16x16x32_bf16 v[60:63], v[172:175], v[140:143], v[60:63]
    v_mfma_f32_16x16x32_bf16 v[124:127], v[188:191], v[140:143], v[124:127]
    v_mfma_f32_16x16x32_bf16 v[120:123], v[188:191], v[136:139], v[120:123]
    v_mfma_f32_16x16x32_bf16 v[116:119], v[188:191], v[132:135], v[116:119]
    v_mfma_f32_16x16x32_bf16 v[112:115], v[188:191], v[128:131], v[112:115]
    s_waitcnt lgkmcnt(0)
    s_barrier
    .p2align 3
    v_mfma_f32_16x16x32_bf16 v[0:3], v[192:195], v[144:147], v[0:3]
    ds_read_b64_tr_b16 v[160:161], v225 offset:32768
    v_mfma_f32_16x16x32_bf16 v[4:7], v[192:195], v[148:151], v[4:7]
    ds_read_b64_tr_b16 v[162:163], v225 offset:36864
    v_mfma_f32_16x16x32_bf16 v[8:11], v[192:195], v[152:155], v[8:11]
    ds_read_b128 v[128:131], v224 offset:32768
    v_mfma_f32_16x16x32_bf16 v[12:15], v[192:195], v[156:159], v[12:15]
    ds_read_b128 v[132:135], v224 offset:34816
    v_mfma_f32_16x16x32_bf16 v[76:79], v[208:211], v[156:159], v[76:79]
    ds_read_b128 v[136:139], v224 offset:36864
    v_mfma_f32_16x16x32_bf16 v[72:75], v[208:211], v[152:155], v[72:75]
    v_mfma_f32_16x16x32_bf16 v[68:71], v[208:211], v[148:151], v[68:71]
    ds_read_b128 v[140:143], v224 offset:38912
    v_mfma_f32_16x16x32_bf16 v[64:67], v[208:211], v[144:147], v[64:67]
    ds_read_b64_tr_b16 v[176:177], v225 offset:40960
    v_mfma_f32_16x16x32_bf16 v[16:19], v[196:199], v[144:147], v[16:19]
    ds_read_b64_tr_b16 v[178:179], v225 offset:45056
    v_mfma_f32_16x16x32_bf16 v[20:23], v[196:199], v[148:151], v[20:23]
    ds_read_b64_tr_b16 v[164:165], v226 offset:32768
    v_mfma_f32_16x16x32_bf16 v[24:27], v[196:199], v[152:155], v[24:27]
    ds_read_b64_tr_b16 v[166:167], v226 offset:36864
    v_mfma_f32_16x16x32_bf16 v[28:31], v[196:199], v[156:159], v[28:31]
    v_mfma_f32_16x16x32_bf16 v[92:95], v[212:215], v[156:159], v[92:95]
    ds_read_b64_tr_b16 v[180:181], v226 offset:40960
    v_mfma_f32_16x16x32_bf16 v[88:91], v[212:215], v[152:155], v[88:91]
    ds_read_b64_tr_b16 v[182:183], v226 offset:45056
    v_mfma_f32_16x16x32_bf16 v[84:87], v[212:215], v[148:151], v[84:87]
    ds_read_b64_tr_b16 v[168:169], v227 offset:32768
    v_mfma_f32_16x16x32_bf16 v[80:83], v[212:215], v[144:147], v[80:83]
    ds_read_b64_tr_b16 v[170:171], v227 offset:36864
    v_mfma_f32_16x16x32_bf16 v[32:35], v[200:203], v[144:147], v[32:35]
    ds_read_b64_tr_b16 v[184:185], v227 offset:40960
    v_mfma_f32_16x16x32_bf16 v[36:39], v[200:203], v[148:151], v[36:39]
    v_mfma_f32_16x16x32_bf16 v[40:43], v[200:203], v[152:155], v[40:43]
    ds_read_b64_tr_b16 v[186:187], v227 offset:45056
    v_mfma_f32_16x16x32_bf16 v[44:47], v[200:203], v[156:159], v[44:47]
    ds_read_b64_tr_b16 v[172:173], v228 offset:32768
    v_mfma_f32_16x16x32_bf16 v[108:111], v[216:219], v[156:159], v[108:111]
    ds_read_b64_tr_b16 v[174:175], v228 offset:36864
    v_mfma_f32_16x16x32_bf16 v[104:107], v[216:219], v[152:155], v[104:107]
    ds_read_b64_tr_b16 v[188:189], v228 offset:40960
    v_mfma_f32_16x16x32_bf16 v[100:103], v[216:219], v[148:151], v[100:103]
    ds_read_b64_tr_b16 v[190:191], v228 offset:45056
    v_mfma_f32_16x16x32_bf16 v[96:99], v[216:219], v[144:147], v[96:99]
    v_mfma_f32_16x16x32_bf16 v[48:51], v[204:207], v[144:147], v[48:51]
    v_mfma_f32_16x16x32_bf16 v[52:55], v[204:207], v[148:151], v[52:55]
    v_mfma_f32_16x16x32_bf16 v[56:59], v[204:207], v[152:155], v[56:59]
    v_mfma_f32_16x16x32_bf16 v[60:63], v[204:207], v[156:159], v[60:63]
    v_mfma_f32_16x16x32_bf16 v[124:127], v[220:223], v[156:159], v[124:127]
    v_mfma_f32_16x16x32_bf16 v[120:123], v[220:223], v[152:155], v[120:123]
    v_mfma_f32_16x16x32_bf16 v[116:119], v[220:223], v[148:151], v[116:119]
    v_mfma_f32_16x16x32_bf16 v[112:115], v[220:223], v[144:147], v[112:115]
    s_waitcnt lgkmcnt(0)
    s_barrier
    .p2align 3
    v_mfma_f32_16x16x32_bf16 v[0:3], v[160:163], v[128:131], v[0:3]
    ds_read_b64_tr_b16 v[192:193], v229 offset:0
    v_mfma_f32_16x16x32_bf16 v[4:7], v[160:163], v[132:135], v[4:7]
    ds_read_b64_tr_b16 v[194:195], v229 offset:4096
    v_mfma_f32_16x16x32_bf16 v[8:11], v[160:163], v[136:139], v[8:11]
    ds_read_b128 v[144:147], v224 offset:33792
    v_mfma_f32_16x16x32_bf16 v[12:15], v[160:163], v[140:143], v[12:15]
    ds_read_b128 v[148:151], v224 offset:35840
    v_mfma_f32_16x16x32_bf16 v[76:79], v[176:179], v[140:143], v[76:79]
    ds_read_b128 v[152:155], v224 offset:37888
    v_mfma_f32_16x16x32_bf16 v[72:75], v[176:179], v[136:139], v[72:75]
    v_mfma_f32_16x16x32_bf16 v[68:71], v[176:179], v[132:135], v[68:71]
    ds_read_b128 v[156:159], v224 offset:39936
    v_mfma_f32_16x16x32_bf16 v[64:67], v[176:179], v[128:131], v[64:67]
    ds_read_b64_tr_b16 v[208:209], v229 offset:8192
    v_mfma_f32_16x16x32_bf16 v[16:19], v[164:167], v[128:131], v[16:19]
    ds_read_b64_tr_b16 v[210:211], v229 offset:12288
    v_mfma_f32_16x16x32_bf16 v[20:23], v[164:167], v[132:135], v[20:23]
    ds_read_b64_tr_b16 v[196:197], v230 offset:0
    v_mfma_f32_16x16x32_bf16 v[24:27], v[164:167], v[136:139], v[24:27]
    ds_read_b64_tr_b16 v[198:199], v230 offset:4096
    v_mfma_f32_16x16x32_bf16 v[28:31], v[164:167], v[140:143], v[28:31]
    v_mfma_f32_16x16x32_bf16 v[92:95], v[180:183], v[140:143], v[92:95]
    ds_read_b64_tr_b16 v[212:213], v230 offset:8192
    v_mfma_f32_16x16x32_bf16 v[88:91], v[180:183], v[136:139], v[88:91]
    ds_read_b64_tr_b16 v[214:215], v230 offset:12288
    v_mfma_f32_16x16x32_bf16 v[84:87], v[180:183], v[132:135], v[84:87]
    ds_read_b64_tr_b16 v[200:201], v231 offset:0
    v_mfma_f32_16x16x32_bf16 v[80:83], v[180:183], v[128:131], v[80:83]
    ds_read_b64_tr_b16 v[202:203], v231 offset:4096
    v_mfma_f32_16x16x32_bf16 v[32:35], v[168:171], v[128:131], v[32:35]
    ds_read_b64_tr_b16 v[216:217], v231 offset:8192
    v_mfma_f32_16x16x32_bf16 v[36:39], v[168:171], v[132:135], v[36:39]
    v_mfma_f32_16x16x32_bf16 v[40:43], v[168:171], v[136:139], v[40:43]
    ds_read_b64_tr_b16 v[218:219], v231 offset:12288
    v_mfma_f32_16x16x32_bf16 v[44:47], v[168:171], v[140:143], v[44:47]
    ds_read_b64_tr_b16 v[204:205], v232 offset:0
    v_mfma_f32_16x16x32_bf16 v[108:111], v[184:187], v[140:143], v[108:111]
    ds_read_b64_tr_b16 v[206:207], v232 offset:4096
    v_mfma_f32_16x16x32_bf16 v[104:107], v[184:187], v[136:139], v[104:107]
    ds_read_b64_tr_b16 v[220:221], v232 offset:8192
    v_mfma_f32_16x16x32_bf16 v[100:103], v[184:187], v[132:135], v[100:103]
    ds_read_b64_tr_b16 v[222:223], v232 offset:12288
    v_mfma_f32_16x16x32_bf16 v[96:99], v[184:187], v[128:131], v[96:99]
    v_mfma_f32_16x16x32_bf16 v[48:51], v[172:175], v[128:131], v[48:51]
    v_mfma_f32_16x16x32_bf16 v[52:55], v[172:175], v[132:135], v[52:55]
    v_mfma_f32_16x16x32_bf16 v[56:59], v[172:175], v[136:139], v[56:59]
    v_mfma_f32_16x16x32_bf16 v[60:63], v[172:175], v[140:143], v[60:63]
    v_mfma_f32_16x16x32_bf16 v[124:127], v[188:191], v[140:143], v[124:127]
    v_mfma_f32_16x16x32_bf16 v[120:123], v[188:191], v[136:139], v[120:123]
    v_mfma_f32_16x16x32_bf16 v[116:119], v[188:191], v[132:135], v[116:119]
    v_mfma_f32_16x16x32_bf16 v[112:115], v[188:191], v[128:131], v[112:115]
    s_waitcnt lgkmcnt(0)
    s_barrier
    .p2align 3
    v_mfma_f32_16x16x32_bf16 v[0:3], v[192:195], v[144:147], v[0:3]
    ds_read_b64_tr_b16 v[160:161], v229 offset:16384
    v_mfma_f32_16x16x32_bf16 v[4:7], v[192:195], v[148:151], v[4:7]
    ds_read_b64_tr_b16 v[162:163], v229 offset:20480
    v_mfma_f32_16x16x32_bf16 v[8:11], v[192:195], v[152:155], v[8:11]
    ds_read_b128 v[128:131], v224 offset:0
    v_mfma_f32_16x16x32_bf16 v[12:15], v[192:195], v[156:159], v[12:15]
    ds_read_b128 v[132:135], v224 offset:2048
    v_mfma_f32_16x16x32_bf16 v[76:79], v[208:211], v[156:159], v[76:79]
    ds_read_b128 v[136:139], v224 offset:4096
    v_mfma_f32_16x16x32_bf16 v[72:75], v[208:211], v[152:155], v[72:75]
    v_mfma_f32_16x16x32_bf16 v[68:71], v[208:211], v[148:151], v[68:71]
    ds_read_b128 v[140:143], v224 offset:6144
    v_mfma_f32_16x16x32_bf16 v[64:67], v[208:211], v[144:147], v[64:67]
    ds_read_b64_tr_b16 v[176:177], v229 offset:24576
    v_mfma_f32_16x16x32_bf16 v[16:19], v[196:199], v[144:147], v[16:19]
    ds_read_b64_tr_b16 v[178:179], v229 offset:28672
    v_mfma_f32_16x16x32_bf16 v[20:23], v[196:199], v[148:151], v[20:23]
    ds_read_b64_tr_b16 v[164:165], v230 offset:16384
    v_mfma_f32_16x16x32_bf16 v[24:27], v[196:199], v[152:155], v[24:27]
    ds_read_b64_tr_b16 v[166:167], v230 offset:20480
    v_mfma_f32_16x16x32_bf16 v[28:31], v[196:199], v[156:159], v[28:31]
    v_mfma_f32_16x16x32_bf16 v[92:95], v[212:215], v[156:159], v[92:95]
    ds_read_b64_tr_b16 v[180:181], v230 offset:24576
    v_mfma_f32_16x16x32_bf16 v[88:91], v[212:215], v[152:155], v[88:91]
    ds_read_b64_tr_b16 v[182:183], v230 offset:28672
    v_mfma_f32_16x16x32_bf16 v[84:87], v[212:215], v[148:151], v[84:87]
    ds_read_b64_tr_b16 v[168:169], v231 offset:16384
    v_mfma_f32_16x16x32_bf16 v[80:83], v[212:215], v[144:147], v[80:83]
    ds_read_b64_tr_b16 v[170:171], v231 offset:20480
    v_mfma_f32_16x16x32_bf16 v[32:35], v[200:203], v[144:147], v[32:35]
    ds_read_b64_tr_b16 v[184:185], v231 offset:24576
    v_mfma_f32_16x16x32_bf16 v[36:39], v[200:203], v[148:151], v[36:39]
    v_mfma_f32_16x16x32_bf16 v[40:43], v[200:203], v[152:155], v[40:43]
    ds_read_b64_tr_b16 v[186:187], v231 offset:28672
    v_mfma_f32_16x16x32_bf16 v[44:47], v[200:203], v[156:159], v[44:47]
    ds_read_b64_tr_b16 v[172:173], v232 offset:16384
    v_mfma_f32_16x16x32_bf16 v[108:111], v[216:219], v[156:159], v[108:111]
    ds_read_b64_tr_b16 v[174:175], v232 offset:20480
    v_mfma_f32_16x16x32_bf16 v[104:107], v[216:219], v[152:155], v[104:107]
    ds_read_b64_tr_b16 v[188:189], v232 offset:24576
    v_mfma_f32_16x16x32_bf16 v[100:103], v[216:219], v[148:151], v[100:103]
    ds_read_b64_tr_b16 v[190:191], v232 offset:28672
    v_mfma_f32_16x16x32_bf16 v[96:99], v[216:219], v[144:147], v[96:99]
    v_mfma_f32_16x16x32_bf16 v[48:51], v[204:207], v[144:147], v[48:51]
    v_mfma_f32_16x16x32_bf16 v[52:55], v[204:207], v[148:151], v[52:55]
    v_mfma_f32_16x16x32_bf16 v[56:59], v[204:207], v[152:155], v[56:59]
    v_mfma_f32_16x16x32_bf16 v[60:63], v[204:207], v[156:159], v[60:63]
    v_mfma_f32_16x16x32_bf16 v[124:127], v[220:223], v[156:159], v[124:127]
    v_mfma_f32_16x16x32_bf16 v[120:123], v[220:223], v[152:155], v[120:123]
    v_mfma_f32_16x16x32_bf16 v[116:119], v[220:223], v[148:151], v[116:119]
    v_mfma_f32_16x16x32_bf16 v[112:115], v[220:223], v[144:147], v[112:115]
    s_waitcnt lgkmcnt(0)
    s_barrier
    .p2align 3
    v_mfma_f32_16x16x32_bf16 v[0:3], v[160:163], v[128:131], v[0:3]
    ds_read_b64_tr_b16 v[192:193], v229 offset:32768
    v_mfma_f32_16x16x32_bf16 v[4:7], v[160:163], v[132:135], v[4:7]
    ds_read_b64_tr_b16 v[194:195], v229 offset:36864
    v_mfma_f32_16x16x32_bf16 v[8:11], v[160:163], v[136:139], v[8:11]
    ds_read_b128 v[144:147], v224 offset:1024
    v_mfma_f32_16x16x32_bf16 v[12:15], v[160:163], v[140:143], v[12:15]
    ds_read_b128 v[148:151], v224 offset:3072
    v_mfma_f32_16x16x32_bf16 v[76:79], v[176:179], v[140:143], v[76:79]
    ds_read_b128 v[152:155], v224 offset:5120
    v_mfma_f32_16x16x32_bf16 v[72:75], v[176:179], v[136:139], v[72:75]
    v_mfma_f32_16x16x32_bf16 v[68:71], v[176:179], v[132:135], v[68:71]
    ds_read_b128 v[156:159], v224 offset:7168
    v_mfma_f32_16x16x32_bf16 v[64:67], v[176:179], v[128:131], v[64:67]
    ds_read_b64_tr_b16 v[208:209], v229 offset:40960
    v_mfma_f32_16x16x32_bf16 v[16:19], v[164:167], v[128:131], v[16:19]
    ds_read_b64_tr_b16 v[210:211], v229 offset:45056
    v_mfma_f32_16x16x32_bf16 v[20:23], v[164:167], v[132:135], v[20:23]
    ds_read_b64_tr_b16 v[196:197], v230 offset:32768
    v_mfma_f32_16x16x32_bf16 v[24:27], v[164:167], v[136:139], v[24:27]
    ds_read_b64_tr_b16 v[198:199], v230 offset:36864
    v_mfma_f32_16x16x32_bf16 v[28:31], v[164:167], v[140:143], v[28:31]
    v_mfma_f32_16x16x32_bf16 v[92:95], v[180:183], v[140:143], v[92:95]
    ds_read_b64_tr_b16 v[212:213], v230 offset:40960
    v_mfma_f32_16x16x32_bf16 v[88:91], v[180:183], v[136:139], v[88:91]
    ds_read_b64_tr_b16 v[214:215], v230 offset:45056
    v_mfma_f32_16x16x32_bf16 v[84:87], v[180:183], v[132:135], v[84:87]
    ds_read_b64_tr_b16 v[200:201], v231 offset:32768
    v_mfma_f32_16x16x32_bf16 v[80:83], v[180:183], v[128:131], v[80:83]
    ds_read_b64_tr_b16 v[202:203], v231 offset:36864
    v_mfma_f32_16x16x32_bf16 v[32:35], v[168:171], v[128:131], v[32:35]
    ds_read_b64_tr_b16 v[216:217], v231 offset:40960
    v_mfma_f32_16x16x32_bf16 v[36:39], v[168:171], v[132:135], v[36:39]
    v_mfma_f32_16x16x32_bf16 v[40:43], v[168:171], v[136:139], v[40:43]
    ds_read_b64_tr_b16 v[218:219], v231 offset:45056
    v_mfma_f32_16x16x32_bf16 v[44:47], v[168:171], v[140:143], v[44:47]
    ds_read_b64_tr_b16 v[204:205], v232 offset:32768
    v_mfma_f32_16x16x32_bf16 v[108:111], v[184:187], v[140:143], v[108:111]
    ds_read_b64_tr_b16 v[206:207], v232 offset:36864
    v_mfma_f32_16x16x32_bf16 v[104:107], v[184:187], v[136:139], v[104:107]
    ds_read_b64_tr_b16 v[220:221], v232 offset:40960
    v_mfma_f32_16x16x32_bf16 v[100:103], v[184:187], v[132:135], v[100:103]
    ds_read_b64_tr_b16 v[222:223], v232 offset:45056
    v_mfma_f32_16x16x32_bf16 v[96:99], v[184:187], v[128:131], v[96:99]
    v_mfma_f32_16x16x32_bf16 v[48:51], v[172:175], v[128:131], v[48:51]
    v_mfma_f32_16x16x32_bf16 v[52:55], v[172:175], v[132:135], v[52:55]
    v_mfma_f32_16x16x32_bf16 v[56:59], v[172:175], v[136:139], v[56:59]
    v_mfma_f32_16x16x32_bf16 v[60:63], v[172:175], v[140:143], v[60:63]
    v_mfma_f32_16x16x32_bf16 v[124:127], v[188:191], v[140:143], v[124:127]
    s_sub_u32 s58, s58, 1
    s_cmp_lg_u32 s58, 0
    .p2align 3
    v_mfma_f32_16x16x32_bf16 v[120:123], v[188:191], v[136:139], v[120:123]
    v_mfma_f32_16x16x32_bf16 v[116:119], v[188:191], v[132:135], v[116:119]
    v_mfma_f32_16x16x32_bf16 v[112:115], v[188:191], v[128:131], v[112:115]
    s_cbranch_scc1 loop_26
    s_waitcnt lgkmcnt(0)
    s_barrier
    .p2align 3
    v_mfma_f32_16x16x32_bf16 v[0:3], v[192:195], v[144:147], v[0:3]
    v_mfma_f32_16x16x32_bf16 v[4:7], v[192:195], v[148:151], v[4:7]
    v_mfma_f32_16x16x32_bf16 v[8:11], v[192:195], v[152:155], v[8:11]
    v_mfma_f32_16x16x32_bf16 v[12:15], v[192:195], v[156:159], v[12:15]
    v_mfma_f32_16x16x32_bf16 v[76:79], v[208:211], v[156:159], v[76:79]
    v_mfma_f32_16x16x32_bf16 v[72:75], v[208:211], v[152:155], v[72:75]
    v_mfma_f32_16x16x32_bf16 v[68:71], v[208:211], v[148:151], v[68:71]
    v_mfma_f32_16x16x32_bf16 v[64:67], v[208:211], v[144:147], v[64:67]
    v_mfma_f32_16x16x32_bf16 v[16:19], v[196:199], v[144:147], v[16:19]
    v_mfma_f32_16x16x32_bf16 v[20:23], v[196:199], v[148:151], v[20:23]
    v_mfma_f32_16x16x32_bf16 v[24:27], v[196:199], v[152:155], v[24:27]
    v_mfma_f32_16x16x32_bf16 v[28:31], v[196:199], v[156:159], v[28:31]
    v_mfma_f32_16x16x32_bf16 v[92:95], v[212:215], v[156:159], v[92:95]
    v_mfma_f32_16x16x32_bf16 v[88:91], v[212:215], v[152:155], v[88:91]
    v_mfma_f32_16x16x32_bf16 v[84:87], v[212:215], v[148:151], v[84:87]
    v_mfma_f32_16x16x32_bf16 v[80:83], v[212:215], v[144:147], v[80:83]
    v_mfma_f32_16x16x32_bf16 v[32:35], v[200:203], v[144:147], v[32:35]
    v_mfma_f32_16x16x32_bf16 v[36:39], v[200:203], v[148:151], v[36:39]
    v_mfma_f32_16x16x32_bf16 v[40:43], v[200:203], v[152:155], v[40:43]
    v_mfma_f32_16x16x32_bf16 v[44:47], v[200:203], v[156:159], v[44:47]
    v_mfma_f32_16x16x32_bf16 v[108:111], v[216:219], v[156:159], v[108:111]
    v_mfma_f32_16x16x32_bf16 v[104:107], v[216:219], v[152:155], v[104:107]
    v_mfma_f32_16x16x32_bf16 v[100:103], v[216:219], v[148:151], v[100:103]
    v_mfma_f32_16x16x32_bf16 v[96:99], v[216:219], v[144:147], v[96:99]
    v_mfma_f32_16x16x32_bf16 v[48:51], v[204:207], v[144:147], v[48:51]
    v_mfma_f32_16x16x32_bf16 v[52:55], v[204:207], v[148:151], v[52:55]
    v_mfma_f32_16x16x32_bf16 v[56:59], v[204:207], v[152:155], v[56:59]
    v_mfma_f32_16x16x32_bf16 v[60:63], v[204:207], v[156:159], v[60:63]
    v_mfma_f32_16x16x32_bf16 v[124:127], v[220:223], v[156:159], v[124:127]
    v_mfma_f32_16x16x32_bf16 v[120:123], v[220:223], v[152:155], v[120:123]
    v_mfma_f32_16x16x32_bf16 v[116:119], v[220:223], v[148:151], v[116:119]
    v_mfma_f32_16x16x32_bf16 v[112:115], v[220:223], v[144:147], v[112:115]
    s_setprio 1
    v_add_u32 v191, s88, v254
    s_barrier
    s_add_u32 s93, s51, 0
    s_and_b32 s93, s93, 15
    s_lshl_b32 s93, s93, 12
    s_add_u32 m0, s61, 0
    s_mul_i32 s59, s93, 112
    buffer_load_dwordx4 v236, s[24:27], s59 offen lds
    s_nop 7
    s_lshl_b32 s55, s43, 9
    s_add_u32 s55, s55, 159744
    v_and_b32 v232, 0xf0, v254
    v_lshrrev_b32 v232, 1, v232
    v_add_u32 v232, s55, v232
    ds_read_b64 v[220:221], v232 offset:0
    ds_read_b64 v[222:223], v232 offset:128
    ds_read_b64 v[224:225], v232 offset:256
    ds_read_b64 v[226:227], v232 offset:384
    s_waitcnt lgkmcnt(0)
    v_sub_f32 v192, 0, v220
    buffer_load_dwordx4 v237, s[24:27], s59 offen offset:1024 lds
    v_mul_f32 v196, 0xbfb8aa3b, v221
    v_mul_f32 v200, v221, v221
    v_sub_f32 v193, 0, v222
    v_mul_f32 v197, 0xbfb8aa3b, v223
    v_mul_f32 v201, v223, v223
    v_sub_f32 v194, 0, v224
    v_mul_f32 v198, 0xbfb8aa3b, v225
    v_mul_f32 v202, v225, v225
    buffer_load_dwordx4 v242, s[4:7], s93 offen offset:2048 lds
    s_add_u32 s93, s93, 2048
    s_and_b32 s93, s93, 65535
    v_sub_f32 v195, 0, v226
    v_mul_f32 v199, 0xbfb8aa3b, v227
    v_mul_f32 v203, v227, v227
    v_rcp_f32 v200, v200
    v_rcp_f32 v201, v201
    v_rcp_f32 v202, v202
    v_rcp_f32 v203, v203
    s_nop 0
    s_barrier
    s_add_u32 m0, s62, 114688
    s_nop 0
    buffer_load_dwordx4 v191, s[4:7], s94 offen lds
    s_lshl_b32 s55, s44, 8
    s_add_u32 s55, s55, 161664
    v_lshrrev_b32 v235, 8, v254
    v_lshlrev_b32 v235, 4, v235
    v_add_u32 v235, s55, v235
    ds_read_b128 v[204:207], v235 offset:0
    ds_read_b128 v[208:211], v235 offset:512
    ds_read_b128 v[212:215], v235 offset:64
    buffer_load_dwordx4 v191, s[4:7], s94 offen offset:1024 lds
    ds_read_b128 v[216:219], v235 offset:576
    s_waitcnt lgkmcnt(0)
    v_fmac_f32 v0, v192, v204
    v_fmac_f32 v1, v192, v205
    v_fmac_f32 v2, v192, v206
    s_add_u32 m0, s61, 16384
    s_mul_i32 s59, s93, 112
    buffer_load_dwordx4 v236, s[24:27], s59 offen lds
    v_fmac_f32 v3, v192, v207
    v_mul_f32 v220, v196, v0
    v_mul_f32 v221, v196, v1
    v_mul_f32 v222, v196, v2
    buffer_load_dwordx4 v237, s[24:27], s59 offen offset:1024 lds
    v_mul_f32 v223, v196, v3
    v_fmac_f32 v64, v192, v208
    v_fmac_f32 v65, v192, v209
    v_fmac_f32 v66, v192, v210
    v_fmac_f32 v67, v192, v211
    buffer_load_dwordx4 v242, s[4:7], s93 offen offset:2048 lds
    s_add_u32 s93, s93, 6144
    s_and_b32 s93, s93, 65535
    v_exp_f32 v220, v220
    v_exp_f32 v221, v221
    v_exp_f32 v222, v222
    v_exp_f32 v223, v223
    v_mul_f32 v0, v0, v64
    s_barrier
    s_add_u32 m0, s62, 114688
    s_nop 0
    buffer_load_dwordx4 v191, s[4:7], s94 offen offset:2048 lds
    v_mul_f32 v1, v1, v65
    v_mul_f32 v2, v2, v66
    v_mul_f32 v3, v3, v67
    v_fma_f32 v220, v220, v200, v200
    buffer_load_dwordx4 v191, s[4:7], s94 offen offset:3072 lds
    s_add_u32 s94, s94, 32768
    s_and_b32 s94, s94, 262143
    v_fma_f32 v221, v221, v200, v200
    v_fma_f32 v222, v222, v200, v200
    v_fma_f32 v223, v223, v200, v200
    v_rcp_f32 v220, v220
    v_rcp_f32 v221, v221
    s_add_u32 m0, s61, 32768
    s_mul_i32 s59, s93, 112
    buffer_load_dwordx4 v236, s[24:27], s59 offen lds
    v_rcp_f32 v222, v222
    v_rcp_f32 v223, v223
    v_mul_f32 v0, v0, v220
    v_mul_f32 v1, v1, v221
    v_mul_f32 v2, v2, v222
    buffer_load_dwordx4 v237, s[24:27], s59 offen offset:1024 lds
    v_mul_f32 v3, v3, v223
    v_cvt_pk_bf16_f32 v224, v0, v1
    v_cvt_pk_bf16_f32 v225, v2, v3
    v_fmac_f32 v16, v192, v212
    v_fmac_f32 v17, v192, v213
    buffer_load_dwordx4 v242, s[4:7], s93 offen offset:2048 lds
    s_add_u32 s93, s93, 2048
    s_and_b32 s93, s93, 65535
    v_fmac_f32 v18, v192, v214
    v_fmac_f32 v19, v192, v215
    v_mul_f32 v220, v196, v16
    v_mul_f32 v221, v196, v17
    v_mul_f32 v222, v196, v18
    s_barrier
    s_add_u32 m0, s62, 131072
    s_nop 0
    buffer_load_dwordx4 v191, s[4:7], s94 offen lds
    v_mul_f32 v223, v196, v19
    v_fmac_f32 v80, v192, v216
    v_fmac_f32 v81, v192, v217
    v_fmac_f32 v82, v192, v218
    buffer_load_dwordx4 v191, s[4:7], s94 offen offset:1024 lds
    v_fmac_f32 v83, v192, v219
    v_exp_f32 v220, v220
    v_exp_f32 v221, v221
    v_exp_f32 v222, v222
    s_add_u32 m0, s61, 49152
    s_mul_i32 s59, s93, 112
    buffer_load_dwordx4 v236, s[24:27], s59 offen lds
    v_exp_f32 v223, v223
    v_mul_f32 v16, v16, v80
    v_mul_f32 v17, v17, v81
    v_mul_f32 v18, v18, v82
    buffer_load_dwordx4 v237, s[24:27], s59 offen offset:1024 lds
    v_mul_f32 v19, v19, v83
    v_fma_f32 v220, v220, v200, v200
    v_fma_f32 v221, v221, v200, v200
    v_fma_f32 v222, v222, v200, v200
    buffer_load_dwordx4 v242, s[4:7], s93 offen offset:2048 lds
    s_add_u32 s93, s93, 6144
    s_and_b32 s93, s93, 65535
    v_fma_f32 v223, v223, v200, v200
    v_rcp_f32 v220, v220
    v_rcp_f32 v221, v221
    v_rcp_f32 v222, v222
    s_barrier
    s_add_u32 m0, s62, 131072
    s_nop 0
    buffer_load_dwordx4 v191, s[4:7], s94 offen offset:2048 lds
    v_rcp_f32 v223, v223
    v_mul_f32 v16, v16, v220
    v_mul_f32 v17, v17, v221
    v_mul_f32 v18, v18, v222
    buffer_load_dwordx4 v191, s[4:7], s94 offen offset:3072 lds
    s_add_u32 s94, s94, 32768
    s_and_b32 s94, s94, 262143
    v_mul_f32 v19, v19, v223
    v_cvt_pk_bf16_f32 v226, v16, v17
    v_cvt_pk_bf16_f32 v227, v18, v19
    s_add_u32 s55, s89, 0
    buffer_store_dwordx4 v[224:227], v254, s[4:7], s55 offen sc0 sc1
    s_add_u32 m0, s61, 65536
    s_mul_i32 s59, s93, 112
    buffer_load_dwordx4 v236, s[24:27], s59 offen lds
    v_fmac_f32 v4, v193, v204
    v_fmac_f32 v5, v193, v205
    v_fmac_f32 v6, v193, v206
    v_fmac_f32 v7, v193, v207
    v_mul_f32 v220, v197, v4
    buffer_load_dwordx4 v237, s[24:27], s59 offen offset:1024 lds
    v_mul_f32 v221, v197, v5
    v_mul_f32 v222, v197, v6
    v_mul_f32 v223, v197, v7
    v_fmac_f32 v68, v193, v208
    buffer_load_dwordx4 v242, s[4:7], s93 offen offset:2048 lds
    s_add_u32 s93, s93, 2048
    s_and_b32 s93, s93, 65535
    v_fmac_f32 v69, v193, v209
    v_fmac_f32 v70, v193, v210
    v_fmac_f32 v71, v193, v211
    v_exp_f32 v220, v220
    v_exp_f32 v221, v221
    s_waitcnt vmcnt(14)
    s_barrier
    s_add_u32 m0, s62, 98304
    s_nop 0
    buffer_load_dwordx4 v191, s[4:7], s94 offen lds
    v_exp_f32 v222, v222
    v_exp_f32 v223, v223
    v_mul_f32 v4, v4, v68
    v_mul_f32 v5, v5, v69
    buffer_load_dwordx4 v191, s[4:7], s94 offen offset:1024 lds
    v_mul_f32 v6, v6, v70
    v_mul_f32 v7, v7, v71
    v_fma_f32 v220, v220, v201, v201
    v_fma_f32 v221, v221, v201, v201
    s_add_u32 m0, s61, 81920
    s_mul_i32 s59, s93, 112
    buffer_load_dwordx4 v236, s[24:27], s59 offen lds
    v_fma_f32 v222, v222, v201, v201
    v_fma_f32 v223, v223, v201, v201
    v_rcp_f32 v220, v220
    v_rcp_f32 v221, v221
    v_rcp_f32 v222, v222
    buffer_load_dwordx4 v237, s[24:27], s59 offen offset:1024 lds
    v_rcp_f32 v223, v223
    v_mul_f32 v4, v4, v220
    v_mul_f32 v5, v5, v221
    v_mul_f32 v6, v6, v222
    buffer_load_dwordx4 v242, s[4:7], s93 offen offset:2048 lds
    s_add_u32 s93, s93, 6144
    s_and_b32 s93, s93, 65535
    v_mul_f32 v7, v7, v223
    v_cvt_pk_bf16_f32 v228, v4, v5
    v_cvt_pk_bf16_f32 v229, v6, v7
    v_fmac_f32 v20, v193, v212
    v_fmac_f32 v21, v193, v213
    s_barrier
    s_add_u32 m0, s62, 98304
    s_nop 0
    buffer_load_dwordx4 v191, s[4:7], s94 offen offset:2048 lds
    v_fmac_f32 v22, v193, v214
    v_fmac_f32 v23, v193, v215
    v_mul_f32 v220, v197, v20
    v_mul_f32 v221, v197, v21
    buffer_load_dwordx4 v191, s[4:7], s94 offen offset:3072 lds
    s_add_u32 s94, s94, 32768
    s_and_b32 s94, s94, 262143
    v_mul_f32 v222, v197, v22
    v_mul_f32 v223, v197, v23
    v_fmac_f32 v84, v193, v216
    v_fmac_f32 v85, v193, v217
    v_fmac_f32 v86, v193, v218
    s_add_u32 m0, s61, 0
    s_mul_i32 s59, s93, 112
    buffer_load_dwordx4 v236, s[24:27], s59 offen lds
    v_fmac_f32 v87, v193, v219
    v_exp_f32 v220, v220
    v_exp_f32 v221, v221
    v_exp_f32 v222, v222
    buffer_load_dwordx4 v237, s[24:27], s59 offen offset:1024 lds
    v_exp_f32 v223, v223
    v_mul_f32 v20, v20, v84
    v_mul_f32 v21, v21, v85
    v_mul_f32 v22, v22, v86
    v_mul_f32 v23, v23, v87
    buffer_load_dwordx4 v242, s[4:7], s93 offen offset:2048 lds
    s_add_u32 s93, s93, 2048
    s_and_b32 s93, s93, 65535
    v_fma_f32 v220, v220, v201, v201
    v_fma_f32 v221, v221, v201, v201
    v_fma_f32 v222, v222, v201, v201
    v_fma_f32 v223, v223, v201, v201
    v_rcp_f32 v220, v220
    s_waitcnt vmcnt(14)
    s_barrier
    s_xor_b32 s55, s42, 3
    s_or_b32 s55, s46, s55
    s_cbranch_scc1 cf_27
    v_mov_b32 v252, 0
    v_mov_b32 v253, 1
    s_lshl_b32 s55, s2, 2
    s_add_u32 s55, s55, 71568384
    s_mov_b64 exec, 1
    buffer_store_dword v253, v252, s[4:7], s55 offen sc0 sc1
    s_mov_b64 exec, -1
cf_27:
    s_add_u32 m0, s62, 114688
    s_nop 0
    buffer_load_dwordx4 v191, s[4:7], s94 offen lds
    v_rcp_f32 v221, v221
    v_rcp_f32 v222, v222
    v_rcp_f32 v223, v223
    v_mul_f32 v20, v20, v220
    buffer_load_dwordx4 v191, s[4:7], s94 offen offset:1024 lds
    v_mul_f32 v21, v21, v221
    v_mul_f32 v22, v22, v222
    v_mul_f32 v23, v23, v223
    v_cvt_pk_bf16_f32 v230, v20, v21
    s_add_u32 m0, s61, 16384
    s_mul_i32 s59, s93, 112
    buffer_load_dwordx4 v236, s[24:27], s59 offen lds
    v_cvt_pk_bf16_f32 v231, v22, v23
    s_add_u32 s55, s89, 2048
    buffer_store_dwordx4 v[228:231], v254, s[4:7], s55 offen sc0 sc1
    v_fmac_f32 v8, v194, v204
    v_fmac_f32 v9, v194, v205
    v_fmac_f32 v10, v194, v206
    buffer_load_dwordx4 v237, s[24:27], s59 offen offset:1024 lds
    v_fmac_f32 v11, v194, v207
    v_mul_f32 v220, v198, v8
    v_mul_f32 v221, v198, v9
    v_mul_f32 v222, v198, v10
    buffer_load_dwordx4 v242, s[4:7], s93 offen offset:2048 lds
    s_add_u32 s93, s93, 6144
    s_and_b32 s93, s93, 65535
    v_mul_f32 v223, v198, v11
    v_fmac_f32 v72, v194, v208
    v_fmac_f32 v73, v194, v209
    v_fmac_f32 v74, v194, v210
    v_fmac_f32 v75, v194, v211
    s_barrier
    s_add_u32 m0, s62, 114688
    s_nop 0
    buffer_load_dwordx4 v191, s[4:7], s94 offen offset:2048 lds
    v_exp_f32 v220, v220
    v_exp_f32 v221, v221
    v_exp_f32 v222, v222
    v_exp_f32 v223, v223
    buffer_load_dwordx4 v191, s[4:7], s94 offen offset:3072 lds
    s_add_u32 s94, s94, 32768
    s_and_b32 s94, s94, 262143
    v_mul_f32 v8, v8, v72
    v_mul_f32 v9, v9, v73
    v_mul_f32 v10, v10, v74
    v_mul_f32 v11, v11, v75
    s_add_u32 m0, s61, 32768
    s_mul_i32 s59, s93, 112
    buffer_load_dwordx4 v236, s[24:27], s59 offen lds
    v_fma_f32 v220, v220, v202, v202
    v_fma_f32 v221, v221, v202, v202
    v_fma_f32 v222, v222, v202, v202
    v_fma_f32 v223, v223, v202, v202
    buffer_load_dwordx4 v237, s[24:27], s59 offen offset:1024 lds
    v_rcp_f32 v220, v220
    v_rcp_f32 v221, v221
    v_rcp_f32 v222, v222
    v_rcp_f32 v223, v223
    buffer_load_dwordx4 v242, s[4:7], s93 offen offset:2048 lds
    s_add_u32 s93, s93, 2048
    s_and_b32 s93, s93, 65535
    v_mul_f32 v8, v8, v220
    v_mul_f32 v9, v9, v221
    v_mul_f32 v10, v10, v222
    v_mul_f32 v11, v11, v223
    s_waitcnt vmcnt(14)
    s_barrier
    s_add_u32 m0, s62, 131072
    s_nop 0
    buffer_load_dwordx4 v191, s[4:7], s94 offen lds
    v_cvt_pk_bf16_f32 v224, v8, v9
    v_cvt_pk_bf16_f32 v225, v10, v11
    v_fmac_f32 v24, v194, v212
    v_fmac_f32 v25, v194, v213
    buffer_load_dwordx4 v191, s[4:7], s94 offen offset:1024 lds
    v_fmac_f32 v26, v194, v214
    v_fmac_f32 v27, v194, v215
    v_mul_f32 v220, v198, v24
    v_mul_f32 v221, v198, v25
    v_mul_f32 v222, v198, v26
    s_add_u32 m0, s61, 49152
    s_mul_i32 s59, s93, 112
    buffer_load_dwordx4 v236, s[24:27], s59 offen lds
    v_mul_f32 v223, v198, v27
    v_fmac_f32 v88, v194, v216
    v_fmac_f32 v89, v194, v217
    v_fmac_f32 v90, v194, v218
    v_fmac_f32 v91, v194, v219
    buffer_load_dwordx4 v237, s[24:27], s59 offen offset:1024 lds
    v_exp_f32 v220, v220
    v_exp_f32 v221, v221
    v_exp_f32 v222, v222
    v_exp_f32 v223, v223
    v_mul_f32 v24, v24, v88
    buffer_load_dwordx4 v242, s[4:7], s93 offen offset:2048 lds
    s_add_u32 s93, s93, 6144
    s_and_b32 s93, s93, 65535
    v_mul_f32 v25, v25, v89
    v_mul_f32 v26, v26, v90
    v_mul_f32 v27, v27, v91
    v_fma_f32 v220, v220, v202, v202
    v_fma_f32 v221, v221, v202, v202
    s_barrier
    s_add_u32 m0, s62, 131072
    s_nop 0
    buffer_load_dwordx4 v191, s[4:7], s94 offen offset:2048 lds
    v_fma_f32 v222, v222, v202, v202
    v_fma_f32 v223, v223, v202, v202
    v_rcp_f32 v220, v220
    v_rcp_f32 v221, v221
    buffer_load_dwordx4 v191, s[4:7], s94 offen offset:3072 lds
    s_add_u32 s94, s94, 32768
    s_and_b32 s94, s94, 262143
    v_rcp_f32 v222, v222
    v_rcp_f32 v223, v223
    v_mul_f32 v24, v24, v220
    v_mul_f32 v25, v25, v221
    s_add_u32 m0, s61, 65536
    s_mul_i32 s59, s93, 112
    buffer_load_dwordx4 v236, s[24:27], s59 offen lds
    v_mul_f32 v26, v26, v222
    v_mul_f32 v27, v27, v223
    v_cvt_pk_bf16_f32 v226, v24, v25
    v_cvt_pk_bf16_f32 v227, v26, v27
    buffer_load_dwordx4 v237, s[24:27], s59 offen offset:1024 lds
    s_add_u32 s55, s89, 4096
    buffer_store_dwordx4 v[224:227], v254, s[4:7], s55 offen sc0 sc1
    v_fmac_f32 v12, v195, v204
    v_fmac_f32 v13, v195, v205
    v_fmac_f32 v14, v195, v206
    buffer_load_dwordx4 v242, s[4:7], s93 offen offset:2048 lds
    s_add_u32 s93, s93, 2048
    s_and_b32 s93, s93, 65535
    v_fmac_f32 v15, v195, v207
    v_mul_f32 v220, v199, v12
    v_mul_f32 v221, v199, v13
    v_mul_f32 v222, v199, v14
    v_mul_f32 v223, v199, v15
    s_waitcnt vmcnt(14)
    s_barrier
    s_add_u32 m0, s62, 98304
    s_nop 0
    buffer_load_dwordx4 v191, s[4:7], s94 offen lds
    v_fmac_f32 v76, v195, v208
    v_fmac_f32 v77, v195, v209
    v_fmac_f32 v78, v195, v210
    v_fmac_f32 v79, v195, v211
    buffer_load_dwordx4 v191, s[4:7], s94 offen offset:1024 lds
    v_exp_f32 v220, v220
    v_exp_f32 v221, v221
    v_exp_f32 v222, v222
    v_exp_f32 v223, v223
    s_add_u32 m0, s61, 81920
    s_mul_i32 s59, s93, 112
    buffer_load_dwordx4 v236, s[24:27], s59 offen lds
    v_mul_f32 v12, v12, v76
    v_mul_f32 v13, v13, v77
    v_mul_f32 v14, v14, v78
    v_mul_f32 v15, v15, v79
    buffer_load_dwordx4 v237, s[24:27], s59 offen offset:1024 lds
    v_fma_f32 v220, v220, v203, v203
    v_fma_f32 v221, v221, v203, v203
    v_fma_f32 v222, v222, v203, v203
    v_fma_f32 v223, v223, v203, v203
    buffer_load_dwordx4 v242, s[4:7], s93 offen offset:2048 lds
    s_add_u32 s93, s93, 6144
    s_and_b32 s93, s93, 65535
    v_rcp_f32 v220, v220
    v_rcp_f32 v221, v221
    v_rcp_f32 v222, v222
    v_rcp_f32 v223, v223
    s_barrier
    s_add_u32 m0, s62, 98304
    s_nop 0
    buffer_load_dwordx4 v191, s[4:7], s94 offen offset:2048 lds
    v_mul_f32 v12, v12, v220
    v_mul_f32 v13, v13, v221
    v_mul_f32 v14, v14, v222
    v_mul_f32 v15, v15, v223
    buffer_load_dwordx4 v191, s[4:7], s94 offen offset:3072 lds
    s_add_u32 s94, s94, 32768
    s_and_b32 s94, s94, 262143
    v_cvt_pk_bf16_f32 v228, v12, v13
    v_cvt_pk_bf16_f32 v229, v14, v15
    v_fmac_f32 v28, v195, v212
    v_fmac_f32 v29, v195, v213
    v_fmac_f32 v30, v195, v214
    s_add_u32 m0, s61, 0
    s_mul_i32 s59, s93, 112
    buffer_load_dwordx4 v236, s[24:27], s59 offen lds
    v_fmac_f32 v31, v195, v215
    v_mul_f32 v220, v199, v28
    v_mul_f32 v221, v199, v29
    v_mul_f32 v222, v199, v30
    v_mul_f32 v223, v199, v31
    buffer_load_dwordx4 v237, s[24:27], s59 offen offset:1024 lds
    v_fmac_f32 v92, v195, v216
    v_fmac_f32 v93, v195, v217
    v_fmac_f32 v94, v195, v218
    v_fmac_f32 v95, v195, v219
    v_exp_f32 v220, v220
    buffer_load_dwordx4 v242, s[4:7], s93 offen offset:2048 lds
    s_add_u32 s93, s93, 2048
    s_and_b32 s93, s93, 65535
    v_exp_f32 v221, v221
    v_exp_f32 v222, v222
    v_exp_f32 v223, v223
    v_mul_f32 v28, v28, v92
    v_mul_f32 v29, v29, v93
    s_waitcnt vmcnt(14)
    s_barrier
    s_add_u32 m0, s62, 114688
    s_nop 0
    buffer_load_dwordx4 v191, s[4:7], s94 offen lds
    v_mul_f32 v30, v30, v94
    v_mul_f32 v31, v31, v95
    v_fma_f32 v220, v220, v203, v203
    buffer_load_dwordx4 v191, s[4:7], s94 offen offset:1024 lds
    v_fma_f32 v221, v221, v203, v203
    v_fma_f32 v222, v222, v203, v203
    v_fma_f32 v223, v223, v203, v203
    s_add_u32 m0, s61, 16384
    s_mul_i32 s59, s93, 112
    buffer_load_dwordx4 v236, s[24:27], s59 offen lds
    v_rcp_f32 v220, v220
    v_rcp_f32 v221, v221
    v_rcp_f32 v222, v222
    v_rcp_f32 v223, v223
    buffer_load_dwordx4 v237, s[24:27], s59 offen offset:1024 lds
    v_mul_f32 v28, v28, v220
    v_mul_f32 v29, v29, v221
    v_mul_f32 v30, v30, v222
    buffer_load_dwordx4 v242, s[4:7], s93 offen offset:2048 lds
    s_add_u32 s93, s93, 6144
    s_and_b32 s93, s93, 65535
    v_mul_f32 v31, v31, v223
    v_cvt_pk_bf16_f32 v230, v28, v29
    v_cvt_pk_bf16_f32 v231, v30, v31
    s_add_u32 s55, s89, 6144
    buffer_store_dwordx4 v[228:231], v254, s[4:7], s55 offen sc0 sc1
    s_barrier
    s_add_u32 m0, s62, 114688
    s_nop 0
    buffer_load_dwordx4 v191, s[4:7], s94 offen offset:2048 lds
    ds_read_b128 v[204:207], v235 offset:128
    ds_read_b128 v[208:211], v235 offset:640
    ds_read_b128 v[212:215], v235 offset:192
    ds_read_b128 v[216:219], v235 offset:704
    s_waitcnt lgkmcnt(0)
    buffer_load_dwordx4 v191, s[4:7], s94 offen offset:3072 lds
    s_add_u32 s94, s94, 32768
    s_and_b32 s94, s94, 262143
    v_fmac_f32 v32, v192, v204
    v_fmac_f32 v33, v192, v205
    v_fmac_f32 v34, v192, v206
    v_fmac_f32 v35, v192, v207
    v_mul_f32 v220, v196, v32
    s_add_u32 m0, s61, 32768
    s_mul_i32 s59, s93, 112
    buffer_load_dwordx4 v236, s[24:27], s59 offen lds
    v_mul_f32 v221, v196, v33
    v_mul_f32 v222, v196, v34
    v_mul_f32 v223, v196, v35
    v_fmac_f32 v96, v192, v208
    v_fmac_f32 v97, v192, v209
    buffer_load_dwordx4 v237, s[24:27], s59 offen offset:1024 lds
    v_fmac_f32 v98, v192, v210
    v_fmac_f32 v99, v192, v211
    v_exp_f32 v220, v220
    v_exp_f32 v221, v221
    v_exp_f32 v222, v222
    buffer_load_dwordx4 v242, s[4:7], s93 offen offset:2048 lds
    s_add_u32 s93, s93, 2048
    s_and_b32 s93, s93, 65535
    v_exp_f32 v223, v223
    v_mul_f32 v32, v32, v96
    v_mul_f32 v33, v33, v97
    v_mul_f32 v34, v34, v98
    v_mul_f32 v35, v35, v99
    v_fma_f32 v220, v220, v200, v200
    s_waitcnt vmcnt(14)
    s_barrier
    s_add_u32 m0, s62, 131072
    s_nop 0
    buffer_load_dwordx4 v191, s[4:7], s94 offen lds
    v_fma_f32 v221, v221, v200, v200
    v_fma_f32 v222, v222, v200, v200
    v_fma_f32 v223, v223, v200, v200
    v_rcp_f32 v220, v220
    buffer_load_dwordx4 v191, s[4:7], s94 offen offset:1024 lds
    v_rcp_f32 v221, v221
    v_rcp_f32 v222, v222
    v_rcp_f32 v223, v223
    v_mul_f32 v32, v32, v220
    v_mul_f32 v33, v33, v221
    s_add_u32 m0, s61, 49152
    s_mul_i32 s59, s93, 112
    buffer_load_dwordx4 v236, s[24:27], s59 offen lds
    v_mul_f32 v34, v34, v222
    v_mul_f32 v35, v35, v223
    v_cvt_pk_bf16_f32 v224, v32, v33
    v_cvt_pk_bf16_f32 v225, v34, v35
    v_fmac_f32 v48, v192, v212
    buffer_load_dwordx4 v237, s[24:27], s59 offen offset:1024 lds
    v_fmac_f32 v49, v192, v213
    v_fmac_f32 v50, v192, v214
    v_fmac_f32 v51, v192, v215
    v_mul_f32 v220, v196, v48
    v_mul_f32 v221, v196, v49
    buffer_load_dwordx4 v242, s[4:7], s93 offen offset:2048 lds
    s_add_u32 s93, s93, 10240
    s_and_b32 s93, s93, 65535
    v_mul_f32 v222, v196, v50
    v_mul_f32 v223, v196, v51
    v_fmac_f32 v112, v192, v216
    v_fmac_f32 v113, v192, v217
    v_fmac_f32 v114, v192, v218
    s_barrier
    s_add_u32 m0, s62, 131072
    s_nop 0
    buffer_load_dwordx4 v191, s[4:7], s94 offen offset:2048 lds
    v_fmac_f32 v115, v192, v219
    v_exp_f32 v220, v220
    v_exp_f32 v221, v221
    v_exp_f32 v222, v222
    buffer_load_dwordx4 v191, s[4:7], s94 offen offset:3072 lds
    s_add_u32 s94, s94, 49152
    s_and_b32 s94, s94, 262143
    v_exp_f32 v223, v223
    v_mul_f32 v48, v48, v112
    v_mul_f32 v49, v49, v113
    v_mul_f32 v50, v50, v114
    s_add_u32 m0, s61, 65536
    s_mul_i32 s59, s93, 112
    buffer_load_dwordx4 v236, s[24:27], s59 offen lds
    v_mul_f32 v51, v51, v115
    v_fma_f32 v220, v220, v200, v200
    v_fma_f32 v221, v221, v200, v200
    v_fma_f32 v222, v222, v200, v200
    buffer_load_dwordx4 v237, s[24:27], s59 offen offset:1024 lds
    v_fma_f32 v223, v223, v200, v200
    v_rcp_f32 v220, v220
    v_rcp_f32 v221, v221
    v_rcp_f32 v222, v222
    buffer_load_dwordx4 v242, s[4:7], s93 offen offset:2048 lds
    s_add_u32 s93, s93, 2048
    s_and_b32 s93, s93, 65535
    v_rcp_f32 v223, v223
    v_mul_f32 v48, v48, v220
    v_mul_f32 v49, v49, v221
    v_mul_f32 v50, v50, v222
    s_waitcnt vmcnt(13)
    s_barrier
    s_cmp_lg_u32 s42, 0
    s_cbranch_scc1 wf_28
    s_lshr_b32 s55, s2, 5
    s_lshl_b32 s55, s55, 2
    s_add_u32 s55, s55, s0
    v_mov_b32 v252, 2048
    v_mov_b32 v253, 0x01010101
    s_mov_b64 exec, 1
    s_cmp_eq_u32 s45, 0
    s_cbranch_scc1 st_29
    buffer_store_dword v253, v252, s[4:7], s55 offen sc0 sc1
    s_branch st_30
st_29:
    buffer_store_dword v253, v252, s[4:7], s55 offen
st_30:
    s_mov_b64 exec, -1
wf_28:
    s_add_u32 m0, s62, 98304
    s_nop 0
    buffer_load_dwordx4 v191, s[4:7], s94 offen lds
    v_mul_f32 v51, v51, v223
    v_cvt_pk_bf16_f32 v226, v48, v49
    v_cvt_pk_bf16_f32 v227, v50, v51
    s_add_u32 s55, s89, 131072
    buffer_store_dwordx4 v[224:227], v254, s[4:7], s55 offen sc0 sc1
    buffer_load_dwordx4 v191, s[4:7], s94 offen offset:1024 lds
    v_fmac_f32 v36, v193, v204
    v_fmac_f32 v37, v193, v205
    v_fmac_f32 v38, v193, v206
    v_fmac_f32 v39, v193, v207
    s_add_u32 m0, s61, 81920
    s_mul_i32 s59, s93, 112
    buffer_load_dwordx4 v236, s[24:27], s59 offen lds
    v_mul_f32 v220, v197, v36
    v_mul_f32 v221, v197, v37
    v_mul_f32 v222, v197, v38
    v_mul_f32 v223, v197, v39
    buffer_load_dwordx4 v237, s[24:27], s59 offen offset:1024 lds
    v_fmac_f32 v100, v193, v208
    v_fmac_f32 v101, v193, v209
    v_fmac_f32 v102, v193, v210
    v_fmac_f32 v103, v193, v211
    buffer_load_dwordx4 v242, s[4:7], s93 offen offset:2048 lds
    s_add_u32 s93, s93, 6144
    s_and_b32 s93, s93, 65535
    v_exp_f32 v220, v220
    v_exp_f32 v221, v221
    v_exp_f32 v222, v222
    v_exp_f32 v223, v223
    v_mul_f32 v36, v36, v100
    s_barrier
    s_add_u32 m0, s62, 98304
    s_nop 0
    buffer_load_dwordx4 v191, s[4:7], s94 offen offset:2048 lds
    v_mul_f32 v37, v37, v101
    v_mul_f32 v38, v38, v102
    v_mul_f32 v39, v39, v103
    v_fma_f32 v220, v220, v201, v201
    buffer_load_dwordx4 v191, s[4:7], s94 offen offset:3072 lds
    s_add_u32 s94, s94, 32768
    s_and_b32 s94, s94, 262143
    v_fma_f32 v221, v221, v201, v201
    v_fma_f32 v222, v222, v201, v201
    v_fma_f32 v223, v223, v201, v201
    v_rcp_f32 v220, v220
    v_rcp_f32 v221, v221
    s_add_u32 m0, s61, 0
    s_mul_i32 s59, s93, 112
    buffer_load_dwordx4 v236, s[24:27], s59 offen lds
    v_rcp_f32 v222, v222
    v_rcp_f32 v223, v223
    v_mul_f32 v36, v36, v220
    v_mul_f32 v37, v37, v221
    v_mul_f32 v38, v38, v222
    buffer_load_dwordx4 v237, s[24:27], s59 offen offset:1024 lds
    v_mul_f32 v39, v39, v223
    v_cvt_pk_bf16_f32 v228, v36, v37
    v_cvt_pk_bf16_f32 v229, v38, v39
    v_fmac_f32 v52, v193, v212
    v_fmac_f32 v53, v193, v213
    buffer_load_dwordx4 v242, s[4:7], s93 offen offset:2048 lds
    s_add_u32 s93, s93, 2048
    s_and_b32 s93, s93, 65535
    v_fmac_f32 v54, v193, v214
    v_fmac_f32 v55, v193, v215
    v_mul_f32 v220, v197, v52
    v_mul_f32 v221, v197, v53
    v_mul_f32 v222, v197, v54
    s_waitcnt vmcnt(14)
    s_barrier
    s_add_u32 m0, s62, 114688
    s_nop 0
    buffer_load_dwordx4 v191, s[4:7], s94 offen lds
    v_mul_f32 v223, v197, v55
    v_fmac_f32 v116, v193, v216
    v_fmac_f32 v117, v193, v217
    v_fmac_f32 v118, v193, v218
    buffer_load_dwordx4 v191, s[4:7], s94 offen offset:1024 lds
    v_fmac_f32 v119, v193, v219
    v_exp_f32 v220, v220
    v_exp_f32 v221, v221
    v_exp_f32 v222, v222
    s_add_u32 m0, s61, 16384
    s_mul_i32 s59, s93, 112
    buffer_load_dwordx4 v236, s[24:27], s59 offen lds
    v_exp_f32 v223, v223
    v_mul_f32 v52, v52, v116
    v_mul_f32 v53, v53, v117
    v_mul_f32 v54, v54, v118
    buffer_load_dwordx4 v237, s[24:27], s59 offen offset:1024 lds
    v_mul_f32 v55, v55, v119
    v_fma_f32 v220, v220, v201, v201
    v_fma_f32 v221, v221, v201, v201
    v_fma_f32 v222, v222, v201, v201
    buffer_load_dwordx4 v242, s[4:7], s93 offen offset:2048 lds
    s_add_u32 s93, s93, 6144
    s_and_b32 s93, s93, 65535
    v_fma_f32 v223, v223, v201, v201
    v_rcp_f32 v220, v220
    v_rcp_f32 v221, v221
    v_rcp_f32 v222, v222
    s_barrier
    s_add_u32 m0, s62, 114688
    s_nop 0
    buffer_load_dwordx4 v191, s[4:7], s94 offen offset:2048 lds
    v_rcp_f32 v223, v223
    v_mul_f32 v52, v52, v220
    v_mul_f32 v53, v53, v221
    v_mul_f32 v54, v54, v222
    buffer_load_dwordx4 v191, s[4:7], s94 offen offset:3072 lds
    s_add_u32 s94, s94, 32768
    s_and_b32 s94, s94, 262143
    v_mul_f32 v55, v55, v223
    v_cvt_pk_bf16_f32 v230, v52, v53
    v_cvt_pk_bf16_f32 v231, v54, v55
    s_add_u32 s55, s89, 133120
    buffer_store_dwordx4 v[228:231], v254, s[4:7], s55 offen sc0 sc1
    s_add_u32 m0, s61, 32768
    s_mul_i32 s59, s93, 112
    buffer_load_dwordx4 v236, s[24:27], s59 offen lds
    v_fmac_f32 v40, v194, v204
    v_fmac_f32 v41, v194, v205
    v_fmac_f32 v42, v194, v206
    v_fmac_f32 v43, v194, v207
    v_mul_f32 v220, v198, v40
    buffer_load_dwordx4 v237, s[24:27], s59 offen offset:1024 lds
    v_mul_f32 v221, v198, v41
    v_mul_f32 v222, v198, v42
    v_mul_f32 v223, v198, v43
    v_fmac_f32 v104, v194, v208
    buffer_load_dwordx4 v242, s[4:7], s93 offen offset:2048 lds
    s_add_u32 s93, s93, 2048
    s_and_b32 s93, s93, 65535
    v_fmac_f32 v105, v194, v209
    v_fmac_f32 v106, v194, v210
    v_fmac_f32 v107, v194, v211
    v_exp_f32 v220, v220
    v_exp_f32 v221, v221
    s_waitcnt vmcnt(14)
    s_barrier
    s_mov_b32 s55, 71568384
    buffer_load_dwordx4 v[184:187], v254, s[4:7], s55 offen sc0 sc1
    s_add_u32 m0, s62, 131072
    s_nop 0
    buffer_load_dwordx4 v191, s[4:7], s94 offen lds
    v_exp_f32 v222, v222
    v_exp_f32 v223, v223
    v_mul_f32 v40, v40, v104
    v_mul_f32 v41, v41, v105
    buffer_load_dwordx4 v191, s[4:7], s94 offen offset:1024 lds
    v_mul_f32 v42, v42, v106
    v_mul_f32 v43, v43, v107
    v_fma_f32 v220, v220, v202, v202
    v_fma_f32 v221, v221, v202, v202
    s_add_u32 m0, s61, 49152
    s_mul_i32 s59, s93, 112
    buffer_load_dwordx4 v236, s[24:27], s59 offen lds
    v_fma_f32 v222, v222, v202, v202
    v_fma_f32 v223, v223, v202, v202
    v_rcp_f32 v220, v220
    v_rcp_f32 v221, v221
    v_rcp_f32 v222, v222
    buffer_load_dwordx4 v237, s[24:27], s59 offen offset:1024 lds
    v_rcp_f32 v223, v223
    v_mul_f32 v40, v40, v220
    v_mul_f32 v41, v41, v221
    v_mul_f32 v42, v42, v222
    buffer_load_dwordx4 v242, s[4:7], s93 offen offset:2048 lds
    s_add_u32 s93, s93, 6144
    s_and_b32 s93, s93, 65535
    v_mul_f32 v43, v43, v223
    v_cvt_pk_bf16_f32 v224, v40, v41
    v_cvt_pk_bf16_f32 v225, v42, v43
    v_fmac_f32 v56, v194, v212
    v_fmac_f32 v57, v194, v213
    s_barrier
    s_add_u32 m0, s62, 131072
    s_nop 0
    buffer_load_dwordx4 v191, s[4:7], s94 offen offset:2048 lds
    v_fmac_f32 v58, v194, v214
    v_fmac_f32 v59, v194, v215
    v_mul_f32 v220, v198, v56
    v_mul_f32 v221, v198, v57
    buffer_load_dwordx4 v191, s[4:7], s94 offen offset:3072 lds
    s_add_u32 s94, s94, 32768
    s_and_b32 s94, s94, 262143
    v_mul_f32 v222, v198, v58
    v_mul_f32 v223, v198, v59
    v_fmac_f32 v120, v194, v216
    v_fmac_f32 v121, v194, v217
    v_fmac_f32 v122, v194, v218
    s_add_u32 m0, s61, 65536
    s_mul_i32 s59, s93, 112
    buffer_load_dwordx4 v236, s[24:27], s59 offen lds
    v_fmac_f32 v123, v194, v219
    v_exp_f32 v220, v220
    v_exp_f32 v221, v221
    v_exp_f32 v222, v222
    buffer_load_dwordx4 v237, s[24:27], s59 offen offset:1024 lds
    v_exp_f32 v223, v223
    v_mul_f32 v56, v56, v120
    v_mul_f32 v57, v57, v121
    v_mul_f32 v58, v58, v122
    v_mul_f32 v59, v59, v123
    buffer_load_dwordx4 v242, s[4:7], s93 offen offset:2048 lds
    s_add_u32 s93, s93, 2048
    s_and_b32 s93, s93, 65535
    v_fma_f32 v220, v220, v202, v202
    v_fma_f32 v221, v221, v202, v202
    v_fma_f32 v222, v222, v202, v202
    v_fma_f32 v223, v223, v202, v202
    v_rcp_f32 v220, v220
    s_waitcnt vmcnt(15)
    s_barrier
    s_add_u32 m0, s62, 98304
    s_nop 0
    buffer_load_dwordx4 v191, s[4:7], s94 offen lds
    v_rcp_f32 v221, v221
    v_rcp_f32 v222, v222
    v_rcp_f32 v223, v223
    v_mul_f32 v56, v56, v220
    buffer_load_dwordx4 v191, s[4:7], s94 offen offset:1024 lds
    v_mul_f32 v57, v57, v221
    v_mul_f32 v58, v58, v222
    v_mul_f32 v59, v59, v223
    v_cvt_pk_bf16_f32 v226, v56, v57
    s_add_u32 m0, s61, 81920
    s_mul_i32 s59, s93, 112
    buffer_load_dwordx4 v236, s[24:27], s59 offen lds
    v_cvt_pk_bf16_f32 v227, v58, v59
    s_add_u32 s55, s89, 135168
    buffer_store_dwordx4 v[224:227], v254, s[4:7], s55 offen sc0 sc1
    v_fmac_f32 v44, v195, v204
    v_fmac_f32 v45, v195, v205
    v_fmac_f32 v46, v195, v206
    buffer_load_dwordx4 v237, s[24:27], s59 offen offset:1024 lds
    v_fmac_f32 v47, v195, v207
    v_mul_f32 v220, v199, v44
    v_mul_f32 v221, v199, v45
    v_mul_f32 v222, v199, v46
    buffer_load_dwordx4 v242, s[4:7], s93 offen offset:2048 lds
    s_add_u32 s93, s93, 6144
    s_and_b32 s93, s93, 65535
    v_mul_f32 v223, v199, v47
    v_fmac_f32 v108, v195, v208
    v_fmac_f32 v109, v195, v209
    v_fmac_f32 v110, v195, v210
    v_fmac_f32 v111, v195, v211
    s_barrier
    s_waitcnt vmcnt(16)
    s_cmp_eq_u32 s46, 1
    s_cbranch_scc1 a4_31
    v_and_b32 v184, v184, v185
    v_and_b32 v186, v186, v187
    v_and_b32 v184, v184, v186
    v_cmp_ne_u32 vcc, 1, v184
    s_cbranch_vccz a4_31
    s_mov_b32 s55, 71568384
    s_mov_b32 s56, 262144
p4_32:
    buffer_load_dwordx4 v[184:187], v254, s[4:7], s55 offen sc0 sc1
    s_waitcnt vmcnt(0)
    v_and_b32 v184, v184, v185
    v_and_b32 v186, v186, v187
    v_and_b32 v184, v184, v186
    v_cmp_ne_u32 vcc, 1, v184
    s_cbranch_vccz p4_33
    s_sleep 1
    s_sub_u32 s56, s56, 1
    s_cmp_lg_u32 s56, 0
    s_cbranch_scc1 p4_32
p4_33:
a4_31:
    s_add_u32 m0, s62, 98304
    s_nop 0
    buffer_load_dwordx4 v191, s[4:7], s94 offen offset:2048 lds
    v_exp_f32 v220, v220
    v_exp_f32 v221, v221
    v_exp_f32 v222, v222
    v_exp_f32 v223, v223
    buffer_load_dwordx4 v191, s[4:7], s94 offen offset:3072 lds
    s_add_u32 s94, s94, 32768
    s_and_b32 s94, s94, 262143
    v_mul_f32 v44, v44, v108
    v_mul_f32 v45, v45, v109
    v_mul_f32 v46, v46, v110
    v_mul_f32 v47, v47, v111
    s_add_u32 m0, s61, 0
    s_mul_i32 s59, s93, 112
    buffer_load_dwordx4 v236, s[24:27], s59 offen lds
    v_fma_f32 v220, v220, v203, v203
    v_fma_f32 v221, v221, v203, v203
    v_fma_f32 v222, v222, v203, v203
    v_fma_f32 v223, v223, v203, v203
    buffer_load_dwordx4 v237, s[24:27], s59 offen offset:1024 lds
    v_rcp_f32 v220, v220
    v_rcp_f32 v221, v221
    v_rcp_f32 v222, v222
    v_rcp_f32 v223, v223
    buffer_load_dwordx4 v242, s[4:7], s93 offen offset:2048 lds
    s_add_u32 s93, s93, 2048
    s_and_b32 s93, s93, 65535
    v_mul_f32 v44, v44, v220
    v_mul_f32 v45, v45, v221
    v_mul_f32 v46, v46, v222
    v_mul_f32 v47, v47, v223
    s_waitcnt vmcnt(14)
    s_barrier
    v_lshrrev_b32 v252, 2, v254
    v_min_u32 v252, 28, v252
    s_add_u32 s55, s0, 2048
    buffer_load_dword v232, v252, s[4:7], s55 offen sc0 sc1
    s_add_u32 m0, s62, 114688
    s_nop 0
    buffer_load_dwordx4 v191, s[4:7], s94 offen lds
    v_cvt_pk_bf16_f32 v228, v44, v45
    v_cvt_pk_bf16_f32 v229, v46, v47
    v_fmac_f32 v60, v195, v212
    v_fmac_f32 v61, v195, v213
    buffer_load_dwordx4 v191, s[4:7], s94 offen offset:1024 lds
    v_fmac_f32 v62, v195, v214
    v_fmac_f32 v63, v195, v215
    v_mul_f32 v220, v199, v60
    v_mul_f32 v221, v199, v61
    v_mul_f32 v222, v199, v62
    s_add_u32 m0, s61, 16384
    s_mul_i32 s59, s93, 112
    buffer_load_dwordx4 v236, s[24:27], s59 offen lds
    v_mul_f32 v223, v199, v63
    v_fmac_f32 v124, v195, v216
    v_fmac_f32 v125, v195, v217
    v_fmac_f32 v126, v195, v218
    v_fmac_f32 v127, v195, v219
    buffer_load_dwordx4 v237, s[24:27], s59 offen offset:1024 lds
    v_exp_f32 v220, v220
    v_exp_f32 v221, v221
    v_exp_f32 v222, v222
    v_exp_f32 v223, v223
    v_mul_f32 v60, v60, v124
    buffer_load_dwordx4 v242, s[4:7], s93 offen offset:2048 lds
    v_mul_f32 v61, v61, v125
    v_mul_f32 v62, v62, v126
    v_mul_f32 v63, v63, v127
    v_fma_f32 v220, v220, v203, v203
    v_fma_f32 v221, v221, v203, v203
    s_barrier
    s_add_u32 m0, s62, 114688
    s_nop 0
    buffer_load_dwordx4 v191, s[4:7], s94 offen offset:2048 lds
    v_fma_f32 v222, v222, v203, v203
    v_fma_f32 v223, v223, v203, v203
    buffer_load_dwordx4 v191, s[4:7], s94 offen offset:3072 lds
    v_rcp_f32 v220, v220
    v_rcp_f32 v221, v221
    s_add_u32 m0, s62, 32768
    s_add_u32 s59, s68, 0
    buffer_load_dwordx4 v238, s[20:23], s59 offen lds
    v_rcp_f32 v222, v222
    v_rcp_f32 v223, v223
    buffer_load_dwordx4 v239, s[20:23], s59 offen offset:1024 lds
    v_mul_f32 v60, v60, v220
    v_mul_f32 v61, v61, v221
    buffer_load_dwordx4 v240, s[20:23], s59 offen offset:2048 lds
    v_mul_f32 v62, v62, v222
    v_mul_f32 v63, v63, v223
    buffer_load_dwordx4 v241, s[20:23], s59 offen offset:3072 lds
    v_cvt_pk_bf16_f32 v230, v60, v61
    v_cvt_pk_bf16_f32 v231, v62, v63
    s_add_u32 s55, s89, 137216
    buffer_store_dwordx4 v[228:231], v254, s[4:7], s55 offen sc0 sc1
    s_waitcnt vmcnt(16)
    s_barrier
    s_waitcnt vmcnt(12)
    v_cmp_ne_u32 vcc, 0x01010101, v232
    s_cbranch_vccz ap_34
    v_lshrrev_b32 v252, 2, v254
    v_min_u32 v252, 28, v252
    s_add_u32 s55, s0, 2048
    s_mov_b32 s56, 262144
poll_35:
    buffer_load_dword v253, v252, s[4:7], s55 offen sc0 sc1
    s_waitcnt vmcnt(0)
    v_cmp_ne_u32 vcc, 0x01010101, v253
    s_cbranch_vccz pd_36
    s_sleep 1
    s_sub_u32 s56, s56, 1
    s_cmp_lg_u32 s56, 0
    s_cbranch_scc1 poll_35
pd_36:
ap_34:
    s_add_u32 s88, s95, s62
    v_add_u32 v191, s88, v254
    s_add_u32 m0, s62, 131072
    s_mov_b32 s92, 0
    buffer_load_dwordx4 v191, s[4:7], s92 offen lds
    buffer_load_dwordx4 v191, s[4:7], s92 offen offset:1024 lds
    s_add_u32 m0, s62, 49152
    s_add_u32 s59, s68, 655360
    buffer_load_dwordx4 v238, s[20:23], s59 offen lds
    buffer_load_dwordx4 v239, s[20:23], s59 offen offset:1024 lds
    buffer_load_dwordx4 v240, s[20:23], s59 offen offset:2048 lds
    buffer_load_dwordx4 v241, s[20:23], s59 offen offset:3072 lds
    s_barrier
    s_add_u32 m0, s62, 131072
    s_mov_b32 s92, 0
    buffer_load_dwordx4 v191, s[4:7], s92 offen offset:2048 lds
    buffer_load_dwordx4 v191, s[4:7], s92 offen offset:3072 lds
    s_add_u32 m0, s62, 65536
    s_add_u32 s59, s68, 917504
    buffer_load_dwordx4 v238, s[20:23], s59 offen lds
    buffer_load_dwordx4 v239, s[20:23], s59 offen offset:1024 lds
    buffer_load_dwordx4 v240, s[20:23], s59 offen offset:2048 lds
    buffer_load_dwordx4 v241, s[20:23], s59 offen offset:3072 lds
    s_waitcnt vmcnt(17)
    s_barrier
    s_add_u32 m0, s62, 98304
    s_mov_b32 s92, 16384
    buffer_load_dwordx4 v191, s[4:7], s92 offen lds
    buffer_load_dwordx4 v191, s[4:7], s92 offen offset:1024 lds
    s_add_u32 m0, s62, 81920
    s_add_u32 s59, s68, 1572864
    buffer_load_dwordx4 v238, s[20:23], s59 offen lds
    buffer_load_dwordx4 v239, s[20:23], s59 offen offset:1024 lds
    buffer_load_dwordx4 v240, s[20:23], s59 offen offset:2048 lds
    buffer_load_dwordx4 v241, s[20:23], s59 offen offset:3072 lds
    s_waitcnt vmcnt(18)
    s_barrier
    s_cmp_lg_u32 s42, 1
    s_cbranch_scc1 wf_37
    s_lshr_b32 s55, s2, 5
    s_lshl_b32 s55, s55, 2
    s_add_u32 s55, s55, s0
    v_mov_b32 v252, 2080
    v_mov_b32 v253, 0x01010101
    s_mov_b64 exec, 1
    s_cmp_eq_u32 s45, 0
    s_cbranch_scc1 st_38
    buffer_store_dword v253, v252, s[4:7], s55 offen sc0 sc1
    s_branch st_39
st_38:
    buffer_store_dword v253, v252, s[4:7], s55 offen
st_39:
    s_mov_b64 exec, -1
wf_37:
    s_add_u32 m0, s62, 98304
    s_mov_b32 s92, 16384
    buffer_load_dwordx4 v191, s[4:7], s92 offen offset:2048 lds
    buffer_load_dwordx4 v191, s[4:7], s92 offen offset:3072 lds
    s_add_u32 m0, s62, 0
    s_add_u32 s59, s68, 1835008
    buffer_load_dwordx4 v238, s[20:23], s59 offen lds
    buffer_load_dwordx4 v239, s[20:23], s59 offen offset:1024 lds
    buffer_load_dwordx4 v240, s[20:23], s59 offen offset:2048 lds
    buffer_load_dwordx4 v241, s[20:23], s59 offen offset:3072 lds
    s_waitcnt vmcnt(16)
    s_barrier
    ds_read_b64_tr_b16 v[32:33], v244 offset:32768
    ds_read_b64_tr_b16 v[34:35], v244 offset:36864
    ds_read_b128 v[0:3], v243 offset:32768
    ds_read_b128 v[4:7], v243 offset:34816
    ds_read_b128 v[8:11], v243 offset:36864
    ds_read_b128 v[12:15], v243 offset:38912
    ds_read_b64_tr_b16 v[36:37], v245 offset:32768
    ds_read_b64_tr_b16 v[38:39], v245 offset:36864
    ds_read_b64_tr_b16 v[40:41], v246 offset:32768
    ds_read_b64_tr_b16 v[42:43], v246 offset:36864
    ds_read_b64_tr_b16 v[44:45], v247 offset:32768
    ds_read_b64_tr_b16 v[46:47], v247 offset:36864
    ds_read_b64_tr_b16 v[48:49], v244 offset:40960
    ds_read_b64_tr_b16 v[50:51], v244 offset:45056
    ds_read_b128 v[16:19], v243 offset:33792
    ds_read_b128 v[20:23], v243 offset:35840
    ds_read_b128 v[24:27], v243 offset:37888
    ds_read_b128 v[28:31], v243 offset:39936
    ds_read_b64_tr_b16 v[52:53], v245 offset:40960
    ds_read_b64_tr_b16 v[54:55], v245 offset:45056
    ds_read_b64_tr_b16 v[56:57], v246 offset:40960
    ds_read_b64_tr_b16 v[58:59], v246 offset:45056
    ds_read_b64_tr_b16 v[60:61], v247 offset:40960
    ds_read_b64_tr_b16 v[62:63], v247 offset:45056
    s_add_u32 m0, s62, 114688
    s_mov_b32 s92, 32768
    buffer_load_dwordx4 v191, s[4:7], s92 offen lds
    buffer_load_dwordx4 v191, s[4:7], s92 offen offset:1024 lds
    buffer_load_dwordx4 v191, s[4:7], s92 offen offset:2048 lds
    buffer_load_dwordx4 v191, s[4:7], s92 offen offset:3072 lds
    s_setprio 0
    s_lshl_b32 s55, s51, 14
    s_add_u32 s55, s55, s62
    s_add_u32 s55, s55, s47
    s_add_u32 s88, s55, 1310720
    s_xor_b32 s89, s88, 16384
    s_add_u32 s59, s1, s49
    s_add_u32 s60, s59, 4096
    s_mov_b32 s58, 4
    s_waitcnt vmcnt(8) lgkmcnt(0)
    s_barrier
    .p2align 3
    v_mfma_f32_16x16x32_bf16 v[128:131], v[32:35], v[0:3], 0
    ds_read_b64_tr_b16 v[96:97], v248 offset:0
    v_mfma_f32_16x16x32_bf16 v[128:131], v[48:51], v[16:19], v[128:131]
    ds_read_b64_tr_b16 v[98:99], v248 offset:4096
    v_mfma_f32_16x16x32_bf16 v[132:135], v[48:51], v[20:23], 0
    ds_read_b128 v[64:67], v243 offset:0
    v_mfma_f32_16x16x32_bf16 v[132:135], v[32:35], v[4:7], v[132:135]
    ds_read_b128 v[68:71], v243 offset:2048
    v_mfma_f32_16x16x32_bf16 v[136:139], v[32:35], v[8:11], 0
    ds_read_b128 v[72:75], v243 offset:4096
    v_mfma_f32_16x16x32_bf16 v[136:139], v[48:51], v[24:27], v[136:139]
    ds_read_b128 v[76:79], v243 offset:6144
    v_mfma_f32_16x16x32_bf16 v[140:143], v[48:51], v[28:31], 0
    ds_read_b64_tr_b16 v[100:101], v249 offset:0
    v_mfma_f32_16x16x32_bf16 v[140:143], v[32:35], v[12:15], v[140:143]
    ds_read_b64_tr_b16 v[102:103], v249 offset:4096
    v_mfma_f32_16x16x32_bf16 v[156:159], v[36:39], v[12:15], 0
    v_mfma_f32_16x16x32_bf16 v[156:159], v[52:55], v[28:31], v[156:159]
    ds_read_b64_tr_b16 v[104:105], v250 offset:0
    v_mfma_f32_16x16x32_bf16 v[152:155], v[52:55], v[24:27], 0
    ds_read_b64_tr_b16 v[106:107], v250 offset:4096
    v_mfma_f32_16x16x32_bf16 v[152:155], v[36:39], v[8:11], v[152:155]
    ds_read_b64_tr_b16 v[108:109], v251 offset:0
    v_mfma_f32_16x16x32_bf16 v[148:151], v[36:39], v[4:7], 0
    ds_read_b64_tr_b16 v[110:111], v251 offset:4096
    v_mfma_f32_16x16x32_bf16 v[148:151], v[52:55], v[20:23], v[148:151]
    ds_read_b64_tr_b16 v[112:113], v248 offset:8192
    v_mfma_f32_16x16x32_bf16 v[144:147], v[52:55], v[16:19], 0
    ds_read_b64_tr_b16 v[114:115], v248 offset:12288
    v_mfma_f32_16x16x32_bf16 v[144:147], v[36:39], v[0:3], v[144:147]
    ds_read_b128 v[80:83], v243 offset:1024
    v_mfma_f32_16x16x32_bf16 v[160:163], v[40:43], v[0:3], 0
    ds_read_b128 v[84:87], v243 offset:3072
    v_mfma_f32_16x16x32_bf16 v[160:163], v[56:59], v[16:19], v[160:163]
    v_mfma_f32_16x16x32_bf16 v[164:167], v[56:59], v[20:23], 0
    ds_read_b128 v[88:91], v243 offset:5120
    v_mfma_f32_16x16x32_bf16 v[164:167], v[40:43], v[4:7], v[164:167]
    ds_read_b128 v[92:95], v243 offset:7168
    v_mfma_f32_16x16x32_bf16 v[168:171], v[40:43], v[8:11], 0
    ds_read_b64_tr_b16 v[116:117], v249 offset:8192
    v_mfma_f32_16x16x32_bf16 v[168:171], v[56:59], v[24:27], v[168:171]
    ds_read_b64_tr_b16 v[118:119], v249 offset:12288
    v_mfma_f32_16x16x32_bf16 v[172:175], v[56:59], v[28:31], 0
    ds_read_b64_tr_b16 v[120:121], v250 offset:8192
    v_mfma_f32_16x16x32_bf16 v[172:175], v[40:43], v[12:15], v[172:175]
    ds_read_b64_tr_b16 v[122:123], v250 offset:12288
    v_mfma_f32_16x16x32_bf16 v[188:191], v[44:47], v[12:15], 0
    ds_read_b64_tr_b16 v[124:125], v251 offset:8192
    v_mfma_f32_16x16x32_bf16 v[188:191], v[60:63], v[28:31], v[188:191]
    ds_read_b64_tr_b16 v[126:127], v251 offset:12288
    v_mfma_f32_16x16x32_bf16 v[184:187], v[60:63], v[24:27], 0
    v_mfma_f32_16x16x32_bf16 v[184:187], v[44:47], v[8:11], v[184:187]
    v_mfma_f32_16x16x32_bf16 v[180:183], v[44:47], v[4:7], 0
    v_mfma_f32_16x16x32_bf16 v[180:183], v[60:63], v[20:23], v[180:183]
    v_mfma_f32_16x16x32_bf16 v[176:179], v[60:63], v[16:19], 0
    v_mfma_f32_16x16x32_bf16 v[176:179], v[44:47], v[0:3], v[176:179]
    .p2align 3
loop_40:
    s_waitcnt vmcnt(0) lgkmcnt(0)
    s_barrier
    .p2align 3
    v_mfma_f32_16x16x32_bf16 v[128:131], v[96:99], v[64:67], v[128:131]
    ds_read_b64_tr_b16 v[32:33], v248 offset:16384
    v_mfma_f32_16x16x32_bf16 v[128:131], v[112:115], v[80:83], v[128:131]
    ds_read_b64_tr_b16 v[34:35], v248 offset:20480
    v_mfma_f32_16x16x32_bf16 v[132:135], v[112:115], v[84:87], v[132:135]
    ds_read_b128 v[0:3], v243 offset:16384
    v_mfma_f32_16x16x32_bf16 v[132:135], v[96:99], v[68:71], v[132:135]
    ds_read_b128 v[4:7], v243 offset:18432
    v_mfma_f32_16x16x32_bf16 v[136:139], v[96:99], v[72:75], v[136:139]
    ds_read_b128 v[8:11], v243 offset:20480
    v_mfma_f32_16x16x32_bf16 v[136:139], v[112:115], v[88:91], v[136:139]
    ds_read_b128 v[12:15], v243 offset:22528
    v_mfma_f32_16x16x32_bf16 v[140:143], v[112:115], v[92:95], v[140:143]
    ds_read_b64_tr_b16 v[36:37], v249 offset:16384
    v_mfma_f32_16x16x32_bf16 v[140:143], v[96:99], v[76:79], v[140:143]
    ds_read_b64_tr_b16 v[38:39], v249 offset:20480
    v_mfma_f32_16x16x32_bf16 v[156:159], v[100:103], v[76:79], v[156:159]
    v_mfma_f32_16x16x32_bf16 v[156:159], v[116:119], v[92:95], v[156:159]
    ds_read_b64_tr_b16 v[40:41], v250 offset:16384
    v_mfma_f32_16x16x32_bf16 v[152:155], v[116:119], v[88:91], v[152:155]
    ds_read_b64_tr_b16 v[42:43], v250 offset:20480
    v_mfma_f32_16x16x32_bf16 v[152:155], v[100:103], v[72:75], v[152:155]
    ds_read_b64_tr_b16 v[44:45], v251 offset:16384
    v_mfma_f32_16x16x32_bf16 v[148:151], v[100:103], v[68:71], v[148:151]
    ds_read_b64_tr_b16 v[46:47], v251 offset:20480
    v_mfma_f32_16x16x32_bf16 v[148:151], v[116:119], v[84:87], v[148:151]
    ds_read_b64_tr_b16 v[48:49], v248 offset:24576
    v_mfma_f32_16x16x32_bf16 v[144:147], v[116:119], v[80:83], v[144:147]
    ds_read_b64_tr_b16 v[50:51], v248 offset:28672
    v_mfma_f32_16x16x32_bf16 v[144:147], v[100:103], v[64:67], v[144:147]
    ds_read_b128 v[16:19], v243 offset:17408
    v_mfma_f32_16x16x32_bf16 v[160:163], v[104:107], v[64:67], v[160:163]
    ds_read_b128 v[20:23], v243 offset:19456
    v_mfma_f32_16x16x32_bf16 v[160:163], v[120:123], v[80:83], v[160:163]
    v_mfma_f32_16x16x32_bf16 v[164:167], v[120:123], v[84:87], v[164:167]
    ds_read_b128 v[24:27], v243 offset:21504
    v_mfma_f32_16x16x32_bf16 v[164:167], v[104:107], v[68:71], v[164:167]
    ds_read_b128 v[28:31], v243 offset:23552
    v_mfma_f32_16x16x32_bf16 v[168:171], v[104:107], v[72:75], v[168:171]
    ds_read_b64_tr_b16 v[52:53], v249 offset:24576
    v_mfma_f32_16x16x32_bf16 v[168:171], v[120:123], v[88:91], v[168:171]
    ds_read_b64_tr_b16 v[54:55], v249 offset:28672
    v_mfma_f32_16x16x32_bf16 v[172:175], v[120:123], v[92:95], v[172:175]
    ds_read_b64_tr_b16 v[56:57], v250 offset:24576
    v_mfma_f32_16x16x32_bf16 v[172:175], v[104:107], v[76:79], v[172:175]
    ds_read_b64_tr_b16 v[58:59], v250 offset:28672
    v_mfma_f32_16x16x32_bf16 v[188:191], v[108:111], v[76:79], v[188:191]
    ds_read_b64_tr_b16 v[60:61], v251 offset:24576
    v_mfma_f32_16x16x32_bf16 v[188:191], v[124:127], v[92:95], v[188:191]
    ds_read_b64_tr_b16 v[62:63], v251 offset:28672
    v_mfma_f32_16x16x32_bf16 v[184:187], v[124:127], v[88:91], v[184:187]
    v_mfma_f32_16x16x32_bf16 v[184:187], v[108:111], v[72:75], v[184:187]
    v_mfma_f32_16x16x32_bf16 v[180:183], v[108:111], v[68:71], v[180:183]
    v_mfma_f32_16x16x32_bf16 v[180:183], v[124:127], v[84:87], v[180:183]
    v_mfma_f32_16x16x32_bf16 v[176:179], v[124:127], v[80:83], v[176:179]
    v_mfma_f32_16x16x32_bf16 v[176:179], v[108:111], v[64:67], v[176:179]
    s_waitcnt lgkmcnt(0)
    s_barrier
    .p2align 3
    v_mfma_f32_16x16x32_bf16 v[128:131], v[32:35], v[0:3], v[128:131]
    ds_read_b64_tr_b16 v[96:97], v248 offset:32768
    v_mfma_f32_16x16x32_bf16 v[128:131], v[48:51], v[16:19], v[128:131]
    ds_read_b64_tr_b16 v[98:99], v248 offset:36864
    v_mfma_f32_16x16x32_bf16 v[132:135], v[48:51], v[20:23], v[132:135]
    ds_read_b128 v[64:67], v243 offset:32768
    v_mfma_f32_16x16x32_bf16 v[132:135], v[32:35], v[4:7], v[132:135]
    ds_read_b128 v[68:71], v243 offset:34816
    v_mfma_f32_16x16x32_bf16 v[136:139], v[32:35], v[8:11], v[136:139]
    ds_read_b128 v[72:75], v243 offset:36864
    v_mfma_f32_16x16x32_bf16 v[136:139], v[48:51], v[24:27], v[136:139]
    ds_read_b128 v[76:79], v243 offset:38912
    v_mfma_f32_16x16x32_bf16 v[140:143], v[48:51], v[28:31], v[140:143]
    ds_read_b64_tr_b16 v[100:101], v249 offset:32768
    v_mfma_f32_16x16x32_bf16 v[140:143], v[32:35], v[12:15], v[140:143]
    ds_read_b64_tr_b16 v[102:103], v249 offset:36864
    v_mfma_f32_16x16x32_bf16 v[156:159], v[36:39], v[12:15], v[156:159]
    v_mfma_f32_16x16x32_bf16 v[156:159], v[52:55], v[28:31], v[156:159]
    ds_read_b64_tr_b16 v[104:105], v250 offset:32768
    v_mfma_f32_16x16x32_bf16 v[152:155], v[52:55], v[24:27], v[152:155]
    ds_read_b64_tr_b16 v[106:107], v250 offset:36864
    v_mfma_f32_16x16x32_bf16 v[152:155], v[36:39], v[8:11], v[152:155]
    ds_read_b64_tr_b16 v[108:109], v251 offset:32768
    v_mfma_f32_16x16x32_bf16 v[148:151], v[36:39], v[4:7], v[148:151]
    ds_read_b64_tr_b16 v[110:111], v251 offset:36864
    v_mfma_f32_16x16x32_bf16 v[148:151], v[52:55], v[20:23], v[148:151]
    ds_read_b64_tr_b16 v[112:113], v248 offset:40960
    v_mfma_f32_16x16x32_bf16 v[144:147], v[52:55], v[16:19], v[144:147]
    ds_read_b64_tr_b16 v[114:115], v248 offset:45056
    v_mfma_f32_16x16x32_bf16 v[144:147], v[36:39], v[0:3], v[144:147]
    ds_read_b128 v[80:83], v243 offset:33792
    v_mfma_f32_16x16x32_bf16 v[160:163], v[40:43], v[0:3], v[160:163]
    ds_read_b128 v[84:87], v243 offset:35840
    v_mfma_f32_16x16x32_bf16 v[160:163], v[56:59], v[16:19], v[160:163]
    v_mfma_f32_16x16x32_bf16 v[164:167], v[56:59], v[20:23], v[164:167]
    ds_read_b128 v[88:91], v243 offset:37888
    v_mfma_f32_16x16x32_bf16 v[164:167], v[40:43], v[4:7], v[164:167]
    ds_read_b128 v[92:95], v243 offset:39936
    v_mfma_f32_16x16x32_bf16 v[168:171], v[40:43], v[8:11], v[168:171]
    ds_read_b64_tr_b16 v[116:117], v249 offset:40960
    v_mfma_f32_16x16x32_bf16 v[168:171], v[56:59], v[24:27], v[168:171]
    ds_read_b64_tr_b16 v[118:119], v249 offset:45056
    v_mfma_f32_16x16x32_bf16 v[172:175], v[56:59], v[28:31], v[172:175]
    ds_read_b64_tr_b16 v[120:121], v250 offset:40960
    v_mfma_f32_16x16x32_bf16 v[172:175], v[40:43], v[12:15], v[172:175]
    ds_read_b64_tr_b16 v[122:123], v250 offset:45056
    v_mfma_f32_16x16x32_bf16 v[188:191], v[44:47], v[12:15], v[188:191]
    ds_read_b64_tr_b16 v[124:125], v251 offset:40960
    v_mfma_f32_16x16x32_bf16 v[188:191], v[60:63], v[28:31], v[188:191]
    ds_read_b64_tr_b16 v[126:127], v251 offset:45056
    v_mfma_f32_16x16x32_bf16 v[184:187], v[60:63], v[24:27], v[184:187]
    v_mfma_f32_16x16x32_bf16 v[184:187], v[44:47], v[8:11], v[184:187]
    v_mfma_f32_16x16x32_bf16 v[180:183], v[44:47], v[4:7], v[180:183]
    v_mfma_f32_16x16x32_bf16 v[180:183], v[60:63], v[20:23], v[180:183]
    v_mfma_f32_16x16x32_bf16 v[176:179], v[60:63], v[16:19], v[176:179]
    v_mfma_f32_16x16x32_bf16 v[176:179], v[44:47], v[0:3], v[176:179]
    s_waitcnt lgkmcnt(0)
    s_barrier
    .p2align 3
    v_mfma_f32_16x16x32_bf16 v[128:131], v[96:99], v[64:67], v[128:131]
    ds_read_b64_tr_b16 v[32:33], v244 offset:0
    v_mfma_f32_16x16x32_bf16 v[128:131], v[112:115], v[80:83], v[128:131]
    ds_read_b64_tr_b16 v[34:35], v244 offset:4096
    v_mfma_f32_16x16x32_bf16 v[132:135], v[112:115], v[84:87], v[132:135]
    ds_read_b128 v[0:3], v243 offset:0
    v_mfma_f32_16x16x32_bf16 v[132:135], v[96:99], v[68:71], v[132:135]
    ds_read_b128 v[4:7], v243 offset:2048
    v_mfma_f32_16x16x32_bf16 v[136:139], v[96:99], v[72:75], v[136:139]
    ds_read_b128 v[8:11], v243 offset:4096
    v_mfma_f32_16x16x32_bf16 v[136:139], v[112:115], v[88:91], v[136:139]
    ds_read_b128 v[12:15], v243 offset:6144
    v_mfma_f32_16x16x32_bf16 v[140:143], v[112:115], v[92:95], v[140:143]
    ds_read_b64_tr_b16 v[36:37], v245 offset:0
    v_mfma_f32_16x16x32_bf16 v[140:143], v[96:99], v[76:79], v[140:143]
    ds_read_b64_tr_b16 v[38:39], v245 offset:4096
    v_mfma_f32_16x16x32_bf16 v[156:159], v[100:103], v[76:79], v[156:159]
    v_mfma_f32_16x16x32_bf16 v[156:159], v[116:119], v[92:95], v[156:159]
    ds_read_b64_tr_b16 v[40:41], v246 offset:0
    v_mfma_f32_16x16x32_bf16 v[152:155], v[116:119], v[88:91], v[152:155]
    ds_read_b64_tr_b16 v[42:43], v246 offset:4096
    v_mfma_f32_16x16x32_bf16 v[152:155], v[100:103], v[72:75], v[152:155]
    ds_read_b64_tr_b16 v[44:45], v247 offset:0
    v_mfma_f32_16x16x32_bf16 v[148:151], v[100:103], v[68:71], v[148:151]
    ds_read_b64_tr_b16 v[46:47], v247 offset:4096
    v_mfma_f32_16x16x32_bf16 v[148:151], v[116:119], v[84:87], v[148:151]
    ds_read_b64_tr_b16 v[48:49], v244 offset:8192
    v_mfma_f32_16x16x32_bf16 v[144:147], v[116:119], v[80:83], v[144:147]
    ds_read_b64_tr_b16 v[50:51], v244 offset:12288
    v_mfma_f32_16x16x32_bf16 v[144:147], v[100:103], v[64:67], v[144:147]
    ds_read_b128 v[16:19], v243 offset:1024
    v_mfma_f32_16x16x32_bf16 v[160:163], v[104:107], v[64:67], v[160:163]
    ds_read_b128 v[20:23], v243 offset:3072
    v_mfma_f32_16x16x32_bf16 v[160:163], v[120:123], v[80:83], v[160:163]
    v_mfma_f32_16x16x32_bf16 v[164:167], v[120:123], v[84:87], v[164:167]
    ds_read_b128 v[24:27], v243 offset:5120
    v_mfma_f32_16x16x32_bf16 v[164:167], v[104:107], v[68:71], v[164:167]
    ds_read_b128 v[28:31], v243 offset:7168
    v_mfma_f32_16x16x32_bf16 v[168:171], v[104:107], v[72:75], v[168:171]
    ds_read_b64_tr_b16 v[52:53], v245 offset:8192
    v_mfma_f32_16x16x32_bf16 v[168:171], v[120:123], v[88:91], v[168:171]
    ds_read_b64_tr_b16 v[54:55], v245 offset:12288
    v_mfma_f32_16x16x32_bf16 v[172:175], v[120:123], v[92:95], v[172:175]
    ds_read_b64_tr_b16 v[56:57], v246 offset:8192
    v_mfma_f32_16x16x32_bf16 v[172:175], v[104:107], v[76:79], v[172:175]
    ds_read_b64_tr_b16 v[58:59], v246 offset:12288
    v_mfma_f32_16x16x32_bf16 v[188:191], v[108:111], v[76:79], v[188:191]
    ds_read_b64_tr_b16 v[60:61], v247 offset:8192
    v_mfma_f32_16x16x32_bf16 v[188:191], v[124:127], v[92:95], v[188:191]
    ds_read_b64_tr_b16 v[62:63], v247 offset:12288
    v_mfma_f32_16x16x32_bf16 v[184:187], v[124:127], v[88:91], v[184:187]
    v_mfma_f32_16x16x32_bf16 v[184:187], v[108:111], v[72:75], v[184:187]
    v_mfma_f32_16x16x32_bf16 v[180:183], v[108:111], v[68:71], v[180:183]
    v_mfma_f32_16x16x32_bf16 v[180:183], v[124:127], v[84:87], v[180:183]
    v_mfma_f32_16x16x32_bf16 v[176:179], v[124:127], v[80:83], v[176:179]
    v_mfma_f32_16x16x32_bf16 v[176:179], v[108:111], v[64:67], v[176:179]
    s_waitcnt lgkmcnt(0)
    s_barrier
    .p2align 3
    v_mfma_f32_16x16x32_bf16 v[128:131], v[32:35], v[0:3], v[128:131]
    ds_read_b64_tr_b16 v[96:97], v244 offset:16384
    v_mfma_f32_16x16x32_bf16 v[128:131], v[48:51], v[16:19], v[128:131]
    ds_read_b64_tr_b16 v[98:99], v244 offset:20480
    v_mfma_f32_16x16x32_bf16 v[132:135], v[48:51], v[20:23], v[132:135]
    ds_read_b128 v[64:67], v243 offset:16384
    v_mfma_f32_16x16x32_bf16 v[132:135], v[32:35], v[4:7], v[132:135]
    ds_read_b128 v[68:71], v243 offset:18432
    v_mfma_f32_16x16x32_bf16 v[136:139], v[32:35], v[8:11], v[136:139]
    ds_read_b128 v[72:75], v243 offset:20480
    v_mfma_f32_16x16x32_bf16 v[136:139], v[48:51], v[24:27], v[136:139]
    ds_read_b128 v[76:79], v243 offset:22528
    v_mfma_f32_16x16x32_bf16 v[140:143], v[48:51], v[28:31], v[140:143]
    ds_read_b64_tr_b16 v[100:101], v245 offset:16384
    v_mfma_f32_16x16x32_bf16 v[140:143], v[32:35], v[12:15], v[140:143]
    ds_read_b64_tr_b16 v[102:103], v245 offset:20480
    v_mfma_f32_16x16x32_bf16 v[156:159], v[36:39], v[12:15], v[156:159]
    v_mfma_f32_16x16x32_bf16 v[156:159], v[52:55], v[28:31], v[156:159]
    ds_read_b64_tr_b16 v[104:105], v246 offset:16384
    v_mfma_f32_16x16x32_bf16 v[152:155], v[52:55], v[24:27], v[152:155]
    ds_read_b64_tr_b16 v[106:107], v246 offset:20480
    v_mfma_f32_16x16x32_bf16 v[152:155], v[36:39], v[8:11], v[152:155]
    ds_read_b64_tr_b16 v[108:109], v247 offset:16384
    v_mfma_f32_16x16x32_bf16 v[148:151], v[36:39], v[4:7], v[148:151]
    ds_read_b64_tr_b16 v[110:111], v247 offset:20480
    v_mfma_f32_16x16x32_bf16 v[148:151], v[52:55], v[20:23], v[148:151]
    ds_read_b64_tr_b16 v[112:113], v244 offset:24576
    v_mfma_f32_16x16x32_bf16 v[144:147], v[52:55], v[16:19], v[144:147]
    ds_read_b64_tr_b16 v[114:115], v244 offset:28672
    v_mfma_f32_16x16x32_bf16 v[144:147], v[36:39], v[0:3], v[144:147]
    ds_read_b128 v[80:83], v243 offset:17408
    v_mfma_f32_16x16x32_bf16 v[160:163], v[40:43], v[0:3], v[160:163]
    ds_read_b128 v[84:87], v243 offset:19456
    v_mfma_f32_16x16x32_bf16 v[160:163], v[56:59], v[16:19], v[160:163]
    v_mfma_f32_16x16x32_bf16 v[164:167], v[56:59], v[20:23], v[164:167]
    ds_read_b128 v[88:91], v243 offset:21504
    v_mfma_f32_16x16x32_bf16 v[164:167], v[40:43], v[4:7], v[164:167]
    ds_read_b128 v[92:95], v243 offset:23552
    v_mfma_f32_16x16x32_bf16 v[168:171], v[40:43], v[8:11], v[168:171]
    ds_read_b64_tr_b16 v[116:117], v245 offset:24576
    v_mfma_f32_16x16x32_bf16 v[168:171], v[56:59], v[24:27], v[168:171]
    ds_read_b64_tr_b16 v[118:119], v245 offset:28672
    v_mfma_f32_16x16x32_bf16 v[172:175], v[56:59], v[28:31], v[172:175]
    ds_read_b64_tr_b16 v[120:121], v246 offset:24576
    v_mfma_f32_16x16x32_bf16 v[172:175], v[40:43], v[12:15], v[172:175]
    ds_read_b64_tr_b16 v[122:123], v246 offset:28672
    v_mfma_f32_16x16x32_bf16 v[188:191], v[44:47], v[12:15], v[188:191]
    ds_read_b64_tr_b16 v[124:125], v247 offset:24576
    v_mfma_f32_16x16x32_bf16 v[188:191], v[60:63], v[28:31], v[188:191]
    ds_read_b64_tr_b16 v[126:127], v247 offset:28672
    v_mfma_f32_16x16x32_bf16 v[184:187], v[60:63], v[24:27], v[184:187]
    v_mfma_f32_16x16x32_bf16 v[184:187], v[44:47], v[8:11], v[184:187]
    v_mfma_f32_16x16x32_bf16 v[180:183], v[44:47], v[4:7], v[180:183]
    v_mfma_f32_16x16x32_bf16 v[180:183], v[60:63], v[20:23], v[180:183]
    v_mfma_f32_16x16x32_bf16 v[176:179], v[60:63], v[16:19], v[176:179]
    v_mfma_f32_16x16x32_bf16 v[176:179], v[44:47], v[0:3], v[176:179]
    s_waitcnt lgkmcnt(0)
    s_barrier
    .p2align 3
    v_mfma_f32_16x16x32_bf16 v[128:131], v[96:99], v[64:67], v[128:131]
    ds_read_b64_tr_b16 v[32:33], v244 offset:32768
    v_mfma_f32_16x16x32_bf16 v[128:131], v[112:115], v[80:83], v[128:131]
    ds_read_b64_tr_b16 v[34:35], v244 offset:36864
    v_mfma_f32_16x16x32_bf16 v[132:135], v[112:115], v[84:87], v[132:135]
    ds_read_b128 v[0:3], v243 offset:32768
    v_mfma_f32_16x16x32_bf16 v[132:135], v[96:99], v[68:71], v[132:135]
    ds_read_b128 v[4:7], v243 offset:34816
    v_mfma_f32_16x16x32_bf16 v[136:139], v[96:99], v[72:75], v[136:139]
    ds_read_b128 v[8:11], v243 offset:36864
    v_mfma_f32_16x16x32_bf16 v[136:139], v[112:115], v[88:91], v[136:139]
    ds_read_b128 v[12:15], v243 offset:38912
    v_mfma_f32_16x16x32_bf16 v[140:143], v[112:115], v[92:95], v[140:143]
    ds_read_b64_tr_b16 v[36:37], v245 offset:32768
    v_mfma_f32_16x16x32_bf16 v[140:143], v[96:99], v[76:79], v[140:143]
    ds_read_b64_tr_b16 v[38:39], v245 offset:36864
    v_mfma_f32_16x16x32_bf16 v[156:159], v[100:103], v[76:79], v[156:159]
    v_mfma_f32_16x16x32_bf16 v[156:159], v[116:119], v[92:95], v[156:159]
    ds_read_b64_tr_b16 v[40:41], v246 offset:32768
    v_mfma_f32_16x16x32_bf16 v[152:155], v[116:119], v[88:91], v[152:155]
    ds_read_b64_tr_b16 v[42:43], v246 offset:36864
    v_mfma_f32_16x16x32_bf16 v[152:155], v[100:103], v[72:75], v[152:155]
    ds_read_b64_tr_b16 v[44:45], v247 offset:32768
    v_mfma_f32_16x16x32_bf16 v[148:151], v[100:103], v[68:71], v[148:151]
    ds_read_b64_tr_b16 v[46:47], v247 offset:36864
    v_mfma_f32_16x16x32_bf16 v[148:151], v[116:119], v[84:87], v[148:151]
    ds_read_b64_tr_b16 v[48:49], v244 offset:40960
    v_mfma_f32_16x16x32_bf16 v[144:147], v[116:119], v[80:83], v[144:147]
    ds_read_b64_tr_b16 v[50:51], v244 offset:45056
    v_mfma_f32_16x16x32_bf16 v[144:147], v[100:103], v[64:67], v[144:147]
    ds_read_b128 v[16:19], v243 offset:33792
    v_mfma_f32_16x16x32_bf16 v[160:163], v[104:107], v[64:67], v[160:163]
    ds_read_b128 v[20:23], v243 offset:35840
    v_mfma_f32_16x16x32_bf16 v[160:163], v[120:123], v[80:83], v[160:163]
    v_mfma_f32_16x16x32_bf16 v[164:167], v[120:123], v[84:87], v[164:167]
    ds_read_b128 v[24:27], v243 offset:37888
    v_mfma_f32_16x16x32_bf16 v[164:167], v[104:107], v[68:71], v[164:167]
    ds_read_b128 v[28:31], v243 offset:39936
    v_mfma_f32_16x16x32_bf16 v[168:171], v[104:107], v[72:75], v[168:171]
    ds_read_b64_tr_b16 v[52:53], v245 offset:40960
    v_mfma_f32_16x16x32_bf16 v[168:171], v[120:123], v[88:91], v[168:171]
    ds_read_b64_tr_b16 v[54:55], v245 offset:45056
    v_mfma_f32_16x16x32_bf16 v[172:175], v[120:123], v[92:95], v[172:175]
    ds_read_b64_tr_b16 v[56:57], v246 offset:40960
    v_mfma_f32_16x16x32_bf16 v[172:175], v[104:107], v[76:79], v[172:175]
    ds_read_b64_tr_b16 v[58:59], v246 offset:45056
    v_mfma_f32_16x16x32_bf16 v[188:191], v[108:111], v[76:79], v[188:191]
    ds_read_b64_tr_b16 v[60:61], v247 offset:40960
    v_mfma_f32_16x16x32_bf16 v[188:191], v[124:127], v[92:95], v[188:191]
    ds_read_b64_tr_b16 v[62:63], v247 offset:45056
    v_mfma_f32_16x16x32_bf16 v[184:187], v[124:127], v[88:91], v[184:187]
    v_mfma_f32_16x16x32_bf16 v[184:187], v[108:111], v[72:75], v[184:187]
    v_mfma_f32_16x16x32_bf16 v[180:183], v[108:111], v[68:71], v[180:183]
    v_mfma_f32_16x16x32_bf16 v[180:183], v[124:127], v[84:87], v[180:183]
    v_mfma_f32_16x16x32_bf16 v[176:179], v[124:127], v[80:83], v[176:179]
    v_mfma_f32_16x16x32_bf16 v[176:179], v[108:111], v[64:67], v[176:179]
    s_waitcnt lgkmcnt(0)
    s_barrier
    .p2align 3
    v_mfma_f32_16x16x32_bf16 v[128:131], v[32:35], v[0:3], v[128:131]
    ds_read_b64_tr_b16 v[96:97], v248 offset:0
    v_mfma_f32_16x16x32_bf16 v[128:131], v[48:51], v[16:19], v[128:131]
    ds_read_b64_tr_b16 v[98:99], v248 offset:4096
    v_mfma_f32_16x16x32_bf16 v[132:135], v[48:51], v[20:23], v[132:135]
    ds_read_b128 v[64:67], v243 offset:0
    v_mfma_f32_16x16x32_bf16 v[132:135], v[32:35], v[4:7], v[132:135]
    ds_read_b128 v[68:71], v243 offset:2048
    v_mfma_f32_16x16x32_bf16 v[136:139], v[32:35], v[8:11], v[136:139]
    ds_read_b128 v[72:75], v243 offset:4096
    v_mfma_f32_16x16x32_bf16 v[136:139], v[48:51], v[24:27], v[136:139]
    ds_read_b128 v[76:79], v243 offset:6144
    v_mfma_f32_16x16x32_bf16 v[140:143], v[48:51], v[28:31], v[140:143]
    ds_read_b64_tr_b16 v[100:101], v249 offset:0
    v_mfma_f32_16x16x32_bf16 v[140:143], v[32:35], v[12:15], v[140:143]
    ds_read_b64_tr_b16 v[102:103], v249 offset:4096
    v_mfma_f32_16x16x32_bf16 v[156:159], v[36:39], v[12:15], v[156:159]
    v_mfma_f32_16x16x32_bf16 v[156:159], v[52:55], v[28:31], v[156:159]
    ds_read_b64_tr_b16 v[104:105], v250 offset:0
    v_mfma_f32_16x16x32_bf16 v[152:155], v[52:55], v[24:27], v[152:155]
    ds_read_b64_tr_b16 v[106:107], v250 offset:4096
    v_mfma_f32_16x16x32_bf16 v[152:155], v[36:39], v[8:11], v[152:155]
    ds_read_b64_tr_b16 v[108:109], v251 offset:0
    v_mfma_f32_16x16x32_bf16 v[148:151], v[36:39], v[4:7], v[148:151]
    ds_read_b64_tr_b16 v[110:111], v251 offset:4096
    v_mfma_f32_16x16x32_bf16 v[148:151], v[52:55], v[20:23], v[148:151]
    ds_read_b64_tr_b16 v[112:113], v248 offset:8192
    v_mfma_f32_16x16x32_bf16 v[144:147], v[52:55], v[16:19], v[144:147]
    ds_read_b64_tr_b16 v[114:115], v248 offset:12288
    v_mfma_f32_16x16x32_bf16 v[144:147], v[36:39], v[0:3], v[144:147]
    ds_read_b128 v[80:83], v243 offset:1024
    v_mfma_f32_16x16x32_bf16 v[160:163], v[40:43], v[0:3], v[160:163]
    ds_read_b128 v[84:87], v243 offset:3072
    v_mfma_f32_16x16x32_bf16 v[160:163], v[56:59], v[16:19], v[160:163]
    v_mfma_f32_16x16x32_bf16 v[164:167], v[56:59], v[20:23], v[164:167]
    ds_read_b128 v[88:91], v243 offset:5120
    v_mfma_f32_16x16x32_bf16 v[164:167], v[40:43], v[4:7], v[164:167]
    ds_read_b128 v[92:95], v243 offset:7168
    v_mfma_f32_16x16x32_bf16 v[168:171], v[40:43], v[8:11], v[168:171]
    ds_read_b64_tr_b16 v[116:117], v249 offset:8192
    v_mfma_f32_16x16x32_bf16 v[168:171], v[56:59], v[24:27], v[168:171]
    ds_read_b64_tr_b16 v[118:119], v249 offset:12288
    v_mfma_f32_16x16x32_bf16 v[172:175], v[56:59], v[28:31], v[172:175]
    ds_read_b64_tr_b16 v[120:121], v250 offset:8192
    v_mfma_f32_16x16x32_bf16 v[172:175], v[40:43], v[12:15], v[172:175]
    ds_read_b64_tr_b16 v[122:123], v250 offset:12288
    v_mfma_f32_16x16x32_bf16 v[188:191], v[44:47], v[12:15], v[188:191]
    ds_read_b64_tr_b16 v[124:125], v251 offset:8192
    v_mfma_f32_16x16x32_bf16 v[188:191], v[60:63], v[28:31], v[188:191]
    ds_read_b64_tr_b16 v[126:127], v251 offset:12288
    v_mfma_f32_16x16x32_bf16 v[184:187], v[60:63], v[24:27], v[184:187]
    v_mfma_f32_16x16x32_bf16 v[184:187], v[44:47], v[8:11], v[184:187]
    v_mfma_f32_16x16x32_bf16 v[180:183], v[44:47], v[4:7], v[180:183]
    v_mfma_f32_16x16x32_bf16 v[180:183], v[60:63], v[20:23], v[180:183]
    s_sub_u32 s58, s58, 1
    s_cmp_lg_u32 s58, 0
    .p2align 3
    v_mfma_f32_16x16x32_bf16 v[176:179], v[60:63], v[16:19], v[176:179]
    v_mfma_f32_16x16x32_bf16 v[176:179], v[44:47], v[0:3], v[176:179]
    s_cbranch_scc1 loop_40
    s_waitcnt lgkmcnt(0)
    s_barrier
    .p2align 3
    v_mfma_f32_16x16x32_bf16 v[128:131], v[96:99], v[64:67], v[128:131]
    ds_read_b64_tr_b16 v[32:33], v248 offset:16384
    v_mfma_f32_16x16x32_bf16 v[128:131], v[112:115], v[80:83], v[128:131]
    ds_read_b64_tr_b16 v[34:35], v248 offset:20480
    v_mfma_f32_16x16x32_bf16 v[132:135], v[112:115], v[84:87], v[132:135]
    ds_read_b128 v[0:3], v243 offset:16384
    v_mfma_f32_16x16x32_bf16 v[132:135], v[96:99], v[68:71], v[132:135]
    ds_read_b128 v[4:7], v243 offset:18432
    v_mfma_f32_16x16x32_bf16 v[136:139], v[96:99], v[72:75], v[136:139]
    ds_read_b128 v[8:11], v243 offset:20480
    v_mfma_f32_16x16x32_bf16 v[136:139], v[112:115], v[88:91], v[136:139]
    ds_read_b128 v[12:15], v243 offset:22528
    v_mfma_f32_16x16x32_bf16 v[140:143], v[112:115], v[92:95], v[140:143]
    ds_read_b64_tr_b16 v[36:37], v249 offset:16384
    v_mfma_f32_16x16x32_bf16 v[140:143], v[96:99], v[76:79], v[140:143]
    ds_read_b64_tr_b16 v[38:39], v249 offset:20480
    v_mfma_f32_16x16x32_bf16 v[156:159], v[100:103], v[76:79], v[156:159]
    v_mfma_f32_16x16x32_bf16 v[156:159], v[116:119], v[92:95], v[156:159]
    ds_read_b64_tr_b16 v[40:41], v250 offset:16384
    v_mfma_f32_16x16x32_bf16 v[152:155], v[116:119], v[88:91], v[152:155]
    ds_read_b64_tr_b16 v[42:43], v250 offset:20480
    v_mfma_f32_16x16x32_bf16 v[152:155], v[100:103], v[72:75], v[152:155]
    ds_read_b64_tr_b16 v[44:45], v251 offset:16384
    v_mfma_f32_16x16x32_bf16 v[148:151], v[100:103], v[68:71], v[148:151]
    ds_read_b64_tr_b16 v[46:47], v251 offset:20480
    v_mfma_f32_16x16x32_bf16 v[148:151], v[116:119], v[84:87], v[148:151]
    ds_read_b64_tr_b16 v[48:49], v248 offset:24576
    v_mfma_f32_16x16x32_bf16 v[144:147], v[116:119], v[80:83], v[144:147]
    ds_read_b64_tr_b16 v[50:51], v248 offset:28672
    v_mfma_f32_16x16x32_bf16 v[144:147], v[100:103], v[64:67], v[144:147]
    ds_read_b128 v[16:19], v243 offset:17408
    v_mfma_f32_16x16x32_bf16 v[160:163], v[104:107], v[64:67], v[160:163]
    ds_read_b128 v[20:23], v243 offset:19456
    v_mfma_f32_16x16x32_bf16 v[160:163], v[120:123], v[80:83], v[160:163]
    v_mfma_f32_16x16x32_bf16 v[164:167], v[120:123], v[84:87], v[164:167]
    ds_read_b128 v[24:27], v243 offset:21504
    v_mfma_f32_16x16x32_bf16 v[164:167], v[104:107], v[68:71], v[164:167]
    ds_read_b128 v[28:31], v243 offset:23552
    v_mfma_f32_16x16x32_bf16 v[168:171], v[104:107], v[72:75], v[168:171]
    ds_read_b64_tr_b16 v[52:53], v249 offset:24576
    v_mfma_f32_16x16x32_bf16 v[168:171], v[120:123], v[88:91], v[168:171]
    ds_read_b64_tr_b16 v[54:55], v249 offset:28672
    v_mfma_f32_16x16x32_bf16 v[172:175], v[120:123], v[92:95], v[172:175]
    ds_read_b64_tr_b16 v[56:57], v250 offset:24576
    v_mfma_f32_16x16x32_bf16 v[172:175], v[104:107], v[76:79], v[172:175]
    ds_read_b64_tr_b16 v[58:59], v250 offset:28672
    v_mfma_f32_16x16x32_bf16 v[188:191], v[108:111], v[76:79], v[188:191]
    ds_read_b64_tr_b16 v[60:61], v251 offset:24576
    v_mfma_f32_16x16x32_bf16 v[188:191], v[124:127], v[92:95], v[188:191]
    ds_read_b64_tr_b16 v[62:63], v251 offset:28672
    v_mfma_f32_16x16x32_bf16 v[184:187], v[124:127], v[88:91], v[184:187]
    v_mfma_f32_16x16x32_bf16 v[184:187], v[108:111], v[72:75], v[184:187]
    v_mfma_f32_16x16x32_bf16 v[180:183], v[108:111], v[68:71], v[180:183]
    v_mfma_f32_16x16x32_bf16 v[180:183], v[124:127], v[84:87], v[180:183]
    v_mfma_f32_16x16x32_bf16 v[176:179], v[124:127], v[80:83], v[176:179]
    v_mfma_f32_16x16x32_bf16 v[176:179], v[108:111], v[64:67], v[176:179]
    s_waitcnt lgkmcnt(0)
    s_barrier
    .p2align 3
    v_mfma_f32_16x16x32_bf16 v[128:131], v[32:35], v[0:3], v[128:131]
    ds_read_b64_tr_b16 v[96:97], v248 offset:32768
    v_mfma_f32_16x16x32_bf16 v[128:131], v[48:51], v[16:19], v[128:131]
    ds_read_b64_tr_b16 v[98:99], v248 offset:36864
    v_mfma_f32_16x16x32_bf16 v[132:135], v[48:51], v[20:23], v[132:135]
    ds_read_b128 v[64:67], v243 offset:32768
    v_mfma_f32_16x16x32_bf16 v[132:135], v[32:35], v[4:7], v[132:135]
    ds_read_b128 v[68:71], v243 offset:34816
    v_mfma_f32_16x16x32_bf16 v[136:139], v[32:35], v[8:11], v[136:139]
    ds_read_b128 v[72:75], v243 offset:36864
    v_mfma_f32_16x16x32_bf16 v[136:139], v[48:51], v[24:27], v[136:139]
    ds_read_b128 v[76:79], v243 offset:38912
    v_mfma_f32_16x16x32_bf16 v[140:143], v[48:51], v[28:31], v[140:143]
    ds_read_b64_tr_b16 v[100:101], v249 offset:32768
    v_mfma_f32_16x16x32_bf16 v[140:143], v[32:35], v[12:15], v[140:143]
    ds_read_b64_tr_b16 v[102:103], v249 offset:36864
    v_mfma_f32_16x16x32_bf16 v[156:159], v[36:39], v[12:15], v[156:159]
    v_mfma_f32_16x16x32_bf16 v[156:159], v[52:55], v[28:31], v[156:159]
    ds_read_b64_tr_b16 v[104:105], v250 offset:32768
    v_mfma_f32_16x16x32_bf16 v[152:155], v[52:55], v[24:27], v[152:155]
    ds_read_b64_tr_b16 v[106:107], v250 offset:36864
    v_mfma_f32_16x16x32_bf16 v[152:155], v[36:39], v[8:11], v[152:155]
    ds_read_b64_tr_b16 v[108:109], v251 offset:32768
    v_mfma_f32_16x16x32_bf16 v[148:151], v[36:39], v[4:7], v[148:151]
    ds_read_b64_tr_b16 v[110:111], v251 offset:36864
    v_mfma_f32_16x16x32_bf16 v[148:151], v[52:55], v[20:23], v[148:151]
    ds_read_b64_tr_b16 v[112:113], v248 offset:40960
    v_mfma_f32_16x16x32_bf16 v[144:147], v[52:55], v[16:19], v[144:147]
    ds_read_b64_tr_b16 v[114:115], v248 offset:45056
    v_mfma_f32_16x16x32_bf16 v[144:147], v[36:39], v[0:3], v[144:147]
    ds_read_b128 v[80:83], v243 offset:33792
    v_mfma_f32_16x16x32_bf16 v[160:163], v[40:43], v[0:3], v[160:163]
    ds_read_b128 v[84:87], v243 offset:35840
    v_mfma_f32_16x16x32_bf16 v[160:163], v[56:59], v[16:19], v[160:163]
    v_mfma_f32_16x16x32_bf16 v[164:167], v[56:59], v[20:23], v[164:167]
    ds_read_b128 v[88:91], v243 offset:37888
    v_mfma_f32_16x16x32_bf16 v[164:167], v[40:43], v[4:7], v[164:167]
    ds_read_b128 v[92:95], v243 offset:39936
    v_mfma_f32_16x16x32_bf16 v[168:171], v[40:43], v[8:11], v[168:171]
    ds_read_b64_tr_b16 v[116:117], v249 offset:40960
    v_mfma_f32_16x16x32_bf16 v[168:171], v[56:59], v[24:27], v[168:171]
    ds_read_b64_tr_b16 v[118:119], v249 offset:45056
    v_mfma_f32_16x16x32_bf16 v[172:175], v[56:59], v[28:31], v[172:175]
    ds_read_b64_tr_b16 v[120:121], v250 offset:40960
    v_mfma_f32_16x16x32_bf16 v[172:175], v[40:43], v[12:15], v[172:175]
    ds_read_b64_tr_b16 v[122:123], v250 offset:45056
    v_mfma_f32_16x16x32_bf16 v[188:191], v[44:47], v[12:15], v[188:191]
    ds_read_b64_tr_b16 v[124:125], v251 offset:40960
    v_mfma_f32_16x16x32_bf16 v[188:191], v[60:63], v[28:31], v[188:191]
    ds_read_b64_tr_b16 v[126:127], v251 offset:45056
    v_mfma_f32_16x16x32_bf16 v[184:187], v[60:63], v[24:27], v[184:187]
    v_mfma_f32_16x16x32_bf16 v[184:187], v[44:47], v[8:11], v[184:187]
    v_mfma_f32_16x16x32_bf16 v[180:183], v[44:47], v[4:7], v[180:183]
    v_mfma_f32_16x16x32_bf16 v[180:183], v[60:63], v[20:23], v[180:183]
    v_mfma_f32_16x16x32_bf16 v[176:179], v[60:63], v[16:19], v[176:179]
    v_mfma_f32_16x16x32_bf16 v[176:179], v[44:47], v[0:3], v[176:179]
    s_waitcnt lgkmcnt(0)
    s_barrier
    .p2align 3
    v_mfma_f32_16x16x32_bf16 v[128:131], v[96:99], v[64:67], v[128:131]
    v_mfma_f32_16x16x32_bf16 v[128:131], v[112:115], v[80:83], v[128:131]
    v_mfma_f32_16x16x32_bf16 v[132:135], v[112:115], v[84:87], v[132:135]
    buffer_load_dwordx4 v[196:199], v254, s[4:7], s59 offen offset:0
    .p2align 3
    v_mfma_f32_16x16x32_bf16 v[132:135], v[96:99], v[68:71], v[132:135]
    v_mfma_f32_16x16x32_bf16 v[136:139], v[96:99], v[72:75], v[136:139]
    v_mfma_f32_16x16x32_bf16 v[136:139], v[112:115], v[88:91], v[136:139]
    v_mfma_f32_16x16x32_bf16 v[140:143], v[112:115], v[92:95], v[140:143]
    buffer_load_dwordx4 v[200:203], v254, s[4:7], s59 offen offset:2048
    .p2align 3
    v_mfma_f32_16x16x32_bf16 v[140:143], v[96:99], v[76:79], v[140:143]
    v_mfma_f32_16x16x32_bf16 v[156:159], v[100:103], v[76:79], v[156:159]
    v_mfma_f32_16x16x32_bf16 v[156:159], v[116:119], v[92:95], v[156:159]
    v_mfma_f32_16x16x32_bf16 v[152:155], v[116:119], v[88:91], v[152:155]
    buffer_load_dwordx4 v[204:207], v254, s[4:7], s60 offen offset:0
    .p2align 3
    v_mfma_f32_16x16x32_bf16 v[152:155], v[100:103], v[72:75], v[152:155]
    v_mfma_f32_16x16x32_bf16 v[148:151], v[100:103], v[68:71], v[148:151]
    v_mfma_f32_16x16x32_bf16 v[148:151], v[116:119], v[84:87], v[148:151]
    v_mfma_f32_16x16x32_bf16 v[144:147], v[116:119], v[80:83], v[144:147]
    buffer_load_dwordx4 v[208:211], v254, s[4:7], s60 offen offset:2048
    .p2align 3
    v_mfma_f32_16x16x32_bf16 v[144:147], v[100:103], v[64:67], v[144:147]
    v_mfma_f32_16x16x32_bf16 v[160:163], v[104:107], v[64:67], v[160:163]
    v_mfma_f32_16x16x32_bf16 v[160:163], v[120:123], v[80:83], v[160:163]
    v_mfma_f32_16x16x32_bf16 v[164:167], v[120:123], v[84:87], v[164:167]
    v_mfma_f32_16x16x32_bf16 v[164:167], v[104:107], v[68:71], v[164:167]
    v_mfma_f32_16x16x32_bf16 v[168:171], v[104:107], v[72:75], v[168:171]
    v_mfma_f32_16x16x32_bf16 v[168:171], v[120:123], v[88:91], v[168:171]
    v_mfma_f32_16x16x32_bf16 v[172:175], v[120:123], v[92:95], v[172:175]
    v_mfma_f32_16x16x32_bf16 v[172:175], v[104:107], v[76:79], v[172:175]
    v_mfma_f32_16x16x32_bf16 v[188:191], v[108:111], v[76:79], v[188:191]
    v_mfma_f32_16x16x32_bf16 v[188:191], v[124:127], v[92:95], v[188:191]
    v_mfma_f32_16x16x32_bf16 v[184:187], v[124:127], v[88:91], v[184:187]
    v_mfma_f32_16x16x32_bf16 v[184:187], v[108:111], v[72:75], v[184:187]
    v_mfma_f32_16x16x32_bf16 v[180:183], v[108:111], v[68:71], v[180:183]
    v_mfma_f32_16x16x32_bf16 v[180:183], v[124:127], v[84:87], v[180:183]
    v_mfma_f32_16x16x32_bf16 v[176:179], v[124:127], v[80:83], v[176:179]
    v_mfma_f32_16x16x32_bf16 v[176:179], v[108:111], v[64:67], v[176:179]
    s_nop 7
    v_cvt_pk_bf16_f32 v0, v160, v161
    v_cvt_pk_bf16_f32 v1, v162, v163
    v_cvt_pk_bf16_f32 v2, v176, v177
    v_cvt_pk_bf16_f32 v3, v178, v179
    v_min_u32 v0, -2, v0
    v_min_u32 v1, -2, v1
    v_min_u32 v2, -2, v2
    v_min_u32 v3, -2, v3
    buffer_store_dwordx4 v[0:3], v254, s[4:7], s88 offen offset:0 sc0 sc1
    v_cvt_pk_bf16_f32 v4, v164, v165
    v_cvt_pk_bf16_f32 v5, v166, v167
    v_cvt_pk_bf16_f32 v6, v180, v181
    v_cvt_pk_bf16_f32 v7, v182, v183
    v_min_u32 v4, -2, v4
    v_min_u32 v5, -2, v5
    v_min_u32 v6, -2, v6
    v_min_u32 v7, -2, v7
    buffer_store_dwordx4 v[4:7], v254, s[4:7], s88 offen offset:1024 sc0 sc1
    v_cvt_pk_bf16_f32 v8, v168, v169
    v_cvt_pk_bf16_f32 v9, v170, v171
    v_cvt_pk_bf16_f32 v10, v184, v185
    v_cvt_pk_bf16_f32 v11, v186, v187
    v_min_u32 v8, -2, v8
    v_min_u32 v9, -2, v9
    v_min_u32 v10, -2, v10
    v_min_u32 v11, -2, v11
    buffer_store_dwordx4 v[8:11], v254, s[4:7], s88 offen offset:2048 sc0 sc1
    v_cvt_pk_bf16_f32 v12, v172, v173
    v_cvt_pk_bf16_f32 v13, v174, v175
    v_cvt_pk_bf16_f32 v14, v188, v189
    v_cvt_pk_bf16_f32 v15, v190, v191
    v_min_u32 v12, -2, v12
    v_min_u32 v13, -2, v13
    v_min_u32 v14, -2, v14
    v_min_u32 v15, -2, v15
    buffer_store_dwordx4 v[12:15], v254, s[4:7], s88 offen offset:3072 sc0 sc1
    s_waitcnt vmcnt(4)
    v_lshlrev_b32 v160, 16, v196
    v_and_b32 v161, 0xffff0000, v196
    v_lshlrev_b32 v162, 16, v197
    v_and_b32 v163, 0xffff0000, v197
    v_pk_add_f32 v[128:129], v[128:129], v[160:161]
    v_pk_add_f32 v[130:131], v[130:131], v[162:163]
    v_lshlrev_b32 v164, 16, v198
    v_and_b32 v165, 0xffff0000, v198
    v_lshlrev_b32 v166, 16, v199
    v_and_b32 v167, 0xffff0000, v199
    v_pk_add_f32 v[144:145], v[144:145], v[164:165]
    v_pk_add_f32 v[146:147], v[146:147], v[166:167]
    v_lshlrev_b32 v168, 16, v200
    v_and_b32 v169, 0xffff0000, v200
    v_lshlrev_b32 v170, 16, v201
    v_and_b32 v171, 0xffff0000, v201
    v_pk_add_f32 v[132:133], v[132:133], v[168:169]
    v_pk_add_f32 v[134:135], v[134:135], v[170:171]
    v_lshlrev_b32 v172, 16, v202
    v_and_b32 v173, 0xffff0000, v202
    v_lshlrev_b32 v174, 16, v203
    v_and_b32 v175, 0xffff0000, v203
    v_pk_add_f32 v[148:149], v[148:149], v[172:173]
    v_pk_add_f32 v[150:151], v[150:151], v[174:175]
    v_lshlrev_b32 v160, 16, v204
    v_and_b32 v161, 0xffff0000, v204
    v_lshlrev_b32 v162, 16, v205
    v_and_b32 v163, 0xffff0000, v205
    v_pk_add_f32 v[136:137], v[136:137], v[160:161]
    v_pk_add_f32 v[138:139], v[138:139], v[162:163]
    v_lshlrev_b32 v164, 16, v206
    v_and_b32 v165, 0xffff0000, v206
    v_lshlrev_b32 v166, 16, v207
    v_and_b32 v167, 0xffff0000, v207
    v_pk_add_f32 v[152:153], v[152:153], v[164:165]
    v_pk_add_f32 v[154:155], v[154:155], v[166:167]
    v_lshlrev_b32 v168, 16, v208
    v_and_b32 v169, 0xffff0000, v208
    v_lshlrev_b32 v170, 16, v209
    v_and_b32 v171, 0xffff0000, v209
    v_pk_add_f32 v[140:141], v[140:141], v[168:169]
    v_pk_add_f32 v[142:143], v[142:143], v[170:171]
    v_lshlrev_b32 v172, 16, v210
    v_and_b32 v173, 0xffff0000, v210
    v_lshlrev_b32 v174, 16, v211
    v_and_b32 v175, 0xffff0000, v211
    v_pk_add_f32 v[156:157], v[156:157], v[172:173]
    v_pk_add_f32 v[158:159], v[158:159], v[174:175]
    s_mov_b32 s56, 262144
poll_41:
    buffer_load_dwordx4 v[16:19], v254, s[4:7], s89 offen offset:0 sc0 sc1
    buffer_load_dwordx4 v[20:23], v254, s[4:7], s89 offen offset:1024 sc0 sc1
    buffer_load_dwordx4 v[24:27], v254, s[4:7], s89 offen offset:2048 sc0 sc1
    buffer_load_dwordx4 v[28:31], v254, s[4:7], s89 offen offset:3072 sc0 sc1
    s_waitcnt vmcnt(0)
    v_max3_u32 v192, v16, v17, v18
    v_max3_u32 v193, v19, v20, v21
    v_max3_u32 v192, v192, v22, v23
    v_max3_u32 v193, v193, v24, v25
    v_max3_u32 v192, v192, v26, v27
    v_max3_u32 v193, v193, v28, v29
    v_max3_u32 v192, v192, v30, v31
    v_max_u32 v192, v192, v193
    v_cmp_eq_u32 vcc, -1, v192
    s_cbranch_vccz pd_42
    s_sub_u32 s56, s56, 1
    s_cmp_lg_u32 s56, 0
    s_cbranch_scc1 poll_41
pd_42:
    v_lshlrev_b32 v160, 16, v16
    v_and_b32 v161, 0xffff0000, v16
    v_lshlrev_b32 v162, 16, v17
    v_and_b32 v163, 0xffff0000, v17
    v_pk_add_f32 v[128:129], v[128:129], v[160:161]
    v_pk_add_f32 v[130:131], v[130:131], v[162:163]
    v_lshlrev_b32 v164, 16, v18
    v_and_b32 v165, 0xffff0000, v18
    v_lshlrev_b32 v166, 16, v19
    v_and_b32 v167, 0xffff0000, v19
    v_pk_add_f32 v[144:145], v[144:145], v[164:165]
    v_pk_add_f32 v[146:147], v[146:147], v[166:167]
    v_lshlrev_b32 v168, 16, v20
    v_and_b32 v169, 0xffff0000, v20
    v_lshlrev_b32 v170, 16, v21
    v_and_b32 v171, 0xffff0000, v21
    v_pk_add_f32 v[132:133], v[132:133], v[168:169]
    v_pk_add_f32 v[134:135], v[134:135], v[170:171]
    v_lshlrev_b32 v172, 16, v22
    v_and_b32 v173, 0xffff0000, v22
    v_lshlrev_b32 v174, 16, v23
    v_and_b32 v175, 0xffff0000, v23
    v_pk_add_f32 v[148:149], v[148:149], v[172:173]
    v_pk_add_f32 v[150:151], v[150:151], v[174:175]
    v_lshlrev_b32 v160, 16, v24
    v_and_b32 v161, 0xffff0000, v24
    v_lshlrev_b32 v162, 16, v25
    v_and_b32 v163, 0xffff0000, v25
    v_pk_add_f32 v[136:137], v[136:137], v[160:161]
    v_pk_add_f32 v[138:139], v[138:139], v[162:163]
    v_lshlrev_b32 v164, 16, v26
    v_and_b32 v165, 0xffff0000, v26
    v_lshlrev_b32 v166, 16, v27
    v_and_b32 v167, 0xffff0000, v27
    v_pk_add_f32 v[152:153], v[152:153], v[164:165]
    v_pk_add_f32 v[154:155], v[154:155], v[166:167]
    v_lshlrev_b32 v168, 16, v28
    v_and_b32 v169, 0xffff0000, v28
    v_lshlrev_b32 v170, 16, v29
    v_and_b32 v171, 0xffff0000, v29
    v_pk_add_f32 v[140:141], v[140:141], v[168:169]
    v_pk_add_f32 v[142:143], v[142:143], v[170:171]
    v_lshlrev_b32 v172, 16, v30
    v_and_b32 v173, 0xffff0000, v30
    v_lshlrev_b32 v174, 16, v31
    v_and_b32 v175, 0xffff0000, v31
    v_pk_add_f32 v[156:157], v[156:157], v[172:173]
    v_pk_add_f32 v[158:159], v[158:159], v[174:175]
    s_cmp_lg_u32 s46, 0
    s_cbranch_scc1 X_fin
    s_add_u32 s59, s1, s48
    s_add_u32 s60, s59, 4096
    v_cvt_pk_bf16_f32 v236, v128, v129
    v_cvt_pk_bf16_f32 v237, v130, v131
    v_cvt_pk_bf16_f32 v238, v144, v145
    v_cvt_pk_bf16_f32 v239, v146, v147
    buffer_store_dwordx4 v[236:239], v254, s[4:7], s59 offen offset:0 sc0 sc1
    v_cvt_pk_bf16_f32 v240, v132, v133
    v_cvt_pk_bf16_f32 v241, v134, v135
    v_cvt_pk_bf16_f32 v242, v148, v149
    v_cvt_pk_bf16_f32 v243, v150, v151
    buffer_store_dwordx4 v[240:243], v254, s[4:7], s59 offen offset:2048 sc0 sc1
    v_cvt_pk_bf16_f32 v244, v136, v137
    v_cvt_pk_bf16_f32 v245, v138, v139
    v_cvt_pk_bf16_f32 v246, v152, v153
    v_cvt_pk_bf16_f32 v247, v154, v155
    buffer_store_dwordx4 v[244:247], v254, s[4:7], s60 offen offset:0 sc0 sc1
    v_cvt_pk_bf16_f32 v248, v140, v141
    v_cvt_pk_bf16_f32 v249, v142, v143
    v_cvt_pk_bf16_f32 v250, v156, v157
    v_cvt_pk_bf16_f32 v251, v158, v159
    buffer_store_dwordx4 v[248:251], v254, s[4:7], s60 offen offset:2048 sc0 sc1
    v_mov_b32 v234, 0x3f803f80
    v_dot2_f32_bf16 v226, v236, v234, 0
    v_dot2_f32_bf16 v230, v236, v236, 0
    v_dot2_f32_bf16 v227, v240, v234, 0
    v_dot2_f32_bf16 v231, v240, v240, 0
    v_dot2_f32_bf16 v228, v244, v234, 0
    v_dot2_f32_bf16 v232, v244, v244, 0
    v_dot2_f32_bf16 v229, v248, v234, 0
    v_dot2_f32_bf16 v233, v248, v248, 0
    v_dot2_f32_bf16 v226, v237, v234, v226
    v_dot2_f32_bf16 v230, v237, v237, v230
    v_dot2_f32_bf16 v227, v241, v234, v227
    v_dot2_f32_bf16 v231, v241, v241, v231
    v_dot2_f32_bf16 v228, v245, v234, v228
    v_dot2_f32_bf16 v232, v245, v245, v232
    v_dot2_f32_bf16 v229, v249, v234, v229
    v_dot2_f32_bf16 v233, v249, v249, v233
    v_dot2_f32_bf16 v226, v238, v234, v226
    v_dot2_f32_bf16 v230, v238, v238, v230
    v_dot2_f32_bf16 v227, v242, v234, v227
    v_dot2_f32_bf16 v231, v242, v242, v231
    v_dot2_f32_bf16 v228, v246, v234, v228
    v_dot2_f32_bf16 v232, v246, v246, v232
    v_dot2_f32_bf16 v229, v250, v234, v229
    v_dot2_f32_bf16 v233, v250, v250, v233
    v_dot2_f32_bf16 v226, v239, v234, v226
    v_dot2_f32_bf16 v230, v239, v239, v230
    v_dot2_f32_bf16 v227, v243, v234, v227
    v_dot2_f32_bf16 v231, v243, v243, v231
    v_dot2_f32_bf16 v228, v247, v234, v228
    v_dot2_f32_bf16 v232, v247, v247, v232
    v_dot2_f32_bf16 v229, v251, v234, v229
    v_dot2_f32_bf16 v233, v251, v251, v233
    s_lshl_b32 s55, s42, 9
    s_add_u32 s55, s55, 155648
    s_nop 1
    v_permlane32_swap_b32 v226, v228
    v_permlane32_swap_b32 v227, v229
    v_permlane32_swap_b32 v230, v232
    v_permlane32_swap_b32 v231, v233
    v_add_f32 v226, v226, v228
    v_add_f32 v227, v227, v229
    v_add_f32 v230, v230, v232
    v_add_f32 v231, v231, v233
    v_lshrrev_b32 v234, 1, v254
    v_add_u32 v234, s55, v234
    v_permlane16_swap_b32 v226, v227
    v_permlane16_swap_b32 v230, v231
    v_add_f32 v226, v226, v227
    v_add_f32 v227, v230, v231
    ds_write_b64 v234, v[226:227]
    s_mov_b32 s46, 1
    s_add_u32 s47, s47, 262144
    s_add_u32 s49, s49, 524288
    s_add_u32 s50, s50, 917504
    s_add_u32 s52, s52, 65536
    s_add_u32 s54, s54, 32768
    s_add_u32 s0, s0, 32768
    s_branch X_layer
X_fin:
    v_and_b32 v192, 0xf0, v254
    v_lshlrev_b32 v192, 7, v192
    v_and_b32 v193, 0x100, v254
    v_lshrrev_b32 v193, 3, v193
    v_add_u32 v192, v192, v193
    v_and_b32 v193, 0x200, v254
    v_lshrrev_b32 v193, 5, v193
    v_add_u32 v192, v192, v193
    s_lshl_b32 s55, s40, 18
    s_lshl_b32 s56, s43, 17
    s_add_u32 s55, s55, s56
    s_lshl_b32 s56, s51, 7
    s_add_u32 s55, s55, s56
    s_lshl_b32 s56, s44, 6
    s_add_u32 s55, s55, s56
    v_cvt_pk_bf16_f32 v0, v128, v129
    v_cvt_pk_bf16_f32 v1, v130, v131
    v_cvt_pk_bf16_f32 v2, v144, v145
    v_cvt_pk_bf16_f32 v3, v146, v147
    s_nop 1
    v_permlane16_swap_b32 v0, v2
    v_permlane16_swap_b32 v1, v3
    buffer_store_dwordx4 v[0:3], v192, s[28:31], s55 offen sc0 sc1
    s_add_u32 s55, s55, 32768
    v_cvt_pk_bf16_f32 v4, v132, v133
    v_cvt_pk_bf16_f32 v5, v134, v135
    v_cvt_pk_bf16_f32 v6, v148, v149
    v_cvt_pk_bf16_f32 v7, v150, v151
    s_nop 1
    v_permlane16_swap_b32 v4, v6
    v_permlane16_swap_b32 v5, v7
    buffer_store_dwordx4 v[4:7], v192, s[28:31], s55 offen sc0 sc1
    s_add_u32 s55, s55, 32768
    v_cvt_pk_bf16_f32 v8, v136, v137
    v_cvt_pk_bf16_f32 v9, v138, v139
    v_cvt_pk_bf16_f32 v10, v152, v153
    v_cvt_pk_bf16_f32 v11, v154, v155
    s_nop 1
    v_permlane16_swap_b32 v8, v10
    v_permlane16_swap_b32 v9, v11
    buffer_store_dwordx4 v[8:11], v192, s[28:31], s55 offen sc0 sc1
    s_add_u32 s55, s55, 32768
    v_cvt_pk_bf16_f32 v12, v140, v141
    v_cvt_pk_bf16_f32 v13, v142, v143
    v_cvt_pk_bf16_f32 v14, v156, v157
    v_cvt_pk_bf16_f32 v15, v158, v159
    s_nop 1
    v_permlane16_swap_b32 v12, v14
    v_permlane16_swap_b32 v13, v15
    buffer_store_dwordx4 v[12:15], v192, s[28:31], s55 offen sc0 sc1
    s_add_u32 s55, s55, 32768
    s_endpgm
Y_first:
    v_mov_b32 v120, 0x3f80
    v_lshrrev_b32 v224, 4, v254
    v_and_b32 v225, 1, v224
    v_lshlrev_b32 v225, 4, v225
    v_lshlrev_b32 v225, v225, v120
    v_bfe_u32 v224, v224, 1, 3
    v_cmp_eq_u32 vcc, 0, v224
    s_nop 1
    v_cndmask_b32 v120, 0, v225, vcc
    v_cmp_eq_u32 vcc, 1, v224
    s_nop 1
    v_cndmask_b32 v121, 0, v225, vcc
    v_cmp_eq_u32 vcc, 2, v224
    s_nop 1
    v_cndmask_b32 v122, 0, v225, vcc
    v_cmp_eq_u32 vcc, 3, v224
    s_nop 1
    v_cndmask_b32 v123, 0, v225, vcc
    v_lshrrev_b32 v224, 7, v254
    v_and_b32 v225, 0x70, v254
    v_and_b32 v226, 6, v224
    v_lshlrev_b32 v226, 4, v226
    v_xor_b32 v225, v225, v226
    v_lshl_add_u32 v172, v224, 7, v225
    s_min_u32 s55, s42, 2
    s_lshl_b32 s55, s55, 12
    v_add_u32 v172, s55, v172
    s_add_u32 s55, s62, 100352
    v_add_u32 v224, s55, v254
    v_mov_b32 v225, 0x3f803f80
    s_setprio 1
    s_waitcnt vmcnt(27)
    s_barrier
    ds_read_b128 v[144:147], v224 offset:0
    ds_read_b128 v[148:151], v224 offset:1024
    ds_read_b128 v[152:155], v224 offset:2048
    ds_read_b128 v[156:159], v224 offset:3072
    s_waitcnt lgkmcnt(0)
    v_dot2_f32_bf16 v160, v144, v225, 0
    v_dot2_f32_bf16 v161, v144, v144, 0
    v_dot2_f32_bf16 v162, v148, v225, 0
    v_dot2_f32_bf16 v163, v148, v148, 0
    v_dot2_f32_bf16 v164, v152, v225, 0
    v_dot2_f32_bf16 v165, v152, v152, 0
    v_dot2_f32_bf16 v166, v156, v225, 0
    v_dot2_f32_bf16 v167, v156, v156, 0
    v_dot2_f32_bf16 v160, v145, v225, v160
    v_dot2_f32_bf16 v161, v145, v145, v161
    v_dot2_f32_bf16 v162, v149, v225, v162
    v_dot2_f32_bf16 v163, v149, v149, v163
    v_dot2_f32_bf16 v164, v153, v225, v164
    v_dot2_f32_bf16 v165, v153, v153, v165
    v_dot2_f32_bf16 v166, v157, v225, v166
    v_dot2_f32_bf16 v167, v157, v157, v167
    v_dot2_f32_bf16 v160, v146, v225, v160
    v_dot2_f32_bf16 v161, v146, v146, v161
    v_dot2_f32_bf16 v162, v150, v225, v162
    v_dot2_f32_bf16 v163, v150, v150, v163
    v_dot2_f32_bf16 v164, v154, v225, v164
    v_dot2_f32_bf16 v165, v154, v154, v165
    v_dot2_f32_bf16 v166, v158, v225, v166
    v_dot2_f32_bf16 v167, v158, v158, v167
    v_dot2_f32_bf16 v160, v147, v225, v160
    v_dot2_f32_bf16 v161, v147, v147, v161
    v_dot2_f32_bf16 v162, v151, v225, v162
    v_dot2_f32_bf16 v163, v151, v151, v163
    v_dot2_f32_bf16 v164, v155, v225, v164
    v_dot2_f32_bf16 v165, v155, v155, v165
    v_dot2_f32_bf16 v166, v159, v225, v166
    v_dot2_f32_bf16 v167, v159, v159, v167
    s_and_b32 s55, s40, 3
    s_cmp_lg_u32 s55, 0
    s_cbranch_scc1 qc_43
    ds_read_b128 v[128:131], v172 offset:0
    ds_read_b128 v[132:135], v172 offset:1024
    ds_read_b128 v[136:139], v172 offset:2048
    ds_read_b128 v[140:143], v172 offset:3072
    s_waitcnt lgkmcnt(0)
    v_mfma_f32_16x16x32_bf16 v[124:127], v[120:123], v[128:131], 0
    v_mfma_f32_16x16x32_bf16 v[124:127], v[120:123], v[132:135], v[124:127]
    v_mfma_f32_16x16x32_bf16 v[124:127], v[120:123], v[136:139], v[124:127]
    v_mfma_f32_16x16x32_bf16 v[124:127], v[120:123], v[140:143], v[124:127]
    s_nop 7
qc_43:
    s_waitcnt vmcnt(24)
    s_barrier
    s_add_u32 m0, s61, 0
    s_mul_i32 s59, s93, 96
    buffer_load_dwordx4 v200, s[8:11], s59 offen lds
    v_add_f32_dpp v160, v160, v160 quad_perm:[1,0,3,2] row_mask:0xf bank_mask:0xf
    v_add_f32_dpp v161, v161, v161 quad_perm:[1,0,3,2] row_mask:0xf bank_mask:0xf
    v_add_f32_dpp v162, v162, v162 quad_perm:[1,0,3,2] row_mask:0xf bank_mask:0xf
    v_add_f32_dpp v163, v163, v163 quad_perm:[1,0,3,2] row_mask:0xf bank_mask:0xf
    v_add_f32_dpp v164, v164, v164 quad_perm:[1,0,3,2] row_mask:0xf bank_mask:0xf
    v_add_f32_dpp v165, v165, v165 quad_perm:[1,0,3,2] row_mask:0xf bank_mask:0xf
    v_add_f32_dpp v166, v166, v166 quad_perm:[1,0,3,2] row_mask:0xf bank_mask:0xf
    v_add_f32_dpp v167, v167, v167 quad_perm:[1,0,3,2] row_mask:0xf bank_mask:0xf
    buffer_load_dwordx4 v201, s[8:11], s59 offen offset:1024 lds
    v_add_f32_dpp v160, v160, v160 quad_perm:[2,3,0,1] row_mask:0xf bank_mask:0xf
    v_add_f32_dpp v161, v161, v161 quad_perm:[2,3,0,1] row_mask:0xf bank_mask:0xf
    v_add_f32_dpp v162, v162, v162 quad_perm:[2,3,0,1] row_mask:0xf bank_mask:0xf
    v_add_f32_dpp v163, v163, v163 quad_perm:[2,3,0,1] row_mask:0xf bank_mask:0xf
    v_add_f32_dpp v164, v164, v164 quad_perm:[2,3,0,1] row_mask:0xf bank_mask:0xf
    v_add_f32_dpp v165, v165, v165 quad_perm:[2,3,0,1] row_mask:0xf bank_mask:0xf
    v_add_f32_dpp v166, v166, v166 quad_perm:[2,3,0,1] row_mask:0xf bank_mask:0xf
    v_add_f32_dpp v167, v167, v167 quad_perm:[2,3,0,1] row_mask:0xf bank_mask:0xf
    buffer_load_dwordx4 v202, s[8:11], s59 offen offset:2048 lds
    s_add_u32 s93, s93, 2048
    s_and_b32 s93, s93, 65535
    v_add_f32_dpp v160, v160, v160 row_half_mirror row_mask:0xf bank_mask:0xf
    v_add_f32_dpp v161, v161, v161 row_half_mirror row_mask:0xf bank_mask:0xf
    v_add_f32_dpp v162, v162, v162 row_half_mirror row_mask:0xf bank_mask:0xf
    v_add_f32_dpp v163, v163, v163 row_half_mirror row_mask:0xf bank_mask:0xf
    v_add_f32_dpp v164, v164, v164 row_half_mirror row_mask:0xf bank_mask:0xf
    v_add_f32_dpp v165, v165, v165 row_half_mirror row_mask:0xf bank_mask:0xf
    v_add_f32_dpp v166, v166, v166 row_half_mirror row_mask:0xf bank_mask:0xf
    v_add_f32_dpp v167, v167, v167 row_half_mirror row_mask:0xf bank_mask:0xf
    s_and_b32 s55, s40, 3
    s_cmp_lg_u32 s55, 0
    s_cbranch_scc1 qc_44
    ds_read_b128 v[128:131], v172 offset:16384
    ds_read_b128 v[132:135], v172 offset:17408
    ds_read_b128 v[136:139], v172 offset:18432
    ds_read_b128 v[140:143], v172 offset:19456
    s_waitcnt lgkmcnt(0)
    v_mfma_f32_16x16x32_bf16 v[124:127], v[120:123], v[128:131], v[124:127]
    v_mfma_f32_16x16x32_bf16 v[124:127], v[120:123], v[132:135], v[124:127]
    v_mfma_f32_16x16x32_bf16 v[124:127], v[120:123], v[136:139], v[124:127]
    v_mfma_f32_16x16x32_bf16 v[124:127], v[120:123], v[140:143], v[124:127]
    s_nop 7
qc_44:
    s_waitcnt vmcnt(17)
    s_barrier
    s_add_u32 m0, s91, 98304
    s_mov_b64 exec, s[84:85]
    buffer_load_dwordx4 v221, s[36:39], s94 offen lds
    s_mov_b64 exec, -1
    v_and_b32 v224, 0x70, v254
    s_add_u32 m0, s62, 100352
    s_nop 0
    buffer_load_dwordx4 v217, s[36:39], s94 offen lds
    v_cmp_eq_u32 vcc, 16, v224
    s_nop 1
    v_cndmask_b32 v160, v160, v162, vcc
    v_cndmask_b32 v161, v161, v163, vcc
    buffer_load_dwordx4 v218, s[36:39], s94 offen offset:1024 lds
    v_cmp_eq_u32 vcc, 32, v224
    s_nop 1
    v_cndmask_b32 v160, v160, v164, vcc
    v_cndmask_b32 v161, v161, v165, vcc
    s_add_u32 m0, s61, 16384
    s_mul_i32 s59, s93, 96
    buffer_load_dwordx4 v200, s[8:11], s59 offen lds
    v_cmp_eq_u32 vcc, 48, v224
    s_nop 1
    v_cndmask_b32 v160, v160, v166, vcc
    v_cndmask_b32 v161, v161, v167, vcc
    buffer_load_dwordx4 v201, s[8:11], s59 offen offset:1024 lds
    v_lshrrev_b32 v225, 7, v254
    buffer_load_dwordx4 v202, s[8:11], s59 offen offset:2048 lds
    s_add_u32 s93, s93, 6144
    s_and_b32 s93, s93, 65535
    v_lshlrev_b32 v225, 3, v225
    v_lshl_add_u32 v224, v224, 2, v225
    s_and_b32 s55, s40, 3
    s_cmp_lg_u32 s55, 1
    s_cbranch_scc1 qc_45
    ds_read_b128 v[128:131], v172 offset:32768
    ds_read_b128 v[132:135], v172 offset:33792
    ds_read_b128 v[136:139], v172 offset:34816
    ds_read_b128 v[140:143], v172 offset:35840
    s_waitcnt lgkmcnt(0)
    v_mfma_f32_16x16x32_bf16 v[124:127], v[120:123], v[128:131], 0
    v_mfma_f32_16x16x32_bf16 v[124:127], v[120:123], v[132:135], v[124:127]
    v_mfma_f32_16x16x32_bf16 v[124:127], v[120:123], v[136:139], v[124:127]
    v_mfma_f32_16x16x32_bf16 v[124:127], v[120:123], v[140:143], v[124:127]
    s_nop 7
qc_45:
    s_lshl_b32 s55, s51, 10
    s_lshr_b32 s56, s62, 4
    s_add_u32 s55, s55, s56
    s_add_u32 s55, s55, s53
    s_add_u32 s55, s55, 65536
    s_mov_b32 s70, 0x0f0f0f0f
    s_mov_b32 s71, 0x0f0f0f0f
    s_mov_b64 exec, s[70:71]
    buffer_store_dwordx2 v[160:161], v224, s[4:7], s55 offen sc0 sc1
    s_mov_b64 exec, -1
    s_waitcnt vmcnt(16)
    s_barrier
    s_add_u32 m0, s62, 100352
    s_nop 0
    buffer_load_dwordx4 v219, s[36:39], s94 offen offset:2048 lds
    s_add_u32 s55, s51, 4
    s_and_b32 s56, s55, 7
    s_lshr_b32 s55, s55, 3
    s_and_b32 s55, s55, 1
    s_lshl_b32 s56, s56, 1
    s_add_u32 s55, s55, s56
    s_lshl_b32 s79, s55, 4
    s_add_u32 s79, s79, s40
    s_lshr_b32 s55, s79, 1
    s_cmp_lt_u32 s55, 56
    s_cselect_b32 s72, s80, s82
    s_cselect_b32 s73, s81, s83
    s_cselect_b32 s56, 0, 56
    s_sub_u32 s55, s55, s56
    s_lshl_b32 s76, s55, 7
    s_and_b32 s55, s79, 1
    s_lshl_b32 s55, s55, 2
    s_add_u32 s55, s55, s42
    s_mul_i32 s55, s55, 917504
    s_add_u32 s76, s76, s55
    s_cmp_lt_u32 s79, 224
    s_cselect_b32 s76, s76, 2130706432
    v_lshrrev_b32 v96, 7, v254
    buffer_load_dwordx4 v220, s[36:39], s94 offen offset:3072 lds
    s_add_u32 s94, s94, 256
    s_and_b32 s94, s94, 2047
    v_mul_u32_u24 v96, 7168, v96
    v_and_b32 v224, 0x70, v254
    s_add_u32 m0, s61, 32768
    s_mul_i32 s59, s93, 96
    buffer_load_dwordx4 v200, s[8:11], s59 offen lds
    v_add_u32 v96, v96, v224
    v_lshrrev_b32 v97, 6, v254
    v_mul_u32_u24 v97, 7168, v97
    buffer_load_dwordx4 v201, s[8:11], s59 offen offset:1024 lds
    v_lshrrev_b32 v224, 3, v254
    v_and_b32 v224, 0x20, v224
    buffer_load_dwordx4 v202, s[8:11], s59 offen offset:2048 lds
    s_add_u32 s93, s93, 2048
    s_and_b32 s93, s93, 65535
    v_and_b32 v225, 0x30, v254
    v_xor_b32 v224, v224, v225
    v_add_u32 v97, v97, v224
    s_and_b32 s55, s40, 3
    s_cmp_lg_u32 s55, 1
    s_cbranch_scc1 qc_46
    v_add_u32 v252, 49152, v172
    ds_read_b128 v[128:131], v252 offset:0
    ds_read_b128 v[132:135], v252 offset:1024
    ds_read_b128 v[136:139], v252 offset:2048
    ds_read_b128 v[140:143], v252 offset:3072
    s_waitcnt lgkmcnt(0)
    v_mfma_f32_16x16x32_bf16 v[124:127], v[120:123], v[128:131], v[124:127]
    v_mfma_f32_16x16x32_bf16 v[124:127], v[120:123], v[132:135], v[124:127]
    v_mfma_f32_16x16x32_bf16 v[124:127], v[120:123], v[136:139], v[124:127]
    v_mfma_f32_16x16x32_bf16 v[124:127], v[120:123], v[140:143], v[124:127]
    s_nop 7
qc_46:
    s_waitcnt vmcnt(18)
    s_barrier
    s_add_u32 m0, s91, 116736
    s_mov_b64 exec, s[84:85]
    buffer_load_dwordx4 v221, s[36:39], s94 offen lds
    s_mov_b64 exec, -1
    s_add_u32 m0, s62, 118784
    s_nop 0
    buffer_load_dwordx4 v217, s[36:39], s94 offen lds
    buffer_load_dwordx4 v218, s[36:39], s94 offen offset:1024 lds
    s_add_u32 m0, s61, 49152
    s_mul_i32 s59, s93, 96
    buffer_load_dwordx4 v200, s[8:11], s59 offen lds
    buffer_load_dwordx4 v201, s[8:11], s59 offen offset:1024 lds
    buffer_load_dwordx4 v202, s[8:11], s59 offen offset:2048 lds
    s_add_u32 s93, s93, 6144
    s_and_b32 s93, s93, 65535
    s_getreg_b32 s77, hwreg(HW_REG_XCC_ID, 0, 4)
    s_mul_i32 s55, s77, s77
    s_lshl_b32 s55, s55, 15
    s_lshl_b32 s77, s77, 6
    s_add_u32 s77, s77, s55
    s_add_u32 s77, s77, 1
    s_and_b32 s55, s40, 3
    s_cmp_lg_u32 s55, 2
    s_cbranch_scc1 qc_47
    v_add_u32 v252, 49152, v172
    ds_read_b128 v[128:131], v252 offset:16384
    ds_read_b128 v[132:135], v252 offset:17408
    ds_read_b128 v[136:139], v252 offset:18432
    ds_read_b128 v[140:143], v252 offset:19456
    s_waitcnt lgkmcnt(0)
    v_mfma_f32_16x16x32_bf16 v[124:127], v[120:123], v[128:131], 0
    v_mfma_f32_16x16x32_bf16 v[124:127], v[120:123], v[132:135], v[124:127]
    v_mfma_f32_16x16x32_bf16 v[124:127], v[120:123], v[136:139], v[124:127]
    v_mfma_f32_16x16x32_bf16 v[124:127], v[120:123], v[140:143], v[124:127]
    s_nop 7
qc_47:
    s_waitcnt vmcnt(21)
    s_barrier
    s_add_u32 m0, s62, 118784
    s_nop 0
    buffer_load_dwordx4 v219, s[36:39], s94 offen offset:2048 lds
    buffer_load_dwordx4 v220, s[36:39], s94 offen offset:3072 lds
    s_add_u32 s94, s94, 256
    s_and_b32 s94, s94, 2047
    s_add_u32 m0, s61, 65536
    s_mul_i32 s59, s93, 96
    buffer_load_dwordx4 v200, s[8:11], s59 offen lds
    buffer_load_dwordx4 v201, s[8:11], s59 offen offset:1024 lds
    buffer_load_dwordx4 v202, s[8:11], s59 offen offset:2048 lds
    s_add_u32 s93, s93, 2048
    s_and_b32 s93, s93, 65535
    s_and_b32 s55, s40, 3
    s_cmp_lg_u32 s55, 2
    s_cbranch_scc1 qc_48
    v_add_u32 v252, 49152, v172
    ds_read_b128 v[128:131], v252 offset:32768
    ds_read_b128 v[132:135], v252 offset:33792
    ds_read_b128 v[136:139], v252 offset:34816
    ds_read_b128 v[140:143], v252 offset:35840
    s_waitcnt lgkmcnt(0)
    v_mfma_f32_16x16x32_bf16 v[124:127], v[120:123], v[128:131], v[124:127]
    v_mfma_f32_16x16x32_bf16 v[124:127], v[120:123], v[132:135], v[124:127]
    v_mfma_f32_16x16x32_bf16 v[124:127], v[120:123], v[136:139], v[124:127]
    v_mfma_f32_16x16x32_bf16 v[124:127], v[120:123], v[140:143], v[124:127]
    s_nop 7
qc_48:
    buffer_load_dwordx4 v[0:3], v96, s[72:75], s76 offen
    s_add_u32 s76, s76, 57344
    s_waitcnt vmcnt(15)
    s_barrier
    s_add_u32 m0, s91, 135168
    s_mov_b64 exec, s[84:85]
    buffer_load_dwordx4 v221, s[36:39], s94 offen lds
    s_mov_b64 exec, -1
    s_add_u32 m0, s62, 137216
    s_nop 0
    buffer_load_dwordx4 v217, s[36:39], s94 offen lds
    buffer_load_dwordx4 v218, s[36:39], s94 offen offset:1024 lds
    s_add_u32 m0, s61, 81920
    s_mul_i32 s59, s93, 96
    buffer_load_dwordx4 v200, s[8:11], s59 offen lds
    buffer_load_dwordx4 v201, s[8:11], s59 offen offset:1024 lds
    buffer_load_dwordx4 v202, s[8:11], s59 offen offset:2048 lds
    s_add_u32 s93, s93, 6144
    s_and_b32 s93, s93, 65535
    s_and_b32 s55, s40, 3
    s_cmp_lg_u32 s55, 3
    s_cbranch_scc1 qc_49
    ds_read_b128 v[128:131], v172 offset:0
    ds_read_b128 v[132:135], v172 offset:1024
    ds_read_b128 v[136:139], v172 offset:2048
    ds_read_b128 v[140:143], v172 offset:3072
    s_waitcnt lgkmcnt(0)
    v_mfma_f32_16x16x32_bf16 v[124:127], v[120:123], v[128:131], 0
    v_mfma_f32_16x16x32_bf16 v[124:127], v[120:123], v[132:135], v[124:127]
    v_mfma_f32_16x16x32_bf16 v[124:127], v[120:123], v[136:139], v[124:127]
    v_mfma_f32_16x16x32_bf16 v[124:127], v[120:123], v[140:143], v[124:127]
    s_nop 7
qc_49:
    s_barrier
    s_add_u32 m0, s62, 137216
    s_nop 0
    buffer_load_dwordx4 v219, s[36:39], s94 offen offset:2048 lds
    buffer_load_dwordx4 v220, s[36:39], s94 offen offset:3072 lds
    s_add_u32 s94, s94, 256
    s_and_b32 s94, s94, 2047
    s_add_u32 m0, s61, 0
    s_mul_i32 s59, s93, 96
    buffer_load_dwordx4 v200, s[8:11], s59 offen lds
    buffer_load_dwordx4 v201, s[8:11], s59 offen offset:1024 lds
    buffer_load_dwordx4 v202, s[8:11], s59 offen offset:2048 lds
    s_add_u32 s93, s93, 2048
    s_and_b32 s93, s93, 65535
    s_and_b32 s55, s40, 3
    s_cmp_lg_u32 s55, 3
    s_cbranch_scc1 qc_50
    ds_read_b128 v[128:131], v172 offset:16384
    ds_read_b128 v[132:135], v172 offset:17408
    ds_read_b128 v[136:139], v172 offset:18432
    ds_read_b128 v[140:143], v172 offset:19456
    s_waitcnt lgkmcnt(0)
    v_mfma_f32_16x16x32_bf16 v[124:127], v[120:123], v[128:131], v[124:127]
    v_mfma_f32_16x16x32_bf16 v[124:127], v[120:123], v[132:135], v[124:127]
    v_mfma_f32_16x16x32_bf16 v[124:127], v[120:123], v[136:139], v[124:127]
    v_mfma_f32_16x16x32_bf16 v[124:127], v[120:123], v[140:143], v[124:127]
    s_nop 7
qc_50:
    buffer_load_dwordx4 v[4:7], v96, s[72:75], s76 offen
    s_add_u32 s76, s76, 57344
    s_waitcnt vmcnt(16)
    s_barrier
    s_add_u32 m0, s91, 98304
    s_mov_b64 exec, s[84:85]
    buffer_load_dwordx4 v221, s[36:39], s94 offen lds
    s_mov_b64 exec, -1
    v_add_f32_dpp v124, v124, v124 row_ror:8 row_mask:0xf bank_mask:0xf
    s_add_u32 m0, s62, 100352
    s_nop 0
    buffer_load_dwordx4 v217, s[36:39], s94 offen lds
    v_add_f32_dpp v125, v125, v125 row_ror:8 row_mask:0xf bank_mask:0xf
    buffer_load_dwordx4 v218, s[36:39], s94 offen offset:1024 lds
    v_add_f32_dpp v126, v126, v126 row_ror:8 row_mask:0xf bank_mask:0xf
    v_add_f32_dpp v127, v127, v127 row_ror:8 row_mask:0xf bank_mask:0xf
    s_add_u32 m0, s61, 16384
    s_mul_i32 s59, s93, 96
    buffer_load_dwordx4 v200, s[8:11], s59 offen lds
    v_and_b32 v224, 0x70, v254
    buffer_load_dwordx4 v201, s[8:11], s59 offen offset:1024 lds
    v_lshrrev_b32 v225, 4, v254
    buffer_load_dwordx4 v202, s[8:11], s59 offen offset:2048 lds
    s_add_u32 s93, s93, 6144
    s_and_b32 s93, s93, 65535
    v_and_b32 v225, 16, v225
    v_lshl_add_u32 v224, v224, 1, v225
    s_mul_i32 s55, s40, 12288
    s_lshl_b32 s56, s42, 12
    s_add_u32 s55, s55, s56
    s_lshl_b32 s56, s51, 8
    s_add_u32 s55, s55, s56
    s_add_u32 s55, s55, 70516736
    s_cmp_lt_u32 s42, 3
    s_cselect_b32 s55, s55, 2130706432
    s_mov_b64 exec, 0x00ff00ff
    buffer_store_dwordx4 v[124:127], v224, s[4:7], s55 offen sc0 sc1
    s_mov_b64 exec, -1
    s_barrier
    s_add_u32 m0, s62, 100352
    s_nop 0
    buffer_load_dwordx4 v219, s[36:39], s94 offen offset:2048 lds
    v_lshrrev_b32 v224, 7, v254
    v_and_b32 v225, 0x70, v254
    buffer_load_dwordx4 v220, s[36:39], s94 offen offset:3072 lds
    s_add_u32 s94, s94, 256
    s_and_b32 s94, s94, 2047
    v_and_b32 v226, 6, v224
    v_lshlrev_b32 v226, 4, v226
    s_add_u32 m0, s61, 32768
    s_mul_i32 s59, s93, 96
    buffer_load_dwordx4 v200, s[8:11], s59 offen lds
    v_xor_b32 v225, v225, v226
    v_mul_u32_u24 v224, 2048, v224
    buffer_load_dwordx4 v201, s[8:11], s59 offen offset:1024 lds
    v_add3_u32 v203, v224, v225, s64
    v_add_u32 v204, 15360, v203
    buffer_load_dwordx4 v202, s[8:11], s59 offen offset:2048 lds
    s_add_u32 s93, s93, 2048
    s_and_b32 s93, s93, 65535
    v_add_u32 v205, 30720, v203
    v_add_u32 v206, 46080, v203
    v_lshrrev_b32 v99, 8, v254
    v_mul_u32_u24 v99, 7168, v99
    v_and_b32 v224, 0xf0, v254
    v_add_u32 v99, v99, v224
    s_mul_i32 s55, s2, 28672
    v_add_u32 v99, s55, v99
    buffer_load_dwordx4 v[8:11], v96, s[72:75], s76 offen
    s_add_u32 s76, s76, 57344
    s_waitcnt vmcnt(17)
    s_barrier
    s_add_u32 m0, s91, 116736
    s_mov_b64 exec, s[84:85]
    buffer_load_dwordx4 v221, s[36:39], s94 offen lds
    s_mov_b64 exec, -1
    s_add_u32 m0, s62, 118784
    s_nop 0
    buffer_load_dwordx4 v217, s[36:39], s94 offen lds
    buffer_load_dwordx4 v218, s[36:39], s94 offen offset:1024 lds
    s_add_u32 m0, s61, 49152
    s_mul_i32 s59, s93, 96
    buffer_load_dwordx4 v200, s[8:11], s59 offen lds
    buffer_load_dwordx4 v201, s[8:11], s59 offen offset:1024 lds
    buffer_load_dwordx4 v202, s[8:11], s59 offen offset:2048 lds
    s_add_u32 s93, s93, 10240
    s_and_b32 s93, s93, 65535
    buffer_load_dwordx4 v[12:15], v96, s[72:75], s76 offen
    s_add_u32 s76, s76, 57344
    s_waitcnt vmcnt(13)
    s_barrier
    s_add_u32 m0, s62, 118784
    s_nop 0
    buffer_load_dwordx4 v219, s[36:39], s94 offen offset:2048 lds
    buffer_load_dwordx4 v220, s[36:39], s94 offen offset:3072 lds
    s_add_u32 s94, s94, 384
    s_and_b32 s94, s94, 2047
    s_lshr_b32 s55, s2, 3
    s_lshl_b32 s55, s55, 1
    s_add_u32 s55, s55, s44
    s_and_b32 s56, s2, 7
    s_lshl_b32 s90, s43, 3
    s_add_u32 s90, s90, s56
    s_lshl_b32 s90, s90, 7
    s_add_u32 s90, s90, s55
    s_lshl_b32 s90, s90, 10
    s_add_u32 s90, s90, 67108864
    s_mul_i32 s55, s55, 114688
    s_mul_i32 s56, s56, 896
    s_add_u32 s70, s55, s56
    s_add_u32 m0, s61, 65536
    s_mul_i32 s59, s93, 96
    buffer_load_dwordx4 v200, s[8:11], s59 offen lds
    buffer_load_dwordx4 v201, s[8:11], s59 offen offset:1024 lds
    buffer_load_dwordx4 v[64:67], v97, s[16:19], s70 offen offset:384
    buffer_load_dwordx4 v202, s[8:11], s59 offen offset:2048 lds
    s_add_u32 s93, s93, 2048
    s_and_b32 s93, s93, 65535
    buffer_load_dwordx4 v[68:71], v97, s[16:19], s70 offen offset:448
    s_cmp_lg_u32 s42, 1
    s_cbranch_scc1 hs_51
    v_mov_b32 v252, 0
    v_mov_b32 v253, 1
    s_lshl_b32 s55, s2, 2
    s_add_u32 s55, s55, 71565312
    s_mov_b64 exec, 1
    buffer_store_dword v253, v252, s[4:7], s55 offen sc0 sc1
    s_mov_b64 exec, -1
hs_51:
    s_waitcnt vmcnt(18)
    s_barrier
    s_add_u32 m0, s91, 135168
    s_mov_b64 exec, s[84:85]
    buffer_load_dwordx4 v221, s[36:39], s94 offen lds
    s_mov_b64 exec, -1
    s_add_u32 m0, s62, 137216
    s_nop 0
    buffer_load_dwordx4 v217, s[36:39], s94 offen lds
    buffer_load_dwordx4 v218, s[36:39], s94 offen offset:1024 lds
    s_add_u32 m0, s61, 81920
    s_mul_i32 s59, s93, 96
    buffer_load_dwordx4 v200, s[8:11], s59 offen lds
    buffer_load_dwordx4 v201, s[8:11], s59 offen offset:1024 lds
    buffer_load_dwordx4 v202, s[8:11], s59 offen offset:2048 lds
    s_add_u32 s93, s93, 6144
    s_and_b32 s93, s93, 65535
    buffer_load_dwordx4 v[16:19], v96, s[72:75], s76 offen
    s_add_u32 s76, s76, 57344
    s_barrier
    s_add_u32 m0, s62, 137216
    s_nop 0
    buffer_load_dwordx4 v219, s[36:39], s94 offen offset:2048 lds
    buffer_load_dwordx4 v220, s[36:39], s94 offen offset:3072 lds
    s_add_u32 s94, s94, 256
    s_and_b32 s94, s94, 2047
    s_add_u32 m0, s61, 0
    s_mul_i32 s59, s93, 96
    buffer_load_dwordx4 v200, s[8:11], s59 offen lds
    buffer_load_dwordx4 v201, s[8:11], s59 offen offset:1024 lds
    buffer_load_dwordx4 v202, s[8:11], s59 offen offset:2048 lds
    s_add_u32 s93, s93, 2048
    s_and_b32 s93, s93, 65535
    s_cmp_eq_u32 s44, 0
    s_movk_i32 s55, 1408
    s_cselect_b32 s55, s55, 4480
    buffer_load_dwordx4 v[104:107], v99, s[16:19], s55 offen
    s_waitcnt vmcnt(18)
    s_barrier
    s_add_u32 m0, s91, 98304
    s_mov_b64 exec, s[84:85]
    buffer_load_dwordx4 v221, s[36:39], s94 offen lds
    s_mov_b64 exec, -1
    s_add_u32 m0, s62, 100352
    s_nop 0
    buffer_load_dwordx4 v217, s[36:39], s94 offen lds
    buffer_load_dwordx4 v218, s[36:39], s94 offen offset:1024 lds
    s_add_u32 m0, s61, 16384
    s_mul_i32 s59, s93, 96
    buffer_load_dwordx4 v200, s[8:11], s59 offen lds
    buffer_load_dwordx4 v201, s[8:11], s59 offen offset:1024 lds
    buffer_load_dwordx4 v202, s[8:11], s59 offen offset:2048 lds
    s_add_u32 s93, s93, 6144
    s_and_b32 s93, s93, 65535
    buffer_load_dwordx4 v[20:23], v96, s[72:75], s76 offen
    s_add_u32 s76, s76, 57344
    s_barrier
    v_lshlrev_b32 v227, 1, v254
    v_and_b32 v227, 0xff, v227
    buffer_load_dword v98, v227, s[32:35], 0 offen sc0 sc1
    s_add_u32 m0, s62, 100352
    s_nop 0
    buffer_load_dwordx4 v219, s[36:39], s94 offen offset:2048 lds
    buffer_load_dwordx4 v220, s[36:39], s94 offen offset:3072 lds
    s_add_u32 s94, s94, 256
    s_and_b32 s94, s94, 2047
    s_add_u32 m0, s61, 32768
    s_mul_i32 s59, s93, 96
    buffer_load_dwordx4 v200, s[8:11], s59 offen lds
    buffer_load_dwordx4 v201, s[8:11], s59 offen offset:1024 lds
    buffer_load_dwordx4 v202, s[8:11], s59 offen offset:2048 lds
    s_add_u32 s93, s93, 2048
    s_and_b32 s93, s93, 65535
    s_cmp_eq_u32 s44, 0
    s_movk_i32 s55, 2432
    s_cselect_b32 s55, s55, 5376
    buffer_load_dwordx4 v[108:111], v99, s[16:19], s55 offen
    s_waitcnt vmcnt(18)
    s_barrier
    s_add_u32 m0, s91, 116736
    s_mov_b64 exec, s[84:85]
    buffer_load_dwordx4 v221, s[36:39], s94 offen lds
    s_mov_b64 exec, -1
    s_add_u32 m0, s62, 118784
    s_nop 0
    buffer_load_dwordx4 v217, s[36:39], s94 offen lds
    buffer_load_dwordx4 v218, s[36:39], s94 offen offset:1024 lds
    s_add_u32 m0, s61, 49152
    s_mul_i32 s59, s93, 96
    buffer_load_dwordx4 v200, s[8:11], s59 offen lds
    buffer_load_dwordx4 v201, s[8:11], s59 offen offset:1024 lds
    buffer_load_dwordx4 v202, s[8:11], s59 offen offset:2048 lds
    s_add_u32 s93, s93, 6144
    s_and_b32 s93, s93, 65535
    buffer_load_dwordx4 v[24:27], v96, s[72:75], s76 offen
    s_add_u32 s76, s76, 57344
    s_barrier
    s_add_u32 m0, s62, 118784
    s_nop 0
    buffer_load_dwordx4 v219, s[36:39], s94 offen offset:2048 lds
    buffer_load_dwordx4 v220, s[36:39], s94 offen offset:3072 lds
    s_add_u32 s94, s94, 256
    s_and_b32 s94, s94, 2047
    s_add_u32 m0, s61, 65536
    s_mul_i32 s59, s93, 96
    buffer_load_dwordx4 v200, s[8:11], s59 offen lds
    buffer_load_dwordx4 v201, s[8:11], s59 offen offset:1024 lds
    buffer_load_dwordx4 v202, s[8:11], s59 offen offset:2048 lds
    s_add_u32 s93, s93, 2048
    s_and_b32 s93, s93, 65535
    s_cmp_eq_u32 s44, 0
    s_movk_i32 s55, 3328
    s_cselect_b32 s55, s55, 6528
    buffer_load_dwordx4 v[112:115], v99, s[16:19], s55 offen
    s_waitcnt vmcnt(17)
    s_barrier
    s_mov_b32 s56, 262144
hs_52:
    v_and_b32 v225, 63, v98
    v_cmp_ne_u32 vcc, 32, v225
    s_cbranch_vccz hs_53
    buffer_load_dword v98, v227, s[32:35], 0 offen sc0 sc1
    s_waitcnt vmcnt(0)
    s_sub_u32 s56, s56, 1
    s_cmp_lg_u32 s56, 0
    s_cbranch_scc1 hs_52
hs_53:
    s_mov_b32 s55, 71565312
    buffer_load_dwordx4 v[72:75], v254, s[4:7], s55 offen sc0 sc1
    s_add_u32 m0, s91, 135168
    s_mov_b64 exec, s[84:85]
    buffer_load_dwordx4 v221, s[36:39], s94 offen lds
    s_mov_b64 exec, -1
    s_add_u32 m0, s62, 137216
    s_nop 0
    buffer_load_dwordx4 v217, s[36:39], s94 offen lds
    buffer_load_dwordx4 v218, s[36:39], s94 offen offset:1024 lds
    s_add_u32 m0, s61, 81920
    s_mul_i32 s59, s93, 96
    buffer_load_dwordx4 v200, s[8:11], s59 offen lds
    buffer_load_dwordx4 v201, s[8:11], s59 offen offset:1024 lds
    buffer_load_dwordx4 v202, s[8:11], s59 offen offset:2048 lds
    s_add_u32 s93, s93, 6144
    s_and_b32 s93, s93, 65535
    s_and_b32 s55, s2, 7
    s_lshl_b32 s56, s77, 5
    v_readlane_b32 s55, v98, s55
    s_nop 3
    s_cmp_lg_u32 s55, s56
    s_cselect_b32 s45, 1, 0
    v_mov_b32 v224, 163712
    v_mov_b32 v225, s45
    ds_write_b32 v224, v225
    buffer_load_dwordx4 v[28:31], v96, s[72:75], s76 offen
    s_add_u32 s76, s76, 57344
    s_barrier
    s_add_u32 m0, s62, 137216
    s_nop 0
    buffer_load_dwordx4 v219, s[36:39], s94 offen offset:2048 lds
    v_and_b32 v173, 0xf0, v254
    buffer_load_dwordx4 v220, s[36:39], s94 offen offset:3072 lds
    s_add_u32 s94, s94, 256
    s_and_b32 s94, s94, 2047
    v_min_u32 v173, 0xb0, v173
    s_mul_i32 s55, s42, 192
    v_add_u32 v173, s55, v173
    s_add_u32 m0, s61, 0
    s_mul_i32 s59, s93, 96
    buffer_load_dwordx4 v200, s[8:11], s59 offen lds
    v_lshrrev_b32 v224, 8, v173
    v_and_b32 v225, 0xff, v173
    buffer_load_dwordx4 v201, s[8:11], s59 offen offset:1024 lds
    v_lshl_add_u32 v224, v224, 12, v225
    v_lshrrev_b32 v225, 8, v254
    buffer_load_dwordx4 v202, s[8:11], s59 offen offset:2048 lds
    s_add_u32 s93, s93, 2048
    s_and_b32 s93, s93, 65535
    v_mul_u32_u24 v225, 12288, v225
    s_lshl_b32 s55, s51, 8
    v_add3_u32 v174, v224, v225, s55
    s_waitcnt vmcnt(17)
    s_barrier
    s_add_u32 m0, s91, 98304
    s_mov_b64 exec, s[84:85]
    buffer_load_dwordx4 v221, s[36:39], s94 offen lds
    s_mov_b64 exec, -1
    s_add_u32 m0, s62, 100352
    s_nop 0
    buffer_load_dwordx4 v217, s[36:39], s94 offen lds
    buffer_load_dwordx4 v218, s[36:39], s94 offen offset:1024 lds
    s_add_u32 m0, s61, 16384
    s_mul_i32 s59, s93, 96
    buffer_load_dwordx4 v200, s[8:11], s59 offen lds
    buffer_load_dwordx4 v201, s[8:11], s59 offen offset:1024 lds
    buffer_load_dwordx4 v202, s[8:11], s59 offen offset:2048 lds
    s_add_u32 s93, s93, 6144
    s_and_b32 s93, s93, 65535
    s_barrier
    s_waitcnt vmcnt(18)
    v_and_b32 v72, v72, v73
    v_and_b32 v74, v74, v75
    v_and_b32 v72, v72, v74
    v_cmp_ne_u32 vcc, 1, v72
    s_cbranch_vccz a4_54
    s_mov_b32 s55, 71565312
    s_mov_b32 s56, 262144
p4_55:
    buffer_load_dwordx4 v[72:75], v254, s[4:7], s55 offen sc0 sc1
    s_waitcnt vmcnt(0)
    v_and_b32 v72, v72, v73
    v_and_b32 v74, v74, v75
    v_and_b32 v72, v72, v74
    v_cmp_ne_u32 vcc, 1, v72
    s_cbranch_vccz p4_56
    s_sleep 1
    s_sub_u32 s56, s56, 1
    s_cmp_lg_u32 s56, 0
    s_cbranch_scc1 p4_55
p4_56:
a4_54:
    s_add_u32 m0, s62, 100352
    s_nop 0
    buffer_load_dwordx4 v219, s[36:39], s94 offen offset:2048 lds
    buffer_load_dwordx4 v220, s[36:39], s94 offen offset:3072 lds
    s_add_u32 s94, s94, 256
    s_and_b32 s94, s94, 2047
    v_and_b32 v226, 0xf0, v254
    v_and_b32 v227, 0x300, v254
    v_lshl_add_u32 v227, v227, 2, v226
    s_lshl_b32 s78, s42, 8
    s_add_u32 s78, s78, s53
    s_add_u32 s78, s78, 65536
    s_add_u32 m0, s61, 32768
    s_mul_i32 s59, s93, 96
    buffer_load_dwordx4 v200, s[8:11], s59 offen lds
    buffer_load_dwordx4 v[144:147], v227, s[4:7], s78 offen
    s_add_u32 s78, s78, 4096
    buffer_load_dwordx4 v201, s[8:11], s59 offen offset:1024 lds
    buffer_load_dwordx4 v[148:151], v227, s[4:7], s78 offen
    s_add_u32 s78, s78, 4096
    buffer_load_dwordx4 v202, s[8:11], s59 offen offset:2048 lds
    s_add_u32 s93, s93, 2048
    s_and_b32 s93, s93, 65535
    buffer_load_dwordx4 v[152:155], v227, s[4:7], s78 offen
    s_add_u32 s78, s78, 4096
    s_waitcnt vmcnt(17)
    s_barrier
    s_add_u32 m0, s91, 116736
    s_mov_b64 exec, s[84:85]
    buffer_load_dwordx4 v221, s[36:39], s94 offen lds
    s_mov_b64 exec, -1
    s_add_u32 m0, s62, 118784
    s_nop 0
    buffer_load_dwordx4 v217, s[36:39], s94 offen lds
    buffer_load_dwordx4 v[156:159], v227, s[4:7], s78 offen
    s_add_u32 s78, s78, 4096
    buffer_load_dwordx4 v218, s[36:39], s94 offen offset:1024 lds
    v_lshrrev_b32 v224, 7, v254
    v_and_b32 v175, 0x70, v254
    v_lshl_add_u32 v224, v224, 10, v175
    s_sub_u32 s70, s53, 4127872
    s_cmp_eq_u32 s40, 0
    s_cselect_b32 s70, 2130706432, s70
    s_add_u32 m0, s61, 49152
    s_mul_i32 s59, s93, 96
    buffer_load_dwordx4 v200, s[8:11], s59 offen lds
    buffer_load_dwordx4 v201, s[8:11], s59 offen offset:1024 lds
    buffer_load_dwordx4 v[164:167], v224, s[4:7], s70 offen
    s_add_u32 s70, s70, 8192
    buffer_load_dwordx4 v202, s[8:11], s59 offen offset:2048 lds
    s_add_u32 s93, s93, 6144
    s_and_b32 s93, s93, 65535
    buffer_load_dwordx4 v[168:171], v224, s[4:7], s70 offen
    s_add_u32 s70, s70, 8192
    s_barrier
    s_add_u32 m0, s62, 118784
    s_nop 0
    buffer_load_dwordx4 v219, s[36:39], s94 offen offset:2048 lds
    buffer_load_dwordx4 v220, s[36:39], s94 offen offset:3072 lds
    s_add_u32 s94, s94, 256
    s_and_b32 s94, s94, 2047
    s_add_u32 m0, s61, 65536
    s_mul_i32 s59, s93, 96
    buffer_load_dwordx4 v200, s[8:11], s59 offen lds
    s_mov_b32 s55, 70516736
    buffer_load_dwordx4 v[76:79], v174, s[4:7], s55 offen sc1
    buffer_load_dwordx4 v201, s[8:11], s59 offen offset:1024 lds
    buffer_load_dwordx4 v202, s[8:11], s59 offen offset:2048 lds
    s_add_u32 s93, s93, 2048
    s_and_b32 s93, s93, 65535
    s_mov_b32 s55, 70565888
    buffer_load_dwordx4 v[80:83], v174, s[4:7], s55 offen sc1
    s_waitcnt vmcnt(22)
    s_barrier
    s_waitcnt vmcnt(13)
    s_add_u32 m0, s91, 135168
    s_mov_b64 exec, s[84:85]
    buffer_load_dwordx4 v221, s[36:39], s94 offen lds
    s_mov_b64 exec, -1
    s_mov_b32 s55, 70615040
    buffer_load_dwordx4 v[84:87], v174, s[4:7], s55 offen sc1
    s_mov_b32 s55, 70664192
    buffer_load_dwordx4 v[88:91], v174, s[4:7], s55 offen sc1
    v_add_f32 v144, v144, v148
    v_add_f32 v145, v145, v149
    s_add_u32 m0, s62, 137216
    s_nop 0
    buffer_load_dwordx4 v217, s[36:39], s94 offen lds
    v_add_f32 v146, v146, v150
    v_add_f32 v147, v147, v151
    v_add_f32 v152, v152, v156
    v_add_f32 v153, v153, v157
    v_add_f32 v154, v154, v158
    buffer_load_dwordx4 v218, s[36:39], s94 offen offset:1024 lds
    v_add_f32 v155, v155, v159
    v_add_f32 v160, v144, v152
    v_add_f32 v161, v145, v153
    v_add_f32 v162, v146, v154
    s_add_u32 m0, s61, 81920
    s_mul_i32 s59, s93, 96
    buffer_load_dwordx4 v200, s[8:11], s59 offen lds
    v_add_f32 v163, v147, v155
    v_mov_b32 v144, v160
    v_mov_b32 v145, v161
    v_mov_b32 v146, v162
    v_mov_b32 v147, v163
    buffer_load_dwordx4 v201, s[8:11], s59 offen offset:1024 lds
    s_nop 1
    v_permlane16_swap_b32 v160, v144
    v_permlane16_swap_b32 v161, v145
    v_permlane16_swap_b32 v162, v146
    buffer_load_dwordx4 v202, s[8:11], s59 offen offset:2048 lds
    s_add_u32 s93, s93, 6144
    s_and_b32 s93, s93, 65535
    v_permlane16_swap_b32 v163, v147
    v_add_f32 v160, v160, v144
    v_add_f32 v161, v161, v145
    v_add_f32 v162, v162, v146
    v_add_f32 v163, v163, v147
    s_barrier
    s_add_u32 m0, s62, 137216
    s_nop 0
    buffer_load_dwordx4 v219, s[36:39], s94 offen offset:2048 lds
    v_mov_b32 v144, v160
    v_mov_b32 v145, v161
    buffer_load_dwordx4 v220, s[36:39], s94 offen offset:3072 lds
    s_add_u32 s94, s94, 256
    s_and_b32 s94, s94, 2047
    v_mov_b32 v146, v162
    v_mov_b32 v147, v163
    s_nop 1
    s_add_u32 m0, s61, 0
    s_mul_i32 s59, s93, 96
    buffer_load_dwordx4 v200, s[8:11], s59 offen lds
    v_permlane32_swap_b32 v160, v144
    v_permlane32_swap_b32 v161, v145
    buffer_load_dwordx4 v201, s[8:11], s59 offen offset:1024 lds
    v_permlane32_swap_b32 v162, v146
    v_permlane32_swap_b32 v163, v147
    v_add_f32 v160, v160, v144
    buffer_load_dwordx4 v202, s[8:11], s59 offen offset:2048 lds
    s_add_u32 s93, s93, 2048
    s_and_b32 s93, s93, 65535
    v_add_f32 v161, v161, v145
    v_add_f32 v162, v162, v146
    v_add_f32 v163, v163, v147
    s_waitcnt vmcnt(18)
    s_barrier
    s_add_u32 m0, s91, 98304
    s_mov_b64 exec, s[84:85]
    buffer_load_dwordx4 v221, s[36:39], s94 offen lds
    s_mov_b64 exec, -1
    v_mul_f32 v160, 0x3a800000, v160
    v_mul_f32 v161, 0x3a800000, v161
    s_add_u32 m0, s62, 100352
    s_nop 0
    buffer_load_dwordx4 v217, s[36:39], s94 offen lds
    v_fma_f32 v161, -v160, v160, v161
    v_max_f32 v161, 0, v161
    v_cvt_pk_bf16_f32 v160, v160, v160
    buffer_load_dwordx4 v218, s[36:39], s94 offen offset:1024 lds
    v_lshlrev_b32 v160, 16, v160
    v_cvt_pk_bf16_f32 v161, v161, v161
    v_lshlrev_b32 v161, 16, v161
    s_add_u32 m0, s61, 16384
    s_mul_i32 s59, s93, 96
    buffer_load_dwordx4 v200, s[8:11], s59 offen lds
    v_add_f32 v161, 0x3727c5ac, v161
    v_cvt_pk_bf16_f32 v161, v161, v161
    v_lshlrev_b32 v161, 16, v161
    buffer_load_dwordx4 v201, s[8:11], s59 offen offset:1024 lds
    v_sqrt_f32 v161, v161
    s_nop 0
    v_cvt_pk_bf16_f32 v161, v161, v161
    buffer_load_dwordx4 v202, s[8:11], s59 offen offset:2048 lds
    v_lshlrev_b32 v161, 16, v161
    v_rcp_f32 v161, v161
    s_nop 0
    s_barrier
    s_add_u32 m0, s62, 100352
    s_nop 0
    buffer_load_dwordx4 v219, s[36:39], s94 offen offset:2048 lds
    v_mul_f32 v162, 0x3a800000, v162
    v_mul_f32 v163, 0x3a800000, v163
    v_fma_f32 v163, -v162, v162, v163
    v_max_f32 v163, 0, v163
    buffer_load_dwordx4 v220, s[36:39], s94 offen offset:3072 lds
    v_cvt_pk_bf16_f32 v162, v162, v162
    v_lshlrev_b32 v162, 16, v162
    v_cvt_pk_bf16_f32 v163, v163, v163
    v_lshlrev_b32 v163, 16, v163
    v_add_f32 v163, 0x3727c5ac, v163
    s_lshl_b32 s93, s43, 1
    s_add_u32 s93, s51, s93
    s_and_b32 s93, s93, 15
    s_add_u32 m0, s62, 32768
    s_lshl_b32 s93, s93, 17
    buffer_load_dwordx4 v203, s[12:15], s93 offen lds
    v_cvt_pk_bf16_f32 v163, v163, v163
    v_lshlrev_b32 v163, 16, v163
    v_sqrt_f32 v163, v163
    s_nop 0
    buffer_load_dwordx4 v204, s[12:15], s93 offen offset:1024 lds
    v_cvt_pk_bf16_f32 v163, v163, v163
    v_lshlrev_b32 v163, 16, v163
    v_rcp_f32 v163, v163
    s_nop 0
    v_lshrrev_b32 v226, 1, v226
    s_lshl_b32 s55, s42, 7
    s_add_u32 s55, s55, 159808
    v_add_u32 v226, s55, v226
    v_sub_f32 v160, 0, v160
    v_sub_f32 v162, 0, v162
    ds_write2_b32 v226, v160, v162 offset0:0 offset1:1
    ds_write2_b32 v226, v161, v163 offset0:144 offset1:145
    buffer_load_dwordx4 v205, s[12:15], s93 offen offset:2048 lds
    v_add_f32 v164, v164, v168
    v_add_f32 v165, v165, v169
    v_add_f32 v166, v166, v170
    v_add_f32 v167, v167, v171
    buffer_load_dwordx4 v206, s[12:15], s93 offen offset:3072 lds
    s_add_u32 s93, s93, 524288
    s_and_b32 s93, s93, 2097151
    s_nop 1
    v_add_f32_dpp v164, v164, v164 row_ror:8 row_mask:0xf bank_mask:0xf
    v_add_f32_dpp v165, v165, v165 row_ror:8 row_mask:0xf bank_mask:0xf
    v_add_f32_dpp v166, v166, v166 row_ror:8 row_mask:0xf bank_mask:0xf
    v_add_f32_dpp v167, v167, v167 row_ror:8 row_mask:0xf bank_mask:0xf
    s_waitcnt vmcnt(15)
    s_barrier
    s_add_u32 m0, s62, 49152
    s_nop 0
    buffer_load_dwordx4 v203, s[12:15], s93 offen lds
    v_mov_b32 v168, v164
    v_mov_b32 v169, v165
    v_mov_b32 v170, v166
    v_mov_b32 v171, v167
    s_nop 1
    v_permlane16_swap_b32 v164, v168
    buffer_load_dwordx4 v204, s[12:15], s93 offen offset:1024 lds
    v_permlane16_swap_b32 v165, v169
    v_permlane16_swap_b32 v166, v170
    v_permlane16_swap_b32 v167, v171
    v_add_f32 v164, v164, v168
    v_add_f32 v165, v165, v169
    v_add_f32 v166, v166, v170
    v_add_f32 v167, v167, v171
    buffer_load_dwordx4 v205, s[12:15], s93 offen offset:2048 lds
    v_mov_b32 v168, v164
    v_mov_b32 v169, v165
    v_mov_b32 v170, v166
    v_mov_b32 v171, v167
    s_nop 1
    v_permlane32_swap_b32 v164, v168
    buffer_load_dwordx4 v206, s[12:15], s93 offen offset:3072 lds
    s_add_u32 s93, s93, 524288
    s_and_b32 s93, s93, 2097151
    v_permlane32_swap_b32 v165, v169
    v_permlane32_swap_b32 v166, v170
    v_permlane32_swap_b32 v167, v171
    v_add_f32 v164, v164, v168
    v_add_f32 v165, v165, v169
    v_add_f32 v166, v166, v170
    v_add_f32 v167, v167, v171
    buffer_load_dwordx4 v[32:35], v96, s[72:75], s76 offen
    s_add_u32 s76, s76, 57344
    buffer_load_dwordx4 v[36:39], v96, s[72:75], s76 offen
    s_add_u32 s76, s76, 57344
    s_barrier
    s_add_u32 m0, s62, 65536
    s_nop 0
    buffer_load_dwordx4 v203, s[12:15], s93 offen lds
    v_mul_f32 v164, 0x3a800000, v164
    v_mul_f32 v165, 0x3a800000, v165
    v_fma_f32 v165, -v164, v164, v165
    v_max_f32 v165, 0, v165
    v_cvt_pk_bf16_f32 v164, v164, v164
    v_lshlrev_b32 v164, 16, v164
    v_cvt_pk_bf16_f32 v165, v165, v165
    v_lshlrev_b32 v165, 16, v165
    v_add_f32 v165, 0x3727c5ac, v165
    v_cvt_pk_bf16_f32 v165, v165, v165
    buffer_load_dwordx4 v204, s[12:15], s93 offen offset:1024 lds
    v_lshlrev_b32 v165, 16, v165
    v_sqrt_f32 v165, v165
    s_nop 0
    v_cvt_pk_bf16_f32 v165, v165, v165
    v_lshlrev_b32 v165, 16, v165
    v_rcp_f32 v165, v165
    s_nop 0
    v_mul_f32 v166, 0x3a800000, v166
    v_mul_f32 v167, 0x3a800000, v167
    v_fma_f32 v167, -v166, v166, v167
    buffer_load_dwordx4 v205, s[12:15], s93 offen offset:2048 lds
    v_max_f32 v167, 0, v167
    v_cvt_pk_bf16_f32 v166, v166, v166
    v_lshlrev_b32 v166, 16, v166
    v_cvt_pk_bf16_f32 v167, v167, v167
    v_lshlrev_b32 v167, 16, v167
    v_add_f32 v167, 0x3727c5ac, v167
    v_cvt_pk_bf16_f32 v167, v167, v167
    v_lshlrev_b32 v167, 16, v167
    v_sqrt_f32 v167, v167
    s_nop 0
    buffer_load_dwordx4 v206, s[12:15], s93 offen offset:3072 lds
    s_add_u32 s93, s93, 524288
    s_and_b32 s93, s93, 2097151
    v_cvt_pk_bf16_f32 v167, v167, v167
    v_lshlrev_b32 v167, 16, v167
    v_rcp_f32 v167, v167
    s_nop 0
    v_lshrrev_b32 v175, 1, v175
    v_add_u32 v175, 159744, v175
    v_sub_f32 v164, 0, v164
    v_sub_f32 v166, 0, v166
    ds_write2_b32 v175, v164, v166 offset0:0 offset1:1
    ds_write2_b32 v175, v165, v167 offset0:144 offset1:145
    buffer_load_dwordx4 v[40:43], v96, s[72:75], s76 offen
    s_add_u32 s76, s76, 57344
    buffer_load_dwordx4 v[44:47], v96, s[72:75], s76 offen
    s_add_u32 s76, s76, 57344
    s_waitcnt vmcnt(16)
    s_barrier
    s_add_u32 m0, s62, 81920
    s_nop 0
    buffer_load_dwordx4 v203, s[12:15], s93 offen lds
    v_add_f32 v76, v76, v80
    v_add_f32 v77, v77, v81
    v_add_f32 v78, v78, v82
    v_add_f32 v79, v79, v83
    v_add_f32 v84, v84, v88
    v_add_f32 v85, v85, v89
    buffer_load_dwordx4 v204, s[12:15], s93 offen offset:1024 lds
    v_add_f32 v86, v86, v90
    v_add_f32 v87, v87, v91
    v_add_f32 v76, v76, v84
    v_add_f32 v77, v77, v85
    v_add_f32 v78, v78, v86
    v_add_f32 v79, v79, v87
    buffer_load_dwordx4 v205, s[12:15], s93 offen offset:2048 lds
    v_mov_b32 v80, v76
    v_mov_b32 v81, v77
    v_mov_b32 v82, v78
    v_mov_b32 v83, v79
    s_nop 1
    v_permlane16_swap_b32 v76, v80
    buffer_load_dwordx4 v206, s[12:15], s93 offen offset:3072 lds
    s_add_u32 s93, s93, 655360
    s_and_b32 s93, s93, 2097151
    v_permlane16_swap_b32 v77, v81
    v_permlane16_swap_b32 v78, v82
    v_permlane16_swap_b32 v79, v83
    v_add_f32 v76, v76, v80
    v_add_f32 v77, v77, v81
    v_add_f32 v78, v78, v82
    v_add_f32 v79, v79, v83
    buffer_load_dwordx4 v[48:51], v96, s[72:75], s76 offen
    s_add_u32 s76, s76, 57344
    buffer_load_dwordx4 v[52:55], v96, s[72:75], s76 offen
    s_add_u32 s76, s76, 57344
    s_barrier
    s_add_u32 m0, s62, 0
    s_nop 0
    buffer_load_dwordx4 v203, s[12:15], s93 offen lds
    v_mov_b32 v80, v76
    v_mov_b32 v81, v77
    v_mov_b32 v82, v78
    buffer_load_dwordx4 v204, s[12:15], s93 offen offset:1024 lds
    v_mov_b32 v83, v79
    s_nop 1
    v_permlane32_swap_b32 v76, v80
    v_permlane32_swap_b32 v77, v81
    buffer_load_dwordx4 v205, s[12:15], s93 offen offset:2048 lds
    v_permlane32_swap_b32 v78, v82
    v_permlane32_swap_b32 v79, v83
    v_add_f32 v76, v76, v80
    v_add_f32 v77, v77, v81
    buffer_load_dwordx4 v206, s[12:15], s93 offen offset:3072 lds
    s_add_u32 s93, s93, 524288
    s_and_b32 s93, s93, 2097151
    v_add_f32 v78, v78, v82
    v_add_f32 v79, v79, v83
    v_add_u32 v173, 160896, v173
    ds_write_b128 v173, v[76:79]
    buffer_load_dwordx4 v[56:59], v96, s[72:75], s76 offen
    s_add_u32 s76, s76, 57344
    buffer_load_dwordx4 v[60:63], v96, s[72:75], s76 offen
    s_add_u32 s76, s76, 57344
    s_waitcnt lgkmcnt(0)
    s_barrier
    s_add_u32 m0, s62, 16384
    s_nop 0
    buffer_load_dwordx4 v203, s[12:15], s93 offen lds
    buffer_load_dwordx4 v204, s[12:15], s93 offen offset:1024 lds
    buffer_load_dwordx4 v205, s[12:15], s93 offen offset:2048 lds
    buffer_load_dwordx4 v206, s[12:15], s93 offen offset:3072 lds
    s_add_u32 s93, s93, 524288
    s_and_b32 s93, s93, 2097151
    buffer_store_dwordx4 v[64:67], v254, s[4:7], s90 offen sc0 sc1
    s_add_u32 s90, s90, 65536
    buffer_store_dwordx4 v[68:71], v254, s[4:7], s90 offen sc0 sc1
    s_add_u32 s90, s90, 65536
    s_cmp_eq_u32 s44, 0
    s_movk_i32 s55, 1408
    s_cselect_b32 s55, s55, 4480
    s_lshl_b32 s56, s43, 23
    s_add_u32 s55, s55, s56
    s_add_u32 s55, s55, 83886336
    buffer_store_dwordx4 v[104:107], v99, s[4:7], s55 offen sc0 sc1
    s_cmp_eq_u32 s44, 0
    s_movk_i32 s55, 2432
    s_cselect_b32 s55, s55, 5376
    s_lshl_b32 s56, s43, 23
    s_add_u32 s55, s55, s56
    s_add_u32 s55, s55, 83886336
    buffer_store_dwordx4 v[108:111], v99, s[4:7], s55 offen sc0 sc1
    s_cmp_eq_u32 s44, 0
    s_movk_i32 s55, 3328
    s_cselect_b32 s55, s55, 6528
    s_lshl_b32 s56, s43, 23
    s_add_u32 s55, s55, s56
    s_add_u32 s55, s55, 83886336
    buffer_store_dwordx4 v[112:115], v99, s[4:7], s55 offen sc0 sc1
    s_setprio 0
    s_branch Y_g2
Y_layer:
    s_mov_b32 s36, s4
    s_mov_b32 s37, s5
    s_mov_b32 s38, s6
    s_mov_b32 s39, s7
    s_add_u32 s88, s48, s62
    s_lshl_b32 s56, s43, 10
    s_add_u32 s89, s48, s56
    s_sub_u32 s89, s89, 4179968
    v_add_u32 v217, s88, v254
    s_lshl_b32 s94, s51, 14
    s_cmp_eq_u32 s40, 0
    s_cselect_b32 s89, 2130706432, s89
    s_sub_u32 s89, s89, s88
    v_add_u32 v221, s89, v217
    s_lshl_b32 s91, s43, 10
    s_cmp_eq_u32 s44, 0
    s_cselect_b32 s84, -1, 0
    s_not_b32 s85, s84
    s_add_u32 s59, s0, 4294967232
    s_add_u32 s60, s54, 8064
    s_and_b32 s55, s40, 3
    s_cselect_b32 s59, s59, s60
    s_cselect_b32 s60, 28, 60
    s_add_u32 s55, s0, 64
    s_cmp_eq_u32 s40, 0
    s_cselect_b32 s59, s55, s59
    s_cselect_b32 s60, 28, s60
    v_lshrrev_b32 v224, 2, v254
    v_and_b32 v224, 60, v224
    v_min_u32 v225, s60, v224
    v_add_u32 v225, s59, v225
    v_min_u32 v224, 28, v224
    v_add_u32 v224, s55, v224
    v_cmp_gt_u32 vcc, 256, v254
    v_lshlrev_b32 v226, 3, v254
    v_and_b32 v226, 0xfff, v226
    v_cndmask_b32 v224, v225, v224, vcc
    s_add_u32 s92, s88, s94
    s_barrier
    buffer_load_dword v251, v226, s[4:7], s92 offen sc0 sc1
    s_mov_b32 s56, 262144
poll_57:
    buffer_load_dword v225, v224, s[4:7], 0 offen sc0 sc1
    s_waitcnt vmcnt(0)
    v_cmp_ne_u32 vcc, 0x01010101, v225
    s_cbranch_vccz pd_58
    s_sleep 1
    s_sub_u32 s56, s56, 1
    s_cmp_lg_u32 s56, 0
    s_cbranch_scc1 poll_57
pd_58:
    s_add_u32 m0, s91, 98304
    s_mov_b64 exec, s[84:85]
    buffer_load_dwordx4 v221, s[36:39], s94 offen lds
    s_mov_b64 exec, -1
    s_add_u32 m0, s62, 100352
    s_nop 0
    buffer_load_dwordx4 v217, s[36:39], s94 offen lds
    buffer_load_dwordx4 v217, s[36:39], s94 offen offset:1024 lds
    buffer_load_dwordx4 v217, s[36:39], s94 offen offset:2048 lds
    buffer_load_dwordx4 v217, s[36:39], s94 offen offset:3072 lds
    s_add_u32 s94, s94, 32768
    s_and_b32 s94, s94, 262143
    s_add_u32 m0, s91, 116736
    s_mov_b64 exec, s[84:85]
    buffer_load_dwordx4 v221, s[36:39], s94 offen lds
    s_mov_b64 exec, -1
    s_add_u32 m0, s62, 118784
    s_nop 0
    buffer_load_dwordx4 v217, s[36:39], s94 offen lds
    buffer_load_dwordx4 v217, s[36:39], s94 offen offset:1024 lds
    buffer_load_dwordx4 v217, s[36:39], s94 offen offset:2048 lds
    buffer_load_dwordx4 v217, s[36:39], s94 offen offset:3072 lds
    s_add_u32 s94, s94, 32768
    s_and_b32 s94, s94, 262143
    s_add_u32 m0, s91, 135168
    s_mov_b64 exec, s[84:85]
    buffer_load_dwordx4 v221, s[36:39], s94 offen lds
    s_mov_b64 exec, -1
    s_add_u32 m0, s62, 137216
    s_nop 0
    buffer_load_dwordx4 v217, s[36:39], s94 offen lds
    buffer_load_dwordx4 v217, s[36:39], s94 offen offset:1024 lds
    buffer_load_dwordx4 v217, s[36:39], s94 offen offset:2048 lds
    buffer_load_dwordx4 v217, s[36:39], s94 offen offset:3072 lds
    s_add_u32 s94, s94, 32768
    s_and_b32 s94, s94, 262143
    s_setprio 1
    s_waitcnt vmcnt(10)
    s_barrier
    s_barrier
    s_add_u32 m0, s61, 0
    s_mul_i32 s59, s93, 96
    buffer_load_dwordx4 v200, s[8:11], s59 offen lds
    buffer_load_dwordx4 v201, s[8:11], s59 offen offset:1024 lds
    buffer_load_dwordx4 v202, s[8:11], s59 offen offset:2048 lds
    s_add_u32 s93, s93, 2048
    s_and_b32 s93, s93, 65535
    s_waitcnt vmcnt(8)
    s_barrier
    s_add_u32 m0, s91, 98304
    s_mov_b64 exec, s[84:85]
    buffer_load_dwordx4 v221, s[36:39], s94 offen lds
    s_mov_b64 exec, -1
    s_add_u32 m0, s62, 100352
    s_nop 0
    buffer_load_dwordx4 v217, s[36:39], s94 offen lds
    buffer_load_dwordx4 v217, s[36:39], s94 offen offset:1024 lds
    s_add_u32 m0, s61, 16384
    s_mul_i32 s59, s93, 96
    buffer_load_dwordx4 v200, s[8:11], s59 offen lds
    buffer_load_dwordx4 v201, s[8:11], s59 offen offset:1024 lds
    buffer_load_dwordx4 v202, s[8:11], s59 offen offset:2048 lds
    s_add_u32 s93, s93, 6144
    s_and_b32 s93, s93, 65535
    s_barrier
    s_add_u32 m0, s62, 100352
    s_nop 0
    buffer_load_dwordx4 v217, s[36:39], s94 offen offset:2048 lds
    buffer_load_dwordx4 v217, s[36:39], s94 offen offset:3072 lds
    s_add_u32 s94, s94, 32768
    s_and_b32 s94, s94, 262143
    s_add_u32 m0, s61, 32768
    s_mul_i32 s59, s93, 96
    buffer_load_dwordx4 v200, s[8:11], s59 offen lds
    buffer_load_dwordx4 v201, s[8:11], s59 offen offset:1024 lds
    buffer_load_dwordx4 v202, s[8:11], s59 offen offset:2048 lds
    s_add_u32 s93, s93, 2048
    s_and_b32 s93, s93, 65535
    s_cmp_lg_u32 s42, 0
    s_cbranch_scc1 wf_59
    s_lshl_b32 s55, s51, 2
    s_add_u32 s55, s55, s54
    v_mov_b32 v252, 14336
    v_mov_b32 v253, 0x01010101
    s_mov_b64 exec, 1
    buffer_store_dword v253, v252, s[4:7], s55 offen sc0 sc1
    s_mov_b64 exec, -1
wf_59:
    s_waitcnt vmcnt(14)
    s_barrier
    s_add_u32 m0, s91, 116736
    s_mov_b64 exec, s[84:85]
    buffer_load_dwordx4 v221, s[36:39], s94 offen lds
    s_mov_b64 exec, -1
    s_add_u32 m0, s62, 118784
    s_nop 0
    buffer_load_dwordx4 v217, s[36:39], s94 offen lds
    buffer_load_dwordx4 v217, s[36:39], s94 offen offset:1024 lds
    s_add_u32 m0, s61, 49152
    s_mul_i32 s59, s93, 96
    buffer_load_dwordx4 v200, s[8:11], s59 offen lds
    buffer_load_dwordx4 v201, s[8:11], s59 offen offset:1024 lds
    buffer_load_dwordx4 v202, s[8:11], s59 offen offset:2048 lds
    s_add_u32 s93, s93, 6144
    s_and_b32 s93, s93, 65535
    s_barrier
    s_add_u32 m0, s62, 118784
    s_nop 0
    buffer_load_dwordx4 v217, s[36:39], s94 offen offset:2048 lds
    buffer_load_dwordx4 v217, s[36:39], s94 offen offset:3072 lds
    s_add_u32 s94, s94, 32768
    s_and_b32 s94, s94, 262143
    s_add_u32 m0, s61, 65536
    s_mul_i32 s59, s93, 96
    buffer_load_dwordx4 v200, s[8:11], s59 offen lds
    buffer_load_dwordx4 v201, s[8:11], s59 offen offset:1024 lds
    buffer_load_dwordx4 v202, s[8:11], s59 offen offset:2048 lds
    s_add_u32 s93, s93, 2048
    s_and_b32 s93, s93, 65535
    s_waitcnt vmcnt(14)
    s_barrier
    s_add_u32 m0, s91, 135168
    s_mov_b64 exec, s[84:85]
    buffer_load_dwordx4 v221, s[36:39], s94 offen lds
    s_mov_b64 exec, -1
    s_add_u32 m0, s62, 137216
    s_nop 0
    buffer_load_dwordx4 v217, s[36:39], s94 offen lds
    buffer_load_dwordx4 v217, s[36:39], s94 offen offset:1024 lds
    s_add_u32 m0, s61, 81920
    s_mul_i32 s59, s93, 96
    buffer_load_dwordx4 v200, s[8:11], s59 offen lds
    buffer_load_dwordx4 v201, s[8:11], s59 offen offset:1024 lds
    buffer_load_dwordx4 v202, s[8:11], s59 offen offset:2048 lds
    s_add_u32 s93, s93, 6144
    s_and_b32 s93, s93, 65535
    s_barrier
    s_add_u32 m0, s62, 137216
    s_nop 0
    buffer_load_dwordx4 v217, s[36:39], s94 offen offset:2048 lds
    buffer_load_dwordx4 v217, s[36:39], s94 offen offset:3072 lds
    s_add_u32 s94, s94, 32768
    s_and_b32 s94, s94, 262143
    s_add_u32 m0, s61, 0
    s_mul_i32 s59, s93, 96
    buffer_load_dwordx4 v200, s[8:11], s59 offen lds
    buffer_load_dwordx4 v201, s[8:11], s59 offen offset:1024 lds
    buffer_load_dwordx4 v202, s[8:11], s59 offen offset:2048 lds
    s_add_u32 s93, s93, 2048
    s_and_b32 s93, s93, 65535
    s_waitcnt vmcnt(14)
    s_barrier
    v_lshrrev_b32 v224, 2, v254
    v_and_b32 v225, 64, v224
    v_and_b32 v224, 60, v224
    s_cmp_eq_u32 s40, 0
    s_cselect_b32 s55, 0, 2
    v_mul_lo_u32 v225, v225, s55
    v_sub_u32 v98, v224, v225
    v_add_u32 v98, 14336, v98
    buffer_load_dword v251, v98, s[4:7], s54 offen sc0 sc1
    s_add_u32 m0, s91, 98304
    s_mov_b64 exec, s[84:85]
    buffer_load_dwordx4 v221, s[36:39], s94 offen lds
    s_mov_b64 exec, -1
    s_add_u32 m0, s62, 100352
    s_nop 0
    buffer_load_dwordx4 v217, s[36:39], s94 offen lds
    buffer_load_dwordx4 v217, s[36:39], s94 offen offset:1024 lds
    s_add_u32 m0, s61, 16384
    s_mul_i32 s59, s93, 96
    buffer_load_dwordx4 v200, s[8:11], s59 offen lds
    buffer_load_dwordx4 v201, s[8:11], s59 offen offset:1024 lds
    buffer_load_dwordx4 v202, s[8:11], s59 offen offset:2048 lds
    s_add_u32 s93, s93, 6144
    s_and_b32 s93, s93, 65535
    s_barrier
    s_add_u32 m0, s62, 100352
    s_nop 0
    buffer_load_dwordx4 v217, s[36:39], s94 offen offset:2048 lds
    buffer_load_dwordx4 v217, s[36:39], s94 offen offset:3072 lds
    s_add_u32 s94, s94, 32768
    s_and_b32 s94, s94, 262143
    s_add_u32 m0, s61, 32768
    s_mul_i32 s59, s93, 96
    buffer_load_dwordx4 v200, s[8:11], s59 offen lds
    buffer_load_dwordx4 v201, s[8:11], s59 offen offset:1024 lds
    buffer_load_dwordx4 v202, s[8:11], s59 offen offset:2048 lds
    s_add_u32 s93, s93, 2048
    s_and_b32 s93, s93, 65535
    s_waitcnt vmcnt(15)
    s_barrier
    s_add_u32 m0, s91, 116736
    s_mov_b64 exec, s[84:85]
    buffer_load_dwordx4 v221, s[36:39], s94 offen lds
    s_mov_b64 exec, -1
    s_add_u32 m0, s62, 118784
    s_nop 0
    buffer_load_dwordx4 v217, s[36:39], s94 offen lds
    buffer_load_dwordx4 v217, s[36:39], s94 offen offset:1024 lds
    s_add_u32 m0, s61, 49152
    s_mul_i32 s59, s93, 96
    buffer_load_dwordx4 v200, s[8:11], s59 offen lds
    buffer_load_dwordx4 v201, s[8:11], s59 offen offset:1024 lds
    buffer_load_dwordx4 v202, s[8:11], s59 offen offset:2048 lds
    s_add_u32 s93, s93, 10240
    s_and_b32 s93, s93, 65535
    s_barrier
    s_waitcnt vmcnt(17)
    s_mov_b32 s56, 262144
poll_60:
    v_cmp_ne_u32 vcc, 0x01010101, v251
    s_cbranch_vccz pd_61
    buffer_load_dword v251, v98, s[4:7], s54 offen sc0 sc1
    s_waitcnt vmcnt(0)
    s_sub_u32 s56, s56, 1
    s_cmp_lg_u32 s56, 0
    s_cbranch_scc1 poll_60
pd_61:
    s_add_u32 m0, s62, 118784
    s_nop 0
    buffer_load_dwordx4 v217, s[36:39], s94 offen offset:2048 lds
    buffer_load_dwordx4 v217, s[36:39], s94 offen offset:3072 lds
    s_add_u32 s94, s94, 49152
    s_and_b32 s94, s94, 262143
    s_add_u32 m0, s61, 65536
    s_mul_i32 s59, s93, 96
    buffer_load_dwordx4 v200, s[8:11], s59 offen lds
    buffer_load_dwordx4 v201, s[8:11], s59 offen offset:1024 lds
    buffer_load_dwordx4 v202, s[8:11], s59 offen offset:2048 lds
    s_add_u32 s93, s93, 2048
    s_and_b32 s93, s93, 65535
    s_waitcnt vmcnt(14)
    s_barrier
    s_add_u32 m0, s91, 135168
    s_mov_b64 exec, s[84:85]
    buffer_load_dwordx4 v221, s[36:39], s94 offen lds
    s_mov_b64 exec, -1
    s_add_u32 m0, s62, 137216
    s_nop 0
    buffer_load_dwordx4 v217, s[36:39], s94 offen lds
    buffer_load_dwordx4 v217, s[36:39], s94 offen offset:1024 lds
    v_and_b32 v226, 0xf0, v254
    v_and_b32 v227, 0x300, v254
    v_lshl_add_u32 v227, v227, 2, v226
    s_lshl_b32 s78, s42, 8
    s_add_u32 s78, s78, s53
    s_add_u32 m0, s61, 81920
    s_mul_i32 s59, s93, 96
    buffer_load_dwordx4 v200, s[8:11], s59 offen lds
    buffer_load_dwordx4 v201, s[8:11], s59 offen offset:1024 lds
    buffer_load_dwordx4 v202, s[8:11], s59 offen offset:2048 lds
    s_add_u32 s93, s93, 6144
    s_and_b32 s93, s93, 65535
    buffer_load_dwordx4 v[144:147], v227, s[4:7], s78 offen
    s_add_u32 s78, s78, 4096
    s_barrier
    s_add_u32 m0, s62, 137216
    s_nop 0
    buffer_load_dwordx4 v217, s[36:39], s94 offen offset:2048 lds
    buffer_load_dwordx4 v217, s[36:39], s94 offen offset:3072 lds
    s_add_u32 s94, s94, 32768
    s_and_b32 s94, s94, 262143
    s_add_u32 m0, s61, 0
    s_mul_i32 s59, s93, 96
    buffer_load_dwordx4 v200, s[8:11], s59 offen lds
    buffer_load_dwordx4 v201, s[8:11], s59 offen offset:1024 lds
    buffer_load_dwordx4 v202, s[8:11], s59 offen offset:2048 lds
    s_add_u32 s93, s93, 2048
    s_and_b32 s93, s93, 65535
    buffer_load_dwordx4 v[148:151], v227, s[4:7], s78 offen
    s_add_u32 s78, s78, 4096
    s_waitcnt vmcnt(16)
    s_barrier
    s_add_u32 m0, s91, 98304
    s_mov_b64 exec, s[84:85]
    buffer_load_dwordx4 v221, s[36:39], s94 offen lds
    s_mov_b64 exec, -1
    s_add_u32 m0, s62, 100352
    s_nop 0
    buffer_load_dwordx4 v217, s[36:39], s94 offen lds
    buffer_load_dwordx4 v217, s[36:39], s94 offen offset:1024 lds
    s_add_u32 m0, s61, 16384
    s_mul_i32 s59, s93, 96
    buffer_load_dwordx4 v200, s[8:11], s59 offen lds
    buffer_load_dwordx4 v201, s[8:11], s59 offen offset:1024 lds
    buffer_load_dwordx4 v202, s[8:11], s59 offen offset:2048 lds
    s_add_u32 s93, s93, 6144
    s_and_b32 s93, s93, 65535
    buffer_load_dwordx4 v[152:155], v227, s[4:7], s78 offen
    s_add_u32 s78, s78, 4096
    s_barrier
    s_add_u32 m0, s62, 100352
    s_nop 0
    buffer_load_dwordx4 v217, s[36:39], s94 offen offset:2048 lds
    buffer_load_dwordx4 v217, s[36:39], s94 offen offset:3072 lds
    s_add_u32 s94, s94, 32768
    s_and_b32 s94, s94, 262143
    s_add_u32 m0, s61, 32768
    s_mul_i32 s59, s93, 96
    buffer_load_dwordx4 v200, s[8:11], s59 offen lds
    buffer_load_dwordx4 v201, s[8:11], s59 offen offset:1024 lds
    buffer_load_dwordx4 v202, s[8:11], s59 offen offset:2048 lds
    s_add_u32 s93, s93, 2048
    s_and_b32 s93, s93, 65535
    buffer_load_dwordx4 v[156:159], v227, s[4:7], s78 offen
    s_add_u32 s78, s78, 4096
    s_waitcnt vmcnt(17)
    s_barrier
    s_add_u32 m0, s91, 116736
    s_mov_b64 exec, s[84:85]
    buffer_load_dwordx4 v221, s[36:39], s94 offen lds
    s_mov_b64 exec, -1
    s_add_u32 m0, s62, 118784
    s_nop 0
    buffer_load_dwordx4 v217, s[36:39], s94 offen lds
    buffer_load_dwordx4 v217, s[36:39], s94 offen offset:1024 lds
    s_add_u32 m0, s61, 49152
    s_mul_i32 s59, s93, 96
    buffer_load_dwordx4 v200, s[8:11], s59 offen lds
    buffer_load_dwordx4 v201, s[8:11], s59 offen offset:1024 lds
    buffer_load_dwordx4 v202, s[8:11], s59 offen offset:2048 lds
    s_add_u32 s93, s93, 6144
    s_and_b32 s93, s93, 65535
    s_barrier
    s_add_u32 m0, s62, 118784
    s_nop 0
    buffer_load_dwordx4 v217, s[36:39], s94 offen offset:2048 lds
    buffer_load_dwordx4 v217, s[36:39], s94 offen offset:3072 lds
    s_add_u32 s94, s94, 32768
    s_and_b32 s94, s94, 262143
    v_lshrrev_b32 v224, 7, v254
    v_and_b32 v175, 0x70, v254
    v_lshl_add_u32 v224, v224, 10, v175
    s_sub_u32 s70, s53, 4193408
    s_cmp_eq_u32 s40, 0
    s_cselect_b32 s70, 2130706432, s70
    s_add_u32 m0, s61, 65536
    s_mul_i32 s59, s93, 96
    buffer_load_dwordx4 v200, s[8:11], s59 offen lds
    buffer_load_dwordx4 v201, s[8:11], s59 offen offset:1024 lds
    buffer_load_dwordx4 v[164:167], v224, s[4:7], s70 offen
    s_add_u32 s70, s70, 8192
    buffer_load_dwordx4 v202, s[8:11], s59 offen offset:2048 lds
    s_add_u32 s93, s93, 2048
    s_and_b32 s93, s93, 65535
    buffer_load_dwordx4 v[168:171], v224, s[4:7], s70 offen
    s_add_u32 s70, s70, 8192
    s_waitcnt vmcnt(17)
    s_barrier
    s_waitcnt vmcnt(13)
    s_add_u32 m0, s91, 135168
    s_mov_b64 exec, s[84:85]
    buffer_load_dwordx4 v221, s[36:39], s94 offen lds
    s_mov_b64 exec, -1
    v_add_f32 v144, v144, v148
    v_add_f32 v145, v145, v149
    v_add_f32 v146, v146, v150
    v_add_f32 v147, v147, v151
    s_add_u32 m0, s62, 137216
    s_nop 0
    buffer_load_dwordx4 v217, s[36:39], s94 offen lds
    v_add_f32 v152, v152, v156
    v_add_f32 v153, v153, v157
    v_add_f32 v154, v154, v158
    v_add_f32 v155, v155, v159
    buffer_load_dwordx4 v217, s[36:39], s94 offen offset:1024 lds
    v_add_f32 v160, v144, v152
    v_add_f32 v161, v145, v153
    v_add_f32 v162, v146, v154
    v_add_f32 v163, v147, v155
    s_add_u32 m0, s61, 81920
    s_mul_i32 s59, s93, 96
    buffer_load_dwordx4 v200, s[8:11], s59 offen lds
    v_mov_b32 v144, v160
    v_mov_b32 v145, v161
    v_mov_b32 v146, v162
    v_mov_b32 v147, v163
    buffer_load_dwordx4 v201, s[8:11], s59 offen offset:1024 lds
    s_nop 1
    v_permlane16_swap_b32 v160, v144
    v_permlane16_swap_b32 v161, v145
    v_permlane16_swap_b32 v162, v146
    buffer_load_dwordx4 v202, s[8:11], s59 offen offset:2048 lds
    s_add_u32 s93, s93, 6144
    s_and_b32 s93, s93, 65535
    v_permlane16_swap_b32 v163, v147
    v_add_f32 v160, v160, v144
    v_add_f32 v161, v161, v145
    v_add_f32 v162, v162, v146
    v_add_f32 v163, v163, v147
    s_barrier
    s_add_u32 m0, s62, 137216
    s_nop 0
    buffer_load_dwordx4 v217, s[36:39], s94 offen offset:2048 lds
    v_mov_b32 v144, v160
    v_mov_b32 v145, v161
    buffer_load_dwordx4 v217, s[36:39], s94 offen offset:3072 lds
    s_add_u32 s94, s94, 32768
    s_and_b32 s94, s94, 262143
    v_mov_b32 v146, v162
    v_mov_b32 v147, v163
    s_nop 1
    s_add_u32 m0, s61, 0
    s_mul_i32 s59, s93, 96
    buffer_load_dwordx4 v200, s[8:11], s59 offen lds
    v_permlane32_swap_b32 v160, v144
    v_permlane32_swap_b32 v161, v145
    buffer_load_dwordx4 v201, s[8:11], s59 offen offset:1024 lds
    v_permlane32_swap_b32 v162, v146
    v_permlane32_swap_b32 v163, v147
    v_add_f32 v160, v160, v144
    buffer_load_dwordx4 v202, s[8:11], s59 offen offset:2048 lds
    s_add_u32 s93, s93, 2048
    s_and_b32 s93, s93, 65535
    v_add_f32 v161, v161, v145
    v_add_f32 v162, v162, v146
    v_add_f32 v163, v163, v147
    s_waitcnt vmcnt(16)
    s_barrier
    s_add_u32 m0, s91, 98304
    s_mov_b64 exec, s[84:85]
    buffer_load_dwordx4 v221, s[36:39], s94 offen lds
    s_mov_b64 exec, -1
    v_mul_f32 v160, 0x3a800000, v160
    v_mul_f32 v161, 0x3a800000, v161
    s_add_u32 m0, s62, 100352
    s_nop 0
    buffer_load_dwordx4 v217, s[36:39], s94 offen lds
    v_fma_f32 v161, -v160, v160, v161
    v_max_f32 v161, 0, v161
    v_cvt_pk_bf16_f32 v160, v160, v160
    buffer_load_dwordx4 v217, s[36:39], s94 offen offset:1024 lds
    v_lshlrev_b32 v160, 16, v160
    v_cvt_pk_bf16_f32 v161, v161, v161
    v_lshlrev_b32 v161, 16, v161
    s_add_u32 m0, s61, 16384
    s_mul_i32 s59, s93, 96
    buffer_load_dwordx4 v200, s[8:11], s59 offen lds
    v_add_f32 v161, 0x3727c5ac, v161
    v_cvt_pk_bf16_f32 v161, v161, v161
    v_lshlrev_b32 v161, 16, v161
    buffer_load_dwordx4 v201, s[8:11], s59 offen offset:1024 lds
    v_sqrt_f32 v161, v161
    s_nop 0
    v_cvt_pk_bf16_f32 v161, v161, v161
    buffer_load_dwordx4 v202, s[8:11], s59 offen offset:2048 lds
    s_add_u32 s93, s93, 6144
    s_and_b32 s93, s93, 65535
    v_lshlrev_b32 v161, 16, v161
    v_rcp_f32 v161, v161
    s_nop 0
    s_barrier
    s_add_u32 m0, s62, 100352
    s_nop 0
    buffer_load_dwordx4 v217, s[36:39], s94 offen offset:2048 lds
    v_mul_f32 v162, 0x3a800000, v162
    v_mul_f32 v163, 0x3a800000, v163
    v_fma_f32 v163, -v162, v162, v163
    buffer_load_dwordx4 v217, s[36:39], s94 offen offset:3072 lds
    s_add_u32 s94, s94, 32768
    s_and_b32 s94, s94, 262143
    v_max_f32 v163, 0, v163
    v_cvt_pk_bf16_f32 v162, v162, v162
    v_lshlrev_b32 v162, 16, v162
    v_cvt_pk_bf16_f32 v163, v163, v163
    s_add_u32 m0, s61, 32768
    s_mul_i32 s59, s93, 96
    buffer_load_dwordx4 v200, s[8:11], s59 offen lds
    v_lshlrev_b32 v163, 16, v163
    v_add_f32 v163, 0x3727c5ac, v163
    v_cvt_pk_bf16_f32 v163, v163, v163
    buffer_load_dwordx4 v201, s[8:11], s59 offen offset:1024 lds
    v_lshlrev_b32 v163, 16, v163
    v_sqrt_f32 v163, v163
    s_nop 0
    v_cvt_pk_bf16_f32 v163, v163, v163
    buffer_load_dwordx4 v202, s[8:11], s59 offen offset:2048 lds
    s_add_u32 s93, s93, 2048
    s_and_b32 s93, s93, 65535
    v_lshlrev_b32 v163, 16, v163
    v_rcp_f32 v163, v163
    s_nop 0
    v_lshrrev_b32 v226, 1, v226
    s_lshl_b32 s55, s42, 7
    s_add_u32 s55, s55, 159808
    v_add_u32 v226, s55, v226
    v_sub_f32 v160, 0, v160
    v_sub_f32 v162, 0, v162
    ds_write2_b32 v226, v160, v162 offset0:0 offset1:1
    ds_write2_b32 v226, v161, v163 offset0:144 offset1:145
    s_waitcnt vmcnt(14)
    s_barrier
    s_add_u32 m0, s91, 116736
    s_mov_b64 exec, s[84:85]
    buffer_load_dwordx4 v221, s[36:39], s94 offen lds
    s_mov_b64 exec, -1
    v_add_f32 v164, v164, v168
    v_add_f32 v165, v165, v169
    v_add_f32 v166, v166, v170
    s_add_u32 m0, s62, 118784
    s_nop 0
    buffer_load_dwordx4 v217, s[36:39], s94 offen lds
    v_add_f32 v167, v167, v171
    s_nop 1
    v_add_f32_dpp v164, v164, v164 row_ror:8 row_mask:0xf bank_mask:0xf
    v_add_f32_dpp v165, v165, v165 row_ror:8 row_mask:0xf bank_mask:0xf
    buffer_load_dwordx4 v217, s[36:39], s94 offen offset:1024 lds
    v_add_f32_dpp v166, v166, v166 row_ror:8 row_mask:0xf bank_mask:0xf
    v_add_f32_dpp v167, v167, v167 row_ror:8 row_mask:0xf bank_mask:0xf
    v_mov_b32 v168, v164
    v_mov_b32 v169, v165
    s_add_u32 m0, s61, 49152
    s_mul_i32 s59, s93, 96
    buffer_load_dwordx4 v200, s[8:11], s59 offen lds
    v_mov_b32 v170, v166
    v_mov_b32 v171, v167
    s_nop 1
    buffer_load_dwordx4 v201, s[8:11], s59 offen offset:1024 lds
    v_permlane16_swap_b32 v164, v168
    v_permlane16_swap_b32 v165, v169
    v_permlane16_swap_b32 v166, v170
    v_permlane16_swap_b32 v167, v171
    buffer_load_dwordx4 v202, s[8:11], s59 offen offset:2048 lds
    s_add_u32 s93, s93, 6144
    s_and_b32 s93, s93, 65535
    v_add_f32 v164, v164, v168
    v_add_f32 v165, v165, v169
    v_add_f32 v166, v166, v170
    v_add_f32 v167, v167, v171
    s_barrier
    s_add_u32 m0, s62, 118784
    s_nop 0
    buffer_load_dwordx4 v217, s[36:39], s94 offen offset:2048 lds
    v_mov_b32 v168, v164
    v_mov_b32 v169, v165
    buffer_load_dwordx4 v217, s[36:39], s94 offen offset:3072 lds
    s_add_u32 s94, s94, 32768
    s_and_b32 s94, s94, 262143
    v_mov_b32 v170, v166
    v_mov_b32 v171, v167
    s_nop 1
    s_add_u32 m0, s61, 65536
    s_mul_i32 s59, s93, 96
    buffer_load_dwordx4 v200, s[8:11], s59 offen lds
    v_permlane32_swap_b32 v164, v168
    v_permlane32_swap_b32 v165, v169
    buffer_load_dwordx4 v201, s[8:11], s59 offen offset:1024 lds
    v_permlane32_swap_b32 v166, v170
    v_permlane32_swap_b32 v167, v171
    v_add_f32 v164, v164, v168
    buffer_load_dwordx4 v202, s[8:11], s59 offen offset:2048 lds
    s_add_u32 s93, s93, 2048
    s_and_b32 s93, s93, 65535
    v_add_f32 v165, v165, v169
    v_add_f32 v166, v166, v170
    v_add_f32 v167, v167, v171
    s_waitcnt vmcnt(14)
    s_barrier
    s_add_u32 m0, s91, 135168
    s_mov_b64 exec, s[84:85]
    buffer_load_dwordx4 v221, s[36:39], s94 offen lds
    s_mov_b64 exec, -1
    v_mul_f32 v164, 0x3a800000, v164
    v_mul_f32 v165, 0x3a800000, v165
    s_add_u32 m0, s62, 137216
    s_nop 0
    buffer_load_dwordx4 v217, s[36:39], s94 offen lds
    v_fma_f32 v165, -v164, v164, v165
    v_max_f32 v165, 0, v165
    v_cvt_pk_bf16_f32 v164, v164, v164
    buffer_load_dwordx4 v217, s[36:39], s94 offen offset:1024 lds
    v_lshlrev_b32 v164, 16, v164
    v_cvt_pk_bf16_f32 v165, v165, v165
    v_lshlrev_b32 v165, 16, v165
    s_add_u32 m0, s61, 81920
    s_mul_i32 s59, s93, 96
    buffer_load_dwordx4 v200, s[8:11], s59 offen lds
    v_add_f32 v165, 0x3727c5ac, v165
    v_cvt_pk_bf16_f32 v165, v165, v165
    v_lshlrev_b32 v165, 16, v165
    buffer_load_dwordx4 v201, s[8:11], s59 offen offset:1024 lds
    v_sqrt_f32 v165, v165
    s_nop 0
    v_cvt_pk_bf16_f32 v165, v165, v165
    buffer_load_dwordx4 v202, s[8:11], s59 offen offset:2048 lds
    s_add_u32 s93, s93, 6144
    s_and_b32 s93, s93, 65535
    v_lshlrev_b32 v165, 16, v165
    v_rcp_f32 v165, v165
    s_nop 0
    s_barrier
    s_add_u32 m0, s62, 137216
    s_nop 0
    buffer_load_dwordx4 v217, s[36:39], s94 offen offset:2048 lds
    v_mul_f32 v166, 0x3a800000, v166
    v_mul_f32 v167, 0x3a800000, v167
    v_fma_f32 v167, -v166, v166, v167
    v_max_f32 v167, 0, v167
    buffer_load_dwordx4 v217, s[36:39], s94 offen offset:3072 lds
    s_add_u32 s94, s94, 32768
    s_and_b32 s94, s94, 262143
    v_cvt_pk_bf16_f32 v166, v166, v166
    v_lshlrev_b32 v166, 16, v166
    v_cvt_pk_bf16_f32 v167, v167, v167
    v_lshlrev_b32 v167, 16, v167
    v_add_f32 v167, 0x3727c5ac, v167
    s_add_u32 m0, s61, 0
    s_mul_i32 s59, s93, 96
    buffer_load_dwordx4 v200, s[8:11], s59 offen lds
    v_cvt_pk_bf16_f32 v167, v167, v167
    v_lshlrev_b32 v167, 16, v167
    v_sqrt_f32 v167, v167
    s_nop 0
    buffer_load_dwordx4 v201, s[8:11], s59 offen offset:1024 lds
    v_cvt_pk_bf16_f32 v167, v167, v167
    v_lshlrev_b32 v167, 16, v167
    v_rcp_f32 v167, v167
    s_nop 0
    v_lshrrev_b32 v175, 1, v175
    buffer_load_dwordx4 v202, s[8:11], s59 offen offset:2048 lds
    s_add_u32 s93, s93, 2048
    s_and_b32 s93, s93, 65535
    v_add_u32 v175, 159744, v175
    v_sub_f32 v164, 0, v164
    v_sub_f32 v166, 0, v166
    ds_write2_b32 v175, v164, v166 offset0:0 offset1:1
    ds_write2_b32 v175, v165, v167 offset0:144 offset1:145
    s_waitcnt vmcnt(14)
    s_barrier
    s_add_u32 m0, s91, 98304
    s_mov_b64 exec, s[84:85]
    buffer_load_dwordx4 v221, s[36:39], s94 offen lds
    s_mov_b64 exec, -1
    s_add_u32 m0, s62, 100352
    s_nop 0
    buffer_load_dwordx4 v217, s[36:39], s94 offen lds
    buffer_load_dwordx4 v217, s[36:39], s94 offen offset:1024 lds
    s_add_u32 m0, s61, 16384
    s_mul_i32 s59, s93, 96
    buffer_load_dwordx4 v200, s[8:11], s59 offen lds
    buffer_load_dwordx4 v201, s[8:11], s59 offen offset:1024 lds
    buffer_load_dwordx4 v202, s[8:11], s59 offen offset:2048 lds
    s_barrier
    s_add_u32 m0, s62, 100352
    s_nop 0
    buffer_load_dwordx4 v217, s[36:39], s94 offen offset:2048 lds
    buffer_load_dwordx4 v217, s[36:39], s94 offen offset:3072 lds
    s_lshl_b32 s93, s43, 1
    s_add_u32 s93, s51, s93
    s_and_b32 s93, s93, 15
    s_add_u32 m0, s62, 32768
    s_lshl_b32 s93, s93, 17
    buffer_load_dwordx4 v203, s[12:15], s93 offen lds
    buffer_load_dwordx4 v204, s[12:15], s93 offen offset:1024 lds
    buffer_load_dwordx4 v205, s[12:15], s93 offen offset:2048 lds
    buffer_load_dwordx4 v206, s[12:15], s93 offen offset:3072 lds
    s_add_u32 s93, s93, 524288
    s_and_b32 s93, s93, 2097151
    s_waitcnt vmcnt(15)
    s_barrier
    s_add_u32 m0, s62, 49152
    s_nop 0
    buffer_load_dwordx4 v203, s[12:15], s93 offen lds
    buffer_load_dwordx4 v204, s[12:15], s93 offen offset:1024 lds
    buffer_load_dwordx4 v205, s[12:15], s93 offen offset:2048 lds
    buffer_load_dwordx4 v206, s[12:15], s93 offen offset:3072 lds
    s_add_u32 s93, s93, 524288
    s_and_b32 s93, s93, 2097151
    s_barrier
    s_add_u32 m0, s62, 65536
    s_nop 0
    buffer_load_dwordx4 v203, s[12:15], s93 offen lds
    buffer_load_dwordx4 v204, s[12:15], s93 offen offset:1024 lds
    buffer_load_dwordx4 v205, s[12:15], s93 offen offset:2048 lds
    buffer_load_dwordx4 v206, s[12:15], s93 offen offset:3072 lds
    s_add_u32 s93, s93, 524288
    s_and_b32 s93, s93, 2097151
    s_waitcnt vmcnt(12)
    s_barrier
    s_add_u32 m0, s62, 81920
    s_nop 0
    buffer_load_dwordx4 v203, s[12:15], s93 offen lds
    buffer_load_dwordx4 v204, s[12:15], s93 offen offset:1024 lds
    buffer_load_dwordx4 v205, s[12:15], s93 offen offset:2048 lds
    buffer_load_dwordx4 v206, s[12:15], s93 offen offset:3072 lds
    s_add_u32 s93, s93, 655360
    s_and_b32 s93, s93, 2097151
    s_barrier
    s_add_u32 m0, s62, 0
    s_nop 0
    buffer_load_dwordx4 v203, s[12:15], s93 offen lds
    buffer_load_dwordx4 v204, s[12:15], s93 offen offset:1024 lds
    buffer_load_dwordx4 v205, s[12:15], s93 offen offset:2048 lds
    buffer_load_dwordx4 v206, s[12:15], s93 offen offset:3072 lds
    s_add_u32 s93, s93, 524288
    s_and_b32 s93, s93, 2097151
    s_waitcnt lgkmcnt(0)
    s_barrier
    s_add_u32 m0, s62, 16384
    s_nop 0
    buffer_load_dwordx4 v203, s[12:15], s93 offen lds
    buffer_load_dwordx4 v204, s[12:15], s93 offen offset:1024 lds
    buffer_load_dwordx4 v205, s[12:15], s93 offen offset:2048 lds
    buffer_load_dwordx4 v206, s[12:15], s93 offen offset:3072 lds
    s_add_u32 s93, s93, 524288
    s_and_b32 s93, s93, 2097151
    s_setprio 0
Y_g2:
    v_lshlrev_b32 v224, 7, v254
    s_lshl_b32 s55, s44, 19
    s_add_u32 s55, s55, s93
    s_and_b32 s55, s55, 2097151
    s_add_u32 s55, s55, s63
    buffer_load_dword v251, v224, s[12:15], s55 offen
    v_mov_b32 v112, -1
    v_mov_b32 v113, -1
    v_mov_b32 v114, -1
    v_mov_b32 v115, -1
    s_lshl_b32 s94, s51, 14
    s_add_u32 s88, s47, s62
    v_add_u32 v217, s88, v254
    s_add_u32 s55, s88, s94
    s_add_u32 s55, s55, 1310720
    buffer_store_dwordx4 v[112:115], v254, s[4:7], s55 offen offset:0 sc0 sc1
    buffer_store_dwordx4 v[112:115], v254, s[4:7], s55 offen offset:1024 sc0 sc1
    buffer_store_dwordx4 v[112:115], v254, s[4:7], s55 offen offset:2048 sc0 sc1
    buffer_store_dwordx4 v[112:115], v254, s[4:7], s55 offen offset:3072 sc0 sc1
    s_cmp_lg_u32 s46, 0
    s_cbranch_scc1 cp_62
    v_and_b32 v225, 0xf0, v254
    v_lshrrev_b32 v224, 8, v254
    v_lshlrev_b32 v226, 5, v224
    v_xor_b32 v225, v225, v226
    v_mul_u32_u24 v224, 7168, v224
    v_add_u32 v224, s65, v224
    v_add_u32 v207, v224, v225
    v_xor_b32 v225, 0x80, v225
    v_add_u32 v224, v224, v225
    v_add_u32 v208, 27648, v224
    v_add_u32 v209, 55296, v207
    v_add_u32 v210, 55296, v208
    v_lshrrev_b32 v224, 7, v254
    v_and_b32 v225, 0x70, v254
    v_and_b32 v226, 6, v224
    v_lshlrev_b32 v226, 4, v226
    v_xor_b32 v225, v225, v226
    v_mul_u32_u24 v224, 7168, v224
    v_add3_u32 v211, v224, v225, s66
    v_add_u32 v212, 56320, v211
    v_add_u32 v222, s67, v254
    v_and_b32 v225, 0xf0, v254
    v_lshrrev_b32 v224, 8, v254
    v_lshlrev_b32 v226, 5, v224
    v_xor_b32 v225, v225, v226
    v_mul_u32_u24 v224, 2048, v224
    v_add_u32 v213, v224, v225
    v_xor_b32 v225, 0x80, v225
    v_add_u32 v224, v224, v225
    v_add_u32 v214, 7168, v224
    v_add_u32 v215, 14336, v213
    v_add_u32 v216, 14336, v214
    s_lshl_b32 s60, s43, 23
    s_add_u32 s60, s60, 83886336
    s_add_u32 s55, s4, s60
    s_addc_u32 s56, s5, 0
    s_lshr_b32 s57, 0, s41
    s_and_b32 s57, s57, 1
    s_cselect_b32 s28, s55, s16
    s_cselect_b32 s29, s56, s17
    s_mov_b32 s30, 7340032
    s_mov_b32 s31, 0x00020000
    s_lshl_b32 s60, s43, 23
    s_add_u32 s60, s60, 83886336
    s_add_u32 s55, s4, s60
    s_addc_u32 s56, s5, 0
    s_lshr_b32 s57, 16392, s41
    s_and_b32 s57, s57, 1
    s_cselect_b32 s24, s55, s16
    s_cselect_b32 s25, s56, s17
    s_mov_b32 s26, 7340032
    s_mov_b32 s27, 0x00020000
cp_62:
    s_barrier
    s_add_u32 m0, s62, 98304
    s_nop 0
    buffer_load_dwordx4 v217, s[4:7], s94 offen lds
    buffer_load_dwordx4 v217, s[4:7], s94 offen offset:1024 lds
    buffer_load_dwordx4 v217, s[4:7], s94 offen offset:2048 lds
    buffer_load_dwordx4 v217, s[4:7], s94 offen offset:3072 lds
    s_add_u32 s94, s94, 32768
    s_and_b32 s94, s94, 262143
    s_waitcnt vmcnt(0)
    s_barrier
    v_lshrrev_b32 v252, 2, v254
    v_min_u32 v252, 28, v252
    s_add_u32 s55, s0, 0
    s_mov_b32 s56, 262144
poll_63:
    buffer_load_dword v253, v252, s[4:7], s55 offen sc0 sc1
    s_waitcnt vmcnt(0)
    v_cmp_ne_u32 vcc, 0x01010101, v253
    s_cbranch_vccz pd_64
    s_sleep 1
    s_sub_u32 s56, s56, 1
    s_cmp_lg_u32 s56, 0
    s_cbranch_scc1 poll_63
pd_64:
    s_add_u32 m0, s62, 114688
    s_nop 0
    buffer_load_dwordx4 v217, s[4:7], s94 offen lds
    buffer_load_dwordx4 v217, s[4:7], s94 offen offset:1024 lds
    buffer_load_dwordx4 v217, s[4:7], s94 offen offset:2048 lds
    buffer_load_dwordx4 v217, s[4:7], s94 offen offset:3072 lds
    s_add_u32 s94, s94, 32768
    s_and_b32 s94, s94, 262143
    s_add_u32 m0, s62, 131072
    s_nop 0
    buffer_load_dwordx4 v217, s[4:7], s94 offen lds
    buffer_load_dwordx4 v217, s[4:7], s94 offen offset:1024 lds
    buffer_load_dwordx4 v217, s[4:7], s94 offen offset:2048 lds
    buffer_load_dwordx4 v217, s[4:7], s94 offen offset:3072 lds
    s_add_u32 s94, s94, 32768
    s_and_b32 s94, s94, 262143
    s_waitcnt vmcnt(4)
    s_barrier
    s_add_u32 m0, s62, 98304
    s_nop 0
    buffer_load_dwordx4 v217, s[4:7], s94 offen lds
    buffer_load_dwordx4 v217, s[4:7], s94 offen offset:1024 lds
    buffer_load_dwordx4 v217, s[4:7], s94 offen offset:2048 lds
    buffer_load_dwordx4 v217, s[4:7], s94 offen offset:3072 lds
    s_add_u32 s94, s94, 32768
    s_and_b32 s94, s94, 262143
    s_waitcnt vmcnt(4)
    s_barrier
    s_add_u32 m0, s62, 114688
    s_nop 0
    buffer_load_dwordx4 v217, s[4:7], s94 offen lds
    buffer_load_dwordx4 v217, s[4:7], s94 offen offset:1024 lds
    buffer_load_dwordx4 v217, s[4:7], s94 offen offset:2048 lds
    buffer_load_dwordx4 v217, s[4:7], s94 offen offset:3072 lds
    s_add_u32 s94, s94, 32768
    s_and_b32 s94, s94, 262143
    s_add_u32 m0, s62, 32768
    s_nop 0
    buffer_load_dwordx4 v203, s[12:15], s93 offen lds
    buffer_load_dwordx4 v204, s[12:15], s93 offen offset:1024 lds
    buffer_load_dwordx4 v205, s[12:15], s93 offen offset:2048 lds
    buffer_load_dwordx4 v206, s[12:15], s93 offen offset:3072 lds
    s_add_u32 s93, s93, 524288
    s_and_b32 s93, s93, 2097151
    s_waitcnt vmcnt(8)
    s_barrier
    s_add_u32 m0, s62, 131072
    s_nop 0
    buffer_load_dwordx4 v217, s[4:7], s94 offen lds
    buffer_load_dwordx4 v217, s[4:7], s94 offen offset:1024 lds
    buffer_load_dwordx4 v217, s[4:7], s94 offen offset:2048 lds
    buffer_load_dwordx4 v217, s[4:7], s94 offen offset:3072 lds
    s_add_u32 s94, s94, 32768
    s_and_b32 s94, s94, 262143
    s_waitcnt vmcnt(8)
    s_barrier
    v_lshrrev_b32 v252, 2, v254
    v_min_u32 v252, 60, v252
    s_add_u32 s55, s54, 0
    buffer_load_dword v251, v252, s[4:7], s55 offen sc0 sc1
    s_add_u32 m0, s62, 98304
    s_nop 0
    buffer_load_dwordx4 v217, s[4:7], s94 offen lds
    buffer_load_dwordx4 v217, s[4:7], s94 offen offset:1024 lds
    buffer_load_dwordx4 v217, s[4:7], s94 offen offset:2048 lds
    buffer_load_dwordx4 v217, s[4:7], s94 offen offset:3072 lds
    s_add_u32 s94, s94, 32768
    s_and_b32 s94, s94, 262143
    s_add_u32 m0, s62, 49152
    s_nop 0
    buffer_load_dwordx4 v203, s[12:15], s93 offen lds
    buffer_load_dwordx4 v204, s[12:15], s93 offen offset:1024 lds
    buffer_load_dwordx4 v205, s[12:15], s93 offen offset:2048 lds
    buffer_load_dwordx4 v206, s[12:15], s93 offen offset:3072 lds
    s_add_u32 s93, s93, 524288
    s_and_b32 s93, s93, 2097151
    s_waitcnt vmcnt(9)
    s_barrier
    s_add_u32 m0, s62, 114688
    s_nop 0
    buffer_load_dwordx4 v217, s[4:7], s94 offen lds
    buffer_load_dwordx4 v217, s[4:7], s94 offen offset:1024 lds
    buffer_load_dwordx4 v217, s[4:7], s94 offen offset:2048 lds
    buffer_load_dwordx4 v217, s[4:7], s94 offen offset:3072 lds
    s_add_u32 s94, s94, 49152
    s_and_b32 s94, s94, 262143
    s_waitcnt vmcnt(8)
    s_barrier
    v_cmp_ne_u32 vcc, 0x01010101, v251
    s_cbranch_vccz ap_65
    v_lshrrev_b32 v252, 2, v254
    v_min_u32 v252, 60, v252
    s_add_u32 s55, s54, 0
    s_mov_b32 s56, 262144
poll_66:
    buffer_load_dword v253, v252, s[4:7], s55 offen sc0 sc1
    s_waitcnt vmcnt(0)
    v_cmp_ne_u32 vcc, 0x01010101, v253
    s_cbranch_vccz pd_67
    s_sleep 1
    s_sub_u32 s56, s56, 1
    s_cmp_lg_u32 s56, 0
    s_cbranch_scc1 poll_66
pd_67:
ap_65:
    s_add_u32 m0, s62, 131072
    s_nop 0
    buffer_load_dwordx4 v217, s[4:7], s94 offen lds
    buffer_load_dwordx4 v217, s[4:7], s94 offen offset:1024 lds
    buffer_load_dwordx4 v217, s[4:7], s94 offen offset:2048 lds
    buffer_load_dwordx4 v217, s[4:7], s94 offen offset:3072 lds
    s_add_u32 s94, s94, 32768
    s_and_b32 s94, s94, 262143
    s_waitcnt vmcnt(4)
    s_barrier
    s_add_u32 m0, s62, 98304
    s_nop 0
    buffer_load_dwordx4 v217, s[4:7], s94 offen lds
    buffer_load_dwordx4 v217, s[4:7], s94 offen offset:1024 lds
    buffer_load_dwordx4 v217, s[4:7], s94 offen offset:2048 lds
    buffer_load_dwordx4 v217, s[4:7], s94 offen offset:3072 lds
    s_add_u32 s94, s94, 32768
    s_and_b32 s94, s94, 262143
    s_waitcnt vmcnt(4)
    s_barrier
    s_add_u32 m0, s62, 114688
    s_nop 0
    buffer_load_dwordx4 v217, s[4:7], s94 offen lds
    buffer_load_dwordx4 v217, s[4:7], s94 offen offset:1024 lds
    buffer_load_dwordx4 v217, s[4:7], s94 offen offset:2048 lds
    buffer_load_dwordx4 v217, s[4:7], s94 offen offset:3072 lds
    s_add_u32 s94, s94, 32768
    s_and_b32 s94, s94, 262143
    s_waitcnt vmcnt(4)
    s_barrier
    s_add_u32 m0, s62, 131072
    s_nop 0
    buffer_load_dwordx4 v217, s[4:7], s94 offen lds
    buffer_load_dwordx4 v217, s[4:7], s94 offen offset:1024 lds
    buffer_load_dwordx4 v217, s[4:7], s94 offen offset:2048 lds
    buffer_load_dwordx4 v217, s[4:7], s94 offen offset:3072 lds
    s_add_u32 s94, s94, 32768
    s_and_b32 s94, s94, 262143
    s_waitcnt vmcnt(4)
    s_barrier
    s_add_u32 m0, s62, 98304
    s_nop 0
    buffer_load_dwordx4 v217, s[4:7], s94 offen lds
    buffer_load_dwordx4 v217, s[4:7], s94 offen offset:1024 lds
    buffer_load_dwordx4 v217, s[4:7], s94 offen offset:2048 lds
    buffer_load_dwordx4 v217, s[4:7], s94 offen offset:3072 lds
    s_add_u32 s94, s94, 32768
    s_and_b32 s94, s94, 262143
    s_waitcnt vmcnt(4)
    s_barrier
    s_add_u32 m0, s62, 114688
    s_nop 0
    buffer_load_dwordx4 v217, s[4:7], s94 offen lds
    buffer_load_dwordx4 v217, s[4:7], s94 offen offset:1024 lds
    buffer_load_dwordx4 v217, s[4:7], s94 offen offset:2048 lds
    buffer_load_dwordx4 v217, s[4:7], s94 offen offset:3072 lds
    s_add_u32 s94, s94, 32768
    s_and_b32 s94, s94, 262143
    s_waitcnt vmcnt(4)
    s_barrier
    s_add_u32 m0, s62, 131072
    s_nop 0
    buffer_load_dwordx4 v217, s[4:7], s94 offen lds
    buffer_load_dwordx4 v217, s[4:7], s94 offen offset:1024 lds
    buffer_load_dwordx4 v217, s[4:7], s94 offen offset:2048 lds
    buffer_load_dwordx4 v217, s[4:7], s94 offen offset:3072 lds
    s_add_u32 s94, s94, 32768
    s_and_b32 s94, s94, 262143
    s_waitcnt vmcnt(4)
    s_barrier
    s_add_u32 m0, s62, 98304
    s_nop 0
    buffer_load_dwordx4 v217, s[4:7], s94 offen lds
    buffer_load_dwordx4 v217, s[4:7], s94 offen offset:1024 lds
    buffer_load_dwordx4 v217, s[4:7], s94 offen offset:2048 lds
    buffer_load_dwordx4 v217, s[4:7], s94 offen offset:3072 lds
    s_waitcnt vmcnt(4)
    s_barrier
    s_lshl_b32 s93, s51, 12
    s_add_u32 m0, s62, 65536
    s_mul_i32 s59, s93, 112
    buffer_load_dwordx4 v207, s[28:31], s59 offen lds
    buffer_load_dwordx4 v208, s[28:31], s59 offen offset:1024 lds
    buffer_load_dwordx4 v209, s[28:31], s59 offen offset:2048 lds
    buffer_load_dwordx4 v210, s[28:31], s59 offen offset:3072 lds
    s_add_u32 s93, s93, 2048
    s_and_b32 s93, s93, 65535
    s_waitcnt vmcnt(4)
    s_barrier
    s_add_u32 m0, s62, 81920
    s_mul_i32 s59, s93, 112
    buffer_load_dwordx4 v207, s[28:31], s59 offen lds
    buffer_load_dwordx4 v208, s[28:31], s59 offen offset:1024 lds
    buffer_load_dwordx4 v209, s[28:31], s59 offen offset:2048 lds
    buffer_load_dwordx4 v210, s[28:31], s59 offen offset:3072 lds
    s_add_u32 s93, s93, 6144
    s_and_b32 s93, s93, 65535
    s_barrier
    s_add_u32 m0, s62, 0
    s_mul_i32 s59, s93, 112
    buffer_load_dwordx4 v207, s[28:31], s59 offen lds
    buffer_load_dwordx4 v208, s[28:31], s59 offen offset:1024 lds
    buffer_load_dwordx4 v209, s[28:31], s59 offen offset:2048 lds
    buffer_load_dwordx4 v210, s[28:31], s59 offen offset:3072 lds
    s_add_u32 s93, s93, 2048
    s_and_b32 s93, s93, 65535
    s_add_u32 m0, s62, 16384
    s_mul_i32 s59, s93, 112
    buffer_load_dwordx4 v207, s[28:31], s59 offen lds
    buffer_load_dwordx4 v208, s[28:31], s59 offen offset:1024 lds
    buffer_load_dwordx4 v209, s[28:31], s59 offen offset:2048 lds
    buffer_load_dwordx4 v210, s[28:31], s59 offen offset:3072 lds
    s_add_u32 s93, s93, 6144
    s_and_b32 s93, s93, 65535
    s_cmp_lg_u32 s46, 0
    s_cbranch_scc1 jf_68
    v_mov_b32 v104, 0x3f80
    v_lshrrev_b32 v224, 4, v254
    v_and_b32 v225, 1, v224
    v_lshlrev_b32 v225, 4, v225
    v_lshlrev_b32 v225, v225, v104
    v_bfe_u32 v224, v224, 1, 3
    v_cmp_eq_u32 vcc, 0, v224
    s_nop 1
    v_cndmask_b32 v104, 0, v225, vcc
    v_cmp_eq_u32 vcc, 1, v224
    s_nop 1
    v_cndmask_b32 v105, 0, v225, vcc
    v_cmp_eq_u32 vcc, 2, v224
    s_nop 1
    v_cndmask_b32 v106, 0, v225, vcc
    v_cmp_eq_u32 vcc, 3, v224
    s_nop 1
    v_cndmask_b32 v107, 0, v225, vcc
    s_nop 1
    v_mfma_f32_16x16x32_bf16 v[100:103], v[104:107], v[0:3], 0
    v_mfma_f32_16x16x32_bf16 v[100:103], v[104:107], v[4:7], v[100:103]
    v_mfma_f32_16x16x32_bf16 v[100:103], v[104:107], v[8:11], v[100:103]
    v_mfma_f32_16x16x32_bf16 v[100:103], v[104:107], v[12:15], v[100:103]
    v_mfma_f32_16x16x32_bf16 v[100:103], v[104:107], v[16:19], v[100:103]
    v_mfma_f32_16x16x32_bf16 v[100:103], v[104:107], v[20:23], v[100:103]
    v_mfma_f32_16x16x32_bf16 v[100:103], v[104:107], v[24:27], v[100:103]
    v_mfma_f32_16x16x32_bf16 v[100:103], v[104:107], v[28:31], v[100:103]
    v_mfma_f32_16x16x32_bf16 v[100:103], v[104:107], v[32:35], v[100:103]
    v_mfma_f32_16x16x32_bf16 v[100:103], v[104:107], v[36:39], v[100:103]
    v_mfma_f32_16x16x32_bf16 v[100:103], v[104:107], v[40:43], v[100:103]
    v_mfma_f32_16x16x32_bf16 v[100:103], v[104:107], v[44:47], v[100:103]
    v_mfma_f32_16x16x32_bf16 v[100:103], v[104:107], v[48:51], v[100:103]
    v_mfma_f32_16x16x32_bf16 v[100:103], v[104:107], v[52:55], v[100:103]
    v_mfma_f32_16x16x32_bf16 v[100:103], v[104:107], v[56:59], v[100:103]
    v_mfma_f32_16x16x32_bf16 v[100:103], v[104:107], v[60:63], v[100:103]
    s_and_b32 s56, s79, 1
    s_lshl_b32 s56, s56, 2
    s_add_u32 s56, s56, s42
    s_mul_i32 s56, s56, 28672
    s_lshr_b32 s55, s79, 1
    s_lshl_b32 s55, s55, 8
    s_add_u32 s55, s55, s56
    s_add_u32 s55, s55, 70778880
    s_cmp_lt_u32 s79, 224
    s_cselect_b32 s55, s55, 2130706432
    v_and_b32 v224, 0x70, v254
    v_lshrrev_b32 v225, 4, v254
    v_and_b32 v225, 16, v225
    v_lshl_add_u32 v224, v224, 1, v225
    s_nop 2
    v_add_f32_dpp v100, v100, v100 row_ror:8 row_mask:0xf bank_mask:0xf
    v_add_f32_dpp v101, v101, v101 row_ror:8 row_mask:0xf bank_mask:0xf
    v_add_f32_dpp v102, v102, v102 row_ror:8 row_mask:0xf bank_mask:0xf
    v_add_f32_dpp v103, v103, v103 row_ror:8 row_mask:0xf bank_mask:0xf
    s_mov_b64 exec, 0x00ff00ff
    buffer_store_dwordx4 v[100:103], v224, s[4:7], s55 offen sc0 sc1
    s_mov_b64 exec, -1
jf_68:
    s_add_u32 s88, s49, s62
    s_lshl_b32 s94, s51, 14
    v_add_u32 v217, s88, v254
    s_and_b32 s55, s51, 1
    s_mul_i32 s55, s55, 458752
    s_add_u32 s95, s50, s55
    s_and_b32 s55, s41, 7
    s_lshl_b32 s55, s55, 14
    s_and_b32 s56, s1, 0x3fff
    s_add_u32 s55, s55, s56
    s_add_u32 s89, s55, s95
    s_and_b32 s55, s41, 6
    s_add_u32 s55, s55, 48
    s_lshl_b32 s55, s55, 13
    s_and_b32 s56, s41, 1
    s_lshl_b32 s56, s56, 10
    s_add_u32 s55, s55, s56
    s_add_u32 s55, s55, s62
    s_add_u32 s90, s55, s95
    s_barrier
    s_add_u32 m0, s62, 98304
    s_nop 0
    buffer_load_dwordx4 v217, s[4:7], s94 offen lds
    buffer_load_dwordx4 v217, s[4:7], s94 offen offset:1024 lds
    buffer_load_dwordx4 v217, s[4:7], s94 offen offset:2048 lds
    buffer_load_dwordx4 v217, s[4:7], s94 offen offset:3072 lds
    s_add_u32 s94, s94, 32768
    s_and_b32 s94, s94, 262143
    s_waitcnt vmcnt(0)
    s_barrier
    v_lshrrev_b32 v252, 2, v254
    v_min_u32 v252, 28, v252
    s_add_u32 s55, s0, 32
    buffer_load_dword v251, v252, s[4:7], s55 offen sc0 sc1
    s_setprio 1
    s_barrier
    s_waitcnt vmcnt(0)
    v_cmp_ne_u32 vcc, 0x01010101, v251
    s_cbranch_vccz ap_69
    v_lshrrev_b32 v252, 2, v254
    v_min_u32 v252, 28, v252
    s_add_u32 s55, s0, 32
    s_mov_b32 s56, 262144
poll_70:
    buffer_load_dword v253, v252, s[4:7], s55 offen sc0 sc1
    s_waitcnt vmcnt(0)
    v_cmp_ne_u32 vcc, 0x01010101, v253
    s_cbranch_vccz pd_71
    s_sleep 1
    s_sub_u32 s56, s56, 1
    s_cmp_lg_u32 s56, 0
    s_cbranch_scc1 poll_70
pd_71:
ap_69:
    s_add_u32 m0, s62, 114688
    s_nop 0
    buffer_load_dwordx4 v217, s[4:7], s94 offen lds
    buffer_load_dwordx4 v217, s[4:7], s94 offen offset:1024 lds
    buffer_load_dwordx4 v217, s[4:7], s94 offen offset:2048 lds
    buffer_load_dwordx4 v217, s[4:7], s94 offen offset:3072 lds
    s_add_u32 s94, s94, 32768
    s_and_b32 s94, s94, 262143
    s_add_u32 m0, s62, 131072
    s_nop 0
    buffer_load_dwordx4 v217, s[4:7], s94 offen lds
    buffer_load_dwordx4 v217, s[4:7], s94 offen offset:1024 lds
    buffer_load_dwordx4 v217, s[4:7], s94 offen offset:2048 lds
    buffer_load_dwordx4 v217, s[4:7], s94 offen offset:3072 lds
    s_add_u32 s94, s94, 32768
    s_and_b32 s94, s94, 262143
    s_add_u32 m0, s62, 32768
    s_mul_i32 s59, s93, 112
    buffer_load_dwordx4 v207, s[28:31], s59 offen lds
    buffer_load_dwordx4 v208, s[28:31], s59 offen offset:1024 lds
    buffer_load_dwordx4 v209, s[28:31], s59 offen offset:2048 lds
    buffer_load_dwordx4 v210, s[28:31], s59 offen offset:3072 lds
    s_add_u32 s93, s93, 2048
    s_and_b32 s93, s93, 65535
    s_waitcnt vmcnt(8)
    s_barrier
    s_add_u32 m0, s62, 98304
    s_nop 0
    buffer_load_dwordx4 v217, s[4:7], s94 offen lds
    buffer_load_dwordx4 v217, s[4:7], s94 offen offset:1024 lds
    s_add_u32 m0, s62, 49152
    s_mul_i32 s59, s93, 112
    buffer_load_dwordx4 v207, s[28:31], s59 offen lds
    buffer_load_dwordx4 v208, s[28:31], s59 offen offset:1024 lds
    buffer_load_dwordx4 v209, s[28:31], s59 offen offset:2048 lds
    buffer_load_dwordx4 v210, s[28:31], s59 offen offset:3072 lds
    s_add_u32 s93, s93, 6144
    s_and_b32 s93, s93, 65535
    s_add_u32 m0, s62, 65536
    s_mul_i32 s59, s93, 112
    buffer_load_dwordx4 v207, s[28:31], s59 offen lds
    s_barrier
    s_add_u32 m0, s62, 98304
    s_nop 0
    buffer_load_dwordx4 v217, s[4:7], s94 offen offset:2048 lds
    buffer_load_dwordx4 v217, s[4:7], s94 offen offset:3072 lds
    s_add_u32 s94, s94, 32768
    s_and_b32 s94, s94, 262143
    s_add_u32 m0, s62, 65536
    s_nop 0
    buffer_load_dwordx4 v208, s[28:31], s59 offen offset:1024 lds
    buffer_load_dwordx4 v209, s[28:31], s59 offen offset:2048 lds
    buffer_load_dwordx4 v210, s[28:31], s59 offen offset:3072 lds
    s_add_u32 s93, s93, 2048
    s_and_b32 s93, s93, 65535
    s_add_u32 m0, s62, 81920
    s_mul_i32 s59, s93, 112
    buffer_load_dwordx4 v207, s[28:31], s59 offen lds
    buffer_load_dwordx4 v208, s[28:31], s59 offen offset:1024 lds
    s_cmp_lg_u32 s42, 0
    s_cbranch_scc1 wf_72
    s_lshl_b32 s55, s51, 2
    s_add_u32 s55, s55, s54
    v_mov_b32 v252, 12288
    v_mov_b32 v253, 0x01010101
    s_mov_b64 exec, 1
    buffer_store_dword v253, v252, s[4:7], s55 offen sc0 sc1
    s_mov_b64 exec, -1
wf_72:
    s_xor_b32 s55, s42, 1
    s_or_b32 s55, s46, s55
    s_cbranch_scc1 cf_73
    v_mov_b32 v252, 0
    v_mov_b32 v253, 1
    s_lshl_b32 s55, s2, 2
    s_add_u32 s55, s55, 71566336
    s_mov_b64 exec, 1
    buffer_store_dword v253, v252, s[4:7], s55 offen sc0 sc1
    s_mov_b64 exec, -1
cf_73:
    s_waitcnt vmcnt(14)
    s_barrier
    s_add_u32 m0, s62, 114688
    s_nop 0
    buffer_load_dwordx4 v217, s[4:7], s94 offen lds
    buffer_load_dwordx4 v217, s[4:7], s94 offen offset:1024 lds
    s_add_u32 m0, s62, 81920
    s_nop 0
    buffer_load_dwordx4 v209, s[28:31], s59 offen offset:2048 lds
    buffer_load_dwordx4 v210, s[28:31], s59 offen offset:3072 lds
    s_add_u32 s93, s93, 6144
    s_and_b32 s93, s93, 65535
    s_add_u32 m0, s62, 0
    s_mul_i32 s59, s93, 112
    buffer_load_dwordx4 v207, s[28:31], s59 offen lds
    buffer_load_dwordx4 v208, s[28:31], s59 offen offset:1024 lds
    buffer_load_dwordx4 v209, s[28:31], s59 offen offset:2048 lds
    s_waitcnt vmcnt(15)
    s_barrier
    s_add_u32 m0, s62, 114688
    s_nop 0
    buffer_load_dwordx4 v217, s[4:7], s94 offen offset:2048 lds
    buffer_load_dwordx4 v217, s[4:7], s94 offen offset:3072 lds
    s_add_u32 s94, s94, 32768
    s_and_b32 s94, s94, 262143
    s_add_u32 m0, s62, 0
    s_nop 0
    buffer_load_dwordx4 v210, s[28:31], s59 offen offset:3072 lds
    s_add_u32 s93, s93, 2048
    s_and_b32 s93, s93, 65535
    s_add_u32 m0, s62, 16384
    s_mul_i32 s59, s93, 112
    buffer_load_dwordx4 v207, s[28:31], s59 offen lds
    buffer_load_dwordx4 v208, s[28:31], s59 offen offset:1024 lds
    buffer_load_dwordx4 v209, s[28:31], s59 offen offset:2048 lds
    buffer_load_dwordx4 v210, s[28:31], s59 offen offset:3072 lds
    s_add_u32 s93, s93, 6144
    s_and_b32 s93, s93, 65535
    s_lshl_b32 s55, s46, 4
    s_lshr_b32 s56, s40, 1
    s_add_u32 s55, s55, s56
    s_cmp_lg_u32 s55, 0
    s_cbranch_scc1 w2_74
    v_lshlrev_b32 v252, 3, v254
    s_lshl_b32 s55, s2, 2
    s_add_u32 s55, s55, s42
    s_lshl_b32 s55, s55, 13
    buffer_load_dword v250, v252, s[20:23], s55 offen
w2_74:
    s_waitcnt vmcnt(16)
    s_barrier
    s_add_u32 m0, s62, 131072
    s_nop 0
    buffer_load_dwordx4 v217, s[4:7], s94 offen lds
    buffer_load_dwordx4 v217, s[4:7], s94 offen offset:1024 lds
    s_add_u32 m0, s62, 32768
    s_mul_i32 s59, s93, 112
    buffer_load_dwordx4 v207, s[28:31], s59 offen lds
    buffer_load_dwordx4 v208, s[28:31], s59 offen offset:1024 lds
    buffer_load_dwordx4 v209, s[28:31], s59 offen offset:2048 lds
    buffer_load_dwordx4 v210, s[28:31], s59 offen offset:3072 lds
    s_add_u32 s93, s93, 2048
    s_and_b32 s93, s93, 65535
    s_add_u32 m0, s62, 49152
    s_mul_i32 s59, s93, 112
    buffer_load_dwordx4 v207, s[28:31], s59 offen lds
    s_waitcnt vmcnt(17)
    s_barrier
    v_lshrrev_b32 v252, 2, v254
    v_min_u32 v252, 60, v252
    s_add_u32 s55, s54, 12288
    buffer_load_dword v251, v252, s[4:7], s55 offen sc0 sc1
    s_add_u32 m0, s62, 131072
    s_nop 0
    buffer_load_dwordx4 v217, s[4:7], s94 offen offset:2048 lds
    buffer_load_dwordx4 v217, s[4:7], s94 offen offset:3072 lds
    s_add_u32 s94, s94, 32768
    s_and_b32 s94, s94, 262143
    s_add_u32 m0, s62, 49152
    s_nop 0
    buffer_load_dwordx4 v208, s[28:31], s59 offen offset:1024 lds
    buffer_load_dwordx4 v209, s[28:31], s59 offen offset:2048 lds
    buffer_load_dwordx4 v210, s[28:31], s59 offen offset:3072 lds
    s_add_u32 s93, s93, 6144
    s_and_b32 s93, s93, 65535
    s_add_u32 m0, s62, 65536
    s_mul_i32 s59, s93, 112
    buffer_load_dwordx4 v207, s[28:31], s59 offen lds
    buffer_load_dwordx4 v208, s[28:31], s59 offen offset:1024 lds
    s_lshl_b32 s55, s46, 4
    s_lshr_b32 s56, s40, 1
    s_add_u32 s55, s55, s56
    s_cmp_lg_u32 s55, 1
    s_cbranch_scc1 w2_75
    v_lshlrev_b32 v252, 3, v254
    s_lshl_b32 s55, s2, 2
    s_add_u32 s55, s55, s42
    s_lshl_b32 s55, s55, 13
    buffer_load_dword v250, v252, s[20:23], s55 offen
w2_75:
    s_waitcnt vmcnt(19)
    s_barrier
    s_add_u32 m0, s62, 98304
    s_nop 0
    buffer_load_dwordx4 v217, s[4:7], s94 offen lds
    buffer_load_dwordx4 v217, s[4:7], s94 offen offset:1024 lds
    s_add_u32 m0, s62, 65536
    s_nop 0
    buffer_load_dwordx4 v209, s[28:31], s59 offen offset:2048 lds
    buffer_load_dwordx4 v210, s[28:31], s59 offen offset:3072 lds
    s_add_u32 s93, s93, 2048
    s_and_b32 s93, s93, 65535
    s_add_u32 m0, s62, 81920
    s_mul_i32 s59, s93, 112
    buffer_load_dwordx4 v207, s[28:31], s59 offen lds
    buffer_load_dwordx4 v208, s[28:31], s59 offen offset:1024 lds
    buffer_load_dwordx4 v209, s[28:31], s59 offen offset:2048 lds
    s_waitcnt vmcnt(22)
    s_barrier
    s_add_u32 m0, s62, 98304
    s_nop 0
    buffer_load_dwordx4 v217, s[4:7], s94 offen offset:2048 lds
    buffer_load_dwordx4 v217, s[4:7], s94 offen offset:3072 lds
    s_add_u32 s94, s94, 32768
    s_and_b32 s94, s94, 262143
    s_add_u32 m0, s62, 81920
    s_nop 0
    buffer_load_dwordx4 v210, s[28:31], s59 offen offset:3072 lds
    s_add_u32 s93, s93, 6144
    s_and_b32 s93, s93, 65535
    s_add_u32 m0, s62, 0
    s_mul_i32 s59, s93, 112
    buffer_load_dwordx4 v207, s[28:31], s59 offen lds
    buffer_load_dwordx4 v208, s[28:31], s59 offen offset:1024 lds
    buffer_load_dwordx4 v209, s[28:31], s59 offen offset:2048 lds
    buffer_load_dwordx4 v210, s[28:31], s59 offen offset:3072 lds
    s_add_u32 s93, s93, 2048
    s_and_b32 s93, s93, 65535
    s_lshl_b32 s55, s46, 4
    s_lshr_b32 s56, s40, 1
    s_add_u32 s55, s55, s56
    s_cmp_lg_u32 s55, 2
    s_cbranch_scc1 w2_76
    v_lshlrev_b32 v252, 3, v254
    s_lshl_b32 s55, s2, 2
    s_add_u32 s55, s55, s42
    s_lshl_b32 s55, s55, 13
    buffer_load_dword v250, v252, s[20:23], s55 offen
w2_76:
    s_waitcnt vmcnt(19)
    s_barrier
    v_cmp_ne_u32 vcc, 0x01010101, v251
    s_cbranch_vccz ap_77
    v_lshrrev_b32 v252, 2, v254
    v_min_u32 v252, 60, v252
    s_add_u32 s55, s54, 12288
    s_mov_b32 s56, 262144
poll_78:
    buffer_load_dword v253, v252, s[4:7], s55 offen sc0 sc1
    s_waitcnt vmcnt(0)
    v_cmp_ne_u32 vcc, 0x01010101, v253
    s_cbranch_vccz pd_79
    s_sleep 1
    s_sub_u32 s56, s56, 1
    s_cmp_lg_u32 s56, 0
    s_cbranch_scc1 poll_78
pd_79:
ap_77:
    s_add_u32 m0, s62, 114688
    s_nop 0
    buffer_load_dwordx4 v217, s[4:7], s94 offen lds
    buffer_load_dwordx4 v217, s[4:7], s94 offen offset:1024 lds
    s_add_u32 m0, s62, 16384
    s_mul_i32 s59, s93, 112
    buffer_load_dwordx4 v207, s[28:31], s59 offen lds
    v_and_b32 v226, 0xf0, v254
    v_and_b32 v227, 0x300, v254
    v_lshl_add_u32 v227, v227, 2, v226
    s_lshl_b32 s78, s42, 8
    s_add_u32 s78, s78, s52
    buffer_load_dwordx4 v208, s[28:31], s59 offen offset:1024 lds
    buffer_load_dwordx4 v209, s[28:31], s59 offen offset:2048 lds
    buffer_load_dwordx4 v210, s[28:31], s59 offen offset:3072 lds
    s_add_u32 s93, s93, 10240
    s_and_b32 s93, s93, 65535
    buffer_load_dwordx4 v[96:99], v227, s[4:7], s78 offen
    s_add_u32 s78, s78, 4096
    s_waitcnt vmcnt(23)
    s_barrier
    s_mov_b32 s55, 71566336
    buffer_load_dwordx4 v[128:131], v254, s[4:7], s55 offen sc0 sc1
    s_add_u32 m0, s62, 114688
    s_nop 0
    buffer_load_dwordx4 v217, s[4:7], s94 offen offset:2048 lds
    buffer_load_dwordx4 v217, s[4:7], s94 offen offset:3072 lds
    s_add_u32 s94, s94, 49152
    s_and_b32 s94, s94, 262143
    s_add_u32 m0, s62, 32768
    s_mul_i32 s59, s93, 112
    buffer_load_dwordx4 v207, s[28:31], s59 offen lds
    buffer_load_dwordx4 v208, s[28:31], s59 offen offset:1024 lds
    buffer_load_dwordx4 v209, s[28:31], s59 offen offset:2048 lds
    buffer_load_dwordx4 v210, s[28:31], s59 offen offset:3072 lds
    s_add_u32 s93, s93, 2048
    s_and_b32 s93, s93, 65535
    buffer_load_dwordx4 v[100:103], v227, s[4:7], s78 offen
    s_add_u32 s78, s78, 4096
    s_lshl_b32 s55, s46, 4
    s_lshr_b32 s56, s40, 1
    s_add_u32 s55, s55, s56
    s_cmp_lg_u32 s55, 3
    s_cbranch_scc1 w2_80
    v_lshlrev_b32 v252, 3, v254
    s_lshl_b32 s55, s2, 2
    s_add_u32 s55, s55, s42
    s_lshl_b32 s55, s55, 13
    buffer_load_dword v250, v252, s[20:23], s55 offen
w2_80:
    s_waitcnt vmcnt(20)
    s_barrier
    s_add_u32 m0, s62, 131072
    s_nop 0
    buffer_load_dwordx4 v217, s[4:7], s94 offen lds
    buffer_load_dwordx4 v217, s[4:7], s94 offen offset:1024 lds
    s_add_u32 m0, s62, 49152
    s_mul_i32 s59, s93, 112
    buffer_load_dwordx4 v207, s[28:31], s59 offen lds
    buffer_load_dwordx4 v208, s[28:31], s59 offen offset:1024 lds
    buffer_load_dwordx4 v209, s[28:31], s59 offen offset:2048 lds
    buffer_load_dwordx4 v210, s[28:31], s59 offen offset:3072 lds
    s_add_u32 s93, s93, 6144
    s_and_b32 s93, s93, 65535
    buffer_load_dwordx4 v[104:107], v227, s[4:7], s78 offen
    s_add_u32 s78, s78, 4096
    s_waitcnt vmcnt(26)
    s_barrier
    s_add_u32 m0, s62, 131072
    s_nop 0
    buffer_load_dwordx4 v217, s[4:7], s94 offen offset:2048 lds
    buffer_load_dwordx4 v217, s[4:7], s94 offen offset:3072 lds
    s_add_u32 s94, s94, 32768
    s_and_b32 s94, s94, 262143
    s_add_u32 m0, s62, 65536
    s_mul_i32 s59, s93, 112
    buffer_load_dwordx4 v207, s[28:31], s59 offen lds
    buffer_load_dwordx4 v208, s[28:31], s59 offen offset:1024 lds
    buffer_load_dwordx4 v209, s[28:31], s59 offen offset:2048 lds
    buffer_load_dwordx4 v210, s[28:31], s59 offen offset:3072 lds
    s_add_u32 s93, s93, 2048
    s_and_b32 s93, s93, 65535
    buffer_load_dwordx4 v[108:111], v227, s[4:7], s78 offen
    s_add_u32 s78, s78, 4096
    s_lshl_b32 s55, s46, 4
    s_lshr_b32 s56, s40, 1
    s_add_u32 s55, s55, s56
    s_cmp_lg_u32 s55, 4
    s_cbranch_scc1 w2_81
    v_lshlrev_b32 v252, 3, v254
    s_lshl_b32 s55, s2, 2
    s_add_u32 s55, s55, s42
    s_lshl_b32 s55, s55, 13
    buffer_load_dword v250, v252, s[20:23], s55 offen
w2_81:
    s_waitcnt vmcnt(19)
    s_barrier
    s_cmp_eq_u32 s46, 1
    s_cbranch_scc1 a4_82
    v_and_b32 v128, v128, v129
    v_and_b32 v130, v130, v131
    v_and_b32 v128, v128, v130
    v_cmp_ne_u32 vcc, 1, v128
    s_cbranch_vccz a4_82
    s_mov_b32 s55, 71566336
    s_mov_b32 s56, 262144
p4_83:
    buffer_load_dwordx4 v[128:131], v254, s[4:7], s55 offen sc0 sc1
    s_waitcnt vmcnt(0)
    v_and_b32 v128, v128, v129
    v_and_b32 v130, v130, v131
    v_and_b32 v128, v128, v130
    v_cmp_ne_u32 vcc, 1, v128
    s_cbranch_vccz p4_84
    s_sleep 1
    s_sub_u32 s56, s56, 1
    s_cmp_lg_u32 s56, 0
    s_cbranch_scc1 p4_83
p4_84:
a4_82:
    s_cmp_lg_u32 s46, 0
    s_cbranch_scc1 cs_85
    s_and_b32 s55, s41, 1
    s_mul_i32 s56, s55, 384
    s_xor_b32 s55, s55, 1
    s_lshl_b32 s55, s55, 9
    s_cmp_eq_u32 s44, 0
    s_cselect_b32 s55, s56, s55
    s_mul_i32 s56, s41, 896
    s_add_u32 s55, s55, s56
    s_mul_i32 s56, s43, 14336
    s_add_u32 s55, s55, s56
    s_add_u32 s55, s55, 70778880
    v_lshrrev_b32 v224, 9, v254
    v_mul_u32_u24 v224, 28672, v224
    v_and_b32 v225, 0x1f0, v254
    v_add_u32 v224, v224, v225
    buffer_load_dwordx4 v[128:131], v224, s[4:7], s55 offen sc1
    s_add_u32 s55, s55, 57344
    buffer_load_dwordx4 v[132:135], v224, s[4:7], s55 offen sc1
    s_add_u32 s55, s55, 57344
    buffer_load_dwordx4 v[136:139], v224, s[4:7], s55 offen sc1
    s_add_u32 s55, s55, 57344
    buffer_load_dwordx4 v[140:143], v224, s[4:7], s55 offen sc1
    s_add_u32 s55, s55, 57344
cs_85:
    s_add_u32 m0, s62, 98304
    s_nop 0
    buffer_load_dwordx4 v217, s[4:7], s94 offen lds
    buffer_load_dwordx4 v217, s[4:7], s94 offen offset:1024 lds
    s_add_u32 m0, s62, 81920
    s_mul_i32 s59, s93, 112
    buffer_load_dwordx4 v207, s[28:31], s59 offen lds
    buffer_load_dwordx4 v208, s[28:31], s59 offen offset:1024 lds
    buffer_load_dwordx4 v209, s[28:31], s59 offen offset:2048 lds
    buffer_load_dwordx4 v210, s[28:31], s59 offen offset:3072 lds
    s_add_u32 s93, s93, 6144
    s_and_b32 s93, s93, 65535
    s_barrier
    s_add_u32 m0, s62, 98304
    s_nop 0
    buffer_load_dwordx4 v217, s[4:7], s94 offen offset:2048 lds
    buffer_load_dwordx4 v217, s[4:7], s94 offen offset:3072 lds
    s_add_u32 s94, s94, 32768
    s_and_b32 s94, s94, 262143
    s_add_u32 m0, s62, 0
    s_mul_i32 s59, s93, 112
    buffer_load_dwordx4 v207, s[28:31], s59 offen lds
    buffer_load_dwordx4 v208, s[28:31], s59 offen offset:1024 lds
    buffer_load_dwordx4 v209, s[28:31], s59 offen offset:2048 lds
    buffer_load_dwordx4 v210, s[28:31], s59 offen offset:3072 lds
    s_add_u32 s93, s93, 2048
    s_and_b32 s93, s93, 65535
    s_lshl_b32 s55, s46, 4
    s_lshr_b32 s56, s40, 1
    s_add_u32 s55, s55, s56
    s_cmp_lg_u32 s55, 5
    s_cbranch_scc1 w2_86
    v_lshlrev_b32 v252, 3, v254
    s_lshl_b32 s55, s2, 2
    s_add_u32 s55, s55, s42
    s_lshl_b32 s55, s55, 13
    buffer_load_dword v250, v252, s[20:23], s55 offen
w2_86:
    s_waitcnt vmcnt(17)
    s_barrier
    s_waitcnt vmcnt(12)
    s_add_u32 m0, s62, 114688
    s_nop 0
    buffer_load_dwordx4 v217, s[4:7], s94 offen lds
    v_add_f32 v96, v96, v100
    v_add_f32 v97, v97, v101
    v_add_f32 v98, v98, v102
    v_add_f32 v99, v99, v103
    buffer_load_dwordx4 v217, s[4:7], s94 offen offset:1024 lds
    v_add_f32 v104, v104, v108
    v_add_f32 v105, v105, v109
    v_add_f32 v106, v106, v110
    v_add_f32 v107, v107, v111
    s_add_u32 m0, s62, 16384
    s_mul_i32 s59, s93, 112
    buffer_load_dwordx4 v207, s[28:31], s59 offen lds
    v_add_f32 v192, v96, v104
    v_add_f32 v193, v97, v105
    v_add_f32 v194, v98, v106
    v_add_f32 v195, v99, v107
    buffer_load_dwordx4 v208, s[28:31], s59 offen offset:1024 lds
    v_mov_b32 v96, v192
    v_mov_b32 v97, v193
    v_mov_b32 v98, v194
    v_mov_b32 v99, v195
    buffer_load_dwordx4 v209, s[28:31], s59 offen offset:2048 lds
    s_nop 1
    v_permlane16_swap_b32 v192, v96
    v_permlane16_swap_b32 v193, v97
    v_permlane16_swap_b32 v194, v98
    buffer_load_dwordx4 v210, s[28:31], s59 offen offset:3072 lds
    s_add_u32 s93, s93, 6144
    s_and_b32 s93, s93, 65535
    v_permlane16_swap_b32 v195, v99
    v_add_f32 v192, v192, v96
    v_add_f32 v193, v193, v97
    v_add_f32 v194, v194, v98
    v_add_f32 v195, v195, v99
    s_barrier
    s_add_u32 m0, s62, 114688
    s_nop 0
    buffer_load_dwordx4 v217, s[4:7], s94 offen offset:2048 lds
    v_mov_b32 v96, v192
    v_mov_b32 v97, v193
    buffer_load_dwordx4 v217, s[4:7], s94 offen offset:3072 lds
    s_add_u32 s94, s94, 32768
    s_and_b32 s94, s94, 262143
    v_mov_b32 v98, v194
    v_mov_b32 v99, v195
    s_add_u32 m0, s62, 32768
    s_mul_i32 s59, s93, 112
    buffer_load_dwordx4 v207, s[28:31], s59 offen lds
    s_nop 1
    v_permlane32_swap_b32 v192, v96
    buffer_load_dwordx4 v208, s[28:31], s59 offen offset:1024 lds
    v_permlane32_swap_b32 v193, v97
    v_permlane32_swap_b32 v194, v98
    buffer_load_dwordx4 v209, s[28:31], s59 offen offset:2048 lds
    v_permlane32_swap_b32 v195, v99
    v_add_f32 v192, v192, v96
    buffer_load_dwordx4 v210, s[28:31], s59 offen offset:3072 lds
    s_add_u32 s93, s93, 2048
    s_and_b32 s93, s93, 65535
    v_add_f32 v193, v193, v97
    v_add_f32 v194, v194, v98
    v_add_f32 v195, v195, v99
    s_lshl_b32 s55, s46, 4
    s_lshr_b32 s56, s40, 1
    s_add_u32 s55, s55, s56
    s_cmp_lg_u32 s55, 6
    s_cbranch_scc1 w2_87
    v_lshlrev_b32 v252, 3, v254
    s_lshl_b32 s55, s2, 2
    s_add_u32 s55, s55, s42
    s_lshl_b32 s55, s55, 13
    buffer_load_dword v250, v252, s[20:23], s55 offen
w2_87:
    s_waitcnt vmcnt(16)
    s_barrier
    s_cmp_lg_u32 s46, 0
    s_cbranch_scc1 cs_88
    v_add_f32 v128, v128, v132
    v_add_f32 v136, v136, v140
    v_add_f32 v129, v129, v133
    v_add_f32 v137, v137, v141
    v_add_f32 v130, v130, v134
    v_add_f32 v138, v138, v142
    v_add_f32 v131, v131, v135
    v_add_f32 v139, v139, v143
    v_add_f32 v128, v128, v136
    v_add_f32 v129, v129, v137
    v_add_f32 v130, v130, v138
    v_add_f32 v131, v131, v139
    v_mov_b32 v132, v128
    v_mov_b32 v133, v129
    v_mov_b32 v134, v130
    v_mov_b32 v135, v131
    s_nop 1
    v_permlane32_swap_b32 v128, v132
    v_permlane32_swap_b32 v129, v133
    v_permlane32_swap_b32 v130, v134
    v_permlane32_swap_b32 v131, v135
    v_add_f32 v128, v128, v132
    v_add_f32 v129, v129, v133
    v_add_f32 v130, v130, v134
    v_add_f32 v131, v131, v135
    s_lshl_b32 s55, s42, 9
    s_add_u32 s55, s55, 161664
    v_and_b32 v225, 0x1f0, v254
    v_add_u32 v224, s55, v225
    ds_write_b128 v224, v[128:131]
cs_88:
    s_add_u32 m0, s62, 131072
    s_nop 0
    buffer_load_dwordx4 v217, s[4:7], s94 offen lds
    v_mul_f32 v192, 0x3a800000, v192
    v_mul_f32 v193, 0x3a800000, v193
    buffer_load_dwordx4 v217, s[4:7], s94 offen offset:1024 lds
    v_fma_f32 v193, -v192, v192, v193
    v_max_f32 v193, 0, v193
    v_cvt_pk_bf16_f32 v192, v192, v192
    s_add_u32 m0, s62, 49152
    s_mul_i32 s59, s93, 112
    buffer_load_dwordx4 v207, s[28:31], s59 offen lds
    v_lshlrev_b32 v192, 16, v192
    v_cvt_pk_bf16_f32 v193, v193, v193
    v_lshlrev_b32 v193, 16, v193
    buffer_load_dwordx4 v208, s[28:31], s59 offen offset:1024 lds
    v_add_f32 v193, 0x3727c5ac, v193
    v_cvt_pk_bf16_f32 v193, v193, v193
    v_lshlrev_b32 v193, 16, v193
    buffer_load_dwordx4 v209, s[28:31], s59 offen offset:2048 lds
    v_sqrt_f32 v193, v193
    s_nop 0
    v_cvt_pk_bf16_f32 v193, v193, v193
    buffer_load_dwordx4 v210, s[28:31], s59 offen offset:3072 lds
    s_add_u32 s93, s93, 6144
    s_and_b32 s93, s93, 65535
    v_lshlrev_b32 v193, 16, v193
    v_rcp_f32 v193, v193
    s_nop 0
    s_barrier
    s_add_u32 m0, s62, 131072
    s_nop 0
    buffer_load_dwordx4 v217, s[4:7], s94 offen offset:2048 lds
    v_mul_f32 v194, 0x3a800000, v194
    v_mul_f32 v195, 0x3a800000, v195
    v_fma_f32 v195, -v194, v194, v195
    buffer_load_dwordx4 v217, s[4:7], s94 offen offset:3072 lds
    s_add_u32 s94, s94, 32768
    s_and_b32 s94, s94, 262143
    v_max_f32 v195, 0, v195
    v_cvt_pk_bf16_f32 v194, v194, v194
    v_lshlrev_b32 v194, 16, v194
    s_add_u32 m0, s62, 65536
    s_mul_i32 s59, s93, 112
    buffer_load_dwordx4 v207, s[28:31], s59 offen lds
    v_cvt_pk_bf16_f32 v195, v195, v195
    v_lshlrev_b32 v195, 16, v195
    v_add_f32 v195, 0x3727c5ac, v195
    buffer_load_dwordx4 v208, s[28:31], s59 offen offset:1024 lds
    v_cvt_pk_bf16_f32 v195, v195, v195
    v_lshlrev_b32 v195, 16, v195
    v_sqrt_f32 v195, v195
    buffer_load_dwordx4 v209, s[28:31], s59 offen offset:2048 lds
    s_nop 0
    v_cvt_pk_bf16_f32 v195, v195, v195
    v_lshlrev_b32 v195, 16, v195
    buffer_load_dwordx4 v210, s[28:31], s59 offen offset:3072 lds
    s_add_u32 s93, s93, 2048
    s_and_b32 s93, s93, 65535
    v_rcp_f32 v195, v195
    s_nop 0
    s_lshl_b32 s55, s42, 8
    s_add_u32 s55, s55, 159744
    v_add_u32 v226, s55, v226
    ds_write_b128 v226, v[192:195]
    s_lshl_b32 s55, s46, 4
    s_lshr_b32 s56, s40, 1
    s_add_u32 s55, s55, s56
    s_cmp_lg_u32 s55, 7
    s_cbranch_scc1 w2_89
    v_lshlrev_b32 v252, 3, v254
    s_lshl_b32 s55, s2, 2
    s_add_u32 s55, s55, s42
    s_lshl_b32 s55, s55, 13
    buffer_load_dword v250, v252, s[20:23], s55 offen
w2_89:
    s_waitcnt vmcnt(16)
    s_barrier
    s_add_u32 m0, s62, 98304
    s_nop 0
    buffer_load_dwordx4 v217, s[4:7], s94 offen lds
    buffer_load_dwordx4 v217, s[4:7], s94 offen offset:1024 lds
    s_add_u32 m0, s62, 81920
    s_mul_i32 s59, s93, 112
    buffer_load_dwordx4 v207, s[28:31], s59 offen lds
    buffer_load_dwordx4 v208, s[28:31], s59 offen offset:1024 lds
    buffer_load_dwordx4 v209, s[28:31], s59 offen offset:2048 lds
    buffer_load_dwordx4 v210, s[28:31], s59 offen offset:3072 lds
    s_add_u32 s93, s93, 6144
    s_and_b32 s93, s93, 65535
    s_barrier
    s_add_u32 m0, s62, 98304
    s_nop 0
    buffer_load_dwordx4 v217, s[4:7], s94 offen offset:2048 lds
    s_lshl_b32 s55, s43, 13
    s_add_u32 s55, s55, 98304
    v_add_u32 v176, s55, v254
    v_lshrrev_b32 v224, 6, v254
    v_lshrrev_b32 v225, 1, v224
    buffer_load_dwordx4 v217, s[4:7], s94 offen offset:3072 lds
    s_add_u32 s94, s94, 32768
    s_and_b32 s94, s94, 262143
    v_and_b32 v225, 3, v225
    s_lshl_b32 s55, s44, 1
    v_xor_b32 v225, s55, v225
    v_lshlrev_b32 v225, 5, v225
    v_lshl_add_u32 v225, v224, 7, v225
    s_add_u32 m0, s62, 0
    s_mul_i32 s59, s93, 112
    buffer_load_dwordx4 v207, s[28:31], s59 offen lds
    v_and_b32 v180, 0x30, v254
    v_lshrrev_b32 v180, 1, v180
    v_add_u32 v177, v225, v180
    buffer_load_dwordx4 v208, s[28:31], s59 offen offset:1024 lds
    v_xor_b32 v178, 32, v177
    v_lshrrev_b32 v225, 2, v224
    v_and_b32 v225, 1, v225
    v_xor_b32 v225, s44, v225
    buffer_load_dwordx4 v209, s[28:31], s59 offen offset:2048 lds
    v_lshlrev_b32 v225, 5, v225
    v_lshl_add_u32 v225, v224, 6, v225
    v_add_u32 v225, v225, v180
    buffer_load_dwordx4 v210, s[28:31], s59 offen offset:3072 lds
    s_add_u32 s93, s93, 2048
    s_and_b32 s93, s93, 65535
    v_add_u32 v179, 2048, v225
    v_add_u32 v180, 49152, v177
    v_add_u32 v181, 49152, v178
    v_add_u32 v182, 49152, v179
    s_waitcnt vmcnt(16)
    s_barrier
    s_cmp_lg_u32 s46, 0
    s_cbranch_scc1 cp_90
    s_lshl_b32 s55, s2, 2
    s_add_u32 s55, s55, s42
    s_lshl_b32 s55, s55, 13
    v_and_b32 v252, 0x300, v254
    v_and_b32 v253, 0xf0, v254
    v_lshl_add_u32 v249, v252, 3, v253
    buffer_load_dwordx4 v[240:243], v249, s[20:23], s55 offen offset:256
    buffer_load_dwordx4 v[244:247], v249, s[20:23], s55 offen offset:1280
cp_90:
    s_add_u32 m0, s62, 114688
    s_nop 0
    buffer_load_dwordx4 v217, s[4:7], s94 offen lds
    buffer_load_dwordx4 v217, s[4:7], s94 offen offset:1024 lds
    s_add_u32 m0, s62, 16384
    s_mul_i32 s59, s93, 112
    buffer_load_dwordx4 v207, s[28:31], s59 offen lds
    buffer_load_dwordx4 v208, s[28:31], s59 offen offset:1024 lds
    buffer_load_dwordx4 v209, s[28:31], s59 offen offset:2048 lds
    buffer_load_dwordx4 v210, s[28:31], s59 offen offset:3072 lds
    s_add_u32 s93, s93, 6144
    s_and_b32 s93, s93, 65535
    s_waitcnt lgkmcnt(0)
    s_barrier
    s_add_u32 m0, s62, 114688
    s_nop 0
    buffer_load_dwordx4 v217, s[4:7], s94 offen offset:2048 lds
    s_lshl_b32 s55, s43, 9
    s_add_u32 s55, s55, 159744
    v_and_b32 v224, 0xf0, v254
    v_lshrrev_b32 v224, 1, v224
    v_add_u32 v224, s55, v224
    ds_read_b64 v[96:97], v224 offset:0
    ds_read_b64 v[98:99], v224 offset:128
    buffer_load_dwordx4 v217, s[4:7], s94 offen offset:3072 lds
    s_add_u32 s94, s94, 32768
    s_and_b32 s94, s94, 262143
    ds_read_b64 v[100:101], v224 offset:256
    ds_read_b64 v[102:103], v224 offset:384
    s_waitcnt lgkmcnt(0)
    s_add_u32 m0, s62, 32768
    s_mul_i32 s59, s93, 112
    buffer_load_dwordx4 v207, s[28:31], s59 offen lds
    v_sub_f32 v196, 0, v96
    v_mul_f32 v184, 0xbfb8aa3b, v97
    v_mul_f32 v188, v97, v97
    v_sub_f32 v197, 0, v98
    buffer_load_dwordx4 v208, s[28:31], s59 offen offset:1024 lds
    v_mul_f32 v185, 0xbfb8aa3b, v99
    v_mul_f32 v189, v99, v99
    v_sub_f32 v198, 0, v100
    buffer_load_dwordx4 v209, s[28:31], s59 offen offset:2048 lds
    v_mul_f32 v186, 0xbfb8aa3b, v101
    v_mul_f32 v190, v101, v101
    v_sub_f32 v199, 0, v102
    buffer_load_dwordx4 v210, s[28:31], s59 offen offset:3072 lds
    s_add_u32 s93, s93, 2048
    s_and_b32 s93, s93, 65535
    v_mul_f32 v187, 0xbfb8aa3b, v103
    v_mul_f32 v191, v103, v103
    v_rcp_f32 v188, v188
    v_rcp_f32 v189, v189
    s_waitcnt vmcnt(16)
    s_barrier
    s_add_u32 m0, s62, 131072
    s_nop 0
    buffer_load_dwordx4 v217, s[4:7], s94 offen lds
    v_rcp_f32 v190, v190
    v_rcp_f32 v191, v191
    s_nop 0
    buffer_load_dwordx4 v217, s[4:7], s94 offen offset:1024 lds
    v_lshrrev_b32 v224, 8, v254
    v_lshlrev_b32 v224, 4, v224
    v_add_u32 v224, 162688, v224
    s_and_b32 s56, s41, 1
    s_add_u32 s55, s56, s44
    s_lshl_b32 s55, s55, 7
    v_add_u32 v225, s55, v224
    s_xor_b32 s56, s56, 1
    s_lshl_b32 s56, s56, 2
    s_add_u32 s56, s56, s44
    s_lshl_b32 s56, s56, 6
    v_add_u32 v224, s56, v224
    s_add_u32 m0, s62, 49152
    s_mul_i32 s59, s93, 112
    buffer_load_dwordx4 v207, s[28:31], s59 offen lds
    ds_read_b128 v[96:99], v225 offset:0
    ds_read_b128 v[100:103], v225 offset:64
    ds_read_b128 v[104:107], v224 offset:0
    buffer_load_dwordx4 v208, s[28:31], s59 offen offset:1024 lds
    ds_read_b128 v[108:111], v225 offset:512
    ds_read_b128 v[112:115], v225 offset:576
    ds_read_b128 v[116:119], v224 offset:512
    s_waitcnt lgkmcnt(0)
    buffer_load_dwordx4 v209, s[28:31], s59 offen offset:2048 lds
    v_mul_f32 v0, v196, v96
    v_mul_f32 v1, v196, v97
    v_mul_f32 v2, v196, v98
    buffer_load_dwordx4 v210, s[28:31], s59 offen offset:3072 lds
    s_add_u32 s93, s93, 6144
    s_and_b32 s93, s93, 65535
    v_mul_f32 v3, v196, v99
    v_mul_f32 v4, v197, v96
    v_mul_f32 v5, v197, v97
    v_mul_f32 v6, v197, v98
    s_barrier
    s_add_u32 m0, s62, 131072
    s_nop 0
    buffer_load_dwordx4 v217, s[4:7], s94 offen offset:2048 lds
    v_mul_f32 v7, v197, v99
    v_mul_f32 v8, v198, v96
    v_mul_f32 v9, v198, v97
    v_mul_f32 v10, v198, v98
    buffer_load_dwordx4 v217, s[4:7], s94 offen offset:3072 lds
    s_add_u32 s94, s94, 32768
    s_and_b32 s94, s94, 262143
    v_mul_f32 v11, v198, v99
    v_mul_f32 v12, v199, v96
    v_mul_f32 v13, v199, v97
    v_mul_f32 v14, v199, v98
    s_add_u32 m0, s62, 65536
    s_mul_i32 s59, s93, 112
    buffer_load_dwordx4 v207, s[28:31], s59 offen lds
    v_mul_f32 v15, v199, v99
    v_mul_f32 v16, v196, v100
    v_mul_f32 v17, v196, v101
    v_mul_f32 v18, v196, v102
    buffer_load_dwordx4 v208, s[28:31], s59 offen offset:1024 lds
    v_mul_f32 v19, v196, v103
    v_mul_f32 v20, v197, v100
    v_mul_f32 v21, v197, v101
    v_mul_f32 v22, v197, v102
    buffer_load_dwordx4 v209, s[28:31], s59 offen offset:2048 lds
    v_mul_f32 v23, v197, v103
    v_mul_f32 v24, v198, v100
    v_mul_f32 v25, v198, v101
    v_mul_f32 v26, v198, v102
    buffer_load_dwordx4 v210, s[28:31], s59 offen offset:3072 lds
    s_add_u32 s93, s93, 2048
    s_and_b32 s93, s93, 65535
    v_mul_f32 v27, v198, v103
    v_mul_f32 v28, v199, v100
    v_mul_f32 v29, v199, v101
    v_mul_f32 v30, v199, v102
    s_waitcnt vmcnt(16)
    s_barrier
    s_add_u32 m0, s62, 98304
    s_nop 0
    buffer_load_dwordx4 v217, s[4:7], s94 offen lds
    v_mul_f32 v31, v199, v103
    v_mul_f32 v32, v196, v104
    v_mul_f32 v33, v196, v105
    v_mul_f32 v34, v196, v106
    buffer_load_dwordx4 v217, s[4:7], s94 offen offset:1024 lds
    v_mul_f32 v35, v196, v107
    v_mul_f32 v36, v197, v104
    v_mul_f32 v37, v197, v105
    v_mul_f32 v38, v197, v106
    s_add_u32 m0, s62, 81920
    s_mul_i32 s59, s93, 112
    buffer_load_dwordx4 v207, s[28:31], s59 offen lds
    v_mul_f32 v39, v197, v107
    v_mul_f32 v40, v198, v104
    v_mul_f32 v41, v198, v105
    v_mul_f32 v42, v198, v106
    buffer_load_dwordx4 v208, s[28:31], s59 offen offset:1024 lds
    v_mul_f32 v43, v198, v107
    v_mul_f32 v44, v199, v104
    v_mul_f32 v45, v199, v105
    v_mul_f32 v46, v199, v106
    buffer_load_dwordx4 v209, s[28:31], s59 offen offset:2048 lds
    v_mul_f32 v47, v199, v107
    v_mul_f32 v48, v196, v108
    v_mul_f32 v49, v196, v109
    v_mul_f32 v50, v196, v110
    buffer_load_dwordx4 v210, s[28:31], s59 offen offset:3072 lds
    v_mul_f32 v51, v196, v111
    v_mul_f32 v52, v197, v108
    v_mul_f32 v53, v197, v109
    v_mul_f32 v54, v197, v110
    s_barrier
    s_add_u32 m0, s62, 98304
    s_nop 0
    buffer_load_dwordx4 v217, s[4:7], s94 offen offset:2048 lds
    v_mul_f32 v55, v197, v111
    v_mul_f32 v56, v198, v108
    v_mul_f32 v57, v198, v109
    v_mul_f32 v58, v198, v110
    buffer_load_dwordx4 v217, s[4:7], s94 offen offset:3072 lds
    v_mul_f32 v59, v198, v111
    v_mul_f32 v60, v199, v108
    v_mul_f32 v61, v199, v109
    v_mul_f32 v62, v199, v110
    v_mul_f32 v63, v199, v111
    s_add_u32 s93, s51, 11
    s_and_b32 s93, s93, 15
    s_lshl_b32 s93, s93, 12
    s_add_u32 m0, s61, 0
    s_mul_i32 s59, s93, 112
    buffer_load_dwordx4 v211, s[24:27], s59 offen lds
    v_mul_f32 v64, v196, v112
    v_mul_f32 v65, v196, v113
    v_mul_f32 v66, v196, v114
    v_mul_f32 v67, v196, v115
    v_mul_f32 v68, v197, v112
    buffer_load_dwordx4 v212, s[24:27], s59 offen offset:1024 lds
    v_mul_f32 v69, v197, v113
    v_mul_f32 v70, v197, v114
    v_mul_f32 v71, v197, v115
    v_mul_f32 v72, v198, v112
    v_mul_f32 v73, v198, v113
    buffer_load_dwordx4 v222, s[4:7], s93 offen offset:2048 lds
    s_add_u32 s93, s93, 2048
    s_and_b32 s93, s93, 65535
    v_mul_f32 v74, v198, v114
    v_mul_f32 v75, v198, v115
    v_mul_f32 v76, v199, v112
    v_mul_f32 v77, v199, v113
    v_mul_f32 v78, v199, v114
    s_cmp_lg_u32 s46, 0
    s_cbranch_scc1 cp_91
    s_lshl_b32 s55, s2, 2
    s_add_u32 s55, s55, s42
    s_lshl_b32 s55, s55, 13
    s_add_u32 s55, s55, 100663552
    s_cmp_lt_u32 s2, 224
    s_cselect_b32 s55, s55, 2130706432
    buffer_store_dwordx4 v[240:243], v249, s[4:7], s55 offen offset:256 sc0 sc1
    buffer_store_dwordx4 v[244:247], v249, s[4:7], s55 offen offset:1280 sc0 sc1
    s_add_u32 s55, s4, 100663552
    s_addc_u32 s56, s5, 0
    s_lshr_b32 s57, 3084, s51
    s_and_b32 s57, s57, 1
    s_cselect_b32 s20, s55, s20
    s_cselect_b32 s21, s56, s21
cp_91:
    s_waitcnt vmcnt(15)
    s_barrier
    s_add_u32 m0, s61, 16384
    s_mul_i32 s59, s93, 112
    buffer_load_dwordx4 v211, s[24:27], s59 offen lds
    v_mul_f32 v79, v199, v115
    v_mul_f32 v80, v196, v116
    v_mul_f32 v81, v196, v117
    v_mul_f32 v82, v196, v118
    v_mul_f32 v83, v196, v119
    buffer_load_dwordx4 v212, s[24:27], s59 offen offset:1024 lds
    v_mul_f32 v84, v197, v116
    v_mul_f32 v85, v197, v117
    v_mul_f32 v86, v197, v118
    v_mul_f32 v87, v197, v119
    v_mul_f32 v88, v198, v116
    v_mul_f32 v89, v198, v117
    buffer_load_dwordx4 v222, s[4:7], s93 offen offset:2048 lds
    s_add_u32 s93, s93, 6144
    s_and_b32 s93, s93, 65535
    v_mul_f32 v90, v198, v118
    v_mul_f32 v91, v198, v119
    v_mul_f32 v92, v199, v116
    v_mul_f32 v93, v199, v117
    v_mul_f32 v94, v199, v118
    v_mul_f32 v95, v199, v119
    s_barrier
    s_add_u32 m0, s61, 32768
    s_mul_i32 s59, s93, 112
    buffer_load_dwordx4 v211, s[24:27], s59 offen lds
    buffer_load_dwordx4 v212, s[24:27], s59 offen offset:1024 lds
    buffer_load_dwordx4 v222, s[4:7], s93 offen offset:2048 lds
    s_add_u32 s93, s93, 2048
    s_and_b32 s93, s93, 65535
    s_waitcnt vmcnt(9)
    s_barrier
    s_add_u32 m0, s61, 49152
    s_mul_i32 s59, s93, 112
    buffer_load_dwordx4 v211, s[24:27], s59 offen lds
    buffer_load_dwordx4 v212, s[24:27], s59 offen offset:1024 lds
    buffer_load_dwordx4 v222, s[4:7], s93 offen offset:2048 lds
    s_add_u32 s93, s93, 6144
    s_and_b32 s93, s93, 65535
    s_barrier
    s_add_u32 m0, s61, 65536
    s_mul_i32 s59, s93, 112
    buffer_load_dwordx4 v211, s[24:27], s59 offen lds
    buffer_load_dwordx4 v212, s[24:27], s59 offen offset:1024 lds
    buffer_load_dwordx4 v222, s[4:7], s93 offen offset:2048 lds
    s_add_u32 s93, s93, 2048
    s_and_b32 s93, s93, 65535
    s_waitcnt vmcnt(12)
    s_barrier
    s_add_u32 m0, s61, 81920
    s_mul_i32 s59, s93, 112
    buffer_load_dwordx4 v211, s[24:27], s59 offen lds
    buffer_load_dwordx4 v212, s[24:27], s59 offen offset:1024 lds
    buffer_load_dwordx4 v222, s[4:7], s93 offen offset:2048 lds
    s_add_u32 s93, s93, 2048
    s_and_b32 s93, s93, 65535
    s_setprio 0
    ds_read_b64_tr_b16 v[128:129], v177 offset:0
    ds_read_b64_tr_b16 v[130:131], v177 offset:3072
    ds_read_b128 v[96:99], v176 offset:16384
    ds_read_b128 v[100:103], v176 offset:18432
    ds_read_b128 v[104:107], v176 offset:20480
    ds_read_b128 v[108:111], v176 offset:22528
    ds_read_b64_tr_b16 v[140:141], v177 offset:6144
    ds_read_b64_tr_b16 v[142:143], v177 offset:9216
    ds_read_b64_tr_b16 v[132:133], v178 offset:0
    ds_read_b64_tr_b16 v[134:135], v178 offset:3072
    ds_read_b64_tr_b16 v[144:145], v178 offset:6144
    ds_read_b64_tr_b16 v[146:147], v178 offset:9216
    ds_read_b64_tr_b16 v[136:137], v179 offset:0
    ds_read_b64_tr_b16 v[138:139], v179 offset:3072
    ds_read_b64_tr_b16 v[148:149], v179 offset:6144
    ds_read_b64_tr_b16 v[150:151], v179 offset:9216
    s_add_u32 s88, s95, s62
    v_add_u32 v217, s88, v254
    s_mov_b32 s58, 5
    s_waitcnt vmcnt(12) lgkmcnt(0)
    s_barrier
    .p2align 3
    v_mfma_f32_16x16x32_bf16 v[0:3], v[128:131], v[96:99], v[0:3]
    ds_read_b64_tr_b16 v[152:153], v177 offset:16384
    v_mfma_f32_16x16x32_bf16 v[4:7], v[128:131], v[100:103], v[4:7]
    ds_read_b64_tr_b16 v[154:155], v177 offset:19456
    v_mfma_f32_16x16x32_bf16 v[8:11], v[128:131], v[104:107], v[8:11]
    ds_read_b128 v[112:115], v176 offset:17408
    v_mfma_f32_16x16x32_bf16 v[12:15], v[128:131], v[108:111], v[12:15]
    ds_read_b128 v[116:119], v176 offset:19456
    v_mfma_f32_16x16x32_bf16 v[60:63], v[140:143], v[108:111], v[60:63]
    ds_read_b128 v[120:123], v176 offset:21504
    v_mfma_f32_16x16x32_bf16 v[56:59], v[140:143], v[104:107], v[56:59]
    ds_read_b128 v[124:127], v176 offset:23552
    v_mfma_f32_16x16x32_bf16 v[52:55], v[140:143], v[100:103], v[52:55]
    ds_read_b64_tr_b16 v[164:165], v177 offset:22528
    v_mfma_f32_16x16x32_bf16 v[48:51], v[140:143], v[96:99], v[48:51]
    ds_read_b64_tr_b16 v[166:167], v177 offset:25600
    v_mfma_f32_16x16x32_bf16 v[16:19], v[132:135], v[96:99], v[16:19]
    v_mfma_f32_16x16x32_bf16 v[20:23], v[132:135], v[100:103], v[20:23]
    ds_read_b64_tr_b16 v[156:157], v178 offset:16384
    v_mfma_f32_16x16x32_bf16 v[24:27], v[132:135], v[104:107], v[24:27]
    ds_read_b64_tr_b16 v[158:159], v178 offset:19456
    v_mfma_f32_16x16x32_bf16 v[28:31], v[132:135], v[108:111], v[28:31]
    ds_read_b64_tr_b16 v[168:169], v178 offset:22528
    v_mfma_f32_16x16x32_bf16 v[76:79], v[144:147], v[108:111], v[76:79]
    ds_read_b64_tr_b16 v[170:171], v178 offset:25600
    v_mfma_f32_16x16x32_bf16 v[72:75], v[144:147], v[104:107], v[72:75]
    ds_read_b64_tr_b16 v[160:161], v179 offset:16384
    v_mfma_f32_16x16x32_bf16 v[68:71], v[144:147], v[100:103], v[68:71]
    ds_read_b64_tr_b16 v[162:163], v179 offset:19456
    v_mfma_f32_16x16x32_bf16 v[64:67], v[144:147], v[96:99], v[64:67]
    ds_read_b64_tr_b16 v[172:173], v179 offset:22528
    v_mfma_f32_16x16x32_bf16 v[32:35], v[136:139], v[96:99], v[32:35]
    ds_read_b64_tr_b16 v[174:175], v179 offset:25600
    v_mfma_f32_16x16x32_bf16 v[36:39], v[136:139], v[100:103], v[36:39]
    v_mfma_f32_16x16x32_bf16 v[40:43], v[136:139], v[104:107], v[40:43]
    v_mfma_f32_16x16x32_bf16 v[44:47], v[136:139], v[108:111], v[44:47]
    v_mfma_f32_16x16x32_bf16 v[92:95], v[148:151], v[108:111], v[92:95]
    v_mfma_f32_16x16x32_bf16 v[88:91], v[148:151], v[104:107], v[88:91]
    v_mfma_f32_16x16x32_bf16 v[84:87], v[148:151], v[100:103], v[84:87]
    v_mfma_f32_16x16x32_bf16 v[80:83], v[148:151], v[96:99], v[80:83]
    .p2align 3
loop_92:
    s_waitcnt vmcnt(9) lgkmcnt(0)
    s_barrier
    .p2align 3
    v_mfma_f32_16x16x32_bf16 v[0:3], v[152:155], v[112:115], v[0:3]
    ds_read_b64_tr_b16 v[128:129], v177 offset:32768
    v_mfma_f32_16x16x32_bf16 v[4:7], v[152:155], v[116:119], v[4:7]
    ds_read_b64_tr_b16 v[130:131], v177 offset:35840
    v_mfma_f32_16x16x32_bf16 v[8:11], v[152:155], v[120:123], v[8:11]
    ds_read_b128 v[96:99], v176 offset:32768
    v_mfma_f32_16x16x32_bf16 v[12:15], v[152:155], v[124:127], v[12:15]
    ds_read_b128 v[100:103], v176 offset:34816
    v_mfma_f32_16x16x32_bf16 v[60:63], v[164:167], v[124:127], v[60:63]
    ds_read_b128 v[104:107], v176 offset:36864
    v_mfma_f32_16x16x32_bf16 v[56:59], v[164:167], v[120:123], v[56:59]
    ds_read_b128 v[108:111], v176 offset:38912
    v_mfma_f32_16x16x32_bf16 v[52:55], v[164:167], v[116:119], v[52:55]
    ds_read_b64_tr_b16 v[140:141], v177 offset:38912
    v_mfma_f32_16x16x32_bf16 v[48:51], v[164:167], v[112:115], v[48:51]
    ds_read_b64_tr_b16 v[142:143], v177 offset:41984
    v_mfma_f32_16x16x32_bf16 v[16:19], v[156:159], v[112:115], v[16:19]
    v_mfma_f32_16x16x32_bf16 v[20:23], v[156:159], v[116:119], v[20:23]
    ds_read_b64_tr_b16 v[132:133], v178 offset:32768
    v_mfma_f32_16x16x32_bf16 v[24:27], v[156:159], v[120:123], v[24:27]
    ds_read_b64_tr_b16 v[134:135], v178 offset:35840
    v_mfma_f32_16x16x32_bf16 v[28:31], v[156:159], v[124:127], v[28:31]
    ds_read_b64_tr_b16 v[144:145], v178 offset:38912
    v_mfma_f32_16x16x32_bf16 v[76:79], v[168:171], v[124:127], v[76:79]
    ds_read_b64_tr_b16 v[146:147], v178 offset:41984
    v_mfma_f32_16x16x32_bf16 v[72:75], v[168:171], v[120:123], v[72:75]
    ds_read_b64_tr_b16 v[136:137], v179 offset:32768
    v_mfma_f32_16x16x32_bf16 v[68:71], v[168:171], v[116:119], v[68:71]
    ds_read_b64_tr_b16 v[138:139], v179 offset:35840
    v_mfma_f32_16x16x32_bf16 v[64:67], v[168:171], v[112:115], v[64:67]
    ds_read_b64_tr_b16 v[148:149], v179 offset:38912
    v_mfma_f32_16x16x32_bf16 v[32:35], v[160:163], v[112:115], v[32:35]
    ds_read_b64_tr_b16 v[150:151], v179 offset:41984
    v_mfma_f32_16x16x32_bf16 v[36:39], v[160:163], v[116:119], v[36:39]
    v_mfma_f32_16x16x32_bf16 v[40:43], v[160:163], v[120:123], v[40:43]
    v_mfma_f32_16x16x32_bf16 v[44:47], v[160:163], v[124:127], v[44:47]
    v_mfma_f32_16x16x32_bf16 v[92:95], v[172:175], v[124:127], v[92:95]
    v_mfma_f32_16x16x32_bf16 v[88:91], v[172:175], v[120:123], v[88:91]
    v_mfma_f32_16x16x32_bf16 v[84:87], v[172:175], v[116:119], v[84:87]
    v_mfma_f32_16x16x32_bf16 v[80:83], v[172:175], v[112:115], v[80:83]
    s_waitcnt vmcnt(6) lgkmcnt(0)
    s_barrier
    .p2align 3
    v_mfma_f32_16x16x32_bf16 v[0:3], v[128:131], v[96:99], v[0:3]
    ds_read_b64_tr_b16 v[152:153], v180 offset:0
    v_mfma_f32_16x16x32_bf16 v[4:7], v[128:131], v[100:103], v[4:7]
    ds_read_b64_tr_b16 v[154:155], v180 offset:3072
    v_mfma_f32_16x16x32_bf16 v[8:11], v[128:131], v[104:107], v[8:11]
    ds_read_b128 v[112:115], v176 offset:33792
    v_mfma_f32_16x16x32_bf16 v[12:15], v[128:131], v[108:111], v[12:15]
    ds_read_b128 v[116:119], v176 offset:35840
    v_mfma_f32_16x16x32_bf16 v[60:63], v[140:143], v[108:111], v[60:63]
    ds_read_b128 v[120:123], v176 offset:37888
    v_mfma_f32_16x16x32_bf16 v[56:59], v[140:143], v[104:107], v[56:59]
    ds_read_b128 v[124:127], v176 offset:39936
    v_mfma_f32_16x16x32_bf16 v[52:55], v[140:143], v[100:103], v[52:55]
    ds_read_b64_tr_b16 v[164:165], v180 offset:6144
    v_mfma_f32_16x16x32_bf16 v[48:51], v[140:143], v[96:99], v[48:51]
    ds_read_b64_tr_b16 v[166:167], v180 offset:9216
    v_mfma_f32_16x16x32_bf16 v[16:19], v[132:135], v[96:99], v[16:19]
    v_mfma_f32_16x16x32_bf16 v[20:23], v[132:135], v[100:103], v[20:23]
    ds_read_b64_tr_b16 v[156:157], v181 offset:0
    v_mfma_f32_16x16x32_bf16 v[24:27], v[132:135], v[104:107], v[24:27]
    ds_read_b64_tr_b16 v[158:159], v181 offset:3072
    v_mfma_f32_16x16x32_bf16 v[28:31], v[132:135], v[108:111], v[28:31]
    ds_read_b64_tr_b16 v[168:169], v181 offset:6144
    v_mfma_f32_16x16x32_bf16 v[76:79], v[144:147], v[108:111], v[76:79]
    ds_read_b64_tr_b16 v[170:171], v181 offset:9216
    v_mfma_f32_16x16x32_bf16 v[72:75], v[144:147], v[104:107], v[72:75]
    ds_read_b64_tr_b16 v[160:161], v182 offset:0
    v_mfma_f32_16x16x32_bf16 v[68:71], v[144:147], v[100:103], v[68:71]
    ds_read_b64_tr_b16 v[162:163], v182 offset:3072
    v_mfma_f32_16x16x32_bf16 v[64:67], v[144:147], v[96:99], v[64:67]
    ds_read_b64_tr_b16 v[172:173], v182 offset:6144
    v_mfma_f32_16x16x32_bf16 v[32:35], v[136:139], v[96:99], v[32:35]
    ds_read_b64_tr_b16 v[174:175], v182 offset:9216
    v_mfma_f32_16x16x32_bf16 v[36:39], v[136:139], v[100:103], v[36:39]
    v_mfma_f32_16x16x32_bf16 v[40:43], v[136:139], v[104:107], v[40:43]
    v_mfma_f32_16x16x32_bf16 v[44:47], v[136:139], v[108:111], v[44:47]
    v_mfma_f32_16x16x32_bf16 v[92:95], v[148:151], v[108:111], v[92:95]
    v_mfma_f32_16x16x32_bf16 v[88:91], v[148:151], v[104:107], v[88:91]
    v_mfma_f32_16x16x32_bf16 v[84:87], v[148:151], v[100:103], v[84:87]
    v_mfma_f32_16x16x32_bf16 v[80:83], v[148:151], v[96:99], v[80:83]
    s_waitcnt vmcnt(3) lgkmcnt(0)
    s_barrier
    .p2align 3
    v_mfma_f32_16x16x32_bf16 v[0:3], v[152:155], v[112:115], v[0:3]
    ds_read_b64_tr_b16 v[128:129], v180 offset:16384
    v_mfma_f32_16x16x32_bf16 v[4:7], v[152:155], v[116:119], v[4:7]
    ds_read_b64_tr_b16 v[130:131], v180 offset:19456
    v_mfma_f32_16x16x32_bf16 v[8:11], v[152:155], v[120:123], v[8:11]
    ds_read_b128 v[96:99], v176 offset:0
    v_mfma_f32_16x16x32_bf16 v[12:15], v[152:155], v[124:127], v[12:15]
    ds_read_b128 v[100:103], v176 offset:2048
    v_mfma_f32_16x16x32_bf16 v[60:63], v[164:167], v[124:127], v[60:63]
    ds_read_b128 v[104:107], v176 offset:4096
    v_mfma_f32_16x16x32_bf16 v[56:59], v[164:167], v[120:123], v[56:59]
    ds_read_b128 v[108:111], v176 offset:6144
    v_mfma_f32_16x16x32_bf16 v[52:55], v[164:167], v[116:119], v[52:55]
    ds_read_b64_tr_b16 v[140:141], v180 offset:22528
    v_mfma_f32_16x16x32_bf16 v[48:51], v[164:167], v[112:115], v[48:51]
    ds_read_b64_tr_b16 v[142:143], v180 offset:25600
    v_mfma_f32_16x16x32_bf16 v[16:19], v[156:159], v[112:115], v[16:19]
    v_mfma_f32_16x16x32_bf16 v[20:23], v[156:159], v[116:119], v[20:23]
    ds_read_b64_tr_b16 v[132:133], v181 offset:16384
    v_mfma_f32_16x16x32_bf16 v[24:27], v[156:159], v[120:123], v[24:27]
    ds_read_b64_tr_b16 v[134:135], v181 offset:19456
    v_mfma_f32_16x16x32_bf16 v[28:31], v[156:159], v[124:127], v[28:31]
    ds_read_b64_tr_b16 v[144:145], v181 offset:22528
    v_mfma_f32_16x16x32_bf16 v[76:79], v[168:171], v[124:127], v[76:79]
    ds_read_b64_tr_b16 v[146:147], v181 offset:25600
    v_mfma_f32_16x16x32_bf16 v[72:75], v[168:171], v[120:123], v[72:75]
    ds_read_b64_tr_b16 v[136:137], v182 offset:16384
    v_mfma_f32_16x16x32_bf16 v[68:71], v[168:171], v[116:119], v[68:71]
    ds_read_b64_tr_b16 v[138:139], v182 offset:19456
    v_mfma_f32_16x16x32_bf16 v[64:67], v[168:171], v[112:115], v[64:67]
    ds_read_b64_tr_b16 v[148:149], v182 offset:22528
    v_mfma_f32_16x16x32_bf16 v[32:35], v[160:163], v[112:115], v[32:35]
    ds_read_b64_tr_b16 v[150:151], v182 offset:25600
    v_mfma_f32_16x16x32_bf16 v[36:39], v[160:163], v[116:119], v[36:39]
    v_mfma_f32_16x16x32_bf16 v[40:43], v[160:163], v[120:123], v[40:43]
    v_mfma_f32_16x16x32_bf16 v[44:47], v[160:163], v[124:127], v[44:47]
    v_mfma_f32_16x16x32_bf16 v[92:95], v[172:175], v[124:127], v[92:95]
    v_mfma_f32_16x16x32_bf16 v[88:91], v[172:175], v[120:123], v[88:91]
    v_mfma_f32_16x16x32_bf16 v[84:87], v[172:175], v[116:119], v[84:87]
    v_mfma_f32_16x16x32_bf16 v[80:83], v[172:175], v[112:115], v[80:83]
    s_waitcnt vmcnt(0) lgkmcnt(0)
    s_barrier
    .p2align 3
    v_mfma_f32_16x16x32_bf16 v[0:3], v[128:131], v[96:99], v[0:3]
    ds_read_b64_tr_b16 v[152:153], v180 offset:32768
    v_mfma_f32_16x16x32_bf16 v[4:7], v[128:131], v[100:103], v[4:7]
    ds_read_b64_tr_b16 v[154:155], v180 offset:35840
    v_mfma_f32_16x16x32_bf16 v[8:11], v[128:131], v[104:107], v[8:11]
    ds_read_b128 v[112:115], v176 offset:1024
    v_mfma_f32_16x16x32_bf16 v[12:15], v[128:131], v[108:111], v[12:15]
    ds_read_b128 v[116:119], v176 offset:3072
    v_mfma_f32_16x16x32_bf16 v[60:63], v[140:143], v[108:111], v[60:63]
    ds_read_b128 v[120:123], v176 offset:5120
    v_mfma_f32_16x16x32_bf16 v[56:59], v[140:143], v[104:107], v[56:59]
    ds_read_b128 v[124:127], v176 offset:7168
    v_mfma_f32_16x16x32_bf16 v[52:55], v[140:143], v[100:103], v[52:55]
    ds_read_b64_tr_b16 v[164:165], v180 offset:38912
    v_mfma_f32_16x16x32_bf16 v[48:51], v[140:143], v[96:99], v[48:51]
    ds_read_b64_tr_b16 v[166:167], v180 offset:41984
    v_mfma_f32_16x16x32_bf16 v[16:19], v[132:135], v[96:99], v[16:19]
    v_mfma_f32_16x16x32_bf16 v[20:23], v[132:135], v[100:103], v[20:23]
    ds_read_b64_tr_b16 v[156:157], v181 offset:32768
    v_mfma_f32_16x16x32_bf16 v[24:27], v[132:135], v[104:107], v[24:27]
    ds_read_b64_tr_b16 v[158:159], v181 offset:35840
    v_mfma_f32_16x16x32_bf16 v[28:31], v[132:135], v[108:111], v[28:31]
    ds_read_b64_tr_b16 v[168:169], v181 offset:38912
    v_mfma_f32_16x16x32_bf16 v[76:79], v[144:147], v[108:111], v[76:79]
    ds_read_b64_tr_b16 v[170:171], v181 offset:41984
    v_mfma_f32_16x16x32_bf16 v[72:75], v[144:147], v[104:107], v[72:75]
    ds_read_b64_tr_b16 v[160:161], v182 offset:32768
    v_mfma_f32_16x16x32_bf16 v[68:71], v[144:147], v[100:103], v[68:71]
    ds_read_b64_tr_b16 v[162:163], v182 offset:35840
    v_mfma_f32_16x16x32_bf16 v[64:67], v[144:147], v[96:99], v[64:67]
    ds_read_b64_tr_b16 v[172:173], v182 offset:38912
    v_mfma_f32_16x16x32_bf16 v[32:35], v[136:139], v[96:99], v[32:35]
    ds_read_b64_tr_b16 v[174:175], v182 offset:41984
    v_mfma_f32_16x16x32_bf16 v[36:39], v[136:139], v[100:103], v[36:39]
    v_mfma_f32_16x16x32_bf16 v[40:43], v[136:139], v[104:107], v[40:43]
    v_mfma_f32_16x16x32_bf16 v[44:47], v[136:139], v[108:111], v[44:47]
    v_mfma_f32_16x16x32_bf16 v[92:95], v[148:151], v[108:111], v[92:95]
    v_mfma_f32_16x16x32_bf16 v[88:91], v[148:151], v[104:107], v[88:91]
    v_mfma_f32_16x16x32_bf16 v[84:87], v[148:151], v[100:103], v[84:87]
    v_mfma_f32_16x16x32_bf16 v[80:83], v[148:151], v[96:99], v[80:83]
    s_waitcnt lgkmcnt(0)
    s_barrier
    .p2align 3
    v_mfma_f32_16x16x32_bf16 v[0:3], v[152:155], v[112:115], v[0:3]
    ds_read_b64_tr_b16 v[128:129], v177 offset:0
    v_mfma_f32_16x16x32_bf16 v[4:7], v[152:155], v[116:119], v[4:7]
    ds_read_b64_tr_b16 v[130:131], v177 offset:3072
    v_mfma_f32_16x16x32_bf16 v[8:11], v[152:155], v[120:123], v[8:11]
    ds_read_b128 v[96:99], v176 offset:16384
    v_mfma_f32_16x16x32_bf16 v[12:15], v[152:155], v[124:127], v[12:15]
    ds_read_b128 v[100:103], v176 offset:18432
    v_mfma_f32_16x16x32_bf16 v[60:63], v[164:167], v[124:127], v[60:63]
    ds_read_b128 v[104:107], v176 offset:20480
    v_mfma_f32_16x16x32_bf16 v[56:59], v[164:167], v[120:123], v[56:59]
    ds_read_b128 v[108:111], v176 offset:22528
    v_mfma_f32_16x16x32_bf16 v[52:55], v[164:167], v[116:119], v[52:55]
    ds_read_b64_tr_b16 v[140:141], v177 offset:6144
    v_mfma_f32_16x16x32_bf16 v[48:51], v[164:167], v[112:115], v[48:51]
    ds_read_b64_tr_b16 v[142:143], v177 offset:9216
    v_mfma_f32_16x16x32_bf16 v[16:19], v[156:159], v[112:115], v[16:19]
    v_mfma_f32_16x16x32_bf16 v[20:23], v[156:159], v[116:119], v[20:23]
    ds_read_b64_tr_b16 v[132:133], v178 offset:0
    v_mfma_f32_16x16x32_bf16 v[24:27], v[156:159], v[120:123], v[24:27]
    ds_read_b64_tr_b16 v[134:135], v178 offset:3072
    v_mfma_f32_16x16x32_bf16 v[28:31], v[156:159], v[124:127], v[28:31]
    ds_read_b64_tr_b16 v[144:145], v178 offset:6144
    v_mfma_f32_16x16x32_bf16 v[76:79], v[168:171], v[124:127], v[76:79]
    ds_read_b64_tr_b16 v[146:147], v178 offset:9216
    v_mfma_f32_16x16x32_bf16 v[72:75], v[168:171], v[120:123], v[72:75]
    ds_read_b64_tr_b16 v[136:137], v179 offset:0
    v_mfma_f32_16x16x32_bf16 v[68:71], v[168:171], v[116:119], v[68:71]
    ds_read_b64_tr_b16 v[138:139], v179 offset:3072
    v_mfma_f32_16x16x32_bf16 v[64:67], v[168:171], v[112:115], v[64:67]
    ds_read_b64_tr_b16 v[148:149], v179 offset:6144
    v_mfma_f32_16x16x32_bf16 v[32:35], v[160:163], v[112:115], v[32:35]
    ds_read_b64_tr_b16 v[150:151], v179 offset:9216
    v_mfma_f32_16x16x32_bf16 v[36:39], v[160:163], v[116:119], v[36:39]
    v_mfma_f32_16x16x32_bf16 v[40:43], v[160:163], v[120:123], v[40:43]
    v_mfma_f32_16x16x32_bf16 v[44:47], v[160:163], v[124:127], v[44:47]
    v_mfma_f32_16x16x32_bf16 v[92:95], v[172:175], v[124:127], v[92:95]
    v_mfma_f32_16x16x32_bf16 v[88:91], v[172:175], v[120:123], v[88:91]
    v_mfma_f32_16x16x32_bf16 v[84:87], v[172:175], v[116:119], v[84:87]
    v_mfma_f32_16x16x32_bf16 v[80:83], v[172:175], v[112:115], v[80:83]
    s_waitcnt lgkmcnt(0)
    s_barrier
    .p2align 3
    v_mfma_f32_16x16x32_bf16 v[0:3], v[128:131], v[96:99], v[0:3]
    ds_read_b64_tr_b16 v[152:153], v177 offset:16384
    v_mfma_f32_16x16x32_bf16 v[4:7], v[128:131], v[100:103], v[4:7]
    ds_read_b64_tr_b16 v[154:155], v177 offset:19456
    v_mfma_f32_16x16x32_bf16 v[8:11], v[128:131], v[104:107], v[8:11]
    ds_read_b128 v[112:115], v176 offset:17408
    v_mfma_f32_16x16x32_bf16 v[12:15], v[128:131], v[108:111], v[12:15]
    ds_read_b128 v[116:119], v176 offset:19456
    v_mfma_f32_16x16x32_bf16 v[60:63], v[140:143], v[108:111], v[60:63]
    ds_read_b128 v[120:123], v176 offset:21504
    v_mfma_f32_16x16x32_bf16 v[56:59], v[140:143], v[104:107], v[56:59]
    ds_read_b128 v[124:127], v176 offset:23552
    v_mfma_f32_16x16x32_bf16 v[52:55], v[140:143], v[100:103], v[52:55]
    ds_read_b64_tr_b16 v[164:165], v177 offset:22528
    v_mfma_f32_16x16x32_bf16 v[48:51], v[140:143], v[96:99], v[48:51]
    ds_read_b64_tr_b16 v[166:167], v177 offset:25600
    v_mfma_f32_16x16x32_bf16 v[16:19], v[132:135], v[96:99], v[16:19]
    v_mfma_f32_16x16x32_bf16 v[20:23], v[132:135], v[100:103], v[20:23]
    ds_read_b64_tr_b16 v[156:157], v178 offset:16384
    v_mfma_f32_16x16x32_bf16 v[24:27], v[132:135], v[104:107], v[24:27]
    ds_read_b64_tr_b16 v[158:159], v178 offset:19456
    v_mfma_f32_16x16x32_bf16 v[28:31], v[132:135], v[108:111], v[28:31]
    ds_read_b64_tr_b16 v[168:169], v178 offset:22528
    v_mfma_f32_16x16x32_bf16 v[76:79], v[144:147], v[108:111], v[76:79]
    ds_read_b64_tr_b16 v[170:171], v178 offset:25600
    v_mfma_f32_16x16x32_bf16 v[72:75], v[144:147], v[104:107], v[72:75]
    ds_read_b64_tr_b16 v[160:161], v179 offset:16384
    v_mfma_f32_16x16x32_bf16 v[68:71], v[144:147], v[100:103], v[68:71]
    ds_read_b64_tr_b16 v[162:163], v179 offset:19456
    v_mfma_f32_16x16x32_bf16 v[64:67], v[144:147], v[96:99], v[64:67]
    ds_read_b64_tr_b16 v[172:173], v179 offset:22528
    v_mfma_f32_16x16x32_bf16 v[32:35], v[136:139], v[96:99], v[32:35]
    ds_read_b64_tr_b16 v[174:175], v179 offset:25600
    v_mfma_f32_16x16x32_bf16 v[36:39], v[136:139], v[100:103], v[36:39]
    v_mfma_f32_16x16x32_bf16 v[40:43], v[136:139], v[104:107], v[40:43]
    v_mfma_f32_16x16x32_bf16 v[44:47], v[136:139], v[108:111], v[44:47]
    v_mfma_f32_16x16x32_bf16 v[92:95], v[148:151], v[108:111], v[92:95]
    s_sub_u32 s58, s58, 1
    s_cmp_lg_u32 s58, 0
    .p2align 3
    v_mfma_f32_16x16x32_bf16 v[88:91], v[148:151], v[104:107], v[88:91]
    v_mfma_f32_16x16x32_bf16 v[84:87], v[148:151], v[100:103], v[84:87]
    v_mfma_f32_16x16x32_bf16 v[80:83], v[148:151], v[96:99], v[80:83]
    s_cbranch_scc1 loop_92
    s_waitcnt lgkmcnt(0)
    s_barrier
    .p2align 3
    v_mfma_f32_16x16x32_bf16 v[0:3], v[152:155], v[112:115], v[0:3]
    v_mfma_f32_16x16x32_bf16 v[4:7], v[152:155], v[116:119], v[4:7]
    v_mfma_f32_16x16x32_bf16 v[8:11], v[152:155], v[120:123], v[8:11]
    v_mfma_f32_16x16x32_bf16 v[12:15], v[152:155], v[124:127], v[12:15]
    v_mfma_f32_16x16x32_bf16 v[60:63], v[164:167], v[124:127], v[60:63]
    v_mfma_f32_16x16x32_bf16 v[56:59], v[164:167], v[120:123], v[56:59]
    v_mfma_f32_16x16x32_bf16 v[52:55], v[164:167], v[116:119], v[52:55]
    v_mfma_f32_16x16x32_bf16 v[48:51], v[164:167], v[112:115], v[48:51]
    v_mfma_f32_16x16x32_bf16 v[16:19], v[156:159], v[112:115], v[16:19]
    v_mfma_f32_16x16x32_bf16 v[20:23], v[156:159], v[116:119], v[20:23]
    v_mfma_f32_16x16x32_bf16 v[24:27], v[156:159], v[120:123], v[24:27]
    v_mfma_f32_16x16x32_bf16 v[28:31], v[156:159], v[124:127], v[28:31]
    v_mfma_f32_16x16x32_bf16 v[76:79], v[168:171], v[124:127], v[76:79]
    v_mfma_f32_16x16x32_bf16 v[72:75], v[168:171], v[120:123], v[72:75]
    v_mfma_f32_16x16x32_bf16 v[68:71], v[168:171], v[116:119], v[68:71]
    v_mfma_f32_16x16x32_bf16 v[64:67], v[168:171], v[112:115], v[64:67]
    v_mfma_f32_16x16x32_bf16 v[32:35], v[160:163], v[112:115], v[32:35]
    v_mfma_f32_16x16x32_bf16 v[36:39], v[160:163], v[116:119], v[36:39]
    v_mfma_f32_16x16x32_bf16 v[40:43], v[160:163], v[120:123], v[40:43]
    v_mfma_f32_16x16x32_bf16 v[44:47], v[160:163], v[124:127], v[44:47]
    v_mfma_f32_16x16x32_bf16 v[92:95], v[172:175], v[124:127], v[92:95]
    v_mfma_f32_16x16x32_bf16 v[88:91], v[172:175], v[120:123], v[88:91]
    v_mfma_f32_16x16x32_bf16 v[84:87], v[172:175], v[116:119], v[84:87]
    v_mfma_f32_16x16x32_bf16 v[80:83], v[172:175], v[112:115], v[80:83]
    s_setprio 1
    s_barrier
    s_add_u32 m0, s62, 131072
    s_mov_b32 s92, 49152
    buffer_load_dwordx4 v217, s[4:7], s92 offen lds
    s_nop 7
    v_mul_f32 v96, v184, v0
    v_mul_f32 v97, v184, v1
    buffer_load_dwordx4 v217, s[4:7], s92 offen offset:1024 lds
    v_mul_f32 v98, v184, v2
    v_mul_f32 v99, v184, v3
    v_exp_f32 v96, v96
    v_exp_f32 v97, v97
    buffer_load_dwordx4 v217, s[4:7], s92 offen offset:2048 lds
    v_exp_f32 v98, v98
    v_exp_f32 v99, v99
    v_mul_f32 v0, v0, v48
    v_mul_f32 v1, v1, v49
    buffer_load_dwordx4 v217, s[4:7], s92 offen offset:3072 lds
    v_mul_f32 v2, v2, v50
    v_mul_f32 v3, v3, v51
    v_fma_f32 v96, v96, v188, v188
    v_fma_f32 v97, v97, v188, v188
    s_add_u32 m0, s62, 16384
    s_add_u32 s59, s68, 2490368
    buffer_load_dwordx4 v213, s[20:23], s59 offen lds
    v_fma_f32 v98, v98, v188, v188
    v_fma_f32 v99, v99, v188, v188
    v_rcp_f32 v96, v96
    v_rcp_f32 v97, v97
    buffer_load_dwordx4 v214, s[20:23], s59 offen offset:1024 lds
    v_rcp_f32 v98, v98
    v_rcp_f32 v99, v99
    v_mul_f32 v0, v0, v96
    v_mul_f32 v1, v1, v97
    buffer_load_dwordx4 v215, s[20:23], s59 offen offset:2048 lds
    v_mul_f32 v2, v2, v98
    v_mul_f32 v3, v3, v99
    v_cvt_pk_bf16_f32 v100, v0, v1
    v_cvt_pk_bf16_f32 v101, v2, v3
    buffer_load_dwordx4 v216, s[20:23], s59 offen offset:3072 lds
    v_mul_f32 v96, v184, v16
    v_mul_f32 v97, v184, v17
    v_mul_f32 v98, v184, v18
    v_mul_f32 v99, v184, v19
    s_barrier
    s_add_u32 m0, s62, 98304
    s_mov_b32 s92, 65536
    buffer_load_dwordx4 v217, s[4:7], s92 offen lds
    v_exp_f32 v96, v96
    v_exp_f32 v97, v97
    v_exp_f32 v98, v98
    buffer_load_dwordx4 v217, s[4:7], s92 offen offset:1024 lds
    v_exp_f32 v99, v99
    v_mul_f32 v16, v16, v64
    v_mul_f32 v17, v17, v65
    v_mul_f32 v18, v18, v66
    buffer_load_dwordx4 v217, s[4:7], s92 offen offset:2048 lds
    v_mul_f32 v19, v19, v67
    v_fma_f32 v96, v96, v188, v188
    v_fma_f32 v97, v97, v188, v188
    buffer_load_dwordx4 v217, s[4:7], s92 offen offset:3072 lds
    v_fma_f32 v98, v98, v188, v188
    v_fma_f32 v99, v99, v188, v188
    v_rcp_f32 v96, v96
    v_rcp_f32 v97, v97
    s_add_u32 m0, s62, 32768
    s_add_u32 s59, s68, 2752512
    buffer_load_dwordx4 v213, s[20:23], s59 offen lds
    v_rcp_f32 v98, v98
    v_rcp_f32 v99, v99
    v_mul_f32 v16, v16, v96
    buffer_load_dwordx4 v214, s[20:23], s59 offen offset:1024 lds
    v_mul_f32 v17, v17, v97
    v_mul_f32 v18, v18, v98
    v_mul_f32 v19, v19, v99
    v_cvt_pk_bf16_f32 v102, v16, v17
    buffer_load_dwordx4 v215, s[20:23], s59 offen offset:2048 lds
    v_cvt_pk_bf16_f32 v103, v18, v19
    s_add_u32 s55, s89, 262144
    buffer_store_dwordx4 v[100:103], v254, s[4:7], s55 offen sc0 sc1
    v_mul_f32 v96, v185, v4
    buffer_load_dwordx4 v216, s[20:23], s59 offen offset:3072 lds
    v_mul_f32 v97, v185, v5
    v_mul_f32 v98, v185, v6
    v_mul_f32 v99, v185, v7
    v_exp_f32 v96, v96
    s_waitcnt vmcnt(13)
    s_barrier
    s_add_u32 m0, s62, 114688
    s_mov_b32 s92, 81920
    buffer_load_dwordx4 v217, s[4:7], s92 offen lds
    v_exp_f32 v97, v97
    v_exp_f32 v98, v98
    v_exp_f32 v99, v99
    buffer_load_dwordx4 v217, s[4:7], s92 offen offset:1024 lds
    v_mul_f32 v4, v4, v52
    v_mul_f32 v5, v5, v53
    v_mul_f32 v6, v6, v54
    v_mul_f32 v7, v7, v55
    buffer_load_dwordx4 v217, s[4:7], s92 offen offset:2048 lds
    v_fma_f32 v96, v96, v189, v189
    v_fma_f32 v97, v97, v189, v189
    v_fma_f32 v98, v98, v189, v189
    buffer_load_dwordx4 v217, s[4:7], s92 offen offset:3072 lds
    v_fma_f32 v99, v99, v189, v189
    v_rcp_f32 v96, v96
    v_rcp_f32 v97, v97
    v_rcp_f32 v98, v98
    s_add_u32 m0, s62, 49152
    s_add_u32 s59, s68, 3407872
    buffer_load_dwordx4 v213, s[20:23], s59 offen lds
    v_rcp_f32 v99, v99
    v_mul_f32 v4, v4, v96
    v_mul_f32 v5, v5, v97
    v_mul_f32 v6, v6, v98
    buffer_load_dwordx4 v214, s[20:23], s59 offen offset:1024 lds
    v_mul_f32 v7, v7, v99
    v_cvt_pk_bf16_f32 v104, v4, v5
    v_cvt_pk_bf16_f32 v105, v6, v7
    buffer_load_dwordx4 v215, s[20:23], s59 offen offset:2048 lds
    v_mul_f32 v96, v185, v20
    v_mul_f32 v97, v185, v21
    v_mul_f32 v98, v185, v22
    v_mul_f32 v99, v185, v23
    buffer_load_dwordx4 v216, s[20:23], s59 offen offset:3072 lds
    v_exp_f32 v96, v96
    v_exp_f32 v97, v97
    v_exp_f32 v98, v98
    v_exp_f32 v99, v99
    s_waitcnt vmcnt(13)
    s_barrier
    s_add_u32 m0, s62, 131072
    s_mov_b32 s92, 98304
    buffer_load_dwordx4 v217, s[4:7], s92 offen lds
    v_mul_f32 v20, v20, v68
    v_mul_f32 v21, v21, v69
    v_mul_f32 v22, v22, v70
    buffer_load_dwordx4 v217, s[4:7], s92 offen offset:1024 lds
    v_mul_f32 v23, v23, v71
    v_fma_f32 v96, v96, v189, v189
    v_fma_f32 v97, v97, v189, v189
    v_fma_f32 v98, v98, v189, v189
    buffer_load_dwordx4 v217, s[4:7], s92 offen offset:2048 lds
    v_fma_f32 v99, v99, v189, v189
    v_rcp_f32 v96, v96
    v_rcp_f32 v97, v97
    buffer_load_dwordx4 v217, s[4:7], s92 offen offset:3072 lds
    v_rcp_f32 v98, v98
    v_rcp_f32 v99, v99
    v_mul_f32 v20, v20, v96
    v_mul_f32 v21, v21, v97
    s_add_u32 m0, s62, 65536
    s_add_u32 s59, s68, 65536
    buffer_load_dwordx4 v213, s[20:23], s59 offen lds
    v_mul_f32 v22, v22, v98
    v_mul_f32 v23, v23, v99
    v_cvt_pk_bf16_f32 v106, v20, v21
    v_cvt_pk_bf16_f32 v107, v22, v23
    buffer_load_dwordx4 v214, s[20:23], s59 offen offset:1024 lds
    s_add_u32 s55, s89, 264192
    buffer_store_dwordx4 v[104:107], v254, s[4:7], s55 offen sc0 sc1
    v_mul_f32 v96, v186, v8
    v_mul_f32 v97, v186, v9
    buffer_load_dwordx4 v215, s[20:23], s59 offen offset:2048 lds
    v_mul_f32 v98, v186, v10
    v_mul_f32 v99, v186, v11
    v_exp_f32 v96, v96
    v_exp_f32 v97, v97
    buffer_load_dwordx4 v216, s[20:23], s59 offen offset:3072 lds
    v_exp_f32 v98, v98
    v_exp_f32 v99, v99
    v_mul_f32 v8, v8, v56
    v_mul_f32 v9, v9, v57
    s_waitcnt vmcnt(13)
    s_barrier
    v_lshrrev_b32 v252, 2, v254
    v_min_u32 v252, 28, v252
    s_add_u32 s55, s0, 2080
    buffer_load_dword v251, v252, s[4:7], s55 offen sc0 sc1
    s_add_u32 m0, s62, 98304
    s_mov_b32 s92, 114688
    buffer_load_dwordx4 v217, s[4:7], s92 offen lds
    v_mul_f32 v10, v10, v58
    v_mul_f32 v11, v11, v59
    v_fma_f32 v96, v96, v190, v190
    v_fma_f32 v97, v97, v190, v190
    buffer_load_dwordx4 v217, s[4:7], s92 offen offset:1024 lds
    v_fma_f32 v98, v98, v190, v190
    v_fma_f32 v99, v99, v190, v190
    v_rcp_f32 v96, v96
    v_rcp_f32 v97, v97
    buffer_load_dwordx4 v217, s[4:7], s92 offen offset:2048 lds
    v_rcp_f32 v98, v98
    v_rcp_f32 v99, v99
    v_mul_f32 v8, v8, v96
    v_mul_f32 v9, v9, v97
    buffer_load_dwordx4 v217, s[4:7], s92 offen offset:3072 lds
    v_mul_f32 v10, v10, v98
    v_mul_f32 v11, v11, v99
    v_cvt_pk_bf16_f32 v100, v8, v9
    v_cvt_pk_bf16_f32 v101, v10, v11
    s_add_u32 m0, s62, 81920
    s_add_u32 s59, s68, 720896
    buffer_load_dwordx4 v213, s[20:23], s59 offen lds
    v_mul_f32 v96, v186, v24
    v_mul_f32 v97, v186, v25
    v_mul_f32 v98, v186, v26
    v_mul_f32 v99, v186, v27
    buffer_load_dwordx4 v214, s[20:23], s59 offen offset:1024 lds
    v_exp_f32 v96, v96
    v_exp_f32 v97, v97
    v_exp_f32 v98, v98
    v_exp_f32 v99, v99
    buffer_load_dwordx4 v215, s[20:23], s59 offen offset:2048 lds
    v_mul_f32 v24, v24, v72
    v_mul_f32 v25, v25, v73
    v_mul_f32 v26, v26, v74
    v_mul_f32 v27, v27, v75
    buffer_load_dwordx4 v216, s[20:23], s59 offen offset:3072 lds
    v_fma_f32 v96, v96, v190, v190
    v_fma_f32 v97, v97, v190, v190
    v_fma_f32 v98, v98, v190, v190
    v_fma_f32 v99, v99, v190, v190
    s_waitcnt vmcnt(14)
    s_barrier
    s_waitcnt vmcnt(8)
    v_cmp_ne_u32 vcc, 0x01010101, v251
    s_cbranch_vccz ap_93
    v_lshrrev_b32 v252, 2, v254
    v_min_u32 v252, 28, v252
    s_add_u32 s55, s0, 2080
    s_mov_b32 s56, 262144
poll_94:
    buffer_load_dword v253, v252, s[4:7], s55 offen sc0 sc1
    s_waitcnt vmcnt(0)
    v_cmp_ne_u32 vcc, 0x01010101, v253
    s_cbranch_vccz pd_95
    s_sleep 1
    s_sub_u32 s56, s56, 1
    s_cmp_lg_u32 s56, 0
    s_cbranch_scc1 poll_94
pd_95:
ap_93:
    s_add_u32 m0, s62, 114688
    s_mov_b32 s92, 131072
    buffer_load_dwordx4 v217, s[4:7], s92 offen lds
    v_rcp_f32 v96, v96
    v_rcp_f32 v97, v97
    v_rcp_f32 v98, v98
    buffer_load_dwordx4 v217, s[4:7], s92 offen offset:1024 lds
    v_rcp_f32 v99, v99
    v_mul_f32 v24, v24, v96
    v_mul_f32 v25, v25, v97
    v_mul_f32 v26, v26, v98
    buffer_load_dwordx4 v217, s[4:7], s92 offen offset:2048 lds
    v_mul_f32 v27, v27, v99
    v_cvt_pk_bf16_f32 v102, v24, v25
    v_cvt_pk_bf16_f32 v103, v26, v27
    buffer_load_dwordx4 v217, s[4:7], s92 offen offset:3072 lds
    s_add_u32 s55, s89, 266240
    buffer_store_dwordx4 v[100:103], v254, s[4:7], s55 offen sc0 sc1
    v_mul_f32 v96, v187, v12
    v_mul_f32 v97, v187, v13
    v_mul_f32 v98, v187, v14
    s_add_u32 m0, s62, 0
    s_add_u32 s59, s68, 983040
    buffer_load_dwordx4 v213, s[20:23], s59 offen lds
    v_mul_f32 v99, v187, v15
    v_exp_f32 v96, v96
    v_exp_f32 v97, v97
    buffer_load_dwordx4 v214, s[20:23], s59 offen offset:1024 lds
    v_exp_f32 v98, v98
    v_exp_f32 v99, v99
    v_mul_f32 v12, v12, v60
    v_mul_f32 v13, v13, v61
    buffer_load_dwordx4 v215, s[20:23], s59 offen offset:2048 lds
    v_mul_f32 v14, v14, v62
    v_mul_f32 v15, v15, v63
    v_fma_f32 v96, v96, v191, v191
    buffer_load_dwordx4 v216, s[20:23], s59 offen offset:3072 lds
    v_fma_f32 v97, v97, v191, v191
    v_fma_f32 v98, v98, v191, v191
    v_fma_f32 v99, v99, v191, v191
    v_rcp_f32 v96, v96
    s_waitcnt vmcnt(13)
    s_barrier
    s_add_u32 m0, s62, 131072
    s_mov_b32 s92, 147456
    buffer_load_dwordx4 v217, s[4:7], s92 offen lds
    v_rcp_f32 v97, v97
    v_rcp_f32 v98, v98
    v_rcp_f32 v99, v99
    buffer_load_dwordx4 v217, s[4:7], s92 offen offset:1024 lds
    v_mul_f32 v12, v12, v96
    v_mul_f32 v13, v13, v97
    v_mul_f32 v14, v14, v98
    v_mul_f32 v15, v15, v99
    buffer_load_dwordx4 v217, s[4:7], s92 offen offset:2048 lds
    v_cvt_pk_bf16_f32 v104, v12, v13
    v_cvt_pk_bf16_f32 v105, v14, v15
    v_mul_f32 v96, v187, v28
    buffer_load_dwordx4 v217, s[4:7], s92 offen offset:3072 lds
    v_mul_f32 v97, v187, v29
    v_mul_f32 v98, v187, v30
    v_mul_f32 v99, v187, v31
    v_exp_f32 v96, v96
    s_add_u32 m0, s62, 16384
    s_add_u32 s59, s68, 1638400
    buffer_load_dwordx4 v213, s[20:23], s59 offen lds
    v_exp_f32 v97, v97
    v_exp_f32 v98, v98
    v_exp_f32 v99, v99
    v_mul_f32 v28, v28, v76
    buffer_load_dwordx4 v214, s[20:23], s59 offen offset:1024 lds
    v_mul_f32 v29, v29, v77
    v_mul_f32 v30, v30, v78
    v_mul_f32 v31, v31, v79
    buffer_load_dwordx4 v215, s[20:23], s59 offen offset:2048 lds
    v_fma_f32 v96, v96, v191, v191
    v_fma_f32 v97, v97, v191, v191
    v_fma_f32 v98, v98, v191, v191
    v_fma_f32 v99, v99, v191, v191
    buffer_load_dwordx4 v216, s[20:23], s59 offen offset:3072 lds
    v_rcp_f32 v96, v96
    v_rcp_f32 v97, v97
    v_rcp_f32 v98, v98
    v_rcp_f32 v99, v99
    s_waitcnt vmcnt(13)
    s_barrier
    s_add_u32 m0, s62, 98304
    s_mov_b32 s92, 163840
    buffer_load_dwordx4 v217, s[4:7], s92 offen lds
    v_mul_f32 v28, v28, v96
    v_mul_f32 v29, v29, v97
    v_mul_f32 v30, v30, v98
    buffer_load_dwordx4 v217, s[4:7], s92 offen offset:1024 lds
    v_mul_f32 v31, v31, v99
    v_cvt_pk_bf16_f32 v106, v28, v29
    v_cvt_pk_bf16_f32 v107, v30, v31
    buffer_load_dwordx4 v217, s[4:7], s92 offen offset:2048 lds
    s_add_u32 s55, s89, 268288
    buffer_store_dwordx4 v[104:107], v254, s[4:7], s55 offen sc0 sc1
    s_lshl_b32 s55, s43, 12
    s_lshl_b32 s56, s44, 3
    s_add_u32 s55, s55, s56
    s_add_u32 s55, s55, 147456
    v_add_u32 v120, s55, v254
    v_mul_f32 v96, v184, v32
    buffer_load_dwordx4 v217, s[4:7], s92 offen offset:3072 lds
    v_mul_f32 v97, v184, v33
    v_mul_f32 v98, v184, v34
    v_mul_f32 v99, v184, v35
    s_add_u32 m0, s62, 32768
    s_add_u32 s59, s68, 1900544
    buffer_load_dwordx4 v213, s[20:23], s59 offen lds
    v_exp_f32 v96, v96
    v_exp_f32 v97, v97
    v_exp_f32 v98, v98
    buffer_load_dwordx4 v214, s[20:23], s59 offen offset:1024 lds
    v_exp_f32 v99, v99
    v_mul_f32 v32, v32, v80
    v_mul_f32 v33, v33, v81
    buffer_load_dwordx4 v215, s[20:23], s59 offen offset:2048 lds
    v_mul_f32 v34, v34, v82
    v_mul_f32 v35, v35, v83
    v_fma_f32 v96, v96, v188, v188
    buffer_load_dwordx4 v216, s[20:23], s59 offen offset:3072 lds
    v_fma_f32 v97, v97, v188, v188
    v_fma_f32 v98, v98, v188, v188
    v_fma_f32 v99, v99, v188, v188
    v_rcp_f32 v96, v96
    s_waitcnt vmcnt(13)
    s_barrier
    s_add_u32 m0, s62, 114688
    s_mov_b32 s92, 180224
    buffer_load_dwordx4 v217, s[4:7], s92 offen lds
    v_rcp_f32 v97, v97
    v_rcp_f32 v98, v98
    v_rcp_f32 v99, v99
    buffer_load_dwordx4 v217, s[4:7], s92 offen offset:1024 lds
    v_mul_f32 v32, v32, v96
    v_mul_f32 v33, v33, v97
    v_mul_f32 v34, v34, v98
    v_mul_f32 v35, v35, v99
    buffer_load_dwordx4 v217, s[4:7], s92 offen offset:2048 lds
    v_cvt_pk_bf16_f32 v108, v32, v33
    v_cvt_pk_bf16_f32 v109, v34, v35
    ds_write_b64 v120, v[108:109] offset:0
    buffer_load_dwordx4 v217, s[4:7], s92 offen offset:3072 lds
    v_mul_f32 v96, v185, v36
    v_mul_f32 v97, v185, v37
    v_mul_f32 v98, v185, v38
    v_mul_f32 v99, v185, v39
    s_add_u32 m0, s62, 49152
    s_add_u32 s59, s68, 2555904
    buffer_load_dwordx4 v213, s[20:23], s59 offen lds
    v_exp_f32 v96, v96
    v_exp_f32 v97, v97
    v_exp_f32 v98, v98
    v_exp_f32 v99, v99
    buffer_load_dwordx4 v214, s[20:23], s59 offen offset:1024 lds
    v_mul_f32 v36, v36, v84
    v_mul_f32 v37, v37, v85
    v_mul_f32 v38, v38, v86
    buffer_load_dwordx4 v215, s[20:23], s59 offen offset:2048 lds
    v_mul_f32 v39, v39, v87
    v_fma_f32 v96, v96, v189, v189
    v_fma_f32 v97, v97, v189, v189
    v_fma_f32 v98, v98, v189, v189
    buffer_load_dwordx4 v216, s[20:23], s59 offen offset:3072 lds
    v_fma_f32 v99, v99, v189, v189
    v_rcp_f32 v96, v96
    v_rcp_f32 v97, v97
    v_rcp_f32 v98, v98
    s_waitcnt vmcnt(12)
    s_barrier
    s_cmp_lg_u32 s42, 0
    s_cbranch_scc1 wf_96
    s_lshr_b32 s55, s2, 5
    s_lshl_b32 s55, s55, 2
    s_add_u32 s55, s55, s0
    v_mov_b32 v252, 2112
    v_mov_b32 v253, 0x01010101
    s_mov_b64 exec, 1
    s_cmp_eq_u32 s45, 0
    s_cbranch_scc1 st_97
    buffer_store_dword v253, v252, s[4:7], s55 offen sc0 sc1
    s_branch st_98
st_97:
    buffer_store_dword v253, v252, s[4:7], s55 offen
st_98:
    s_mov_b64 exec, -1
wf_96:
    s_add_u32 m0, s62, 131072
    s_mov_b32 s92, 196608
    buffer_load_dwordx4 v217, s[4:7], s92 offen lds
    v_rcp_f32 v99, v99
    v_mul_f32 v36, v36, v96
    v_mul_f32 v37, v37, v97
    buffer_load_dwordx4 v217, s[4:7], s92 offen offset:1024 lds
    v_mul_f32 v38, v38, v98
    v_mul_f32 v39, v39, v99
    v_cvt_pk_bf16_f32 v110, v36, v37
    v_cvt_pk_bf16_f32 v111, v38, v39
    buffer_load_dwordx4 v217, s[4:7], s92 offen offset:2048 lds
    ds_write_b64 v120, v[110:111] offset:1024
    v_mul_f32 v96, v186, v40
    v_mul_f32 v97, v186, v41
    v_mul_f32 v98, v186, v42
    buffer_load_dwordx4 v217, s[4:7], s92 offen offset:3072 lds
    v_mul_f32 v99, v186, v43
    v_exp_f32 v96, v96
    v_exp_f32 v97, v97
    v_exp_f32 v98, v98
    s_add_u32 m0, s62, 65536
    s_add_u32 s59, s68, 2818048
    buffer_load_dwordx4 v213, s[20:23], s59 offen lds
    v_exp_f32 v99, v99
    v_mul_f32 v40, v40, v88
    v_mul_f32 v41, v41, v89
    v_mul_f32 v42, v42, v90
    buffer_load_dwordx4 v214, s[20:23], s59 offen offset:1024 lds
    v_mul_f32 v43, v43, v91
    v_fma_f32 v96, v96, v190, v190
    v_fma_f32 v97, v97, v190, v190
    v_fma_f32 v98, v98, v190, v190
    buffer_load_dwordx4 v215, s[20:23], s59 offen offset:2048 lds
    v_fma_f32 v99, v99, v190, v190
    v_rcp_f32 v96, v96
    v_rcp_f32 v97, v97
    v_rcp_f32 v98, v98
    buffer_load_dwordx4 v216, s[20:23], s59 offen offset:3072 lds
    v_rcp_f32 v99, v99
    v_mul_f32 v40, v40, v96
    v_mul_f32 v41, v41, v97
    v_mul_f32 v42, v42, v98
    s_waitcnt vmcnt(12)
    s_barrier
    s_add_u32 m0, s62, 98304
    s_mov_b32 s92, 212992
    buffer_load_dwordx4 v217, s[4:7], s92 offen lds
    v_mul_f32 v43, v43, v99
    v_cvt_pk_bf16_f32 v112, v40, v41
    v_cvt_pk_bf16_f32 v113, v42, v43
    ds_write_b64 v120, v[112:113] offset:2048
    buffer_load_dwordx4 v217, s[4:7], s92 offen offset:1024 lds
    v_mul_f32 v96, v187, v44
    v_mul_f32 v97, v187, v45
    v_mul_f32 v98, v187, v46
    v_mul_f32 v99, v187, v47
    buffer_load_dwordx4 v217, s[4:7], s92 offen offset:2048 lds
    v_exp_f32 v96, v96
    v_exp_f32 v97, v97
    v_exp_f32 v98, v98
    v_exp_f32 v99, v99
    buffer_load_dwordx4 v217, s[4:7], s92 offen offset:3072 lds
    v_mul_f32 v44, v44, v92
    v_mul_f32 v45, v45, v93
    v_mul_f32 v46, v46, v94
    v_mul_f32 v47, v47, v95
    s_add_u32 m0, s62, 81920
    s_add_u32 s59, s68, 3473408
    buffer_load_dwordx4 v213, s[20:23], s59 offen lds
    v_fma_f32 v96, v96, v191, v191
    v_fma_f32 v97, v97, v191, v191
    v_fma_f32 v98, v98, v191, v191
    v_fma_f32 v99, v99, v191, v191
    buffer_load_dwordx4 v214, s[20:23], s59 offen offset:1024 lds
    v_rcp_f32 v96, v96
    v_rcp_f32 v97, v97
    v_rcp_f32 v98, v98
    v_rcp_f32 v99, v99
    buffer_load_dwordx4 v215, s[20:23], s59 offen offset:2048 lds
    v_mul_f32 v44, v44, v96
    v_mul_f32 v45, v45, v97
    v_mul_f32 v46, v46, v98
    v_mul_f32 v47, v47, v99
    buffer_load_dwordx4 v216, s[20:23], s59 offen offset:3072 lds
    v_cvt_pk_bf16_f32 v114, v44, v45
    v_cvt_pk_bf16_f32 v115, v46, v47
    ds_write_b64 v120, v[114:115] offset:3072
    s_lshr_b32 s55, s62, 1
    s_add_u32 s55, s55, 147456
    v_add_u32 v121, s55, v254
    s_waitcnt vmcnt(12) lgkmcnt(0)
    s_barrier
    s_add_u32 m0, s62, 114688
    s_mov_b32 s92, 229376
    buffer_load_dwordx4 v217, s[4:7], s92 offen lds
    ds_read_b128 v[100:103], v121 offset:0
    ds_read_b128 v[104:107], v121 offset:1024
    buffer_load_dwordx4 v217, s[4:7], s92 offen offset:1024 lds
    s_waitcnt lgkmcnt(0)
    buffer_store_dwordx4 v[100:103], v254, s[4:7], s90 offen offset:0 sc0 sc1
    buffer_load_dwordx4 v217, s[4:7], s92 offen offset:2048 lds
    buffer_store_dwordx4 v[104:107], v254, s[4:7], s90 offen offset:2048 sc0 sc1
    s_cmp_eq_u32 s46, 0
    s_cselect_b32 s63, s63, 2130706432
    buffer_load_dwordx4 v217, s[4:7], s92 offen offset:3072 lds
    v_lshrrev_b32 v224, 7, v254
    v_and_b32 v225, 0x70, v254
    s_add_u32 m0, s62, 0
    s_add_u32 s59, s69, 262144
    buffer_load_dwordx4 v213, s[20:23], s59 offen lds
    v_and_b32 v226, 6, v224
    v_lshlrev_b32 v226, 4, v226
    buffer_load_dwordx4 v214, s[20:23], s59 offen offset:1024 lds
    v_xor_b32 v225, v225, v226
    v_mul_u32_u24 v224, 6144, v224
    buffer_load_dwordx4 v215, s[20:23], s59 offen offset:2048 lds
    v_add3_u32 v224, v224, v225, s63
    s_lshr_b32 s55, s61, 10
    s_add_u32 s55, s55, 0
    s_and_b32 s56, s55, 3
    s_lshl_b32 s56, s56, 3
    s_mul_i32 s56, s56, 6144
    s_lshr_b32 s55, s55, 2
    s_lshl_b32 s55, s55, 11
    s_add_u32 s55, s55, s56
    s_sub_u32 s55, s55, 0
    v_add_u32 v200, s55, v224
    buffer_load_dwordx4 v216, s[20:23], s59 offen offset:3072 lds
    s_lshr_b32 s55, s61, 10
    s_add_u32 s55, s55, 1
    s_and_b32 s56, s55, 3
    s_lshl_b32 s56, s56, 3
    s_mul_i32 s56, s56, 6144
    s_lshr_b32 s55, s55, 2
    s_lshl_b32 s55, s55, 11
    s_add_u32 s55, s55, s56
    s_sub_u32 s55, s55, 1024
    v_add_u32 v201, s55, v224
    s_lshr_b32 s55, s61, 10
    s_add_u32 s55, s55, 2
    s_and_b32 s56, s55, 3
    s_lshl_b32 s56, s56, 3
    s_mul_i32 s56, s56, 6144
    s_lshr_b32 s55, s55, 2
    s_lshl_b32 s55, s55, 11
    s_add_u32 s55, s55, s56
    s_sub_u32 s55, s55, 2048
    v_add_u32 v202, s55, v224
    s_waitcnt vmcnt(14)
    s_barrier
    v_lshrrev_b32 v252, 2, v254
    v_min_u32 v252, 28, v252
    s_add_u32 s55, s0, 2112
    buffer_load_dword v251, v252, s[4:7], s55 offen sc0 sc1
    s_add_u32 m0, s62, 131072
    s_mov_b32 s92, 245760
    buffer_load_dwordx4 v217, s[4:7], s92 offen lds
    buffer_load_dwordx4 v217, s[4:7], s92 offen offset:1024 lds
    buffer_load_dwordx4 v217, s[4:7], s92 offen offset:2048 lds
    buffer_load_dwordx4 v217, s[4:7], s92 offen offset:3072 lds
    s_add_u32 m0, s62, 16384
    s_add_u32 s59, s69, 524288
    buffer_load_dwordx4 v213, s[20:23], s59 offen lds
    buffer_load_dwordx4 v214, s[20:23], s59 offen offset:1024 lds
    buffer_load_dwordx4 v215, s[20:23], s59 offen offset:2048 lds
    buffer_load_dwordx4 v216, s[20:23], s59 offen offset:3072 lds
    s_waitcnt vmcnt(13)
    s_barrier
    s_cmp_lg_u32 s42, 1
    s_cbranch_scc1 wf_99
    s_lshr_b32 s55, s2, 5
    s_lshl_b32 s55, s55, 2
    s_add_u32 s55, s55, s0
    v_mov_b32 v252, 2144
    v_mov_b32 v253, 0x01010101
    s_mov_b64 exec, 1
    s_cmp_eq_u32 s45, 0
    s_cbranch_scc1 st_100
    buffer_store_dword v253, v252, s[4:7], s55 offen sc0 sc1
    s_branch st_101
st_100:
    buffer_store_dword v253, v252, s[4:7], s55 offen
st_101:
    s_mov_b64 exec, -1
wf_99:
    s_waitcnt vmcnt(8)
    v_cmp_ne_u32 vcc, 0x01010101, v251
    s_cbranch_vccz ap_102
    v_lshrrev_b32 v252, 2, v254
    v_min_u32 v252, 28, v252
    s_add_u32 s55, s0, 2112
    s_mov_b32 s56, 262144
poll_103:
    buffer_load_dword v253, v252, s[4:7], s55 offen sc0 sc1
    s_waitcnt vmcnt(0)
    v_cmp_ne_u32 vcc, 0x01010101, v253
    s_cbranch_vccz pd_104
    s_sleep 1
    s_sub_u32 s56, s56, 1
    s_cmp_lg_u32 s56, 0
    s_cbranch_scc1 poll_103
pd_104:
ap_102:
    s_add_u32 m0, s62, 98304
    s_mov_b32 s92, 262144
    buffer_load_dwordx4 v217, s[4:7], s92 offen lds
    buffer_load_dwordx4 v217, s[4:7], s92 offen offset:1024 lds
    buffer_load_dwordx4 v217, s[4:7], s92 offen offset:2048 lds
    buffer_load_dwordx4 v217, s[4:7], s92 offen offset:3072 lds
    s_add_u32 m0, s62, 32768
    s_add_u32 s59, s69, 1179648
    buffer_load_dwordx4 v213, s[20:23], s59 offen lds
    buffer_load_dwordx4 v214, s[20:23], s59 offen offset:1024 lds
    buffer_load_dwordx4 v215, s[20:23], s59 offen offset:2048 lds
    buffer_load_dwordx4 v216, s[20:23], s59 offen offset:3072 lds
    s_waitcnt vmcnt(12)
    s_barrier
    s_add_u32 m0, s62, 114688
    s_mov_b32 s92, 278528
    buffer_load_dwordx4 v217, s[4:7], s92 offen lds
    buffer_load_dwordx4 v217, s[4:7], s92 offen offset:1024 lds
    buffer_load_dwordx4 v217, s[4:7], s92 offen offset:2048 lds
    buffer_load_dwordx4 v217, s[4:7], s92 offen offset:3072 lds
    s_add_u32 m0, s62, 49152
    s_add_u32 s59, s69, 1441792
    buffer_load_dwordx4 v213, s[20:23], s59 offen lds
    buffer_load_dwordx4 v214, s[20:23], s59 offen offset:1024 lds
    buffer_load_dwordx4 v215, s[20:23], s59 offen offset:2048 lds
    buffer_load_dwordx4 v216, s[20:23], s59 offen offset:3072 lds
    s_waitcnt vmcnt(12)
    s_barrier
    s_add_u32 m0, s62, 131072
    s_mov_b32 s92, 294912
    buffer_load_dwordx4 v217, s[4:7], s92 offen lds
    buffer_load_dwordx4 v217, s[4:7], s92 offen offset:1024 lds
    buffer_load_dwordx4 v217, s[4:7], s92 offen offset:2048 lds
    buffer_load_dwordx4 v217, s[4:7], s92 offen offset:3072 lds
    s_add_u32 m0, s62, 65536
    s_add_u32 s59, s69, 2097152
    buffer_load_dwordx4 v213, s[20:23], s59 offen lds
    buffer_load_dwordx4 v214, s[20:23], s59 offen offset:1024 lds
    buffer_load_dwordx4 v215, s[20:23], s59 offen offset:2048 lds
    buffer_load_dwordx4 v216, s[20:23], s59 offen offset:3072 lds
    s_waitcnt vmcnt(12)
    s_barrier
    s_add_u32 m0, s62, 98304
    s_mov_b32 s92, 311296
    buffer_load_dwordx4 v217, s[4:7], s92 offen lds
    buffer_load_dwordx4 v217, s[4:7], s92 offen offset:1024 lds
    buffer_load_dwordx4 v217, s[4:7], s92 offen offset:2048 lds
    buffer_load_dwordx4 v217, s[4:7], s92 offen offset:3072 lds
    s_add_u32 m0, s62, 81920
    s_add_u32 s59, s69, 2359296
    buffer_load_dwordx4 v213, s[20:23], s59 offen lds
    buffer_load_dwordx4 v214, s[20:23], s59 offen offset:1024 lds
    buffer_load_dwordx4 v215, s[20:23], s59 offen offset:2048 lds
    buffer_load_dwordx4 v216, s[20:23], s59 offen offset:3072 lds
    s_waitcnt vmcnt(12)
    s_barrier
    s_add_u32 m0, s62, 114688
    s_mov_b32 s92, 327680
    buffer_load_dwordx4 v217, s[4:7], s92 offen lds
    buffer_load_dwordx4 v217, s[4:7], s92 offen offset:1024 lds
    buffer_load_dwordx4 v217, s[4:7], s92 offen offset:2048 lds
    buffer_load_dwordx4 v217, s[4:7], s92 offen offset:3072 lds
    s_add_u32 m0, s62, 0
    s_add_u32 s59, s69, 3014656
    buffer_load_dwordx4 v213, s[20:23], s59 offen lds
    buffer_load_dwordx4 v214, s[20:23], s59 offen offset:1024 lds
    buffer_load_dwordx4 v215, s[20:23], s59 offen offset:2048 lds
    buffer_load_dwordx4 v216, s[20:23], s59 offen offset:3072 lds
    s_waitcnt vmcnt(12)
    s_barrier
    s_add_u32 m0, s62, 131072
    s_mov_b32 s92, 344064
    buffer_load_dwordx4 v217, s[4:7], s92 offen lds
    buffer_load_dwordx4 v217, s[4:7], s92 offen offset:1024 lds
    buffer_load_dwordx4 v217, s[4:7], s92 offen offset:2048 lds
    buffer_load_dwordx4 v217, s[4:7], s92 offen offset:3072 lds
    s_add_u32 m0, s62, 16384
    s_add_u32 s59, s69, 3276800
    buffer_load_dwordx4 v213, s[20:23], s59 offen lds
    buffer_load_dwordx4 v214, s[20:23], s59 offen offset:1024 lds
    buffer_load_dwordx4 v215, s[20:23], s59 offen offset:2048 lds
    buffer_load_dwordx4 v216, s[20:23], s59 offen offset:3072 lds
    s_waitcnt vmcnt(12)
    s_barrier
    s_add_u32 m0, s62, 98304
    s_mov_b32 s92, 360448
    buffer_load_dwordx4 v217, s[4:7], s92 offen lds
    buffer_load_dwordx4 v217, s[4:7], s92 offen offset:1024 lds
    buffer_load_dwordx4 v217, s[4:7], s92 offen offset:2048 lds
    buffer_load_dwordx4 v217, s[4:7], s92 offen offset:3072 lds
    s_add_u32 m0, s62, 32768
    s_add_u32 s59, s69, 393216
    buffer_load_dwordx4 v213, s[20:23], s59 offen lds
    buffer_load_dwordx4 v214, s[20:23], s59 offen offset:1024 lds
    buffer_load_dwordx4 v215, s[20:23], s59 offen offset:2048 lds
    buffer_load_dwordx4 v216, s[20:23], s59 offen offset:3072 lds
    s_waitcnt vmcnt(12)
    s_barrier
    v_lshrrev_b32 v252, 2, v254
    v_min_u32 v252, 28, v252
    s_add_u32 s55, s0, 2144
    buffer_load_dword v251, v252, s[4:7], s55 offen sc0 sc1
    s_add_u32 m0, s62, 114688
    s_mov_b32 s92, 376832
    buffer_load_dwordx4 v217, s[4:7], s92 offen lds
    buffer_load_dwordx4 v217, s[4:7], s92 offen offset:1024 lds
    buffer_load_dwordx4 v217, s[4:7], s92 offen offset:2048 lds
    buffer_load_dwordx4 v217, s[4:7], s92 offen offset:3072 lds
    s_add_u32 m0, s62, 49152
    s_add_u32 s59, s69, 1310720
    buffer_load_dwordx4 v213, s[20:23], s59 offen lds
    buffer_load_dwordx4 v214, s[20:23], s59 offen offset:1024 lds
    buffer_load_dwordx4 v215, s[20:23], s59 offen offset:2048 lds
    buffer_load_dwordx4 v216, s[20:23], s59 offen offset:3072 lds
    s_waitcnt vmcnt(13)
    s_barrier
    s_waitcnt vmcnt(8)
    v_cmp_ne_u32 vcc, 0x01010101, v251
    s_cbranch_vccz ap_105
    v_lshrrev_b32 v252, 2, v254
    v_min_u32 v252, 28, v252
    s_add_u32 s55, s0, 2144
    s_mov_b32 s56, 262144
poll_106:
    buffer_load_dword v253, v252, s[4:7], s55 offen sc0 sc1
    s_waitcnt vmcnt(0)
    v_cmp_ne_u32 vcc, 0x01010101, v253
    s_cbranch_vccz pd_107
    s_sleep 1
    s_sub_u32 s56, s56, 1
    s_cmp_lg_u32 s56, 0
    s_cbranch_scc1 poll_106
pd_107:
ap_105:
    s_add_u32 m0, s62, 131072
    s_mov_b32 s92, 393216
    buffer_load_dwordx4 v217, s[4:7], s92 offen lds
    buffer_load_dwordx4 v217, s[4:7], s92 offen offset:1024 lds
    buffer_load_dwordx4 v217, s[4:7], s92 offen offset:2048 lds
    buffer_load_dwordx4 v217, s[4:7], s92 offen offset:3072 lds
    s_add_u32 m0, s62, 65536
    s_add_u32 s59, s69, 2228224
    buffer_load_dwordx4 v213, s[20:23], s59 offen lds
    buffer_load_dwordx4 v214, s[20:23], s59 offen offset:1024 lds
    buffer_load_dwordx4 v215, s[20:23], s59 offen offset:2048 lds
    buffer_load_dwordx4 v216, s[20:23], s59 offen offset:3072 lds
    s_waitcnt vmcnt(12)
    s_barrier
    s_add_u32 m0, s62, 98304
    s_mov_b32 s92, 409600
    buffer_load_dwordx4 v217, s[4:7], s92 offen lds
    buffer_load_dwordx4 v217, s[4:7], s92 offen offset:1024 lds
    buffer_load_dwordx4 v217, s[4:7], s92 offen offset:2048 lds
    buffer_load_dwordx4 v217, s[4:7], s92 offen offset:3072 lds
    s_add_u32 m0, s62, 81920
    s_add_u32 s59, s69, 3145728
    buffer_load_dwordx4 v213, s[20:23], s59 offen lds
    buffer_load_dwordx4 v214, s[20:23], s59 offen offset:1024 lds
    buffer_load_dwordx4 v215, s[20:23], s59 offen offset:2048 lds
    buffer_load_dwordx4 v216, s[20:23], s59 offen offset:3072 lds
    s_waitcnt vmcnt(12)
    s_barrier
    s_add_u32 m0, s62, 114688
    s_mov_b32 s92, 425984
    buffer_load_dwordx4 v217, s[4:7], s92 offen lds
    buffer_load_dwordx4 v217, s[4:7], s92 offen offset:1024 lds
    buffer_load_dwordx4 v217, s[4:7], s92 offen offset:2048 lds
    buffer_load_dwordx4 v217, s[4:7], s92 offen offset:3072 lds
    s_lshl_b32 s93, s51, 12
    s_add_u32 m0, s61, 0
    s_mul_i32 s59, s93, 96
    buffer_load_dwordx4 v200, s[8:11], s59 offen lds
    buffer_load_dwordx4 v201, s[8:11], s59 offen offset:1024 lds
    buffer_load_dwordx4 v202, s[8:11], s59 offen offset:2048 lds
    s_add_u32 s93, s93, 2048
    s_and_b32 s93, s93, 65535
    s_waitcnt vmcnt(11)
    s_barrier
    s_add_u32 m0, s62, 131072
    s_mov_b32 s92, 442368
    buffer_load_dwordx4 v217, s[4:7], s92 offen lds
    buffer_load_dwordx4 v217, s[4:7], s92 offen offset:1024 lds
    buffer_load_dwordx4 v217, s[4:7], s92 offen offset:2048 lds
    buffer_load_dwordx4 v217, s[4:7], s92 offen offset:3072 lds
    s_add_u32 m0, s61, 16384
    s_mul_i32 s59, s93, 96
    buffer_load_dwordx4 v200, s[8:11], s59 offen lds
    buffer_load_dwordx4 v201, s[8:11], s59 offen offset:1024 lds
    buffer_load_dwordx4 v202, s[8:11], s59 offen offset:2048 lds
    s_add_u32 s93, s93, 6144
    s_and_b32 s93, s93, 65535
    s_waitcnt vmcnt(10)
    s_barrier
    s_add_u32 m0, s61, 32768
    s_mul_i32 s59, s93, 96
    buffer_load_dwordx4 v200, s[8:11], s59 offen lds
    buffer_load_dwordx4 v201, s[8:11], s59 offen offset:1024 lds
    buffer_load_dwordx4 v202, s[8:11], s59 offen offset:2048 lds
    s_add_u32 s93, s93, 2048
    s_and_b32 s93, s93, 65535
    s_add_u32 m0, s61, 49152
    s_mul_i32 s59, s93, 96
    buffer_load_dwordx4 v200, s[8:11], s59 offen lds
    buffer_load_dwordx4 v201, s[8:11], s59 offen offset:1024 lds
    buffer_load_dwordx4 v202, s[8:11], s59 offen offset:2048 lds
    s_add_u32 s93, s93, 6144
    s_and_b32 s93, s93, 65535
    s_waitcnt vmcnt(9)
    s_barrier
    s_add_u32 m0, s61, 65536
    s_mul_i32 s59, s93, 96
    buffer_load_dwordx4 v200, s[8:11], s59 offen lds
    buffer_load_dwordx4 v201, s[8:11], s59 offen offset:1024 lds
    buffer_load_dwordx4 v202, s[8:11], s59 offen offset:2048 lds
    s_add_u32 s93, s93, 2048
    s_and_b32 s93, s93, 65535
    s_barrier
    s_add_u32 m0, s61, 81920
    s_mul_i32 s59, s93, 96
    buffer_load_dwordx4 v200, s[8:11], s59 offen lds
    buffer_load_dwordx4 v201, s[8:11], s59 offen offset:1024 lds
    buffer_load_dwordx4 v202, s[8:11], s59 offen offset:2048 lds
    s_add_u32 s93, s93, 6144
    s_and_b32 s93, s93, 65535
    s_setprio 0
    s_cmp_lg_u32 s46, 0
    s_cbranch_scc1 K_end
    s_lshl_b32 s60, s43, 23
    s_add_u32 s60, s60, 83886336
    s_add_u32 s55, s4, s60
    s_addc_u32 s56, s5, 0
    s_lshr_b32 s57, 5280, s41
    s_and_b32 s57, s57, 1
    s_cselect_b32 s28, s55, s16
    s_cselect_b32 s29, s56, s17
    s_mov_b32 s30, 7340032
    s_mov_b32 s31, 0x00020000
    s_mov_b32 s46, 1
    s_add_u32 s47, s47, 262144
    s_add_u32 s49, s49, 524288
    s_add_u32 s50, s50, 917504
    s_add_u32 s52, s52, 65536
    s_add_u32 s54, s54, 32768
    s_add_u32 s0, s0, 32768
    s_branch Y_layer
K_end:
    s_endpgm

.section .rodata,"a"
.p2align 6
.amdhsa_kernel interleave_layers__sliding_local_dilated__glu_gated_swiglu__prompt_kernel
  .amdhsa_next_free_vgpr 256
  .amdhsa_next_free_sgpr 102
  .amdhsa_accum_offset 256
  .amdhsa_group_segment_fixed_size 0
  .amdhsa_kernarg_size 80
  .amdhsa_user_sgpr_count 2
  .amdhsa_user_sgpr_kernarg_segment_ptr 1
  .amdhsa_system_sgpr_workgroup_id_x 1
.end_amdhsa_kernel
```

```asm
; @launch grid=(256,1,1) block=(512,1,1) lds=163840
.amdgcn_target "amdgcn-amd-amdhsa--gfx950"
.text
.globl interleave_layers__sliding_local_dilated__glu_gated_swiglu__prompt_kernel
.p2align 8
.type interleave_layers__sliding_local_dilated__glu_gated_swiglu__prompt_kernel,@function
interleave_layers__sliding_local_dilated__glu_gated_swiglu__prompt_kernel:
    s_cmp_ge_u32 s2, 256
    s_cbranch_scc0 K_go
    s_endpgm
K_go:
    s_load_dwordx4 s[72:75], s[0:1], 0
    s_load_dwordx2 s[76:77], s[0:1], 16
    s_load_dwordx8 s[80:87], s[0:1], 32
    s_load_dwordx4 s[88:91], s[0:1], 64
    v_lshrrev_b32 v1, 6, v0
    v_and_b32 v254, 63, v0
    v_readfirstlane_b32 s3, v1
    v_lshlrev_b32 v254, 4, v254
    s_and_b32 s55, s2, 6
    s_lshl_b32 s55, s55, 1
    s_lshr_b32 s56, s2, 3
    s_and_b32 s56, s56, 3
    s_add_u32 s40, s55, s56
    s_and_b32 s55, s2, 1
    s_lshr_b32 s56, s2, 5
    s_lshl_b32 s41, s55, 3
    s_add_u32 s41, s41, s56
    s_lshl_b32 s51, s56, 1
    s_add_u32 s51, s51, s55
    s_and_b32 s42, s3, 3
    s_and_b32 s43, s3, 1
    s_lshr_b32 s44, s42, 1
    s_lshl_b32 s55, s43, 1
    s_add_u32 s55, s55, s44
    s_mul_i32 s61, s55, 3072
    s_lshl_b32 s62, s55, 12
    s_mov_b32 s45, 1
    s_mov_b32 s46, 0
    s_lshl_b32 s47, s40, 22
    s_add_u32 s49, s47, 524288
    s_add_u32 s48, s47, 786432
    s_add_u32 s50, s47, 2097152
    s_add_u32 s52, s47, 1835008
    s_add_u32 s53, s52, 32768
    s_lshl_b32 s54, s40, 7
    s_add_u32 s54, s54, 71303168
    s_lshl_b32 s63, s51, 7
    s_lshl_b32 s55, s44, 16
    s_add_u32 s64, s63, s55
    s_mul_i32 s55, s44, 114688
    s_mul_i32 s56, s41, 448
    s_add_u32 s55, s55, s56
    s_and_b32 s56, s41, 1
    s_mul_i32 s56, s56, 192
    s_add_u32 s65, s55, s56
    s_sub_u32 s66, s55, s56
    s_add_u32 s66, s66, 256
    s_lshl_b32 s55, s43, 4
    s_add_u32 s55, s55, s41
    s_lshl_b32 s55, s55, 6
    s_add_u32 s55, s55, s44
    s_lshl_b32 s55, s55, 10
    s_add_u32 s67, s55, 67106816
    s_and_b32 s55, s51, 1
    s_mul_i32 s55, s55, 3670016
    s_lshr_b32 s56, s51, 1
    s_lshl_b32 s56, s56, 8
    s_add_u32 s55, s55, s56
    s_lshl_b32 s56, s44, 15
    s_add_u32 s55, s55, s56
    s_lshl_b32 s56, s43, 16
    s_add_u32 s69, s55, s56
    s_add_u32 s68, s69, s56
    s_waitcnt lgkmcnt(0)
    s_mov_b32 s8, s74
    s_mov_b32 s9, s75
    s_mov_b32 s10, 6291456
    s_mov_b32 s11, 0x00020000
    s_mov_b32 s36, s72
    s_mov_b32 s37, s73
    s_mov_b32 s38, 4194304
    s_mov_b32 s39, 0x00020000
    s_mov_b32 s4, s90
    s_mov_b32 s5, s91
    s_mov_b32 s6, 268435456
    s_mov_b32 s7, 0x00020000
    s_mov_b32 s24, s72
    s_mov_b32 s25, s73
    s_mov_b32 s26, 4194304
    s_mov_b32 s27, 0x00020000
    s_mov_b32 s12, s76
    s_mov_b32 s13, s77
    s_mov_b32 s14, 2097152
    s_mov_b32 s15, 0x00020000
    s_cmp_eq_u32 s43, 0
    s_cselect_b32 s16, s80, s82
    s_cselect_b32 s17, s81, s83
    s_mov_b32 s18, 7340032
    s_mov_b32 s19, 0x00020000
    s_mov_b32 s20, s84
    s_mov_b32 s21, s85
    s_mov_b32 s22, 7340032
    s_mov_b32 s23, 0x00020000
    s_mov_b32 s28, s86
    s_mov_b32 s29, s87
    s_mov_b32 s30, 4194304
    s_mov_b32 s31, 0x00020000
    s_mov_b32 s32, s88
    s_mov_b32 s33, s89
    s_mov_b32 s34, 256
    s_mov_b32 s35, 0x00020000
    s_and_b32 s55, s2, 1
    s_lshl_b32 s55, s55, 13
    s_add_u32 s55, s55, 16384
    s_add_u32 s0, s54, s55
    s_lshl_b32 s55, s51, 14
    s_lshl_b32 s56, s43, 13
    s_add_u32 s55, s55, s56
    s_lshl_b32 s56, s44, 10
    s_add_u32 s1, s55, s56
    s_cmp_lt_u32 s3, 4
    s_cbranch_scc1 X_start
    v_lshrrev_b32 v224, 7, v254
    v_and_b32 v225, 0x70, v254
    v_and_b32 v226, 6, v224
    v_lshlrev_b32 v226, 4, v226
    v_xor_b32 v225, v225, v226
    v_and_b32 v226, 4, v224
    v_add_u32 v224, v224, v226
    v_mul_u32_u24 v224, 6144, v224
    v_add3_u32 v224, v224, v225, s63
    s_lshr_b32 s55, s61, 10
    s_add_u32 s55, s55, 0
    s_and_b32 s56, s55, 3
    s_and_b32 s57, s56, 1
    s_lshl_b32 s57, s57, 4
    s_and_b32 s56, s56, 2
    s_lshl_b32 s56, s56, 1
    s_add_u32 s56, s56, s57
    s_mul_i32 s56, s56, 6144
    s_lshr_b32 s55, s55, 2
    s_lshl_b32 s55, s55, 11
    s_add_u32 s55, s55, s56
    s_sub_u32 s55, s55, 0
    v_add_u32 v200, s55, v224
    s_lshr_b32 s55, s61, 10
    s_add_u32 s55, s55, 1
    s_and_b32 s56, s55, 3
    s_and_b32 s57, s56, 1
    s_lshl_b32 s57, s57, 4
    s_and_b32 s56, s56, 2
    s_lshl_b32 s56, s56, 1
    s_add_u32 s56, s56, s57
    s_mul_i32 s56, s56, 6144
    s_lshr_b32 s55, s55, 2
    s_lshl_b32 s55, s55, 11
    s_add_u32 s55, s55, s56
    s_sub_u32 s55, s55, 1024
    v_add_u32 v201, s55, v224
    s_lshr_b32 s55, s61, 10
    s_add_u32 s55, s55, 2
    s_and_b32 s56, s55, 3
    s_and_b32 s57, s56, 1
    s_lshl_b32 s57, s57, 4
    s_and_b32 s56, s56, 2
    s_lshl_b32 s56, s56, 1
    s_add_u32 s56, s56, s57
    s_mul_i32 s56, s56, 6144
    s_lshr_b32 s55, s55, 2
    s_lshl_b32 s55, s55, 11
    s_add_u32 s55, s55, s56
    s_sub_u32 s55, s55, 2048
    v_add_u32 v202, s55, v224
    s_and_b32 s55, s40, 4
    s_lshl_b32 s55, s55, 1
    s_lshr_b32 s56, s40, 3
    s_add_u32 s55, s55, s56
    s_add_u32 s92, s55, s51
    s_and_b32 s92, s92, 15
    s_lshl_b32 s93, s92, 12
    s_add_u32 m0, s61, 0
    s_mul_i32 s59, s93, 96
    buffer_load_dwordx4 v200, s[8:11], s59 offen lds
    buffer_load_dwordx4 v201, s[8:11], s59 offen offset:1024 lds
    buffer_load_dwordx4 v202, s[8:11], s59 offen offset:2048 lds
    s_add_u32 s93, s93, 2048
    s_and_b32 s93, s93, 65535
    s_lshl_b32 s55, s40, 18
    s_lshl_b32 s56, s62, 4
    s_add_u32 s88, s55, s56
    s_lshl_b32 s56, s43, 14
    s_add_u32 s89, s55, s56
    s_sub_u32 s89, s89, 32768
    v_lshrrev_b32 v224, 7, v254
    v_and_b32 v225, 0x70, v254
    v_and_b32 v226, 6, v224
    v_lshlrev_b32 v226, 4, v226
    v_xor_b32 v225, v225, v226
    v_mul_u32_u24 v224, 2048, v224
    v_add3_u32 v217, v224, v225, s88
    v_add_u32 v218, 15360, v217
    v_add_u32 v219, 30720, v217
    v_add_u32 v220, 46080, v217
    s_lshl_b32 s94, s92, 7
    s_cmp_eq_u32 s40, 0
    s_cselect_b32 s89, 2130706432, s89
    s_sub_u32 s89, s89, s88
    v_add_u32 v221, s89, v217
    s_lshl_b32 s91, s43, 10
    s_cmp_eq_u32 s44, 0
    s_cselect_b32 s84, -1, 0
    s_not_b32 s85, s84
    s_add_u32 m0, s91, 98304
    s_mov_b64 exec, s[84:85]
    buffer_load_dwordx4 v221, s[36:39], s94 offen lds
    s_mov_b64 exec, -1
    s_add_u32 m0, s62, 100352
    s_nop 0
    buffer_load_dwordx4 v217, s[36:39], s94 offen lds
    buffer_load_dwordx4 v218, s[36:39], s94 offen offset:1024 lds
    buffer_load_dwordx4 v219, s[36:39], s94 offen offset:2048 lds
    buffer_load_dwordx4 v220, s[36:39], s94 offen offset:3072 lds
    s_add_u32 s94, s94, 256
    s_and_b32 s94, s94, 2047
    s_add_u32 m0, s61, 16384
    s_mul_i32 s59, s93, 96
    buffer_load_dwordx4 v200, s[8:11], s59 offen lds
    buffer_load_dwordx4 v201, s[8:11], s59 offen offset:1024 lds
    buffer_load_dwordx4 v202, s[8:11], s59 offen offset:2048 lds
    s_add_u32 s93, s93, 6144
    s_and_b32 s93, s93, 65535
    s_add_u32 m0, s91, 116736
    s_mov_b64 exec, s[84:85]
    buffer_load_dwordx4 v221, s[36:39], s94 offen lds
    s_mov_b64 exec, -1
    s_add_u32 m0, s62, 118784
    s_nop 0
    buffer_load_dwordx4 v217, s[36:39], s94 offen lds
    buffer_load_dwordx4 v218, s[36:39], s94 offen offset:1024 lds
    buffer_load_dwordx4 v219, s[36:39], s94 offen offset:2048 lds
    buffer_load_dwordx4 v220, s[36:39], s94 offen offset:3072 lds
    s_add_u32 s94, s94, 256
    s_and_b32 s94, s94, 2047
    s_add_u32 m0, s61, 32768
    s_mul_i32 s59, s93, 96
    buffer_load_dwordx4 v200, s[8:11], s59 offen lds
    buffer_load_dwordx4 v201, s[8:11], s59 offen offset:1024 lds
    buffer_load_dwordx4 v202, s[8:11], s59 offen offset:2048 lds
    s_add_u32 s93, s93, 2048
    s_and_b32 s93, s93, 65535
    s_cmp_lt_u32 s2, 128
    s_cselect_b32 s72, s80, s82
    s_cselect_b32 s73, s81, s83
    s_mov_b32 s74, 7340032
    s_mov_b32 s75, 0x00020000
    s_and_b32 s55, s2, 127
    s_mul_i32 s55, s55, 57344
    s_lshl_b32 s56, s42, 14
    s_add_u32 s55, s55, s56
    v_lshlrev_b32 v227, 3, v254
    buffer_load_dword v251, v227, s[72:75], s55 offen
    s_cmp_eq_u32 s42, 3
    s_cbranch_scc1 t_1
    s_add_u32 s55, s55, 8192
    buffer_load_dword v251, v227, s[72:75], s55 offen
    s_branch t_2
t_1:
    s_lshl_b32 s55, s2, 13
    buffer_load_dword v251, v227, s[12:15], s55 offen
t_2:
    s_add_u32 m0, s91, 135168
    s_mov_b64 exec, s[84:85]
    buffer_load_dwordx4 v221, s[36:39], s94 offen lds
    s_mov_b64 exec, -1
    s_add_u32 m0, s62, 137216
    s_nop 0
    buffer_load_dwordx4 v217, s[36:39], s94 offen lds
    buffer_load_dwordx4 v218, s[36:39], s94 offen offset:1024 lds
    buffer_load_dwordx4 v219, s[36:39], s94 offen offset:2048 lds
    buffer_load_dwordx4 v220, s[36:39], s94 offen offset:3072 lds
    s_add_u32 s94, s94, 256
    s_and_b32 s94, s94, 2047
    s_add_u32 m0, s61, 49152
    s_mul_i32 s59, s93, 96
    buffer_load_dwordx4 v200, s[8:11], s59 offen lds
    buffer_load_dwordx4 v201, s[8:11], s59 offen offset:1024 lds
    buffer_load_dwordx4 v202, s[8:11], s59 offen offset:2048 lds
    s_add_u32 s93, s93, 6144
    s_and_b32 s93, s93, 65535
    s_add_u32 s55, s62, 100352
    v_add_u32 v224, s55, v254
    v_mov_b32 v225, 0x3f803f80
    s_waitcnt vmcnt(21)
    ds_read_b128 v[144:147], v224 offset:0
    ds_read_b128 v[148:151], v224 offset:1024
    ds_read_b128 v[152:155], v224 offset:2048
    ds_read_b128 v[156:159], v224 offset:3072
    s_waitcnt lgkmcnt(0)
    v_dot2_f32_bf16 v160, v144, v225, 0
    v_dot2_f32_bf16 v161, v144, v144, 0
    v_dot2_f32_bf16 v162, v148, v225, 0
    v_dot2_f32_bf16 v163, v148, v148, 0
    v_dot2_f32_bf16 v164, v152, v225, 0
    v_dot2_f32_bf16 v165, v152, v152, 0
    v_dot2_f32_bf16 v166, v156, v225, 0
    v_dot2_f32_bf16 v167, v156, v156, 0
    v_dot2_f32_bf16 v160, v145, v225, v160
    v_dot2_f32_bf16 v161, v145, v145, v161
    v_dot2_f32_bf16 v162, v149, v225, v162
    v_dot2_f32_bf16 v163, v149, v149, v163
    v_dot2_f32_bf16 v164, v153, v225, v164
    v_dot2_f32_bf16 v165, v153, v153, v165
    v_dot2_f32_bf16 v166, v157, v225, v166
    v_dot2_f32_bf16 v167, v157, v157, v167
    v_dot2_f32_bf16 v160, v146, v225, v160
    v_dot2_f32_bf16 v161, v146, v146, v161
    v_dot2_f32_bf16 v162, v150, v225, v162
    v_dot2_f32_bf16 v163, v150, v150, v163
    v_dot2_f32_bf16 v164, v154, v225, v164
    v_dot2_f32_bf16 v165, v154, v154, v165
    v_dot2_f32_bf16 v166, v158, v225, v166
    v_dot2_f32_bf16 v167, v158, v158, v167
    v_dot2_f32_bf16 v160, v147, v225, v160
    v_dot2_f32_bf16 v161, v147, v147, v161
    v_dot2_f32_bf16 v162, v151, v225, v162
    v_dot2_f32_bf16 v163, v151, v151, v163
    v_dot2_f32_bf16 v164, v155, v225, v164
    v_dot2_f32_bf16 v165, v155, v155, v165
    v_dot2_f32_bf16 v166, v159, v225, v166
    v_dot2_f32_bf16 v167, v159, v159, v167
    s_add_u32 m0, s61, 65536
    s_mul_i32 s59, s93, 96
    buffer_load_dwordx4 v200, s[8:11], s59 offen lds
    buffer_load_dwordx4 v201, s[8:11], s59 offen offset:1024 lds
    buffer_load_dwordx4 v202, s[8:11], s59 offen offset:2048 lds
    s_add_u32 s93, s93, 2048
    s_and_b32 s93, s93, 65535
    s_add_u32 m0, s61, 81920
    s_mul_i32 s59, s93, 96
    buffer_load_dwordx4 v200, s[8:11], s59 offen lds
    buffer_load_dwordx4 v201, s[8:11], s59 offen offset:1024 lds
    buffer_load_dwordx4 v202, s[8:11], s59 offen offset:2048 lds
    s_add_u32 s93, s93, 6144
    s_and_b32 s93, s93, 65535
    s_branch Y_first
X_start:
    s_cmp_lg_u32 s42, 0
    s_cbranch_scc1 xz_5
    v_mov_b32 v103, 0
    v_lshrrev_b32 v100, 2, v254
    s_lshl_b32 s55, s2, 8
    s_add_u32 s55, s55, 71303168
    buffer_store_dword v103, v100, s[4:7], s55 offen sc0 sc1
    v_lshlrev_b32 v100, 6, v254
    s_lshl_b32 s55, s2, 2
    s_add_u32 s55, s55, 71565312
    s_mov_b64 exec, 15
    buffer_store_dword v103, v100, s[4:7], s55 offen sc0 sc1
    s_mov_b64 exec, -1
xz_5:
    s_getpc_b64 s[72:73]
K_pc:
    s_mov_b32 s74, K_end-K_pc
    s_mov_b32 s75, 0x00020000
    s_lshr_b32 s55, s2, 3
    s_lshl_b32 s55, s55, 2
    s_add_u32 s55, s55, s42
    s_lshl_b32 s55, s55, 10
    v_lshlrev_b32 v100, 3, v254
    s_mov_b64 exec, 0xff
    buffer_load_dword v235, v100, s[72:75], s55 offen
    s_mov_b64 exec, -1
    s_cmp_lg_u32 s42, 0
    s_cbranch_scc1 xz_6
    s_getreg_b32 s59, hwreg(HW_REG_XCC_ID, 0, 4)
    s_mul_i32 s55, s59, s59
    s_lshl_b32 s55, s55, 15
    s_lshl_b32 s59, s59, 6
    s_add_u32 s59, s59, s55
    s_add_u32 s59, s59, 1
    v_mov_b32 v253, s59
    s_and_b32 s55, s2, 7
    s_lshl_b32 s55, s55, 5
    v_mov_b32 v252, 0
    s_waitcnt vmcnt(1)
    s_mov_b64 exec, 1
    buffer_atomic_add v253, v252, s[32:35], s55 offen sc1
    s_mov_b64 exec, -1
xz_6:
X_layer:
    v_lshrrev_b32 v206, 4, v254
    v_lshrrev_b32 v207, 8, v254
    v_and_b32 v208, 15, v206
    s_lshl_b32 s55, s43, 13
    s_add_u32 s55, s55, 98304
    s_cmp_lg_u32 s46, 0
    s_cbranch_scc1 g1_7
    v_and_b32 v210, 6, v208
    v_xor_b32 v210, v210, v207
    v_lshlrev_b32 v210, 4, v210
    v_lshl_add_u32 v200, v208, 7, v210
    v_xor_b32 v201, 64, v200
    s_branch g1_8
g1_7:
    v_mov_b32 v200, v254
    v_add_u32 v201, 1024, v254
g1_8:
    v_add_u32 v200, s55, v200
    v_add_u32 v201, s55, v201
    v_lshrrev_b32 v209, 6, v254
    v_lshrrev_b32 v210, 1, v209
    v_and_b32 v210, 3, v210
    s_lshl_b32 s55, s44, 1
    v_xor_b32 v210, s55, v210
    v_lshlrev_b32 v209, 7, v209
    v_lshl_add_u32 v209, v210, 5, v209
    v_and_b32 v210, 0x30, v254
    v_lshrrev_b32 v210, 1, v210
    v_add_u32 v202, v209, v210
    v_xor_b32 v203, 32, v202
    v_add_u32 v204, 49152, v202
    v_add_u32 v205, 49152, v203
    s_add_u32 s88, s1, s47
    v_lshlrev_b32 v209, 2, v207
    v_sub_u32 v209, v208, v209
    v_cmp_le_i32 s[72:73], 0, v209
    v_cmp_le_i32 s[74:75], 1, v209
    v_cmp_le_i32 s[76:77], 2, v209
    v_cmp_le_i32 s[78:79], 3, v209
    v_and_b32 v210, 1, v208
    v_cmp_eq_u32 s[80:81], 1, v210
    v_sub_u32 v209, v209, v210
    v_mov_b32 v212, 0x0c0c0c0c
    v_mov_b32 v210, 0xc0c0100
    v_mov_b32 v211, 0x1000c0c
    v_cmp_le_i32 vcc, 0, v209
    v_cndmask_b32 v210, v210, v211, s[80:81]
    s_not_b64 s[82:83], vcc
    v_cndmask_b32 v214, v210, v212, vcc
    v_cndmask_b32 v216, v212, v210, vcc
    v_mov_b32 v210, 0xc0c0302
    v_mov_b32 v211, 0x3020c0c
    v_cmp_le_i32 vcc, 2, v209
    v_cndmask_b32 v210, v210, v211, s[80:81]
    s_not_b64 s[84:85], vcc
    v_cndmask_b32 v215, v210, v212, vcc
    v_cndmask_b32 v217, v212, v210, vcc
    s_or_b32 s55, s40, s43
    s_cmp_eq_u32 s55, 0
    s_cselect_b64 s[82:83], s[82:83], 0
    s_cselect_b64 s[84:85], s[84:85], 0
    s_lshl_b32 s55, s43, 8
    s_add_u32 s55, s55, 159744
    v_lshlrev_b32 v218, 2, v208
    v_add_u32 v218, s55, v218
    v_lshlrev_b32 v219, 4, v207
    v_add_u32 v219, s55, v219
    s_lshl_b32 s55, s44, 7
    s_add_u32 s55, s55, 160896
    v_lshlrev_b32 v220, 4, v207
    v_add_u32 v220, s55, v220
    v_lshlrev_b32 v221, 2, v208
    v_add_u32 v221, s55, v221
    v_mov_b32 v222, 0x3f803f80
    v_mov_b32 v223, 0x3f803f80
    v_mov_b32 v224, 0x3f803f80
    v_mov_b32 v225, 0x3f803f80
    v_mov_b32 v213, 163712
    v_and_b32 v206, 0xf0, v254
    v_lshlrev_b32 v206, 7, v206
    v_and_b32 v210, 0x100, v254
    v_lshrrev_b32 v210, 3, v210
    v_add_u32 v206, v206, v210
    v_and_b32 v210, 0x200, v254
    v_lshrrev_b32 v210, 5, v210
    v_add_u32 v206, v206, v210
    s_lshl_b32 s92, s40, 18
    s_lshl_b32 s56, s43, 17
    s_add_u32 s92, s92, s56
    s_lshl_b32 s56, s51, 7
    s_add_u32 s92, s92, s56
    s_lshl_b32 s56, s44, 6
    s_add_u32 s92, s92, s56
    s_cmp_eq_u32 s46, 0
    s_cbranch_scc1 g1_9
    s_waitcnt vmcnt(0) lgkmcnt(0)
    s_barrier
    s_cmp_lg_u32 s42, 2
    s_cbranch_scc1 wf_10
    s_lshr_b32 s55, s2, 5
    s_lshl_b32 s55, s55, 2
    s_add_u32 s55, s55, s0
    v_mov_b32 v252, 64
    v_mov_b32 v253, 0x01010101
    s_mov_b64 exec, 1
    s_cmp_eq_u32 s45, 0
    s_cbranch_scc1 st_11
    buffer_store_dword v253, v252, s[4:7], s55 offen sc0 sc1
    s_branch st_12
st_11:
    buffer_store_dword v253, v252, s[4:7], s55 offen
st_12:
    s_mov_b64 exec, -1
wf_10:
    s_cmp_lg_u32 s42, 3
    s_cbranch_scc1 wf_13
    s_lshl_b32 s55, s51, 2
    s_add_u32 s55, s55, s54
    v_mov_b32 v252, 8192
    v_mov_b32 v253, 0x01010101
    s_mov_b64 exec, 1
    buffer_store_dword v253, v252, s[4:7], s55 offen sc0 sc1
    s_mov_b64 exec, -1
wf_13:
    s_cmp_lg_u32 s42, 0
    s_cbranch_scc1 so_14
    v_add_u32 v234, 155648, v254
    ds_read_b128 v[226:229], v234
    ds_read_b128 v[230:233], v234 offset:1024
    s_lshl_b32 s55, s51, 10
    s_add_u32 s55, s55, s53
    s_waitcnt lgkmcnt(0)
    v_add_f32 v226, v226, v230
    v_add_f32 v227, v227, v231
    v_add_f32 v228, v228, v232
    v_add_f32 v229, v229, v233
    buffer_store_dwordx4 v[226:229], v254, s[4:7], s55 offen sc0 sc1
so_14:
g1_9:
    s_barrier
    ds_read_b64_tr_b16 v[152:153], v202 offset:0
    ds_read_b64_tr_b16 v[154:155], v202 offset:2048
    ds_read_b128 v[116:119], v200 offset:2048
    ds_read_b128 v[120:123], v200 offset:4096
    ds_read_b128 v[124:127], v200 offset:6144
    ds_read_b128 v[128:131], v200 offset:8192
    ds_read_b64_tr_b16 v[156:157], v203 offset:0
    ds_read_b64_tr_b16 v[158:159], v203 offset:2048
    ds_read_b64_tr_b16 v[160:161], v202 offset:4096
    ds_read_b64_tr_b16 v[162:163], v202 offset:6144
    ds_read_b128 v[112:115], v200 offset:0
    ds_read_b64_tr_b16 v[164:165], v203 offset:4096
    ds_read_b64_tr_b16 v[166:167], v203 offset:6144
    ds_read_b64_tr_b16 v[168:169], v202 offset:8192
    ds_read_b64_tr_b16 v[170:171], v202 offset:10240
    ds_read_b64_tr_b16 v[172:173], v203 offset:8192
    ds_read_b64_tr_b16 v[174:175], v203 offset:10240
    s_mov_b32 s58, 5
    s_waitcnt lgkmcnt(0)
    s_barrier
    .p2align 3
    v_mfma_f32_16x16x32_bf16 v[0:3], v[152:155], v[116:119], 0
    ds_read_b64_tr_b16 v[176:177], v202 offset:16384
    v_mfma_f32_16x16x32_bf16 v[8:11], v[152:155], v[120:123], 0
    ds_read_b64_tr_b16 v[178:179], v202 offset:18432
    v_mfma_f32_16x16x32_bf16 v[16:19], v[152:155], v[124:127], 0
    ds_read_b128 v[136:139], v201 offset:2048
    v_mfma_f32_16x16x32_bf16 v[24:27], v[152:155], v[128:131], 0
    ds_read_b128 v[140:143], v201 offset:4096
    v_mfma_f32_16x16x32_bf16 v[28:31], v[156:159], v[128:131], 0
    ds_read_b128 v[144:147], v201 offset:6144
    v_mfma_f32_16x16x32_bf16 v[20:23], v[156:159], v[124:127], 0
    v_mfma_f32_16x16x32_bf16 v[12:15], v[156:159], v[120:123], 0
    ds_read_b128 v[148:151], v201 offset:8192
    v_mfma_f32_16x16x32_bf16 v[4:7], v[156:159], v[116:119], 0
    ds_read_b64_tr_b16 v[180:181], v203 offset:16384
    v_mfma_f32_16x16x32_bf16 v[40:43], v[160:163], v[116:119], 0
    ds_read_b64_tr_b16 v[182:183], v203 offset:18432
    v_mfma_f32_16x16x32_bf16 v[48:51], v[160:163], v[120:123], 0
    ds_read_b64_tr_b16 v[184:185], v202 offset:20480
    v_mfma_f32_16x16x32_bf16 v[56:59], v[160:163], v[124:127], 0
    v_mfma_f32_16x16x32_bf16 v[64:67], v[160:163], v[128:131], 0
    ds_read_b64_tr_b16 v[186:187], v202 offset:22528
    v_mfma_f32_16x16x32_bf16 v[32:35], v[160:163], v[112:115], 0
    ds_read_b128 v[132:135], v201 offset:0
    v_mfma_f32_16x16x32_bf16 v[36:39], v[164:167], v[112:115], 0
    ds_read_b64_tr_b16 v[188:189], v203 offset:20480
    v_mfma_f32_16x16x32_bf16 v[68:71], v[164:167], v[128:131], 0
    ds_read_b64_tr_b16 v[190:191], v203 offset:22528
    v_mfma_f32_16x16x32_bf16 v[60:63], v[164:167], v[124:127], 0
    v_mfma_f32_16x16x32_bf16 v[52:55], v[164:167], v[120:123], 0
    ds_read_b64_tr_b16 v[192:193], v202 offset:24576
    v_mfma_f32_16x16x32_bf16 v[44:47], v[164:167], v[116:119], 0
    ds_read_b64_tr_b16 v[194:195], v202 offset:26624
    v_mfma_f32_16x16x32_bf16 v[72:75], v[112:115], v[168:171], 0
    ds_read_b64_tr_b16 v[196:197], v203 offset:24576
    v_mfma_f32_16x16x32_bf16 v[80:83], v[116:119], v[168:171], 0
    ds_read_b64_tr_b16 v[198:199], v203 offset:26624
    v_mfma_f32_16x16x32_bf16 v[88:91], v[120:123], v[168:171], 0
    v_mfma_f32_16x16x32_bf16 v[96:99], v[124:127], v[168:171], 0
    v_mfma_f32_16x16x32_bf16 v[104:107], v[128:131], v[168:171], 0
    v_mfma_f32_16x16x32_bf16 v[108:111], v[128:131], v[172:175], 0
    v_mfma_f32_16x16x32_bf16 v[100:103], v[124:127], v[172:175], 0
    v_mfma_f32_16x16x32_bf16 v[92:95], v[120:123], v[172:175], 0
    v_mfma_f32_16x16x32_bf16 v[84:87], v[116:119], v[172:175], 0
    v_mfma_f32_16x16x32_bf16 v[76:79], v[112:115], v[172:175], 0
    .p2align 3
loop_15:
    s_waitcnt lgkmcnt(0)
    s_barrier
    .p2align 3
    v_mfma_f32_16x16x32_bf16 v[0:3], v[176:179], v[136:139], v[0:3]
    ds_read_b64_tr_b16 v[152:153], v202 offset:32768
    v_mfma_f32_16x16x32_bf16 v[8:11], v[176:179], v[140:143], v[8:11]
    ds_read_b64_tr_b16 v[154:155], v202 offset:34816
    v_mfma_f32_16x16x32_bf16 v[16:19], v[176:179], v[144:147], v[16:19]
    ds_read_b128 v[116:119], v200 offset:20480
    v_mfma_f32_16x16x32_bf16 v[24:27], v[176:179], v[148:151], v[24:27]
    ds_read_b128 v[120:123], v200 offset:22528
    v_mfma_f32_16x16x32_bf16 v[28:31], v[180:183], v[148:151], v[28:31]
    ds_read_b128 v[124:127], v200 offset:24576
    v_mfma_f32_16x16x32_bf16 v[20:23], v[180:183], v[144:147], v[20:23]
    v_mfma_f32_16x16x32_bf16 v[12:15], v[180:183], v[140:143], v[12:15]
    ds_read_b128 v[128:131], v200 offset:26624
    v_mfma_f32_16x16x32_bf16 v[4:7], v[180:183], v[136:139], v[4:7]
    ds_read_b64_tr_b16 v[156:157], v203 offset:32768
    v_mfma_f32_16x16x32_bf16 v[40:43], v[184:187], v[136:139], v[40:43]
    ds_read_b64_tr_b16 v[158:159], v203 offset:34816
    v_mfma_f32_16x16x32_bf16 v[48:51], v[184:187], v[140:143], v[48:51]
    ds_read_b64_tr_b16 v[160:161], v202 offset:36864
    v_mfma_f32_16x16x32_bf16 v[56:59], v[184:187], v[144:147], v[56:59]
    v_mfma_f32_16x16x32_bf16 v[64:67], v[184:187], v[148:151], v[64:67]
    ds_read_b64_tr_b16 v[162:163], v202 offset:38912
    v_mfma_f32_16x16x32_bf16 v[32:35], v[184:187], v[132:135], v[32:35]
    ds_read_b128 v[112:115], v200 offset:18432
    v_mfma_f32_16x16x32_bf16 v[36:39], v[188:191], v[132:135], v[36:39]
    ds_read_b64_tr_b16 v[164:165], v203 offset:36864
    v_mfma_f32_16x16x32_bf16 v[68:71], v[188:191], v[148:151], v[68:71]
    ds_read_b64_tr_b16 v[166:167], v203 offset:38912
    v_mfma_f32_16x16x32_bf16 v[60:63], v[188:191], v[144:147], v[60:63]
    v_mfma_f32_16x16x32_bf16 v[52:55], v[188:191], v[140:143], v[52:55]
    ds_read_b64_tr_b16 v[168:169], v202 offset:40960
    v_mfma_f32_16x16x32_bf16 v[44:47], v[188:191], v[136:139], v[44:47]
    ds_read_b64_tr_b16 v[170:171], v202 offset:43008
    v_mfma_f32_16x16x32_bf16 v[72:75], v[132:135], v[192:195], v[72:75]
    ds_read_b64_tr_b16 v[172:173], v203 offset:40960
    v_mfma_f32_16x16x32_bf16 v[80:83], v[136:139], v[192:195], v[80:83]
    ds_read_b64_tr_b16 v[174:175], v203 offset:43008
    v_mfma_f32_16x16x32_bf16 v[88:91], v[140:143], v[192:195], v[88:91]
    v_mfma_f32_16x16x32_bf16 v[96:99], v[144:147], v[192:195], v[96:99]
    v_mfma_f32_16x16x32_bf16 v[104:107], v[148:151], v[192:195], v[104:107]
    v_mfma_f32_16x16x32_bf16 v[108:111], v[148:151], v[196:199], v[108:111]
    v_mfma_f32_16x16x32_bf16 v[100:103], v[144:147], v[196:199], v[100:103]
    v_mfma_f32_16x16x32_bf16 v[92:95], v[140:143], v[196:199], v[92:95]
    v_mfma_f32_16x16x32_bf16 v[84:87], v[136:139], v[196:199], v[84:87]
    v_mfma_f32_16x16x32_bf16 v[76:79], v[132:135], v[196:199], v[76:79]
    s_waitcnt vmcnt(0) lgkmcnt(0)
    s_barrier
    .p2align 3
    v_mfma_f32_16x16x32_bf16 v[0:3], v[152:155], v[116:119], v[0:3]
    ds_read_b64_tr_b16 v[176:177], v204 offset:0
    v_mfma_f32_16x16x32_bf16 v[8:11], v[152:155], v[120:123], v[8:11]
    ds_read_b64_tr_b16 v[178:179], v204 offset:2048
    v_mfma_f32_16x16x32_bf16 v[16:19], v[152:155], v[124:127], v[16:19]
    ds_read_b128 v[136:139], v201 offset:20480
    v_mfma_f32_16x16x32_bf16 v[24:27], v[152:155], v[128:131], v[24:27]
    ds_read_b128 v[140:143], v201 offset:22528
    v_mfma_f32_16x16x32_bf16 v[28:31], v[156:159], v[128:131], v[28:31]
    ds_read_b128 v[144:147], v201 offset:24576
    v_mfma_f32_16x16x32_bf16 v[20:23], v[156:159], v[124:127], v[20:23]
    v_mfma_f32_16x16x32_bf16 v[12:15], v[156:159], v[120:123], v[12:15]
    ds_read_b128 v[148:151], v201 offset:26624
    v_mfma_f32_16x16x32_bf16 v[4:7], v[156:159], v[116:119], v[4:7]
    ds_read_b64_tr_b16 v[180:181], v205 offset:0
    v_mfma_f32_16x16x32_bf16 v[40:43], v[160:163], v[116:119], v[40:43]
    ds_read_b64_tr_b16 v[182:183], v205 offset:2048
    v_mfma_f32_16x16x32_bf16 v[48:51], v[160:163], v[120:123], v[48:51]
    ds_read_b64_tr_b16 v[184:185], v204 offset:4096
    v_mfma_f32_16x16x32_bf16 v[56:59], v[160:163], v[124:127], v[56:59]
    v_mfma_f32_16x16x32_bf16 v[64:67], v[160:163], v[128:131], v[64:67]
    ds_read_b64_tr_b16 v[186:187], v204 offset:6144
    v_mfma_f32_16x16x32_bf16 v[32:35], v[160:163], v[112:115], v[32:35]
    ds_read_b128 v[132:135], v201 offset:18432
    v_mfma_f32_16x16x32_bf16 v[36:39], v[164:167], v[112:115], v[36:39]
    ds_read_b64_tr_b16 v[188:189], v205 offset:4096
    v_mfma_f32_16x16x32_bf16 v[68:71], v[164:167], v[128:131], v[68:71]
    ds_read_b64_tr_b16 v[190:191], v205 offset:6144
    v_mfma_f32_16x16x32_bf16 v[60:63], v[164:167], v[124:127], v[60:63]
    v_mfma_f32_16x16x32_bf16 v[52:55], v[164:167], v[120:123], v[52:55]
    ds_read_b64_tr_b16 v[192:193], v204 offset:8192
    v_mfma_f32_16x16x32_bf16 v[44:47], v[164:167], v[116:119], v[44:47]
    ds_read_b64_tr_b16 v[194:195], v204 offset:10240
    v_mfma_f32_16x16x32_bf16 v[72:75], v[112:115], v[168:171], v[72:75]
    ds_read_b64_tr_b16 v[196:197], v205 offset:8192
    v_mfma_f32_16x16x32_bf16 v[80:83], v[116:119], v[168:171], v[80:83]
    ds_read_b64_tr_b16 v[198:199], v205 offset:10240
    v_mfma_f32_16x16x32_bf16 v[88:91], v[120:123], v[168:171], v[88:91]
    v_mfma_f32_16x16x32_bf16 v[96:99], v[124:127], v[168:171], v[96:99]
    v_mfma_f32_16x16x32_bf16 v[104:107], v[128:131], v[168:171], v[104:107]
    v_mfma_f32_16x16x32_bf16 v[108:111], v[128:131], v[172:175], v[108:111]
    v_mfma_f32_16x16x32_bf16 v[100:103], v[124:127], v[172:175], v[100:103]
    v_mfma_f32_16x16x32_bf16 v[92:95], v[120:123], v[172:175], v[92:95]
    v_mfma_f32_16x16x32_bf16 v[84:87], v[116:119], v[172:175], v[84:87]
    v_mfma_f32_16x16x32_bf16 v[76:79], v[112:115], v[172:175], v[76:79]
    s_waitcnt lgkmcnt(0)
    s_barrier
    .p2align 3
    v_mfma_f32_16x16x32_bf16 v[0:3], v[176:179], v[136:139], v[0:3]
    ds_read_b64_tr_b16 v[152:153], v204 offset:16384
    v_mfma_f32_16x16x32_bf16 v[8:11], v[176:179], v[140:143], v[8:11]
    ds_read_b64_tr_b16 v[154:155], v204 offset:18432
    v_mfma_f32_16x16x32_bf16 v[16:19], v[176:179], v[144:147], v[16:19]
    ds_read_b128 v[116:119], v200 offset:38912
    v_mfma_f32_16x16x32_bf16 v[24:27], v[176:179], v[148:151], v[24:27]
    ds_read_b128 v[120:123], v200 offset:40960
    v_mfma_f32_16x16x32_bf16 v[28:31], v[180:183], v[148:151], v[28:31]
    ds_read_b128 v[124:127], v200 offset:43008
    v_mfma_f32_16x16x32_bf16 v[20:23], v[180:183], v[144:147], v[20:23]
    v_mfma_f32_16x16x32_bf16 v[12:15], v[180:183], v[140:143], v[12:15]
    ds_read_b128 v[128:131], v200 offset:45056
    v_mfma_f32_16x16x32_bf16 v[4:7], v[180:183], v[136:139], v[4:7]
    ds_read_b64_tr_b16 v[156:157], v205 offset:16384
    v_mfma_f32_16x16x32_bf16 v[40:43], v[184:187], v[136:139], v[40:43]
    ds_read_b64_tr_b16 v[158:159], v205 offset:18432
    v_mfma_f32_16x16x32_bf16 v[48:51], v[184:187], v[140:143], v[48:51]
    ds_read_b64_tr_b16 v[160:161], v204 offset:20480
    v_mfma_f32_16x16x32_bf16 v[56:59], v[184:187], v[144:147], v[56:59]
    v_mfma_f32_16x16x32_bf16 v[64:67], v[184:187], v[148:151], v[64:67]
    ds_read_b64_tr_b16 v[162:163], v204 offset:22528
    v_mfma_f32_16x16x32_bf16 v[32:35], v[184:187], v[132:135], v[32:35]
    ds_read_b128 v[112:115], v200 offset:36864
    v_mfma_f32_16x16x32_bf16 v[36:39], v[188:191], v[132:135], v[36:39]
    ds_read_b64_tr_b16 v[164:165], v205 offset:20480
    v_mfma_f32_16x16x32_bf16 v[68:71], v[188:191], v[148:151], v[68:71]
    ds_read_b64_tr_b16 v[166:167], v205 offset:22528
    v_mfma_f32_16x16x32_bf16 v[60:63], v[188:191], v[144:147], v[60:63]
    v_mfma_f32_16x16x32_bf16 v[52:55], v[188:191], v[140:143], v[52:55]
    ds_read_b64_tr_b16 v[168:169], v204 offset:24576
    v_mfma_f32_16x16x32_bf16 v[44:47], v[188:191], v[136:139], v[44:47]
    ds_read_b64_tr_b16 v[170:171], v204 offset:26624
    v_mfma_f32_16x16x32_bf16 v[72:75], v[132:135], v[192:195], v[72:75]
    ds_read_b64_tr_b16 v[172:173], v205 offset:24576
    v_mfma_f32_16x16x32_bf16 v[80:83], v[136:139], v[192:195], v[80:83]
    ds_read_b64_tr_b16 v[174:175], v205 offset:26624
    v_mfma_f32_16x16x32_bf16 v[88:91], v[140:143], v[192:195], v[88:91]
    v_mfma_f32_16x16x32_bf16 v[96:99], v[144:147], v[192:195], v[96:99]
    v_mfma_f32_16x16x32_bf16 v[104:107], v[148:151], v[192:195], v[104:107]
    v_mfma_f32_16x16x32_bf16 v[108:111], v[148:151], v[196:199], v[108:111]
    v_mfma_f32_16x16x32_bf16 v[100:103], v[144:147], v[196:199], v[100:103]
    v_mfma_f32_16x16x32_bf16 v[92:95], v[140:143], v[196:199], v[92:95]
    v_mfma_f32_16x16x32_bf16 v[84:87], v[136:139], v[196:199], v[84:87]
    v_mfma_f32_16x16x32_bf16 v[76:79], v[132:135], v[196:199], v[76:79]
    s_waitcnt lgkmcnt(0)
    s_barrier
    .p2align 3
    v_mfma_f32_16x16x32_bf16 v[0:3], v[152:155], v[116:119], v[0:3]
    ds_read_b64_tr_b16 v[176:177], v204 offset:32768
    v_mfma_f32_16x16x32_bf16 v[8:11], v[152:155], v[120:123], v[8:11]
    ds_read_b64_tr_b16 v[178:179], v204 offset:34816
    v_mfma_f32_16x16x32_bf16 v[16:19], v[152:155], v[124:127], v[16:19]
    ds_read_b128 v[136:139], v201 offset:38912
    v_mfma_f32_16x16x32_bf16 v[24:27], v[152:155], v[128:131], v[24:27]
    ds_read_b128 v[140:143], v201 offset:40960
    v_mfma_f32_16x16x32_bf16 v[28:31], v[156:159], v[128:131], v[28:31]
    ds_read_b128 v[144:147], v201 offset:43008
    v_mfma_f32_16x16x32_bf16 v[20:23], v[156:159], v[124:127], v[20:23]
    v_mfma_f32_16x16x32_bf16 v[12:15], v[156:159], v[120:123], v[12:15]
    ds_read_b128 v[148:151], v201 offset:45056
    v_mfma_f32_16x16x32_bf16 v[4:7], v[156:159], v[116:119], v[4:7]
    ds_read_b64_tr_b16 v[180:181], v205 offset:32768
    v_mfma_f32_16x16x32_bf16 v[40:43], v[160:163], v[116:119], v[40:43]
    ds_read_b64_tr_b16 v[182:183], v205 offset:34816
    v_mfma_f32_16x16x32_bf16 v[48:51], v[160:163], v[120:123], v[48:51]
    ds_read_b64_tr_b16 v[184:185], v204 offset:36864
    v_mfma_f32_16x16x32_bf16 v[56:59], v[160:163], v[124:127], v[56:59]
    v_mfma_f32_16x16x32_bf16 v[64:67], v[160:163], v[128:131], v[64:67]
    ds_read_b64_tr_b16 v[186:187], v204 offset:38912
    v_mfma_f32_16x16x32_bf16 v[32:35], v[160:163], v[112:115], v[32:35]
    ds_read_b128 v[132:135], v201 offset:36864
    v_mfma_f32_16x16x32_bf16 v[36:39], v[164:167], v[112:115], v[36:39]
    ds_read_b64_tr_b16 v[188:189], v205 offset:36864
    v_mfma_f32_16x16x32_bf16 v[68:71], v[164:167], v[128:131], v[68:71]
    ds_read_b64_tr_b16 v[190:191], v205 offset:38912
    v_mfma_f32_16x16x32_bf16 v[60:63], v[164:167], v[124:127], v[60:63]
    v_mfma_f32_16x16x32_bf16 v[52:55], v[164:167], v[120:123], v[52:55]
    ds_read_b64_tr_b16 v[192:193], v204 offset:40960
    v_mfma_f32_16x16x32_bf16 v[44:47], v[164:167], v[116:119], v[44:47]
    ds_read_b64_tr_b16 v[194:195], v204 offset:43008
    v_mfma_f32_16x16x32_bf16 v[72:75], v[112:115], v[168:171], v[72:75]
    ds_read_b64_tr_b16 v[196:197], v205 offset:40960
    v_mfma_f32_16x16x32_bf16 v[80:83], v[116:119], v[168:171], v[80:83]
    ds_read_b64_tr_b16 v[198:199], v205 offset:43008
    v_mfma_f32_16x16x32_bf16 v[88:91], v[120:123], v[168:171], v[88:91]
    v_mfma_f32_16x16x32_bf16 v[96:99], v[124:127], v[168:171], v[96:99]
    v_mfma_f32_16x16x32_bf16 v[104:107], v[128:131], v[168:171], v[104:107]
    v_mfma_f32_16x16x32_bf16 v[108:111], v[128:131], v[172:175], v[108:111]
    v_mfma_f32_16x16x32_bf16 v[100:103], v[124:127], v[172:175], v[100:103]
    v_mfma_f32_16x16x32_bf16 v[92:95], v[120:123], v[172:175], v[92:95]
    v_mfma_f32_16x16x32_bf16 v[84:87], v[116:119], v[172:175], v[84:87]
    v_mfma_f32_16x16x32_bf16 v[76:79], v[112:115], v[172:175], v[76:79]
    s_waitcnt lgkmcnt(0)
    s_barrier
    .p2align 3
    v_mfma_f32_16x16x32_bf16 v[0:3], v[176:179], v[136:139], v[0:3]
    ds_read_b64_tr_b16 v[152:153], v202 offset:0
    v_mfma_f32_16x16x32_bf16 v[8:11], v[176:179], v[140:143], v[8:11]
    ds_read_b64_tr_b16 v[154:155], v202 offset:2048
    v_mfma_f32_16x16x32_bf16 v[16:19], v[176:179], v[144:147], v[16:19]
    ds_read_b128 v[116:119], v200 offset:2048
    v_mfma_f32_16x16x32_bf16 v[24:27], v[176:179], v[148:151], v[24:27]
    ds_read_b128 v[120:123], v200 offset:4096
    v_mfma_f32_16x16x32_bf16 v[28:31], v[180:183], v[148:151], v[28:31]
    ds_read_b128 v[124:127], v200 offset:6144
    v_mfma_f32_16x16x32_bf16 v[20:23], v[180:183], v[144:147], v[20:23]
    v_mfma_f32_16x16x32_bf16 v[12:15], v[180:183], v[140:143], v[12:15]
    ds_read_b128 v[128:131], v200 offset:8192
    v_mfma_f32_16x16x32_bf16 v[4:7], v[180:183], v[136:139], v[4:7]
    ds_read_b64_tr_b16 v[156:157], v203 offset:0
    v_mfma_f32_16x16x32_bf16 v[40:43], v[184:187], v[136:139], v[40:43]
    ds_read_b64_tr_b16 v[158:159], v203 offset:2048
    v_mfma_f32_16x16x32_bf16 v[48:51], v[184:187], v[140:143], v[48:51]
    ds_read_b64_tr_b16 v[160:161], v202 offset:4096
    v_mfma_f32_16x16x32_bf16 v[56:59], v[184:187], v[144:147], v[56:59]
    v_mfma_f32_16x16x32_bf16 v[64:67], v[184:187], v[148:151], v[64:67]
    ds_read_b64_tr_b16 v[162:163], v202 offset:6144
    v_mfma_f32_16x16x32_bf16 v[32:35], v[184:187], v[132:135], v[32:35]
    ds_read_b128 v[112:115], v200 offset:0
    v_mfma_f32_16x16x32_bf16 v[36:39], v[188:191], v[132:135], v[36:39]
    ds_read_b64_tr_b16 v[164:165], v203 offset:4096
    v_mfma_f32_16x16x32_bf16 v[68:71], v[188:191], v[148:151], v[68:71]
    ds_read_b64_tr_b16 v[166:167], v203 offset:6144
    v_mfma_f32_16x16x32_bf16 v[60:63], v[188:191], v[144:147], v[60:63]
    v_mfma_f32_16x16x32_bf16 v[52:55], v[188:191], v[140:143], v[52:55]
    ds_read_b64_tr_b16 v[168:169], v202 offset:8192
    v_mfma_f32_16x16x32_bf16 v[44:47], v[188:191], v[136:139], v[44:47]
    ds_read_b64_tr_b16 v[170:171], v202 offset:10240
    v_mfma_f32_16x16x32_bf16 v[72:75], v[132:135], v[192:195], v[72:75]
    ds_read_b64_tr_b16 v[172:173], v203 offset:8192
    v_mfma_f32_16x16x32_bf16 v[80:83], v[136:139], v[192:195], v[80:83]
    ds_read_b64_tr_b16 v[174:175], v203 offset:10240
    v_mfma_f32_16x16x32_bf16 v[88:91], v[140:143], v[192:195], v[88:91]
    v_mfma_f32_16x16x32_bf16 v[96:99], v[144:147], v[192:195], v[96:99]
    v_mfma_f32_16x16x32_bf16 v[104:107], v[148:151], v[192:195], v[104:107]
    v_mfma_f32_16x16x32_bf16 v[108:111], v[148:151], v[196:199], v[108:111]
    v_mfma_f32_16x16x32_bf16 v[100:103], v[144:147], v[196:199], v[100:103]
    v_mfma_f32_16x16x32_bf16 v[92:95], v[140:143], v[196:199], v[92:95]
    v_mfma_f32_16x16x32_bf16 v[84:87], v[136:139], v[196:199], v[84:87]
    v_mfma_f32_16x16x32_bf16 v[76:79], v[132:135], v[196:199], v[76:79]
    s_waitcnt lgkmcnt(0)
    s_barrier
    .p2align 3
    v_mfma_f32_16x16x32_bf16 v[0:3], v[152:155], v[116:119], v[0:3]
    ds_read_b64_tr_b16 v[176:177], v202 offset:16384
    v_mfma_f32_16x16x32_bf16 v[8:11], v[152:155], v[120:123], v[8:11]
    ds_read_b64_tr_b16 v[178:179], v202 offset:18432
    v_mfma_f32_16x16x32_bf16 v[16:19], v[152:155], v[124:127], v[16:19]
    ds_read_b128 v[136:139], v201 offset:2048
    v_mfma_f32_16x16x32_bf16 v[24:27], v[152:155], v[128:131], v[24:27]
    ds_read_b128 v[140:143], v201 offset:4096
    v_mfma_f32_16x16x32_bf16 v[28:31], v[156:159], v[128:131], v[28:31]
    ds_read_b128 v[144:147], v201 offset:6144
    v_mfma_f32_16x16x32_bf16 v[20:23], v[156:159], v[124:127], v[20:23]
    v_mfma_f32_16x16x32_bf16 v[12:15], v[156:159], v[120:123], v[12:15]
    ds_read_b128 v[148:151], v201 offset:8192
    v_mfma_f32_16x16x32_bf16 v[4:7], v[156:159], v[116:119], v[4:7]
    ds_read_b64_tr_b16 v[180:181], v203 offset:16384
    v_mfma_f32_16x16x32_bf16 v[40:43], v[160:163], v[116:119], v[40:43]
    ds_read_b64_tr_b16 v[182:183], v203 offset:18432
    v_mfma_f32_16x16x32_bf16 v[48:51], v[160:163], v[120:123], v[48:51]
    ds_read_b64_tr_b16 v[184:185], v202 offset:20480
    v_mfma_f32_16x16x32_bf16 v[56:59], v[160:163], v[124:127], v[56:59]
    v_mfma_f32_16x16x32_bf16 v[64:67], v[160:163], v[128:131], v[64:67]
    ds_read_b64_tr_b16 v[186:187], v202 offset:22528
    v_mfma_f32_16x16x32_bf16 v[32:35], v[160:163], v[112:115], v[32:35]
    ds_read_b128 v[132:135], v201 offset:0
    v_mfma_f32_16x16x32_bf16 v[36:39], v[164:167], v[112:115], v[36:39]
    ds_read_b64_tr_b16 v[188:189], v203 offset:20480
    v_mfma_f32_16x16x32_bf16 v[68:71], v[164:167], v[128:131], v[68:71]
    ds_read_b64_tr_b16 v[190:191], v203 offset:22528
    v_mfma_f32_16x16x32_bf16 v[60:63], v[164:167], v[124:127], v[60:63]
    v_mfma_f32_16x16x32_bf16 v[52:55], v[164:167], v[120:123], v[52:55]
    ds_read_b64_tr_b16 v[192:193], v202 offset:24576
    v_mfma_f32_16x16x32_bf16 v[44:47], v[164:167], v[116:119], v[44:47]
    ds_read_b64_tr_b16 v[194:195], v202 offset:26624
    v_mfma_f32_16x16x32_bf16 v[72:75], v[112:115], v[168:171], v[72:75]
    ds_read_b64_tr_b16 v[196:197], v203 offset:24576
    v_mfma_f32_16x16x32_bf16 v[80:83], v[116:119], v[168:171], v[80:83]
    ds_read_b64_tr_b16 v[198:199], v203 offset:26624
    v_mfma_f32_16x16x32_bf16 v[88:91], v[120:123], v[168:171], v[88:91]
    v_mfma_f32_16x16x32_bf16 v[96:99], v[124:127], v[168:171], v[96:99]
    v_mfma_f32_16x16x32_bf16 v[104:107], v[128:131], v[168:171], v[104:107]
    v_mfma_f32_16x16x32_bf16 v[108:111], v[128:131], v[172:175], v[108:111]
    v_mfma_f32_16x16x32_bf16 v[100:103], v[124:127], v[172:175], v[100:103]
    s_sub_u32 s58, s58, 1
    s_cmp_lg_u32 s58, 0
    .p2align 3
    v_mfma_f32_16x16x32_bf16 v[92:95], v[120:123], v[172:175], v[92:95]
    v_mfma_f32_16x16x32_bf16 v[84:87], v[116:119], v[172:175], v[84:87]
    v_mfma_f32_16x16x32_bf16 v[76:79], v[112:115], v[172:175], v[76:79]
    s_cbranch_scc1 loop_15
    s_waitcnt lgkmcnt(0)
    s_barrier
    .p2align 3
    v_mfma_f32_16x16x32_bf16 v[0:3], v[176:179], v[136:139], v[0:3]
    ds_read_b128 v[152:155], v220 offset:0
    v_mfma_f32_16x16x32_bf16 v[8:11], v[176:179], v[140:143], v[8:11]
    ds_read_b128 v[156:159], v220 offset:64
    v_mfma_f32_16x16x32_bf16 v[16:19], v[176:179], v[144:147], v[16:19]
    ds_read_b128 v[160:163], v220 offset:256
    v_mfma_f32_16x16x32_bf16 v[24:27], v[176:179], v[148:151], v[24:27]
    ds_read_b128 v[164:167], v220 offset:320
    v_mfma_f32_16x16x32_bf16 v[28:31], v[180:183], v[148:151], v[28:31]
    ds_read_b32 v112, v218 offset:0
    v_mfma_f32_16x16x32_bf16 v[20:23], v[180:183], v[144:147], v[20:23]
    v_mfma_f32_16x16x32_bf16 v[12:15], v[180:183], v[140:143], v[12:15]
    ds_read_b32 v113, v218 offset:64
    v_mfma_f32_16x16x32_bf16 v[4:7], v[180:183], v[136:139], v[4:7]
    ds_read_b32 v114, v218 offset:128
    v_mfma_f32_16x16x32_bf16 v[40:43], v[184:187], v[136:139], v[40:43]
    ds_read_b32 v115, v218 offset:192
    v_mfma_f32_16x16x32_bf16 v[48:51], v[184:187], v[140:143], v[48:51]
    ds_read_b32 v116, v218 offset:256
    v_mfma_f32_16x16x32_bf16 v[56:59], v[184:187], v[144:147], v[56:59]
    v_mfma_f32_16x16x32_bf16 v[64:67], v[184:187], v[148:151], v[64:67]
    ds_read_b32 v118, v218 offset:576
    v_mfma_f32_16x16x32_bf16 v[32:35], v[184:187], v[132:135], v[32:35]
    ds_read_b32 v119, v218 offset:640
    v_mfma_f32_16x16x32_bf16 v[36:39], v[188:191], v[132:135], v[36:39]
    ds_read_b32 v120, v218 offset:704
    v_mfma_f32_16x16x32_bf16 v[68:71], v[188:191], v[148:151], v[68:71]
    ds_read_b32 v121, v218 offset:768
    v_mfma_f32_16x16x32_bf16 v[60:63], v[188:191], v[144:147], v[60:63]
    v_mfma_f32_16x16x32_bf16 v[52:55], v[188:191], v[140:143], v[52:55]
    ds_read_b32 v122, v218 offset:832
    v_mfma_f32_16x16x32_bf16 v[44:47], v[188:191], v[136:139], v[44:47]
    ds_read_b32 v168, v221 offset:512
    v_mfma_f32_16x16x32_bf16 v[72:75], v[132:135], v[192:195], v[72:75]
    ds_read_b32 v169, v221 offset:576
    v_mfma_f32_16x16x32_bf16 v[80:83], v[136:139], v[192:195], v[80:83]
    ds_read_b32 v170, v213
    v_mfma_f32_16x16x32_bf16 v[88:91], v[140:143], v[192:195], v[88:91]
    v_mfma_f32_16x16x32_bf16 v[96:99], v[144:147], v[192:195], v[96:99]
    v_mfma_f32_16x16x32_bf16 v[104:107], v[148:151], v[192:195], v[104:107]
    v_mfma_f32_16x16x32_bf16 v[108:111], v[148:151], v[196:199], v[108:111]
    v_mfma_f32_16x16x32_bf16 v[100:103], v[144:147], v[196:199], v[100:103]
    v_mfma_f32_16x16x32_bf16 v[92:95], v[140:143], v[196:199], v[92:95]
    s_cmp_lg_u32 s46, 0
    s_cbranch_scc1 g1_16
    buffer_load_dwordx4 v[236:239], v206, s[24:27], s92 offen
    s_add_u32 s92, s92, 32768
    buffer_load_dwordx4 v[240:243], v206, s[24:27], s92 offen
    s_add_u32 s92, s92, 32768
    buffer_load_dwordx4 v[244:247], v206, s[24:27], s92 offen
    s_add_u32 s92, s92, 32768
    buffer_load_dwordx4 v[248:251], v206, s[24:27], s92 offen
    s_add_u32 s92, s92, 32768
g1_16:
    .p2align 3
    v_mfma_f32_16x16x32_bf16 v[84:87], v[136:139], v[196:199], v[84:87]
    v_mfma_f32_16x16x32_bf16 v[76:79], v[132:135], v[196:199], v[76:79]
    s_waitcnt lgkmcnt(0)
    .p2align 3
    ds_read_b128 v[132:135], v219 offset:0
    ds_read_b128 v[176:179], v219 offset:576
    ds_read_b128 v[136:139], v219 offset:64
    ds_read_b128 v[180:183], v219 offset:640
    ds_read_b128 v[140:143], v219 offset:128
    ds_read_b128 v[184:187], v219 offset:704
    ds_read_b128 v[144:147], v219 offset:192
    ds_read_b128 v[188:191], v219 offset:768
    ds_read_b128 v[148:151], v219 offset:256
    ds_read_b128 v[192:195], v219 offset:832
    v_pk_fma_f32 v[0:1], v[112:113], v[152:153], v[0:1] op_sel:[1,0,0] op_sel_hi:[1,1,1]
    v_pk_fma_f32 v[2:3], v[112:113], v[154:155], v[2:3] op_sel:[1,0,0] op_sel_hi:[1,1,1]
    v_pk_fma_f32 v[4:5], v[112:113], v[156:157], v[4:5] op_sel:[1,0,0] op_sel_hi:[1,1,1]
    v_pk_fma_f32 v[6:7], v[112:113], v[158:159], v[6:7] op_sel:[1,0,0] op_sel_hi:[1,1,1]
    v_pk_fma_f32 v[8:9], v[114:115], v[152:153], v[8:9] op_sel:[0,0,0] op_sel_hi:[0,1,1]
    v_pk_fma_f32 v[10:11], v[114:115], v[154:155], v[10:11] op_sel:[0,0,0] op_sel_hi:[0,1,1]
    v_pk_fma_f32 v[12:13], v[114:115], v[156:157], v[12:13] op_sel:[0,0,0] op_sel_hi:[0,1,1]
    v_pk_fma_f32 v[14:15], v[114:115], v[158:159], v[14:15] op_sel:[0,0,0] op_sel_hi:[0,1,1]
    v_pk_fma_f32 v[16:17], v[114:115], v[152:153], v[16:17] op_sel:[1,0,0] op_sel_hi:[1,1,1]
    v_pk_fma_f32 v[18:19], v[114:115], v[154:155], v[18:19] op_sel:[1,0,0] op_sel_hi:[1,1,1]
    v_pk_fma_f32 v[20:21], v[114:115], v[156:157], v[20:21] op_sel:[1,0,0] op_sel_hi:[1,1,1]
    v_pk_fma_f32 v[22:23], v[114:115], v[158:159], v[22:23] op_sel:[1,0,0] op_sel_hi:[1,1,1]
    v_pk_fma_f32 v[24:25], v[116:117], v[152:153], v[24:25] op_sel:[0,0,0] op_sel_hi:[0,1,1]
    v_pk_fma_f32 v[26:27], v[116:117], v[154:155], v[26:27] op_sel:[0,0,0] op_sel_hi:[0,1,1]
    v_pk_fma_f32 v[28:29], v[116:117], v[156:157], v[28:29] op_sel:[0,0,0] op_sel_hi:[0,1,1]
    v_pk_fma_f32 v[30:31], v[116:117], v[158:159], v[30:31] op_sel:[0,0,0] op_sel_hi:[0,1,1]
    v_pk_fma_f32 v[32:33], v[112:113], v[160:161], v[32:33] op_sel:[0,0,0] op_sel_hi:[0,1,1]
    v_pk_fma_f32 v[34:35], v[112:113], v[162:163], v[34:35] op_sel:[0,0,0] op_sel_hi:[0,1,1]
    v_pk_fma_f32 v[36:37], v[112:113], v[164:165], v[36:37] op_sel:[0,0,0] op_sel_hi:[0,1,1]
    v_pk_fma_f32 v[38:39], v[112:113], v[166:167], v[38:39] op_sel:[0,0,0] op_sel_hi:[0,1,1]
    v_pk_fma_f32 v[40:41], v[112:113], v[160:161], v[40:41] op_sel:[1,0,0] op_sel_hi:[1,1,1]
    v_pk_fma_f32 v[42:43], v[112:113], v[162:163], v[42:43] op_sel:[1,0,0] op_sel_hi:[1,1,1]
    v_pk_fma_f32 v[44:45], v[112:113], v[164:165], v[44:45] op_sel:[1,0,0] op_sel_hi:[1,1,1]
    v_pk_fma_f32 v[46:47], v[112:113], v[166:167], v[46:47] op_sel:[1,0,0] op_sel_hi:[1,1,1]
    v_pk_fma_f32 v[48:49], v[114:115], v[160:161], v[48:49] op_sel:[0,0,0] op_sel_hi:[0,1,1]
    v_pk_fma_f32 v[50:51], v[114:115], v[162:163], v[50:51] op_sel:[0,0,0] op_sel_hi:[0,1,1]
    v_pk_fma_f32 v[52:53], v[114:115], v[164:165], v[52:53] op_sel:[0,0,0] op_sel_hi:[0,1,1]
    v_pk_fma_f32 v[54:55], v[114:115], v[166:167], v[54:55] op_sel:[0,0,0] op_sel_hi:[0,1,1]
    v_pk_fma_f32 v[56:57], v[114:115], v[160:161], v[56:57] op_sel:[1,0,0] op_sel_hi:[1,1,1]
    v_pk_fma_f32 v[58:59], v[114:115], v[162:163], v[58:59] op_sel:[1,0,0] op_sel_hi:[1,1,1]
    v_pk_fma_f32 v[60:61], v[114:115], v[164:165], v[60:61] op_sel:[1,0,0] op_sel_hi:[1,1,1]
    v_pk_fma_f32 v[62:63], v[114:115], v[166:167], v[62:63] op_sel:[1,0,0] op_sel_hi:[1,1,1]
    v_pk_fma_f32 v[64:65], v[116:117], v[160:161], v[64:65] op_sel:[0,0,0] op_sel_hi:[0,1,1]
    v_pk_fma_f32 v[66:67], v[116:117], v[162:163], v[66:67] op_sel:[0,0,0] op_sel_hi:[0,1,1]
    v_pk_fma_f32 v[68:69], v[116:117], v[164:165], v[68:69] op_sel:[0,0,0] op_sel_hi:[0,1,1]
    v_pk_fma_f32 v[70:71], v[116:117], v[166:167], v[70:71] op_sel:[0,0,0] op_sel_hi:[0,1,1]
    v_cvt_pk_bf16_f32 v0, v0, v1
    v_cvt_pk_bf16_f32 v1, v2, v3
    v_cvt_pk_bf16_f32 v2, v4, v5
    v_cvt_pk_bf16_f32 v3, v6, v7
    v_cvt_pk_bf16_f32 v8, v8, v9
    v_cvt_pk_bf16_f32 v9, v10, v11
    v_cvt_pk_bf16_f32 v10, v12, v13
    v_cvt_pk_bf16_f32 v11, v14, v15
    v_cvt_pk_bf16_f32 v16, v16, v17
    v_cvt_pk_bf16_f32 v17, v18, v19
    v_cvt_pk_bf16_f32 v18, v20, v21
    v_cvt_pk_bf16_f32 v19, v22, v23
    v_cvt_pk_bf16_f32 v24, v24, v25
    v_cvt_pk_bf16_f32 v25, v26, v27
    v_cvt_pk_bf16_f32 v26, v28, v29
    v_cvt_pk_bf16_f32 v27, v30, v31
    v_pk_mul_f32 v[32:33], v[118:119], v[32:33] op_sel:[0,0] op_sel_hi:[0,1]
    v_pk_mul_f32 v[34:35], v[118:119], v[34:35] op_sel:[0,0] op_sel_hi:[0,1]
    v_pk_mul_f32 v[36:37], v[118:119], v[36:37] op_sel:[0,0] op_sel_hi:[0,1]
    v_pk_mul_f32 v[38:39], v[118:119], v[38:39] op_sel:[0,0] op_sel_hi:[0,1]
    v_pk_mul_f32 v[40:41], v[118:119], v[40:41] op_sel:[1,0] op_sel_hi:[1,1]
    v_pk_mul_f32 v[42:43], v[118:119], v[42:43] op_sel:[1,0] op_sel_hi:[1,1]
    v_pk_mul_f32 v[44:45], v[118:119], v[44:45] op_sel:[1,0] op_sel_hi:[1,1]
    v_pk_mul_f32 v[46:47], v[118:119], v[46:47] op_sel:[1,0] op_sel_hi:[1,1]
    v_pk_mul_f32 v[48:49], v[120:121], v[48:49] op_sel:[0,0] op_sel_hi:[0,1]
    v_pk_mul_f32 v[50:51], v[120:121], v[50:51] op_sel:[0,0] op_sel_hi:[0,1]
    v_pk_mul_f32 v[52:53], v[120:121], v[52:53] op_sel:[0,0] op_sel_hi:[0,1]
    v_pk_mul_f32 v[54:55], v[120:121], v[54:55] op_sel:[0,0] op_sel_hi:[0,1]
    v_pk_mul_f32 v[56:57], v[120:121], v[56:57] op_sel:[1,0] op_sel_hi:[1,1]
    v_pk_mul_f32 v[58:59], v[120:121], v[58:59] op_sel:[1,0] op_sel_hi:[1,1]
    v_pk_mul_f32 v[60:61], v[120:121], v[60:61] op_sel:[1,0] op_sel_hi:[1,1]
    v_pk_mul_f32 v[62:63], v[120:121], v[62:63] op_sel:[1,0] op_sel_hi:[1,1]
    v_pk_mul_f32 v[64:65], v[122:123], v[64:65] op_sel:[0,0] op_sel_hi:[0,1]
    v_pk_mul_f32 v[66:67], v[122:123], v[66:67] op_sel:[0,0] op_sel_hi:[0,1]
    v_pk_mul_f32 v[68:69], v[122:123], v[68:69] op_sel:[0,0] op_sel_hi:[0,1]
    v_pk_mul_f32 v[70:71], v[122:123], v[70:71] op_sel:[0,0] op_sel_hi:[0,1]
    v_cvt_pk_bf16_f32 v32, v32, v33
    v_cvt_pk_bf16_f32 v33, v34, v35
    v_cvt_pk_bf16_f32 v34, v36, v37
    v_cvt_pk_bf16_f32 v35, v38, v39
    v_cvt_pk_bf16_f32 v40, v40, v41
    v_cvt_pk_bf16_f32 v41, v42, v43
    v_cvt_pk_bf16_f32 v42, v44, v45
    v_cvt_pk_bf16_f32 v43, v46, v47
    v_cvt_pk_bf16_f32 v48, v48, v49
    v_cvt_pk_bf16_f32 v49, v50, v51
    v_cvt_pk_bf16_f32 v50, v52, v53
    v_cvt_pk_bf16_f32 v51, v54, v55
    v_cvt_pk_bf16_f32 v56, v56, v57
    v_cvt_pk_bf16_f32 v57, v58, v59
    v_cvt_pk_bf16_f32 v58, v60, v61
    v_cvt_pk_bf16_f32 v59, v62, v63
    v_cvt_pk_bf16_f32 v64, v64, v65
    v_cvt_pk_bf16_f32 v65, v66, v67
    v_cvt_pk_bf16_f32 v66, v68, v69
    v_cvt_pk_bf16_f32 v67, v70, v71
    v_readfirstlane_b32 s45, v170
    s_waitcnt lgkmcnt(0)
    v_mfma_f32_16x16x32_bf16 v[4:7], v[40:43], v[0:3], 0
    v_mfma_f32_16x16x32_bf16 v[44:47], v[32:35], v[0:3], 0
    v_mfma_f32_16x16x32_bf16 v[12:15], v[48:51], v[8:11], 0
    v_mfma_f32_16x16x32_bf16 v[52:55], v[40:43], v[8:11], 0
    v_mfma_f32_16x16x32_bf16 v[20:23], v[56:59], v[16:19], 0
    v_mfma_f32_16x16x32_bf16 v[60:63], v[48:51], v[16:19], 0
    v_mfma_f32_16x16x32_bf16 v[28:31], v[64:67], v[24:27], 0
    v_mfma_f32_16x16x32_bf16 v[68:71], v[56:59], v[24:27], 0
    v_pk_fma_f32 v[72:73], v[132:133], v[168:169], v[72:73] op_sel:[0,0,0] op_sel_hi:[1,0,1]
    v_pk_fma_f32 v[74:75], v[134:135], v[168:169], v[74:75] op_sel:[0,0,0] op_sel_hi:[1,0,1]
    v_pk_fma_f32 v[76:77], v[132:133], v[168:169], v[76:77] op_sel:[0,1,0] op_sel_hi:[1,1,1]
    v_pk_fma_f32 v[78:79], v[134:135], v[168:169], v[78:79] op_sel:[0,1,0] op_sel_hi:[1,1,1]
    v_pk_fma_f32 v[80:81], v[136:137], v[168:169], v[80:81] op_sel:[0,0,0] op_sel_hi:[1,0,1]
    v_pk_fma_f32 v[82:83], v[138:139], v[168:169], v[82:83] op_sel:[0,0,0] op_sel_hi:[1,0,1]
    v_pk_fma_f32 v[84:85], v[136:137], v[168:169], v[84:85] op_sel:[0,1,0] op_sel_hi:[1,1,1]
    v_pk_fma_f32 v[86:87], v[138:139], v[168:169], v[86:87] op_sel:[0,1,0] op_sel_hi:[1,1,1]
    v_pk_fma_f32 v[88:89], v[140:141], v[168:169], v[88:89] op_sel:[0,0,0] op_sel_hi:[1,0,1]
    v_pk_fma_f32 v[90:91], v[142:143], v[168:169], v[90:91] op_sel:[0,0,0] op_sel_hi:[1,0,1]
    v_pk_fma_f32 v[92:93], v[140:141], v[168:169], v[92:93] op_sel:[0,1,0] op_sel_hi:[1,1,1]
    v_pk_fma_f32 v[94:95], v[142:143], v[168:169], v[94:95] op_sel:[0,1,0] op_sel_hi:[1,1,1]
    v_pk_fma_f32 v[96:97], v[144:145], v[168:169], v[96:97] op_sel:[0,0,0] op_sel_hi:[1,0,1]
    v_pk_fma_f32 v[98:99], v[146:147], v[168:169], v[98:99] op_sel:[0,0,0] op_sel_hi:[1,0,1]
    v_pk_fma_f32 v[100:101], v[144:145], v[168:169], v[100:101] op_sel:[0,1,0] op_sel_hi:[1,1,1]
    v_pk_fma_f32 v[102:103], v[146:147], v[168:169], v[102:103] op_sel:[0,1,0] op_sel_hi:[1,1,1]
    v_pk_fma_f32 v[104:105], v[148:149], v[168:169], v[104:105] op_sel:[0,0,0] op_sel_hi:[1,0,1]
    v_pk_fma_f32 v[106:107], v[150:151], v[168:169], v[106:107] op_sel:[0,0,0] op_sel_hi:[1,0,1]
    v_pk_fma_f32 v[108:109], v[148:149], v[168:169], v[108:109] op_sel:[0,1,0] op_sel_hi:[1,1,1]
    v_pk_fma_f32 v[110:111], v[150:151], v[168:169], v[110:111] op_sel:[0,1,0] op_sel_hi:[1,1,1]
    v_cndmask_b32 v44, v44, v4, s[72:73]
    v_cndmask_b32 v45, v45, v5, s[74:75]
    v_cndmask_b32 v46, v46, v6, s[76:77]
    v_cndmask_b32 v47, v47, v7, s[78:79]
    v_cndmask_b32 v52, v52, v12, s[72:73]
    v_cndmask_b32 v53, v53, v13, s[74:75]
    v_cndmask_b32 v54, v54, v14, s[76:77]
    v_cndmask_b32 v55, v55, v15, s[78:79]
    v_cndmask_b32 v60, v60, v20, s[72:73]
    v_cndmask_b32 v61, v61, v21, s[74:75]
    v_cndmask_b32 v62, v62, v22, s[76:77]
    v_cndmask_b32 v63, v63, v23, s[78:79]
    v_cndmask_b32 v68, v68, v28, s[72:73]
    v_cndmask_b32 v69, v69, v29, s[74:75]
    v_cndmask_b32 v70, v70, v30, s[76:77]
    v_cndmask_b32 v71, v71, v31, s[78:79]
    v_cndmask_b32 v44, v44, v45, s[80:81]
    v_cndmask_b32 v45, v46, v47, s[80:81]
    v_cndmask_b32 v52, v52, v53, s[80:81]
    v_cndmask_b32 v53, v54, v55, s[80:81]
    v_cndmask_b32 v60, v60, v61, s[80:81]
    v_cndmask_b32 v61, v62, v63, s[80:81]
    v_cndmask_b32 v68, v68, v69, s[80:81]
    v_cndmask_b32 v69, v70, v71, s[80:81]
    v_mov_b32 v209, 0xf149f2ca
    v_cndmask_b32 v44, v44, v209, s[82:83]
    v_cndmask_b32 v45, v45, v209, s[84:85]
    v_max_f32 v46, v44, v45
    v_max_f32 v54, v52, v53
    v_max_f32 v62, v60, v61
    v_max_f32 v70, v68, v69
    v_pk_mul_f32 v[72:73], v[176:177], v[72:73] op_sel:[0,0] op_sel_hi:[1,1]
    v_pk_mul_f32 v[74:75], v[178:179], v[74:75] op_sel:[0,0] op_sel_hi:[1,1]
    v_permlane32_swap_b32 v46, v62
    v_permlane32_swap_b32 v54, v70
    v_max_f32 v46, v46, v62
    v_max_f32 v54, v54, v70
    v_pk_mul_f32 v[76:77], v[176:177], v[76:77] op_sel:[0,0] op_sel_hi:[1,1]
    v_pk_mul_f32 v[78:79], v[178:179], v[78:79] op_sel:[0,0] op_sel_hi:[1,1]
    v_permlane16_swap_b32 v46, v54
    v_max_f32 v46, v46, v54
    v_mov_b32 v54, v46
    v_pk_mul_f32 v[80:81], v[180:181], v[80:81] op_sel:[0,0] op_sel_hi:[1,1]
    v_pk_mul_f32 v[82:83], v[182:183], v[82:83] op_sel:[0,0] op_sel_hi:[1,1]
    v_permlane16_swap_b32 v46, v54
    v_mov_b32 v62, v46
    v_mov_b32 v70, v54
    v_pk_mul_f32 v[84:85], v[180:181], v[84:85] op_sel:[0,0] op_sel_hi:[1,1]
    v_pk_mul_f32 v[86:87], v[182:183], v[86:87] op_sel:[0,0] op_sel_hi:[1,1]
    v_permlane32_swap_b32 v46, v62
    v_permlane32_swap_b32 v54, v70
    v_mul_f32 v119, 0x3e8293ee, v119
    v_mul_f32 v120, 0x3e8293ee, v120
    v_mul_f32 v121, 0x3e8293ee, v121
    v_mul_f32 v122, 0x3e8293ee, v122
    v_sub_f32 v44, v44, v46
    v_sub_f32 v45, v45, v46
    v_sub_f32 v52, v52, v54
    v_sub_f32 v53, v53, v54
    v_sub_f32 v60, v60, v62
    v_sub_f32 v61, v61, v62
    v_sub_f32 v68, v68, v70
    v_sub_f32 v69, v69, v70
    v_mul_f32 v44, v119, v44
    v_mul_f32 v45, v119, v45
    v_mul_f32 v52, v120, v52
    v_mul_f32 v53, v120, v53
    v_mul_f32 v60, v121, v60
    v_mul_f32 v61, v121, v61
    v_mul_f32 v68, v122, v68
    v_mul_f32 v69, v122, v69
    v_exp_f32 v44, v44
    v_exp_f32 v45, v45
    v_exp_f32 v52, v52
    v_exp_f32 v53, v53
    v_exp_f32 v60, v60
    v_exp_f32 v61, v61
    v_exp_f32 v68, v68
    v_exp_f32 v69, v69
    .p2align 3
    v_pk_mul_f32 v[88:89], v[184:185], v[88:89] op_sel:[0,0] op_sel_hi:[1,1]
    v_pk_mul_f32 v[90:91], v[186:187], v[90:91] op_sel:[0,0] op_sel_hi:[1,1]
    v_pk_mul_f32 v[92:93], v[184:185], v[92:93] op_sel:[0,0] op_sel_hi:[1,1]
    v_pk_mul_f32 v[94:95], v[186:187], v[94:95] op_sel:[0,0] op_sel_hi:[1,1]
    v_pk_mul_f32 v[96:97], v[188:189], v[96:97] op_sel:[0,0] op_sel_hi:[1,1]
    v_pk_mul_f32 v[98:99], v[190:191], v[98:99] op_sel:[0,0] op_sel_hi:[1,1]
    v_pk_mul_f32 v[100:101], v[188:189], v[100:101] op_sel:[0,0] op_sel_hi:[1,1]
    v_pk_mul_f32 v[102:103], v[190:191], v[102:103] op_sel:[0,0] op_sel_hi:[1,1]
    v_pk_mul_f32 v[104:105], v[192:193], v[104:105] op_sel:[0,0] op_sel_hi:[1,1]
    v_pk_mul_f32 v[106:107], v[194:195], v[106:107] op_sel:[0,0] op_sel_hi:[1,1]
    v_pk_mul_f32 v[108:109], v[192:193], v[108:109] op_sel:[0,0] op_sel_hi:[1,1]
    v_pk_mul_f32 v[110:111], v[194:195], v[110:111] op_sel:[0,0] op_sel_hi:[1,1]
    v_cvt_pk_bf16_f32 v44, v44, v45
    v_cvt_pk_bf16_f32 v52, v52, v53
    v_cvt_pk_bf16_f32 v60, v60, v61
    v_cvt_pk_bf16_f32 v68, v68, v69
    v_cvt_pk_bf16_f32 v226, v72, v73
    v_cvt_pk_bf16_f32 v227, v74, v75
    v_cvt_pk_bf16_f32 v152, v76, v77
    v_cvt_pk_bf16_f32 v153, v78, v79
    v_cvt_pk_bf16_f32 v228, v80, v81
    v_cvt_pk_bf16_f32 v229, v82, v83
    v_cvt_pk_bf16_f32 v154, v84, v85
    v_cvt_pk_bf16_f32 v155, v86, v87
    v_cvt_pk_bf16_f32 v230, v88, v89
    v_cvt_pk_bf16_f32 v231, v90, v91
    v_cvt_pk_bf16_f32 v156, v92, v93
    v_cvt_pk_bf16_f32 v157, v94, v95
    v_cvt_pk_bf16_f32 v232, v96, v97
    v_cvt_pk_bf16_f32 v233, v98, v99
    v_cvt_pk_bf16_f32 v158, v100, v101
    v_cvt_pk_bf16_f32 v159, v102, v103
    v_cvt_pk_bf16_f32 v234, v104, v105
    v_cvt_pk_bf16_f32 v235, v106, v107
    v_cvt_pk_bf16_f32 v160, v108, v109
    v_cvt_pk_bf16_f32 v161, v110, v111
    v_perm_b32 v4, v44, v44, v214
    v_perm_b32 v5, v44, v44, v215
    v_perm_b32 v6, v44, v44, v216
    v_perm_b32 v7, v44, v44, v217
    v_perm_b32 v12, v52, v52, v214
    v_perm_b32 v13, v52, v52, v215
    v_perm_b32 v14, v52, v52, v216
    v_perm_b32 v15, v52, v52, v217
    v_perm_b32 v20, v60, v60, v214
    v_perm_b32 v21, v60, v60, v215
    v_perm_b32 v22, v60, v60, v216
    v_perm_b32 v23, v60, v60, v217
    v_perm_b32 v28, v68, v68, v214
    v_perm_b32 v29, v68, v68, v215
    v_perm_b32 v30, v68, v68, v216
    v_perm_b32 v31, v68, v68, v217
    s_add_u32 s55, s88, 4096
    v_mfma_f32_16x16x32_bf16 v[0:3], v[222:225], v[4:7], 0
    v_mfma_f32_16x16x32_bf16 v[8:11], v[222:225], v[12:15], 0
    v_mfma_f32_16x16x32_bf16 v[16:19], v[222:225], v[20:23], 0
    v_mfma_f32_16x16x32_bf16 v[24:27], v[222:225], v[28:31], 0
    v_mfma_f32_16x16x32_bf16 v[72:75], v[226:229], v[4:7], 0
    v_mfma_f32_16x16x32_bf16 v[76:79], v[152:155], v[4:7], 0
    v_mfma_f32_16x16x32_bf16 v[80:83], v[228:231], v[12:15], 0
    v_mfma_f32_16x16x32_bf16 v[84:87], v[154:157], v[12:15], 0
    v_mfma_f32_16x16x32_bf16 v[88:91], v[230:233], v[20:23], 0
    v_mfma_f32_16x16x32_bf16 v[92:95], v[156:159], v[20:23], 0
    v_mfma_f32_16x16x32_bf16 v[96:99], v[232:235], v[28:31], 0
    v_mfma_f32_16x16x32_bf16 v[100:103], v[158:161], v[28:31], 0
    v_rcp_f32 v0, v0
    v_rcp_f32 v8, v8
    v_rcp_f32 v16, v16
    v_rcp_f32 v24, v24
    v_pk_mul_f32 v[72:73], v[0:1], v[72:73] op_sel:[0,0] op_sel_hi:[0,1]
    v_pk_mul_f32 v[74:75], v[0:1], v[74:75] op_sel:[0,0] op_sel_hi:[0,1]
    v_pk_mul_f32 v[76:77], v[0:1], v[76:77] op_sel:[0,0] op_sel_hi:[0,1]
    v_pk_mul_f32 v[78:79], v[0:1], v[78:79] op_sel:[0,0] op_sel_hi:[0,1]
    v_cvt_pk_bf16_f32 v72, v72, v73
    v_cvt_pk_bf16_f32 v73, v74, v75
    v_cvt_pk_bf16_f32 v74, v76, v77
    v_cvt_pk_bf16_f32 v75, v78, v79
    buffer_store_dwordx4 v[72:75], v254, s[4:7], s88 offen offset:0 sc0 sc1
    v_pk_mul_f32 v[80:81], v[8:9], v[80:81] op_sel:[0,0] op_sel_hi:[0,1]
    v_pk_mul_f32 v[82:83], v[8:9], v[82:83] op_sel:[0,0] op_sel_hi:[0,1]
    v_pk_mul_f32 v[84:85], v[8:9], v[84:85] op_sel:[0,0] op_sel_hi:[0,1]
    v_pk_mul_f32 v[86:87], v[8:9], v[86:87] op_sel:[0,0] op_sel_hi:[0,1]
    v_cvt_pk_bf16_f32 v80, v80, v81
    v_cvt_pk_bf16_f32 v81, v82, v83
    v_cvt_pk_bf16_f32 v82, v84, v85
    v_cvt_pk_bf16_f32 v83, v86, v87
    buffer_store_dwordx4 v[80:83], v254, s[4:7], s88 offen offset:2048 sc0 sc1
    v_pk_mul_f32 v[88:89], v[16:17], v[88:89] op_sel:[0,0] op_sel_hi:[0,1]
    v_pk_mul_f32 v[90:91], v[16:17], v[90:91] op_sel:[0,0] op_sel_hi:[0,1]
    v_pk_mul_f32 v[92:93], v[16:17], v[92:93] op_sel:[0,0] op_sel_hi:[0,1]
    v_pk_mul_f32 v[94:95], v[16:17], v[94:95] op_sel:[0,0] op_sel_hi:[0,1]
    v_cvt_pk_bf16_f32 v88, v88, v89
    v_cvt_pk_bf16_f32 v89, v90, v91
    v_cvt_pk_bf16_f32 v90, v92, v93
    v_cvt_pk_bf16_f32 v91, v94, v95
    buffer_store_dwordx4 v[88:91], v254, s[4:7], s55 offen offset:0 sc0 sc1
    s_nop 1
    v_pk_mul_f32 v[96:97], v[24:25], v[96:97] op_sel:[0,0] op_sel_hi:[0,1]
    v_pk_mul_f32 v[98:99], v[24:25], v[98:99] op_sel:[0,0] op_sel_hi:[0,1]
    v_pk_mul_f32 v[100:101], v[24:25], v[100:101] op_sel:[0,0] op_sel_hi:[0,1]
    v_pk_mul_f32 v[102:103], v[24:25], v[102:103] op_sel:[0,0] op_sel_hi:[0,1]
    v_cvt_pk_bf16_f32 v96, v96, v97
    v_cvt_pk_bf16_f32 v97, v98, v99
    v_cvt_pk_bf16_f32 v98, v100, v101
    v_cvt_pk_bf16_f32 v99, v102, v103
    buffer_store_dwordx4 v[96:99], v254, s[4:7], s55 offen offset:2048 sc0 sc1
    s_lshl_b32 s55, s43, 13
    s_add_u32 s55, s55, 98304
    v_add_u32 v136, s55, v254
    v_lshrrev_b32 v152, 6, v254
    v_lshrrev_b32 v153, 1, v152
    v_and_b32 v153, 3, v153
    s_lshl_b32 s55, s44, 1
    v_xor_b32 v153, s55, v153
    v_lshlrev_b32 v152, 7, v152
    v_lshl_add_u32 v152, v153, 5, v152
    v_and_b32 v153, 0x30, v254
    v_lshrrev_b32 v153, 1, v153
    v_add_u32 v137, v152, v153
    v_xor_b32 v138, 32, v137
    v_add_u32 v139, 49152, v137
    v_add_u32 v140, 49152, v138
    s_cmp_lg_u32 s46, 0
    s_cbranch_scc1 g2_17
    s_waitcnt vmcnt(4)
    v_permlane16_swap_b32 v236, v238
    v_permlane16_swap_b32 v237, v239
    v_permlane16_swap_b32 v240, v242
    v_permlane16_swap_b32 v241, v243
    v_permlane16_swap_b32 v244, v246
    v_permlane16_swap_b32 v245, v247
    v_permlane16_swap_b32 v248, v250
    v_permlane16_swap_b32 v249, v251
g2_17:
    v_lshlrev_b32 v0, 16, v236
    v_and_b32 v1, 0xffff0000, v236
    v_lshlrev_b32 v2, 16, v237
    v_and_b32 v3, 0xffff0000, v237
    v_lshlrev_b32 v16, 16, v238
    v_and_b32 v17, 0xffff0000, v238
    v_lshlrev_b32 v18, 16, v239
    v_and_b32 v19, 0xffff0000, v239
    v_lshlrev_b32 v4, 16, v240
    v_and_b32 v5, 0xffff0000, v240
    v_lshlrev_b32 v6, 16, v241
    v_and_b32 v7, 0xffff0000, v241
    v_lshlrev_b32 v20, 16, v242
    v_and_b32 v21, 0xffff0000, v242
    v_lshlrev_b32 v22, 16, v243
    v_and_b32 v23, 0xffff0000, v243
    v_lshlrev_b32 v8, 16, v244
    v_and_b32 v9, 0xffff0000, v244
    v_lshlrev_b32 v10, 16, v245
    v_and_b32 v11, 0xffff0000, v245
    v_lshlrev_b32 v24, 16, v246
    v_and_b32 v25, 0xffff0000, v246
    v_lshlrev_b32 v26, 16, v247
    v_and_b32 v27, 0xffff0000, v247
    v_lshlrev_b32 v12, 16, v248
    v_and_b32 v13, 0xffff0000, v248
    v_lshlrev_b32 v14, 16, v249
    v_and_b32 v15, 0xffff0000, v249
    v_lshlrev_b32 v28, 16, v250
    v_and_b32 v29, 0xffff0000, v250
    v_lshlrev_b32 v30, 16, v251
    v_and_b32 v31, 0xffff0000, v251
    s_waitcnt vmcnt(0)
    s_barrier
    s_cmp_lg_u32 s42, 2
    s_cbranch_scc1 wf_18
    s_lshr_b32 s55, s2, 5
    s_lshl_b32 s55, s55, 2
    s_add_u32 s55, s55, s0
    v_mov_b32 v252, 0
    v_mov_b32 v253, 0x01010101
    s_mov_b64 exec, 1
    s_cmp_eq_u32 s45, 0
    s_cbranch_scc1 st_19
    buffer_store_dword v253, v252, s[4:7], s55 offen sc0 sc1
    s_branch st_20
st_19:
    buffer_store_dword v253, v252, s[4:7], s55 offen
st_20:
    s_mov_b64 exec, -1
wf_18:
    s_cmp_lg_u32 s42, 3
    s_cbranch_scc1 wf_21
    s_lshl_b32 s55, s51, 2
    s_add_u32 s55, s55, s54
    v_mov_b32 v252, 0
    v_mov_b32 v253, 0x01010101
    s_mov_b64 exec, 1
    buffer_store_dword v253, v252, s[4:7], s55 offen sc0 sc1
    s_mov_b64 exec, -1
wf_21:
    s_barrier
    ds_read_b64_tr_b16 v[104:105], v137 offset:32768
    ds_read_b64_tr_b16 v[106:107], v137 offset:34816
    ds_read_b128 v[32:35], v136 offset:0
    ds_read_b128 v[36:39], v136 offset:2048
    ds_read_b128 v[40:43], v136 offset:4096
    ds_read_b128 v[44:47], v136 offset:6144
    ds_read_b64_tr_b16 v[108:109], v138 offset:32768
    ds_read_b64_tr_b16 v[110:111], v138 offset:34816
    ds_read_b64_tr_b16 v[112:113], v137 offset:36864
    ds_read_b64_tr_b16 v[114:115], v137 offset:38912
    ds_read_b128 v[48:51], v136 offset:1024
    ds_read_b128 v[52:55], v136 offset:3072
    ds_read_b128 v[56:59], v136 offset:5120
    ds_read_b128 v[60:63], v136 offset:7168
    ds_read_b64_tr_b16 v[116:117], v138 offset:36864
    ds_read_b64_tr_b16 v[118:119], v138 offset:38912
    s_waitcnt lgkmcnt(0)
    s_barrier
    .p2align 3
    v_mfma_f32_16x16x32_bf16 v[0:3], v[104:107], v[32:35], v[0:3]
    ds_read_b64_tr_b16 v[120:121], v137 offset:40960
    ds_read_b64_tr_b16 v[122:123], v137 offset:43008
    v_mfma_f32_16x16x32_bf16 v[0:3], v[112:115], v[48:51], v[0:3]
    ds_read_b128 v[64:67], v136 offset:16384
    v_mfma_f32_16x16x32_bf16 v[4:7], v[112:115], v[52:55], v[4:7]
    ds_read_b128 v[68:71], v136 offset:18432
    v_mfma_f32_16x16x32_bf16 v[4:7], v[104:107], v[36:39], v[4:7]
    ds_read_b128 v[72:75], v136 offset:20480
    ds_read_b128 v[76:79], v136 offset:22528
    v_mfma_f32_16x16x32_bf16 v[8:11], v[104:107], v[40:43], v[8:11]
    ds_read_b64_tr_b16 v[124:125], v138 offset:40960
    v_mfma_f32_16x16x32_bf16 v[8:11], v[112:115], v[56:59], v[8:11]
    ds_read_b64_tr_b16 v[126:127], v138 offset:43008
    v_mfma_f32_16x16x32_bf16 v[12:15], v[112:115], v[60:63], v[12:15]
    ds_read_b64_tr_b16 v[128:129], v137 offset:45056
    ds_read_b64_tr_b16 v[130:131], v137 offset:47104
    v_mfma_f32_16x16x32_bf16 v[12:15], v[104:107], v[44:47], v[12:15]
    ds_read_b128 v[80:83], v136 offset:17408
    v_mfma_f32_16x16x32_bf16 v[28:31], v[108:111], v[44:47], v[28:31]
    ds_read_b128 v[84:87], v136 offset:19456
    v_mfma_f32_16x16x32_bf16 v[28:31], v[116:119], v[60:63], v[28:31]
    ds_read_b128 v[88:91], v136 offset:21504
    ds_read_b128 v[92:95], v136 offset:23552
    v_mfma_f32_16x16x32_bf16 v[24:27], v[116:119], v[56:59], v[24:27]
    ds_read_b64_tr_b16 v[132:133], v138 offset:45056
    v_mfma_f32_16x16x32_bf16 v[24:27], v[108:111], v[40:43], v[24:27]
    ds_read_b64_tr_b16 v[134:135], v138 offset:47104
    v_mfma_f32_16x16x32_bf16 v[20:23], v[108:111], v[36:39], v[20:23]
    v_mfma_f32_16x16x32_bf16 v[20:23], v[116:119], v[52:55], v[20:23]
    v_mfma_f32_16x16x32_bf16 v[16:19], v[116:119], v[48:51], v[16:19]
    v_mfma_f32_16x16x32_bf16 v[16:19], v[108:111], v[32:35], v[16:19]
    s_waitcnt lgkmcnt(0)
    s_barrier
    .p2align 3
    v_mfma_f32_16x16x32_bf16 v[0:3], v[120:123], v[64:67], v[0:3]
    ds_read_b64_tr_b16 v[104:105], v139 offset:0
    ds_read_b64_tr_b16 v[106:107], v139 offset:2048
    v_mfma_f32_16x16x32_bf16 v[0:3], v[128:131], v[80:83], v[0:3]
    ds_read_b128 v[32:35], v136 offset:32768
    v_mfma_f32_16x16x32_bf16 v[4:7], v[128:131], v[84:87], v[4:7]
    ds_read_b128 v[36:39], v136 offset:34816
    v_mfma_f32_16x16x32_bf16 v[4:7], v[120:123], v[68:71], v[4:7]
    ds_read_b128 v[40:43], v136 offset:36864
    ds_read_b128 v[44:47], v136 offset:38912
    v_mfma_f32_16x16x32_bf16 v[8:11], v[120:123], v[72:75], v[8:11]
    ds_read_b64_tr_b16 v[108:109], v140 offset:0
    v_mfma_f32_16x16x32_bf16 v[8:11], v[128:131], v[88:91], v[8:11]
    ds_read_b64_tr_b16 v[110:111], v140 offset:2048
    v_mfma_f32_16x16x32_bf16 v[12:15], v[128:131], v[92:95], v[12:15]
    ds_read_b64_tr_b16 v[112:113], v139 offset:4096
    ds_read_b64_tr_b16 v[114:115], v139 offset:6144
    v_mfma_f32_16x16x32_bf16 v[12:15], v[120:123], v[76:79], v[12:15]
    ds_read_b128 v[48:51], v136 offset:33792
    v_mfma_f32_16x16x32_bf16 v[28:31], v[124:127], v[76:79], v[28:31]
    ds_read_b128 v[52:55], v136 offset:35840
    v_mfma_f32_16x16x32_bf16 v[28:31], v[132:135], v[92:95], v[28:31]
    ds_read_b128 v[56:59], v136 offset:37888
    ds_read_b128 v[60:63], v136 offset:39936
    v_mfma_f32_16x16x32_bf16 v[24:27], v[132:135], v[88:91], v[24:27]
    ds_read_b64_tr_b16 v[116:117], v140 offset:4096
    v_mfma_f32_16x16x32_bf16 v[24:27], v[124:127], v[72:75], v[24:27]
    ds_read_b64_tr_b16 v[118:119], v140 offset:6144
    v_mfma_f32_16x16x32_bf16 v[20:23], v[124:127], v[68:71], v[20:23]
    v_mfma_f32_16x16x32_bf16 v[20:23], v[132:135], v[84:87], v[20:23]
    v_mfma_f32_16x16x32_bf16 v[16:19], v[132:135], v[80:83], v[16:19]
    v_mfma_f32_16x16x32_bf16 v[16:19], v[124:127], v[64:67], v[16:19]
    s_waitcnt lgkmcnt(0)
    s_barrier
    .p2align 3
    v_mfma_f32_16x16x32_bf16 v[0:3], v[104:107], v[32:35], v[0:3]
    ds_read_b64_tr_b16 v[120:121], v139 offset:8192
    ds_read_b64_tr_b16 v[122:123], v139 offset:10240
    v_mfma_f32_16x16x32_bf16 v[0:3], v[112:115], v[48:51], v[0:3]
    ds_read_b128 v[64:67], v136 offset:0
    v_mfma_f32_16x16x32_bf16 v[4:7], v[112:115], v[52:55], v[4:7]
    ds_read_b128 v[68:71], v136 offset:2048
    v_mfma_f32_16x16x32_bf16 v[4:7], v[104:107], v[36:39], v[4:7]
    ds_read_b128 v[72:75], v136 offset:4096
    ds_read_b128 v[76:79], v136 offset:6144
    v_mfma_f32_16x16x32_bf16 v[8:11], v[104:107], v[40:43], v[8:11]
    ds_read_b64_tr_b16 v[124:125], v140 offset:8192
    v_mfma_f32_16x16x32_bf16 v[8:11], v[112:115], v[56:59], v[8:11]
    ds_read_b64_tr_b16 v[126:127], v140 offset:10240
    v_mfma_f32_16x16x32_bf16 v[12:15], v[112:115], v[60:63], v[12:15]
    ds_read_b64_tr_b16 v[128:129], v139 offset:12288
    ds_read_b64_tr_b16 v[130:131], v139 offset:14336
    v_mfma_f32_16x16x32_bf16 v[12:15], v[104:107], v[44:47], v[12:15]
    ds_read_b128 v[80:83], v136 offset:1024
    v_mfma_f32_16x16x32_bf16 v[28:31], v[108:111], v[44:47], v[28:31]
    ds_read_b128 v[84:87], v136 offset:3072
    v_mfma_f32_16x16x32_bf16 v[28:31], v[116:119], v[60:63], v[28:31]
    ds_read_b128 v[88:91], v136 offset:5120
    ds_read_b128 v[92:95], v136 offset:7168
    v_mfma_f32_16x16x32_bf16 v[24:27], v[116:119], v[56:59], v[24:27]
    ds_read_b64_tr_b16 v[132:133], v140 offset:12288
    v_mfma_f32_16x16x32_bf16 v[24:27], v[108:111], v[40:43], v[24:27]
    ds_read_b64_tr_b16 v[134:135], v140 offset:14336
    v_mfma_f32_16x16x32_bf16 v[20:23], v[108:111], v[36:39], v[20:23]
    v_mfma_f32_16x16x32_bf16 v[20:23], v[116:119], v[52:55], v[20:23]
    v_mfma_f32_16x16x32_bf16 v[16:19], v[116:119], v[48:51], v[16:19]
    v_mfma_f32_16x16x32_bf16 v[16:19], v[108:111], v[32:35], v[16:19]
    s_waitcnt lgkmcnt(0)
    s_barrier
    .p2align 3
    v_mfma_f32_16x16x32_bf16 v[0:3], v[120:123], v[64:67], v[0:3]
    ds_read_b64_tr_b16 v[104:105], v139 offset:16384
    ds_read_b64_tr_b16 v[106:107], v139 offset:18432
    v_mfma_f32_16x16x32_bf16 v[0:3], v[128:131], v[80:83], v[0:3]
    ds_read_b128 v[32:35], v136 offset:16384
    v_mfma_f32_16x16x32_bf16 v[4:7], v[128:131], v[84:87], v[4:7]
    ds_read_b128 v[36:39], v136 offset:18432
    v_mfma_f32_16x16x32_bf16 v[4:7], v[120:123], v[68:71], v[4:7]
    ds_read_b128 v[40:43], v136 offset:20480
    ds_read_b128 v[44:47], v136 offset:22528
    v_mfma_f32_16x16x32_bf16 v[8:11], v[120:123], v[72:75], v[8:11]
    ds_read_b64_tr_b16 v[108:109], v140 offset:16384
    v_mfma_f32_16x16x32_bf16 v[8:11], v[128:131], v[88:91], v[8:11]
    ds_read_b64_tr_b16 v[110:111], v140 offset:18432
    v_mfma_f32_16x16x32_bf16 v[12:15], v[128:131], v[92:95], v[12:15]
    ds_read_b64_tr_b16 v[112:113], v139 offset:20480
    ds_read_b64_tr_b16 v[114:115], v139 offset:22528
    v_mfma_f32_16x16x32_bf16 v[12:15], v[120:123], v[76:79], v[12:15]
    ds_read_b128 v[48:51], v136 offset:17408
    v_mfma_f32_16x16x32_bf16 v[28:31], v[124:127], v[76:79], v[28:31]
    ds_read_b128 v[52:55], v136 offset:19456
    v_mfma_f32_16x16x32_bf16 v[28:31], v[132:135], v[92:95], v[28:31]
    ds_read_b128 v[56:59], v136 offset:21504
    ds_read_b128 v[60:63], v136 offset:23552
    v_mfma_f32_16x16x32_bf16 v[24:27], v[132:135], v[88:91], v[24:27]
    ds_read_b64_tr_b16 v[116:117], v140 offset:20480
    v_mfma_f32_16x16x32_bf16 v[24:27], v[124:127], v[72:75], v[24:27]
    ds_read_b64_tr_b16 v[118:119], v140 offset:22528
    v_mfma_f32_16x16x32_bf16 v[20:23], v[124:127], v[68:71], v[20:23]
    v_mfma_f32_16x16x32_bf16 v[20:23], v[132:135], v[84:87], v[20:23]
    v_mfma_f32_16x16x32_bf16 v[16:19], v[132:135], v[80:83], v[16:19]
    v_mfma_f32_16x16x32_bf16 v[16:19], v[124:127], v[64:67], v[16:19]
    s_waitcnt lgkmcnt(0)
    s_barrier
    .p2align 3
    v_mfma_f32_16x16x32_bf16 v[0:3], v[104:107], v[32:35], v[0:3]
    ds_read_b64_tr_b16 v[120:121], v139 offset:24576
    ds_read_b64_tr_b16 v[122:123], v139 offset:26624
    v_mfma_f32_16x16x32_bf16 v[0:3], v[112:115], v[48:51], v[0:3]
    ds_read_b128 v[64:67], v136 offset:32768
    v_mfma_f32_16x16x32_bf16 v[4:7], v[112:115], v[52:55], v[4:7]
    ds_read_b128 v[68:71], v136 offset:34816
    v_mfma_f32_16x16x32_bf16 v[4:7], v[104:107], v[36:39], v[4:7]
    ds_read_b128 v[72:75], v136 offset:36864
    ds_read_b128 v[76:79], v136 offset:38912
    v_mfma_f32_16x16x32_bf16 v[8:11], v[104:107], v[40:43], v[8:11]
    ds_read_b64_tr_b16 v[124:125], v140 offset:24576
    v_mfma_f32_16x16x32_bf16 v[8:11], v[112:115], v[56:59], v[8:11]
    ds_read_b64_tr_b16 v[126:127], v140 offset:26624
    v_mfma_f32_16x16x32_bf16 v[12:15], v[112:115], v[60:63], v[12:15]
    ds_read_b64_tr_b16 v[128:129], v139 offset:28672
    ds_read_b64_tr_b16 v[130:131], v139 offset:30720
    v_mfma_f32_16x16x32_bf16 v[12:15], v[104:107], v[44:47], v[12:15]
    ds_read_b128 v[80:83], v136 offset:33792
    v_mfma_f32_16x16x32_bf16 v[28:31], v[108:111], v[44:47], v[28:31]
    ds_read_b128 v[84:87], v136 offset:35840
    v_mfma_f32_16x16x32_bf16 v[28:31], v[116:119], v[60:63], v[28:31]
    ds_read_b128 v[88:91], v136 offset:37888
    ds_read_b128 v[92:95], v136 offset:39936
    v_mfma_f32_16x16x32_bf16 v[24:27], v[116:119], v[56:59], v[24:27]
    ds_read_b64_tr_b16 v[132:133], v140 offset:28672
    v_mfma_f32_16x16x32_bf16 v[24:27], v[108:111], v[40:43], v[24:27]
    ds_read_b64_tr_b16 v[134:135], v140 offset:30720
    v_mfma_f32_16x16x32_bf16 v[20:23], v[108:111], v[36:39], v[20:23]
    v_mfma_f32_16x16x32_bf16 v[20:23], v[116:119], v[52:55], v[20:23]
    v_mfma_f32_16x16x32_bf16 v[16:19], v[116:119], v[48:51], v[16:19]
    v_mfma_f32_16x16x32_bf16 v[16:19], v[108:111], v[32:35], v[16:19]
    s_waitcnt lgkmcnt(0)
    s_barrier
    .p2align 3
    v_mfma_f32_16x16x32_bf16 v[0:3], v[120:123], v[64:67], v[0:3]
    ds_read_b64_tr_b16 v[104:105], v139 offset:32768
    ds_read_b64_tr_b16 v[106:107], v139 offset:34816
    v_mfma_f32_16x16x32_bf16 v[0:3], v[128:131], v[80:83], v[0:3]
    ds_read_b128 v[32:35], v136 offset:0
    v_mfma_f32_16x16x32_bf16 v[4:7], v[128:131], v[84:87], v[4:7]
    ds_read_b128 v[36:39], v136 offset:2048
    v_mfma_f32_16x16x32_bf16 v[4:7], v[120:123], v[68:71], v[4:7]
    ds_read_b128 v[40:43], v136 offset:4096
    ds_read_b128 v[44:47], v136 offset:6144
    v_mfma_f32_16x16x32_bf16 v[8:11], v[120:123], v[72:75], v[8:11]
    ds_read_b64_tr_b16 v[108:109], v140 offset:32768
    v_mfma_f32_16x16x32_bf16 v[8:11], v[128:131], v[88:91], v[8:11]
    ds_read_b64_tr_b16 v[110:111], v140 offset:34816
    v_mfma_f32_16x16x32_bf16 v[12:15], v[128:131], v[92:95], v[12:15]
    ds_read_b64_tr_b16 v[112:113], v139 offset:36864
    ds_read_b64_tr_b16 v[114:115], v139 offset:38912
    v_mfma_f32_16x16x32_bf16 v[12:15], v[120:123], v[76:79], v[12:15]
    ds_read_b128 v[48:51], v136 offset:1024
    v_mfma_f32_16x16x32_bf16 v[28:31], v[124:127], v[76:79], v[28:31]
    ds_read_b128 v[52:55], v136 offset:3072
    v_mfma_f32_16x16x32_bf16 v[28:31], v[132:135], v[92:95], v[28:31]
    ds_read_b128 v[56:59], v136 offset:5120
    ds_read_b128 v[60:63], v136 offset:7168
    v_mfma_f32_16x16x32_bf16 v[24:27], v[132:135], v[88:91], v[24:27]
    ds_read_b64_tr_b16 v[116:117], v140 offset:36864
    v_mfma_f32_16x16x32_bf16 v[24:27], v[124:127], v[72:75], v[24:27]
    ds_read_b64_tr_b16 v[118:119], v140 offset:38912
    v_mfma_f32_16x16x32_bf16 v[20:23], v[124:127], v[68:71], v[20:23]
    v_mfma_f32_16x16x32_bf16 v[20:23], v[132:135], v[84:87], v[20:23]
    v_mfma_f32_16x16x32_bf16 v[16:19], v[132:135], v[80:83], v[16:19]
    v_mfma_f32_16x16x32_bf16 v[16:19], v[124:127], v[64:67], v[16:19]
    s_waitcnt lgkmcnt(0)
    s_barrier
    .p2align 3
    v_mfma_f32_16x16x32_bf16 v[0:3], v[104:107], v[32:35], v[0:3]
    ds_read_b64_tr_b16 v[120:121], v139 offset:40960
    ds_read_b64_tr_b16 v[122:123], v139 offset:43008
    v_mfma_f32_16x16x32_bf16 v[0:3], v[112:115], v[48:51], v[0:3]
    ds_read_b128 v[64:67], v136 offset:16384
    v_mfma_f32_16x16x32_bf16 v[4:7], v[112:115], v[52:55], v[4:7]
    ds_read_b128 v[68:71], v136 offset:18432
    v_mfma_f32_16x16x32_bf16 v[4:7], v[104:107], v[36:39], v[4:7]
    ds_read_b128 v[72:75], v136 offset:20480
    ds_read_b128 v[76:79], v136 offset:22528
    v_mfma_f32_16x16x32_bf16 v[8:11], v[104:107], v[40:43], v[8:11]
    ds_read_b64_tr_b16 v[124:125], v140 offset:40960
    v_mfma_f32_16x16x32_bf16 v[8:11], v[112:115], v[56:59], v[8:11]
    ds_read_b64_tr_b16 v[126:127], v140 offset:43008
    v_mfma_f32_16x16x32_bf16 v[12:15], v[112:115], v[60:63], v[12:15]
    ds_read_b64_tr_b16 v[128:129], v139 offset:45056
    ds_read_b64_tr_b16 v[130:131], v139 offset:47104
    v_mfma_f32_16x16x32_bf16 v[12:15], v[104:107], v[44:47], v[12:15]
    ds_read_b128 v[80:83], v136 offset:17408
    v_mfma_f32_16x16x32_bf16 v[28:31], v[108:111], v[44:47], v[28:31]
    ds_read_b128 v[84:87], v136 offset:19456
    v_mfma_f32_16x16x32_bf16 v[28:31], v[116:119], v[60:63], v[28:31]
    ds_read_b128 v[88:91], v136 offset:21504
    ds_read_b128 v[92:95], v136 offset:23552
    v_mfma_f32_16x16x32_bf16 v[24:27], v[116:119], v[56:59], v[24:27]
    ds_read_b64_tr_b16 v[132:133], v140 offset:45056
    v_mfma_f32_16x16x32_bf16 v[24:27], v[108:111], v[40:43], v[24:27]
    ds_read_b64_tr_b16 v[134:135], v140 offset:47104
    v_mfma_f32_16x16x32_bf16 v[20:23], v[108:111], v[36:39], v[20:23]
    v_mfma_f32_16x16x32_bf16 v[20:23], v[116:119], v[52:55], v[20:23]
    v_mfma_f32_16x16x32_bf16 v[16:19], v[116:119], v[48:51], v[16:19]
    v_mfma_f32_16x16x32_bf16 v[16:19], v[108:111], v[32:35], v[16:19]
    s_waitcnt lgkmcnt(0)
    s_barrier
    .p2align 3
    v_mfma_f32_16x16x32_bf16 v[0:3], v[120:123], v[64:67], v[0:3]
    ds_read_b64_tr_b16 v[104:105], v137 offset:0
    ds_read_b64_tr_b16 v[106:107], v137 offset:2048
    v_mfma_f32_16x16x32_bf16 v[0:3], v[128:131], v[80:83], v[0:3]
    ds_read_b128 v[32:35], v136 offset:32768
    v_mfma_f32_16x16x32_bf16 v[4:7], v[128:131], v[84:87], v[4:7]
    ds_read_b128 v[36:39], v136 offset:34816
    v_mfma_f32_16x16x32_bf16 v[4:7], v[120:123], v[68:71], v[4:7]
    ds_read_b128 v[40:43], v136 offset:36864
    ds_read_b128 v[44:47], v136 offset:38912
    v_mfma_f32_16x16x32_bf16 v[8:11], v[120:123], v[72:75], v[8:11]
    ds_read_b64_tr_b16 v[108:109], v138 offset:0
    v_mfma_f32_16x16x32_bf16 v[8:11], v[128:131], v[88:91], v[8:11]
    ds_read_b64_tr_b16 v[110:111], v138 offset:2048
    v_mfma_f32_16x16x32_bf16 v[12:15], v[128:131], v[92:95], v[12:15]
    ds_read_b64_tr_b16 v[112:113], v137 offset:4096
    ds_read_b64_tr_b16 v[114:115], v137 offset:6144
    v_mfma_f32_16x16x32_bf16 v[12:15], v[120:123], v[76:79], v[12:15]
    ds_read_b128 v[48:51], v136 offset:33792
    v_mfma_f32_16x16x32_bf16 v[28:31], v[124:127], v[76:79], v[28:31]
    ds_read_b128 v[52:55], v136 offset:35840
    v_mfma_f32_16x16x32_bf16 v[28:31], v[132:135], v[92:95], v[28:31]
    ds_read_b128 v[56:59], v136 offset:37888
    ds_read_b128 v[60:63], v136 offset:39936
    v_mfma_f32_16x16x32_bf16 v[24:27], v[132:135], v[88:91], v[24:27]
    ds_read_b64_tr_b16 v[116:117], v138 offset:4096
    v_mfma_f32_16x16x32_bf16 v[24:27], v[124:127], v[72:75], v[24:27]
    ds_read_b64_tr_b16 v[118:119], v138 offset:6144
    v_mfma_f32_16x16x32_bf16 v[20:23], v[124:127], v[68:71], v[20:23]
    v_mfma_f32_16x16x32_bf16 v[20:23], v[132:135], v[84:87], v[20:23]
    v_mfma_f32_16x16x32_bf16 v[16:19], v[132:135], v[80:83], v[16:19]
    v_mfma_f32_16x16x32_bf16 v[16:19], v[124:127], v[64:67], v[16:19]
    s_waitcnt lgkmcnt(0)
    s_barrier
    .p2align 3
    v_mfma_f32_16x16x32_bf16 v[0:3], v[104:107], v[32:35], v[0:3]
    ds_read_b64_tr_b16 v[120:121], v137 offset:8192
    ds_read_b64_tr_b16 v[122:123], v137 offset:10240
    v_mfma_f32_16x16x32_bf16 v[0:3], v[112:115], v[48:51], v[0:3]
    ds_read_b128 v[64:67], v136 offset:0
    v_mfma_f32_16x16x32_bf16 v[4:7], v[112:115], v[52:55], v[4:7]
    ds_read_b128 v[68:71], v136 offset:2048
    v_mfma_f32_16x16x32_bf16 v[4:7], v[104:107], v[36:39], v[4:7]
    ds_read_b128 v[72:75], v136 offset:4096
    ds_read_b128 v[76:79], v136 offset:6144
    v_mfma_f32_16x16x32_bf16 v[8:11], v[104:107], v[40:43], v[8:11]
    ds_read_b64_tr_b16 v[124:125], v138 offset:8192
    v_mfma_f32_16x16x32_bf16 v[8:11], v[112:115], v[56:59], v[8:11]
    ds_read_b64_tr_b16 v[126:127], v138 offset:10240
    v_mfma_f32_16x16x32_bf16 v[12:15], v[112:115], v[60:63], v[12:15]
    ds_read_b64_tr_b16 v[128:129], v137 offset:12288
    ds_read_b64_tr_b16 v[130:131], v137 offset:14336
    v_mfma_f32_16x16x32_bf16 v[12:15], v[104:107], v[44:47], v[12:15]
    ds_read_b128 v[80:83], v136 offset:1024
    v_mfma_f32_16x16x32_bf16 v[28:31], v[108:111], v[44:47], v[28:31]
    ds_read_b128 v[84:87], v136 offset:3072
    v_mfma_f32_16x16x32_bf16 v[28:31], v[116:119], v[60:63], v[28:31]
    ds_read_b128 v[88:91], v136 offset:5120
    ds_read_b128 v[92:95], v136 offset:7168
    v_mfma_f32_16x16x32_bf16 v[24:27], v[116:119], v[56:59], v[24:27]
    ds_read_b64_tr_b16 v[132:133], v138 offset:12288
    v_mfma_f32_16x16x32_bf16 v[24:27], v[108:111], v[40:43], v[24:27]
    ds_read_b64_tr_b16 v[134:135], v138 offset:14336
    v_mfma_f32_16x16x32_bf16 v[20:23], v[108:111], v[36:39], v[20:23]
    v_mfma_f32_16x16x32_bf16 v[20:23], v[116:119], v[52:55], v[20:23]
    v_mfma_f32_16x16x32_bf16 v[16:19], v[116:119], v[48:51], v[16:19]
    v_mfma_f32_16x16x32_bf16 v[16:19], v[108:111], v[32:35], v[16:19]
    s_waitcnt lgkmcnt(0)
    s_barrier
    .p2align 3
    v_mfma_f32_16x16x32_bf16 v[0:3], v[120:123], v[64:67], v[0:3]
    ds_read_b64_tr_b16 v[104:105], v137 offset:16384
    ds_read_b64_tr_b16 v[106:107], v137 offset:18432
    v_mfma_f32_16x16x32_bf16 v[0:3], v[128:131], v[80:83], v[0:3]
    ds_read_b128 v[32:35], v136 offset:16384
    v_mfma_f32_16x16x32_bf16 v[4:7], v[128:131], v[84:87], v[4:7]
    ds_read_b128 v[36:39], v136 offset:18432
    v_mfma_f32_16x16x32_bf16 v[4:7], v[120:123], v[68:71], v[4:7]
    ds_read_b128 v[40:43], v136 offset:20480
    ds_read_b128 v[44:47], v136 offset:22528
    v_mfma_f32_16x16x32_bf16 v[8:11], v[120:123], v[72:75], v[8:11]
    ds_read_b64_tr_b16 v[108:109], v138 offset:16384
    v_mfma_f32_16x16x32_bf16 v[8:11], v[128:131], v[88:91], v[8:11]
    ds_read_b64_tr_b16 v[110:111], v138 offset:18432
    v_mfma_f32_16x16x32_bf16 v[12:15], v[128:131], v[92:95], v[12:15]
    ds_read_b64_tr_b16 v[112:113], v137 offset:20480
    ds_read_b64_tr_b16 v[114:115], v137 offset:22528
    v_mfma_f32_16x16x32_bf16 v[12:15], v[120:123], v[76:79], v[12:15]
    ds_read_b128 v[48:51], v136 offset:17408
    v_mfma_f32_16x16x32_bf16 v[28:31], v[124:127], v[76:79], v[28:31]
    ds_read_b128 v[52:55], v136 offset:19456
    v_mfma_f32_16x16x32_bf16 v[28:31], v[132:135], v[92:95], v[28:31]
    ds_read_b128 v[56:59], v136 offset:21504
    ds_read_b128 v[60:63], v136 offset:23552
    v_mfma_f32_16x16x32_bf16 v[24:27], v[132:135], v[88:91], v[24:27]
    ds_read_b64_tr_b16 v[116:117], v138 offset:20480
    v_mfma_f32_16x16x32_bf16 v[24:27], v[124:127], v[72:75], v[24:27]
    ds_read_b64_tr_b16 v[118:119], v138 offset:22528
    v_mfma_f32_16x16x32_bf16 v[20:23], v[124:127], v[68:71], v[20:23]
    v_mfma_f32_16x16x32_bf16 v[20:23], v[132:135], v[84:87], v[20:23]
    v_mfma_f32_16x16x32_bf16 v[16:19], v[132:135], v[80:83], v[16:19]
    v_mfma_f32_16x16x32_bf16 v[16:19], v[124:127], v[64:67], v[16:19]
    s_waitcnt lgkmcnt(0)
    s_barrier
    .p2align 3
    v_mfma_f32_16x16x32_bf16 v[0:3], v[104:107], v[32:35], v[0:3]
    ds_read_b64_tr_b16 v[120:121], v137 offset:24576
    ds_read_b64_tr_b16 v[122:123], v137 offset:26624
    v_mfma_f32_16x16x32_bf16 v[0:3], v[112:115], v[48:51], v[0:3]
    ds_read_b128 v[64:67], v136 offset:32768
    v_mfma_f32_16x16x32_bf16 v[4:7], v[112:115], v[52:55], v[4:7]
    ds_read_b128 v[68:71], v136 offset:34816
    v_mfma_f32_16x16x32_bf16 v[4:7], v[104:107], v[36:39], v[4:7]
    ds_read_b128 v[72:75], v136 offset:36864
    ds_read_b128 v[76:79], v136 offset:38912
    v_mfma_f32_16x16x32_bf16 v[8:11], v[104:107], v[40:43], v[8:11]
    ds_read_b64_tr_b16 v[124:125], v138 offset:24576
    v_mfma_f32_16x16x32_bf16 v[8:11], v[112:115], v[56:59], v[8:11]
    ds_read_b64_tr_b16 v[126:127], v138 offset:26624
    v_mfma_f32_16x16x32_bf16 v[12:15], v[112:115], v[60:63], v[12:15]
    ds_read_b64_tr_b16 v[128:129], v137 offset:28672
    ds_read_b64_tr_b16 v[130:131], v137 offset:30720
    v_mfma_f32_16x16x32_bf16 v[12:15], v[104:107], v[44:47], v[12:15]
    ds_read_b128 v[80:83], v136 offset:33792
    v_mfma_f32_16x16x32_bf16 v[28:31], v[108:111], v[44:47], v[28:31]
    ds_read_b128 v[84:87], v136 offset:35840
    v_mfma_f32_16x16x32_bf16 v[28:31], v[116:119], v[60:63], v[28:31]
    ds_read_b128 v[88:91], v136 offset:37888
    ds_read_b128 v[92:95], v136 offset:39936
    v_mfma_f32_16x16x32_bf16 v[24:27], v[116:119], v[56:59], v[24:27]
    ds_read_b64_tr_b16 v[132:133], v138 offset:28672
    v_mfma_f32_16x16x32_bf16 v[24:27], v[108:111], v[40:43], v[24:27]
    ds_read_b64_tr_b16 v[134:135], v138 offset:30720
    v_mfma_f32_16x16x32_bf16 v[20:23], v[108:111], v[36:39], v[20:23]
    v_mfma_f32_16x16x32_bf16 v[20:23], v[116:119], v[52:55], v[20:23]
    v_mfma_f32_16x16x32_bf16 v[16:19], v[116:119], v[48:51], v[16:19]
    v_mfma_f32_16x16x32_bf16 v[16:19], v[108:111], v[32:35], v[16:19]
    s_waitcnt lgkmcnt(0)
    s_barrier
    .p2align 3
    v_mfma_f32_16x16x32_bf16 v[0:3], v[120:123], v[64:67], v[0:3]
    ds_read_b64_tr_b16 v[104:105], v137 offset:32768
    ds_read_b64_tr_b16 v[106:107], v137 offset:34816
    v_mfma_f32_16x16x32_bf16 v[0:3], v[128:131], v[80:83], v[0:3]
    ds_read_b128 v[32:35], v136 offset:0
    v_mfma_f32_16x16x32_bf16 v[4:7], v[128:131], v[84:87], v[4:7]
    ds_read_b128 v[36:39], v136 offset:2048
    v_mfma_f32_16x16x32_bf16 v[4:7], v[120:123], v[68:71], v[4:7]
    ds_read_b128 v[40:43], v136 offset:4096
    ds_read_b128 v[44:47], v136 offset:6144
    v_mfma_f32_16x16x32_bf16 v[8:11], v[120:123], v[72:75], v[8:11]
    ds_read_b64_tr_b16 v[108:109], v138 offset:32768
    v_mfma_f32_16x16x32_bf16 v[8:11], v[128:131], v[88:91], v[8:11]
    ds_read_b64_tr_b16 v[110:111], v138 offset:34816
    v_mfma_f32_16x16x32_bf16 v[12:15], v[128:131], v[92:95], v[12:15]
    ds_read_b64_tr_b16 v[112:113], v137 offset:36864
    ds_read_b64_tr_b16 v[114:115], v137 offset:38912
    v_mfma_f32_16x16x32_bf16 v[12:15], v[120:123], v[76:79], v[12:15]
    ds_read_b128 v[48:51], v136 offset:1024
    v_mfma_f32_16x16x32_bf16 v[28:31], v[124:127], v[76:79], v[28:31]
    ds_read_b128 v[52:55], v136 offset:3072
    v_mfma_f32_16x16x32_bf16 v[28:31], v[132:135], v[92:95], v[28:31]
    ds_read_b128 v[56:59], v136 offset:5120
    ds_read_b128 v[60:63], v136 offset:7168
    v_mfma_f32_16x16x32_bf16 v[24:27], v[132:135], v[88:91], v[24:27]
    ds_read_b64_tr_b16 v[116:117], v138 offset:36864
    v_mfma_f32_16x16x32_bf16 v[24:27], v[124:127], v[72:75], v[24:27]
    ds_read_b64_tr_b16 v[118:119], v138 offset:38912
    v_mfma_f32_16x16x32_bf16 v[20:23], v[124:127], v[68:71], v[20:23]
    v_mfma_f32_16x16x32_bf16 v[20:23], v[132:135], v[84:87], v[20:23]
    v_mfma_f32_16x16x32_bf16 v[16:19], v[132:135], v[80:83], v[16:19]
    v_mfma_f32_16x16x32_bf16 v[16:19], v[124:127], v[64:67], v[16:19]
    s_waitcnt lgkmcnt(0)
    s_barrier
    .p2align 3
    v_mfma_f32_16x16x32_bf16 v[0:3], v[104:107], v[32:35], v[0:3]
    ds_read_b64_tr_b16 v[120:121], v137 offset:40960
    ds_read_b64_tr_b16 v[122:123], v137 offset:43008
    v_mfma_f32_16x16x32_bf16 v[0:3], v[112:115], v[48:51], v[0:3]
    ds_read_b128 v[64:67], v136 offset:16384
    v_mfma_f32_16x16x32_bf16 v[4:7], v[112:115], v[52:55], v[4:7]
    ds_read_b128 v[68:71], v136 offset:18432
    v_mfma_f32_16x16x32_bf16 v[4:7], v[104:107], v[36:39], v[4:7]
    ds_read_b128 v[72:75], v136 offset:20480
    ds_read_b128 v[76:79], v136 offset:22528
    v_mfma_f32_16x16x32_bf16 v[8:11], v[104:107], v[40:43], v[8:11]
    ds_read_b64_tr_b16 v[124:125], v138 offset:40960
    v_mfma_f32_16x16x32_bf16 v[8:11], v[112:115], v[56:59], v[8:11]
    ds_read_b64_tr_b16 v[126:127], v138 offset:43008
    v_mfma_f32_16x16x32_bf16 v[12:15], v[112:115], v[60:63], v[12:15]
    ds_read_b64_tr_b16 v[128:129], v137 offset:45056
    ds_read_b64_tr_b16 v[130:131], v137 offset:47104
    v_mfma_f32_16x16x32_bf16 v[12:15], v[104:107], v[44:47], v[12:15]
    ds_read_b128 v[80:83], v136 offset:17408
    v_mfma_f32_16x16x32_bf16 v[28:31], v[108:111], v[44:47], v[28:31]
    ds_read_b128 v[84:87], v136 offset:19456
    v_mfma_f32_16x16x32_bf16 v[28:31], v[116:119], v[60:63], v[28:31]
    ds_read_b128 v[88:91], v136 offset:21504
    ds_read_b128 v[92:95], v136 offset:23552
    v_mfma_f32_16x16x32_bf16 v[24:27], v[116:119], v[56:59], v[24:27]
    ds_read_b64_tr_b16 v[132:133], v138 offset:45056
    v_mfma_f32_16x16x32_bf16 v[24:27], v[108:111], v[40:43], v[24:27]
    ds_read_b64_tr_b16 v[134:135], v138 offset:47104
    v_mfma_f32_16x16x32_bf16 v[20:23], v[108:111], v[36:39], v[20:23]
    v_mfma_f32_16x16x32_bf16 v[20:23], v[116:119], v[52:55], v[20:23]
    v_mfma_f32_16x16x32_bf16 v[16:19], v[116:119], v[48:51], v[16:19]
    v_mfma_f32_16x16x32_bf16 v[16:19], v[108:111], v[32:35], v[16:19]
    s_waitcnt lgkmcnt(0)
    s_barrier
    .p2align 3
    v_mfma_f32_16x16x32_bf16 v[0:3], v[120:123], v[64:67], v[0:3]
    ds_read_b64_tr_b16 v[104:105], v139 offset:0
    ds_read_b64_tr_b16 v[106:107], v139 offset:2048
    v_mfma_f32_16x16x32_bf16 v[0:3], v[128:131], v[80:83], v[0:3]
    ds_read_b128 v[32:35], v136 offset:32768
    v_mfma_f32_16x16x32_bf16 v[4:7], v[128:131], v[84:87], v[4:7]
    ds_read_b128 v[36:39], v136 offset:34816
    v_mfma_f32_16x16x32_bf16 v[4:7], v[120:123], v[68:71], v[4:7]
    ds_read_b128 v[40:43], v136 offset:36864
    ds_read_b128 v[44:47], v136 offset:38912
    v_mfma_f32_16x16x32_bf16 v[8:11], v[120:123], v[72:75], v[8:11]
    ds_read_b64_tr_b16 v[108:109], v140 offset:0
    v_mfma_f32_16x16x32_bf16 v[8:11], v[128:131], v[88:91], v[8:11]
    ds_read_b64_tr_b16 v[110:111], v140 offset:2048
    v_mfma_f32_16x16x32_bf16 v[12:15], v[128:131], v[92:95], v[12:15]
    ds_read_b64_tr_b16 v[112:113], v139 offset:4096
    ds_read_b64_tr_b16 v[114:115], v139 offset:6144
    v_mfma_f32_16x16x32_bf16 v[12:15], v[120:123], v[76:79], v[12:15]
    ds_read_b128 v[48:51], v136 offset:33792
    v_mfma_f32_16x16x32_bf16 v[28:31], v[124:127], v[76:79], v[28:31]
    ds_read_b128 v[52:55], v136 offset:35840
    v_mfma_f32_16x16x32_bf16 v[28:31], v[132:135], v[92:95], v[28:31]
    ds_read_b128 v[56:59], v136 offset:37888
    ds_read_b128 v[60:63], v136 offset:39936
    v_mfma_f32_16x16x32_bf16 v[24:27], v[132:135], v[88:91], v[24:27]
    ds_read_b64_tr_b16 v[116:117], v140 offset:4096
    v_mfma_f32_16x16x32_bf16 v[24:27], v[124:127], v[72:75], v[24:27]
    ds_read_b64_tr_b16 v[118:119], v140 offset:6144
    v_mfma_f32_16x16x32_bf16 v[20:23], v[124:127], v[68:71], v[20:23]
    v_mfma_f32_16x16x32_bf16 v[20:23], v[132:135], v[84:87], v[20:23]
    v_mfma_f32_16x16x32_bf16 v[16:19], v[132:135], v[80:83], v[16:19]
    v_mfma_f32_16x16x32_bf16 v[16:19], v[124:127], v[64:67], v[16:19]
    s_waitcnt lgkmcnt(0)
    s_barrier
    .p2align 3
    v_mfma_f32_16x16x32_bf16 v[0:3], v[104:107], v[32:35], v[0:3]
    ds_read_b64_tr_b16 v[120:121], v139 offset:8192
    ds_read_b64_tr_b16 v[122:123], v139 offset:10240
    v_mfma_f32_16x16x32_bf16 v[0:3], v[112:115], v[48:51], v[0:3]
    ds_read_b128 v[64:67], v136 offset:0
    v_mfma_f32_16x16x32_bf16 v[4:7], v[112:115], v[52:55], v[4:7]
    ds_read_b128 v[68:71], v136 offset:2048
    v_mfma_f32_16x16x32_bf16 v[4:7], v[104:107], v[36:39], v[4:7]
    ds_read_b128 v[72:75], v136 offset:4096
    ds_read_b128 v[76:79], v136 offset:6144
    v_mfma_f32_16x16x32_bf16 v[8:11], v[104:107], v[40:43], v[8:11]
    ds_read_b64_tr_b16 v[124:125], v140 offset:8192
    v_mfma_f32_16x16x32_bf16 v[8:11], v[112:115], v[56:59], v[8:11]
    ds_read_b64_tr_b16 v[126:127], v140 offset:10240
    v_mfma_f32_16x16x32_bf16 v[12:15], v[112:115], v[60:63], v[12:15]
    ds_read_b64_tr_b16 v[128:129], v139 offset:12288
    ds_read_b64_tr_b16 v[130:131], v139 offset:14336
    v_mfma_f32_16x16x32_bf16 v[12:15], v[104:107], v[44:47], v[12:15]
    ds_read_b128 v[80:83], v136 offset:1024
    v_mfma_f32_16x16x32_bf16 v[28:31], v[108:111], v[44:47], v[28:31]
    ds_read_b128 v[84:87], v136 offset:3072
    v_mfma_f32_16x16x32_bf16 v[28:31], v[116:119], v[60:63], v[28:31]
    ds_read_b128 v[88:91], v136 offset:5120
    ds_read_b128 v[92:95], v136 offset:7168
    v_mfma_f32_16x16x32_bf16 v[24:27], v[116:119], v[56:59], v[24:27]
    ds_read_b64_tr_b16 v[132:133], v140 offset:12288
    v_mfma_f32_16x16x32_bf16 v[24:27], v[108:111], v[40:43], v[24:27]
    ds_read_b64_tr_b16 v[134:135], v140 offset:14336
    v_mfma_f32_16x16x32_bf16 v[20:23], v[108:111], v[36:39], v[20:23]
    v_mfma_f32_16x16x32_bf16 v[20:23], v[116:119], v[52:55], v[20:23]
    v_mfma_f32_16x16x32_bf16 v[16:19], v[116:119], v[48:51], v[16:19]
    v_mfma_f32_16x16x32_bf16 v[16:19], v[108:111], v[32:35], v[16:19]
    s_waitcnt lgkmcnt(0)
    s_barrier
    .p2align 3
    v_mfma_f32_16x16x32_bf16 v[0:3], v[120:123], v[64:67], v[0:3]
    v_mfma_f32_16x16x32_bf16 v[0:3], v[128:131], v[80:83], v[0:3]
    v_mfma_f32_16x16x32_bf16 v[4:7], v[128:131], v[84:87], v[4:7]
    v_mfma_f32_16x16x32_bf16 v[4:7], v[120:123], v[68:71], v[4:7]
    v_mfma_f32_16x16x32_bf16 v[8:11], v[120:123], v[72:75], v[8:11]
    v_mfma_f32_16x16x32_bf16 v[8:11], v[128:131], v[88:91], v[8:11]
    v_mfma_f32_16x16x32_bf16 v[12:15], v[128:131], v[92:95], v[12:15]
    v_mfma_f32_16x16x32_bf16 v[12:15], v[120:123], v[76:79], v[12:15]
    v_mfma_f32_16x16x32_bf16 v[28:31], v[124:127], v[76:79], v[28:31]
    v_mfma_f32_16x16x32_bf16 v[28:31], v[132:135], v[92:95], v[28:31]
    v_mfma_f32_16x16x32_bf16 v[24:27], v[132:135], v[88:91], v[24:27]
    v_mfma_f32_16x16x32_bf16 v[24:27], v[124:127], v[72:75], v[24:27]
    v_mfma_f32_16x16x32_bf16 v[20:23], v[124:127], v[68:71], v[20:23]
    v_mfma_f32_16x16x32_bf16 v[20:23], v[132:135], v[84:87], v[20:23]
    v_mfma_f32_16x16x32_bf16 v[16:19], v[132:135], v[80:83], v[16:19]
    v_mfma_f32_16x16x32_bf16 v[16:19], v[124:127], v[64:67], v[16:19]
    s_nop 7
    s_add_u32 s59, s1, s49
    s_add_u32 s60, s59, 4096
    v_cvt_pk_bf16_f32 v192, v0, v1
    v_cvt_pk_bf16_f32 v193, v2, v3
    v_cvt_pk_bf16_f32 v194, v16, v17
    v_cvt_pk_bf16_f32 v195, v18, v19
    buffer_store_dwordx4 v[192:195], v254, s[4:7], s59 offen offset:0 sc0 sc1
    v_cvt_pk_bf16_f32 v196, v4, v5
    v_cvt_pk_bf16_f32 v197, v6, v7
    v_cvt_pk_bf16_f32 v198, v20, v21
    v_cvt_pk_bf16_f32 v199, v22, v23
    buffer_store_dwordx4 v[196:199], v254, s[4:7], s59 offen offset:2048 sc0 sc1
    v_cvt_pk_bf16_f32 v200, v8, v9
    v_cvt_pk_bf16_f32 v201, v10, v11
    v_cvt_pk_bf16_f32 v202, v24, v25
    v_cvt_pk_bf16_f32 v203, v26, v27
    buffer_store_dwordx4 v[200:203], v254, s[4:7], s60 offen offset:0 sc0 sc1
    v_cvt_pk_bf16_f32 v204, v12, v13
    v_cvt_pk_bf16_f32 v205, v14, v15
    v_cvt_pk_bf16_f32 v206, v28, v29
    v_cvt_pk_bf16_f32 v207, v30, v31
    buffer_store_dwordx4 v[204:207], v254, s[4:7], s60 offen offset:2048 sc0 sc1
    v_mov_b32 v216, 0x3f803f80
    v_dot2_f32_bf16 v208, v192, v216, 0
    v_dot2_f32_bf16 v212, v192, v192, 0
    v_dot2_f32_bf16 v209, v196, v216, 0
    v_dot2_f32_bf16 v213, v196, v196, 0
    v_dot2_f32_bf16 v210, v200, v216, 0
    v_dot2_f32_bf16 v214, v200, v200, 0
    v_dot2_f32_bf16 v211, v204, v216, 0
    v_dot2_f32_bf16 v215, v204, v204, 0
    v_dot2_f32_bf16 v208, v193, v216, v208
    v_dot2_f32_bf16 v212, v193, v193, v212
    v_dot2_f32_bf16 v209, v197, v216, v209
    v_dot2_f32_bf16 v213, v197, v197, v213
    v_dot2_f32_bf16 v210, v201, v216, v210
    v_dot2_f32_bf16 v214, v201, v201, v214
    v_dot2_f32_bf16 v211, v205, v216, v211
    v_dot2_f32_bf16 v215, v205, v205, v215
    v_dot2_f32_bf16 v208, v194, v216, v208
    v_dot2_f32_bf16 v212, v194, v194, v212
    v_dot2_f32_bf16 v209, v198, v216, v209
    v_dot2_f32_bf16 v213, v198, v198, v213
    v_dot2_f32_bf16 v210, v202, v216, v210
    v_dot2_f32_bf16 v214, v202, v202, v214
    v_dot2_f32_bf16 v211, v206, v216, v211
    v_dot2_f32_bf16 v215, v206, v206, v215
    v_dot2_f32_bf16 v208, v195, v216, v208
    v_dot2_f32_bf16 v212, v195, v195, v212
    v_dot2_f32_bf16 v209, v199, v216, v209
    v_dot2_f32_bf16 v213, v199, v199, v213
    v_dot2_f32_bf16 v210, v203, v216, v210
    v_dot2_f32_bf16 v214, v203, v203, v214
    v_dot2_f32_bf16 v211, v207, v216, v211
    v_dot2_f32_bf16 v215, v207, v207, v215
    s_lshl_b32 s55, s42, 9
    s_add_u32 s55, s55, 155648
    s_nop 1
    v_permlane32_swap_b32 v208, v210
    v_permlane32_swap_b32 v209, v211
    v_permlane32_swap_b32 v212, v214
    v_permlane32_swap_b32 v213, v215
    v_add_f32 v208, v208, v210
    v_add_f32 v209, v209, v211
    v_add_f32 v212, v212, v214
    v_add_f32 v213, v213, v215
    v_lshrrev_b32 v216, 1, v254
    v_add_u32 v216, s55, v216
    v_permlane16_swap_b32 v208, v209
    v_permlane16_swap_b32 v212, v213
    v_add_f32 v208, v208, v209
    v_add_f32 v209, v212, v213
    ds_write_b64 v216, v[208:209]
    s_lshl_b32 s55, s43, 13
    s_add_u32 s55, s55, 98304
    v_add_u32 v224, s55, v254
    s_lshl_b32 s56, s44, 2
    v_lshrrev_b32 v233, 6, v254
    v_and_b32 v234, 7, v233
    v_xor_b32 v234, s56, v234
    v_lshlrev_b32 v233, 8, v233
    v_lshl_add_u32 v233, v234, 5, v233
    v_and_b32 v234, 0x30, v254
    v_lshrrev_b32 v234, 1, v234
    v_add_u32 v233, v233, v234
    v_xor_b32 v225, 0, v233
    v_xor_b32 v226, 32, v233
    v_xor_b32 v227, 64, v233
    v_xor_b32 v228, 96, v233
    v_add_u32 v229, 49152, v225
    v_add_u32 v230, 49152, v226
    v_add_u32 v231, 49152, v227
    v_add_u32 v232, 49152, v228
    v_lshrrev_b32 v233, 7, v254
    v_and_b32 v234, 0x70, v254
    v_and_b32 v235, 6, v233
    v_lshlrev_b32 v235, 4, v235
    v_xor_b32 v234, v234, v235
    v_mul_u32_u24 v233, 7168, v233
    v_add3_u32 v236, v233, v234, s66
    v_add_u32 v237, 56320, v236
    v_add_u32 v242, s67, v254
    v_and_b32 v234, 0xf0, v254
    v_lshrrev_b32 v233, 8, v254
    v_lshlrev_b32 v235, 5, v233
    v_xor_b32 v234, v234, v235
    v_mul_u32_u24 v233, 2048, v233
    v_add_u32 v238, v233, v234
    v_xor_b32 v234, 0x80, v234
    v_add_u32 v233, v233, v234
    v_add_u32 v239, 7168, v233
    v_add_u32 v240, 14336, v238
    v_add_u32 v241, 14336, v239
    v_mov_b32 v243, v224
    s_and_b32 s56, s51, 1
    s_lshl_b32 s56, s56, 2
    s_lshl_b32 s55, s44, 1
    s_add_u32 s56, s56, s55
    v_lshrrev_b32 v233, 6, v254
    v_and_b32 v234, 7, v233
    v_xor_b32 v234, s56, v234
    v_lshlrev_b32 v233, 8, v233
    v_lshl_add_u32 v233, v234, 5, v233
    v_and_b32 v234, 0x30, v254
    v_lshrrev_b32 v234, 1, v234
    v_add_u32 v233, v233, v234
    v_xor_b32 v244, 0, v233
    v_xor_b32 v245, 32, v233
    v_xor_b32 v246, 128, v233
    v_xor_b32 v247, 160, v233
    v_add_u32 v248, 49152, v244
    v_add_u32 v249, 49152, v245
    v_add_u32 v250, 49152, v246
    v_add_u32 v251, 49152, v247
    s_and_b32 s55, s51, 1
    s_mul_i32 s55, s55, 458752
    s_add_u32 s95, s50, s55
    s_and_b32 s55, s41, 7
    s_lshl_b32 s55, s55, 14
    s_and_b32 s56, s1, 0x3fff
    s_add_u32 s55, s55, s56
    s_add_u32 s89, s55, s95
    s_and_b32 s55, s41, 6
    s_add_u32 s55, s55, 48
    s_lshl_b32 s55, s55, 13
    s_and_b32 s56, s41, 1
    s_lshl_b32 s56, s56, 10
    s_add_u32 s55, s55, s56
    s_lshl_b32 s56, s43, 13
    s_add_u32 s55, s55, s56
    s_lshl_b32 s56, s44, 9
    s_add_u32 s55, s55, s56
    s_add_u32 s90, s55, s95
    s_lshl_b32 s60, s43, 23
    s_add_u32 s60, s60, 83886336
    s_mov_b32 s24, s16
    s_mov_b32 s25, s17
    s_mov_b32 s26, s18
    s_mov_b32 s27, s19
    s_add_u32 s88, s49, s62
    s_lshl_b32 s94, s51, 14
    s_waitcnt vmcnt(0) lgkmcnt(0)
    s_barrier
    s_cmp_lg_u32 s42, 2
    s_cbranch_scc1 wf_22
    s_lshr_b32 s55, s2, 5
    s_lshl_b32 s55, s55, 2
    s_add_u32 s55, s55, s0
    v_mov_b32 v252, 32
    v_mov_b32 v253, 0x01010101
    s_mov_b64 exec, 1
    s_cmp_eq_u32 s45, 0
    s_cbranch_scc1 st_23
    buffer_store_dword v253, v252, s[4:7], s55 offen sc0 sc1
    s_branch st_24
st_23:
    buffer_store_dword v253, v252, s[4:7], s55 offen
st_24:
    s_mov_b64 exec, -1
wf_22:
    s_cmp_lg_u32 s42, 0
    s_cbranch_scc1 so_25
    v_add_u32 v216, 155648, v254
    ds_read_b128 v[208:211], v216
    ds_read_b128 v[212:215], v216 offset:1024
    s_lshl_b32 s55, s51, 10
    s_add_u32 s55, s55, s52
    s_waitcnt lgkmcnt(0)
    v_add_f32 v208, v208, v212
    v_add_f32 v209, v209, v213
    v_add_f32 v210, v210, v214
    v_add_f32 v211, v211, v215
    buffer_store_dwordx4 v[208:211], v254, s[4:7], s55 offen sc0 sc1
so_25:
    s_barrier
    ds_read_b64_tr_b16 v[160:161], v229 offset:16384
    ds_read_b64_tr_b16 v[162:163], v229 offset:20480
    ds_read_b128 v[128:131], v224 offset:0
    ds_read_b128 v[132:135], v224 offset:2048
    ds_read_b128 v[136:139], v224 offset:4096
    ds_read_b128 v[140:143], v224 offset:6144
    ds_read_b64_tr_b16 v[176:177], v229 offset:24576
    ds_read_b64_tr_b16 v[178:179], v229 offset:28672
    ds_read_b64_tr_b16 v[164:165], v230 offset:16384
    ds_read_b64_tr_b16 v[166:167], v230 offset:20480
    ds_read_b64_tr_b16 v[180:181], v230 offset:24576
    ds_read_b64_tr_b16 v[182:183], v230 offset:28672
    ds_read_b64_tr_b16 v[168:169], v231 offset:16384
    ds_read_b64_tr_b16 v[170:171], v231 offset:20480
    ds_read_b64_tr_b16 v[184:185], v231 offset:24576
    ds_read_b64_tr_b16 v[186:187], v231 offset:28672
    ds_read_b64_tr_b16 v[172:173], v232 offset:16384
    ds_read_b64_tr_b16 v[174:175], v232 offset:20480
    ds_read_b64_tr_b16 v[188:189], v232 offset:24576
    ds_read_b64_tr_b16 v[190:191], v232 offset:28672
    s_mov_b32 s58, 5
    s_waitcnt lgkmcnt(0)
    s_barrier
    .p2align 3
    v_mfma_f32_16x16x32_bf16 v[0:3], v[160:163], v[128:131], 0
    ds_read_b64_tr_b16 v[192:193], v229 offset:32768
    v_mfma_f32_16x16x32_bf16 v[4:7], v[160:163], v[132:135], 0
    ds_read_b64_tr_b16 v[194:195], v229 offset:36864
    v_mfma_f32_16x16x32_bf16 v[8:11], v[160:163], v[136:139], 0
    ds_read_b128 v[144:147], v224 offset:1024
    v_mfma_f32_16x16x32_bf16 v[12:15], v[160:163], v[140:143], 0
    ds_read_b128 v[148:151], v224 offset:3072
    v_mfma_f32_16x16x32_bf16 v[76:79], v[176:179], v[140:143], 0
    ds_read_b128 v[152:155], v224 offset:5120
    v_mfma_f32_16x16x32_bf16 v[72:75], v[176:179], v[136:139], 0
    v_mfma_f32_16x16x32_bf16 v[68:71], v[176:179], v[132:135], 0
    ds_read_b128 v[156:159], v224 offset:7168
    v_mfma_f32_16x16x32_bf16 v[64:67], v[176:179], v[128:131], 0
    ds_read_b64_tr_b16 v[208:209], v229 offset:40960
    v_mfma_f32_16x16x32_bf16 v[16:19], v[164:167], v[128:131], 0
    ds_read_b64_tr_b16 v[210:211], v229 offset:45056
    v_mfma_f32_16x16x32_bf16 v[20:23], v[164:167], v[132:135], 0
    ds_read_b64_tr_b16 v[196:197], v230 offset:32768
    v_mfma_f32_16x16x32_bf16 v[24:27], v[164:167], v[136:139], 0
    ds_read_b64_tr_b16 v[198:199], v230 offset:36864
    v_mfma_f32_16x16x32_bf16 v[28:31], v[164:167], v[140:143], 0
    v_mfma_f32_16x16x32_bf16 v[92:95], v[180:183], v[140:143], 0
    ds_read_b64_tr_b16 v[212:213], v230 offset:40960
    v_mfma_f32_16x16x32_bf16 v[88:91], v[180:183], v[136:139], 0
    ds_read_b64_tr_b16 v[214:215], v230 offset:45056
    v_mfma_f32_16x16x32_bf16 v[84:87], v[180:183], v[132:135], 0
    ds_read_b64_tr_b16 v[200:201], v231 offset:32768
    v_mfma_f32_16x16x32_bf16 v[80:83], v[180:183], v[128:131], 0
    ds_read_b64_tr_b16 v[202:203], v231 offset:36864
    v_mfma_f32_16x16x32_bf16 v[32:35], v[168:171], v[128:131], 0
    ds_read_b64_tr_b16 v[216:217], v231 offset:40960
    v_mfma_f32_16x16x32_bf16 v[36:39], v[168:171], v[132:135], 0
    v_mfma_f32_16x16x32_bf16 v[40:43], v[168:171], v[136:139], 0
    ds_read_b64_tr_b16 v[218:219], v231 offset:45056
    v_mfma_f32_16x16x32_bf16 v[44:47], v[168:171], v[140:143], 0
    ds_read_b64_tr_b16 v[204:205], v232 offset:32768
    v_mfma_f32_16x16x32_bf16 v[108:111], v[184:187], v[140:143], 0
    ds_read_b64_tr_b16 v[206:207], v232 offset:36864
    v_mfma_f32_16x16x32_bf16 v[104:107], v[184:187], v[136:139], 0
    ds_read_b64_tr_b16 v[220:221], v232 offset:40960
    v_mfma_f32_16x16x32_bf16 v[100:103], v[184:187], v[132:135], 0
    ds_read_b64_tr_b16 v[222:223], v232 offset:45056
    v_mfma_f32_16x16x32_bf16 v[96:99], v[184:187], v[128:131], 0
    v_mfma_f32_16x16x32_bf16 v[48:51], v[172:175], v[128:131], 0
    v_mfma_f32_16x16x32_bf16 v[52:55], v[172:175], v[132:135], 0
    v_mfma_f32_16x16x32_bf16 v[56:59], v[172:175], v[136:139], 0
    v_mfma_f32_16x16x32_bf16 v[60:63], v[172:175], v[140:143], 0
    v_mfma_f32_16x16x32_bf16 v[124:127], v[188:191], v[140:143], 0
    v_mfma_f32_16x16x32_bf16 v[120:123], v[188:191], v[136:139], 0
    v_mfma_f32_16x16x32_bf16 v[116:119], v[188:191], v[132:135], 0
    v_mfma_f32_16x16x32_bf16 v[112:115], v[188:191], v[128:131], 0
    .p2align 3
loop_26:
    s_waitcnt lgkmcnt(0)
    s_barrier
    .p2align 3
    v_mfma_f32_16x16x32_bf16 v[0:3], v[192:195], v[144:147], v[0:3]
    ds_read_b64_tr_b16 v[160:161], v225 offset:0
    v_mfma_f32_16x16x32_bf16 v[4:7], v[192:195], v[148:151], v[4:7]
    ds_read_b64_tr_b16 v[162:163], v225 offset:4096
    v_mfma_f32_16x16x32_bf16 v[8:11], v[192:195], v[152:155], v[8:11]
    ds_read_b128 v[128:131], v224 offset:16384
    v_mfma_f32_16x16x32_bf16 v[12:15], v[192:195], v[156:159], v[12:15]
    ds_read_b128 v[132:135], v224 offset:18432
    v_mfma_f32_16x16x32_bf16 v[76:79], v[208:211], v[156:159], v[76:79]
    ds_read_b128 v[136:139], v224 offset:20480
    v_mfma_f32_16x16x32_bf16 v[72:75], v[208:211], v[152:155], v[72:75]
    v_mfma_f32_16x16x32_bf16 v[68:71], v[208:211], v[148:151], v[68:71]
    ds_read_b128 v[140:143], v224 offset:22528
    v_mfma_f32_16x16x32_bf16 v[64:67], v[208:211], v[144:147], v[64:67]
    ds_read_b64_tr_b16 v[176:177], v225 offset:8192
    v_mfma_f32_16x16x32_bf16 v[16:19], v[196:199], v[144:147], v[16:19]
    ds_read_b64_tr_b16 v[178:179], v225 offset:12288
    v_mfma_f32_16x16x32_bf16 v[20:23], v[196:199], v[148:151], v[20:23]
    ds_read_b64_tr_b16 v[164:165], v226 offset:0
    v_mfma_f32_16x16x32_bf16 v[24:27], v[196:199], v[152:155], v[24:27]
    ds_read_b64_tr_b16 v[166:167], v226 offset:4096
    v_mfma_f32_16x16x32_bf16 v[28:31], v[196:199], v[156:159], v[28:31]
    v_mfma_f32_16x16x32_bf16 v[92:95], v[212:215], v[156:159], v[92:95]
    ds_read_b64_tr_b16 v[180:181], v226 offset:8192
    v_mfma_f32_16x16x32_bf16 v[88:91], v[212:215], v[152:155], v[88:91]
    ds_read_b64_tr_b16 v[182:183], v226 offset:12288
    v_mfma_f32_16x16x32_bf16 v[84:87], v[212:215], v[148:151], v[84:87]
    ds_read_b64_tr_b16 v[168:169], v227 offset:0
    v_mfma_f32_16x16x32_bf16 v[80:83], v[212:215], v[144:147], v[80:83]
    ds_read_b64_tr_b16 v[170:171], v227 offset:4096
    v_mfma_f32_16x16x32_bf16 v[32:35], v[200:203], v[144:147], v[32:35]
    ds_read_b64_tr_b16 v[184:185], v227 offset:8192
    v_mfma_f32_16x16x32_bf16 v[36:39], v[200:203], v[148:151], v[36:39]
    v_mfma_f32_16x16x32_bf16 v[40:43], v[200:203], v[152:155], v[40:43]
    ds_read_b64_tr_b16 v[186:187], v227 offset:12288
    v_mfma_f32_16x16x32_bf16 v[44:47], v[200:203], v[156:159], v[44:47]
    ds_read_b64_tr_b16 v[172:173], v228 offset:0
    v_mfma_f32_16x16x32_bf16 v[108:111], v[216:219], v[156:159], v[108:111]
    ds_read_b64_tr_b16 v[174:175], v228 offset:4096
    v_mfma_f32_16x16x32_bf16 v[104:107], v[216:219], v[152:155], v[104:107]
    ds_read_b64_tr_b16 v[188:189], v228 offset:8192
    v_mfma_f32_16x16x32_bf16 v[100:103], v[216:219], v[148:151], v[100:103]
    ds_read_b64_tr_b16 v[190:191], v228 offset:12288
    v_mfma_f32_16x16x32_bf16 v[96:99], v[216:219], v[144:147], v[96:99]
    v_mfma_f32_16x16x32_bf16 v[48:51], v[204:207], v[144:147], v[48:51]
    v_mfma_f32_16x16x32_bf16 v[52:55], v[204:207], v[148:151], v[52:55]
    v_mfma_f32_16x16x32_bf16 v[56:59], v[204:207], v[152:155], v[56:59]
    v_mfma_f32_16x16x32_bf16 v[60:63], v[204:207], v[156:159], v[60:63]
    v_mfma_f32_16x16x32_bf16 v[124:127], v[220:223], v[156:159], v[124:127]
    v_mfma_f32_16x16x32_bf16 v[120:123], v[220:223], v[152:155], v[120:123]
    v_mfma_f32_16x16x32_bf16 v[116:119], v[220:223], v[148:151], v[116:119]
    v_mfma_f32_16x16x32_bf16 v[112:115], v[220:223], v[144:147], v[112:115]
    s_waitcnt vmcnt(0) lgkmcnt(0)
    s_barrier
    .p2align 3
    v_mfma_f32_16x16x32_bf16 v[0:3], v[160:163], v[128:131], v[0:3]
    ds_read_b64_tr_b16 v[192:193], v225 offset:16384
    v_mfma_f32_16x16x32_bf16 v[4:7], v[160:163], v[132:135], v[4:7]
    ds_read_b64_tr_b16 v[194:195], v225 offset:20480
    v_mfma_f32_16x16x32_bf16 v[8:11], v[160:163], v[136:139], v[8:11]
    ds_read_b128 v[144:147], v224 offset:17408
    v_mfma_f32_16x16x32_bf16 v[12:15], v[160:163], v[140:143], v[12:15]
    ds_read_b128 v[148:151], v224 offset:19456
    v_mfma_f32_16x16x32_bf16 v[76:79], v[176:179], v[140:143], v[76:79]
    ds_read_b128 v[152:155], v224 offset:21504
    v_mfma_f32_16x16x32_bf16 v[72:75], v[176:179], v[136:139], v[72:75]
    v_mfma_f32_16x16x32_bf16 v[68:71], v[176:179], v[132:135], v[68:71]
    ds_read_b128 v[156:159], v224 offset:23552
    v_mfma_f32_16x16x32_bf16 v[64:67], v[176:179], v[128:131], v[64:67]
    ds_read_b64_tr_b16 v[208:209], v225 offset:24576
    v_mfma_f32_16x16x32_bf16 v[16:19], v[164:167], v[128:131], v[16:19]
    ds_read_b64_tr_b16 v[210:211], v225 offset:28672
    v_mfma_f32_16x16x32_bf16 v[20:23], v[164:167], v[132:135], v[20:23]
    ds_read_b64_tr_b16 v[196:197], v226 offset:16384
    v_mfma_f32_16x16x32_bf16 v[24:27], v[164:167], v[136:139], v[24:27]
    ds_read_b64_tr_b16 v[198:199], v226 offset:20480
    v_mfma_f32_16x16x32_bf16 v[28:31], v[164:167], v[140:143], v[28:31]
    v_mfma_f32_16x16x32_bf16 v[92:95], v[180:183], v[140:143], v[92:95]
    ds_read_b64_tr_b16 v[212:213], v226 offset:24576
    v_mfma_f32_16x16x32_bf16 v[88:91], v[180:183], v[136:139], v[88:91]
    ds_read_b64_tr_b16 v[214:215], v226 offset:28672
    v_mfma_f32_16x16x32_bf16 v[84:87], v[180:183], v[132:135], v[84:87]
    ds_read_b64_tr_b16 v[200:201], v227 offset:16384
    v_mfma_f32_16x16x32_bf16 v[80:83], v[180:183], v[128:131], v[80:83]
    ds_read_b64_tr_b16 v[202:203], v227 offset:20480
    v_mfma_f32_16x16x32_bf16 v[32:35], v[168:171], v[128:131], v[32:35]
    ds_read_b64_tr_b16 v[216:217], v227 offset:24576
    v_mfma_f32_16x16x32_bf16 v[36:39], v[168:171], v[132:135], v[36:39]
    v_mfma_f32_16x16x32_bf16 v[40:43], v[168:171], v[136:139], v[40:43]
    ds_read_b64_tr_b16 v[218:219], v227 offset:28672
    v_mfma_f32_16x16x32_bf16 v[44:47], v[168:171], v[140:143], v[44:47]
    ds_read_b64_tr_b16 v[204:205], v228 offset:16384
    v_mfma_f32_16x16x32_bf16 v[108:111], v[184:187], v[140:143], v[108:111]
    ds_read_b64_tr_b16 v[206:207], v228 offset:20480
    v_mfma_f32_16x16x32_bf16 v[104:107], v[184:187], v[136:139], v[104:107]
    ds_read_b64_tr_b16 v[220:221], v228 offset:24576
    v_mfma_f32_16x16x32_bf16 v[100:103], v[184:187], v[132:135], v[100:103]
    ds_read_b64_tr_b16 v[222:223], v228 offset:28672
    v_mfma_f32_16x16x32_bf16 v[96:99], v[184:187], v[128:131], v[96:99]
    v_mfma_f32_16x16x32_bf16 v[48:51], v[172:175], v[128:131], v[48:51]
    v_mfma_f32_16x16x32_bf16 v[52:55], v[172:175], v[132:135], v[52:55]
    v_mfma_f32_16x16x32_bf16 v[56:59], v[172:175], v[136:139], v[56:59]
    v_mfma_f32_16x16x32_bf16 v[60:63], v[172:175], v[140:143], v[60:63]
    v_mfma_f32_16x16x32_bf16 v[124:127], v[188:191], v[140:143], v[124:127]
    v_mfma_f32_16x16x32_bf16 v[120:123], v[188:191], v[136:139], v[120:123]
    v_mfma_f32_16x16x32_bf16 v[116:119], v[188:191], v[132:135], v[116:119]
    v_mfma_f32_16x16x32_bf16 v[112:115], v[188:191], v[128:131], v[112:115]
    s_waitcnt lgkmcnt(0)
    s_barrier
    .p2align 3
    v_mfma_f32_16x16x32_bf16 v[0:3], v[192:195], v[144:147], v[0:3]
    ds_read_b64_tr_b16 v[160:161], v225 offset:32768
    v_mfma_f32_16x16x32_bf16 v[4:7], v[192:195], v[148:151], v[4:7]
    ds_read_b64_tr_b16 v[162:163], v225 offset:36864
    v_mfma_f32_16x16x32_bf16 v[8:11], v[192:195], v[152:155], v[8:11]
    ds_read_b128 v[128:131], v224 offset:32768
    v_mfma_f32_16x16x32_bf16 v[12:15], v[192:195], v[156:159], v[12:15]
    ds_read_b128 v[132:135], v224 offset:34816
    v_mfma_f32_16x16x32_bf16 v[76:79], v[208:211], v[156:159], v[76:79]
    ds_read_b128 v[136:139], v224 offset:36864
    v_mfma_f32_16x16x32_bf16 v[72:75], v[208:211], v[152:155], v[72:75]
    v_mfma_f32_16x16x32_bf16 v[68:71], v[208:211], v[148:151], v[68:71]
    ds_read_b128 v[140:143], v224 offset:38912
    v_mfma_f32_16x16x32_bf16 v[64:67], v[208:211], v[144:147], v[64:67]
    ds_read_b64_tr_b16 v[176:177], v225 offset:40960
    v_mfma_f32_16x16x32_bf16 v[16:19], v[196:199], v[144:147], v[16:19]
    ds_read_b64_tr_b16 v[178:179], v225 offset:45056
    v_mfma_f32_16x16x32_bf16 v[20:23], v[196:199], v[148:151], v[20:23]
    ds_read_b64_tr_b16 v[164:165], v226 offset:32768
    v_mfma_f32_16x16x32_bf16 v[24:27], v[196:199], v[152:155], v[24:27]
    ds_read_b64_tr_b16 v[166:167], v226 offset:36864
    v_mfma_f32_16x16x32_bf16 v[28:31], v[196:199], v[156:159], v[28:31]
    v_mfma_f32_16x16x32_bf16 v[92:95], v[212:215], v[156:159], v[92:95]
    ds_read_b64_tr_b16 v[180:181], v226 offset:40960
    v_mfma_f32_16x16x32_bf16 v[88:91], v[212:215], v[152:155], v[88:91]
    ds_read_b64_tr_b16 v[182:183], v226 offset:45056
    v_mfma_f32_16x16x32_bf16 v[84:87], v[212:215], v[148:151], v[84:87]
    ds_read_b64_tr_b16 v[168:169], v227 offset:32768
    v_mfma_f32_16x16x32_bf16 v[80:83], v[212:215], v[144:147], v[80:83]
    ds_read_b64_tr_b16 v[170:171], v227 offset:36864
    v_mfma_f32_16x16x32_bf16 v[32:35], v[200:203], v[144:147], v[32:35]
    ds_read_b64_tr_b16 v[184:185], v227 offset:40960
    v_mfma_f32_16x16x32_bf16 v[36:39], v[200:203], v[148:151], v[36:39]
    v_mfma_f32_16x16x32_bf16 v[40:43], v[200:203], v[152:155], v[40:43]
    ds_read_b64_tr_b16 v[186:187], v227 offset:45056
    v_mfma_f32_16x16x32_bf16 v[44:47], v[200:203], v[156:159], v[44:47]
    ds_read_b64_tr_b16 v[172:173], v228 offset:32768
    v_mfma_f32_16x16x32_bf16 v[108:111], v[216:219], v[156:159], v[108:111]
    ds_read_b64_tr_b16 v[174:175], v228 offset:36864
    v_mfma_f32_16x16x32_bf16 v[104:107], v[216:219], v[152:155], v[104:107]
    ds_read_b64_tr_b16 v[188:189], v228 offset:40960
    v_mfma_f32_16x16x32_bf16 v[100:103], v[216:219], v[148:151], v[100:103]
    ds_read_b64_tr_b16 v[190:191], v228 offset:45056
    v_mfma_f32_16x16x32_bf16 v[96:99], v[216:219], v[144:147], v[96:99]
    v_mfma_f32_16x16x32_bf16 v[48:51], v[204:207], v[144:147], v[48:51]
    v_mfma_f32_16x16x32_bf16 v[52:55], v[204:207], v[148:151], v[52:55]
    v_mfma_f32_16x16x32_bf16 v[56:59], v[204:207], v[152:155], v[56:59]
    v_mfma_f32_16x16x32_bf16 v[60:63], v[204:207], v[156:159], v[60:63]
    v_mfma_f32_16x16x32_bf16 v[124:127], v[220:223], v[156:159], v[124:127]
    v_mfma_f32_16x16x32_bf16 v[120:123], v[220:223], v[152:155], v[120:123]
    v_mfma_f32_16x16x32_bf16 v[116:119], v[220:223], v[148:151], v[116:119]
    v_mfma_f32_16x16x32_bf16 v[112:115], v[220:223], v[144:147], v[112:115]
    s_waitcnt lgkmcnt(0)
    s_barrier
    .p2align 3
    v_mfma_f32_16x16x32_bf16 v[0:3], v[160:163], v[128:131], v[0:3]
    ds_read_b64_tr_b16 v[192:193], v229 offset:0
    v_mfma_f32_16x16x32_bf16 v[4:7], v[160:163], v[132:135], v[4:7]
    ds_read_b64_tr_b16 v[194:195], v229 offset:4096
    v_mfma_f32_16x16x32_bf16 v[8:11], v[160:163], v[136:139], v[8:11]
    ds_read_b128 v[144:147], v224 offset:33792
    v_mfma_f32_16x16x32_bf16 v[12:15], v[160:163], v[140:143], v[12:15]
    ds_read_b128 v[148:151], v224 offset:35840
    v_mfma_f32_16x16x32_bf16 v[76:79], v[176:179], v[140:143], v[76:79]
    ds_read_b128 v[152:155], v224 offset:37888
    v_mfma_f32_16x16x32_bf16 v[72:75], v[176:179], v[136:139], v[72:75]
    v_mfma_f32_16x16x32_bf16 v[68:71], v[176:179], v[132:135], v[68:71]
    ds_read_b128 v[156:159], v224 offset:39936
    v_mfma_f32_16x16x32_bf16 v[64:67], v[176:179], v[128:131], v[64:67]
    ds_read_b64_tr_b16 v[208:209], v229 offset:8192
    v_mfma_f32_16x16x32_bf16 v[16:19], v[164:167], v[128:131], v[16:19]
    ds_read_b64_tr_b16 v[210:211], v229 offset:12288
    v_mfma_f32_16x16x32_bf16 v[20:23], v[164:167], v[132:135], v[20:23]
    ds_read_b64_tr_b16 v[196:197], v230 offset:0
    v_mfma_f32_16x16x32_bf16 v[24:27], v[164:167], v[136:139], v[24:27]
    ds_read_b64_tr_b16 v[198:199], v230 offset:4096
    v_mfma_f32_16x16x32_bf16 v[28:31], v[164:167], v[140:143], v[28:31]
    v_mfma_f32_16x16x32_bf16 v[92:95], v[180:183], v[140:143], v[92:95]
    ds_read_b64_tr_b16 v[212:213], v230 offset:8192
    v_mfma_f32_16x16x32_bf16 v[88:91], v[180:183], v[136:139], v[88:91]
    ds_read_b64_tr_b16 v[214:215], v230 offset:12288
    v_mfma_f32_16x16x32_bf16 v[84:87], v[180:183], v[132:135], v[84:87]
    ds_read_b64_tr_b16 v[200:201], v231 offset:0
    v_mfma_f32_16x16x32_bf16 v[80:83], v[180:183], v[128:131], v[80:83]
    ds_read_b64_tr_b16 v[202:203], v231 offset:4096
    v_mfma_f32_16x16x32_bf16 v[32:35], v[168:171], v[128:131], v[32:35]
    ds_read_b64_tr_b16 v[216:217], v231 offset:8192
    v_mfma_f32_16x16x32_bf16 v[36:39], v[168:171], v[132:135], v[36:39]
    v_mfma_f32_16x16x32_bf16 v[40:43], v[168:171], v[136:139], v[40:43]
    ds_read_b64_tr_b16 v[218:219], v231 offset:12288
    v_mfma_f32_16x16x32_bf16 v[44:47], v[168:171], v[140:143], v[44:47]
    ds_read_b64_tr_b16 v[204:205], v232 offset:0
    v_mfma_f32_16x16x32_bf16 v[108:111], v[184:187], v[140:143], v[108:111]
    ds_read_b64_tr_b16 v[206:207], v232 offset:4096
    v_mfma_f32_16x16x32_bf16 v[104:107], v[184:187], v[136:139], v[104:107]
    ds_read_b64_tr_b16 v[220:221], v232 offset:8192
    v_mfma_f32_16x16x32_bf16 v[100:103], v[184:187], v[132:135], v[100:103]
    ds_read_b64_tr_b16 v[222:223], v232 offset:12288
    v_mfma_f32_16x16x32_bf16 v[96:99], v[184:187], v[128:131], v[96:99]
    v_mfma_f32_16x16x32_bf16 v[48:51], v[172:175], v[128:131], v[48:51]
    v_mfma_f32_16x16x32_bf16 v[52:55], v[172:175], v[132:135], v[52:55]
    v_mfma_f32_16x16x32_bf16 v[56:59], v[172:175], v[136:139], v[56:59]
    v_mfma_f32_16x16x32_bf16 v[60:63], v[172:175], v[140:143], v[60:63]
    v_mfma_f32_16x16x32_bf16 v[124:127], v[188:191], v[140:143], v[124:127]
    v_mfma_f32_16x16x32_bf16 v[120:123], v[188:191], v[136:139], v[120:123]
    v_mfma_f32_16x16x32_bf16 v[116:119], v[188:191], v[132:135], v[116:119]
    v_mfma_f32_16x16x32_bf16 v[112:115], v[188:191], v[128:131], v[112:115]
    s_waitcnt lgkmcnt(0)
    s_barrier
    .p2align 3
    v_mfma_f32_16x16x32_bf16 v[0:3], v[192:195], v[144:147], v[0:3]
    ds_read_b64_tr_b16 v[160:161], v229 offset:16384
    v_mfma_f32_16x16x32_bf16 v[4:7], v[192:195], v[148:151], v[4:7]
    ds_read_b64_tr_b16 v[162:163], v229 offset:20480
    v_mfma_f32_16x16x32_bf16 v[8:11], v[192:195], v[152:155], v[8:11]
    ds_read_b128 v[128:131], v224 offset:0
    v_mfma_f32_16x16x32_bf16 v[12:15], v[192:195], v[156:159], v[12:15]
    ds_read_b128 v[132:135], v224 offset:2048
    v_mfma_f32_16x16x32_bf16 v[76:79], v[208:211], v[156:159], v[76:79]
    ds_read_b128 v[136:139], v224 offset:4096
    v_mfma_f32_16x16x32_bf16 v[72:75], v[208:211], v[152:155], v[72:75]
    v_mfma_f32_16x16x32_bf16 v[68:71], v[208:211], v[148:151], v[68:71]
    ds_read_b128 v[140:143], v224 offset:6144
    v_mfma_f32_16x16x32_bf16 v[64:67], v[208:211], v[144:147], v[64:67]
    ds_read_b64_tr_b16 v[176:177], v229 offset:24576
    v_mfma_f32_16x16x32_bf16 v[16:19], v[196:199], v[144:147], v[16:19]
    ds_read_b64_tr_b16 v[178:179], v229 offset:28672
    v_mfma_f32_16x16x32_bf16 v[20:23], v[196:199], v[148:151], v[20:23]
    ds_read_b64_tr_b16 v[164:165], v230 offset:16384
    v_mfma_f32_16x16x32_bf16 v[24:27], v[196:199], v[152:155], v[24:27]
    ds_read_b64_tr_b16 v[166:167], v230 offset:20480
    v_mfma_f32_16x16x32_bf16 v[28:31], v[196:199], v[156:159], v[28:31]
    v_mfma_f32_16x16x32_bf16 v[92:95], v[212:215], v[156:159], v[92:95]
    ds_read_b64_tr_b16 v[180:181], v230 offset:24576
    v_mfma_f32_16x16x32_bf16 v[88:91], v[212:215], v[152:155], v[88:91]
    ds_read_b64_tr_b16 v[182:183], v230 offset:28672
    v_mfma_f32_16x16x32_bf16 v[84:87], v[212:215], v[148:151], v[84:87]
    ds_read_b64_tr_b16 v[168:169], v231 offset:16384
    v_mfma_f32_16x16x32_bf16 v[80:83], v[212:215], v[144:147], v[80:83]
    ds_read_b64_tr_b16 v[170:171], v231 offset:20480
    v_mfma_f32_16x16x32_bf16 v[32:35], v[200:203], v[144:147], v[32:35]
    ds_read_b64_tr_b16 v[184:185], v231 offset:24576
    v_mfma_f32_16x16x32_bf16 v[36:39], v[200:203], v[148:151], v[36:39]
    v_mfma_f32_16x16x32_bf16 v[40:43], v[200:203], v[152:155], v[40:43]
    ds_read_b64_tr_b16 v[186:187], v231 offset:28672
    v_mfma_f32_16x16x32_bf16 v[44:47], v[200:203], v[156:159], v[44:47]
    ds_read_b64_tr_b16 v[172:173], v232 offset:16384
    v_mfma_f32_16x16x32_bf16 v[108:111], v[216:219], v[156:159], v[108:111]
    ds_read_b64_tr_b16 v[174:175], v232 offset:20480
    v_mfma_f32_16x16x32_bf16 v[104:107], v[216:219], v[152:155], v[104:107]
    ds_read_b64_tr_b16 v[188:189], v232 offset:24576
    v_mfma_f32_16x16x32_bf16 v[100:103], v[216:219], v[148:151], v[100:103]
    ds_read_b64_tr_b16 v[190:191], v232 offset:28672
    v_mfma_f32_16x16x32_bf16 v[96:99], v[216:219], v[144:147], v[96:99]
    v_mfma_f32_16x16x32_bf16 v[48:51], v[204:207], v[144:147], v[48:51]
    v_mfma_f32_16x16x32_bf16 v[52:55], v[204:207], v[148:151], v[52:55]
    v_mfma_f32_16x16x32_bf16 v[56:59], v[204:207], v[152:155], v[56:59]
    v_mfma_f32_16x16x32_bf16 v[60:63], v[204:207], v[156:159], v[60:63]
    v_mfma_f32_16x16x32_bf16 v[124:127], v[220:223], v[156:159], v[124:127]
    v_mfma_f32_16x16x32_bf16 v[120:123], v[220:223], v[152:155], v[120:123]
    v_mfma_f32_16x16x32_bf16 v[116:119], v[220:223], v[148:151], v[116:119]
    v_mfma_f32_16x16x32_bf16 v[112:115], v[220:223], v[144:147], v[112:115]
    s_waitcnt lgkmcnt(0)
    s_barrier
    .p2align 3
    v_mfma_f32_16x16x32_bf16 v[0:3], v[160:163], v[128:131], v[0:3]
    ds_read_b64_tr_b16 v[192:193], v229 offset:32768
    v_mfma_f32_16x16x32_bf16 v[4:7], v[160:163], v[132:135], v[4:7]
    ds_read_b64_tr_b16 v[194:195], v229 offset:36864
    v_mfma_f32_16x16x32_bf16 v[8:11], v[160:163], v[136:139], v[8:11]
    ds_read_b128 v[144:147], v224 offset:1024
    v_mfma_f32_16x16x32_bf16 v[12:15], v[160:163], v[140:143], v[12:15]
    ds_read_b128 v[148:151], v224 offset:3072
    v_mfma_f32_16x16x32_bf16 v[76:79], v[176:179], v[140:143], v[76:79]
    ds_read_b128 v[152:155], v224 offset:5120
    v_mfma_f32_16x16x32_bf16 v[72:75], v[176:179], v[136:139], v[72:75]
    v_mfma_f32_16x16x32_bf16 v[68:71], v[176:179], v[132:135], v[68:71]
    ds_read_b128 v[156:159], v224 offset:7168
    v_mfma_f32_16x16x32_bf16 v[64:67], v[176:179], v[128:131], v[64:67]
    ds_read_b64_tr_b16 v[208:209], v229 offset:40960
    v_mfma_f32_16x16x32_bf16 v[16:19], v[164:167], v[128:131], v[16:19]
    ds_read_b64_tr_b16 v[210:211], v229 offset:45056
    v_mfma_f32_16x16x32_bf16 v[20:23], v[164:167], v[132:135], v[20:23]
    ds_read_b64_tr_b16 v[196:197], v230 offset:32768
    v_mfma_f32_16x16x32_bf16 v[24:27], v[164:167], v[136:139], v[24:27]
    ds_read_b64_tr_b16 v[198:199], v230 offset:36864
    v_mfma_f32_16x16x32_bf16 v[28:31], v[164:167], v[140:143], v[28:31]
    v_mfma_f32_16x16x32_bf16 v[92:95], v[180:183], v[140:143], v[92:95]
    ds_read_b64_tr_b16 v[212:213], v230 offset:40960
    v_mfma_f32_16x16x32_bf16 v[88:91], v[180:183], v[136:139], v[88:91]
    ds_read_b64_tr_b16 v[214:215], v230 offset:45056
    v_mfma_f32_16x16x32_bf16 v[84:87], v[180:183], v[132:135], v[84:87]
    ds_read_b64_tr_b16 v[200:201], v231 offset:32768
    v_mfma_f32_16x16x32_bf16 v[80:83], v[180:183], v[128:131], v[80:83]
    ds_read_b64_tr_b16 v[202:203], v231 offset:36864
    v_mfma_f32_16x16x32_bf16 v[32:35], v[168:171], v[128:131], v[32:35]
    ds_read_b64_tr_b16 v[216:217], v231 offset:40960
    v_mfma_f32_16x16x32_bf16 v[36:39], v[168:171], v[132:135], v[36:39]
    v_mfma_f32_16x16x32_bf16 v[40:43], v[168:171], v[136:139], v[40:43]
    ds_read_b64_tr_b16 v[218:219], v231 offset:45056
    v_mfma_f32_16x16x32_bf16 v[44:47], v[168:171], v[140:143], v[44:47]
    ds_read_b64_tr_b16 v[204:205], v232 offset:32768
    v_mfma_f32_16x16x32_bf16 v[108:111], v[184:187], v[140:143], v[108:111]
    ds_read_b64_tr_b16 v[206:207], v232 offset:36864
    v_mfma_f32_16x16x32_bf16 v[104:107], v[184:187], v[136:139], v[104:107]
    ds_read_b64_tr_b16 v[220:221], v232 offset:40960
    v_mfma_f32_16x16x32_bf16 v[100:103], v[184:187], v[132:135], v[100:103]
    ds_read_b64_tr_b16 v[222:223], v232 offset:45056
    v_mfma_f32_16x16x32_bf16 v[96:99], v[184:187], v[128:131], v[96:99]
    v_mfma_f32_16x16x32_bf16 v[48:51], v[172:175], v[128:131], v[48:51]
    v_mfma_f32_16x16x32_bf16 v[52:55], v[172:175], v[132:135], v[52:55]
    v_mfma_f32_16x16x32_bf16 v[56:59], v[172:175], v[136:139], v[56:59]
    v_mfma_f32_16x16x32_bf16 v[60:63], v[172:175], v[140:143], v[60:63]
    v_mfma_f32_16x16x32_bf16 v[124:127], v[188:191], v[140:143], v[124:127]
    s_sub_u32 s58, s58, 1
    s_cmp_lg_u32 s58, 0
    .p2align 3
    v_mfma_f32_16x16x32_bf16 v[120:123], v[188:191], v[136:139], v[120:123]
    v_mfma_f32_16x16x32_bf16 v[116:119], v[188:191], v[132:135], v[116:119]
    v_mfma_f32_16x16x32_bf16 v[112:115], v[188:191], v[128:131], v[112:115]
    s_cbranch_scc1 loop_26
    s_waitcnt lgkmcnt(0)
    s_barrier
    .p2align 3
    v_mfma_f32_16x16x32_bf16 v[0:3], v[192:195], v[144:147], v[0:3]
    v_mfma_f32_16x16x32_bf16 v[4:7], v[192:195], v[148:151], v[4:7]
    v_mfma_f32_16x16x32_bf16 v[8:11], v[192:195], v[152:155], v[8:11]
    v_mfma_f32_16x16x32_bf16 v[12:15], v[192:195], v[156:159], v[12:15]
    v_mfma_f32_16x16x32_bf16 v[76:79], v[208:211], v[156:159], v[76:79]
    v_mfma_f32_16x16x32_bf16 v[72:75], v[208:211], v[152:155], v[72:75]
    v_mfma_f32_16x16x32_bf16 v[68:71], v[208:211], v[148:151], v[68:71]
    v_mfma_f32_16x16x32_bf16 v[64:67], v[208:211], v[144:147], v[64:67]
    v_mfma_f32_16x16x32_bf16 v[16:19], v[196:199], v[144:147], v[16:19]
    v_mfma_f32_16x16x32_bf16 v[20:23], v[196:199], v[148:151], v[20:23]
    v_mfma_f32_16x16x32_bf16 v[24:27], v[196:199], v[152:155], v[24:27]
    v_mfma_f32_16x16x32_bf16 v[28:31], v[196:199], v[156:159], v[28:31]
    v_mfma_f32_16x16x32_bf16 v[92:95], v[212:215], v[156:159], v[92:95]
    v_mfma_f32_16x16x32_bf16 v[88:91], v[212:215], v[152:155], v[88:91]
    v_mfma_f32_16x16x32_bf16 v[84:87], v[212:215], v[148:151], v[84:87]
    v_mfma_f32_16x16x32_bf16 v[80:83], v[212:215], v[144:147], v[80:83]
    v_mfma_f32_16x16x32_bf16 v[32:35], v[200:203], v[144:147], v[32:35]
    v_mfma_f32_16x16x32_bf16 v[36:39], v[200:203], v[148:151], v[36:39]
    v_mfma_f32_16x16x32_bf16 v[40:43], v[200:203], v[152:155], v[40:43]
    v_mfma_f32_16x16x32_bf16 v[44:47], v[200:203], v[156:159], v[44:47]
    v_mfma_f32_16x16x32_bf16 v[108:111], v[216:219], v[156:159], v[108:111]
    v_mfma_f32_16x16x32_bf16 v[104:107], v[216:219], v[152:155], v[104:107]
    v_mfma_f32_16x16x32_bf16 v[100:103], v[216:219], v[148:151], v[100:103]
    v_mfma_f32_16x16x32_bf16 v[96:99], v[216:219], v[144:147], v[96:99]
    v_mfma_f32_16x16x32_bf16 v[48:51], v[204:207], v[144:147], v[48:51]
    v_mfma_f32_16x16x32_bf16 v[52:55], v[204:207], v[148:151], v[52:55]
    v_mfma_f32_16x16x32_bf16 v[56:59], v[204:207], v[152:155], v[56:59]
    v_mfma_f32_16x16x32_bf16 v[60:63], v[204:207], v[156:159], v[60:63]
    v_mfma_f32_16x16x32_bf16 v[124:127], v[220:223], v[156:159], v[124:127]
    v_mfma_f32_16x16x32_bf16 v[120:123], v[220:223], v[152:155], v[120:123]
    v_mfma_f32_16x16x32_bf16 v[116:119], v[220:223], v[148:151], v[116:119]
    v_mfma_f32_16x16x32_bf16 v[112:115], v[220:223], v[144:147], v[112:115]
    s_setprio 1
    v_add_u32 v191, s88, v254
    s_barrier
    s_add_u32 s93, s51, 0
    s_and_b32 s93, s93, 15
    s_lshl_b32 s93, s93, 12
    s_add_u32 m0, s61, 0
    s_mul_i32 s59, s93, 112
    buffer_load_dwordx4 v236, s[24:27], s59 offen lds
    s_nop 7
    s_lshl_b32 s55, s43, 9
    s_add_u32 s55, s55, 159744
    v_and_b32 v232, 0xf0, v254
    v_lshrrev_b32 v232, 1, v232
    v_add_u32 v232, s55, v232
    ds_read_b64 v[220:221], v232 offset:0
    ds_read_b64 v[222:223], v232 offset:128
    ds_read_b64 v[224:225], v232 offset:256
    ds_read_b64 v[226:227], v232 offset:384
    s_waitcnt lgkmcnt(0)
    v_sub_f32 v192, 0, v220
    buffer_load_dwordx4 v237, s[24:27], s59 offen offset:1024 lds
    v_mul_f32 v196, 0xbfb8aa3b, v221
    v_mul_f32 v200, v221, v221
    v_sub_f32 v193, 0, v222
    v_mul_f32 v197, 0xbfb8aa3b, v223
    v_mul_f32 v201, v223, v223
    v_sub_f32 v194, 0, v224
    v_mul_f32 v198, 0xbfb8aa3b, v225
    v_mul_f32 v202, v225, v225
    buffer_load_dwordx4 v242, s[4:7], s93 offen offset:2048 lds
    s_add_u32 s93, s93, 2048
    s_and_b32 s93, s93, 65535
    v_sub_f32 v195, 0, v226
    v_mul_f32 v199, 0xbfb8aa3b, v227
    v_mul_f32 v203, v227, v227
    v_rcp_f32 v200, v200
    v_rcp_f32 v201, v201
    v_rcp_f32 v202, v202
    v_rcp_f32 v203, v203
    s_nop 0
    s_barrier
    s_add_u32 m0, s62, 114688
    s_nop 0
    buffer_load_dwordx4 v191, s[4:7], s94 offen lds
    s_lshl_b32 s55, s44, 8
    s_add_u32 s55, s55, 161664
    v_lshrrev_b32 v235, 8, v254
    v_lshlrev_b32 v235, 4, v235
    v_add_u32 v235, s55, v235
    ds_read_b128 v[204:207], v235 offset:0
    ds_read_b128 v[208:211], v235 offset:512
    ds_read_b128 v[212:215], v235 offset:64
    buffer_load_dwordx4 v191, s[4:7], s94 offen offset:1024 lds
    ds_read_b128 v[216:219], v235 offset:576
    s_waitcnt lgkmcnt(0)
    v_fmac_f32 v0, v192, v204
    v_fmac_f32 v1, v192, v205
    v_fmac_f32 v2, v192, v206
    s_add_u32 m0, s61, 16384
    s_mul_i32 s59, s93, 112
    buffer_load_dwordx4 v236, s[24:27], s59 offen lds
    v_fmac_f32 v3, v192, v207
    v_mul_f32 v220, v196, v0
    v_mul_f32 v221, v196, v1
    v_mul_f32 v222, v196, v2
    buffer_load_dwordx4 v237, s[24:27], s59 offen offset:1024 lds
    v_mul_f32 v223, v196, v3
    v_fmac_f32 v64, v192, v208
    v_fmac_f32 v65, v192, v209
    v_fmac_f32 v66, v192, v210
    v_fmac_f32 v67, v192, v211
    buffer_load_dwordx4 v242, s[4:7], s93 offen offset:2048 lds
    s_add_u32 s93, s93, 6144
    s_and_b32 s93, s93, 65535
    v_exp_f32 v220, v220
    v_exp_f32 v221, v221
    v_exp_f32 v222, v222
    v_exp_f32 v223, v223
    v_mul_f32 v0, v0, v64
    s_barrier
    s_add_u32 m0, s62, 114688
    s_nop 0
    buffer_load_dwordx4 v191, s[4:7], s94 offen offset:2048 lds
    v_mul_f32 v1, v1, v65
    v_mul_f32 v2, v2, v66
    v_mul_f32 v3, v3, v67
    v_fma_f32 v220, v220, v200, v200
    buffer_load_dwordx4 v191, s[4:7], s94 offen offset:3072 lds
    s_add_u32 s94, s94, 32768
    s_and_b32 s94, s94, 262143
    v_fma_f32 v221, v221, v200, v200
    v_fma_f32 v222, v222, v200, v200
    v_fma_f32 v223, v223, v200, v200
    v_rcp_f32 v220, v220
    v_rcp_f32 v221, v221
    s_add_u32 m0, s61, 32768
    s_mul_i32 s59, s93, 112
    buffer_load_dwordx4 v236, s[24:27], s59 offen lds
    v_rcp_f32 v222, v222
    v_rcp_f32 v223, v223
    v_mul_f32 v0, v0, v220
    v_mul_f32 v1, v1, v221
    v_mul_f32 v2, v2, v222
    buffer_load_dwordx4 v237, s[24:27], s59 offen offset:1024 lds
    v_mul_f32 v3, v3, v223
    v_cvt_pk_bf16_f32 v224, v0, v1
    v_cvt_pk_bf16_f32 v225, v2, v3
    v_fmac_f32 v16, v192, v212
    v_fmac_f32 v17, v192, v213
    buffer_load_dwordx4 v242, s[4:7], s93 offen offset:2048 lds
    s_add_u32 s93, s93, 2048
    s_and_b32 s93, s93, 65535
    v_fmac_f32 v18, v192, v214
    v_fmac_f32 v19, v192, v215
    v_mul_f32 v220, v196, v16
    v_mul_f32 v221, v196, v17
    v_mul_f32 v222, v196, v18
    s_barrier
    s_add_u32 m0, s62, 131072
    s_nop 0
    buffer_load_dwordx4 v191, s[4:7], s94 offen lds
    v_mul_f32 v223, v196, v19
    v_fmac_f32 v80, v192, v216
    v_fmac_f32 v81, v192, v217
    v_fmac_f32 v82, v192, v218
    buffer_load_dwordx4 v191, s[4:7], s94 offen offset:1024 lds
    v_fmac_f32 v83, v192, v219
    v_exp_f32 v220, v220
    v_exp_f32 v221, v221
    v_exp_f32 v222, v222
    s_add_u32 m0, s61, 49152
    s_mul_i32 s59, s93, 112
    buffer_load_dwordx4 v236, s[24:27], s59 offen lds
    v_exp_f32 v223, v223
    v_mul_f32 v16, v16, v80
    v_mul_f32 v17, v17, v81
    v_mul_f32 v18, v18, v82
    buffer_load_dwordx4 v237, s[24:27], s59 offen offset:1024 lds
    v_mul_f32 v19, v19, v83
    v_fma_f32 v220, v220, v200, v200
    v_fma_f32 v221, v221, v200, v200
    v_fma_f32 v222, v222, v200, v200
    buffer_load_dwordx4 v242, s[4:7], s93 offen offset:2048 lds
    s_add_u32 s93, s93, 6144
    s_and_b32 s93, s93, 65535
    v_fma_f32 v223, v223, v200, v200
    v_rcp_f32 v220, v220
    v_rcp_f32 v221, v221
    v_rcp_f32 v222, v222
    s_barrier
    s_add_u32 m0, s62, 131072
    s_nop 0
    buffer_load_dwordx4 v191, s[4:7], s94 offen offset:2048 lds
    v_rcp_f32 v223, v223
    v_mul_f32 v16, v16, v220
    v_mul_f32 v17, v17, v221
    v_mul_f32 v18, v18, v222
    buffer_load_dwordx4 v191, s[4:7], s94 offen offset:3072 lds
    s_add_u32 s94, s94, 32768
    s_and_b32 s94, s94, 262143
    v_mul_f32 v19, v19, v223
    v_cvt_pk_bf16_f32 v226, v16, v17
    v_cvt_pk_bf16_f32 v227, v18, v19
    s_add_u32 s55, s89, 0
    buffer_store_dwordx4 v[224:227], v254, s[4:7], s55 offen sc0 sc1
    s_add_u32 m0, s61, 65536
    s_mul_i32 s59, s93, 112
    buffer_load_dwordx4 v236, s[24:27], s59 offen lds
    v_fmac_f32 v4, v193, v204
    v_fmac_f32 v5, v193, v205
    v_fmac_f32 v6, v193, v206
    v_fmac_f32 v7, v193, v207
    v_mul_f32 v220, v197, v4
    buffer_load_dwordx4 v237, s[24:27], s59 offen offset:1024 lds
    v_mul_f32 v221, v197, v5
    v_mul_f32 v222, v197, v6
    v_mul_f32 v223, v197, v7
    v_fmac_f32 v68, v193, v208
    buffer_load_dwordx4 v242, s[4:7], s93 offen offset:2048 lds
    s_add_u32 s93, s93, 2048
    s_and_b32 s93, s93, 65535
    v_fmac_f32 v69, v193, v209
    v_fmac_f32 v70, v193, v210
    v_fmac_f32 v71, v193, v211
    v_exp_f32 v220, v220
    v_exp_f32 v221, v221
    s_waitcnt vmcnt(14)
    s_barrier
    s_add_u32 m0, s62, 98304
    s_nop 0
    buffer_load_dwordx4 v191, s[4:7], s94 offen lds
    v_exp_f32 v222, v222
    v_exp_f32 v223, v223
    v_mul_f32 v4, v4, v68
    v_mul_f32 v5, v5, v69
    buffer_load_dwordx4 v191, s[4:7], s94 offen offset:1024 lds
    v_mul_f32 v6, v6, v70
    v_mul_f32 v7, v7, v71
    v_fma_f32 v220, v220, v201, v201
    v_fma_f32 v221, v221, v201, v201
    s_add_u32 m0, s61, 81920
    s_mul_i32 s59, s93, 112
    buffer_load_dwordx4 v236, s[24:27], s59 offen lds
    v_fma_f32 v222, v222, v201, v201
    v_fma_f32 v223, v223, v201, v201
    v_rcp_f32 v220, v220
    v_rcp_f32 v221, v221
    v_rcp_f32 v222, v222
    buffer_load_dwordx4 v237, s[24:27], s59 offen offset:1024 lds
    v_rcp_f32 v223, v223
    v_mul_f32 v4, v4, v220
    v_mul_f32 v5, v5, v221
    v_mul_f32 v6, v6, v222
    buffer_load_dwordx4 v242, s[4:7], s93 offen offset:2048 lds
    s_add_u32 s93, s93, 6144
    s_and_b32 s93, s93, 65535
    v_mul_f32 v7, v7, v223
    v_cvt_pk_bf16_f32 v228, v4, v5
    v_cvt_pk_bf16_f32 v229, v6, v7
    v_fmac_f32 v20, v193, v212
    v_fmac_f32 v21, v193, v213
    s_barrier
    s_add_u32 m0, s62, 98304
    s_nop 0
    buffer_load_dwordx4 v191, s[4:7], s94 offen offset:2048 lds
    v_fmac_f32 v22, v193, v214
    v_fmac_f32 v23, v193, v215
    v_mul_f32 v220, v197, v20
    v_mul_f32 v221, v197, v21
    buffer_load_dwordx4 v191, s[4:7], s94 offen offset:3072 lds
    s_add_u32 s94, s94, 32768
    s_and_b32 s94, s94, 262143
    v_mul_f32 v222, v197, v22
    v_mul_f32 v223, v197, v23
    v_fmac_f32 v84, v193, v216
    v_fmac_f32 v85, v193, v217
    v_fmac_f32 v86, v193, v218
    s_add_u32 m0, s61, 0
    s_mul_i32 s59, s93, 112
    buffer_load_dwordx4 v236, s[24:27], s59 offen lds
    v_fmac_f32 v87, v193, v219
    v_exp_f32 v220, v220
    v_exp_f32 v221, v221
    v_exp_f32 v222, v222
    buffer_load_dwordx4 v237, s[24:27], s59 offen offset:1024 lds
    v_exp_f32 v223, v223
    v_mul_f32 v20, v20, v84
    v_mul_f32 v21, v21, v85
    v_mul_f32 v22, v22, v86
    v_mul_f32 v23, v23, v87
    buffer_load_dwordx4 v242, s[4:7], s93 offen offset:2048 lds
    s_add_u32 s93, s93, 2048
    s_and_b32 s93, s93, 65535
    v_fma_f32 v220, v220, v201, v201
    v_fma_f32 v221, v221, v201, v201
    v_fma_f32 v222, v222, v201, v201
    v_fma_f32 v223, v223, v201, v201
    v_rcp_f32 v220, v220
    s_waitcnt vmcnt(14)
    s_barrier
    s_add_u32 m0, s62, 114688
    s_nop 0
    buffer_load_dwordx4 v191, s[4:7], s94 offen lds
    v_rcp_f32 v221, v221
    v_rcp_f32 v222, v222
    v_rcp_f32 v223, v223
    v_mul_f32 v20, v20, v220
    buffer_load_dwordx4 v191, s[4:7], s94 offen offset:1024 lds
    v_mul_f32 v21, v21, v221
    v_mul_f32 v22, v22, v222
    v_mul_f32 v23, v23, v223
    v_cvt_pk_bf16_f32 v230, v20, v21
    s_add_u32 m0, s61, 16384
    s_mul_i32 s59, s93, 112
    buffer_load_dwordx4 v236, s[24:27], s59 offen lds
    v_cvt_pk_bf16_f32 v231, v22, v23
    s_add_u32 s55, s89, 2048
    buffer_store_dwordx4 v[228:231], v254, s[4:7], s55 offen sc0 sc1
    v_fmac_f32 v8, v194, v204
    v_fmac_f32 v9, v194, v205
    v_fmac_f32 v10, v194, v206
    buffer_load_dwordx4 v237, s[24:27], s59 offen offset:1024 lds
    v_fmac_f32 v11, v194, v207
    v_mul_f32 v220, v198, v8
    v_mul_f32 v221, v198, v9
    v_mul_f32 v222, v198, v10
    buffer_load_dwordx4 v242, s[4:7], s93 offen offset:2048 lds
    s_add_u32 s93, s93, 6144
    s_and_b32 s93, s93, 65535
    v_mul_f32 v223, v198, v11
    v_fmac_f32 v72, v194, v208
    v_fmac_f32 v73, v194, v209
    v_fmac_f32 v74, v194, v210
    v_fmac_f32 v75, v194, v211
    s_barrier
    s_add_u32 m0, s62, 114688
    s_nop 0
    buffer_load_dwordx4 v191, s[4:7], s94 offen offset:2048 lds
    v_exp_f32 v220, v220
    v_exp_f32 v221, v221
    v_exp_f32 v222, v222
    v_exp_f32 v223, v223
    buffer_load_dwordx4 v191, s[4:7], s94 offen offset:3072 lds
    s_add_u32 s94, s94, 32768
    s_and_b32 s94, s94, 262143
    v_mul_f32 v8, v8, v72
    v_mul_f32 v9, v9, v73
    v_mul_f32 v10, v10, v74
    v_mul_f32 v11, v11, v75
    s_add_u32 m0, s61, 32768
    s_mul_i32 s59, s93, 112
    buffer_load_dwordx4 v236, s[24:27], s59 offen lds
    v_fma_f32 v220, v220, v202, v202
    v_fma_f32 v221, v221, v202, v202
    v_fma_f32 v222, v222, v202, v202
    v_fma_f32 v223, v223, v202, v202
    buffer_load_dwordx4 v237, s[24:27], s59 offen offset:1024 lds
    v_rcp_f32 v220, v220
    v_rcp_f32 v221, v221
    v_rcp_f32 v222, v222
    v_rcp_f32 v223, v223
    buffer_load_dwordx4 v242, s[4:7], s93 offen offset:2048 lds
    s_add_u32 s93, s93, 2048
    s_and_b32 s93, s93, 65535
    v_mul_f32 v8, v8, v220
    v_mul_f32 v9, v9, v221
    v_mul_f32 v10, v10, v222
    v_mul_f32 v11, v11, v223
    s_waitcnt vmcnt(14)
    s_barrier
    s_add_u32 m0, s62, 131072
    s_nop 0
    buffer_load_dwordx4 v191, s[4:7], s94 offen lds
    v_cvt_pk_bf16_f32 v224, v8, v9
    v_cvt_pk_bf16_f32 v225, v10, v11
    v_fmac_f32 v24, v194, v212
    v_fmac_f32 v25, v194, v213
    buffer_load_dwordx4 v191, s[4:7], s94 offen offset:1024 lds
    v_fmac_f32 v26, v194, v214
    v_fmac_f32 v27, v194, v215
    v_mul_f32 v220, v198, v24
    v_mul_f32 v221, v198, v25
    v_mul_f32 v222, v198, v26
    s_add_u32 m0, s61, 49152
    s_mul_i32 s59, s93, 112
    buffer_load_dwordx4 v236, s[24:27], s59 offen lds
    v_mul_f32 v223, v198, v27
    v_fmac_f32 v88, v194, v216
    v_fmac_f32 v89, v194, v217
    v_fmac_f32 v90, v194, v218
    v_fmac_f32 v91, v194, v219
    buffer_load_dwordx4 v237, s[24:27], s59 offen offset:1024 lds
    v_exp_f32 v220, v220
    v_exp_f32 v221, v221
    v_exp_f32 v222, v222
    v_exp_f32 v223, v223
    v_mul_f32 v24, v24, v88
    buffer_load_dwordx4 v242, s[4:7], s93 offen offset:2048 lds
    s_add_u32 s93, s93, 6144
    s_and_b32 s93, s93, 65535
    v_mul_f32 v25, v25, v89
    v_mul_f32 v26, v26, v90
    v_mul_f32 v27, v27, v91
    v_fma_f32 v220, v220, v202, v202
    v_fma_f32 v221, v221, v202, v202
    s_barrier
    s_add_u32 m0, s62, 131072
    s_nop 0
    buffer_load_dwordx4 v191, s[4:7], s94 offen offset:2048 lds
    v_fma_f32 v222, v222, v202, v202
    v_fma_f32 v223, v223, v202, v202
    v_rcp_f32 v220, v220
    v_rcp_f32 v221, v221
    buffer_load_dwordx4 v191, s[4:7], s94 offen offset:3072 lds
    s_add_u32 s94, s94, 32768
    s_and_b32 s94, s94, 262143
    v_rcp_f32 v222, v222
    v_rcp_f32 v223, v223
    v_mul_f32 v24, v24, v220
    v_mul_f32 v25, v25, v221
    s_add_u32 m0, s61, 65536
    s_mul_i32 s59, s93, 112
    buffer_load_dwordx4 v236, s[24:27], s59 offen lds
    v_mul_f32 v26, v26, v222
    v_mul_f32 v27, v27, v223
    v_cvt_pk_bf16_f32 v226, v24, v25
    v_cvt_pk_bf16_f32 v227, v26, v27
    buffer_load_dwordx4 v237, s[24:27], s59 offen offset:1024 lds
    s_add_u32 s55, s89, 4096
    buffer_store_dwordx4 v[224:227], v254, s[4:7], s55 offen sc0 sc1
    v_fmac_f32 v12, v195, v204
    v_fmac_f32 v13, v195, v205
    v_fmac_f32 v14, v195, v206
    buffer_load_dwordx4 v242, s[4:7], s93 offen offset:2048 lds
    s_add_u32 s93, s93, 2048
    s_and_b32 s93, s93, 65535
    v_fmac_f32 v15, v195, v207
    v_mul_f32 v220, v199, v12
    v_mul_f32 v221, v199, v13
    v_mul_f32 v222, v199, v14
    v_mul_f32 v223, v199, v15
    s_waitcnt vmcnt(14)
    s_barrier
    s_add_u32 m0, s62, 98304
    s_nop 0
    buffer_load_dwordx4 v191, s[4:7], s94 offen lds
    v_fmac_f32 v76, v195, v208
    v_fmac_f32 v77, v195, v209
    v_fmac_f32 v78, v195, v210
    v_fmac_f32 v79, v195, v211
    buffer_load_dwordx4 v191, s[4:7], s94 offen offset:1024 lds
    v_exp_f32 v220, v220
    v_exp_f32 v221, v221
    v_exp_f32 v222, v222
    v_exp_f32 v223, v223
    s_add_u32 m0, s61, 81920
    s_mul_i32 s59, s93, 112
    buffer_load_dwordx4 v236, s[24:27], s59 offen lds
    v_mul_f32 v12, v12, v76
    v_mul_f32 v13, v13, v77
    v_mul_f32 v14, v14, v78
    v_mul_f32 v15, v15, v79
    buffer_load_dwordx4 v237, s[24:27], s59 offen offset:1024 lds
    v_fma_f32 v220, v220, v203, v203
    v_fma_f32 v221, v221, v203, v203
    v_fma_f32 v222, v222, v203, v203
    v_fma_f32 v223, v223, v203, v203
    buffer_load_dwordx4 v242, s[4:7], s93 offen offset:2048 lds
    s_add_u32 s93, s93, 6144
    s_and_b32 s93, s93, 65535
    v_rcp_f32 v220, v220
    v_rcp_f32 v221, v221
    v_rcp_f32 v222, v222
    v_rcp_f32 v223, v223
    s_barrier
    s_add_u32 m0, s62, 98304
    s_nop 0
    buffer_load_dwordx4 v191, s[4:7], s94 offen offset:2048 lds
    v_mul_f32 v12, v12, v220
    v_mul_f32 v13, v13, v221
    v_mul_f32 v14, v14, v222
    v_mul_f32 v15, v15, v223
    buffer_load_dwordx4 v191, s[4:7], s94 offen offset:3072 lds
    s_add_u32 s94, s94, 32768
    s_and_b32 s94, s94, 262143
    v_cvt_pk_bf16_f32 v228, v12, v13
    v_cvt_pk_bf16_f32 v229, v14, v15
    v_fmac_f32 v28, v195, v212
    v_fmac_f32 v29, v195, v213
    v_fmac_f32 v30, v195, v214
    s_add_u32 m0, s61, 0
    s_mul_i32 s59, s93, 112
    buffer_load_dwordx4 v236, s[24:27], s59 offen lds
    v_fmac_f32 v31, v195, v215
    v_mul_f32 v220, v199, v28
    v_mul_f32 v221, v199, v29
    v_mul_f32 v222, v199, v30
    v_mul_f32 v223, v199, v31
    buffer_load_dwordx4 v237, s[24:27], s59 offen offset:1024 lds
    v_fmac_f32 v92, v195, v216
    v_fmac_f32 v93, v195, v217
    v_fmac_f32 v94, v195, v218
    v_fmac_f32 v95, v195, v219
    v_exp_f32 v220, v220
    buffer_load_dwordx4 v242, s[4:7], s93 offen offset:2048 lds
    s_add_u32 s93, s93, 2048
    s_and_b32 s93, s93, 65535
    v_exp_f32 v221, v221
    v_exp_f32 v222, v222
    v_exp_f32 v223, v223
    v_mul_f32 v28, v28, v92
    v_mul_f32 v29, v29, v93
    s_waitcnt vmcnt(14)
    s_barrier
    s_add_u32 m0, s62, 114688
    s_nop 0
    buffer_load_dwordx4 v191, s[4:7], s94 offen lds
    v_mul_f32 v30, v30, v94
    v_mul_f32 v31, v31, v95
    v_fma_f32 v220, v220, v203, v203
    buffer_load_dwordx4 v191, s[4:7], s94 offen offset:1024 lds
    v_fma_f32 v221, v221, v203, v203
    v_fma_f32 v222, v222, v203, v203
    v_fma_f32 v223, v223, v203, v203
    s_add_u32 m0, s61, 16384
    s_mul_i32 s59, s93, 112
    buffer_load_dwordx4 v236, s[24:27], s59 offen lds
    v_rcp_f32 v220, v220
    v_rcp_f32 v221, v221
    v_rcp_f32 v222, v222
    v_rcp_f32 v223, v223
    buffer_load_dwordx4 v237, s[24:27], s59 offen offset:1024 lds
    v_mul_f32 v28, v28, v220
    v_mul_f32 v29, v29, v221
    v_mul_f32 v30, v30, v222
    buffer_load_dwordx4 v242, s[4:7], s93 offen offset:2048 lds
    s_add_u32 s93, s93, 6144
    s_and_b32 s93, s93, 65535
    v_mul_f32 v31, v31, v223
    v_cvt_pk_bf16_f32 v230, v28, v29
    v_cvt_pk_bf16_f32 v231, v30, v31
    s_add_u32 s55, s89, 6144
    buffer_store_dwordx4 v[228:231], v254, s[4:7], s55 offen sc0 sc1
    s_barrier
    s_add_u32 m0, s62, 114688
    s_nop 0
    buffer_load_dwordx4 v191, s[4:7], s94 offen offset:2048 lds
    ds_read_b128 v[204:207], v235 offset:128
    ds_read_b128 v[208:211], v235 offset:640
    ds_read_b128 v[212:215], v235 offset:192
    ds_read_b128 v[216:219], v235 offset:704
    s_waitcnt lgkmcnt(0)
    buffer_load_dwordx4 v191, s[4:7], s94 offen offset:3072 lds
    s_add_u32 s94, s94, 32768
    s_and_b32 s94, s94, 262143
    v_fmac_f32 v32, v192, v204
    v_fmac_f32 v33, v192, v205
    v_fmac_f32 v34, v192, v206
    v_fmac_f32 v35, v192, v207
    v_mul_f32 v220, v196, v32
    s_add_u32 m0, s61, 32768
    s_mul_i32 s59, s93, 112
    buffer_load_dwordx4 v236, s[24:27], s59 offen lds
    v_mul_f32 v221, v196, v33
    v_mul_f32 v222, v196, v34
    v_mul_f32 v223, v196, v35
    v_fmac_f32 v96, v192, v208
    v_fmac_f32 v97, v192, v209
    buffer_load_dwordx4 v237, s[24:27], s59 offen offset:1024 lds
    v_fmac_f32 v98, v192, v210
    v_fmac_f32 v99, v192, v211
    v_exp_f32 v220, v220
    v_exp_f32 v221, v221
    v_exp_f32 v222, v222
    buffer_load_dwordx4 v242, s[4:7], s93 offen offset:2048 lds
    s_add_u32 s93, s93, 2048
    s_and_b32 s93, s93, 65535
    v_exp_f32 v223, v223
    v_mul_f32 v32, v32, v96
    v_mul_f32 v33, v33, v97
    v_mul_f32 v34, v34, v98
    v_mul_f32 v35, v35, v99
    v_fma_f32 v220, v220, v200, v200
    s_waitcnt vmcnt(14)
    s_barrier
    s_add_u32 m0, s62, 131072
    s_nop 0
    buffer_load_dwordx4 v191, s[4:7], s94 offen lds
    v_fma_f32 v221, v221, v200, v200
    v_fma_f32 v222, v222, v200, v200
    v_fma_f32 v223, v223, v200, v200
    v_rcp_f32 v220, v220
    buffer_load_dwordx4 v191, s[4:7], s94 offen offset:1024 lds
    v_rcp_f32 v221, v221
    v_rcp_f32 v222, v222
    v_rcp_f32 v223, v223
    v_mul_f32 v32, v32, v220
    v_mul_f32 v33, v33, v221
    s_add_u32 m0, s61, 49152
    s_mul_i32 s59, s93, 112
    buffer_load_dwordx4 v236, s[24:27], s59 offen lds
    v_mul_f32 v34, v34, v222
    v_mul_f32 v35, v35, v223
    v_cvt_pk_bf16_f32 v224, v32, v33
    v_cvt_pk_bf16_f32 v225, v34, v35
    v_fmac_f32 v48, v192, v212
    buffer_load_dwordx4 v237, s[24:27], s59 offen offset:1024 lds
    v_fmac_f32 v49, v192, v213
    v_fmac_f32 v50, v192, v214
    v_fmac_f32 v51, v192, v215
    v_mul_f32 v220, v196, v48
    v_mul_f32 v221, v196, v49
    buffer_load_dwordx4 v242, s[4:7], s93 offen offset:2048 lds
    s_add_u32 s93, s93, 10240
    s_and_b32 s93, s93, 65535
    v_mul_f32 v222, v196, v50
    v_mul_f32 v223, v196, v51
    v_fmac_f32 v112, v192, v216
    v_fmac_f32 v113, v192, v217
    v_fmac_f32 v114, v192, v218
    s_barrier
    s_add_u32 m0, s62, 131072
    s_nop 0
    buffer_load_dwordx4 v191, s[4:7], s94 offen offset:2048 lds
    v_fmac_f32 v115, v192, v219
    v_exp_f32 v220, v220
    v_exp_f32 v221, v221
    v_exp_f32 v222, v222
    buffer_load_dwordx4 v191, s[4:7], s94 offen offset:3072 lds
    s_add_u32 s94, s94, 49152
    s_and_b32 s94, s94, 262143
    v_exp_f32 v223, v223
    v_mul_f32 v48, v48, v112
    v_mul_f32 v49, v49, v113
    v_mul_f32 v50, v50, v114
    s_add_u32 m0, s61, 65536
    s_mul_i32 s59, s93, 112
    buffer_load_dwordx4 v236, s[24:27], s59 offen lds
    v_mul_f32 v51, v51, v115
    v_fma_f32 v220, v220, v200, v200
    v_fma_f32 v221, v221, v200, v200
    v_fma_f32 v222, v222, v200, v200
    buffer_load_dwordx4 v237, s[24:27], s59 offen offset:1024 lds
    v_fma_f32 v223, v223, v200, v200
    v_rcp_f32 v220, v220
    v_rcp_f32 v221, v221
    v_rcp_f32 v222, v222
    buffer_load_dwordx4 v242, s[4:7], s93 offen offset:2048 lds
    s_add_u32 s93, s93, 2048
    s_and_b32 s93, s93, 65535
    v_rcp_f32 v223, v223
    v_mul_f32 v48, v48, v220
    v_mul_f32 v49, v49, v221
    v_mul_f32 v50, v50, v222
    s_waitcnt vmcnt(13)
    s_barrier
    s_cmp_lg_u32 s42, 0
    s_cbranch_scc1 wf_27
    s_lshr_b32 s55, s2, 5
    s_lshl_b32 s55, s55, 2
    s_add_u32 s55, s55, s0
    v_mov_b32 v252, 2048
    v_mov_b32 v253, 0x01010101
    s_mov_b64 exec, 1
    s_cmp_eq_u32 s45, 0
    s_cbranch_scc1 st_28
    buffer_store_dword v253, v252, s[4:7], s55 offen sc0 sc1
    s_branch st_29
st_28:
    buffer_store_dword v253, v252, s[4:7], s55 offen
st_29:
    s_mov_b64 exec, -1
wf_27:
    s_add_u32 m0, s62, 98304
    s_nop 0
    buffer_load_dwordx4 v191, s[4:7], s94 offen lds
    v_mul_f32 v51, v51, v223
    v_cvt_pk_bf16_f32 v226, v48, v49
    v_cvt_pk_bf16_f32 v227, v50, v51
    s_add_u32 s55, s89, 131072
    buffer_store_dwordx4 v[224:227], v254, s[4:7], s55 offen sc0 sc1
    buffer_load_dwordx4 v191, s[4:7], s94 offen offset:1024 lds
    v_fmac_f32 v36, v193, v204
    v_fmac_f32 v37, v193, v205
    v_fmac_f32 v38, v193, v206
    v_fmac_f32 v39, v193, v207
    s_add_u32 m0, s61, 81920
    s_mul_i32 s59, s93, 112
    buffer_load_dwordx4 v236, s[24:27], s59 offen lds
    v_mul_f32 v220, v197, v36
    v_mul_f32 v221, v197, v37
    v_mul_f32 v222, v197, v38
    v_mul_f32 v223, v197, v39
    buffer_load_dwordx4 v237, s[24:27], s59 offen offset:1024 lds
    v_fmac_f32 v100, v193, v208
    v_fmac_f32 v101, v193, v209
    v_fmac_f32 v102, v193, v210
    v_fmac_f32 v103, v193, v211
    buffer_load_dwordx4 v242, s[4:7], s93 offen offset:2048 lds
    s_add_u32 s93, s93, 6144
    s_and_b32 s93, s93, 65535
    v_exp_f32 v220, v220
    v_exp_f32 v221, v221
    v_exp_f32 v222, v222
    v_exp_f32 v223, v223
    v_mul_f32 v36, v36, v100
    s_barrier
    s_add_u32 m0, s62, 98304
    s_nop 0
    buffer_load_dwordx4 v191, s[4:7], s94 offen offset:2048 lds
    v_mul_f32 v37, v37, v101
    v_mul_f32 v38, v38, v102
    v_mul_f32 v39, v39, v103
    v_fma_f32 v220, v220, v201, v201
    buffer_load_dwordx4 v191, s[4:7], s94 offen offset:3072 lds
    s_add_u32 s94, s94, 32768
    s_and_b32 s94, s94, 262143
    v_fma_f32 v221, v221, v201, v201
    v_fma_f32 v222, v222, v201, v201
    v_fma_f32 v223, v223, v201, v201
    v_rcp_f32 v220, v220
    v_rcp_f32 v221, v221
    s_add_u32 m0, s61, 0
    s_mul_i32 s59, s93, 112
    buffer_load_dwordx4 v236, s[24:27], s59 offen lds
    v_rcp_f32 v222, v222
    v_rcp_f32 v223, v223
    v_mul_f32 v36, v36, v220
    v_mul_f32 v37, v37, v221
    v_mul_f32 v38, v38, v222
    buffer_load_dwordx4 v237, s[24:27], s59 offen offset:1024 lds
    v_mul_f32 v39, v39, v223
    v_cvt_pk_bf16_f32 v228, v36, v37
    v_cvt_pk_bf16_f32 v229, v38, v39
    v_fmac_f32 v52, v193, v212
    v_fmac_f32 v53, v193, v213
    buffer_load_dwordx4 v242, s[4:7], s93 offen offset:2048 lds
    s_add_u32 s93, s93, 2048
    s_and_b32 s93, s93, 65535
    v_fmac_f32 v54, v193, v214
    v_fmac_f32 v55, v193, v215
    v_mul_f32 v220, v197, v52
    v_mul_f32 v221, v197, v53
    v_mul_f32 v222, v197, v54
    s_waitcnt vmcnt(14)
    s_barrier
    s_add_u32 m0, s62, 114688
    s_nop 0
    buffer_load_dwordx4 v191, s[4:7], s94 offen lds
    v_mul_f32 v223, v197, v55
    v_fmac_f32 v116, v193, v216
    v_fmac_f32 v117, v193, v217
    v_fmac_f32 v118, v193, v218
    buffer_load_dwordx4 v191, s[4:7], s94 offen offset:1024 lds
    v_fmac_f32 v119, v193, v219
    v_exp_f32 v220, v220
    v_exp_f32 v221, v221
    v_exp_f32 v222, v222
    s_add_u32 m0, s61, 16384
    s_mul_i32 s59, s93, 112
    buffer_load_dwordx4 v236, s[24:27], s59 offen lds
    v_exp_f32 v223, v223
    v_mul_f32 v52, v52, v116
    v_mul_f32 v53, v53, v117
    v_mul_f32 v54, v54, v118
    buffer_load_dwordx4 v237, s[24:27], s59 offen offset:1024 lds
    v_mul_f32 v55, v55, v119
    v_fma_f32 v220, v220, v201, v201
    v_fma_f32 v221, v221, v201, v201
    v_fma_f32 v222, v222, v201, v201
    buffer_load_dwordx4 v242, s[4:7], s93 offen offset:2048 lds
    s_add_u32 s93, s93, 6144
    s_and_b32 s93, s93, 65535
    v_fma_f32 v223, v223, v201, v201
    v_rcp_f32 v220, v220
    v_rcp_f32 v221, v221
    v_rcp_f32 v222, v222
    s_barrier
    s_add_u32 m0, s62, 114688
    s_nop 0
    buffer_load_dwordx4 v191, s[4:7], s94 offen offset:2048 lds
    v_rcp_f32 v223, v223
    v_mul_f32 v52, v52, v220
    v_mul_f32 v53, v53, v221
    v_mul_f32 v54, v54, v222
    buffer_load_dwordx4 v191, s[4:7], s94 offen offset:3072 lds
    s_add_u32 s94, s94, 32768
    s_and_b32 s94, s94, 262143
    v_mul_f32 v55, v55, v223
    v_cvt_pk_bf16_f32 v230, v52, v53
    v_cvt_pk_bf16_f32 v231, v54, v55
    s_add_u32 s55, s89, 133120
    buffer_store_dwordx4 v[228:231], v254, s[4:7], s55 offen sc0 sc1
    s_add_u32 m0, s61, 32768
    s_mul_i32 s59, s93, 112
    buffer_load_dwordx4 v236, s[24:27], s59 offen lds
    v_fmac_f32 v40, v194, v204
    v_fmac_f32 v41, v194, v205
    v_fmac_f32 v42, v194, v206
    v_fmac_f32 v43, v194, v207
    v_mul_f32 v220, v198, v40
    buffer_load_dwordx4 v237, s[24:27], s59 offen offset:1024 lds
    v_mul_f32 v221, v198, v41
    v_mul_f32 v222, v198, v42
    v_mul_f32 v223, v198, v43
    v_fmac_f32 v104, v194, v208
    buffer_load_dwordx4 v242, s[4:7], s93 offen offset:2048 lds
    s_add_u32 s93, s93, 2048
    s_and_b32 s93, s93, 65535
    v_fmac_f32 v105, v194, v209
    v_fmac_f32 v106, v194, v210
    v_fmac_f32 v107, v194, v211
    v_exp_f32 v220, v220
    v_exp_f32 v221, v221
    s_waitcnt vmcnt(14)
    s_barrier
    s_add_u32 m0, s62, 131072
    s_nop 0
    buffer_load_dwordx4 v191, s[4:7], s94 offen lds
    v_exp_f32 v222, v222
    v_exp_f32 v223, v223
    v_mul_f32 v40, v40, v104
    v_mul_f32 v41, v41, v105
    buffer_load_dwordx4 v191, s[4:7], s94 offen offset:1024 lds
    v_mul_f32 v42, v42, v106
    v_mul_f32 v43, v43, v107
    v_fma_f32 v220, v220, v202, v202
    v_fma_f32 v221, v221, v202, v202
    s_add_u32 m0, s61, 49152
    s_mul_i32 s59, s93, 112
    buffer_load_dwordx4 v236, s[24:27], s59 offen lds
    v_fma_f32 v222, v222, v202, v202
    v_fma_f32 v223, v223, v202, v202
    v_rcp_f32 v220, v220
    v_rcp_f32 v221, v221
    v_rcp_f32 v222, v222
    buffer_load_dwordx4 v237, s[24:27], s59 offen offset:1024 lds
    v_rcp_f32 v223, v223
    v_mul_f32 v40, v40, v220
    v_mul_f32 v41, v41, v221
    v_mul_f32 v42, v42, v222
    buffer_load_dwordx4 v242, s[4:7], s93 offen offset:2048 lds
    s_add_u32 s93, s93, 6144
    s_and_b32 s93, s93, 65535
    v_mul_f32 v43, v43, v223
    v_cvt_pk_bf16_f32 v224, v40, v41
    v_cvt_pk_bf16_f32 v225, v42, v43
    v_fmac_f32 v56, v194, v212
    v_fmac_f32 v57, v194, v213
    s_barrier
    s_add_u32 m0, s62, 131072
    s_nop 0
    buffer_load_dwordx4 v191, s[4:7], s94 offen offset:2048 lds
    v_fmac_f32 v58, v194, v214
    v_fmac_f32 v59, v194, v215
    v_mul_f32 v220, v198, v56
    v_mul_f32 v221, v198, v57
    buffer_load_dwordx4 v191, s[4:7], s94 offen offset:3072 lds
    s_add_u32 s94, s94, 32768
    s_and_b32 s94, s94, 262143
    v_mul_f32 v222, v198, v58
    v_mul_f32 v223, v198, v59
    v_fmac_f32 v120, v194, v216
    v_fmac_f32 v121, v194, v217
    v_fmac_f32 v122, v194, v218
    s_add_u32 m0, s61, 65536
    s_mul_i32 s59, s93, 112
    buffer_load_dwordx4 v236, s[24:27], s59 offen lds
    v_fmac_f32 v123, v194, v219
    v_exp_f32 v220, v220
    v_exp_f32 v221, v221
    v_exp_f32 v222, v222
    buffer_load_dwordx4 v237, s[24:27], s59 offen offset:1024 lds
    v_exp_f32 v223, v223
    v_mul_f32 v56, v56, v120
    v_mul_f32 v57, v57, v121
    v_mul_f32 v58, v58, v122
    v_mul_f32 v59, v59, v123
    buffer_load_dwordx4 v242, s[4:7], s93 offen offset:2048 lds
    s_add_u32 s93, s93, 2048
    s_and_b32 s93, s93, 65535
    v_fma_f32 v220, v220, v202, v202
    v_fma_f32 v221, v221, v202, v202
    v_fma_f32 v222, v222, v202, v202
    v_fma_f32 v223, v223, v202, v202
    v_rcp_f32 v220, v220
    s_waitcnt vmcnt(14)
    s_barrier
    s_add_u32 m0, s62, 98304
    s_nop 0
    buffer_load_dwordx4 v191, s[4:7], s94 offen lds
    v_rcp_f32 v221, v221
    v_rcp_f32 v222, v222
    v_rcp_f32 v223, v223
    v_mul_f32 v56, v56, v220
    buffer_load_dwordx4 v191, s[4:7], s94 offen offset:1024 lds
    v_mul_f32 v57, v57, v221
    v_mul_f32 v58, v58, v222
    v_mul_f32 v59, v59, v223
    v_cvt_pk_bf16_f32 v226, v56, v57
    s_add_u32 m0, s61, 81920
    s_mul_i32 s59, s93, 112
    buffer_load_dwordx4 v236, s[24:27], s59 offen lds
    v_cvt_pk_bf16_f32 v227, v58, v59
    s_add_u32 s55, s89, 135168
    buffer_store_dwordx4 v[224:227], v254, s[4:7], s55 offen sc0 sc1
    v_fmac_f32 v44, v195, v204
    v_fmac_f32 v45, v195, v205
    v_fmac_f32 v46, v195, v206
    buffer_load_dwordx4 v237, s[24:27], s59 offen offset:1024 lds
    v_fmac_f32 v47, v195, v207
    v_mul_f32 v220, v199, v44
    v_mul_f32 v221, v199, v45
    v_mul_f32 v222, v199, v46
    buffer_load_dwordx4 v242, s[4:7], s93 offen offset:2048 lds
    s_add_u32 s93, s93, 6144
    s_and_b32 s93, s93, 65535
    v_mul_f32 v223, v199, v47
    v_fmac_f32 v108, v195, v208
    v_fmac_f32 v109, v195, v209
    v_fmac_f32 v110, v195, v210
    v_fmac_f32 v111, v195, v211
    s_barrier
    s_add_u32 m0, s62, 98304
    s_nop 0
    buffer_load_dwordx4 v191, s[4:7], s94 offen offset:2048 lds
    v_exp_f32 v220, v220
    v_exp_f32 v221, v221
    v_exp_f32 v222, v222
    v_exp_f32 v223, v223
    buffer_load_dwordx4 v191, s[4:7], s94 offen offset:3072 lds
    s_add_u32 s94, s94, 32768
    s_and_b32 s94, s94, 262143
    v_mul_f32 v44, v44, v108
    v_mul_f32 v45, v45, v109
    v_mul_f32 v46, v46, v110
    v_mul_f32 v47, v47, v111
    s_add_u32 m0, s61, 0
    s_mul_i32 s59, s93, 112
    buffer_load_dwordx4 v236, s[24:27], s59 offen lds
    v_fma_f32 v220, v220, v203, v203
    v_fma_f32 v221, v221, v203, v203
    v_fma_f32 v222, v222, v203, v203
    v_fma_f32 v223, v223, v203, v203
    buffer_load_dwordx4 v237, s[24:27], s59 offen offset:1024 lds
    v_rcp_f32 v220, v220
    v_rcp_f32 v221, v221
    v_rcp_f32 v222, v222
    v_rcp_f32 v223, v223
    buffer_load_dwordx4 v242, s[4:7], s93 offen offset:2048 lds
    s_add_u32 s93, s93, 2048
    s_and_b32 s93, s93, 65535
    v_mul_f32 v44, v44, v220
    v_mul_f32 v45, v45, v221
    v_mul_f32 v46, v46, v222
    v_mul_f32 v47, v47, v223
    s_waitcnt vmcnt(14)
    s_barrier
    v_lshrrev_b32 v252, 2, v254
    v_min_u32 v252, 28, v252
    s_add_u32 s55, s0, 2048
    buffer_load_dword v232, v252, s[4:7], s55 offen sc0 sc1
    s_add_u32 m0, s62, 114688
    s_nop 0
    buffer_load_dwordx4 v191, s[4:7], s94 offen lds
    v_cvt_pk_bf16_f32 v228, v44, v45
    v_cvt_pk_bf16_f32 v229, v46, v47
    v_fmac_f32 v60, v195, v212
    v_fmac_f32 v61, v195, v213
    buffer_load_dwordx4 v191, s[4:7], s94 offen offset:1024 lds
    v_fmac_f32 v62, v195, v214
    v_fmac_f32 v63, v195, v215
    v_mul_f32 v220, v199, v60
    v_mul_f32 v221, v199, v61
    v_mul_f32 v222, v199, v62
    s_add_u32 m0, s61, 16384
    s_mul_i32 s59, s93, 112
    buffer_load_dwordx4 v236, s[24:27], s59 offen lds
    v_mul_f32 v223, v199, v63
    v_fmac_f32 v124, v195, v216
    v_fmac_f32 v125, v195, v217
    v_fmac_f32 v126, v195, v218
    v_fmac_f32 v127, v195, v219
    buffer_load_dwordx4 v237, s[24:27], s59 offen offset:1024 lds
    v_exp_f32 v220, v220
    v_exp_f32 v221, v221
    v_exp_f32 v222, v222
    v_exp_f32 v223, v223
    v_mul_f32 v60, v60, v124
    buffer_load_dwordx4 v242, s[4:7], s93 offen offset:2048 lds
    v_mul_f32 v61, v61, v125
    v_mul_f32 v62, v62, v126
    v_mul_f32 v63, v63, v127
    v_fma_f32 v220, v220, v203, v203
    v_fma_f32 v221, v221, v203, v203
    s_barrier
    s_add_u32 m0, s62, 114688
    s_nop 0
    buffer_load_dwordx4 v191, s[4:7], s94 offen offset:2048 lds
    v_fma_f32 v222, v222, v203, v203
    v_fma_f32 v223, v223, v203, v203
    buffer_load_dwordx4 v191, s[4:7], s94 offen offset:3072 lds
    v_rcp_f32 v220, v220
    v_rcp_f32 v221, v221
    s_add_u32 m0, s62, 32768
    s_add_u32 s59, s68, 0
    buffer_load_dwordx4 v238, s[20:23], s59 offen lds
    v_rcp_f32 v222, v222
    v_rcp_f32 v223, v223
    buffer_load_dwordx4 v239, s[20:23], s59 offen offset:1024 lds
    v_mul_f32 v60, v60, v220
    v_mul_f32 v61, v61, v221
    buffer_load_dwordx4 v240, s[20:23], s59 offen offset:2048 lds
    v_mul_f32 v62, v62, v222
    v_mul_f32 v63, v63, v223
    buffer_load_dwordx4 v241, s[20:23], s59 offen offset:3072 lds
    v_cvt_pk_bf16_f32 v230, v60, v61
    v_cvt_pk_bf16_f32 v231, v62, v63
    s_add_u32 s55, s89, 137216
    buffer_store_dwordx4 v[228:231], v254, s[4:7], s55 offen sc0 sc1
    s_waitcnt vmcnt(16)
    s_barrier
    s_waitcnt vmcnt(12)
    v_cmp_ne_u32 vcc, 0x01010101, v232
    s_cbranch_vccz ap_30
    v_lshrrev_b32 v252, 2, v254
    v_min_u32 v252, 28, v252
    s_add_u32 s55, s0, 2048
    s_mov_b32 s56, 262144
poll_31:
    buffer_load_dword v253, v252, s[4:7], s55 offen sc0 sc1
    s_waitcnt vmcnt(0)
    v_cmp_ne_u32 vcc, 0x01010101, v253
    s_cbranch_vccz pd_32
    s_sleep 1
    s_sub_u32 s56, s56, 1
    s_cmp_lg_u32 s56, 0
    s_cbranch_scc1 poll_31
pd_32:
ap_30:
    s_add_u32 s88, s95, s62
    v_add_u32 v191, s88, v254
    s_add_u32 m0, s62, 131072
    s_mov_b32 s92, 0
    buffer_load_dwordx4 v191, s[4:7], s92 offen lds
    buffer_load_dwordx4 v191, s[4:7], s92 offen offset:1024 lds
    s_add_u32 m0, s62, 49152
    s_add_u32 s59, s68, 655360
    buffer_load_dwordx4 v238, s[20:23], s59 offen lds
    buffer_load_dwordx4 v239, s[20:23], s59 offen offset:1024 lds
    buffer_load_dwordx4 v240, s[20:23], s59 offen offset:2048 lds
    buffer_load_dwordx4 v241, s[20:23], s59 offen offset:3072 lds
    s_barrier
    s_add_u32 m0, s62, 131072
    s_mov_b32 s92, 0
    buffer_load_dwordx4 v191, s[4:7], s92 offen offset:2048 lds
    buffer_load_dwordx4 v191, s[4:7], s92 offen offset:3072 lds
    s_add_u32 m0, s62, 65536
    s_add_u32 s59, s68, 917504
    buffer_load_dwordx4 v238, s[20:23], s59 offen lds
    buffer_load_dwordx4 v239, s[20:23], s59 offen offset:1024 lds
    buffer_load_dwordx4 v240, s[20:23], s59 offen offset:2048 lds
    buffer_load_dwordx4 v241, s[20:23], s59 offen offset:3072 lds
    s_waitcnt vmcnt(17)
    s_barrier
    s_add_u32 m0, s62, 98304
    s_mov_b32 s92, 16384
    buffer_load_dwordx4 v191, s[4:7], s92 offen lds
    buffer_load_dwordx4 v191, s[4:7], s92 offen offset:1024 lds
    s_add_u32 m0, s62, 81920
    s_add_u32 s59, s68, 1572864
    buffer_load_dwordx4 v238, s[20:23], s59 offen lds
    buffer_load_dwordx4 v239, s[20:23], s59 offen offset:1024 lds
    buffer_load_dwordx4 v240, s[20:23], s59 offen offset:2048 lds
    buffer_load_dwordx4 v241, s[20:23], s59 offen offset:3072 lds
    s_waitcnt vmcnt(18)
    s_barrier
    s_cmp_lg_u32 s42, 1
    s_cbranch_scc1 wf_33
    s_lshr_b32 s55, s2, 5
    s_lshl_b32 s55, s55, 2
    s_add_u32 s55, s55, s0
    v_mov_b32 v252, 2080
    v_mov_b32 v253, 0x01010101
    s_mov_b64 exec, 1
    s_cmp_eq_u32 s45, 0
    s_cbranch_scc1 st_34
    buffer_store_dword v253, v252, s[4:7], s55 offen sc0 sc1
    s_branch st_35
st_34:
    buffer_store_dword v253, v252, s[4:7], s55 offen
st_35:
    s_mov_b64 exec, -1
wf_33:
    s_add_u32 m0, s62, 98304
    s_mov_b32 s92, 16384
    buffer_load_dwordx4 v191, s[4:7], s92 offen offset:2048 lds
    buffer_load_dwordx4 v191, s[4:7], s92 offen offset:3072 lds
    s_add_u32 m0, s62, 0
    s_add_u32 s59, s68, 1835008
    buffer_load_dwordx4 v238, s[20:23], s59 offen lds
    buffer_load_dwordx4 v239, s[20:23], s59 offen offset:1024 lds
    buffer_load_dwordx4 v240, s[20:23], s59 offen offset:2048 lds
    buffer_load_dwordx4 v241, s[20:23], s59 offen offset:3072 lds
    s_waitcnt vmcnt(16)
    s_barrier
    ds_read_b64_tr_b16 v[32:33], v244 offset:32768
    ds_read_b64_tr_b16 v[34:35], v244 offset:36864
    ds_read_b128 v[0:3], v243 offset:32768
    ds_read_b128 v[4:7], v243 offset:34816
    ds_read_b128 v[8:11], v243 offset:36864
    ds_read_b128 v[12:15], v243 offset:38912
    ds_read_b64_tr_b16 v[36:37], v245 offset:32768
    ds_read_b64_tr_b16 v[38:39], v245 offset:36864
    ds_read_b64_tr_b16 v[40:41], v246 offset:32768
    ds_read_b64_tr_b16 v[42:43], v246 offset:36864
    ds_read_b64_tr_b16 v[44:45], v247 offset:32768
    ds_read_b64_tr_b16 v[46:47], v247 offset:36864
    ds_read_b64_tr_b16 v[48:49], v244 offset:40960
    ds_read_b64_tr_b16 v[50:51], v244 offset:45056
    ds_read_b128 v[16:19], v243 offset:33792
    ds_read_b128 v[20:23], v243 offset:35840
    ds_read_b128 v[24:27], v243 offset:37888
    ds_read_b128 v[28:31], v243 offset:39936
    ds_read_b64_tr_b16 v[52:53], v245 offset:40960
    ds_read_b64_tr_b16 v[54:55], v245 offset:45056
    ds_read_b64_tr_b16 v[56:57], v246 offset:40960
    ds_read_b64_tr_b16 v[58:59], v246 offset:45056
    ds_read_b64_tr_b16 v[60:61], v247 offset:40960
    ds_read_b64_tr_b16 v[62:63], v247 offset:45056
    s_add_u32 m0, s62, 114688
    s_mov_b32 s92, 32768
    buffer_load_dwordx4 v191, s[4:7], s92 offen lds
    buffer_load_dwordx4 v191, s[4:7], s92 offen offset:1024 lds
    buffer_load_dwordx4 v191, s[4:7], s92 offen offset:2048 lds
    buffer_load_dwordx4 v191, s[4:7], s92 offen offset:3072 lds
    s_setprio 0
    s_lshl_b32 s55, s51, 14
    s_add_u32 s55, s55, s62
    s_add_u32 s55, s55, s47
    s_add_u32 s88, s55, 1310720
    s_xor_b32 s89, s88, 16384
    s_add_u32 s59, s1, s49
    s_add_u32 s60, s59, 4096
    s_mov_b32 s58, 4
    s_waitcnt vmcnt(8) lgkmcnt(0)
    s_barrier
    .p2align 3
    v_mfma_f32_16x16x32_bf16 v[128:131], v[32:35], v[0:3], 0
    ds_read_b64_tr_b16 v[96:97], v248 offset:0
    v_mfma_f32_16x16x32_bf16 v[128:131], v[48:51], v[16:19], v[128:131]
    ds_read_b64_tr_b16 v[98:99], v248 offset:4096
    v_mfma_f32_16x16x32_bf16 v[132:135], v[48:51], v[20:23], 0
    ds_read_b128 v[64:67], v243 offset:0
    v_mfma_f32_16x16x32_bf16 v[132:135], v[32:35], v[4:7], v[132:135]
    ds_read_b128 v[68:71], v243 offset:2048
    v_mfma_f32_16x16x32_bf16 v[136:139], v[32:35], v[8:11], 0
    ds_read_b128 v[72:75], v243 offset:4096
    v_mfma_f32_16x16x32_bf16 v[136:139], v[48:51], v[24:27], v[136:139]
    ds_read_b128 v[76:79], v243 offset:6144
    v_mfma_f32_16x16x32_bf16 v[140:143], v[48:51], v[28:31], 0
    ds_read_b64_tr_b16 v[100:101], v249 offset:0
    v_mfma_f32_16x16x32_bf16 v[140:143], v[32:35], v[12:15], v[140:143]
    ds_read_b64_tr_b16 v[102:103], v249 offset:4096
    v_mfma_f32_16x16x32_bf16 v[156:159], v[36:39], v[12:15], 0
    v_mfma_f32_16x16x32_bf16 v[156:159], v[52:55], v[28:31], v[156:159]
    ds_read_b64_tr_b16 v[104:105], v250 offset:0
    v_mfma_f32_16x16x32_bf16 v[152:155], v[52:55], v[24:27], 0
    ds_read_b64_tr_b16 v[106:107], v250 offset:4096
    v_mfma_f32_16x16x32_bf16 v[152:155], v[36:39], v[8:11], v[152:155]
    ds_read_b64_tr_b16 v[108:109], v251 offset:0
    v_mfma_f32_16x16x32_bf16 v[148:151], v[36:39], v[4:7], 0
    ds_read_b64_tr_b16 v[110:111], v251 offset:4096
    v_mfma_f32_16x16x32_bf16 v[148:151], v[52:55], v[20:23], v[148:151]
    ds_read_b64_tr_b16 v[112:113], v248 offset:8192
    v_mfma_f32_16x16x32_bf16 v[144:147], v[52:55], v[16:19], 0
    ds_read_b64_tr_b16 v[114:115], v248 offset:12288
    v_mfma_f32_16x16x32_bf16 v[144:147], v[36:39], v[0:3], v[144:147]
    ds_read_b128 v[80:83], v243 offset:1024
    v_mfma_f32_16x16x32_bf16 v[160:163], v[40:43], v[0:3], 0
    ds_read_b128 v[84:87], v243 offset:3072
    v_mfma_f32_16x16x32_bf16 v[160:163], v[56:59], v[16:19], v[160:163]
    v_mfma_f32_16x16x32_bf16 v[164:167], v[56:59], v[20:23], 0
    ds_read_b128 v[88:91], v243 offset:5120
    v_mfma_f32_16x16x32_bf16 v[164:167], v[40:43], v[4:7], v[164:167]
    ds_read_b128 v[92:95], v243 offset:7168
    v_mfma_f32_16x16x32_bf16 v[168:171], v[40:43], v[8:11], 0
    ds_read_b64_tr_b16 v[116:117], v249 offset:8192
    v_mfma_f32_16x16x32_bf16 v[168:171], v[56:59], v[24:27], v[168:171]
    ds_read_b64_tr_b16 v[118:119], v249 offset:12288
    v_mfma_f32_16x16x32_bf16 v[172:175], v[56:59], v[28:31], 0
    ds_read_b64_tr_b16 v[120:121], v250 offset:8192
    v_mfma_f32_16x16x32_bf16 v[172:175], v[40:43], v[12:15], v[172:175]
    ds_read_b64_tr_b16 v[122:123], v250 offset:12288
    v_mfma_f32_16x16x32_bf16 v[188:191], v[44:47], v[12:15], 0
    ds_read_b64_tr_b16 v[124:125], v251 offset:8192
    v_mfma_f32_16x16x32_bf16 v[188:191], v[60:63], v[28:31], v[188:191]
    ds_read_b64_tr_b16 v[126:127], v251 offset:12288
    v_mfma_f32_16x16x32_bf16 v[184:187], v[60:63], v[24:27], 0
    v_mfma_f32_16x16x32_bf16 v[184:187], v[44:47], v[8:11], v[184:187]
    v_mfma_f32_16x16x32_bf16 v[180:183], v[44:47], v[4:7], 0
    v_mfma_f32_16x16x32_bf16 v[180:183], v[60:63], v[20:23], v[180:183]
    v_mfma_f32_16x16x32_bf16 v[176:179], v[60:63], v[16:19], 0
    v_mfma_f32_16x16x32_bf16 v[176:179], v[44:47], v[0:3], v[176:179]
    .p2align 3
loop_36:
    s_waitcnt vmcnt(0) lgkmcnt(0)
    s_barrier
    .p2align 3
    v_mfma_f32_16x16x32_bf16 v[128:131], v[96:99], v[64:67], v[128:131]
    ds_read_b64_tr_b16 v[32:33], v248 offset:16384
    v_mfma_f32_16x16x32_bf16 v[128:131], v[112:115], v[80:83], v[128:131]
    ds_read_b64_tr_b16 v[34:35], v248 offset:20480
    v_mfma_f32_16x16x32_bf16 v[132:135], v[112:115], v[84:87], v[132:135]
    ds_read_b128 v[0:3], v243 offset:16384
    v_mfma_f32_16x16x32_bf16 v[132:135], v[96:99], v[68:71], v[132:135]
    ds_read_b128 v[4:7], v243 offset:18432
    v_mfma_f32_16x16x32_bf16 v[136:139], v[96:99], v[72:75], v[136:139]
    ds_read_b128 v[8:11], v243 offset:20480
    v_mfma_f32_16x16x32_bf16 v[136:139], v[112:115], v[88:91], v[136:139]
    ds_read_b128 v[12:15], v243 offset:22528
    v_mfma_f32_16x16x32_bf16 v[140:143], v[112:115], v[92:95], v[140:143]
    ds_read_b64_tr_b16 v[36:37], v249 offset:16384
    v_mfma_f32_16x16x32_bf16 v[140:143], v[96:99], v[76:79], v[140:143]
    ds_read_b64_tr_b16 v[38:39], v249 offset:20480
    v_mfma_f32_16x16x32_bf16 v[156:159], v[100:103], v[76:79], v[156:159]
    v_mfma_f32_16x16x32_bf16 v[156:159], v[116:119], v[92:95], v[156:159]
    ds_read_b64_tr_b16 v[40:41], v250 offset:16384
    v_mfma_f32_16x16x32_bf16 v[152:155], v[116:119], v[88:91], v[152:155]
    ds_read_b64_tr_b16 v[42:43], v250 offset:20480
    v_mfma_f32_16x16x32_bf16 v[152:155], v[100:103], v[72:75], v[152:155]
    ds_read_b64_tr_b16 v[44:45], v251 offset:16384
    v_mfma_f32_16x16x32_bf16 v[148:151], v[100:103], v[68:71], v[148:151]
    ds_read_b64_tr_b16 v[46:47], v251 offset:20480
    v_mfma_f32_16x16x32_bf16 v[148:151], v[116:119], v[84:87], v[148:151]
    ds_read_b64_tr_b16 v[48:49], v248 offset:24576
    v_mfma_f32_16x16x32_bf16 v[144:147], v[116:119], v[80:83], v[144:147]
    ds_read_b64_tr_b16 v[50:51], v248 offset:28672
    v_mfma_f32_16x16x32_bf16 v[144:147], v[100:103], v[64:67], v[144:147]
    ds_read_b128 v[16:19], v243 offset:17408
    v_mfma_f32_16x16x32_bf16 v[160:163], v[104:107], v[64:67], v[160:163]
    ds_read_b128 v[20:23], v243 offset:19456
    v_mfma_f32_16x16x32_bf16 v[160:163], v[120:123], v[80:83], v[160:163]
    v_mfma_f32_16x16x32_bf16 v[164:167], v[120:123], v[84:87], v[164:167]
    ds_read_b128 v[24:27], v243 offset:21504
    v_mfma_f32_16x16x32_bf16 v[164:167], v[104:107], v[68:71], v[164:167]
    ds_read_b128 v[28:31], v243 offset:23552
    v_mfma_f32_16x16x32_bf16 v[168:171], v[104:107], v[72:75], v[168:171]
    ds_read_b64_tr_b16 v[52:53], v249 offset:24576
    v_mfma_f32_16x16x32_bf16 v[168:171], v[120:123], v[88:91], v[168:171]
    ds_read_b64_tr_b16 v[54:55], v249 offset:28672
    v_mfma_f32_16x16x32_bf16 v[172:175], v[120:123], v[92:95], v[172:175]
    ds_read_b64_tr_b16 v[56:57], v250 offset:24576
    v_mfma_f32_16x16x32_bf16 v[172:175], v[104:107], v[76:79], v[172:175]
    ds_read_b64_tr_b16 v[58:59], v250 offset:28672
    v_mfma_f32_16x16x32_bf16 v[188:191], v[108:111], v[76:79], v[188:191]
    ds_read_b64_tr_b16 v[60:61], v251 offset:24576
    v_mfma_f32_16x16x32_bf16 v[188:191], v[124:127], v[92:95], v[188:191]
    ds_read_b64_tr_b16 v[62:63], v251 offset:28672
    v_mfma_f32_16x16x32_bf16 v[184:187], v[124:127], v[88:91], v[184:187]
    v_mfma_f32_16x16x32_bf16 v[184:187], v[108:111], v[72:75], v[184:187]
    v_mfma_f32_16x16x32_bf16 v[180:183], v[108:111], v[68:71], v[180:183]
    v_mfma_f32_16x16x32_bf16 v[180:183], v[124:127], v[84:87], v[180:183]
    v_mfma_f32_16x16x32_bf16 v[176:179], v[124:127], v[80:83], v[176:179]
    v_mfma_f32_16x16x32_bf16 v[176:179], v[108:111], v[64:67], v[176:179]
    s_waitcnt lgkmcnt(0)
    s_barrier
    .p2align 3
    v_mfma_f32_16x16x32_bf16 v[128:131], v[32:35], v[0:3], v[128:131]
    ds_read_b64_tr_b16 v[96:97], v248 offset:32768
    v_mfma_f32_16x16x32_bf16 v[128:131], v[48:51], v[16:19], v[128:131]
    ds_read_b64_tr_b16 v[98:99], v248 offset:36864
    v_mfma_f32_16x16x32_bf16 v[132:135], v[48:51], v[20:23], v[132:135]
    ds_read_b128 v[64:67], v243 offset:32768
    v_mfma_f32_16x16x32_bf16 v[132:135], v[32:35], v[4:7], v[132:135]
    ds_read_b128 v[68:71], v243 offset:34816
    v_mfma_f32_16x16x32_bf16 v[136:139], v[32:35], v[8:11], v[136:139]
    ds_read_b128 v[72:75], v243 offset:36864
    v_mfma_f32_16x16x32_bf16 v[136:139], v[48:51], v[24:27], v[136:139]
    ds_read_b128 v[76:79], v243 offset:38912
    v_mfma_f32_16x16x32_bf16 v[140:143], v[48:51], v[28:31], v[140:143]
    ds_read_b64_tr_b16 v[100:101], v249 offset:32768
    v_mfma_f32_16x16x32_bf16 v[140:143], v[32:35], v[12:15], v[140:143]
    ds_read_b64_tr_b16 v[102:103], v249 offset:36864
    v_mfma_f32_16x16x32_bf16 v[156:159], v[36:39], v[12:15], v[156:159]
    v_mfma_f32_16x16x32_bf16 v[156:159], v[52:55], v[28:31], v[156:159]
    ds_read_b64_tr_b16 v[104:105], v250 offset:32768
    v_mfma_f32_16x16x32_bf16 v[152:155], v[52:55], v[24:27], v[152:155]
    ds_read_b64_tr_b16 v[106:107], v250 offset:36864
    v_mfma_f32_16x16x32_bf16 v[152:155], v[36:39], v[8:11], v[152:155]
    ds_read_b64_tr_b16 v[108:109], v251 offset:32768
    v_mfma_f32_16x16x32_bf16 v[148:151], v[36:39], v[4:7], v[148:151]
    ds_read_b64_tr_b16 v[110:111], v251 offset:36864
    v_mfma_f32_16x16x32_bf16 v[148:151], v[52:55], v[20:23], v[148:151]
    ds_read_b64_tr_b16 v[112:113], v248 offset:40960
    v_mfma_f32_16x16x32_bf16 v[144:147], v[52:55], v[16:19], v[144:147]
    ds_read_b64_tr_b16 v[114:115], v248 offset:45056
    v_mfma_f32_16x16x32_bf16 v[144:147], v[36:39], v[0:3], v[144:147]
    ds_read_b128 v[80:83], v243 offset:33792
    v_mfma_f32_16x16x32_bf16 v[160:163], v[40:43], v[0:3], v[160:163]
    ds_read_b128 v[84:87], v243 offset:35840
    v_mfma_f32_16x16x32_bf16 v[160:163], v[56:59], v[16:19], v[160:163]
    v_mfma_f32_16x16x32_bf16 v[164:167], v[56:59], v[20:23], v[164:167]
    ds_read_b128 v[88:91], v243 offset:37888
    v_mfma_f32_16x16x32_bf16 v[164:167], v[40:43], v[4:7], v[164:167]
    ds_read_b128 v[92:95], v243 offset:39936
    v_mfma_f32_16x16x32_bf16 v[168:171], v[40:43], v[8:11], v[168:171]
    ds_read_b64_tr_b16 v[116:117], v249 offset:40960
    v_mfma_f32_16x16x32_bf16 v[168:171], v[56:59], v[24:27], v[168:171]
    ds_read_b64_tr_b16 v[118:119], v249 offset:45056
    v_mfma_f32_16x16x32_bf16 v[172:175], v[56:59], v[28:31], v[172:175]
    ds_read_b64_tr_b16 v[120:121], v250 offset:40960
    v_mfma_f32_16x16x32_bf16 v[172:175], v[40:43], v[12:15], v[172:175]
    ds_read_b64_tr_b16 v[122:123], v250 offset:45056
    v_mfma_f32_16x16x32_bf16 v[188:191], v[44:47], v[12:15], v[188:191]
    ds_read_b64_tr_b16 v[124:125], v251 offset:40960
    v_mfma_f32_16x16x32_bf16 v[188:191], v[60:63], v[28:31], v[188:191]
    ds_read_b64_tr_b16 v[126:127], v251 offset:45056
    v_mfma_f32_16x16x32_bf16 v[184:187], v[60:63], v[24:27], v[184:187]
    v_mfma_f32_16x16x32_bf16 v[184:187], v[44:47], v[8:11], v[184:187]
    v_mfma_f32_16x16x32_bf16 v[180:183], v[44:47], v[4:7], v[180:183]
    v_mfma_f32_16x16x32_bf16 v[180:183], v[60:63], v[20:23], v[180:183]
    v_mfma_f32_16x16x32_bf16 v[176:179], v[60:63], v[16:19], v[176:179]
    v_mfma_f32_16x16x32_bf16 v[176:179], v[44:47], v[0:3], v[176:179]
    s_waitcnt lgkmcnt(0)
    s_barrier
    .p2align 3
    v_mfma_f32_16x16x32_bf16 v[128:131], v[96:99], v[64:67], v[128:131]
    ds_read_b64_tr_b16 v[32:33], v244 offset:0
    v_mfma_f32_16x16x32_bf16 v[128:131], v[112:115], v[80:83], v[128:131]
    ds_read_b64_tr_b16 v[34:35], v244 offset:4096
    v_mfma_f32_16x16x32_bf16 v[132:135], v[112:115], v[84:87], v[132:135]
    ds_read_b128 v[0:3], v243 offset:0
    v_mfma_f32_16x16x32_bf16 v[132:135], v[96:99], v[68:71], v[132:135]
    ds_read_b128 v[4:7], v243 offset:2048
    v_mfma_f32_16x16x32_bf16 v[136:139], v[96:99], v[72:75], v[136:139]
    ds_read_b128 v[8:11], v243 offset:4096
    v_mfma_f32_16x16x32_bf16 v[136:139], v[112:115], v[88:91], v[136:139]
    ds_read_b128 v[12:15], v243 offset:6144
    v_mfma_f32_16x16x32_bf16 v[140:143], v[112:115], v[92:95], v[140:143]
    ds_read_b64_tr_b16 v[36:37], v245 offset:0
    v_mfma_f32_16x16x32_bf16 v[140:143], v[96:99], v[76:79], v[140:143]
    ds_read_b64_tr_b16 v[38:39], v245 offset:4096
    v_mfma_f32_16x16x32_bf16 v[156:159], v[100:103], v[76:79], v[156:159]
    v_mfma_f32_16x16x32_bf16 v[156:159], v[116:119], v[92:95], v[156:159]
    ds_read_b64_tr_b16 v[40:41], v246 offset:0
    v_mfma_f32_16x16x32_bf16 v[152:155], v[116:119], v[88:91], v[152:155]
    ds_read_b64_tr_b16 v[42:43], v246 offset:4096
    v_mfma_f32_16x16x32_bf16 v[152:155], v[100:103], v[72:75], v[152:155]
    ds_read_b64_tr_b16 v[44:45], v247 offset:0
    v_mfma_f32_16x16x32_bf16 v[148:151], v[100:103], v[68:71], v[148:151]
    ds_read_b64_tr_b16 v[46:47], v247 offset:4096
    v_mfma_f32_16x16x32_bf16 v[148:151], v[116:119], v[84:87], v[148:151]
    ds_read_b64_tr_b16 v[48:49], v244 offset:8192
    v_mfma_f32_16x16x32_bf16 v[144:147], v[116:119], v[80:83], v[144:147]
    ds_read_b64_tr_b16 v[50:51], v244 offset:12288
    v_mfma_f32_16x16x32_bf16 v[144:147], v[100:103], v[64:67], v[144:147]
    ds_read_b128 v[16:19], v243 offset:1024
    v_mfma_f32_16x16x32_bf16 v[160:163], v[104:107], v[64:67], v[160:163]
    ds_read_b128 v[20:23], v243 offset:3072
    v_mfma_f32_16x16x32_bf16 v[160:163], v[120:123], v[80:83], v[160:163]
    v_mfma_f32_16x16x32_bf16 v[164:167], v[120:123], v[84:87], v[164:167]
    ds_read_b128 v[24:27], v243 offset:5120
    v_mfma_f32_16x16x32_bf16 v[164:167], v[104:107], v[68:71], v[164:167]
    ds_read_b128 v[28:31], v243 offset:7168
    v_mfma_f32_16x16x32_bf16 v[168:171], v[104:107], v[72:75], v[168:171]
    ds_read_b64_tr_b16 v[52:53], v245 offset:8192
    v_mfma_f32_16x16x32_bf16 v[168:171], v[120:123], v[88:91], v[168:171]
    ds_read_b64_tr_b16 v[54:55], v245 offset:12288
    v_mfma_f32_16x16x32_bf16 v[172:175], v[120:123], v[92:95], v[172:175]
    ds_read_b64_tr_b16 v[56:57], v246 offset:8192
    v_mfma_f32_16x16x32_bf16 v[172:175], v[104:107], v[76:79], v[172:175]
    ds_read_b64_tr_b16 v[58:59], v246 offset:12288
    v_mfma_f32_16x16x32_bf16 v[188:191], v[108:111], v[76:79], v[188:191]
    ds_read_b64_tr_b16 v[60:61], v247 offset:8192
    v_mfma_f32_16x16x32_bf16 v[188:191], v[124:127], v[92:95], v[188:191]
    ds_read_b64_tr_b16 v[62:63], v247 offset:12288
    v_mfma_f32_16x16x32_bf16 v[184:187], v[124:127], v[88:91], v[184:187]
    v_mfma_f32_16x16x32_bf16 v[184:187], v[108:111], v[72:75], v[184:187]
    v_mfma_f32_16x16x32_bf16 v[180:183], v[108:111], v[68:71], v[180:183]
    v_mfma_f32_16x16x32_bf16 v[180:183], v[124:127], v[84:87], v[180:183]
    v_mfma_f32_16x16x32_bf16 v[176:179], v[124:127], v[80:83], v[176:179]
    v_mfma_f32_16x16x32_bf16 v[176:179], v[108:111], v[64:67], v[176:179]
    s_waitcnt lgkmcnt(0)
    s_barrier
    .p2align 3
    v_mfma_f32_16x16x32_bf16 v[128:131], v[32:35], v[0:3], v[128:131]
    ds_read_b64_tr_b16 v[96:97], v244 offset:16384
    v_mfma_f32_16x16x32_bf16 v[128:131], v[48:51], v[16:19], v[128:131]
    ds_read_b64_tr_b16 v[98:99], v244 offset:20480
    v_mfma_f32_16x16x32_bf16 v[132:135], v[48:51], v[20:23], v[132:135]
    ds_read_b128 v[64:67], v243 offset:16384
    v_mfma_f32_16x16x32_bf16 v[132:135], v[32:35], v[4:7], v[132:135]
    ds_read_b128 v[68:71], v243 offset:18432
    v_mfma_f32_16x16x32_bf16 v[136:139], v[32:35], v[8:11], v[136:139]
    ds_read_b128 v[72:75], v243 offset:20480
    v_mfma_f32_16x16x32_bf16 v[136:139], v[48:51], v[24:27], v[136:139]
    ds_read_b128 v[76:79], v243 offset:22528
    v_mfma_f32_16x16x32_bf16 v[140:143], v[48:51], v[28:31], v[140:143]
    ds_read_b64_tr_b16 v[100:101], v245 offset:16384
    v_mfma_f32_16x16x32_bf16 v[140:143], v[32:35], v[12:15], v[140:143]
    ds_read_b64_tr_b16 v[102:103], v245 offset:20480
    v_mfma_f32_16x16x32_bf16 v[156:159], v[36:39], v[12:15], v[156:159]
    v_mfma_f32_16x16x32_bf16 v[156:159], v[52:55], v[28:31], v[156:159]
    ds_read_b64_tr_b16 v[104:105], v246 offset:16384
    v_mfma_f32_16x16x32_bf16 v[152:155], v[52:55], v[24:27], v[152:155]
    ds_read_b64_tr_b16 v[106:107], v246 offset:20480
    v_mfma_f32_16x16x32_bf16 v[152:155], v[36:39], v[8:11], v[152:155]
    ds_read_b64_tr_b16 v[108:109], v247 offset:16384
    v_mfma_f32_16x16x32_bf16 v[148:151], v[36:39], v[4:7], v[148:151]
    ds_read_b64_tr_b16 v[110:111], v247 offset:20480
    v_mfma_f32_16x16x32_bf16 v[148:151], v[52:55], v[20:23], v[148:151]
    ds_read_b64_tr_b16 v[112:113], v244 offset:24576
    v_mfma_f32_16x16x32_bf16 v[144:147], v[52:55], v[16:19], v[144:147]
    ds_read_b64_tr_b16 v[114:115], v244 offset:28672
    v_mfma_f32_16x16x32_bf16 v[144:147], v[36:39], v[0:3], v[144:147]
    ds_read_b128 v[80:83], v243 offset:17408
    v_mfma_f32_16x16x32_bf16 v[160:163], v[40:43], v[0:3], v[160:163]
    ds_read_b128 v[84:87], v243 offset:19456
    v_mfma_f32_16x16x32_bf16 v[160:163], v[56:59], v[16:19], v[160:163]
    v_mfma_f32_16x16x32_bf16 v[164:167], v[56:59], v[20:23], v[164:167]
    ds_read_b128 v[88:91], v243 offset:21504
    v_mfma_f32_16x16x32_bf16 v[164:167], v[40:43], v[4:7], v[164:167]
    ds_read_b128 v[92:95], v243 offset:23552
    v_mfma_f32_16x16x32_bf16 v[168:171], v[40:43], v[8:11], v[168:171]
    ds_read_b64_tr_b16 v[116:117], v245 offset:24576
    v_mfma_f32_16x16x32_bf16 v[168:171], v[56:59], v[24:27], v[168:171]
    ds_read_b64_tr_b16 v[118:119], v245 offset:28672
    v_mfma_f32_16x16x32_bf16 v[172:175], v[56:59], v[28:31], v[172:175]
    ds_read_b64_tr_b16 v[120:121], v246 offset:24576
    v_mfma_f32_16x16x32_bf16 v[172:175], v[40:43], v[12:15], v[172:175]
    ds_read_b64_tr_b16 v[122:123], v246 offset:28672
    v_mfma_f32_16x16x32_bf16 v[188:191], v[44:47], v[12:15], v[188:191]
    ds_read_b64_tr_b16 v[124:125], v247 offset:24576
    v_mfma_f32_16x16x32_bf16 v[188:191], v[60:63], v[28:31], v[188:191]
    ds_read_b64_tr_b16 v[126:127], v247 offset:28672
    v_mfma_f32_16x16x32_bf16 v[184:187], v[60:63], v[24:27], v[184:187]
    v_mfma_f32_16x16x32_bf16 v[184:187], v[44:47], v[8:11], v[184:187]
    v_mfma_f32_16x16x32_bf16 v[180:183], v[44:47], v[4:7], v[180:183]
    v_mfma_f32_16x16x32_bf16 v[180:183], v[60:63], v[20:23], v[180:183]
    v_mfma_f32_16x16x32_bf16 v[176:179], v[60:63], v[16:19], v[176:179]
    v_mfma_f32_16x16x32_bf16 v[176:179], v[44:47], v[0:3], v[176:179]
    s_waitcnt lgkmcnt(0)
    s_barrier
    .p2align 3
    v_mfma_f32_16x16x32_bf16 v[128:131], v[96:99], v[64:67], v[128:131]
    ds_read_b64_tr_b16 v[32:33], v244 offset:32768
    v_mfma_f32_16x16x32_bf16 v[128:131], v[112:115], v[80:83], v[128:131]
    ds_read_b64_tr_b16 v[34:35], v244 offset:36864
    v_mfma_f32_16x16x32_bf16 v[132:135], v[112:115], v[84:87], v[132:135]
    ds_read_b128 v[0:3], v243 offset:32768
    v_mfma_f32_16x16x32_bf16 v[132:135], v[96:99], v[68:71], v[132:135]
    ds_read_b128 v[4:7], v243 offset:34816
    v_mfma_f32_16x16x32_bf16 v[136:139], v[96:99], v[72:75], v[136:139]
    ds_read_b128 v[8:11], v243 offset:36864
    v_mfma_f32_16x16x32_bf16 v[136:139], v[112:115], v[88:91], v[136:139]
    ds_read_b128 v[12:15], v243 offset:38912
    v_mfma_f32_16x16x32_bf16 v[140:143], v[112:115], v[92:95], v[140:143]
    ds_read_b64_tr_b16 v[36:37], v245 offset:32768
    v_mfma_f32_16x16x32_bf16 v[140:143], v[96:99], v[76:79], v[140:143]
    ds_read_b64_tr_b16 v[38:39], v245 offset:36864
    v_mfma_f32_16x16x32_bf16 v[156:159], v[100:103], v[76:79], v[156:159]
    v_mfma_f32_16x16x32_bf16 v[156:159], v[116:119], v[92:95], v[156:159]
    ds_read_b64_tr_b16 v[40:41], v246 offset:32768
    v_mfma_f32_16x16x32_bf16 v[152:155], v[116:119], v[88:91], v[152:155]
    ds_read_b64_tr_b16 v[42:43], v246 offset:36864
    v_mfma_f32_16x16x32_bf16 v[152:155], v[100:103], v[72:75], v[152:155]
    ds_read_b64_tr_b16 v[44:45], v247 offset:32768
    v_mfma_f32_16x16x32_bf16 v[148:151], v[100:103], v[68:71], v[148:151]
    ds_read_b64_tr_b16 v[46:47], v247 offset:36864
    v_mfma_f32_16x16x32_bf16 v[148:151], v[116:119], v[84:87], v[148:151]
    ds_read_b64_tr_b16 v[48:49], v244 offset:40960
    v_mfma_f32_16x16x32_bf16 v[144:147], v[116:119], v[80:83], v[144:147]
    ds_read_b64_tr_b16 v[50:51], v244 offset:45056
    v_mfma_f32_16x16x32_bf16 v[144:147], v[100:103], v[64:67], v[144:147]
    ds_read_b128 v[16:19], v243 offset:33792
    v_mfma_f32_16x16x32_bf16 v[160:163], v[104:107], v[64:67], v[160:163]
    ds_read_b128 v[20:23], v243 offset:35840
    v_mfma_f32_16x16x32_bf16 v[160:163], v[120:123], v[80:83], v[160:163]
    v_mfma_f32_16x16x32_bf16 v[164:167], v[120:123], v[84:87], v[164:167]
    ds_read_b128 v[24:27], v243 offset:37888
    v_mfma_f32_16x16x32_bf16 v[164:167], v[104:107], v[68:71], v[164:167]
    ds_read_b128 v[28:31], v243 offset:39936
    v_mfma_f32_16x16x32_bf16 v[168:171], v[104:107], v[72:75], v[168:171]
    ds_read_b64_tr_b16 v[52:53], v245 offset:40960
    v_mfma_f32_16x16x32_bf16 v[168:171], v[120:123], v[88:91], v[168:171]
    ds_read_b64_tr_b16 v[54:55], v245 offset:45056
    v_mfma_f32_16x16x32_bf16 v[172:175], v[120:123], v[92:95], v[172:175]
    ds_read_b64_tr_b16 v[56:57], v246 offset:40960
    v_mfma_f32_16x16x32_bf16 v[172:175], v[104:107], v[76:79], v[172:175]
    ds_read_b64_tr_b16 v[58:59], v246 offset:45056
    v_mfma_f32_16x16x32_bf16 v[188:191], v[108:111], v[76:79], v[188:191]
    ds_read_b64_tr_b16 v[60:61], v247 offset:40960
    v_mfma_f32_16x16x32_bf16 v[188:191], v[124:127], v[92:95], v[188:191]
    ds_read_b64_tr_b16 v[62:63], v247 offset:45056
    v_mfma_f32_16x16x32_bf16 v[184:187], v[124:127], v[88:91], v[184:187]
    v_mfma_f32_16x16x32_bf16 v[184:187], v[108:111], v[72:75], v[184:187]
    v_mfma_f32_16x16x32_bf16 v[180:183], v[108:111], v[68:71], v[180:183]
    v_mfma_f32_16x16x32_bf16 v[180:183], v[124:127], v[84:87], v[180:183]
    v_mfma_f32_16x16x32_bf16 v[176:179], v[124:127], v[80:83], v[176:179]
    v_mfma_f32_16x16x32_bf16 v[176:179], v[108:111], v[64:67], v[176:179]
    s_waitcnt lgkmcnt(0)
    s_barrier
    .p2align 3
    v_mfma_f32_16x16x32_bf16 v[128:131], v[32:35], v[0:3], v[128:131]
    ds_read_b64_tr_b16 v[96:97], v248 offset:0
    v_mfma_f32_16x16x32_bf16 v[128:131], v[48:51], v[16:19], v[128:131]
    ds_read_b64_tr_b16 v[98:99], v248 offset:4096
    v_mfma_f32_16x16x32_bf16 v[132:135], v[48:51], v[20:23], v[132:135]
    ds_read_b128 v[64:67], v243 offset:0
    v_mfma_f32_16x16x32_bf16 v[132:135], v[32:35], v[4:7], v[132:135]
    ds_read_b128 v[68:71], v243 offset:2048
    v_mfma_f32_16x16x32_bf16 v[136:139], v[32:35], v[8:11], v[136:139]
    ds_read_b128 v[72:75], v243 offset:4096
    v_mfma_f32_16x16x32_bf16 v[136:139], v[48:51], v[24:27], v[136:139]
    ds_read_b128 v[76:79], v243 offset:6144
    v_mfma_f32_16x16x32_bf16 v[140:143], v[48:51], v[28:31], v[140:143]
    ds_read_b64_tr_b16 v[100:101], v249 offset:0
    v_mfma_f32_16x16x32_bf16 v[140:143], v[32:35], v[12:15], v[140:143]
    ds_read_b64_tr_b16 v[102:103], v249 offset:4096
    v_mfma_f32_16x16x32_bf16 v[156:159], v[36:39], v[12:15], v[156:159]
    v_mfma_f32_16x16x32_bf16 v[156:159], v[52:55], v[28:31], v[156:159]
    ds_read_b64_tr_b16 v[104:105], v250 offset:0
    v_mfma_f32_16x16x32_bf16 v[152:155], v[52:55], v[24:27], v[152:155]
    ds_read_b64_tr_b16 v[106:107], v250 offset:4096
    v_mfma_f32_16x16x32_bf16 v[152:155], v[36:39], v[8:11], v[152:155]
    ds_read_b64_tr_b16 v[108:109], v251 offset:0
    v_mfma_f32_16x16x32_bf16 v[148:151], v[36:39], v[4:7], v[148:151]
    ds_read_b64_tr_b16 v[110:111], v251 offset:4096
    v_mfma_f32_16x16x32_bf16 v[148:151], v[52:55], v[20:23], v[148:151]
    ds_read_b64_tr_b16 v[112:113], v248 offset:8192
    v_mfma_f32_16x16x32_bf16 v[144:147], v[52:55], v[16:19], v[144:147]
    ds_read_b64_tr_b16 v[114:115], v248 offset:12288
    v_mfma_f32_16x16x32_bf16 v[144:147], v[36:39], v[0:3], v[144:147]
    ds_read_b128 v[80:83], v243 offset:1024
    v_mfma_f32_16x16x32_bf16 v[160:163], v[40:43], v[0:3], v[160:163]
    ds_read_b128 v[84:87], v243 offset:3072
    v_mfma_f32_16x16x32_bf16 v[160:163], v[56:59], v[16:19], v[160:163]
    v_mfma_f32_16x16x32_bf16 v[164:167], v[56:59], v[20:23], v[164:167]
    ds_read_b128 v[88:91], v243 offset:5120
    v_mfma_f32_16x16x32_bf16 v[164:167], v[40:43], v[4:7], v[164:167]
    ds_read_b128 v[92:95], v243 offset:7168
    v_mfma_f32_16x16x32_bf16 v[168:171], v[40:43], v[8:11], v[168:171]
    ds_read_b64_tr_b16 v[116:117], v249 offset:8192
    v_mfma_f32_16x16x32_bf16 v[168:171], v[56:59], v[24:27], v[168:171]
    ds_read_b64_tr_b16 v[118:119], v249 offset:12288
    v_mfma_f32_16x16x32_bf16 v[172:175], v[56:59], v[28:31], v[172:175]
    ds_read_b64_tr_b16 v[120:121], v250 offset:8192
    v_mfma_f32_16x16x32_bf16 v[172:175], v[40:43], v[12:15], v[172:175]
    ds_read_b64_tr_b16 v[122:123], v250 offset:12288
    v_mfma_f32_16x16x32_bf16 v[188:191], v[44:47], v[12:15], v[188:191]
    ds_read_b64_tr_b16 v[124:125], v251 offset:8192
    v_mfma_f32_16x16x32_bf16 v[188:191], v[60:63], v[28:31], v[188:191]
    ds_read_b64_tr_b16 v[126:127], v251 offset:12288
    v_mfma_f32_16x16x32_bf16 v[184:187], v[60:63], v[24:27], v[184:187]
    v_mfma_f32_16x16x32_bf16 v[184:187], v[44:47], v[8:11], v[184:187]
    v_mfma_f32_16x16x32_bf16 v[180:183], v[44:47], v[4:7], v[180:183]
    v_mfma_f32_16x16x32_bf16 v[180:183], v[60:63], v[20:23], v[180:183]
    s_sub_u32 s58, s58, 1
    s_cmp_lg_u32 s58, 0
    .p2align 3
    v_mfma_f32_16x16x32_bf16 v[176:179], v[60:63], v[16:19], v[176:179]
    v_mfma_f32_16x16x32_bf16 v[176:179], v[44:47], v[0:3], v[176:179]
    s_cbranch_scc1 loop_36
    s_waitcnt lgkmcnt(0)
    s_barrier
    .p2align 3
    v_mfma_f32_16x16x32_bf16 v[128:131], v[96:99], v[64:67], v[128:131]
    ds_read_b64_tr_b16 v[32:33], v248 offset:16384
    v_mfma_f32_16x16x32_bf16 v[128:131], v[112:115], v[80:83], v[128:131]
    ds_read_b64_tr_b16 v[34:35], v248 offset:20480
    v_mfma_f32_16x16x32_bf16 v[132:135], v[112:115], v[84:87], v[132:135]
    ds_read_b128 v[0:3], v243 offset:16384
    v_mfma_f32_16x16x32_bf16 v[132:135], v[96:99], v[68:71], v[132:135]
    ds_read_b128 v[4:7], v243 offset:18432
    v_mfma_f32_16x16x32_bf16 v[136:139], v[96:99], v[72:75], v[136:139]
    ds_read_b128 v[8:11], v243 offset:20480
    v_mfma_f32_16x16x32_bf16 v[136:139], v[112:115], v[88:91], v[136:139]
    ds_read_b128 v[12:15], v243 offset:22528
    v_mfma_f32_16x16x32_bf16 v[140:143], v[112:115], v[92:95], v[140:143]
    ds_read_b64_tr_b16 v[36:37], v249 offset:16384
    v_mfma_f32_16x16x32_bf16 v[140:143], v[96:99], v[76:79], v[140:143]
    ds_read_b64_tr_b16 v[38:39], v249 offset:20480
    v_mfma_f32_16x16x32_bf16 v[156:159], v[100:103], v[76:79], v[156:159]
    v_mfma_f32_16x16x32_bf16 v[156:159], v[116:119], v[92:95], v[156:159]
    ds_read_b64_tr_b16 v[40:41], v250 offset:16384
    v_mfma_f32_16x16x32_bf16 v[152:155], v[116:119], v[88:91], v[152:155]
    ds_read_b64_tr_b16 v[42:43], v250 offset:20480
    v_mfma_f32_16x16x32_bf16 v[152:155], v[100:103], v[72:75], v[152:155]
    ds_read_b64_tr_b16 v[44:45], v251 offset:16384
    v_mfma_f32_16x16x32_bf16 v[148:151], v[100:103], v[68:71], v[148:151]
    ds_read_b64_tr_b16 v[46:47], v251 offset:20480
    v_mfma_f32_16x16x32_bf16 v[148:151], v[116:119], v[84:87], v[148:151]
    ds_read_b64_tr_b16 v[48:49], v248 offset:24576
    v_mfma_f32_16x16x32_bf16 v[144:147], v[116:119], v[80:83], v[144:147]
    ds_read_b64_tr_b16 v[50:51], v248 offset:28672
    v_mfma_f32_16x16x32_bf16 v[144:147], v[100:103], v[64:67], v[144:147]
    ds_read_b128 v[16:19], v243 offset:17408
    v_mfma_f32_16x16x32_bf16 v[160:163], v[104:107], v[64:67], v[160:163]
    ds_read_b128 v[20:23], v243 offset:19456
    v_mfma_f32_16x16x32_bf16 v[160:163], v[120:123], v[80:83], v[160:163]
    v_mfma_f32_16x16x32_bf16 v[164:167], v[120:123], v[84:87], v[164:167]
    ds_read_b128 v[24:27], v243 offset:21504
    v_mfma_f32_16x16x32_bf16 v[164:167], v[104:107], v[68:71], v[164:167]
    ds_read_b128 v[28:31], v243 offset:23552
    v_mfma_f32_16x16x32_bf16 v[168:171], v[104:107], v[72:75], v[168:171]
    ds_read_b64_tr_b16 v[52:53], v249 offset:24576
    v_mfma_f32_16x16x32_bf16 v[168:171], v[120:123], v[88:91], v[168:171]
    ds_read_b64_tr_b16 v[54:55], v249 offset:28672
    v_mfma_f32_16x16x32_bf16 v[172:175], v[120:123], v[92:95], v[172:175]
    ds_read_b64_tr_b16 v[56:57], v250 offset:24576
    v_mfma_f32_16x16x32_bf16 v[172:175], v[104:107], v[76:79], v[172:175]
    ds_read_b64_tr_b16 v[58:59], v250 offset:28672
    v_mfma_f32_16x16x32_bf16 v[188:191], v[108:111], v[76:79], v[188:191]
    ds_read_b64_tr_b16 v[60:61], v251 offset:24576
    v_mfma_f32_16x16x32_bf16 v[188:191], v[124:127], v[92:95], v[188:191]
    ds_read_b64_tr_b16 v[62:63], v251 offset:28672
    v_mfma_f32_16x16x32_bf16 v[184:187], v[124:127], v[88:91], v[184:187]
    v_mfma_f32_16x16x32_bf16 v[184:187], v[108:111], v[72:75], v[184:187]
    v_mfma_f32_16x16x32_bf16 v[180:183], v[108:111], v[68:71], v[180:183]
    v_mfma_f32_16x16x32_bf16 v[180:183], v[124:127], v[84:87], v[180:183]
    v_mfma_f32_16x16x32_bf16 v[176:179], v[124:127], v[80:83], v[176:179]
    v_mfma_f32_16x16x32_bf16 v[176:179], v[108:111], v[64:67], v[176:179]
    s_waitcnt lgkmcnt(0)
    s_barrier
    .p2align 3
    v_mfma_f32_16x16x32_bf16 v[128:131], v[32:35], v[0:3], v[128:131]
    ds_read_b64_tr_b16 v[96:97], v248 offset:32768
    v_mfma_f32_16x16x32_bf16 v[128:131], v[48:51], v[16:19], v[128:131]
    ds_read_b64_tr_b16 v[98:99], v248 offset:36864
    v_mfma_f32_16x16x32_bf16 v[132:135], v[48:51], v[20:23], v[132:135]
    ds_read_b128 v[64:67], v243 offset:32768
    v_mfma_f32_16x16x32_bf16 v[132:135], v[32:35], v[4:7], v[132:135]
    ds_read_b128 v[68:71], v243 offset:34816
    v_mfma_f32_16x16x32_bf16 v[136:139], v[32:35], v[8:11], v[136:139]
    ds_read_b128 v[72:75], v243 offset:36864
    v_mfma_f32_16x16x32_bf16 v[136:139], v[48:51], v[24:27], v[136:139]
    ds_read_b128 v[76:79], v243 offset:38912
    v_mfma_f32_16x16x32_bf16 v[140:143], v[48:51], v[28:31], v[140:143]
    ds_read_b64_tr_b16 v[100:101], v249 offset:32768
    v_mfma_f32_16x16x32_bf16 v[140:143], v[32:35], v[12:15], v[140:143]
    ds_read_b64_tr_b16 v[102:103], v249 offset:36864
    v_mfma_f32_16x16x32_bf16 v[156:159], v[36:39], v[12:15], v[156:159]
    v_mfma_f32_16x16x32_bf16 v[156:159], v[52:55], v[28:31], v[156:159]
    ds_read_b64_tr_b16 v[104:105], v250 offset:32768
    v_mfma_f32_16x16x32_bf16 v[152:155], v[52:55], v[24:27], v[152:155]
    ds_read_b64_tr_b16 v[106:107], v250 offset:36864
    v_mfma_f32_16x16x32_bf16 v[152:155], v[36:39], v[8:11], v[152:155]
    ds_read_b64_tr_b16 v[108:109], v251 offset:32768
    v_mfma_f32_16x16x32_bf16 v[148:151], v[36:39], v[4:7], v[148:151]
    ds_read_b64_tr_b16 v[110:111], v251 offset:36864
    v_mfma_f32_16x16x32_bf16 v[148:151], v[52:55], v[20:23], v[148:151]
    ds_read_b64_tr_b16 v[112:113], v248 offset:40960
    v_mfma_f32_16x16x32_bf16 v[144:147], v[52:55], v[16:19], v[144:147]
    ds_read_b64_tr_b16 v[114:115], v248 offset:45056
    v_mfma_f32_16x16x32_bf16 v[144:147], v[36:39], v[0:3], v[144:147]
    ds_read_b128 v[80:83], v243 offset:33792
    v_mfma_f32_16x16x32_bf16 v[160:163], v[40:43], v[0:3], v[160:163]
    ds_read_b128 v[84:87], v243 offset:35840
    v_mfma_f32_16x16x32_bf16 v[160:163], v[56:59], v[16:19], v[160:163]
    v_mfma_f32_16x16x32_bf16 v[164:167], v[56:59], v[20:23], v[164:167]
    ds_read_b128 v[88:91], v243 offset:37888
    v_mfma_f32_16x16x32_bf16 v[164:167], v[40:43], v[4:7], v[164:167]
    ds_read_b128 v[92:95], v243 offset:39936
    v_mfma_f32_16x16x32_bf16 v[168:171], v[40:43], v[8:11], v[168:171]
    ds_read_b64_tr_b16 v[116:117], v249 offset:40960
    v_mfma_f32_16x16x32_bf16 v[168:171], v[56:59], v[24:27], v[168:171]
    ds_read_b64_tr_b16 v[118:119], v249 offset:45056
    v_mfma_f32_16x16x32_bf16 v[172:175], v[56:59], v[28:31], v[172:175]
    ds_read_b64_tr_b16 v[120:121], v250 offset:40960
    v_mfma_f32_16x16x32_bf16 v[172:175], v[40:43], v[12:15], v[172:175]
    ds_read_b64_tr_b16 v[122:123], v250 offset:45056
    v_mfma_f32_16x16x32_bf16 v[188:191], v[44:47], v[12:15], v[188:191]
    ds_read_b64_tr_b16 v[124:125], v251 offset:40960
    v_mfma_f32_16x16x32_bf16 v[188:191], v[60:63], v[28:31], v[188:191]
    ds_read_b64_tr_b16 v[126:127], v251 offset:45056
    v_mfma_f32_16x16x32_bf16 v[184:187], v[60:63], v[24:27], v[184:187]
    v_mfma_f32_16x16x32_bf16 v[184:187], v[44:47], v[8:11], v[184:187]
    v_mfma_f32_16x16x32_bf16 v[180:183], v[44:47], v[4:7], v[180:183]
    v_mfma_f32_16x16x32_bf16 v[180:183], v[60:63], v[20:23], v[180:183]
    v_mfma_f32_16x16x32_bf16 v[176:179], v[60:63], v[16:19], v[176:179]
    v_mfma_f32_16x16x32_bf16 v[176:179], v[44:47], v[0:3], v[176:179]
    s_waitcnt lgkmcnt(0)
    s_barrier
    .p2align 3
    v_mfma_f32_16x16x32_bf16 v[128:131], v[96:99], v[64:67], v[128:131]
    v_mfma_f32_16x16x32_bf16 v[128:131], v[112:115], v[80:83], v[128:131]
    buffer_load_dwordx4 v[196:199], v254, s[4:7], s59 offen offset:0
    .p2align 3
    v_mfma_f32_16x16x32_bf16 v[132:135], v[112:115], v[84:87], v[132:135]
    v_mfma_f32_16x16x32_bf16 v[132:135], v[96:99], v[68:71], v[132:135]
    v_mfma_f32_16x16x32_bf16 v[136:139], v[96:99], v[72:75], v[136:139]
    buffer_load_dwordx4 v[200:203], v254, s[4:7], s59 offen offset:2048
    .p2align 3
    v_mfma_f32_16x16x32_bf16 v[136:139], v[112:115], v[88:91], v[136:139]
    v_mfma_f32_16x16x32_bf16 v[140:143], v[112:115], v[92:95], v[140:143]
    v_mfma_f32_16x16x32_bf16 v[140:143], v[96:99], v[76:79], v[140:143]
    buffer_load_dwordx4 v[204:207], v254, s[4:7], s60 offen offset:0
    .p2align 3
    v_mfma_f32_16x16x32_bf16 v[156:159], v[100:103], v[76:79], v[156:159]
    v_mfma_f32_16x16x32_bf16 v[156:159], v[116:119], v[92:95], v[156:159]
    v_mfma_f32_16x16x32_bf16 v[152:155], v[116:119], v[88:91], v[152:155]
    buffer_load_dwordx4 v[208:211], v254, s[4:7], s60 offen offset:2048
    .p2align 3
    v_mfma_f32_16x16x32_bf16 v[152:155], v[100:103], v[72:75], v[152:155]
    v_mfma_f32_16x16x32_bf16 v[148:151], v[100:103], v[68:71], v[148:151]
    v_mfma_f32_16x16x32_bf16 v[148:151], v[116:119], v[84:87], v[148:151]
    v_mfma_f32_16x16x32_bf16 v[144:147], v[116:119], v[80:83], v[144:147]
    v_mfma_f32_16x16x32_bf16 v[144:147], v[100:103], v[64:67], v[144:147]
    v_mfma_f32_16x16x32_bf16 v[160:163], v[104:107], v[64:67], v[160:163]
    v_mfma_f32_16x16x32_bf16 v[160:163], v[120:123], v[80:83], v[160:163]
    v_mfma_f32_16x16x32_bf16 v[164:167], v[120:123], v[84:87], v[164:167]
    v_mfma_f32_16x16x32_bf16 v[164:167], v[104:107], v[68:71], v[164:167]
    v_mfma_f32_16x16x32_bf16 v[168:171], v[104:107], v[72:75], v[168:171]
    v_mfma_f32_16x16x32_bf16 v[168:171], v[120:123], v[88:91], v[168:171]
    v_mfma_f32_16x16x32_bf16 v[172:175], v[120:123], v[92:95], v[172:175]
    v_mfma_f32_16x16x32_bf16 v[172:175], v[104:107], v[76:79], v[172:175]
    v_mfma_f32_16x16x32_bf16 v[188:191], v[108:111], v[76:79], v[188:191]
    v_mfma_f32_16x16x32_bf16 v[188:191], v[124:127], v[92:95], v[188:191]
    v_mfma_f32_16x16x32_bf16 v[184:187], v[124:127], v[88:91], v[184:187]
    v_mfma_f32_16x16x32_bf16 v[184:187], v[108:111], v[72:75], v[184:187]
    v_mfma_f32_16x16x32_bf16 v[180:183], v[108:111], v[68:71], v[180:183]
    v_mfma_f32_16x16x32_bf16 v[180:183], v[124:127], v[84:87], v[180:183]
    v_mfma_f32_16x16x32_bf16 v[176:179], v[124:127], v[80:83], v[176:179]
    v_mfma_f32_16x16x32_bf16 v[176:179], v[108:111], v[64:67], v[176:179]
    s_nop 7
    v_cvt_pk_bf16_f32 v0, v160, v161
    v_cvt_pk_bf16_f32 v1, v162, v163
    v_cvt_pk_bf16_f32 v2, v176, v177
    v_cvt_pk_bf16_f32 v3, v178, v179
    v_min_u32 v0, -2, v0
    v_min_u32 v1, -2, v1
    v_min_u32 v2, -2, v2
    v_min_u32 v3, -2, v3
    buffer_store_dwordx4 v[0:3], v254, s[4:7], s88 offen offset:0 sc0 sc1
    v_cvt_pk_bf16_f32 v4, v164, v165
    v_cvt_pk_bf16_f32 v5, v166, v167
    v_cvt_pk_bf16_f32 v6, v180, v181
    v_cvt_pk_bf16_f32 v7, v182, v183
    v_min_u32 v4, -2, v4
    v_min_u32 v5, -2, v5
    v_min_u32 v6, -2, v6
    v_min_u32 v7, -2, v7
    buffer_store_dwordx4 v[4:7], v254, s[4:7], s88 offen offset:1024 sc0 sc1
    v_cvt_pk_bf16_f32 v8, v168, v169
    v_cvt_pk_bf16_f32 v9, v170, v171
    v_cvt_pk_bf16_f32 v10, v184, v185
    v_cvt_pk_bf16_f32 v11, v186, v187
    v_min_u32 v8, -2, v8
    v_min_u32 v9, -2, v9
    v_min_u32 v10, -2, v10
    v_min_u32 v11, -2, v11
    buffer_store_dwordx4 v[8:11], v254, s[4:7], s88 offen offset:2048 sc0 sc1
    v_cvt_pk_bf16_f32 v12, v172, v173
    v_cvt_pk_bf16_f32 v13, v174, v175
    v_cvt_pk_bf16_f32 v14, v188, v189
    v_cvt_pk_bf16_f32 v15, v190, v191
    v_min_u32 v12, -2, v12
    v_min_u32 v13, -2, v13
    v_min_u32 v14, -2, v14
    v_min_u32 v15, -2, v15
    buffer_store_dwordx4 v[12:15], v254, s[4:7], s88 offen offset:3072 sc0 sc1
    s_waitcnt vmcnt(4)
    v_lshlrev_b32 v160, 16, v196
    v_and_b32 v161, 0xffff0000, v196
    v_lshlrev_b32 v162, 16, v197
    v_and_b32 v163, 0xffff0000, v197
    v_pk_add_f32 v[128:129], v[128:129], v[160:161]
    v_pk_add_f32 v[130:131], v[130:131], v[162:163]
    v_lshlrev_b32 v164, 16, v198
    v_and_b32 v165, 0xffff0000, v198
    v_lshlrev_b32 v166, 16, v199
    v_and_b32 v167, 0xffff0000, v199
    v_pk_add_f32 v[144:145], v[144:145], v[164:165]
    v_pk_add_f32 v[146:147], v[146:147], v[166:167]
    v_lshlrev_b32 v168, 16, v200
    v_and_b32 v169, 0xffff0000, v200
    v_lshlrev_b32 v170, 16, v201
    v_and_b32 v171, 0xffff0000, v201
    v_pk_add_f32 v[132:133], v[132:133], v[168:169]
    v_pk_add_f32 v[134:135], v[134:135], v[170:171]
    v_lshlrev_b32 v172, 16, v202
    v_and_b32 v173, 0xffff0000, v202
    v_lshlrev_b32 v174, 16, v203
    v_and_b32 v175, 0xffff0000, v203
    v_pk_add_f32 v[148:149], v[148:149], v[172:173]
    v_pk_add_f32 v[150:151], v[150:151], v[174:175]
    v_lshlrev_b32 v160, 16, v204
    v_and_b32 v161, 0xffff0000, v204
    v_lshlrev_b32 v162, 16, v205
    v_and_b32 v163, 0xffff0000, v205
    v_pk_add_f32 v[136:137], v[136:137], v[160:161]
    v_pk_add_f32 v[138:139], v[138:139], v[162:163]
    v_lshlrev_b32 v164, 16, v206
    v_and_b32 v165, 0xffff0000, v206
    v_lshlrev_b32 v166, 16, v207
    v_and_b32 v167, 0xffff0000, v207
    v_pk_add_f32 v[152:153], v[152:153], v[164:165]
    v_pk_add_f32 v[154:155], v[154:155], v[166:167]
    v_lshlrev_b32 v168, 16, v208
    v_and_b32 v169, 0xffff0000, v208
    v_lshlrev_b32 v170, 16, v209
    v_and_b32 v171, 0xffff0000, v209
    v_pk_add_f32 v[140:141], v[140:141], v[168:169]
    v_pk_add_f32 v[142:143], v[142:143], v[170:171]
    v_lshlrev_b32 v172, 16, v210
    v_and_b32 v173, 0xffff0000, v210
    v_lshlrev_b32 v174, 16, v211
    v_and_b32 v175, 0xffff0000, v211
    v_pk_add_f32 v[156:157], v[156:157], v[172:173]
    v_pk_add_f32 v[158:159], v[158:159], v[174:175]
    s_mov_b32 s56, 262144
poll_37:
    buffer_load_dwordx4 v[16:19], v254, s[4:7], s89 offen offset:0 sc0 sc1
    buffer_load_dwordx4 v[20:23], v254, s[4:7], s89 offen offset:1024 sc0 sc1
    buffer_load_dwordx4 v[24:27], v254, s[4:7], s89 offen offset:2048 sc0 sc1
    buffer_load_dwordx4 v[28:31], v254, s[4:7], s89 offen offset:3072 sc0 sc1
    s_waitcnt vmcnt(0)
pc_39:
    v_max3_u32 v192, v16, v17, v18
    v_max3_u32 v193, v19, v20, v21
    v_max3_u32 v192, v192, v22, v23
    v_max3_u32 v193, v193, v24, v25
    v_max3_u32 v192, v192, v26, v27
    v_max3_u32 v193, v193, v28, v29
    v_max3_u32 v192, v192, v30, v31
    v_max_u32 v192, v192, v193
    v_cmp_eq_u32 vcc, -1, v192
    s_cbranch_vccz pd_38
    s_sub_u32 s56, s56, 1
    s_cmp_lg_u32 s56, 0
    s_cbranch_scc1 poll_37
pd_38:
    v_lshlrev_b32 v160, 16, v16
    v_and_b32 v161, 0xffff0000, v16
    v_lshlrev_b32 v162, 16, v17
    v_and_b32 v163, 0xffff0000, v17
    v_pk_add_f32 v[128:129], v[128:129], v[160:161]
    v_pk_add_f32 v[130:131], v[130:131], v[162:163]
    v_lshlrev_b32 v164, 16, v18
    v_and_b32 v165, 0xffff0000, v18
    v_lshlrev_b32 v166, 16, v19
    v_and_b32 v167, 0xffff0000, v19
    v_pk_add_f32 v[144:145], v[144:145], v[164:165]
    v_pk_add_f32 v[146:147], v[146:147], v[166:167]
    v_lshlrev_b32 v168, 16, v20
    v_and_b32 v169, 0xffff0000, v20
    v_lshlrev_b32 v170, 16, v21
    v_and_b32 v171, 0xffff0000, v21
    v_pk_add_f32 v[132:133], v[132:133], v[168:169]
    v_pk_add_f32 v[134:135], v[134:135], v[170:171]
    v_lshlrev_b32 v172, 16, v22
    v_and_b32 v173, 0xffff0000, v22
    v_lshlrev_b32 v174, 16, v23
    v_and_b32 v175, 0xffff0000, v23
    v_pk_add_f32 v[148:149], v[148:149], v[172:173]
    v_pk_add_f32 v[150:151], v[150:151], v[174:175]
    v_lshlrev_b32 v160, 16, v24
    v_and_b32 v161, 0xffff0000, v24
    v_lshlrev_b32 v162, 16, v25
    v_and_b32 v163, 0xffff0000, v25
    v_pk_add_f32 v[136:137], v[136:137], v[160:161]
    v_pk_add_f32 v[138:139], v[138:139], v[162:163]
    v_lshlrev_b32 v164, 16, v26
    v_and_b32 v165, 0xffff0000, v26
    v_lshlrev_b32 v166, 16, v27
    v_and_b32 v167, 0xffff0000, v27
    v_pk_add_f32 v[152:153], v[152:153], v[164:165]
    v_pk_add_f32 v[154:155], v[154:155], v[166:167]
    v_lshlrev_b32 v168, 16, v28
    v_and_b32 v169, 0xffff0000, v28
    v_lshlrev_b32 v170, 16, v29
    v_and_b32 v171, 0xffff0000, v29
    v_pk_add_f32 v[140:141], v[140:141], v[168:169]
    v_pk_add_f32 v[142:143], v[142:143], v[170:171]
    v_lshlrev_b32 v172, 16, v30
    v_and_b32 v173, 0xffff0000, v30
    v_lshlrev_b32 v174, 16, v31
    v_and_b32 v175, 0xffff0000, v31
    v_pk_add_f32 v[156:157], v[156:157], v[172:173]
    v_pk_add_f32 v[158:159], v[158:159], v[174:175]
    s_cmp_lg_u32 s46, 0
    s_cbranch_scc1 X_fin
    s_add_u32 s59, s1, s48
    s_add_u32 s60, s59, 4096
    v_cvt_pk_bf16_f32 v236, v128, v129
    v_cvt_pk_bf16_f32 v237, v130, v131
    v_cvt_pk_bf16_f32 v238, v144, v145
    v_cvt_pk_bf16_f32 v239, v146, v147
    buffer_store_dwordx4 v[236:239], v254, s[4:7], s59 offen offset:0 sc0 sc1
    v_cvt_pk_bf16_f32 v240, v132, v133
    v_cvt_pk_bf16_f32 v241, v134, v135
    v_cvt_pk_bf16_f32 v242, v148, v149
    v_cvt_pk_bf16_f32 v243, v150, v151
    buffer_store_dwordx4 v[240:243], v254, s[4:7], s59 offen offset:2048 sc0 sc1
    v_cvt_pk_bf16_f32 v244, v136, v137
    v_cvt_pk_bf16_f32 v245, v138, v139
    v_cvt_pk_bf16_f32 v246, v152, v153
    v_cvt_pk_bf16_f32 v247, v154, v155
    buffer_store_dwordx4 v[244:247], v254, s[4:7], s60 offen offset:0 sc0 sc1
    v_cvt_pk_bf16_f32 v248, v140, v141
    v_cvt_pk_bf16_f32 v249, v142, v143
    v_cvt_pk_bf16_f32 v250, v156, v157
    v_cvt_pk_bf16_f32 v251, v158, v159
    buffer_store_dwordx4 v[248:251], v254, s[4:7], s60 offen offset:2048 sc0 sc1
    v_mov_b32 v234, 0x3f803f80
    v_dot2_f32_bf16 v226, v236, v234, 0
    v_dot2_f32_bf16 v230, v236, v236, 0
    v_dot2_f32_bf16 v227, v240, v234, 0
    v_dot2_f32_bf16 v231, v240, v240, 0
    v_dot2_f32_bf16 v228, v244, v234, 0
    v_dot2_f32_bf16 v232, v244, v244, 0
    v_dot2_f32_bf16 v229, v248, v234, 0
    v_dot2_f32_bf16 v233, v248, v248, 0
    v_dot2_f32_bf16 v226, v237, v234, v226
    v_dot2_f32_bf16 v230, v237, v237, v230
    v_dot2_f32_bf16 v227, v241, v234, v227
    v_dot2_f32_bf16 v231, v241, v241, v231
    v_dot2_f32_bf16 v228, v245, v234, v228
    v_dot2_f32_bf16 v232, v245, v245, v232
    v_dot2_f32_bf16 v229, v249, v234, v229
    v_dot2_f32_bf16 v233, v249, v249, v233
    v_dot2_f32_bf16 v226, v238, v234, v226
    v_dot2_f32_bf16 v230, v238, v238, v230
    v_dot2_f32_bf16 v227, v242, v234, v227
    v_dot2_f32_bf16 v231, v242, v242, v231
    v_dot2_f32_bf16 v228, v246, v234, v228
    v_dot2_f32_bf16 v232, v246, v246, v232
    v_dot2_f32_bf16 v229, v250, v234, v229
    v_dot2_f32_bf16 v233, v250, v250, v233
    v_dot2_f32_bf16 v226, v239, v234, v226
    v_dot2_f32_bf16 v230, v239, v239, v230
    v_dot2_f32_bf16 v227, v243, v234, v227
    v_dot2_f32_bf16 v231, v243, v243, v231
    v_dot2_f32_bf16 v228, v247, v234, v228
    v_dot2_f32_bf16 v232, v247, v247, v232
    v_dot2_f32_bf16 v229, v251, v234, v229
    v_dot2_f32_bf16 v233, v251, v251, v233
    s_lshl_b32 s55, s42, 9
    s_add_u32 s55, s55, 155648
    s_nop 1
    v_permlane32_swap_b32 v226, v228
    v_permlane32_swap_b32 v227, v229
    v_permlane32_swap_b32 v230, v232
    v_permlane32_swap_b32 v231, v233
    v_add_f32 v226, v226, v228
    v_add_f32 v227, v227, v229
    v_add_f32 v230, v230, v232
    v_add_f32 v231, v231, v233
    v_lshrrev_b32 v234, 1, v254
    v_add_u32 v234, s55, v234
    v_permlane16_swap_b32 v226, v227
    v_permlane16_swap_b32 v230, v231
    v_add_f32 v226, v226, v227
    v_add_f32 v227, v230, v231
    ds_write_b64 v234, v[226:227]
    s_mov_b32 s46, 1
    s_add_u32 s47, s47, 262144
    s_add_u32 s49, s49, 524288
    s_add_u32 s50, s50, 917504
    s_add_u32 s52, s52, 65536
    s_add_u32 s54, s54, 32768
    s_add_u32 s0, s0, 32768
    s_branch X_layer
X_fin:
    v_and_b32 v192, 0xf0, v254
    v_lshlrev_b32 v192, 7, v192
    v_and_b32 v193, 0x100, v254
    v_lshrrev_b32 v193, 3, v193
    v_add_u32 v192, v192, v193
    v_and_b32 v193, 0x200, v254
    v_lshrrev_b32 v193, 5, v193
    v_add_u32 v192, v192, v193
    s_lshl_b32 s55, s40, 18
    s_lshl_b32 s56, s43, 17
    s_add_u32 s55, s55, s56
    s_lshl_b32 s56, s51, 7
    s_add_u32 s55, s55, s56
    s_lshl_b32 s56, s44, 6
    s_add_u32 s55, s55, s56
    v_cvt_pk_bf16_f32 v0, v128, v129
    v_cvt_pk_bf16_f32 v1, v130, v131
    v_cvt_pk_bf16_f32 v2, v144, v145
    v_cvt_pk_bf16_f32 v3, v146, v147
    s_nop 1
    v_permlane16_swap_b32 v0, v2
    v_permlane16_swap_b32 v1, v3
    buffer_store_dwordx4 v[0:3], v192, s[28:31], s55 offen sc0 sc1
    s_add_u32 s55, s55, 32768
    v_cvt_pk_bf16_f32 v4, v132, v133
    v_cvt_pk_bf16_f32 v5, v134, v135
    v_cvt_pk_bf16_f32 v6, v148, v149
    v_cvt_pk_bf16_f32 v7, v150, v151
    s_nop 1
    v_permlane16_swap_b32 v4, v6
    v_permlane16_swap_b32 v5, v7
    buffer_store_dwordx4 v[4:7], v192, s[28:31], s55 offen sc0 sc1
    s_add_u32 s55, s55, 32768
    v_cvt_pk_bf16_f32 v8, v136, v137
    v_cvt_pk_bf16_f32 v9, v138, v139
    v_cvt_pk_bf16_f32 v10, v152, v153
    v_cvt_pk_bf16_f32 v11, v154, v155
    s_nop 1
    v_permlane16_swap_b32 v8, v10
    v_permlane16_swap_b32 v9, v11
    buffer_store_dwordx4 v[8:11], v192, s[28:31], s55 offen sc0 sc1
    s_add_u32 s55, s55, 32768
    v_cvt_pk_bf16_f32 v12, v140, v141
    v_cvt_pk_bf16_f32 v13, v142, v143
    v_cvt_pk_bf16_f32 v14, v156, v157
    v_cvt_pk_bf16_f32 v15, v158, v159
    s_nop 1
    v_permlane16_swap_b32 v12, v14
    v_permlane16_swap_b32 v13, v15
    buffer_store_dwordx4 v[12:15], v192, s[28:31], s55 offen sc0 sc1
    s_add_u32 s55, s55, 32768
    s_endpgm
Y_first:
    v_mov_b32 v120, 0x3f80
    v_lshrrev_b32 v224, 4, v254
    v_and_b32 v225, 1, v224
    v_lshlrev_b32 v225, 4, v225
    v_lshlrev_b32 v225, v225, v120
    v_bfe_u32 v224, v224, 1, 3
    v_cmp_eq_u32 vcc, 0, v224
    s_nop 1
    v_cndmask_b32 v120, 0, v225, vcc
    v_cmp_eq_u32 vcc, 1, v224
    s_nop 1
    v_cndmask_b32 v121, 0, v225, vcc
    v_cmp_eq_u32 vcc, 2, v224
    s_nop 1
    v_cndmask_b32 v122, 0, v225, vcc
    v_cmp_eq_u32 vcc, 3, v224
    s_nop 1
    v_cndmask_b32 v123, 0, v225, vcc
    v_lshrrev_b32 v224, 7, v254
    v_and_b32 v225, 0x70, v254
    v_and_b32 v226, 6, v224
    v_lshlrev_b32 v226, 4, v226
    v_xor_b32 v225, v225, v226
    v_lshl_add_u32 v172, v224, 7, v225
    s_min_u32 s55, s42, 2
    s_lshl_b32 s55, s55, 12
    v_add_u32 v172, s55, v172
    s_setprio 1
    s_barrier
    s_and_b32 s55, s40, 3
    s_cmp_lg_u32 s55, 0
    s_cbranch_scc1 qc_40
    ds_read_b128 v[128:131], v172 offset:0
    ds_read_b128 v[132:135], v172 offset:1024
    ds_read_b128 v[136:139], v172 offset:2048
    ds_read_b128 v[140:143], v172 offset:3072
    s_waitcnt lgkmcnt(0)
    v_mfma_f32_16x16x32_bf16 v[124:127], v[120:123], v[128:131], 0
    v_mfma_f32_16x16x32_bf16 v[124:127], v[120:123], v[132:135], v[124:127]
    v_mfma_f32_16x16x32_bf16 v[124:127], v[120:123], v[136:139], v[124:127]
    v_mfma_f32_16x16x32_bf16 v[124:127], v[120:123], v[140:143], v[124:127]
    s_nop 7
qc_40:
    s_waitcnt vmcnt(24)
    s_barrier
    s_add_u32 m0, s61, 0
    s_mul_i32 s59, s93, 96
    buffer_load_dwordx4 v200, s[8:11], s59 offen lds
    v_add_f32_dpp v160, v160, v160 quad_perm:[1,0,3,2] row_mask:0xf bank_mask:0xf
    v_add_f32_dpp v161, v161, v161 quad_perm:[1,0,3,2] row_mask:0xf bank_mask:0xf
    v_add_f32_dpp v162, v162, v162 quad_perm:[1,0,3,2] row_mask:0xf bank_mask:0xf
    v_add_f32_dpp v163, v163, v163 quad_perm:[1,0,3,2] row_mask:0xf bank_mask:0xf
    v_add_f32_dpp v164, v164, v164 quad_perm:[1,0,3,2] row_mask:0xf bank_mask:0xf
    v_add_f32_dpp v165, v165, v165 quad_perm:[1,0,3,2] row_mask:0xf bank_mask:0xf
    v_add_f32_dpp v166, v166, v166 quad_perm:[1,0,3,2] row_mask:0xf bank_mask:0xf
    v_add_f32_dpp v167, v167, v167 quad_perm:[1,0,3,2] row_mask:0xf bank_mask:0xf
    buffer_load_dwordx4 v201, s[8:11], s59 offen offset:1024 lds
    v_add_f32_dpp v160, v160, v160 quad_perm:[2,3,0,1] row_mask:0xf bank_mask:0xf
    v_add_f32_dpp v161, v161, v161 quad_perm:[2,3,0,1] row_mask:0xf bank_mask:0xf
    v_add_f32_dpp v162, v162, v162 quad_perm:[2,3,0,1] row_mask:0xf bank_mask:0xf
    v_add_f32_dpp v163, v163, v163 quad_perm:[2,3,0,1] row_mask:0xf bank_mask:0xf
    v_add_f32_dpp v164, v164, v164 quad_perm:[2,3,0,1] row_mask:0xf bank_mask:0xf
    v_add_f32_dpp v165, v165, v165 quad_perm:[2,3,0,1] row_mask:0xf bank_mask:0xf
    v_add_f32_dpp v166, v166, v166 quad_perm:[2,3,0,1] row_mask:0xf bank_mask:0xf
    v_add_f32_dpp v167, v167, v167 quad_perm:[2,3,0,1] row_mask:0xf bank_mask:0xf
    buffer_load_dwordx4 v202, s[8:11], s59 offen offset:2048 lds
    s_add_u32 s93, s93, 2048
    s_and_b32 s93, s93, 65535
    v_add_f32_dpp v160, v160, v160 row_half_mirror row_mask:0xf bank_mask:0xf
    v_add_f32_dpp v161, v161, v161 row_half_mirror row_mask:0xf bank_mask:0xf
    v_add_f32_dpp v162, v162, v162 row_half_mirror row_mask:0xf bank_mask:0xf
    v_add_f32_dpp v163, v163, v163 row_half_mirror row_mask:0xf bank_mask:0xf
    v_add_f32_dpp v164, v164, v164 row_half_mirror row_mask:0xf bank_mask:0xf
    v_add_f32_dpp v165, v165, v165 row_half_mirror row_mask:0xf bank_mask:0xf
    v_add_f32_dpp v166, v166, v166 row_half_mirror row_mask:0xf bank_mask:0xf
    v_add_f32_dpp v167, v167, v167 row_half_mirror row_mask:0xf bank_mask:0xf
    s_and_b32 s55, s40, 3
    s_cmp_lg_u32 s55, 0
    s_cbranch_scc1 qc_41
    ds_read_b128 v[128:131], v172 offset:16384
    ds_read_b128 v[132:135], v172 offset:17408
    ds_read_b128 v[136:139], v172 offset:18432
    ds_read_b128 v[140:143], v172 offset:19456
    s_waitcnt lgkmcnt(0)
    v_mfma_f32_16x16x32_bf16 v[124:127], v[120:123], v[128:131], v[124:127]
    v_mfma_f32_16x16x32_bf16 v[124:127], v[120:123], v[132:135], v[124:127]
    v_mfma_f32_16x16x32_bf16 v[124:127], v[120:123], v[136:139], v[124:127]
    v_mfma_f32_16x16x32_bf16 v[124:127], v[120:123], v[140:143], v[124:127]
    s_nop 7
qc_41:
    s_waitcnt vmcnt(19)
    s_barrier
    s_add_u32 m0, s91, 98304
    s_mov_b64 exec, s[84:85]
    buffer_load_dwordx4 v221, s[36:39], s94 offen lds
    s_mov_b64 exec, -1
    v_and_b32 v224, 0x70, v254
    s_add_u32 m0, s62, 100352
    s_nop 0
    buffer_load_dwordx4 v217, s[36:39], s94 offen lds
    v_cmp_eq_u32 vcc, 16, v224
    s_nop 1
    v_cndmask_b32 v160, v160, v162, vcc
    v_cndmask_b32 v161, v161, v163, vcc
    buffer_load_dwordx4 v218, s[36:39], s94 offen offset:1024 lds
    v_cmp_eq_u32 vcc, 32, v224
    s_nop 1
    v_cndmask_b32 v160, v160, v164, vcc
    v_cndmask_b32 v161, v161, v165, vcc
    s_add_u32 m0, s61, 16384
    s_mul_i32 s59, s93, 96
    buffer_load_dwordx4 v200, s[8:11], s59 offen lds
    v_cmp_eq_u32 vcc, 48, v224
    s_nop 1
    v_cndmask_b32 v160, v160, v166, vcc
    v_cndmask_b32 v161, v161, v167, vcc
    buffer_load_dwordx4 v201, s[8:11], s59 offen offset:1024 lds
    v_lshrrev_b32 v225, 7, v254
    buffer_load_dwordx4 v202, s[8:11], s59 offen offset:2048 lds
    s_add_u32 s93, s93, 6144
    s_and_b32 s93, s93, 65535
    v_lshlrev_b32 v225, 3, v225
    v_lshl_add_u32 v224, v224, 2, v225
    s_and_b32 s55, s40, 3
    s_cmp_lg_u32 s55, 1
    s_cbranch_scc1 qc_42
    ds_read_b128 v[128:131], v172 offset:32768
    ds_read_b128 v[132:135], v172 offset:33792
    ds_read_b128 v[136:139], v172 offset:34816
    ds_read_b128 v[140:143], v172 offset:35840
    s_waitcnt lgkmcnt(0)
    v_mfma_f32_16x16x32_bf16 v[124:127], v[120:123], v[128:131], 0
    v_mfma_f32_16x16x32_bf16 v[124:127], v[120:123], v[132:135], v[124:127]
    v_mfma_f32_16x16x32_bf16 v[124:127], v[120:123], v[136:139], v[124:127]
    v_mfma_f32_16x16x32_bf16 v[124:127], v[120:123], v[140:143], v[124:127]
    s_nop 7
qc_42:
    s_lshl_b32 s55, s51, 10
    s_lshr_b32 s56, s62, 4
    s_add_u32 s55, s55, s56
    s_add_u32 s55, s55, s53
    s_add_u32 s55, s55, 65536
    s_mov_b32 s70, 0x0f0f0f0f
    s_mov_b32 s71, 0x0f0f0f0f
    s_mov_b64 exec, s[70:71]
    buffer_store_dwordx2 v[160:161], v224, s[4:7], s55 offen sc0 sc1
    s_mov_b64 exec, -1
    s_waitcnt vmcnt(16)
    s_barrier
    s_add_u32 m0, s62, 100352
    s_nop 0
    buffer_load_dwordx4 v219, s[36:39], s94 offen offset:2048 lds
    s_add_u32 s55, s51, 4
    s_and_b32 s56, s55, 7
    s_lshr_b32 s55, s55, 3
    s_and_b32 s55, s55, 1
    s_lshl_b32 s56, s56, 1
    s_add_u32 s55, s55, s56
    s_lshl_b32 s79, s55, 4
    s_add_u32 s79, s79, s40
    s_lshr_b32 s55, s79, 1
    s_cmp_lt_u32 s55, 56
    s_cselect_b32 s72, s80, s82
    s_cselect_b32 s73, s81, s83
    s_cselect_b32 s56, 0, 56
    s_sub_u32 s55, s55, s56
    s_lshl_b32 s76, s55, 7
    s_and_b32 s55, s79, 1
    s_lshl_b32 s55, s55, 2
    s_add_u32 s55, s55, s42
    s_mul_i32 s55, s55, 917504
    s_add_u32 s76, s76, s55
    s_cmp_lt_u32 s79, 224
    s_cselect_b32 s76, s76, 2130706432
    v_lshrrev_b32 v96, 7, v254
    buffer_load_dwordx4 v220, s[36:39], s94 offen offset:3072 lds
    s_add_u32 s94, s94, 256
    s_and_b32 s94, s94, 2047
    v_mul_u32_u24 v96, 7168, v96
    v_and_b32 v224, 0x70, v254
    s_add_u32 m0, s61, 32768
    s_mul_i32 s59, s93, 96
    buffer_load_dwordx4 v200, s[8:11], s59 offen lds
    v_add_u32 v96, v96, v224
    v_lshrrev_b32 v97, 6, v254
    v_mul_u32_u24 v97, 7168, v97
    buffer_load_dwordx4 v201, s[8:11], s59 offen offset:1024 lds
    v_lshrrev_b32 v224, 3, v254
    v_and_b32 v224, 0x20, v224
    buffer_load_dwordx4 v202, s[8:11], s59 offen offset:2048 lds
    s_add_u32 s93, s93, 2048
    s_and_b32 s93, s93, 65535
    v_and_b32 v225, 0x30, v254
    v_xor_b32 v224, v224, v225
    v_add_u32 v97, v97, v224
    s_and_b32 s55, s40, 3
    s_cmp_lg_u32 s55, 1
    s_cbranch_scc1 qc_43
    v_add_u32 v252, 49152, v172
    ds_read_b128 v[128:131], v252 offset:0
    ds_read_b128 v[132:135], v252 offset:1024
    ds_read_b128 v[136:139], v252 offset:2048
    ds_read_b128 v[140:143], v252 offset:3072
    s_waitcnt lgkmcnt(0)
    v_mfma_f32_16x16x32_bf16 v[124:127], v[120:123], v[128:131], v[124:127]
    v_mfma_f32_16x16x32_bf16 v[124:127], v[120:123], v[132:135], v[124:127]
    v_mfma_f32_16x16x32_bf16 v[124:127], v[120:123], v[136:139], v[124:127]
    v_mfma_f32_16x16x32_bf16 v[124:127], v[120:123], v[140:143], v[124:127]
    s_nop 7
qc_43:
    s_waitcnt vmcnt(18)
    s_barrier
    s_add_u32 m0, s91, 116736
    s_mov_b64 exec, s[84:85]
    buffer_load_dwordx4 v221, s[36:39], s94 offen lds
    s_mov_b64 exec, -1
    s_add_u32 m0, s62, 118784
    s_nop 0
    buffer_load_dwordx4 v217, s[36:39], s94 offen lds
    buffer_load_dwordx4 v218, s[36:39], s94 offen offset:1024 lds
    s_add_u32 m0, s61, 49152
    s_mul_i32 s59, s93, 96
    buffer_load_dwordx4 v200, s[8:11], s59 offen lds
    buffer_load_dwordx4 v201, s[8:11], s59 offen offset:1024 lds
    buffer_load_dwordx4 v202, s[8:11], s59 offen offset:2048 lds
    s_add_u32 s93, s93, 6144
    s_and_b32 s93, s93, 65535
    s_getreg_b32 s77, hwreg(HW_REG_XCC_ID, 0, 4)
    s_mul_i32 s55, s77, s77
    s_lshl_b32 s55, s55, 15
    s_lshl_b32 s77, s77, 6
    s_add_u32 s77, s77, s55
    s_add_u32 s77, s77, 1
    s_and_b32 s55, s40, 3
    s_cmp_lg_u32 s55, 2
    s_cbranch_scc1 qc_44
    v_add_u32 v252, 49152, v172
    ds_read_b128 v[128:131], v252 offset:16384
    ds_read_b128 v[132:135], v252 offset:17408
    ds_read_b128 v[136:139], v252 offset:18432
    ds_read_b128 v[140:143], v252 offset:19456
    s_waitcnt lgkmcnt(0)
    v_mfma_f32_16x16x32_bf16 v[124:127], v[120:123], v[128:131], 0
    v_mfma_f32_16x16x32_bf16 v[124:127], v[120:123], v[132:135], v[124:127]
    v_mfma_f32_16x16x32_bf16 v[124:127], v[120:123], v[136:139], v[124:127]
    v_mfma_f32_16x16x32_bf16 v[124:127], v[120:123], v[140:143], v[124:127]
    s_nop 7
qc_44:
    s_waitcnt vmcnt(21)
    s_barrier
    s_add_u32 m0, s62, 118784
    s_nop 0
    buffer_load_dwordx4 v219, s[36:39], s94 offen offset:2048 lds
    buffer_load_dwordx4 v220, s[36:39], s94 offen offset:3072 lds
    s_add_u32 s94, s94, 256
    s_and_b32 s94, s94, 2047
    s_add_u32 m0, s61, 65536
    s_mul_i32 s59, s93, 96
    buffer_load_dwordx4 v200, s[8:11], s59 offen lds
    buffer_load_dwordx4 v201, s[8:11], s59 offen offset:1024 lds
    buffer_load_dwordx4 v202, s[8:11], s59 offen offset:2048 lds
    s_add_u32 s93, s93, 2048
    s_and_b32 s93, s93, 65535
    s_and_b32 s55, s40, 3
    s_cmp_lg_u32 s55, 2
    s_cbranch_scc1 qc_45
    v_add_u32 v252, 49152, v172
    ds_read_b128 v[128:131], v252 offset:32768
    ds_read_b128 v[132:135], v252 offset:33792
    ds_read_b128 v[136:139], v252 offset:34816
    ds_read_b128 v[140:143], v252 offset:35840
    s_waitcnt lgkmcnt(0)
    v_mfma_f32_16x16x32_bf16 v[124:127], v[120:123], v[128:131], v[124:127]
    v_mfma_f32_16x16x32_bf16 v[124:127], v[120:123], v[132:135], v[124:127]
    v_mfma_f32_16x16x32_bf16 v[124:127], v[120:123], v[136:139], v[124:127]
    v_mfma_f32_16x16x32_bf16 v[124:127], v[120:123], v[140:143], v[124:127]
    s_nop 7
qc_45:
    buffer_load_dwordx4 v[0:3], v96, s[72:75], s76 offen
    s_add_u32 s76, s76, 57344
    s_waitcnt vmcnt(15)
    s_barrier
    s_add_u32 m0, s91, 135168
    s_mov_b64 exec, s[84:85]
    buffer_load_dwordx4 v221, s[36:39], s94 offen lds
    s_mov_b64 exec, -1
    s_add_u32 m0, s62, 137216
    s_nop 0
    buffer_load_dwordx4 v217, s[36:39], s94 offen lds
    buffer_load_dwordx4 v218, s[36:39], s94 offen offset:1024 lds
    s_add_u32 m0, s61, 81920
    s_mul_i32 s59, s93, 96
    buffer_load_dwordx4 v200, s[8:11], s59 offen lds
    buffer_load_dwordx4 v201, s[8:11], s59 offen offset:1024 lds
    buffer_load_dwordx4 v202, s[8:11], s59 offen offset:2048 lds
    s_add_u32 s93, s93, 6144
    s_and_b32 s93, s93, 65535
    s_and_b32 s55, s40, 3
    s_cmp_lg_u32 s55, 3
    s_cbranch_scc1 qc_46
    ds_read_b128 v[128:131], v172 offset:0
    ds_read_b128 v[132:135], v172 offset:1024
    ds_read_b128 v[136:139], v172 offset:2048
    ds_read_b128 v[140:143], v172 offset:3072
    s_waitcnt lgkmcnt(0)
    v_mfma_f32_16x16x32_bf16 v[124:127], v[120:123], v[128:131], 0
    v_mfma_f32_16x16x32_bf16 v[124:127], v[120:123], v[132:135], v[124:127]
    v_mfma_f32_16x16x32_bf16 v[124:127], v[120:123], v[136:139], v[124:127]
    v_mfma_f32_16x16x32_bf16 v[124:127], v[120:123], v[140:143], v[124:127]
    s_nop 7
qc_46:
    buffer_load_dwordx4 v[4:7], v96, s[72:75], s76 offen
    s_add_u32 s76, s76, 57344
    s_barrier
    s_add_u32 m0, s62, 137216
    s_nop 0
    buffer_load_dwordx4 v219, s[36:39], s94 offen offset:2048 lds
    buffer_load_dwordx4 v220, s[36:39], s94 offen offset:3072 lds
    s_add_u32 s94, s94, 256
    s_and_b32 s94, s94, 2047
    s_add_u32 m0, s61, 0
    s_mul_i32 s59, s93, 96
    buffer_load_dwordx4 v200, s[8:11], s59 offen lds
    buffer_load_dwordx4 v201, s[8:11], s59 offen offset:1024 lds
    buffer_load_dwordx4 v202, s[8:11], s59 offen offset:2048 lds
    s_add_u32 s93, s93, 2048
    s_and_b32 s93, s93, 65535
    s_and_b32 s55, s40, 3
    s_cmp_lg_u32 s55, 3
    s_cbranch_scc1 qc_47
    ds_read_b128 v[128:131], v172 offset:16384
    ds_read_b128 v[132:135], v172 offset:17408
    ds_read_b128 v[136:139], v172 offset:18432
    ds_read_b128 v[140:143], v172 offset:19456
    s_waitcnt lgkmcnt(0)
    v_mfma_f32_16x16x32_bf16 v[124:127], v[120:123], v[128:131], v[124:127]
    v_mfma_f32_16x16x32_bf16 v[124:127], v[120:123], v[132:135], v[124:127]
    v_mfma_f32_16x16x32_bf16 v[124:127], v[120:123], v[136:139], v[124:127]
    v_mfma_f32_16x16x32_bf16 v[124:127], v[120:123], v[140:143], v[124:127]
    s_nop 7
qc_47:
    buffer_load_dwordx4 v[8:11], v96, s[72:75], s76 offen
    s_add_u32 s76, s76, 57344
    s_waitcnt vmcnt(17)
    s_barrier
    s_add_u32 m0, s91, 98304
    s_mov_b64 exec, s[84:85]
    buffer_load_dwordx4 v221, s[36:39], s94 offen lds
    s_mov_b64 exec, -1
    v_add_f32_dpp v124, v124, v124 row_ror:8 row_mask:0xf bank_mask:0xf
    s_add_u32 m0, s62, 100352
    s_nop 0
    buffer_load_dwordx4 v217, s[36:39], s94 offen lds
    v_add_f32_dpp v125, v125, v125 row_ror:8 row_mask:0xf bank_mask:0xf
    buffer_load_dwordx4 v218, s[36:39], s94 offen offset:1024 lds
    v_add_f32_dpp v126, v126, v126 row_ror:8 row_mask:0xf bank_mask:0xf
    v_add_f32_dpp v127, v127, v127 row_ror:8 row_mask:0xf bank_mask:0xf
    s_add_u32 m0, s61, 16384
    s_mul_i32 s59, s93, 96
    buffer_load_dwordx4 v200, s[8:11], s59 offen lds
    v_and_b32 v224, 0x70, v254
    buffer_load_dwordx4 v201, s[8:11], s59 offen offset:1024 lds
    v_lshrrev_b32 v225, 4, v254
    buffer_load_dwordx4 v202, s[8:11], s59 offen offset:2048 lds
    s_add_u32 s93, s93, 6144
    s_and_b32 s93, s93, 65535
    v_and_b32 v225, 16, v225
    v_lshl_add_u32 v224, v224, 1, v225
    s_mul_i32 s55, s40, 12288
    s_lshl_b32 s56, s42, 12
    s_add_u32 s55, s55, s56
    s_lshl_b32 s56, s51, 8
    s_add_u32 s55, s55, s56
    s_add_u32 s55, s55, 70516736
    s_cmp_lt_u32 s42, 3
    s_cselect_b32 s55, s55, 2130706432
    s_mov_b64 exec, 0x00ff00ff
    buffer_store_dwordx4 v[124:127], v224, s[4:7], s55 offen sc0 sc1
    s_mov_b64 exec, -1
    s_barrier
    s_add_u32 m0, s62, 100352
    s_nop 0
    buffer_load_dwordx4 v219, s[36:39], s94 offen offset:2048 lds
    v_lshrrev_b32 v224, 7, v254
    v_and_b32 v225, 0x70, v254
    buffer_load_dwordx4 v220, s[36:39], s94 offen offset:3072 lds
    s_add_u32 s94, s94, 256
    s_and_b32 s94, s94, 2047
    v_and_b32 v226, 6, v224
    v_lshlrev_b32 v226, 4, v226
    s_add_u32 m0, s61, 32768
    s_mul_i32 s59, s93, 96
    buffer_load_dwordx4 v200, s[8:11], s59 offen lds
    v_xor_b32 v225, v225, v226
    v_mul_u32_u24 v224, 2048, v224
    buffer_load_dwordx4 v201, s[8:11], s59 offen offset:1024 lds
    v_add3_u32 v203, v224, v225, s64
    v_add_u32 v204, 15360, v203
    buffer_load_dwordx4 v202, s[8:11], s59 offen offset:2048 lds
    s_add_u32 s93, s93, 2048
    s_and_b32 s93, s93, 65535
    v_add_u32 v205, 30720, v203
    v_add_u32 v206, 46080, v203
    buffer_load_dwordx4 v[12:15], v96, s[72:75], s76 offen
    s_add_u32 s76, s76, 57344
    s_waitcnt vmcnt(17)
    s_barrier
    s_add_u32 m0, s91, 116736
    s_mov_b64 exec, s[84:85]
    buffer_load_dwordx4 v221, s[36:39], s94 offen lds
    s_mov_b64 exec, -1
    s_add_u32 m0, s62, 118784
    s_nop 0
    buffer_load_dwordx4 v217, s[36:39], s94 offen lds
    buffer_load_dwordx4 v218, s[36:39], s94 offen offset:1024 lds
    s_add_u32 m0, s61, 49152
    s_mul_i32 s59, s93, 96
    buffer_load_dwordx4 v200, s[8:11], s59 offen lds
    buffer_load_dwordx4 v201, s[8:11], s59 offen offset:1024 lds
    buffer_load_dwordx4 v202, s[8:11], s59 offen offset:2048 lds
    s_add_u32 s93, s93, 10240
    s_and_b32 s93, s93, 65535
    buffer_load_dwordx4 v[16:19], v96, s[72:75], s76 offen
    s_add_u32 s76, s76, 57344
    s_waitcnt vmcnt(13)
    s_barrier
    s_add_u32 m0, s62, 118784
    s_nop 0
    buffer_load_dwordx4 v219, s[36:39], s94 offen offset:2048 lds
    buffer_load_dwordx4 v220, s[36:39], s94 offen offset:3072 lds
    s_add_u32 s94, s94, 384
    s_and_b32 s94, s94, 2047
    s_lshr_b32 s55, s2, 3
    s_lshl_b32 s55, s55, 1
    s_add_u32 s55, s55, s44
    s_and_b32 s56, s2, 7
    s_lshl_b32 s90, s43, 3
    s_add_u32 s90, s90, s56
    s_lshl_b32 s90, s90, 7
    s_add_u32 s90, s90, s55
    s_lshl_b32 s90, s90, 10
    s_add_u32 s90, s90, 67108864
    s_mul_i32 s55, s55, 114688
    s_mul_i32 s56, s56, 896
    s_add_u32 s70, s55, s56
    s_add_u32 m0, s61, 65536
    s_mul_i32 s59, s93, 96
    buffer_load_dwordx4 v200, s[8:11], s59 offen lds
    buffer_load_dwordx4 v201, s[8:11], s59 offen offset:1024 lds
    buffer_load_dwordx4 v[64:67], v97, s[16:19], s70 offen offset:384
    buffer_load_dwordx4 v202, s[8:11], s59 offen offset:2048 lds
    s_add_u32 s93, s93, 2048
    s_and_b32 s93, s93, 65535
    buffer_load_dwordx4 v[68:71], v97, s[16:19], s70 offen offset:448
    s_cmp_lg_u32 s42, 1
    s_cbranch_scc1 hs_48
    v_mov_b32 v252, 0
    v_mov_b32 v253, 1
    s_lshl_b32 s55, s2, 2
    s_add_u32 s55, s55, 71565312
    s_mov_b64 exec, 1
    buffer_store_dword v253, v252, s[4:7], s55 offen sc0 sc1
    s_mov_b64 exec, -1
hs_48:
    s_waitcnt vmcnt(18)
    s_barrier
    s_add_u32 m0, s91, 135168
    s_mov_b64 exec, s[84:85]
    buffer_load_dwordx4 v221, s[36:39], s94 offen lds
    s_mov_b64 exec, -1
    s_add_u32 m0, s62, 137216
    s_nop 0
    buffer_load_dwordx4 v217, s[36:39], s94 offen lds
    buffer_load_dwordx4 v218, s[36:39], s94 offen offset:1024 lds
    s_add_u32 m0, s61, 81920
    s_mul_i32 s59, s93, 96
    buffer_load_dwordx4 v200, s[8:11], s59 offen lds
    buffer_load_dwordx4 v201, s[8:11], s59 offen offset:1024 lds
    buffer_load_dwordx4 v202, s[8:11], s59 offen offset:2048 lds
    s_add_u32 s93, s93, 6144
    s_and_b32 s93, s93, 65535
    buffer_load_dwordx4 v[20:23], v96, s[72:75], s76 offen
    s_add_u32 s76, s76, 57344
    s_barrier
    s_add_u32 m0, s62, 137216
    s_nop 0
    buffer_load_dwordx4 v219, s[36:39], s94 offen offset:2048 lds
    buffer_load_dwordx4 v220, s[36:39], s94 offen offset:3072 lds
    s_add_u32 s94, s94, 256
    s_and_b32 s94, s94, 2047
    s_add_u32 m0, s61, 0
    s_mul_i32 s59, s93, 96
    buffer_load_dwordx4 v200, s[8:11], s59 offen lds
    buffer_load_dwordx4 v201, s[8:11], s59 offen offset:1024 lds
    buffer_load_dwordx4 v202, s[8:11], s59 offen offset:2048 lds
    s_add_u32 s93, s93, 2048
    s_and_b32 s93, s93, 65535
    buffer_load_dwordx4 v[24:27], v96, s[72:75], s76 offen
    s_add_u32 s76, s76, 57344
    s_waitcnt vmcnt(18)
    s_barrier
    s_add_u32 m0, s91, 98304
    s_mov_b64 exec, s[84:85]
    buffer_load_dwordx4 v221, s[36:39], s94 offen lds
    s_mov_b64 exec, -1
    s_add_u32 m0, s62, 100352
    s_nop 0
    buffer_load_dwordx4 v217, s[36:39], s94 offen lds
    buffer_load_dwordx4 v218, s[36:39], s94 offen offset:1024 lds
    s_add_u32 m0, s61, 16384
    s_mul_i32 s59, s93, 96
    buffer_load_dwordx4 v200, s[8:11], s59 offen lds
    buffer_load_dwordx4 v201, s[8:11], s59 offen offset:1024 lds
    buffer_load_dwordx4 v202, s[8:11], s59 offen offset:2048 lds
    s_add_u32 s93, s93, 6144
    s_and_b32 s93, s93, 65535
    buffer_load_dwordx4 v[28:31], v96, s[72:75], s76 offen
    s_add_u32 s76, s76, 57344
    s_barrier
    v_lshlrev_b32 v227, 1, v254
    v_and_b32 v227, 0xff, v227
    buffer_load_dword v98, v227, s[32:35], 0 offen sc0 sc1
    s_add_u32 m0, s62, 100352
    s_nop 0
    buffer_load_dwordx4 v219, s[36:39], s94 offen offset:2048 lds
    buffer_load_dwordx4 v220, s[36:39], s94 offen offset:3072 lds
    s_add_u32 s94, s94, 256
    s_and_b32 s94, s94, 2047
    s_add_u32 m0, s61, 32768
    s_mul_i32 s59, s93, 96
    buffer_load_dwordx4 v200, s[8:11], s59 offen lds
    buffer_load_dwordx4 v201, s[8:11], s59 offen offset:1024 lds
    buffer_load_dwordx4 v202, s[8:11], s59 offen offset:2048 lds
    s_add_u32 s93, s93, 2048
    s_and_b32 s93, s93, 65535
    s_waitcnt vmcnt(17)
    s_barrier
    s_add_u32 m0, s91, 116736
    s_mov_b64 exec, s[84:85]
    buffer_load_dwordx4 v221, s[36:39], s94 offen lds
    s_mov_b64 exec, -1
    s_add_u32 m0, s62, 118784
    s_nop 0
    buffer_load_dwordx4 v217, s[36:39], s94 offen lds
    buffer_load_dwordx4 v218, s[36:39], s94 offen offset:1024 lds
    s_add_u32 m0, s61, 49152
    s_mul_i32 s59, s93, 96
    buffer_load_dwordx4 v200, s[8:11], s59 offen lds
    buffer_load_dwordx4 v201, s[8:11], s59 offen offset:1024 lds
    buffer_load_dwordx4 v202, s[8:11], s59 offen offset:2048 lds
    s_add_u32 s93, s93, 6144
    s_and_b32 s93, s93, 65535
    buffer_load_dwordx4 v[32:35], v96, s[72:75], s76 offen
    s_add_u32 s76, s76, 57344
    s_barrier
    s_add_u32 m0, s62, 118784
    s_nop 0
    buffer_load_dwordx4 v219, s[36:39], s94 offen offset:2048 lds
    buffer_load_dwordx4 v220, s[36:39], s94 offen offset:3072 lds
    s_add_u32 s94, s94, 256
    s_and_b32 s94, s94, 2047
    s_add_u32 m0, s61, 65536
    s_mul_i32 s59, s93, 96
    buffer_load_dwordx4 v200, s[8:11], s59 offen lds
    buffer_load_dwordx4 v201, s[8:11], s59 offen offset:1024 lds
    buffer_load_dwordx4 v202, s[8:11], s59 offen offset:2048 lds
    s_add_u32 s93, s93, 2048
    s_and_b32 s93, s93, 65535
    buffer_load_dwordx4 v[36:39], v96, s[72:75], s76 offen
    s_add_u32 s76, s76, 57344
    s_waitcnt vmcnt(16)
    s_barrier
    s_mov_b32 s56, 262144
hs_49:
    v_and_b32 v225, 63, v98
    v_cmp_ne_u32 vcc, 32, v225
    s_cbranch_vccz hs_50
    buffer_load_dword v98, v227, s[32:35], 0 offen sc0 sc1
    s_waitcnt vmcnt(0)
    s_sub_u32 s56, s56, 1
    s_cmp_lg_u32 s56, 0
    s_cbranch_scc1 hs_49
hs_50:
    s_mov_b32 s55, 71565312
    buffer_load_dwordx4 v[72:75], v254, s[4:7], s55 offen sc0 sc1
    s_add_u32 m0, s91, 135168
    s_mov_b64 exec, s[84:85]
    buffer_load_dwordx4 v221, s[36:39], s94 offen lds
    s_mov_b64 exec, -1
    s_add_u32 m0, s62, 137216
    s_nop 0
    buffer_load_dwordx4 v217, s[36:39], s94 offen lds
    buffer_load_dwordx4 v218, s[36:39], s94 offen offset:1024 lds
    s_add_u32 m0, s61, 81920
    s_mul_i32 s59, s93, 96
    buffer_load_dwordx4 v200, s[8:11], s59 offen lds
    buffer_load_dwordx4 v201, s[8:11], s59 offen offset:1024 lds
    buffer_load_dwordx4 v202, s[8:11], s59 offen offset:2048 lds
    s_add_u32 s93, s93, 6144
    s_and_b32 s93, s93, 65535
    s_and_b32 s55, s2, 7
    s_lshl_b32 s56, s77, 5
    v_readlane_b32 s55, v98, s55
    s_nop 3
    s_cmp_lg_u32 s55, s56
    s_cselect_b32 s45, 1, 0
    v_mov_b32 v224, 163712
    v_mov_b32 v225, s45
    s_mov_b64 exec, 1
    ds_write_b32 v224, v225
    s_mov_b64 exec, -1
    buffer_load_dwordx4 v[40:43], v96, s[72:75], s76 offen
    s_add_u32 s76, s76, 57344
    s_barrier
    s_add_u32 m0, s62, 137216
    s_nop 0
    buffer_load_dwordx4 v219, s[36:39], s94 offen offset:2048 lds
    v_and_b32 v173, 0xf0, v254
    buffer_load_dwordx4 v220, s[36:39], s94 offen offset:3072 lds
    s_add_u32 s94, s94, 256
    s_and_b32 s94, s94, 2047
    v_min_u32 v173, 0xb0, v173
    s_mul_i32 s55, s42, 192
    v_add_u32 v173, s55, v173
    s_add_u32 m0, s61, 0
    s_mul_i32 s59, s93, 96
    buffer_load_dwordx4 v200, s[8:11], s59 offen lds
    v_lshrrev_b32 v224, 8, v173
    v_and_b32 v225, 0xff, v173
    buffer_load_dwordx4 v201, s[8:11], s59 offen offset:1024 lds
    v_lshl_add_u32 v224, v224, 12, v225
    v_lshrrev_b32 v225, 8, v254
    buffer_load_dwordx4 v202, s[8:11], s59 offen offset:2048 lds
    s_add_u32 s93, s93, 2048
    s_and_b32 s93, s93, 65535
    v_mul_u32_u24 v225, 12288, v225
    s_lshl_b32 s55, s51, 8
    v_add3_u32 v174, v224, v225, s55
    s_waitcnt vmcnt(17)
    s_barrier
    s_add_u32 m0, s91, 98304
    s_mov_b64 exec, s[84:85]
    buffer_load_dwordx4 v221, s[36:39], s94 offen lds
    s_mov_b64 exec, -1
    s_add_u32 m0, s62, 100352
    s_nop 0
    buffer_load_dwordx4 v217, s[36:39], s94 offen lds
    buffer_load_dwordx4 v218, s[36:39], s94 offen offset:1024 lds
    s_add_u32 m0, s61, 16384
    s_mul_i32 s59, s93, 96
    buffer_load_dwordx4 v200, s[8:11], s59 offen lds
    buffer_load_dwordx4 v201, s[8:11], s59 offen offset:1024 lds
    buffer_load_dwordx4 v202, s[8:11], s59 offen offset:2048 lds
    s_add_u32 s93, s93, 6144
    s_and_b32 s93, s93, 65535
    buffer_load_dwordx4 v[44:47], v96, s[72:75], s76 offen
    s_add_u32 s76, s76, 57344
    s_barrier
    s_waitcnt vmcnt(19)
    v_and_b32 v72, v72, v73
    v_and_b32 v74, v74, v75
    v_and_b32 v72, v72, v74
    v_cmp_ne_u32 vcc, 1, v72
    s_cbranch_vccz a4_51
    s_mov_b32 s55, 71565312
    s_mov_b32 s56, 262144
p4_52:
    buffer_load_dwordx4 v[72:75], v254, s[4:7], s55 offen sc0 sc1
    s_waitcnt vmcnt(0)
    v_and_b32 v72, v72, v73
    v_and_b32 v74, v74, v75
    v_and_b32 v72, v72, v74
    v_cmp_ne_u32 vcc, 1, v72
    s_cbranch_vccz p4_53
    s_sleep 1
    s_sub_u32 s56, s56, 1
    s_cmp_lg_u32 s56, 0
    s_cbranch_scc1 p4_52
p4_53:
a4_51:
    s_add_u32 m0, s62, 100352
    s_nop 0
    buffer_load_dwordx4 v219, s[36:39], s94 offen offset:2048 lds
    buffer_load_dwordx4 v220, s[36:39], s94 offen offset:3072 lds
    s_add_u32 s94, s94, 256
    s_and_b32 s94, s94, 2047
    v_and_b32 v226, 0xf0, v254
    v_and_b32 v227, 0x300, v254
    v_lshl_add_u32 v227, v227, 2, v226
    s_lshl_b32 s78, s42, 8
    s_add_u32 s78, s78, s53
    s_add_u32 s78, s78, 65536
    s_add_u32 m0, s61, 32768
    s_mul_i32 s59, s93, 96
    buffer_load_dwordx4 v200, s[8:11], s59 offen lds
    buffer_load_dwordx4 v[144:147], v227, s[4:7], s78 offen
    s_add_u32 s78, s78, 4096
    buffer_load_dwordx4 v201, s[8:11], s59 offen offset:1024 lds
    buffer_load_dwordx4 v[148:151], v227, s[4:7], s78 offen
    s_add_u32 s78, s78, 4096
    buffer_load_dwordx4 v202, s[8:11], s59 offen offset:2048 lds
    s_add_u32 s93, s93, 2048
    s_and_b32 s93, s93, 65535
    buffer_load_dwordx4 v[152:155], v227, s[4:7], s78 offen
    s_add_u32 s78, s78, 4096
    s_waitcnt vmcnt(18)
    s_barrier
    s_add_u32 m0, s91, 116736
    s_mov_b64 exec, s[84:85]
    buffer_load_dwordx4 v221, s[36:39], s94 offen lds
    s_mov_b64 exec, -1
    s_add_u32 m0, s62, 118784
    s_nop 0
    buffer_load_dwordx4 v217, s[36:39], s94 offen lds
    buffer_load_dwordx4 v[156:159], v227, s[4:7], s78 offen
    s_add_u32 s78, s78, 4096
    buffer_load_dwordx4 v218, s[36:39], s94 offen offset:1024 lds
    v_lshrrev_b32 v224, 7, v254
    v_and_b32 v175, 0x70, v254
    v_lshl_add_u32 v224, v224, 10, v175
    s_sub_u32 s70, s53, 4127872
    s_cmp_eq_u32 s40, 0
    s_cselect_b32 s70, 2130706432, s70
    s_add_u32 m0, s61, 49152
    s_mul_i32 s59, s93, 96
    buffer_load_dwordx4 v200, s[8:11], s59 offen lds
    buffer_load_dwordx4 v201, s[8:11], s59 offen offset:1024 lds
    buffer_load_dwordx4 v[164:167], v224, s[4:7], s70 offen
    s_add_u32 s70, s70, 8192
    buffer_load_dwordx4 v202, s[8:11], s59 offen offset:2048 lds
    s_add_u32 s93, s93, 6144
    s_and_b32 s93, s93, 65535
    buffer_load_dwordx4 v[168:171], v224, s[4:7], s70 offen
    s_add_u32 s70, s70, 8192
    s_barrier
    s_add_u32 m0, s62, 118784
    s_nop 0
    buffer_load_dwordx4 v219, s[36:39], s94 offen offset:2048 lds
    buffer_load_dwordx4 v220, s[36:39], s94 offen offset:3072 lds
    s_add_u32 s94, s94, 256
    s_and_b32 s94, s94, 2047
    s_add_u32 m0, s61, 65536
    s_mul_i32 s59, s93, 96
    buffer_load_dwordx4 v200, s[8:11], s59 offen lds
    s_mov_b32 s55, 70516736
    buffer_load_dwordx4 v[76:79], v174, s[4:7], s55 offen sc1
    buffer_load_dwordx4 v201, s[8:11], s59 offen offset:1024 lds
    buffer_load_dwordx4 v202, s[8:11], s59 offen offset:2048 lds
    s_add_u32 s93, s93, 2048
    s_and_b32 s93, s93, 65535
    s_mov_b32 s55, 70565888
    buffer_load_dwordx4 v[80:83], v174, s[4:7], s55 offen sc1
    s_waitcnt vmcnt(22)
    s_barrier
    s_waitcnt vmcnt(13)
    s_add_u32 m0, s91, 135168
    s_mov_b64 exec, s[84:85]
    buffer_load_dwordx4 v221, s[36:39], s94 offen lds
    s_mov_b64 exec, -1
    s_mov_b32 s55, 70615040
    buffer_load_dwordx4 v[84:87], v174, s[4:7], s55 offen sc1
    s_mov_b32 s55, 70664192
    buffer_load_dwordx4 v[88:91], v174, s[4:7], s55 offen sc1
    v_add_f32 v144, v144, v148
    v_add_f32 v145, v145, v149
    s_add_u32 m0, s62, 137216
    s_nop 0
    buffer_load_dwordx4 v217, s[36:39], s94 offen lds
    v_add_f32 v146, v146, v150
    v_add_f32 v147, v147, v151
    v_add_f32 v152, v152, v156
    v_add_f32 v153, v153, v157
    v_add_f32 v154, v154, v158
    buffer_load_dwordx4 v218, s[36:39], s94 offen offset:1024 lds
    v_add_f32 v155, v155, v159
    v_add_f32 v160, v144, v152
    v_add_f32 v161, v145, v153
    v_add_f32 v162, v146, v154
    s_add_u32 m0, s61, 81920
    s_mul_i32 s59, s93, 96
    buffer_load_dwordx4 v200, s[8:11], s59 offen lds
    v_add_f32 v163, v147, v155
    v_mov_b32 v144, v160
    v_mov_b32 v145, v161
    v_mov_b32 v146, v162
    v_mov_b32 v147, v163
    buffer_load_dwordx4 v201, s[8:11], s59 offen offset:1024 lds
    s_nop 1
    v_permlane16_swap_b32 v160, v144
    v_permlane16_swap_b32 v161, v145
    v_permlane16_swap_b32 v162, v146
    buffer_load_dwordx4 v202, s[8:11], s59 offen offset:2048 lds
    s_add_u32 s93, s93, 6144
    s_and_b32 s93, s93, 65535
    v_permlane16_swap_b32 v163, v147
    v_add_f32 v160, v160, v144
    v_add_f32 v161, v161, v145
    v_add_f32 v162, v162, v146
    v_add_f32 v163, v163, v147
    s_barrier
    s_add_u32 m0, s62, 137216
    s_nop 0
    buffer_load_dwordx4 v219, s[36:39], s94 offen offset:2048 lds
    v_mov_b32 v144, v160
    v_mov_b32 v145, v161
    buffer_load_dwordx4 v220, s[36:39], s94 offen offset:3072 lds
    s_add_u32 s94, s94, 256
    s_and_b32 s94, s94, 2047
    v_mov_b32 v146, v162
    v_mov_b32 v147, v163
    s_nop 1
    s_add_u32 m0, s61, 0
    s_mul_i32 s59, s93, 96
    buffer_load_dwordx4 v200, s[8:11], s59 offen lds
    v_permlane32_swap_b32 v160, v144
    v_permlane32_swap_b32 v161, v145
    buffer_load_dwordx4 v201, s[8:11], s59 offen offset:1024 lds
    v_permlane32_swap_b32 v162, v146
    v_permlane32_swap_b32 v163, v147
    v_add_f32 v160, v160, v144
    buffer_load_dwordx4 v202, s[8:11], s59 offen offset:2048 lds
    s_add_u32 s93, s93, 2048
    s_and_b32 s93, s93, 65535
    v_add_f32 v161, v161, v145
    v_add_f32 v162, v162, v146
    v_add_f32 v163, v163, v147
    s_waitcnt vmcnt(18)
    s_barrier
    s_add_u32 m0, s91, 98304
    s_mov_b64 exec, s[84:85]
    buffer_load_dwordx4 v221, s[36:39], s94 offen lds
    s_mov_b64 exec, -1
    v_mul_f32 v160, 0x3a800000, v160
    v_mul_f32 v161, 0x3a800000, v161
    s_add_u32 m0, s62, 100352
    s_nop 0
    buffer_load_dwordx4 v217, s[36:39], s94 offen lds
    v_fma_f32 v161, -v160, v160, v161
    v_max_f32 v161, 0, v161
    v_cvt_pk_bf16_f32 v160, v160, v160
    buffer_load_dwordx4 v218, s[36:39], s94 offen offset:1024 lds
    v_lshlrev_b32 v160, 16, v160
    v_cvt_pk_bf16_f32 v161, v161, v161
    v_lshlrev_b32 v161, 16, v161
    s_add_u32 m0, s61, 16384
    s_mul_i32 s59, s93, 96
    buffer_load_dwordx4 v200, s[8:11], s59 offen lds
    v_add_f32 v161, 0x3727c5ac, v161
    v_cvt_pk_bf16_f32 v161, v161, v161
    v_lshlrev_b32 v161, 16, v161
    buffer_load_dwordx4 v201, s[8:11], s59 offen offset:1024 lds
    v_sqrt_f32 v161, v161
    s_nop 0
    v_cvt_pk_bf16_f32 v161, v161, v161
    buffer_load_dwordx4 v202, s[8:11], s59 offen offset:2048 lds
    v_lshlrev_b32 v161, 16, v161
    v_rcp_f32 v161, v161
    s_nop 0
    s_barrier
    s_add_u32 m0, s62, 100352
    s_nop 0
    buffer_load_dwordx4 v219, s[36:39], s94 offen offset:2048 lds
    v_mul_f32 v162, 0x3a800000, v162
    v_mul_f32 v163, 0x3a800000, v163
    v_fma_f32 v163, -v162, v162, v163
    v_max_f32 v163, 0, v163
    buffer_load_dwordx4 v220, s[36:39], s94 offen offset:3072 lds
    v_cvt_pk_bf16_f32 v162, v162, v162
    v_lshlrev_b32 v162, 16, v162
    v_cvt_pk_bf16_f32 v163, v163, v163
    v_lshlrev_b32 v163, 16, v163
    v_add_f32 v163, 0x3727c5ac, v163
    s_lshl_b32 s93, s43, 1
    s_add_u32 s93, s51, s93
    s_and_b32 s93, s93, 15
    s_add_u32 m0, s62, 32768
    s_lshl_b32 s93, s93, 17
    buffer_load_dwordx4 v203, s[12:15], s93 offen lds
    v_cvt_pk_bf16_f32 v163, v163, v163
    v_lshlrev_b32 v163, 16, v163
    v_sqrt_f32 v163, v163
    s_nop 0
    buffer_load_dwordx4 v204, s[12:15], s93 offen offset:1024 lds
    v_cvt_pk_bf16_f32 v163, v163, v163
    v_lshlrev_b32 v163, 16, v163
    v_rcp_f32 v163, v163
    s_nop 0
    v_lshrrev_b32 v226, 1, v226
    s_lshl_b32 s55, s42, 7
    s_add_u32 s55, s55, 159808
    v_add_u32 v226, s55, v226
    v_sub_f32 v160, 0, v160
    v_sub_f32 v162, 0, v162
    s_mov_b64 exec, 0xffff
    ds_write2_b32 v226, v160, v162 offset0:0 offset1:1
    ds_write2_b32 v226, v161, v163 offset0:144 offset1:145
    s_mov_b64 exec, -1
    buffer_load_dwordx4 v205, s[12:15], s93 offen offset:2048 lds
    v_add_f32 v164, v164, v168
    v_add_f32 v165, v165, v169
    v_add_f32 v166, v166, v170
    v_add_f32 v167, v167, v171
    buffer_load_dwordx4 v206, s[12:15], s93 offen offset:3072 lds
    s_add_u32 s93, s93, 524288
    s_and_b32 s93, s93, 2097151
    s_nop 1
    v_add_f32_dpp v164, v164, v164 row_ror:8 row_mask:0xf bank_mask:0xf
    v_add_f32_dpp v165, v165, v165 row_ror:8 row_mask:0xf bank_mask:0xf
    v_add_f32_dpp v166, v166, v166 row_ror:8 row_mask:0xf bank_mask:0xf
    v_add_f32_dpp v167, v167, v167 row_ror:8 row_mask:0xf bank_mask:0xf
    s_waitcnt vmcnt(15)
    s_barrier
    s_add_u32 m0, s62, 49152
    s_nop 0
    buffer_load_dwordx4 v203, s[12:15], s93 offen lds
    v_mov_b32 v168, v164
    v_mov_b32 v169, v165
    v_mov_b32 v170, v166
    v_mov_b32 v171, v167
    s_nop 1
    v_permlane16_swap_b32 v164, v168
    buffer_load_dwordx4 v204, s[12:15], s93 offen offset:1024 lds
    v_permlane16_swap_b32 v165, v169
    v_permlane16_swap_b32 v166, v170
    v_permlane16_swap_b32 v167, v171
    v_add_f32 v164, v164, v168
    v_add_f32 v165, v165, v169
    v_add_f32 v166, v166, v170
    v_add_f32 v167, v167, v171
    buffer_load_dwordx4 v205, s[12:15], s93 offen offset:2048 lds
    v_mov_b32 v168, v164
    v_mov_b32 v169, v165
    v_mov_b32 v170, v166
    v_mov_b32 v171, v167
    s_nop 1
    v_permlane32_swap_b32 v164, v168
    buffer_load_dwordx4 v206, s[12:15], s93 offen offset:3072 lds
    s_add_u32 s93, s93, 524288
    s_and_b32 s93, s93, 2097151
    v_permlane32_swap_b32 v165, v169
    v_permlane32_swap_b32 v166, v170
    v_permlane32_swap_b32 v167, v171
    v_add_f32 v164, v164, v168
    v_add_f32 v165, v165, v169
    v_add_f32 v166, v166, v170
    v_add_f32 v167, v167, v171
    buffer_load_dwordx4 v[48:51], v96, s[72:75], s76 offen
    s_add_u32 s76, s76, 57344
    s_barrier
    s_add_u32 m0, s62, 65536
    s_nop 0
    buffer_load_dwordx4 v203, s[12:15], s93 offen lds
    v_mul_f32 v164, 0x3a800000, v164
    v_mul_f32 v165, 0x3a800000, v165
    v_fma_f32 v165, -v164, v164, v165
    v_max_f32 v165, 0, v165
    v_cvt_pk_bf16_f32 v164, v164, v164
    v_lshlrev_b32 v164, 16, v164
    v_cvt_pk_bf16_f32 v165, v165, v165
    v_lshlrev_b32 v165, 16, v165
    v_add_f32 v165, 0x3727c5ac, v165
    buffer_load_dwordx4 v204, s[12:15], s93 offen offset:1024 lds
    v_cvt_pk_bf16_f32 v165, v165, v165
    v_lshlrev_b32 v165, 16, v165
    v_sqrt_f32 v165, v165
    s_nop 0
    v_cvt_pk_bf16_f32 v165, v165, v165
    v_lshlrev_b32 v165, 16, v165
    v_rcp_f32 v165, v165
    s_nop 0
    v_mul_f32 v166, 0x3a800000, v166
    v_mul_f32 v167, 0x3a800000, v167
    buffer_load_dwordx4 v205, s[12:15], s93 offen offset:2048 lds
    v_fma_f32 v167, -v166, v166, v167
    v_max_f32 v167, 0, v167
    v_cvt_pk_bf16_f32 v166, v166, v166
    v_lshlrev_b32 v166, 16, v166
    v_cvt_pk_bf16_f32 v167, v167, v167
    v_lshlrev_b32 v167, 16, v167
    v_add_f32 v167, 0x3727c5ac, v167
    v_cvt_pk_bf16_f32 v167, v167, v167
    v_lshlrev_b32 v167, 16, v167
    v_sqrt_f32 v167, v167
    buffer_load_dwordx4 v206, s[12:15], s93 offen offset:3072 lds
    s_add_u32 s93, s93, 524288
    s_and_b32 s93, s93, 2097151
    s_nop 0
    v_cvt_pk_bf16_f32 v167, v167, v167
    v_lshlrev_b32 v167, 16, v167
    v_rcp_f32 v167, v167
    s_nop 0
    v_lshrrev_b32 v175, 1, v175
    v_add_u32 v175, 159744, v175
    v_sub_f32 v164, 0, v164
    v_sub_f32 v166, 0, v166
    s_lshl_b32 s55, s42, 1
    s_lshl_b64 exec, 3, s55
    ds_write2_b32 v175, v164, v166 offset0:0 offset1:1
    ds_write2_b32 v175, v165, v167 offset0:144 offset1:145
    s_mov_b64 exec, -1
    buffer_load_dwordx4 v[52:55], v96, s[72:75], s76 offen
    s_add_u32 s76, s76, 57344
    s_waitcnt vmcnt(14)
    s_barrier
    s_add_u32 m0, s62, 81920
    s_nop 0
    buffer_load_dwordx4 v203, s[12:15], s93 offen lds
    v_add_f32 v76, v76, v80
    v_add_f32 v77, v77, v81
    v_add_f32 v78, v78, v82
    v_add_f32 v79, v79, v83
    v_add_f32 v84, v84, v88
    v_add_f32 v85, v85, v89
    buffer_load_dwordx4 v204, s[12:15], s93 offen offset:1024 lds
    v_add_f32 v86, v86, v90
    v_add_f32 v87, v87, v91
    v_add_f32 v76, v76, v84
    v_add_f32 v77, v77, v85
    v_add_f32 v78, v78, v86
    v_add_f32 v79, v79, v87
    buffer_load_dwordx4 v205, s[12:15], s93 offen offset:2048 lds
    v_mov_b32 v80, v76
    v_mov_b32 v81, v77
    v_mov_b32 v82, v78
    v_mov_b32 v83, v79
    s_nop 1
    v_permlane16_swap_b32 v76, v80
    buffer_load_dwordx4 v206, s[12:15], s93 offen offset:3072 lds
    s_add_u32 s93, s93, 655360
    s_and_b32 s93, s93, 2097151
    v_permlane16_swap_b32 v77, v81
    v_permlane16_swap_b32 v78, v82
    v_permlane16_swap_b32 v79, v83
    v_add_f32 v76, v76, v80
    v_add_f32 v77, v77, v81
    v_add_f32 v78, v78, v82
    v_add_f32 v79, v79, v83
    buffer_load_dwordx4 v[56:59], v96, s[72:75], s76 offen
    s_add_u32 s76, s76, 57344
    s_barrier
    s_add_u32 m0, s62, 0
    s_nop 0
    buffer_load_dwordx4 v203, s[12:15], s93 offen lds
    v_mov_b32 v80, v76
    v_mov_b32 v81, v77
    v_mov_b32 v82, v78
    buffer_load_dwordx4 v204, s[12:15], s93 offen offset:1024 lds
    v_mov_b32 v83, v79
    s_nop 1
    v_permlane32_swap_b32 v76, v80
    v_permlane32_swap_b32 v77, v81
    buffer_load_dwordx4 v205, s[12:15], s93 offen offset:2048 lds
    v_permlane32_swap_b32 v78, v82
    v_permlane32_swap_b32 v79, v83
    v_add_f32 v76, v76, v80
    v_add_f32 v77, v77, v81
    buffer_load_dwordx4 v206, s[12:15], s93 offen offset:3072 lds
    s_add_u32 s93, s93, 524288
    s_and_b32 s93, s93, 2097151
    v_add_f32 v78, v78, v82
    v_add_f32 v79, v79, v83
    v_add_u32 v173, 160896, v173
    s_mov_b64 exec, 0xfff
    ds_write_b128 v173, v[76:79]
    s_mov_b64 exec, -1
    buffer_load_dwordx4 v[60:63], v96, s[72:75], s76 offen
    s_add_u32 s76, s76, 57344
    s_waitcnt lgkmcnt(0)
    s_barrier
    s_add_u32 m0, s62, 16384
    s_nop 0
    buffer_load_dwordx4 v203, s[12:15], s93 offen lds
    buffer_load_dwordx4 v204, s[12:15], s93 offen offset:1024 lds
    buffer_load_dwordx4 v205, s[12:15], s93 offen offset:2048 lds
    buffer_load_dwordx4 v206, s[12:15], s93 offen offset:3072 lds
    s_add_u32 s93, s93, 524288
    s_and_b32 s93, s93, 2097151
    buffer_store_dwordx4 v[64:67], v254, s[4:7], s90 offen sc0 sc1
    s_add_u32 s90, s90, 65536
    buffer_store_dwordx4 v[68:71], v254, s[4:7], s90 offen sc0 sc1
    s_add_u32 s90, s90, 65536
    s_setprio 0
    s_branch Y_g2
Y_layer:
    s_mov_b32 s36, s4
    s_mov_b32 s37, s5
    s_mov_b32 s38, s6
    s_mov_b32 s39, s7
    s_add_u32 s88, s48, s62
    s_lshl_b32 s56, s43, 10
    s_add_u32 s89, s48, s56
    s_sub_u32 s89, s89, 4179968
    v_add_u32 v217, s88, v254
    s_lshl_b32 s94, s51, 14
    s_cmp_eq_u32 s40, 0
    s_cselect_b32 s89, 2130706432, s89
    s_sub_u32 s89, s89, s88
    v_add_u32 v221, s89, v217
    s_lshl_b32 s91, s43, 10
    s_cmp_eq_u32 s44, 0
    s_cselect_b32 s84, -1, 0
    s_not_b32 s85, s84
    s_add_u32 s59, s0, 4294967232
    s_add_u32 s60, s54, 8064
    s_and_b32 s55, s40, 3
    s_cselect_b32 s59, s59, s60
    s_cselect_b32 s60, 28, 60
    s_add_u32 s55, s0, 64
    s_cmp_eq_u32 s40, 0
    s_cselect_b32 s59, s55, s59
    s_cselect_b32 s60, 28, s60
    v_lshrrev_b32 v224, 2, v254
    v_and_b32 v224, 60, v224
    v_min_u32 v225, s60, v224
    v_add_u32 v225, s59, v225
    v_min_u32 v224, 28, v224
    v_add_u32 v224, s55, v224
    v_cmp_gt_u32 vcc, 256, v254
    v_lshlrev_b32 v226, 3, v254
    v_and_b32 v226, 0xfff, v226
    v_cndmask_b32 v224, v225, v224, vcc
    s_add_u32 s92, s88, s94
    s_barrier
    buffer_load_dword v251, v226, s[4:7], s92 offen sc0 sc1
    s_mov_b32 s56, 262144
poll_54:
    buffer_load_dword v225, v224, s[4:7], 0 offen sc0 sc1
    s_waitcnt vmcnt(0)
    v_cmp_ne_u32 vcc, 0x01010101, v225
    s_cbranch_vccz pd_55
    s_sleep 1
    s_sub_u32 s56, s56, 1
    s_cmp_lg_u32 s56, 0
    s_cbranch_scc1 poll_54
pd_55:
    s_add_u32 m0, s91, 98304
    s_mov_b64 exec, s[84:85]
    buffer_load_dwordx4 v221, s[36:39], s94 offen lds
    s_mov_b64 exec, -1
    s_add_u32 m0, s62, 100352
    s_nop 0
    buffer_load_dwordx4 v217, s[36:39], s94 offen lds
    buffer_load_dwordx4 v217, s[36:39], s94 offen offset:1024 lds
    buffer_load_dwordx4 v217, s[36:39], s94 offen offset:2048 lds
    buffer_load_dwordx4 v217, s[36:39], s94 offen offset:3072 lds
    s_add_u32 s94, s94, 32768
    s_and_b32 s94, s94, 262143
    s_add_u32 m0, s91, 116736
    s_mov_b64 exec, s[84:85]
    buffer_load_dwordx4 v221, s[36:39], s94 offen lds
    s_mov_b64 exec, -1
    s_add_u32 m0, s62, 118784
    s_nop 0
    buffer_load_dwordx4 v217, s[36:39], s94 offen lds
    buffer_load_dwordx4 v217, s[36:39], s94 offen offset:1024 lds
    buffer_load_dwordx4 v217, s[36:39], s94 offen offset:2048 lds
    buffer_load_dwordx4 v217, s[36:39], s94 offen offset:3072 lds
    s_add_u32 s94, s94, 32768
    s_and_b32 s94, s94, 262143
    s_add_u32 m0, s91, 135168
    s_mov_b64 exec, s[84:85]
    buffer_load_dwordx4 v221, s[36:39], s94 offen lds
    s_mov_b64 exec, -1
    s_add_u32 m0, s62, 137216
    s_nop 0
    buffer_load_dwordx4 v217, s[36:39], s94 offen lds
    buffer_load_dwordx4 v217, s[36:39], s94 offen offset:1024 lds
    buffer_load_dwordx4 v217, s[36:39], s94 offen offset:2048 lds
    buffer_load_dwordx4 v217, s[36:39], s94 offen offset:3072 lds
    s_add_u32 s94, s94, 32768
    s_and_b32 s94, s94, 262143
    s_setprio 1
    s_waitcnt vmcnt(10)
    s_barrier
    s_barrier
    s_add_u32 m0, s61, 0
    s_mul_i32 s59, s93, 96
    buffer_load_dwordx4 v200, s[8:11], s59 offen lds
    buffer_load_dwordx4 v201, s[8:11], s59 offen offset:1024 lds
    buffer_load_dwordx4 v202, s[8:11], s59 offen offset:2048 lds
    s_add_u32 s93, s93, 2048
    s_and_b32 s93, s93, 65535
    s_waitcnt vmcnt(8)
    s_barrier
    s_add_u32 m0, s91, 98304
    s_mov_b64 exec, s[84:85]
    buffer_load_dwordx4 v221, s[36:39], s94 offen lds
    s_mov_b64 exec, -1
    s_add_u32 m0, s62, 100352
    s_nop 0
    buffer_load_dwordx4 v217, s[36:39], s94 offen lds
    buffer_load_dwordx4 v217, s[36:39], s94 offen offset:1024 lds
    s_add_u32 m0, s61, 16384
    s_mul_i32 s59, s93, 96
    buffer_load_dwordx4 v200, s[8:11], s59 offen lds
    buffer_load_dwordx4 v201, s[8:11], s59 offen offset:1024 lds
    buffer_load_dwordx4 v202, s[8:11], s59 offen offset:2048 lds
    s_add_u32 s93, s93, 6144
    s_and_b32 s93, s93, 65535
    s_barrier
    s_add_u32 m0, s62, 100352
    s_nop 0
    buffer_load_dwordx4 v217, s[36:39], s94 offen offset:2048 lds
    buffer_load_dwordx4 v217, s[36:39], s94 offen offset:3072 lds
    s_add_u32 s94, s94, 32768
    s_and_b32 s94, s94, 262143
    s_add_u32 m0, s61, 32768
    s_mul_i32 s59, s93, 96
    buffer_load_dwordx4 v200, s[8:11], s59 offen lds
    buffer_load_dwordx4 v201, s[8:11], s59 offen offset:1024 lds
    buffer_load_dwordx4 v202, s[8:11], s59 offen offset:2048 lds
    s_add_u32 s93, s93, 2048
    s_and_b32 s93, s93, 65535
    s_cmp_lg_u32 s42, 0
    s_cbranch_scc1 wf_56
    s_lshl_b32 s55, s51, 2
    s_add_u32 s55, s55, s54
    v_mov_b32 v252, 14336
    v_mov_b32 v253, 0x01010101
    s_mov_b64 exec, 1
    buffer_store_dword v253, v252, s[4:7], s55 offen sc0 sc1
    s_mov_b64 exec, -1
wf_56:
    s_waitcnt vmcnt(14)
    s_barrier
    s_add_u32 m0, s91, 116736
    s_mov_b64 exec, s[84:85]
    buffer_load_dwordx4 v221, s[36:39], s94 offen lds
    s_mov_b64 exec, -1
    s_add_u32 m0, s62, 118784
    s_nop 0
    buffer_load_dwordx4 v217, s[36:39], s94 offen lds
    buffer_load_dwordx4 v217, s[36:39], s94 offen offset:1024 lds
    s_add_u32 m0, s61, 49152
    s_mul_i32 s59, s93, 96
    buffer_load_dwordx4 v200, s[8:11], s59 offen lds
    buffer_load_dwordx4 v201, s[8:11], s59 offen offset:1024 lds
    buffer_load_dwordx4 v202, s[8:11], s59 offen offset:2048 lds
    s_add_u32 s93, s93, 6144
    s_and_b32 s93, s93, 65535
    s_barrier
    s_add_u32 m0, s62, 118784
    s_nop 0
    buffer_load_dwordx4 v217, s[36:39], s94 offen offset:2048 lds
    buffer_load_dwordx4 v217, s[36:39], s94 offen offset:3072 lds
    s_add_u32 s94, s94, 32768
    s_and_b32 s94, s94, 262143
    s_add_u32 m0, s61, 65536
    s_mul_i32 s59, s93, 96
    buffer_load_dwordx4 v200, s[8:11], s59 offen lds
    buffer_load_dwordx4 v201, s[8:11], s59 offen offset:1024 lds
    buffer_load_dwordx4 v202, s[8:11], s59 offen offset:2048 lds
    s_add_u32 s93, s93, 2048
    s_and_b32 s93, s93, 65535
    s_waitcnt vmcnt(14)
    s_barrier
    s_add_u32 m0, s91, 135168
    s_mov_b64 exec, s[84:85]
    buffer_load_dwordx4 v221, s[36:39], s94 offen lds
    s_mov_b64 exec, -1
    s_add_u32 m0, s62, 137216
    s_nop 0
    buffer_load_dwordx4 v217, s[36:39], s94 offen lds
    buffer_load_dwordx4 v217, s[36:39], s94 offen offset:1024 lds
    s_add_u32 m0, s61, 81920
    s_mul_i32 s59, s93, 96
    buffer_load_dwordx4 v200, s[8:11], s59 offen lds
    buffer_load_dwordx4 v201, s[8:11], s59 offen offset:1024 lds
    buffer_load_dwordx4 v202, s[8:11], s59 offen offset:2048 lds
    s_add_u32 s93, s93, 6144
    s_and_b32 s93, s93, 65535
    s_barrier
    s_add_u32 m0, s62, 137216
    s_nop 0
    buffer_load_dwordx4 v217, s[36:39], s94 offen offset:2048 lds
    buffer_load_dwordx4 v217, s[36:39], s94 offen offset:3072 lds
    s_add_u32 s94, s94, 32768
    s_and_b32 s94, s94, 262143
    s_add_u32 m0, s61, 0
    s_mul_i32 s59, s93, 96
    buffer_load_dwordx4 v200, s[8:11], s59 offen lds
    buffer_load_dwordx4 v201, s[8:11], s59 offen offset:1024 lds
    buffer_load_dwordx4 v202, s[8:11], s59 offen offset:2048 lds
    s_add_u32 s93, s93, 2048
    s_and_b32 s93, s93, 65535
    s_waitcnt vmcnt(14)
    s_barrier
    v_lshrrev_b32 v224, 2, v254
    v_and_b32 v225, 64, v224
    v_and_b32 v224, 60, v224
    s_cmp_eq_u32 s40, 0
    s_cselect_b32 s55, 0, 2
    v_mul_lo_u32 v225, v225, s55
    v_sub_u32 v98, v224, v225
    v_add_u32 v98, 14336, v98
    buffer_load_dword v251, v98, s[4:7], s54 offen sc0 sc1
    s_add_u32 m0, s91, 98304
    s_mov_b64 exec, s[84:85]
    buffer_load_dwordx4 v221, s[36:39], s94 offen lds
    s_mov_b64 exec, -1
    s_add_u32 m0, s62, 100352
    s_nop 0
    buffer_load_dwordx4 v217, s[36:39], s94 offen lds
    buffer_load_dwordx4 v217, s[36:39], s94 offen offset:1024 lds
    s_add_u32 m0, s61, 16384
    s_mul_i32 s59, s93, 96
    buffer_load_dwordx4 v200, s[8:11], s59 offen lds
    buffer_load_dwordx4 v201, s[8:11], s59 offen offset:1024 lds
    buffer_load_dwordx4 v202, s[8:11], s59 offen offset:2048 lds
    s_add_u32 s93, s93, 6144
    s_and_b32 s93, s93, 65535
    s_barrier
    s_add_u32 m0, s62, 100352
    s_nop 0
    buffer_load_dwordx4 v217, s[36:39], s94 offen offset:2048 lds
    buffer_load_dwordx4 v217, s[36:39], s94 offen offset:3072 lds
    s_add_u32 s94, s94, 32768
    s_and_b32 s94, s94, 262143
    s_add_u32 m0, s61, 32768
    s_mul_i32 s59, s93, 96
    buffer_load_dwordx4 v200, s[8:11], s59 offen lds
    buffer_load_dwordx4 v201, s[8:11], s59 offen offset:1024 lds
    buffer_load_dwordx4 v202, s[8:11], s59 offen offset:2048 lds
    s_add_u32 s93, s93, 2048
    s_and_b32 s93, s93, 65535
    s_waitcnt vmcnt(15)
    s_barrier
    s_add_u32 m0, s91, 116736
    s_mov_b64 exec, s[84:85]
    buffer_load_dwordx4 v221, s[36:39], s94 offen lds
    s_mov_b64 exec, -1
    s_add_u32 m0, s62, 118784
    s_nop 0
    buffer_load_dwordx4 v217, s[36:39], s94 offen lds
    buffer_load_dwordx4 v217, s[36:39], s94 offen offset:1024 lds
    s_add_u32 m0, s61, 49152
    s_mul_i32 s59, s93, 96
    buffer_load_dwordx4 v200, s[8:11], s59 offen lds
    buffer_load_dwordx4 v201, s[8:11], s59 offen offset:1024 lds
    buffer_load_dwordx4 v202, s[8:11], s59 offen offset:2048 lds
    s_add_u32 s93, s93, 10240
    s_and_b32 s93, s93, 65535
    s_barrier
    s_waitcnt vmcnt(17)
    s_mov_b32 s56, 262144
poll_57:
    v_cmp_ne_u32 vcc, 0x01010101, v251
    s_cbranch_vccz pd_58
    buffer_load_dword v251, v98, s[4:7], s54 offen sc0 sc1
    s_waitcnt vmcnt(0)
    s_sub_u32 s56, s56, 1
    s_cmp_lg_u32 s56, 0
    s_cbranch_scc1 poll_57
pd_58:
    s_add_u32 m0, s62, 118784
    s_nop 0
    buffer_load_dwordx4 v217, s[36:39], s94 offen offset:2048 lds
    buffer_load_dwordx4 v217, s[36:39], s94 offen offset:3072 lds
    s_add_u32 s94, s94, 49152
    s_and_b32 s94, s94, 262143
    s_add_u32 m0, s61, 65536
    s_mul_i32 s59, s93, 96
    buffer_load_dwordx4 v200, s[8:11], s59 offen lds
    buffer_load_dwordx4 v201, s[8:11], s59 offen offset:1024 lds
    buffer_load_dwordx4 v202, s[8:11], s59 offen offset:2048 lds
    s_add_u32 s93, s93, 2048
    s_and_b32 s93, s93, 65535
    s_waitcnt vmcnt(14)
    s_barrier
    s_add_u32 m0, s91, 135168
    s_mov_b64 exec, s[84:85]
    buffer_load_dwordx4 v221, s[36:39], s94 offen lds
    s_mov_b64 exec, -1
    s_add_u32 m0, s62, 137216
    s_nop 0
    buffer_load_dwordx4 v217, s[36:39], s94 offen lds
    buffer_load_dwordx4 v217, s[36:39], s94 offen offset:1024 lds
    v_and_b32 v226, 0xf0, v254
    v_and_b32 v227, 0x300, v254
    v_lshl_add_u32 v227, v227, 2, v226
    s_lshl_b32 s78, s42, 8
    s_add_u32 s78, s78, s53
    s_add_u32 m0, s61, 81920
    s_mul_i32 s59, s93, 96
    buffer_load_dwordx4 v200, s[8:11], s59 offen lds
    buffer_load_dwordx4 v201, s[8:11], s59 offen offset:1024 lds
    buffer_load_dwordx4 v202, s[8:11], s59 offen offset:2048 lds
    s_add_u32 s93, s93, 6144
    s_and_b32 s93, s93, 65535
    buffer_load_dwordx4 v[144:147], v227, s[4:7], s78 offen
    s_add_u32 s78, s78, 4096
    s_barrier
    s_add_u32 m0, s62, 137216
    s_nop 0
    buffer_load_dwordx4 v217, s[36:39], s94 offen offset:2048 lds
    buffer_load_dwordx4 v217, s[36:39], s94 offen offset:3072 lds
    s_add_u32 s94, s94, 32768
    s_and_b32 s94, s94, 262143
    s_add_u32 m0, s61, 0
    s_mul_i32 s59, s93, 96
    buffer_load_dwordx4 v200, s[8:11], s59 offen lds
    buffer_load_dwordx4 v201, s[8:11], s59 offen offset:1024 lds
    buffer_load_dwordx4 v202, s[8:11], s59 offen offset:2048 lds
    s_add_u32 s93, s93, 2048
    s_and_b32 s93, s93, 65535
    buffer_load_dwordx4 v[148:151], v227, s[4:7], s78 offen
    s_add_u32 s78, s78, 4096
    s_waitcnt vmcnt(16)
    s_barrier
    s_add_u32 m0, s91, 98304
    s_mov_b64 exec, s[84:85]
    buffer_load_dwordx4 v221, s[36:39], s94 offen lds
    s_mov_b64 exec, -1
    s_add_u32 m0, s62, 100352
    s_nop 0
    buffer_load_dwordx4 v217, s[36:39], s94 offen lds
    buffer_load_dwordx4 v217, s[36:39], s94 offen offset:1024 lds
    s_add_u32 m0, s61, 16384
    s_mul_i32 s59, s93, 96
    buffer_load_dwordx4 v200, s[8:11], s59 offen lds
    buffer_load_dwordx4 v201, s[8:11], s59 offen offset:1024 lds
    buffer_load_dwordx4 v202, s[8:11], s59 offen offset:2048 lds
    s_add_u32 s93, s93, 6144
    s_and_b32 s93, s93, 65535
    buffer_load_dwordx4 v[152:155], v227, s[4:7], s78 offen
    s_add_u32 s78, s78, 4096
    s_barrier
    s_add_u32 m0, s62, 100352
    s_nop 0
    buffer_load_dwordx4 v217, s[36:39], s94 offen offset:2048 lds
    buffer_load_dwordx4 v217, s[36:39], s94 offen offset:3072 lds
    s_add_u32 s94, s94, 32768
    s_and_b32 s94, s94, 262143
    s_add_u32 m0, s61, 32768
    s_mul_i32 s59, s93, 96
    buffer_load_dwordx4 v200, s[8:11], s59 offen lds
    buffer_load_dwordx4 v201, s[8:11], s59 offen offset:1024 lds
    buffer_load_dwordx4 v202, s[8:11], s59 offen offset:2048 lds
    s_add_u32 s93, s93, 2048
    s_and_b32 s93, s93, 65535
    buffer_load_dwordx4 v[156:159], v227, s[4:7], s78 offen
    s_add_u32 s78, s78, 4096
    s_waitcnt vmcnt(17)
    s_barrier
    s_add_u32 m0, s91, 116736
    s_mov_b64 exec, s[84:85]
    buffer_load_dwordx4 v221, s[36:39], s94 offen lds
    s_mov_b64 exec, -1
    s_add_u32 m0, s62, 118784
    s_nop 0
    buffer_load_dwordx4 v217, s[36:39], s94 offen lds
    buffer_load_dwordx4 v217, s[36:39], s94 offen offset:1024 lds
    s_add_u32 m0, s61, 49152
    s_mul_i32 s59, s93, 96
    buffer_load_dwordx4 v200, s[8:11], s59 offen lds
    buffer_load_dwordx4 v201, s[8:11], s59 offen offset:1024 lds
    buffer_load_dwordx4 v202, s[8:11], s59 offen offset:2048 lds
    s_add_u32 s93, s93, 6144
    s_and_b32 s93, s93, 65535
    s_barrier
    s_add_u32 m0, s62, 118784
    s_nop 0
    buffer_load_dwordx4 v217, s[36:39], s94 offen offset:2048 lds
    buffer_load_dwordx4 v217, s[36:39], s94 offen offset:3072 lds
    s_add_u32 s94, s94, 32768
    s_and_b32 s94, s94, 262143
    v_lshrrev_b32 v224, 7, v254
    v_and_b32 v175, 0x70, v254
    v_lshl_add_u32 v224, v224, 10, v175
    s_sub_u32 s70, s53, 4193408
    s_cmp_eq_u32 s40, 0
    s_cselect_b32 s70, 2130706432, s70
    s_add_u32 m0, s61, 65536
    s_mul_i32 s59, s93, 96
    buffer_load_dwordx4 v200, s[8:11], s59 offen lds
    buffer_load_dwordx4 v201, s[8:11], s59 offen offset:1024 lds
    buffer_load_dwordx4 v[164:167], v224, s[4:7], s70 offen
    s_add_u32 s70, s70, 8192
    buffer_load_dwordx4 v202, s[8:11], s59 offen offset:2048 lds
    s_add_u32 s93, s93, 2048
    s_and_b32 s93, s93, 65535
    buffer_load_dwordx4 v[168:171], v224, s[4:7], s70 offen
    s_add_u32 s70, s70, 8192
    s_waitcnt vmcnt(17)
    s_barrier
    s_waitcnt vmcnt(13)
    s_add_u32 m0, s91, 135168
    s_mov_b64 exec, s[84:85]
    buffer_load_dwordx4 v221, s[36:39], s94 offen lds
    s_mov_b64 exec, -1
    v_add_f32 v144, v144, v148
    v_add_f32 v145, v145, v149
    v_add_f32 v146, v146, v150
    v_add_f32 v147, v147, v151
    s_add_u32 m0, s62, 137216
    s_nop 0
    buffer_load_dwordx4 v217, s[36:39], s94 offen lds
    v_add_f32 v152, v152, v156
    v_add_f32 v153, v153, v157
    v_add_f32 v154, v154, v158
    v_add_f32 v155, v155, v159
    buffer_load_dwordx4 v217, s[36:39], s94 offen offset:1024 lds
    v_add_f32 v160, v144, v152
    v_add_f32 v161, v145, v153
    v_add_f32 v162, v146, v154
    v_add_f32 v163, v147, v155
    s_add_u32 m0, s61, 81920
    s_mul_i32 s59, s93, 96
    buffer_load_dwordx4 v200, s[8:11], s59 offen lds
    v_mov_b32 v144, v160
    v_mov_b32 v145, v161
    v_mov_b32 v146, v162
    v_mov_b32 v147, v163
    buffer_load_dwordx4 v201, s[8:11], s59 offen offset:1024 lds
    s_nop 1
    v_permlane16_swap_b32 v160, v144
    v_permlane16_swap_b32 v161, v145
    v_permlane16_swap_b32 v162, v146
    buffer_load_dwordx4 v202, s[8:11], s59 offen offset:2048 lds
    s_add_u32 s93, s93, 6144
    s_and_b32 s93, s93, 65535
    v_permlane16_swap_b32 v163, v147
    v_add_f32 v160, v160, v144
    v_add_f32 v161, v161, v145
    v_add_f32 v162, v162, v146
    v_add_f32 v163, v163, v147
    s_barrier
    s_add_u32 m0, s62, 137216
    s_nop 0
    buffer_load_dwordx4 v217, s[36:39], s94 offen offset:2048 lds
    v_mov_b32 v144, v160
    v_mov_b32 v145, v161
    buffer_load_dwordx4 v217, s[36:39], s94 offen offset:3072 lds
    s_add_u32 s94, s94, 32768
    s_and_b32 s94, s94, 262143
    v_mov_b32 v146, v162
    v_mov_b32 v147, v163
    s_nop 1
    s_add_u32 m0, s61, 0
    s_mul_i32 s59, s93, 96
    buffer_load_dwordx4 v200, s[8:11], s59 offen lds
    v_permlane32_swap_b32 v160, v144
    v_permlane32_swap_b32 v161, v145
    buffer_load_dwordx4 v201, s[8:11], s59 offen offset:1024 lds
    v_permlane32_swap_b32 v162, v146
    v_permlane32_swap_b32 v163, v147
    v_add_f32 v160, v160, v144
    buffer_load_dwordx4 v202, s[8:11], s59 offen offset:2048 lds
    s_add_u32 s93, s93, 2048
    s_and_b32 s93, s93, 65535
    v_add_f32 v161, v161, v145
    v_add_f32 v162, v162, v146
    v_add_f32 v163, v163, v147
    s_waitcnt vmcnt(16)
    s_barrier
    s_add_u32 m0, s91, 98304
    s_mov_b64 exec, s[84:85]
    buffer_load_dwordx4 v221, s[36:39], s94 offen lds
    s_mov_b64 exec, -1
    v_mul_f32 v160, 0x3a800000, v160
    v_mul_f32 v161, 0x3a800000, v161
    s_add_u32 m0, s62, 100352
    s_nop 0
    buffer_load_dwordx4 v217, s[36:39], s94 offen lds
    v_fma_f32 v161, -v160, v160, v161
    v_max_f32 v161, 0, v161
    v_cvt_pk_bf16_f32 v160, v160, v160
    buffer_load_dwordx4 v217, s[36:39], s94 offen offset:1024 lds
    v_lshlrev_b32 v160, 16, v160
    v_cvt_pk_bf16_f32 v161, v161, v161
    v_lshlrev_b32 v161, 16, v161
    s_add_u32 m0, s61, 16384
    s_mul_i32 s59, s93, 96
    buffer_load_dwordx4 v200, s[8:11], s59 offen lds
    v_add_f32 v161, 0x3727c5ac, v161
    v_cvt_pk_bf16_f32 v161, v161, v161
    v_lshlrev_b32 v161, 16, v161
    buffer_load_dwordx4 v201, s[8:11], s59 offen offset:1024 lds
    v_sqrt_f32 v161, v161
    s_nop 0
    v_cvt_pk_bf16_f32 v161, v161, v161
    buffer_load_dwordx4 v202, s[8:11], s59 offen offset:2048 lds
    s_add_u32 s93, s93, 6144
    s_and_b32 s93, s93, 65535
    v_lshlrev_b32 v161, 16, v161
    v_rcp_f32 v161, v161
    s_nop 0
    s_barrier
    s_add_u32 m0, s62, 100352
    s_nop 0
    buffer_load_dwordx4 v217, s[36:39], s94 offen offset:2048 lds
    v_mul_f32 v162, 0x3a800000, v162
    v_mul_f32 v163, 0x3a800000, v163
    v_fma_f32 v163, -v162, v162, v163
    buffer_load_dwordx4 v217, s[36:39], s94 offen offset:3072 lds
    s_add_u32 s94, s94, 32768
    s_and_b32 s94, s94, 262143
    v_max_f32 v163, 0, v163
    v_cvt_pk_bf16_f32 v162, v162, v162
    v_lshlrev_b32 v162, 16, v162
    v_cvt_pk_bf16_f32 v163, v163, v163
    s_add_u32 m0, s61, 32768
    s_mul_i32 s59, s93, 96
    buffer_load_dwordx4 v200, s[8:11], s59 offen lds
    v_lshlrev_b32 v163, 16, v163
    v_add_f32 v163, 0x3727c5ac, v163
    v_cvt_pk_bf16_f32 v163, v163, v163
    buffer_load_dwordx4 v201, s[8:11], s59 offen offset:1024 lds
    v_lshlrev_b32 v163, 16, v163
    v_sqrt_f32 v163, v163
    s_nop 0
    v_cvt_pk_bf16_f32 v163, v163, v163
    buffer_load_dwordx4 v202, s[8:11], s59 offen offset:2048 lds
    s_add_u32 s93, s93, 2048
    s_and_b32 s93, s93, 65535
    v_lshlrev_b32 v163, 16, v163
    v_rcp_f32 v163, v163
    s_nop 0
    v_lshrrev_b32 v226, 1, v226
    s_lshl_b32 s55, s42, 7
    s_add_u32 s55, s55, 159808
    v_add_u32 v226, s55, v226
    v_sub_f32 v160, 0, v160
    v_sub_f32 v162, 0, v162
    s_mov_b64 exec, 0xffff
    ds_write2_b32 v226, v160, v162 offset0:0 offset1:1
    ds_write2_b32 v226, v161, v163 offset0:144 offset1:145
    s_mov_b64 exec, -1
    s_waitcnt vmcnt(14)
    s_barrier
    s_add_u32 m0, s91, 116736
    s_mov_b64 exec, s[84:85]
    buffer_load_dwordx4 v221, s[36:39], s94 offen lds
    s_mov_b64 exec, -1
    v_add_f32 v164, v164, v168
    v_add_f32 v165, v165, v169
    v_add_f32 v166, v166, v170
    s_add_u32 m0, s62, 118784
    s_nop 0
    buffer_load_dwordx4 v217, s[36:39], s94 offen lds
    v_add_f32 v167, v167, v171
    s_nop 1
    v_add_f32_dpp v164, v164, v164 row_ror:8 row_mask:0xf bank_mask:0xf
    v_add_f32_dpp v165, v165, v165 row_ror:8 row_mask:0xf bank_mask:0xf
    buffer_load_dwordx4 v217, s[36:39], s94 offen offset:1024 lds
    v_add_f32_dpp v166, v166, v166 row_ror:8 row_mask:0xf bank_mask:0xf
    v_add_f32_dpp v167, v167, v167 row_ror:8 row_mask:0xf bank_mask:0xf
    v_mov_b32 v168, v164
    v_mov_b32 v169, v165
    s_add_u32 m0, s61, 49152
    s_mul_i32 s59, s93, 96
    buffer_load_dwordx4 v200, s[8:11], s59 offen lds
    v_mov_b32 v170, v166
    v_mov_b32 v171, v167
    s_nop 1
    buffer_load_dwordx4 v201, s[8:11], s59 offen offset:1024 lds
    v_permlane16_swap_b32 v164, v168
    v_permlane16_swap_b32 v165, v169
    v_permlane16_swap_b32 v166, v170
    v_permlane16_swap_b32 v167, v171
    buffer_load_dwordx4 v202, s[8:11], s59 offen offset:2048 lds
    s_add_u32 s93, s93, 6144
    s_and_b32 s93, s93, 65535
    v_add_f32 v164, v164, v168
    v_add_f32 v165, v165, v169
    v_add_f32 v166, v166, v170
    v_add_f32 v167, v167, v171
    s_barrier
    s_add_u32 m0, s62, 118784
    s_nop 0
    buffer_load_dwordx4 v217, s[36:39], s94 offen offset:2048 lds
    v_mov_b32 v168, v164
    v_mov_b32 v169, v165
    buffer_load_dwordx4 v217, s[36:39], s94 offen offset:3072 lds
    s_add_u32 s94, s94, 32768
    s_and_b32 s94, s94, 262143
    v_mov_b32 v170, v166
    v_mov_b32 v171, v167
    s_nop 1
    s_add_u32 m0, s61, 65536
    s_mul_i32 s59, s93, 96
    buffer_load_dwordx4 v200, s[8:11], s59 offen lds
    v_permlane32_swap_b32 v164, v168
    v_permlane32_swap_b32 v165, v169
    buffer_load_dwordx4 v201, s[8:11], s59 offen offset:1024 lds
    v_permlane32_swap_b32 v166, v170
    v_permlane32_swap_b32 v167, v171
    v_add_f32 v164, v164, v168
    buffer_load_dwordx4 v202, s[8:11], s59 offen offset:2048 lds
    s_add_u32 s93, s93, 2048
    s_and_b32 s93, s93, 65535
    v_add_f32 v165, v165, v169
    v_add_f32 v166, v166, v170
    v_add_f32 v167, v167, v171
    s_waitcnt vmcnt(14)
    s_barrier
    s_add_u32 m0, s91, 135168
    s_mov_b64 exec, s[84:85]
    buffer_load_dwordx4 v221, s[36:39], s94 offen lds
    s_mov_b64 exec, -1
    v_mul_f32 v164, 0x3a800000, v164
    v_mul_f32 v165, 0x3a800000, v165
    s_add_u32 m0, s62, 137216
    s_nop 0
    buffer_load_dwordx4 v217, s[36:39], s94 offen lds
    v_fma_f32 v165, -v164, v164, v165
    v_max_f32 v165, 0, v165
    v_cvt_pk_bf16_f32 v164, v164, v164
    buffer_load_dwordx4 v217, s[36:39], s94 offen offset:1024 lds
    v_lshlrev_b32 v164, 16, v164
    v_cvt_pk_bf16_f32 v165, v165, v165
    v_lshlrev_b32 v165, 16, v165
    s_add_u32 m0, s61, 81920
    s_mul_i32 s59, s93, 96
    buffer_load_dwordx4 v200, s[8:11], s59 offen lds
    v_add_f32 v165, 0x3727c5ac, v165
    v_cvt_pk_bf16_f32 v165, v165, v165
    v_lshlrev_b32 v165, 16, v165
    buffer_load_dwordx4 v201, s[8:11], s59 offen offset:1024 lds
    v_sqrt_f32 v165, v165
    s_nop 0
    v_cvt_pk_bf16_f32 v165, v165, v165
    buffer_load_dwordx4 v202, s[8:11], s59 offen offset:2048 lds
    s_add_u32 s93, s93, 6144
    s_and_b32 s93, s93, 65535
    v_lshlrev_b32 v165, 16, v165
    v_rcp_f32 v165, v165
    s_nop 0
    s_barrier
    s_add_u32 m0, s62, 137216
    s_nop 0
    buffer_load_dwordx4 v217, s[36:39], s94 offen offset:2048 lds
    v_mul_f32 v166, 0x3a800000, v166
    v_mul_f32 v167, 0x3a800000, v167
    v_fma_f32 v167, -v166, v166, v167
    v_max_f32 v167, 0, v167
    buffer_load_dwordx4 v217, s[36:39], s94 offen offset:3072 lds
    s_add_u32 s94, s94, 32768
    s_and_b32 s94, s94, 262143
    v_cvt_pk_bf16_f32 v166, v166, v166
    v_lshlrev_b32 v166, 16, v166
    v_cvt_pk_bf16_f32 v167, v167, v167
    v_lshlrev_b32 v167, 16, v167
    s_add_u32 m0, s61, 0
    s_mul_i32 s59, s93, 96
    buffer_load_dwordx4 v200, s[8:11], s59 offen lds
    v_add_f32 v167, 0x3727c5ac, v167
    v_cvt_pk_bf16_f32 v167, v167, v167
    v_lshlrev_b32 v167, 16, v167
    v_sqrt_f32 v167, v167
    s_nop 0
    buffer_load_dwordx4 v201, s[8:11], s59 offen offset:1024 lds
    v_cvt_pk_bf16_f32 v167, v167, v167
    v_lshlrev_b32 v167, 16, v167
    v_rcp_f32 v167, v167
    s_nop 0
    buffer_load_dwordx4 v202, s[8:11], s59 offen offset:2048 lds
    s_add_u32 s93, s93, 2048
    s_and_b32 s93, s93, 65535
    v_lshrrev_b32 v175, 1, v175
    v_add_u32 v175, 159744, v175
    v_sub_f32 v164, 0, v164
    v_sub_f32 v166, 0, v166
    s_lshl_b32 s55, s42, 1
    s_lshl_b64 exec, 3, s55
    ds_write2_b32 v175, v164, v166 offset0:0 offset1:1
    ds_write2_b32 v175, v165, v167 offset0:144 offset1:145
    s_mov_b64 exec, -1
    s_waitcnt vmcnt(14)
    s_barrier
    s_add_u32 m0, s91, 98304
    s_mov_b64 exec, s[84:85]
    buffer_load_dwordx4 v221, s[36:39], s94 offen lds
    s_mov_b64 exec, -1
    s_add_u32 m0, s62, 100352
    s_nop 0
    buffer_load_dwordx4 v217, s[36:39], s94 offen lds
    buffer_load_dwordx4 v217, s[36:39], s94 offen offset:1024 lds
    s_add_u32 m0, s61, 16384
    s_mul_i32 s59, s93, 96
    buffer_load_dwordx4 v200, s[8:11], s59 offen lds
    buffer_load_dwordx4 v201, s[8:11], s59 offen offset:1024 lds
    buffer_load_dwordx4 v202, s[8:11], s59 offen offset:2048 lds
    s_barrier
    s_add_u32 m0, s62, 100352
    s_nop 0
    buffer_load_dwordx4 v217, s[36:39], s94 offen offset:2048 lds
    buffer_load_dwordx4 v217, s[36:39], s94 offen offset:3072 lds
    s_lshl_b32 s93, s43, 1
    s_add_u32 s93, s51, s93
    s_and_b32 s93, s93, 15
    s_add_u32 m0, s62, 32768
    s_lshl_b32 s93, s93, 17
    buffer_load_dwordx4 v203, s[12:15], s93 offen lds
    buffer_load_dwordx4 v204, s[12:15], s93 offen offset:1024 lds
    buffer_load_dwordx4 v205, s[12:15], s93 offen offset:2048 lds
    buffer_load_dwordx4 v206, s[12:15], s93 offen offset:3072 lds
    s_add_u32 s93, s93, 524288
    s_and_b32 s93, s93, 2097151
    s_waitcnt vmcnt(15)
    s_barrier
    s_add_u32 m0, s62, 49152
    s_nop 0
    buffer_load_dwordx4 v203, s[12:15], s93 offen lds
    buffer_load_dwordx4 v204, s[12:15], s93 offen offset:1024 lds
    buffer_load_dwordx4 v205, s[12:15], s93 offen offset:2048 lds
    buffer_load_dwordx4 v206, s[12:15], s93 offen offset:3072 lds
    s_add_u32 s93, s93, 524288
    s_and_b32 s93, s93, 2097151
    s_barrier
    s_add_u32 m0, s62, 65536
    s_nop 0
    buffer_load_dwordx4 v203, s[12:15], s93 offen lds
    buffer_load_dwordx4 v204, s[12:15], s93 offen offset:1024 lds
    buffer_load_dwordx4 v205, s[12:15], s93 offen offset:2048 lds
    buffer_load_dwordx4 v206, s[12:15], s93 offen offset:3072 lds
    s_add_u32 s93, s93, 524288
    s_and_b32 s93, s93, 2097151
    s_waitcnt vmcnt(12)
    s_barrier
    s_add_u32 m0, s62, 81920
    s_nop 0
    buffer_load_dwordx4 v203, s[12:15], s93 offen lds
    buffer_load_dwordx4 v204, s[12:15], s93 offen offset:1024 lds
    buffer_load_dwordx4 v205, s[12:15], s93 offen offset:2048 lds
    buffer_load_dwordx4 v206, s[12:15], s93 offen offset:3072 lds
    s_add_u32 s93, s93, 655360
    s_and_b32 s93, s93, 2097151
    s_barrier
    s_add_u32 m0, s62, 0
    s_nop 0
    buffer_load_dwordx4 v203, s[12:15], s93 offen lds
    buffer_load_dwordx4 v204, s[12:15], s93 offen offset:1024 lds
    buffer_load_dwordx4 v205, s[12:15], s93 offen offset:2048 lds
    buffer_load_dwordx4 v206, s[12:15], s93 offen offset:3072 lds
    s_add_u32 s93, s93, 524288
    s_and_b32 s93, s93, 2097151
    s_waitcnt lgkmcnt(0)
    s_barrier
    s_add_u32 m0, s62, 16384
    s_nop 0
    buffer_load_dwordx4 v203, s[12:15], s93 offen lds
    buffer_load_dwordx4 v204, s[12:15], s93 offen offset:1024 lds
    buffer_load_dwordx4 v205, s[12:15], s93 offen offset:2048 lds
    buffer_load_dwordx4 v206, s[12:15], s93 offen offset:3072 lds
    s_add_u32 s93, s93, 524288
    s_and_b32 s93, s93, 2097151
    s_setprio 0
Y_g2:
    v_lshlrev_b32 v224, 7, v254
    s_lshl_b32 s55, s44, 19
    s_add_u32 s55, s55, s93
    s_and_b32 s55, s55, 2097151
    s_add_u32 s55, s55, s63
    buffer_load_dword v251, v224, s[12:15], s55 offen
    v_mov_b32 v112, -1
    v_mov_b32 v113, -1
    v_mov_b32 v114, -1
    v_mov_b32 v115, -1
    s_lshl_b32 s94, s51, 14
    s_add_u32 s88, s47, s62
    v_add_u32 v217, s88, v254
    s_add_u32 s55, s88, s94
    s_add_u32 s55, s55, 1310720
    buffer_store_dwordx4 v[112:115], v254, s[4:7], s55 offen offset:0 sc0 sc1
    buffer_store_dwordx4 v[112:115], v254, s[4:7], s55 offen offset:1024 sc0 sc1
    buffer_store_dwordx4 v[112:115], v254, s[4:7], s55 offen offset:2048 sc0 sc1
    buffer_store_dwordx4 v[112:115], v254, s[4:7], s55 offen offset:3072 sc0 sc1
    s_cmp_lg_u32 s46, 0
    s_cbranch_scc1 cp_59
    v_and_b32 v225, 0xf0, v254
    v_lshrrev_b32 v224, 8, v254
    v_lshlrev_b32 v226, 5, v224
    v_xor_b32 v225, v225, v226
    v_mul_u32_u24 v224, 7168, v224
    v_add_u32 v224, s65, v224
    v_add_u32 v207, v224, v225
    v_xor_b32 v225, 0x80, v225
    v_add_u32 v224, v224, v225
    v_add_u32 v208, 27648, v224
    v_add_u32 v209, 55296, v207
    v_add_u32 v210, 55296, v208
    v_lshrrev_b32 v224, 7, v254
    v_and_b32 v225, 0x70, v254
    v_and_b32 v226, 6, v224
    v_lshlrev_b32 v226, 4, v226
    v_xor_b32 v225, v225, v226
    v_mul_u32_u24 v224, 7168, v224
    v_add3_u32 v211, v224, v225, s66
    v_add_u32 v212, 56320, v211
    v_add_u32 v222, s67, v254
    v_and_b32 v225, 0xf0, v254
    v_lshrrev_b32 v224, 8, v254
    v_lshlrev_b32 v226, 5, v224
    v_xor_b32 v225, v225, v226
    v_mul_u32_u24 v224, 2048, v224
    v_add_u32 v213, v224, v225
    v_xor_b32 v225, 0x80, v225
    v_add_u32 v224, v224, v225
    v_add_u32 v214, 7168, v224
    v_add_u32 v215, 14336, v213
    v_add_u32 v216, 14336, v214
    s_lshl_b32 s60, s43, 23
    s_add_u32 s60, s60, 83886336
    s_mov_b32 s28, s16
    s_mov_b32 s29, s17
    s_mov_b32 s30, s18
    s_mov_b32 s31, s19
    s_lshl_b32 s60, s43, 23
    s_add_u32 s60, s60, 83886336
    s_mov_b32 s24, s16
    s_mov_b32 s25, s17
    s_mov_b32 s26, s18
    s_mov_b32 s27, s19
cp_59:
    s_barrier
    s_add_u32 m0, s62, 98304
    s_nop 0
    buffer_load_dwordx4 v217, s[4:7], s94 offen lds
    buffer_load_dwordx4 v217, s[4:7], s94 offen offset:1024 lds
    buffer_load_dwordx4 v217, s[4:7], s94 offen offset:2048 lds
    buffer_load_dwordx4 v217, s[4:7], s94 offen offset:3072 lds
    s_add_u32 s94, s94, 32768
    s_and_b32 s94, s94, 262143
    s_waitcnt vmcnt(0)
    s_barrier
    v_lshrrev_b32 v252, 2, v254
    v_min_u32 v252, 28, v252
    s_add_u32 s55, s0, 0
    s_mov_b32 s56, 262144
poll_60:
    buffer_load_dword v253, v252, s[4:7], s55 offen sc0 sc1
    s_waitcnt vmcnt(0)
    v_cmp_ne_u32 vcc, 0x01010101, v253
    s_cbranch_vccz pd_61
    s_sleep 1
    s_sub_u32 s56, s56, 1
    s_cmp_lg_u32 s56, 0
    s_cbranch_scc1 poll_60
pd_61:
    s_add_u32 m0, s62, 114688
    s_nop 0
    buffer_load_dwordx4 v217, s[4:7], s94 offen lds
    buffer_load_dwordx4 v217, s[4:7], s94 offen offset:1024 lds
    buffer_load_dwordx4 v217, s[4:7], s94 offen offset:2048 lds
    buffer_load_dwordx4 v217, s[4:7], s94 offen offset:3072 lds
    s_add_u32 s94, s94, 32768
    s_and_b32 s94, s94, 262143
    s_add_u32 m0, s62, 131072
    s_nop 0
    buffer_load_dwordx4 v217, s[4:7], s94 offen lds
    buffer_load_dwordx4 v217, s[4:7], s94 offen offset:1024 lds
    buffer_load_dwordx4 v217, s[4:7], s94 offen offset:2048 lds
    buffer_load_dwordx4 v217, s[4:7], s94 offen offset:3072 lds
    s_add_u32 s94, s94, 32768
    s_and_b32 s94, s94, 262143
    s_waitcnt vmcnt(4)
    s_barrier
    s_add_u32 m0, s62, 98304
    s_nop 0
    buffer_load_dwordx4 v217, s[4:7], s94 offen lds
    buffer_load_dwordx4 v217, s[4:7], s94 offen offset:1024 lds
    buffer_load_dwordx4 v217, s[4:7], s94 offen offset:2048 lds
    buffer_load_dwordx4 v217, s[4:7], s94 offen offset:3072 lds
    s_add_u32 s94, s94, 32768
    s_and_b32 s94, s94, 262143
    s_waitcnt vmcnt(4)
    s_barrier
    s_add_u32 m0, s62, 114688
    s_nop 0
    buffer_load_dwordx4 v217, s[4:7], s94 offen lds
    buffer_load_dwordx4 v217, s[4:7], s94 offen offset:1024 lds
    buffer_load_dwordx4 v217, s[4:7], s94 offen offset:2048 lds
    buffer_load_dwordx4 v217, s[4:7], s94 offen offset:3072 lds
    s_add_u32 s94, s94, 32768
    s_and_b32 s94, s94, 262143
    s_add_u32 m0, s62, 32768
    s_nop 0
    buffer_load_dwordx4 v203, s[12:15], s93 offen lds
    buffer_load_dwordx4 v204, s[12:15], s93 offen offset:1024 lds
    buffer_load_dwordx4 v205, s[12:15], s93 offen offset:2048 lds
    buffer_load_dwordx4 v206, s[12:15], s93 offen offset:3072 lds
    s_add_u32 s93, s93, 524288
    s_and_b32 s93, s93, 2097151
    s_waitcnt vmcnt(8)
    s_barrier
    s_add_u32 m0, s62, 131072
    s_nop 0
    buffer_load_dwordx4 v217, s[4:7], s94 offen lds
    buffer_load_dwordx4 v217, s[4:7], s94 offen offset:1024 lds
    buffer_load_dwordx4 v217, s[4:7], s94 offen offset:2048 lds
    buffer_load_dwordx4 v217, s[4:7], s94 offen offset:3072 lds
    s_add_u32 s94, s94, 32768
    s_and_b32 s94, s94, 262143
    s_waitcnt vmcnt(8)
    s_barrier
    v_lshrrev_b32 v252, 2, v254
    v_min_u32 v252, 60, v252
    s_add_u32 s55, s54, 0
    buffer_load_dword v251, v252, s[4:7], s55 offen sc0 sc1
    s_add_u32 m0, s62, 98304
    s_nop 0
    buffer_load_dwordx4 v217, s[4:7], s94 offen lds
    buffer_load_dwordx4 v217, s[4:7], s94 offen offset:1024 lds
    buffer_load_dwordx4 v217, s[4:7], s94 offen offset:2048 lds
    buffer_load_dwordx4 v217, s[4:7], s94 offen offset:3072 lds
    s_add_u32 s94, s94, 32768
    s_and_b32 s94, s94, 262143
    s_add_u32 m0, s62, 49152
    s_nop 0
    buffer_load_dwordx4 v203, s[12:15], s93 offen lds
    buffer_load_dwordx4 v204, s[12:15], s93 offen offset:1024 lds
    buffer_load_dwordx4 v205, s[12:15], s93 offen offset:2048 lds
    buffer_load_dwordx4 v206, s[12:15], s93 offen offset:3072 lds
    s_add_u32 s93, s93, 524288
    s_and_b32 s93, s93, 2097151
    s_waitcnt vmcnt(9)
    s_barrier
    s_add_u32 m0, s62, 114688
    s_nop 0
    buffer_load_dwordx4 v217, s[4:7], s94 offen lds
    buffer_load_dwordx4 v217, s[4:7], s94 offen offset:1024 lds
    buffer_load_dwordx4 v217, s[4:7], s94 offen offset:2048 lds
    buffer_load_dwordx4 v217, s[4:7], s94 offen offset:3072 lds
    s_add_u32 s94, s94, 49152
    s_and_b32 s94, s94, 262143
    s_waitcnt vmcnt(8)
    s_barrier
    v_cmp_ne_u32 vcc, 0x01010101, v251
    s_cbranch_vccz ap_62
    v_lshrrev_b32 v252, 2, v254
    v_min_u32 v252, 60, v252
    s_add_u32 s55, s54, 0
    s_mov_b32 s56, 262144
poll_63:
    buffer_load_dword v253, v252, s[4:7], s55 offen sc0 sc1
    s_waitcnt vmcnt(0)
    v_cmp_ne_u32 vcc, 0x01010101, v253
    s_cbranch_vccz pd_64
    s_sleep 1
    s_sub_u32 s56, s56, 1
    s_cmp_lg_u32 s56, 0
    s_cbranch_scc1 poll_63
pd_64:
ap_62:
    s_add_u32 m0, s62, 131072
    s_nop 0
    buffer_load_dwordx4 v217, s[4:7], s94 offen lds
    buffer_load_dwordx4 v217, s[4:7], s94 offen offset:1024 lds
    buffer_load_dwordx4 v217, s[4:7], s94 offen offset:2048 lds
    buffer_load_dwordx4 v217, s[4:7], s94 offen offset:3072 lds
    s_add_u32 s94, s94, 32768
    s_and_b32 s94, s94, 262143
    s_waitcnt vmcnt(4)
    s_barrier
    s_add_u32 m0, s62, 98304
    s_nop 0
    buffer_load_dwordx4 v217, s[4:7], s94 offen lds
    buffer_load_dwordx4 v217, s[4:7], s94 offen offset:1024 lds
    buffer_load_dwordx4 v217, s[4:7], s94 offen offset:2048 lds
    buffer_load_dwordx4 v217, s[4:7], s94 offen offset:3072 lds
    s_add_u32 s94, s94, 32768
    s_and_b32 s94, s94, 262143
    s_waitcnt vmcnt(4)
    s_barrier
    s_add_u32 m0, s62, 114688
    s_nop 0
    buffer_load_dwordx4 v217, s[4:7], s94 offen lds
    buffer_load_dwordx4 v217, s[4:7], s94 offen offset:1024 lds
    buffer_load_dwordx4 v217, s[4:7], s94 offen offset:2048 lds
    buffer_load_dwordx4 v217, s[4:7], s94 offen offset:3072 lds
    s_add_u32 s94, s94, 32768
    s_and_b32 s94, s94, 262143
    s_waitcnt vmcnt(4)
    s_barrier
    s_add_u32 m0, s62, 131072
    s_nop 0
    buffer_load_dwordx4 v217, s[4:7], s94 offen lds
    buffer_load_dwordx4 v217, s[4:7], s94 offen offset:1024 lds
    buffer_load_dwordx4 v217, s[4:7], s94 offen offset:2048 lds
    buffer_load_dwordx4 v217, s[4:7], s94 offen offset:3072 lds
    s_add_u32 s94, s94, 32768
    s_and_b32 s94, s94, 262143
    s_waitcnt vmcnt(4)
    s_barrier
    s_add_u32 m0, s62, 98304
    s_nop 0
    buffer_load_dwordx4 v217, s[4:7], s94 offen lds
    buffer_load_dwordx4 v217, s[4:7], s94 offen offset:1024 lds
    buffer_load_dwordx4 v217, s[4:7], s94 offen offset:2048 lds
    buffer_load_dwordx4 v217, s[4:7], s94 offen offset:3072 lds
    s_add_u32 s94, s94, 32768
    s_and_b32 s94, s94, 262143
    s_waitcnt vmcnt(4)
    s_barrier
    s_add_u32 m0, s62, 114688
    s_nop 0
    buffer_load_dwordx4 v217, s[4:7], s94 offen lds
    buffer_load_dwordx4 v217, s[4:7], s94 offen offset:1024 lds
    buffer_load_dwordx4 v217, s[4:7], s94 offen offset:2048 lds
    buffer_load_dwordx4 v217, s[4:7], s94 offen offset:3072 lds
    s_add_u32 s94, s94, 32768
    s_and_b32 s94, s94, 262143
    s_waitcnt vmcnt(4)
    s_barrier
    s_add_u32 m0, s62, 131072
    s_nop 0
    buffer_load_dwordx4 v217, s[4:7], s94 offen lds
    buffer_load_dwordx4 v217, s[4:7], s94 offen offset:1024 lds
    buffer_load_dwordx4 v217, s[4:7], s94 offen offset:2048 lds
    buffer_load_dwordx4 v217, s[4:7], s94 offen offset:3072 lds
    s_add_u32 s94, s94, 32768
    s_and_b32 s94, s94, 262143
    s_waitcnt vmcnt(4)
    s_barrier
    s_add_u32 m0, s62, 98304
    s_nop 0
    buffer_load_dwordx4 v217, s[4:7], s94 offen lds
    buffer_load_dwordx4 v217, s[4:7], s94 offen offset:1024 lds
    buffer_load_dwordx4 v217, s[4:7], s94 offen offset:2048 lds
    buffer_load_dwordx4 v217, s[4:7], s94 offen offset:3072 lds
    s_waitcnt vmcnt(4)
    s_barrier
    s_lshl_b32 s93, s51, 12
    s_add_u32 m0, s62, 65536
    s_mul_i32 s59, s93, 112
    buffer_load_dwordx4 v207, s[28:31], s59 offen lds
    buffer_load_dwordx4 v208, s[28:31], s59 offen offset:1024 lds
    buffer_load_dwordx4 v209, s[28:31], s59 offen offset:2048 lds
    buffer_load_dwordx4 v210, s[28:31], s59 offen offset:3072 lds
    s_add_u32 s93, s93, 2048
    s_and_b32 s93, s93, 65535
    s_waitcnt vmcnt(4)
    s_barrier
    s_add_u32 m0, s62, 81920
    s_mul_i32 s59, s93, 112
    buffer_load_dwordx4 v207, s[28:31], s59 offen lds
    buffer_load_dwordx4 v208, s[28:31], s59 offen offset:1024 lds
    buffer_load_dwordx4 v209, s[28:31], s59 offen offset:2048 lds
    buffer_load_dwordx4 v210, s[28:31], s59 offen offset:3072 lds
    s_add_u32 s93, s93, 6144
    s_and_b32 s93, s93, 65535
    s_barrier
    s_add_u32 m0, s62, 0
    s_mul_i32 s59, s93, 112
    buffer_load_dwordx4 v207, s[28:31], s59 offen lds
    buffer_load_dwordx4 v208, s[28:31], s59 offen offset:1024 lds
    buffer_load_dwordx4 v209, s[28:31], s59 offen offset:2048 lds
    buffer_load_dwordx4 v210, s[28:31], s59 offen offset:3072 lds
    s_add_u32 s93, s93, 2048
    s_and_b32 s93, s93, 65535
    s_add_u32 m0, s62, 16384
    s_mul_i32 s59, s93, 112
    buffer_load_dwordx4 v207, s[28:31], s59 offen lds
    buffer_load_dwordx4 v208, s[28:31], s59 offen offset:1024 lds
    buffer_load_dwordx4 v209, s[28:31], s59 offen offset:2048 lds
    buffer_load_dwordx4 v210, s[28:31], s59 offen offset:3072 lds
    s_add_u32 s93, s93, 6144
    s_and_b32 s93, s93, 65535
    s_cmp_lg_u32 s46, 0
    s_cbranch_scc1 jf_65
    v_mov_b32 v104, 0x3f80
    v_lshrrev_b32 v224, 4, v254
    v_and_b32 v225, 1, v224
    v_lshlrev_b32 v225, 4, v225
    v_lshlrev_b32 v225, v225, v104
    v_bfe_u32 v224, v224, 1, 3
    v_cmp_eq_u32 vcc, 0, v224
    s_nop 1
    v_cndmask_b32 v104, 0, v225, vcc
    v_cmp_eq_u32 vcc, 1, v224
    s_nop 1
    v_cndmask_b32 v105, 0, v225, vcc
    v_cmp_eq_u32 vcc, 2, v224
    s_nop 1
    v_cndmask_b32 v106, 0, v225, vcc
    v_cmp_eq_u32 vcc, 3, v224
    s_nop 1
    v_cndmask_b32 v107, 0, v225, vcc
    s_nop 1
    v_mfma_f32_16x16x32_bf16 v[100:103], v[104:107], v[0:3], 0
    v_mfma_f32_16x16x32_bf16 v[100:103], v[104:107], v[4:7], v[100:103]
    v_mfma_f32_16x16x32_bf16 v[100:103], v[104:107], v[8:11], v[100:103]
    v_mfma_f32_16x16x32_bf16 v[100:103], v[104:107], v[12:15], v[100:103]
    v_mfma_f32_16x16x32_bf16 v[100:103], v[104:107], v[16:19], v[100:103]
    v_mfma_f32_16x16x32_bf16 v[100:103], v[104:107], v[20:23], v[100:103]
    v_mfma_f32_16x16x32_bf16 v[100:103], v[104:107], v[24:27], v[100:103]
    v_mfma_f32_16x16x32_bf16 v[100:103], v[104:107], v[28:31], v[100:103]
    v_mfma_f32_16x16x32_bf16 v[100:103], v[104:107], v[32:35], v[100:103]
    v_mfma_f32_16x16x32_bf16 v[100:103], v[104:107], v[36:39], v[100:103]
    v_mfma_f32_16x16x32_bf16 v[100:103], v[104:107], v[40:43], v[100:103]
    v_mfma_f32_16x16x32_bf16 v[100:103], v[104:107], v[44:47], v[100:103]
    v_mfma_f32_16x16x32_bf16 v[100:103], v[104:107], v[48:51], v[100:103]
    v_mfma_f32_16x16x32_bf16 v[100:103], v[104:107], v[52:55], v[100:103]
    v_mfma_f32_16x16x32_bf16 v[100:103], v[104:107], v[56:59], v[100:103]
    v_mfma_f32_16x16x32_bf16 v[100:103], v[104:107], v[60:63], v[100:103]
    s_and_b32 s56, s79, 1
    s_lshl_b32 s56, s56, 2
    s_add_u32 s56, s56, s42
    s_mul_i32 s56, s56, 28672
    s_lshr_b32 s55, s79, 1
    s_lshl_b32 s55, s55, 8
    s_add_u32 s55, s55, s56
    s_add_u32 s55, s55, 70778880
    s_cmp_lt_u32 s79, 224
    s_cselect_b32 s55, s55, 2130706432
    v_and_b32 v224, 0x70, v254
    v_lshrrev_b32 v225, 4, v254
    v_and_b32 v225, 16, v225
    v_lshl_add_u32 v224, v224, 1, v225
    s_nop 2
    v_add_f32_dpp v100, v100, v100 row_ror:8 row_mask:0xf bank_mask:0xf
    v_add_f32_dpp v101, v101, v101 row_ror:8 row_mask:0xf bank_mask:0xf
    v_add_f32_dpp v102, v102, v102 row_ror:8 row_mask:0xf bank_mask:0xf
    v_add_f32_dpp v103, v103, v103 row_ror:8 row_mask:0xf bank_mask:0xf
    s_mov_b64 exec, 0x00ff00ff
    buffer_store_dwordx4 v[100:103], v224, s[4:7], s55 offen sc0 sc1
    s_mov_b64 exec, -1
jf_65:
    s_add_u32 s88, s49, s62
    s_lshl_b32 s94, s51, 14
    v_add_u32 v217, s88, v254
    s_and_b32 s55, s51, 1
    s_mul_i32 s55, s55, 458752
    s_add_u32 s95, s50, s55
    s_and_b32 s55, s41, 7
    s_lshl_b32 s55, s55, 14
    s_and_b32 s56, s1, 0x3fff
    s_add_u32 s55, s55, s56
    s_add_u32 s89, s55, s95
    s_and_b32 s55, s41, 6
    s_add_u32 s55, s55, 48
    s_lshl_b32 s55, s55, 13
    s_and_b32 s56, s41, 1
    s_lshl_b32 s56, s56, 10
    s_add_u32 s55, s55, s56
    s_lshl_b32 s56, s43, 13
    s_add_u32 s55, s55, s56
    s_lshl_b32 s56, s44, 9
    s_add_u32 s55, s55, s56
    s_add_u32 s90, s55, s95
    s_barrier
    s_add_u32 m0, s62, 98304
    s_nop 0
    buffer_load_dwordx4 v217, s[4:7], s94 offen lds
    buffer_load_dwordx4 v217, s[4:7], s94 offen offset:1024 lds
    buffer_load_dwordx4 v217, s[4:7], s94 offen offset:2048 lds
    buffer_load_dwordx4 v217, s[4:7], s94 offen offset:3072 lds
    s_add_u32 s94, s94, 32768
    s_and_b32 s94, s94, 262143
    s_waitcnt vmcnt(0)
    s_barrier
    v_lshrrev_b32 v252, 2, v254
    v_min_u32 v252, 28, v252
    s_add_u32 s55, s0, 32
    buffer_load_dword v251, v252, s[4:7], s55 offen sc0 sc1
    s_setprio 1
    s_barrier
    s_waitcnt vmcnt(0)
    v_cmp_ne_u32 vcc, 0x01010101, v251
    s_cbranch_vccz ap_66
    v_lshrrev_b32 v252, 2, v254
    v_min_u32 v252, 28, v252
    s_add_u32 s55, s0, 32
    s_mov_b32 s56, 262144
poll_67:
    buffer_load_dword v253, v252, s[4:7], s55 offen sc0 sc1
    s_waitcnt vmcnt(0)
    v_cmp_ne_u32 vcc, 0x01010101, v253
    s_cbranch_vccz pd_68
    s_sleep 1
    s_sub_u32 s56, s56, 1
    s_cmp_lg_u32 s56, 0
    s_cbranch_scc1 poll_67
pd_68:
ap_66:
    s_add_u32 m0, s62, 114688
    s_nop 0
    buffer_load_dwordx4 v217, s[4:7], s94 offen lds
    buffer_load_dwordx4 v217, s[4:7], s94 offen offset:1024 lds
    buffer_load_dwordx4 v217, s[4:7], s94 offen offset:2048 lds
    buffer_load_dwordx4 v217, s[4:7], s94 offen offset:3072 lds
    s_add_u32 s94, s94, 32768
    s_and_b32 s94, s94, 262143
    s_add_u32 m0, s62, 131072
    s_nop 0
    buffer_load_dwordx4 v217, s[4:7], s94 offen lds
    buffer_load_dwordx4 v217, s[4:7], s94 offen offset:1024 lds
    buffer_load_dwordx4 v217, s[4:7], s94 offen offset:2048 lds
    buffer_load_dwordx4 v217, s[4:7], s94 offen offset:3072 lds
    s_add_u32 s94, s94, 32768
    s_and_b32 s94, s94, 262143
    s_add_u32 m0, s62, 32768
    s_mul_i32 s59, s93, 112
    buffer_load_dwordx4 v207, s[28:31], s59 offen lds
    buffer_load_dwordx4 v208, s[28:31], s59 offen offset:1024 lds
    buffer_load_dwordx4 v209, s[28:31], s59 offen offset:2048 lds
    buffer_load_dwordx4 v210, s[28:31], s59 offen offset:3072 lds
    s_add_u32 s93, s93, 2048
    s_and_b32 s93, s93, 65535
    s_waitcnt vmcnt(8)
    s_barrier
    s_add_u32 m0, s62, 98304
    s_nop 0
    buffer_load_dwordx4 v217, s[4:7], s94 offen lds
    buffer_load_dwordx4 v217, s[4:7], s94 offen offset:1024 lds
    s_add_u32 m0, s62, 49152
    s_mul_i32 s59, s93, 112
    buffer_load_dwordx4 v207, s[28:31], s59 offen lds
    buffer_load_dwordx4 v208, s[28:31], s59 offen offset:1024 lds
    buffer_load_dwordx4 v209, s[28:31], s59 offen offset:2048 lds
    buffer_load_dwordx4 v210, s[28:31], s59 offen offset:3072 lds
    s_add_u32 s93, s93, 6144
    s_and_b32 s93, s93, 65535
    s_barrier
    s_add_u32 m0, s62, 98304
    s_nop 0
    buffer_load_dwordx4 v217, s[4:7], s94 offen offset:2048 lds
    buffer_load_dwordx4 v217, s[4:7], s94 offen offset:3072 lds
    s_add_u32 s94, s94, 32768
    s_and_b32 s94, s94, 262143
    s_add_u32 m0, s62, 65536
    s_mul_i32 s59, s93, 112
    buffer_load_dwordx4 v207, s[28:31], s59 offen lds
    buffer_load_dwordx4 v208, s[28:31], s59 offen offset:1024 lds
    buffer_load_dwordx4 v209, s[28:31], s59 offen offset:2048 lds
    buffer_load_dwordx4 v210, s[28:31], s59 offen offset:3072 lds
    s_add_u32 s93, s93, 2048
    s_and_b32 s93, s93, 65535
    s_cmp_lg_u32 s42, 0
    s_cbranch_scc1 wf_69
    s_lshl_b32 s55, s51, 2
    s_add_u32 s55, s55, s54
    v_mov_b32 v252, 12288
    v_mov_b32 v253, 0x01010101
    s_mov_b64 exec, 1
    buffer_store_dword v253, v252, s[4:7], s55 offen sc0 sc1
    s_mov_b64 exec, -1
wf_69:
    s_xor_b32 s55, s42, 1
    s_or_b32 s55, s46, s55
    s_cbranch_scc1 cf_70
    v_mov_b32 v252, 0
    v_mov_b32 v253, 1
    s_lshl_b32 s55, s2, 2
    s_add_u32 s55, s55, 71566336
    s_mov_b64 exec, 1
    buffer_store_dword v253, v252, s[4:7], s55 offen sc0 sc1
    s_mov_b64 exec, -1
cf_70:
    s_waitcnt vmcnt(12)
    s_barrier
    s_add_u32 m0, s62, 114688
    s_nop 0
    buffer_load_dwordx4 v217, s[4:7], s94 offen lds
    buffer_load_dwordx4 v217, s[4:7], s94 offen offset:1024 lds
    s_add_u32 m0, s62, 81920
    s_mul_i32 s59, s93, 112
    buffer_load_dwordx4 v207, s[28:31], s59 offen lds
    buffer_load_dwordx4 v208, s[28:31], s59 offen offset:1024 lds
    buffer_load_dwordx4 v209, s[28:31], s59 offen offset:2048 lds
    buffer_load_dwordx4 v210, s[28:31], s59 offen offset:3072 lds
    s_add_u32 s93, s93, 6144
    s_and_b32 s93, s93, 65535
    s_waitcnt vmcnt(12)
    s_barrier
    s_add_u32 m0, s62, 114688
    s_nop 0
    buffer_load_dwordx4 v217, s[4:7], s94 offen offset:2048 lds
    buffer_load_dwordx4 v217, s[4:7], s94 offen offset:3072 lds
    s_add_u32 s94, s94, 32768
    s_and_b32 s94, s94, 262143
    s_add_u32 m0, s62, 0
    s_mul_i32 s59, s93, 112
    buffer_load_dwordx4 v207, s[28:31], s59 offen lds
    buffer_load_dwordx4 v208, s[28:31], s59 offen offset:1024 lds
    buffer_load_dwordx4 v209, s[28:31], s59 offen offset:2048 lds
    buffer_load_dwordx4 v210, s[28:31], s59 offen offset:3072 lds
    s_add_u32 s93, s93, 2048
    s_and_b32 s93, s93, 65535
    s_lshl_b32 s55, s46, 4
    s_lshr_b32 s56, s40, 1
    s_add_u32 s55, s55, s56
    s_cmp_lg_u32 s55, 0
    s_cbranch_scc1 w2_71
    v_lshlrev_b32 v252, 3, v254
    s_lshl_b32 s55, s2, 2
    s_add_u32 s55, s55, s42
    s_lshl_b32 s55, s55, 13
    buffer_load_dword v250, v252, s[20:23], s55 offen
w2_71:
    s_waitcnt vmcnt(12)
    s_barrier
    s_add_u32 m0, s62, 131072
    s_nop 0
    buffer_load_dwordx4 v217, s[4:7], s94 offen lds
    buffer_load_dwordx4 v217, s[4:7], s94 offen offset:1024 lds
    s_add_u32 m0, s62, 16384
    s_mul_i32 s59, s93, 112
    buffer_load_dwordx4 v207, s[28:31], s59 offen lds
    buffer_load_dwordx4 v208, s[28:31], s59 offen offset:1024 lds
    buffer_load_dwordx4 v209, s[28:31], s59 offen offset:2048 lds
    buffer_load_dwordx4 v210, s[28:31], s59 offen offset:3072 lds
    s_add_u32 s93, s93, 6144
    s_and_b32 s93, s93, 65535
    s_waitcnt vmcnt(12)
    s_barrier
    v_lshrrev_b32 v252, 2, v254
    v_min_u32 v252, 60, v252
    s_add_u32 s55, s54, 12288
    buffer_load_dword v251, v252, s[4:7], s55 offen sc0 sc1
    s_add_u32 m0, s62, 131072
    s_nop 0
    buffer_load_dwordx4 v217, s[4:7], s94 offen offset:2048 lds
    buffer_load_dwordx4 v217, s[4:7], s94 offen offset:3072 lds
    s_add_u32 s94, s94, 32768
    s_and_b32 s94, s94, 262143
    s_add_u32 m0, s62, 32768
    s_mul_i32 s59, s93, 112
    buffer_load_dwordx4 v207, s[28:31], s59 offen lds
    buffer_load_dwordx4 v208, s[28:31], s59 offen offset:1024 lds
    buffer_load_dwordx4 v209, s[28:31], s59 offen offset:2048 lds
    buffer_load_dwordx4 v210, s[28:31], s59 offen offset:3072 lds
    s_add_u32 s93, s93, 2048
    s_and_b32 s93, s93, 65535
    s_lshl_b32 s55, s46, 4
    s_lshr_b32 s56, s40, 1
    s_add_u32 s55, s55, s56
    s_cmp_lg_u32 s55, 1
    s_cbranch_scc1 w2_72
    v_lshlrev_b32 v252, 3, v254
    s_lshl_b32 s55, s2, 2
    s_add_u32 s55, s55, s42
    s_lshl_b32 s55, s55, 13
    buffer_load_dword v250, v252, s[20:23], s55 offen
w2_72:
    s_waitcnt vmcnt(13)
    s_barrier
    s_add_u32 m0, s62, 98304
    s_nop 0
    buffer_load_dwordx4 v217, s[4:7], s94 offen lds
    buffer_load_dwordx4 v217, s[4:7], s94 offen offset:1024 lds
    s_add_u32 m0, s62, 49152
    s_mul_i32 s59, s93, 112
    buffer_load_dwordx4 v207, s[28:31], s59 offen lds
    buffer_load_dwordx4 v208, s[28:31], s59 offen offset:1024 lds
    buffer_load_dwordx4 v209, s[28:31], s59 offen offset:2048 lds
    buffer_load_dwordx4 v210, s[28:31], s59 offen offset:3072 lds
    s_add_u32 s93, s93, 6144
    s_and_b32 s93, s93, 65535
    s_waitcnt vmcnt(13)
    s_barrier
    s_add_u32 m0, s62, 98304
    s_nop 0
    buffer_load_dwordx4 v217, s[4:7], s94 offen offset:2048 lds
    buffer_load_dwordx4 v217, s[4:7], s94 offen offset:3072 lds
    s_add_u32 s94, s94, 32768
    s_and_b32 s94, s94, 262143
    s_add_u32 m0, s62, 65536
    s_mul_i32 s59, s93, 112
    buffer_load_dwordx4 v207, s[28:31], s59 offen lds
    buffer_load_dwordx4 v208, s[28:31], s59 offen offset:1024 lds
    buffer_load_dwordx4 v209, s[28:31], s59 offen offset:2048 lds
    buffer_load_dwordx4 v210, s[28:31], s59 offen offset:3072 lds
    s_add_u32 s93, s93, 2048
    s_and_b32 s93, s93, 65535
    s_lshl_b32 s55, s46, 4
    s_lshr_b32 s56, s40, 1
    s_add_u32 s55, s55, s56
    s_cmp_lg_u32 s55, 2
    s_cbranch_scc1 w2_73
    v_lshlrev_b32 v252, 3, v254
    s_lshl_b32 s55, s2, 2
    s_add_u32 s55, s55, s42
    s_lshl_b32 s55, s55, 13
    buffer_load_dword v250, v252, s[20:23], s55 offen
w2_73:
    s_waitcnt vmcnt(12)
    s_barrier
    v_cmp_ne_u32 vcc, 0x01010101, v251
    s_cbranch_vccz ap_74
    v_lshrrev_b32 v252, 2, v254
    v_min_u32 v252, 60, v252
    s_add_u32 s55, s54, 12288
    s_mov_b32 s56, 262144
poll_75:
    buffer_load_dword v253, v252, s[4:7], s55 offen sc0 sc1
    s_waitcnt vmcnt(0)
    v_cmp_ne_u32 vcc, 0x01010101, v253
    s_cbranch_vccz pd_76
    s_sleep 1
    s_sub_u32 s56, s56, 1
    s_cmp_lg_u32 s56, 0
    s_cbranch_scc1 poll_75
pd_76:
ap_74:
    s_add_u32 m0, s62, 114688
    s_nop 0
    buffer_load_dwordx4 v217, s[4:7], s94 offen lds
    buffer_load_dwordx4 v217, s[4:7], s94 offen offset:1024 lds
    s_add_u32 m0, s62, 81920
    s_mul_i32 s59, s93, 112
    buffer_load_dwordx4 v207, s[28:31], s59 offen lds
    v_and_b32 v226, 0xf0, v254
    v_and_b32 v227, 0x300, v254
    v_lshl_add_u32 v227, v227, 2, v226
    s_lshl_b32 s78, s42, 8
    s_add_u32 s78, s78, s52
    buffer_load_dwordx4 v208, s[28:31], s59 offen offset:1024 lds
    buffer_load_dwordx4 v209, s[28:31], s59 offen offset:2048 lds
    buffer_load_dwordx4 v210, s[28:31], s59 offen offset:3072 lds
    s_add_u32 s93, s93, 6144
    s_and_b32 s93, s93, 65535
    buffer_load_dwordx4 v[96:99], v227, s[4:7], s78 offen
    s_add_u32 s78, s78, 4096
    s_waitcnt vmcnt(13)
    s_barrier
    s_mov_b32 s55, 71566336
    buffer_load_dwordx4 v[128:131], v254, s[4:7], s55 offen sc0 sc1
    s_add_u32 m0, s62, 114688
    s_nop 0
    buffer_load_dwordx4 v217, s[4:7], s94 offen offset:2048 lds
    buffer_load_dwordx4 v217, s[4:7], s94 offen offset:3072 lds
    s_add_u32 s94, s94, 49152
    s_and_b32 s94, s94, 262143
    s_add_u32 m0, s62, 0
    s_mul_i32 s59, s93, 112
    buffer_load_dwordx4 v207, s[28:31], s59 offen lds
    buffer_load_dwordx4 v208, s[28:31], s59 offen offset:1024 lds
    buffer_load_dwordx4 v209, s[28:31], s59 offen offset:2048 lds
    buffer_load_dwordx4 v210, s[28:31], s59 offen offset:3072 lds
    s_add_u32 s93, s93, 2048
    s_and_b32 s93, s93, 65535
    buffer_load_dwordx4 v[100:103], v227, s[4:7], s78 offen
    s_add_u32 s78, s78, 4096
    s_lshl_b32 s55, s46, 4
    s_lshr_b32 s56, s40, 1
    s_add_u32 s55, s55, s56
    s_cmp_lg_u32 s55, 3
    s_cbranch_scc1 w2_77
    v_lshlrev_b32 v252, 3, v254
    s_lshl_b32 s55, s2, 2
    s_add_u32 s55, s55, s42
    s_lshl_b32 s55, s55, 13
    buffer_load_dword v250, v252, s[20:23], s55 offen
w2_77:
    s_waitcnt vmcnt(15)
    s_barrier
    s_add_u32 m0, s62, 131072
    s_nop 0
    buffer_load_dwordx4 v217, s[4:7], s94 offen lds
    buffer_load_dwordx4 v217, s[4:7], s94 offen offset:1024 lds
    s_add_u32 m0, s62, 16384
    s_mul_i32 s59, s93, 112
    buffer_load_dwordx4 v207, s[28:31], s59 offen lds
    buffer_load_dwordx4 v208, s[28:31], s59 offen offset:1024 lds
    buffer_load_dwordx4 v209, s[28:31], s59 offen offset:2048 lds
    buffer_load_dwordx4 v210, s[28:31], s59 offen offset:3072 lds
    s_add_u32 s93, s93, 10240
    s_and_b32 s93, s93, 65535
    buffer_load_dwordx4 v[104:107], v227, s[4:7], s78 offen
    s_add_u32 s78, s78, 4096
    s_waitcnt vmcnt(16)
    s_barrier
    s_add_u32 m0, s62, 131072
    s_nop 0
    buffer_load_dwordx4 v217, s[4:7], s94 offen offset:2048 lds
    buffer_load_dwordx4 v217, s[4:7], s94 offen offset:3072 lds
    s_add_u32 s94, s94, 32768
    s_and_b32 s94, s94, 262143
    s_add_u32 m0, s62, 32768
    s_mul_i32 s59, s93, 112
    buffer_load_dwordx4 v207, s[28:31], s59 offen lds
    buffer_load_dwordx4 v208, s[28:31], s59 offen offset:1024 lds
    buffer_load_dwordx4 v209, s[28:31], s59 offen offset:2048 lds
    buffer_load_dwordx4 v210, s[28:31], s59 offen offset:3072 lds
    s_add_u32 s93, s93, 2048
    s_and_b32 s93, s93, 65535
    buffer_load_dwordx4 v[108:111], v227, s[4:7], s78 offen
    s_add_u32 s78, s78, 4096
    s_lshl_b32 s55, s46, 4
    s_lshr_b32 s56, s40, 1
    s_add_u32 s55, s55, s56
    s_cmp_lg_u32 s55, 4
    s_cbranch_scc1 w2_78
    v_lshlrev_b32 v252, 3, v254
    s_lshl_b32 s55, s2, 2
    s_add_u32 s55, s55, s42
    s_lshl_b32 s55, s55, 13
    buffer_load_dword v250, v252, s[20:23], s55 offen
w2_78:
    s_waitcnt vmcnt(15)
    s_barrier
    s_cmp_eq_u32 s46, 1
    s_cbranch_scc1 a4_79
    v_and_b32 v128, v128, v129
    v_and_b32 v130, v130, v131
    v_and_b32 v128, v128, v130
    v_cmp_ne_u32 vcc, 1, v128
    s_cbranch_vccz a4_79
    s_mov_b32 s55, 71566336
    s_mov_b32 s56, 262144
p4_80:
    buffer_load_dwordx4 v[128:131], v254, s[4:7], s55 offen sc0 sc1
    s_waitcnt vmcnt(0)
    v_and_b32 v128, v128, v129
    v_and_b32 v130, v130, v131
    v_and_b32 v128, v128, v130
    v_cmp_ne_u32 vcc, 1, v128
    s_cbranch_vccz p4_81
    s_sleep 1
    s_sub_u32 s56, s56, 1
    s_cmp_lg_u32 s56, 0
    s_cbranch_scc1 p4_80
p4_81:
a4_79:
    s_cmp_lg_u32 s46, 0
    s_cbranch_scc1 cs_82
    s_and_b32 s55, s41, 1
    s_mul_i32 s56, s55, 384
    s_xor_b32 s55, s55, 1
    s_lshl_b32 s55, s55, 9
    s_cmp_eq_u32 s44, 0
    s_cselect_b32 s55, s56, s55
    s_mul_i32 s56, s41, 896
    s_add_u32 s55, s55, s56
    s_mul_i32 s56, s43, 14336
    s_add_u32 s55, s55, s56
    s_add_u32 s55, s55, 70778880
    v_lshrrev_b32 v224, 9, v254
    v_mul_u32_u24 v224, 28672, v224
    v_and_b32 v225, 0x1f0, v254
    v_add_u32 v224, v224, v225
    buffer_load_dwordx4 v[128:131], v224, s[4:7], s55 offen sc1
    s_add_u32 s55, s55, 57344
    buffer_load_dwordx4 v[132:135], v224, s[4:7], s55 offen sc1
    s_add_u32 s55, s55, 57344
    buffer_load_dwordx4 v[136:139], v224, s[4:7], s55 offen sc1
    s_add_u32 s55, s55, 57344
    buffer_load_dwordx4 v[140:143], v224, s[4:7], s55 offen sc1
    s_add_u32 s55, s55, 57344
cs_82:
    s_add_u32 m0, s62, 98304
    s_nop 0
    buffer_load_dwordx4 v217, s[4:7], s94 offen lds
    buffer_load_dwordx4 v217, s[4:7], s94 offen offset:1024 lds
    s_add_u32 m0, s62, 49152
    s_mul_i32 s59, s93, 112
    buffer_load_dwordx4 v207, s[28:31], s59 offen lds
    buffer_load_dwordx4 v208, s[28:31], s59 offen offset:1024 lds
    buffer_load_dwordx4 v209, s[28:31], s59 offen offset:2048 lds
    buffer_load_dwordx4 v210, s[28:31], s59 offen offset:3072 lds
    s_add_u32 s93, s93, 6144
    s_and_b32 s93, s93, 65535
    s_waitcnt vmcnt(14)
    s_barrier
    s_add_u32 m0, s62, 98304
    s_nop 0
    buffer_load_dwordx4 v217, s[4:7], s94 offen offset:2048 lds
    buffer_load_dwordx4 v217, s[4:7], s94 offen offset:3072 lds
    s_add_u32 s94, s94, 32768
    s_and_b32 s94, s94, 262143
    s_add_u32 m0, s62, 65536
    s_mul_i32 s59, s93, 112
    buffer_load_dwordx4 v207, s[28:31], s59 offen lds
    buffer_load_dwordx4 v208, s[28:31], s59 offen offset:1024 lds
    buffer_load_dwordx4 v209, s[28:31], s59 offen offset:2048 lds
    buffer_load_dwordx4 v210, s[28:31], s59 offen offset:3072 lds
    s_add_u32 s93, s93, 2048
    s_and_b32 s93, s93, 65535
    s_lshl_b32 s55, s46, 4
    s_lshr_b32 s56, s40, 1
    s_add_u32 s55, s55, s56
    s_cmp_lg_u32 s55, 5
    s_cbranch_scc1 w2_83
    v_lshlrev_b32 v252, 3, v254
    s_lshl_b32 s55, s2, 2
    s_add_u32 s55, s55, s42
    s_lshl_b32 s55, s55, 13
    buffer_load_dword v250, v252, s[20:23], s55 offen
w2_83:
    s_waitcnt vmcnt(13)
    s_barrier
    s_waitcnt vmcnt(12)
    s_add_u32 m0, s62, 114688
    s_nop 0
    buffer_load_dwordx4 v217, s[4:7], s94 offen lds
    v_add_f32 v96, v96, v100
    v_add_f32 v97, v97, v101
    v_add_f32 v98, v98, v102
    v_add_f32 v99, v99, v103
    buffer_load_dwordx4 v217, s[4:7], s94 offen offset:1024 lds
    v_add_f32 v104, v104, v108
    v_add_f32 v105, v105, v109
    v_add_f32 v106, v106, v110
    v_add_f32 v107, v107, v111
    s_add_u32 m0, s62, 81920
    s_mul_i32 s59, s93, 112
    buffer_load_dwordx4 v207, s[28:31], s59 offen lds
    v_add_f32 v192, v96, v104
    v_add_f32 v193, v97, v105
    v_add_f32 v194, v98, v106
    v_add_f32 v195, v99, v107
    buffer_load_dwordx4 v208, s[28:31], s59 offen offset:1024 lds
    v_mov_b32 v96, v192
    v_mov_b32 v97, v193
    v_mov_b32 v98, v194
    v_mov_b32 v99, v195
    buffer_load_dwordx4 v209, s[28:31], s59 offen offset:2048 lds
    s_nop 1
    v_permlane16_swap_b32 v192, v96
    v_permlane16_swap_b32 v193, v97
    v_permlane16_swap_b32 v194, v98
    buffer_load_dwordx4 v210, s[28:31], s59 offen offset:3072 lds
    s_add_u32 s93, s93, 6144
    s_and_b32 s93, s93, 65535
    v_permlane16_swap_b32 v195, v99
    v_add_f32 v192, v192, v96
    v_add_f32 v193, v193, v97
    v_add_f32 v194, v194, v98
    v_add_f32 v195, v195, v99
    s_waitcnt vmcnt(12)
    s_barrier
    s_add_u32 m0, s62, 114688
    s_nop 0
    buffer_load_dwordx4 v217, s[4:7], s94 offen offset:2048 lds
    v_mov_b32 v96, v192
    v_mov_b32 v97, v193
    buffer_load_dwordx4 v217, s[4:7], s94 offen offset:3072 lds
    s_add_u32 s94, s94, 32768
    s_and_b32 s94, s94, 262143
    v_mov_b32 v98, v194
    v_mov_b32 v99, v195
    s_add_u32 m0, s62, 0
    s_mul_i32 s59, s93, 112
    buffer_load_dwordx4 v207, s[28:31], s59 offen lds
    s_nop 1
    v_permlane32_swap_b32 v192, v96
    buffer_load_dwordx4 v208, s[28:31], s59 offen offset:1024 lds
    v_permlane32_swap_b32 v193, v97
    v_permlane32_swap_b32 v194, v98
    buffer_load_dwordx4 v209, s[28:31], s59 offen offset:2048 lds
    v_permlane32_swap_b32 v195, v99
    v_add_f32 v192, v192, v96
    buffer_load_dwordx4 v210, s[28:31], s59 offen offset:3072 lds
    s_add_u32 s93, s93, 2048
    s_and_b32 s93, s93, 65535
    v_add_f32 v193, v193, v97
    v_add_f32 v194, v194, v98
    v_add_f32 v195, v195, v99
    s_lshl_b32 s55, s46, 4
    s_lshr_b32 s56, s40, 1
    s_add_u32 s55, s55, s56
    s_cmp_lg_u32 s55, 6
    s_cbranch_scc1 w2_84
    v_lshlrev_b32 v252, 3, v254
    s_lshl_b32 s55, s2, 2
    s_add_u32 s55, s55, s42
    s_lshl_b32 s55, s55, 13
    buffer_load_dword v250, v252, s[20:23], s55 offen
w2_84:
    s_waitcnt vmcnt(12)
    s_barrier
    s_cmp_lg_u32 s46, 0
    s_cbranch_scc1 cs_85
    v_add_f32 v128, v128, v132
    v_add_f32 v136, v136, v140
    v_add_f32 v129, v129, v133
    v_add_f32 v137, v137, v141
    v_add_f32 v130, v130, v134
    v_add_f32 v138, v138, v142
    v_add_f32 v131, v131, v135
    v_add_f32 v139, v139, v143
    v_add_f32 v128, v128, v136
    v_add_f32 v129, v129, v137
    v_add_f32 v130, v130, v138
    v_add_f32 v131, v131, v139
    v_mov_b32 v132, v128
    v_mov_b32 v133, v129
    v_mov_b32 v134, v130
    v_mov_b32 v135, v131
    s_nop 1
    v_permlane32_swap_b32 v128, v132
    v_permlane32_swap_b32 v129, v133
    v_permlane32_swap_b32 v130, v134
    v_permlane32_swap_b32 v131, v135
    v_add_f32 v128, v128, v132
    v_add_f32 v129, v129, v133
    v_add_f32 v130, v130, v134
    v_add_f32 v131, v131, v135
    s_lshl_b32 s55, s42, 9
    s_add_u32 s55, s55, 161664
    v_and_b32 v225, 0x1f0, v254
    v_add_u32 v224, s55, v225
    s_mov_b64 exec, 0xffffffff
    ds_write_b128 v224, v[128:131]
    s_mov_b64 exec, -1
cs_85:
    s_add_u32 m0, s62, 131072
    s_nop 0
    buffer_load_dwordx4 v217, s[4:7], s94 offen lds
    v_mul_f32 v192, 0x3a800000, v192
    v_mul_f32 v193, 0x3a800000, v193
    buffer_load_dwordx4 v217, s[4:7], s94 offen offset:1024 lds
    v_fma_f32 v193, -v192, v192, v193
    v_max_f32 v193, 0, v193
    v_cvt_pk_bf16_f32 v192, v192, v192
    s_add_u32 m0, s62, 16384
    s_mul_i32 s59, s93, 112
    buffer_load_dwordx4 v207, s[28:31], s59 offen lds
    v_lshlrev_b32 v192, 16, v192
    v_cvt_pk_bf16_f32 v193, v193, v193
    v_lshlrev_b32 v193, 16, v193
    buffer_load_dwordx4 v208, s[28:31], s59 offen offset:1024 lds
    v_add_f32 v193, 0x3727c5ac, v193
    v_cvt_pk_bf16_f32 v193, v193, v193
    v_lshlrev_b32 v193, 16, v193
    buffer_load_dwordx4 v209, s[28:31], s59 offen offset:2048 lds
    v_sqrt_f32 v193, v193
    s_nop 0
    v_cvt_pk_bf16_f32 v193, v193, v193
    buffer_load_dwordx4 v210, s[28:31], s59 offen offset:3072 lds
    s_add_u32 s93, s93, 6144
    s_and_b32 s93, s93, 65535
    v_lshlrev_b32 v193, 16, v193
    v_rcp_f32 v193, v193
    s_nop 0
    s_waitcnt vmcnt(12)
    s_barrier
    s_add_u32 m0, s62, 131072
    s_nop 0
    buffer_load_dwordx4 v217, s[4:7], s94 offen offset:2048 lds
    v_mul_f32 v194, 0x3a800000, v194
    v_mul_f32 v195, 0x3a800000, v195
    v_fma_f32 v195, -v194, v194, v195
    buffer_load_dwordx4 v217, s[4:7], s94 offen offset:3072 lds
    s_add_u32 s94, s94, 32768
    s_and_b32 s94, s94, 262143
    v_max_f32 v195, 0, v195
    v_cvt_pk_bf16_f32 v194, v194, v194
    v_lshlrev_b32 v194, 16, v194
    s_add_u32 m0, s62, 32768
    s_mul_i32 s59, s93, 112
    buffer_load_dwordx4 v207, s[28:31], s59 offen lds
    v_cvt_pk_bf16_f32 v195, v195, v195
    v_lshlrev_b32 v195, 16, v195
    v_add_f32 v195, 0x3727c5ac, v195
    buffer_load_dwordx4 v208, s[28:31], s59 offen offset:1024 lds
    v_cvt_pk_bf16_f32 v195, v195, v195
    v_lshlrev_b32 v195, 16, v195
    v_sqrt_f32 v195, v195
    buffer_load_dwordx4 v209, s[28:31], s59 offen offset:2048 lds
    s_nop 0
    v_cvt_pk_bf16_f32 v195, v195, v195
    v_lshlrev_b32 v195, 16, v195
    buffer_load_dwordx4 v210, s[28:31], s59 offen offset:3072 lds
    s_add_u32 s93, s93, 2048
    s_and_b32 s93, s93, 65535
    v_rcp_f32 v195, v195
    s_nop 0
    s_lshl_b32 s55, s42, 8
    s_add_u32 s55, s55, 159744
    v_add_u32 v226, s55, v226
    s_mov_b64 exec, 0xffff
    ds_write_b128 v226, v[192:195]
    s_mov_b64 exec, -1
    s_lshl_b32 s55, s46, 4
    s_lshr_b32 s56, s40, 1
    s_add_u32 s55, s55, s56
    s_cmp_lg_u32 s55, 7
    s_cbranch_scc1 w2_86
    v_lshlrev_b32 v252, 3, v254
    s_lshl_b32 s55, s2, 2
    s_add_u32 s55, s55, s42
    s_lshl_b32 s55, s55, 13
    buffer_load_dword v250, v252, s[20:23], s55 offen
w2_86:
    s_waitcnt vmcnt(12)
    s_barrier
    s_add_u32 m0, s62, 98304
    s_nop 0
    buffer_load_dwordx4 v217, s[4:7], s94 offen lds
    buffer_load_dwordx4 v217, s[4:7], s94 offen offset:1024 lds
    s_add_u32 m0, s62, 49152
    s_mul_i32 s59, s93, 112
    buffer_load_dwordx4 v207, s[28:31], s59 offen lds
    buffer_load_dwordx4 v208, s[28:31], s59 offen offset:1024 lds
    buffer_load_dwordx4 v209, s[28:31], s59 offen offset:2048 lds
    buffer_load_dwordx4 v210, s[28:31], s59 offen offset:3072 lds
    s_add_u32 s93, s93, 6144
    s_and_b32 s93, s93, 65535
    s_waitcnt vmcnt(12)
    s_barrier
    s_add_u32 m0, s62, 98304
    s_nop 0
    buffer_load_dwordx4 v217, s[4:7], s94 offen offset:2048 lds
    s_lshl_b32 s55, s43, 13
    s_add_u32 s55, s55, 98304
    v_add_u32 v176, s55, v254
    v_lshrrev_b32 v224, 6, v254
    v_lshrrev_b32 v225, 1, v224
    buffer_load_dwordx4 v217, s[4:7], s94 offen offset:3072 lds
    s_add_u32 s94, s94, 32768
    s_and_b32 s94, s94, 262143
    v_and_b32 v225, 3, v225
    s_lshl_b32 s55, s44, 1
    v_xor_b32 v225, s55, v225
    v_lshlrev_b32 v225, 5, v225
    v_lshl_add_u32 v225, v224, 7, v225
    s_add_u32 m0, s62, 65536
    s_mul_i32 s59, s93, 112
    buffer_load_dwordx4 v207, s[28:31], s59 offen lds
    v_and_b32 v180, 0x30, v254
    v_lshrrev_b32 v180, 1, v180
    v_add_u32 v177, v225, v180
    buffer_load_dwordx4 v208, s[28:31], s59 offen offset:1024 lds
    v_xor_b32 v178, 32, v177
    v_lshrrev_b32 v225, 2, v224
    v_and_b32 v225, 1, v225
    v_xor_b32 v225, s44, v225
    buffer_load_dwordx4 v209, s[28:31], s59 offen offset:2048 lds
    v_lshlrev_b32 v225, 5, v225
    v_lshl_add_u32 v225, v224, 6, v225
    v_add_u32 v225, v225, v180
    buffer_load_dwordx4 v210, s[28:31], s59 offen offset:3072 lds
    s_add_u32 s93, s93, 2048
    s_and_b32 s93, s93, 65535
    v_add_u32 v179, 2048, v225
    v_add_u32 v180, 49152, v177
    v_add_u32 v181, 49152, v178
    v_add_u32 v182, 49152, v179
    s_waitcnt vmcnt(12)
    s_barrier
    s_add_u32 m0, s62, 114688
    s_nop 0
    buffer_load_dwordx4 v217, s[4:7], s94 offen lds
    buffer_load_dwordx4 v217, s[4:7], s94 offen offset:1024 lds
    s_add_u32 m0, s62, 81920
    s_mul_i32 s59, s93, 112
    buffer_load_dwordx4 v207, s[28:31], s59 offen lds
    buffer_load_dwordx4 v208, s[28:31], s59 offen offset:1024 lds
    buffer_load_dwordx4 v209, s[28:31], s59 offen offset:2048 lds
    buffer_load_dwordx4 v210, s[28:31], s59 offen offset:3072 lds
    s_add_u32 s93, s93, 6144
    s_and_b32 s93, s93, 65535
    s_waitcnt vmcnt(12) lgkmcnt(0)
    s_barrier
    s_add_u32 m0, s62, 114688
    s_nop 0
    buffer_load_dwordx4 v217, s[4:7], s94 offen offset:2048 lds
    s_lshl_b32 s55, s43, 9
    s_add_u32 s55, s55, 159744
    v_and_b32 v224, 0xf0, v254
    v_lshrrev_b32 v224, 1, v224
    v_add_u32 v224, s55, v224
    ds_read_b64 v[96:97], v224 offset:0
    ds_read_b64 v[98:99], v224 offset:128
    buffer_load_dwordx4 v217, s[4:7], s94 offen offset:3072 lds
    s_add_u32 s94, s94, 32768
    s_and_b32 s94, s94, 262143
    ds_read_b64 v[100:101], v224 offset:256
    ds_read_b64 v[102:103], v224 offset:384
    s_waitcnt lgkmcnt(0)
    s_add_u32 m0, s62, 0
    s_mul_i32 s59, s93, 112
    buffer_load_dwordx4 v207, s[28:31], s59 offen lds
    v_sub_f32 v196, 0, v96
    v_mul_f32 v184, 0xbfb8aa3b, v97
    v_mul_f32 v188, v97, v97
    v_sub_f32 v197, 0, v98
    buffer_load_dwordx4 v208, s[28:31], s59 offen offset:1024 lds
    v_mul_f32 v185, 0xbfb8aa3b, v99
    v_mul_f32 v189, v99, v99
    v_sub_f32 v198, 0, v100
    buffer_load_dwordx4 v209, s[28:31], s59 offen offset:2048 lds
    v_mul_f32 v186, 0xbfb8aa3b, v101
    v_mul_f32 v190, v101, v101
    v_sub_f32 v199, 0, v102
    buffer_load_dwordx4 v210, s[28:31], s59 offen offset:3072 lds
    s_add_u32 s93, s93, 2048
    s_and_b32 s93, s93, 65535
    v_mul_f32 v187, 0xbfb8aa3b, v103
    v_mul_f32 v191, v103, v103
    v_rcp_f32 v188, v188
    v_rcp_f32 v189, v189
    s_waitcnt vmcnt(12)
    s_barrier
    s_add_u32 m0, s62, 131072
    s_nop 0
    buffer_load_dwordx4 v217, s[4:7], s94 offen lds
    v_rcp_f32 v190, v190
    v_rcp_f32 v191, v191
    s_nop 0
    buffer_load_dwordx4 v217, s[4:7], s94 offen offset:1024 lds
    v_lshrrev_b32 v224, 8, v254
    v_lshlrev_b32 v224, 4, v224
    v_add_u32 v224, 162688, v224
    s_and_b32 s56, s41, 1
    s_add_u32 s55, s56, s44
    s_lshl_b32 s55, s55, 7
    v_add_u32 v225, s55, v224
    s_xor_b32 s56, s56, 1
    s_lshl_b32 s56, s56, 2
    s_add_u32 s56, s56, s44
    s_lshl_b32 s56, s56, 6
    v_add_u32 v224, s56, v224
    s_add_u32 m0, s62, 16384
    s_mul_i32 s59, s93, 112
    buffer_load_dwordx4 v207, s[28:31], s59 offen lds
    ds_read_b128 v[96:99], v225 offset:0
    ds_read_b128 v[100:103], v225 offset:64
    ds_read_b128 v[104:107], v224 offset:0
    buffer_load_dwordx4 v208, s[28:31], s59 offen offset:1024 lds
    ds_read_b128 v[108:111], v225 offset:512
    ds_read_b128 v[112:115], v225 offset:576
    ds_read_b128 v[116:119], v224 offset:512
    s_waitcnt lgkmcnt(0)
    buffer_load_dwordx4 v209, s[28:31], s59 offen offset:2048 lds
    v_mul_f32 v0, v196, v96
    v_mul_f32 v1, v196, v97
    v_mul_f32 v2, v196, v98
    buffer_load_dwordx4 v210, s[28:31], s59 offen offset:3072 lds
    s_add_u32 s93, s93, 6144
    s_and_b32 s93, s93, 65535
    v_mul_f32 v3, v196, v99
    v_mul_f32 v4, v197, v96
    v_mul_f32 v5, v197, v97
    v_mul_f32 v6, v197, v98
    s_waitcnt vmcnt(12)
    s_barrier
    s_add_u32 m0, s62, 131072
    s_nop 0
    buffer_load_dwordx4 v217, s[4:7], s94 offen offset:2048 lds
    v_mul_f32 v7, v197, v99
    v_mul_f32 v8, v198, v96
    v_mul_f32 v9, v198, v97
    v_mul_f32 v10, v198, v98
    buffer_load_dwordx4 v217, s[4:7], s94 offen offset:3072 lds
    s_add_u32 s94, s94, 32768
    s_and_b32 s94, s94, 262143
    v_mul_f32 v11, v198, v99
    v_mul_f32 v12, v199, v96
    v_mul_f32 v13, v199, v97
    v_mul_f32 v14, v199, v98
    s_add_u32 m0, s62, 32768
    s_mul_i32 s59, s93, 112
    buffer_load_dwordx4 v207, s[28:31], s59 offen lds
    v_mul_f32 v15, v199, v99
    v_mul_f32 v16, v196, v100
    v_mul_f32 v17, v196, v101
    v_mul_f32 v18, v196, v102
    buffer_load_dwordx4 v208, s[28:31], s59 offen offset:1024 lds
    v_mul_f32 v19, v196, v103
    v_mul_f32 v20, v197, v100
    v_mul_f32 v21, v197, v101
    v_mul_f32 v22, v197, v102
    buffer_load_dwordx4 v209, s[28:31], s59 offen offset:2048 lds
    v_mul_f32 v23, v197, v103
    v_mul_f32 v24, v198, v100
    v_mul_f32 v25, v198, v101
    v_mul_f32 v26, v198, v102
    buffer_load_dwordx4 v210, s[28:31], s59 offen offset:3072 lds
    s_add_u32 s93, s93, 2048
    s_and_b32 s93, s93, 65535
    v_mul_f32 v27, v198, v103
    v_mul_f32 v28, v199, v100
    v_mul_f32 v29, v199, v101
    v_mul_f32 v30, v199, v102
    s_waitcnt vmcnt(12)
    s_barrier
    s_add_u32 m0, s62, 98304
    s_nop 0
    buffer_load_dwordx4 v217, s[4:7], s94 offen lds
    v_mul_f32 v31, v199, v103
    v_mul_f32 v32, v196, v104
    v_mul_f32 v33, v196, v105
    v_mul_f32 v34, v196, v106
    buffer_load_dwordx4 v217, s[4:7], s94 offen offset:1024 lds
    v_mul_f32 v35, v196, v107
    v_mul_f32 v36, v197, v104
    v_mul_f32 v37, v197, v105
    v_mul_f32 v38, v197, v106
    s_add_u32 m0, s62, 49152
    s_mul_i32 s59, s93, 112
    buffer_load_dwordx4 v207, s[28:31], s59 offen lds
    v_mul_f32 v39, v197, v107
    v_mul_f32 v40, v198, v104
    v_mul_f32 v41, v198, v105
    v_mul_f32 v42, v198, v106
    buffer_load_dwordx4 v208, s[28:31], s59 offen offset:1024 lds
    v_mul_f32 v43, v198, v107
    v_mul_f32 v44, v199, v104
    v_mul_f32 v45, v199, v105
    v_mul_f32 v46, v199, v106
    buffer_load_dwordx4 v209, s[28:31], s59 offen offset:2048 lds
    v_mul_f32 v47, v199, v107
    v_mul_f32 v48, v196, v108
    v_mul_f32 v49, v196, v109
    v_mul_f32 v50, v196, v110
    buffer_load_dwordx4 v210, s[28:31], s59 offen offset:3072 lds
    s_add_u32 s93, s93, 6144
    s_and_b32 s93, s93, 65535
    v_mul_f32 v51, v196, v111
    v_mul_f32 v52, v197, v108
    v_mul_f32 v53, v197, v109
    v_mul_f32 v54, v197, v110
    s_waitcnt vmcnt(12)
    s_barrier
    s_add_u32 m0, s62, 98304
    s_nop 0
    buffer_load_dwordx4 v217, s[4:7], s94 offen offset:2048 lds
    v_mul_f32 v55, v197, v111
    v_mul_f32 v56, v198, v108
    v_mul_f32 v57, v198, v109
    v_mul_f32 v58, v198, v110
    buffer_load_dwordx4 v217, s[4:7], s94 offen offset:3072 lds
    v_mul_f32 v59, v198, v111
    v_mul_f32 v60, v199, v108
    v_mul_f32 v61, v199, v109
    v_mul_f32 v62, v199, v110
    s_add_u32 m0, s62, 65536
    s_mul_i32 s59, s93, 112
    buffer_load_dwordx4 v207, s[28:31], s59 offen lds
    v_mul_f32 v63, v199, v111
    v_mul_f32 v64, v196, v112
    v_mul_f32 v65, v196, v113
    v_mul_f32 v66, v196, v114
    buffer_load_dwordx4 v208, s[28:31], s59 offen offset:1024 lds
    v_mul_f32 v67, v196, v115
    v_mul_f32 v68, v197, v112
    v_mul_f32 v69, v197, v113
    v_mul_f32 v70, v197, v114
    buffer_load_dwordx4 v209, s[28:31], s59 offen offset:2048 lds
    v_mul_f32 v71, v197, v115
    v_mul_f32 v72, v198, v112
    v_mul_f32 v73, v198, v113
    v_mul_f32 v74, v198, v114
    buffer_load_dwordx4 v210, s[28:31], s59 offen offset:3072 lds
    s_add_u32 s93, s93, 2048
    s_and_b32 s93, s93, 65535
    v_mul_f32 v75, v198, v115
    v_mul_f32 v76, v199, v112
    v_mul_f32 v77, v199, v113
    v_mul_f32 v78, v199, v114
    s_waitcnt vmcnt(12)
    s_barrier
    s_add_u32 m0, s62, 81920
    s_mul_i32 s59, s93, 112
    buffer_load_dwordx4 v207, s[28:31], s59 offen lds
    v_mul_f32 v79, v199, v115
    v_mul_f32 v80, v196, v116
    buffer_load_dwordx4 v208, s[28:31], s59 offen offset:1024 lds
    v_mul_f32 v81, v196, v117
    v_mul_f32 v82, v196, v118
    buffer_load_dwordx4 v209, s[28:31], s59 offen offset:2048 lds
    v_mul_f32 v83, v196, v119
    v_mul_f32 v84, v197, v116
    buffer_load_dwordx4 v210, s[28:31], s59 offen offset:3072 lds
    v_mul_f32 v85, v197, v117
    v_mul_f32 v86, v197, v118
    s_add_u32 s93, s51, 11
    s_and_b32 s93, s93, 15
    s_lshl_b32 s93, s93, 12
    s_add_u32 m0, s61, 0
    s_mul_i32 s59, s93, 112
    buffer_load_dwordx4 v211, s[24:27], s59 offen lds
    v_mul_f32 v87, v197, v119
    v_mul_f32 v88, v198, v116
    buffer_load_dwordx4 v212, s[24:27], s59 offen offset:1024 lds
    v_mul_f32 v89, v198, v117
    v_mul_f32 v90, v198, v118
    buffer_load_dwordx4 v222, s[4:7], s93 offen offset:2048 lds
    s_add_u32 s93, s93, 2048
    s_and_b32 s93, s93, 65535
    v_mul_f32 v91, v198, v119
    v_mul_f32 v92, v199, v116
    s_add_u32 m0, s61, 16384
    s_mul_i32 s59, s93, 112
    buffer_load_dwordx4 v211, s[24:27], s59 offen lds
    v_mul_f32 v93, v199, v117
    v_mul_f32 v94, v199, v118
    v_mul_f32 v95, v199, v119
    s_waitcnt vmcnt(14)
    s_barrier
    s_add_u32 m0, s61, 16384
    s_nop 0
    buffer_load_dwordx4 v212, s[24:27], s59 offen offset:1024 lds
    buffer_load_dwordx4 v222, s[4:7], s93 offen offset:2048 lds
    s_add_u32 s93, s93, 6144
    s_and_b32 s93, s93, 65535
    s_add_u32 m0, s61, 32768
    s_mul_i32 s59, s93, 112
    buffer_load_dwordx4 v211, s[24:27], s59 offen lds
    buffer_load_dwordx4 v212, s[24:27], s59 offen offset:1024 lds
    buffer_load_dwordx4 v222, s[4:7], s93 offen offset:2048 lds
    s_add_u32 s93, s93, 2048
    s_and_b32 s93, s93, 65535
    s_waitcnt vmcnt(13)
    s_barrier
    s_add_u32 m0, s61, 49152
    s_mul_i32 s59, s93, 112
    buffer_load_dwordx4 v211, s[24:27], s59 offen lds
    buffer_load_dwordx4 v212, s[24:27], s59 offen offset:1024 lds
    buffer_load_dwordx4 v222, s[4:7], s93 offen offset:2048 lds
    s_add_u32 s93, s93, 6144
    s_and_b32 s93, s93, 65535
    s_waitcnt vmcnt(12)
    s_barrier
    s_add_u32 m0, s61, 65536
    s_mul_i32 s59, s93, 112
    buffer_load_dwordx4 v211, s[24:27], s59 offen lds
    buffer_load_dwordx4 v212, s[24:27], s59 offen offset:1024 lds
    buffer_load_dwordx4 v222, s[4:7], s93 offen offset:2048 lds
    s_add_u32 s93, s93, 2048
    s_and_b32 s93, s93, 65535
    s_waitcnt vmcnt(12)
    s_barrier
    s_add_u32 m0, s61, 81920
    s_mul_i32 s59, s93, 112
    buffer_load_dwordx4 v211, s[24:27], s59 offen lds
    buffer_load_dwordx4 v212, s[24:27], s59 offen offset:1024 lds
    buffer_load_dwordx4 v222, s[4:7], s93 offen offset:2048 lds
    s_add_u32 s93, s93, 2048
    s_and_b32 s93, s93, 65535
    s_setprio 0
    ds_read_b64_tr_b16 v[128:129], v177 offset:0
    ds_read_b64_tr_b16 v[130:131], v177 offset:3072
    ds_read_b128 v[96:99], v176 offset:16384
    ds_read_b128 v[100:103], v176 offset:18432
    ds_read_b128 v[104:107], v176 offset:20480
    ds_read_b128 v[108:111], v176 offset:22528
    ds_read_b64_tr_b16 v[140:141], v177 offset:6144
    ds_read_b64_tr_b16 v[142:143], v177 offset:9216
    ds_read_b64_tr_b16 v[132:133], v178 offset:0
    ds_read_b64_tr_b16 v[134:135], v178 offset:3072
    ds_read_b64_tr_b16 v[144:145], v178 offset:6144
    ds_read_b64_tr_b16 v[146:147], v178 offset:9216
    ds_read_b64_tr_b16 v[136:137], v179 offset:0
    ds_read_b64_tr_b16 v[138:139], v179 offset:3072
    ds_read_b64_tr_b16 v[148:149], v179 offset:6144
    ds_read_b64_tr_b16 v[150:151], v179 offset:9216
    s_add_u32 s88, s95, s62
    v_add_u32 v217, s88, v254
    s_mov_b32 s58, 5
    s_waitcnt vmcnt(12) lgkmcnt(0)
    s_barrier
    .p2align 3
    v_mfma_f32_16x16x32_bf16 v[0:3], v[128:131], v[96:99], v[0:3]
    ds_read_b64_tr_b16 v[152:153], v177 offset:16384
    v_mfma_f32_16x16x32_bf16 v[4:7], v[128:131], v[100:103], v[4:7]
    ds_read_b64_tr_b16 v[154:155], v177 offset:19456
    v_mfma_f32_16x16x32_bf16 v[8:11], v[128:131], v[104:107], v[8:11]
    ds_read_b128 v[112:115], v176 offset:17408
    v_mfma_f32_16x16x32_bf16 v[12:15], v[128:131], v[108:111], v[12:15]
    ds_read_b128 v[116:119], v176 offset:19456
    v_mfma_f32_16x16x32_bf16 v[60:63], v[140:143], v[108:111], v[60:63]
    ds_read_b128 v[120:123], v176 offset:21504
    v_mfma_f32_16x16x32_bf16 v[56:59], v[140:143], v[104:107], v[56:59]
    ds_read_b128 v[124:127], v176 offset:23552
    v_mfma_f32_16x16x32_bf16 v[52:55], v[140:143], v[100:103], v[52:55]
    ds_read_b64_tr_b16 v[164:165], v177 offset:22528
    v_mfma_f32_16x16x32_bf16 v[48:51], v[140:143], v[96:99], v[48:51]
    ds_read_b64_tr_b16 v[166:167], v177 offset:25600
    v_mfma_f32_16x16x32_bf16 v[16:19], v[132:135], v[96:99], v[16:19]
    v_mfma_f32_16x16x32_bf16 v[20:23], v[132:135], v[100:103], v[20:23]
    ds_read_b64_tr_b16 v[156:157], v178 offset:16384
    v_mfma_f32_16x16x32_bf16 v[24:27], v[132:135], v[104:107], v[24:27]
    ds_read_b64_tr_b16 v[158:159], v178 offset:19456
    v_mfma_f32_16x16x32_bf16 v[28:31], v[132:135], v[108:111], v[28:31]
    ds_read_b64_tr_b16 v[168:169], v178 offset:22528
    v_mfma_f32_16x16x32_bf16 v[76:79], v[144:147], v[108:111], v[76:79]
    ds_read_b64_tr_b16 v[170:171], v178 offset:25600
    v_mfma_f32_16x16x32_bf16 v[72:75], v[144:147], v[104:107], v[72:75]
    ds_read_b64_tr_b16 v[160:161], v179 offset:16384
    v_mfma_f32_16x16x32_bf16 v[68:71], v[144:147], v[100:103], v[68:71]
    ds_read_b64_tr_b16 v[162:163], v179 offset:19456
    v_mfma_f32_16x16x32_bf16 v[64:67], v[144:147], v[96:99], v[64:67]
    ds_read_b64_tr_b16 v[172:173], v179 offset:22528
    v_mfma_f32_16x16x32_bf16 v[32:35], v[136:139], v[96:99], v[32:35]
    ds_read_b64_tr_b16 v[174:175], v179 offset:25600
    v_mfma_f32_16x16x32_bf16 v[36:39], v[136:139], v[100:103], v[36:39]
    v_mfma_f32_16x16x32_bf16 v[40:43], v[136:139], v[104:107], v[40:43]
    v_mfma_f32_16x16x32_bf16 v[44:47], v[136:139], v[108:111], v[44:47]
    v_mfma_f32_16x16x32_bf16 v[92:95], v[148:151], v[108:111], v[92:95]
    v_mfma_f32_16x16x32_bf16 v[88:91], v[148:151], v[104:107], v[88:91]
    v_mfma_f32_16x16x32_bf16 v[84:87], v[148:151], v[100:103], v[84:87]
    v_mfma_f32_16x16x32_bf16 v[80:83], v[148:151], v[96:99], v[80:83]
    .p2align 3
loop_87:
    s_waitcnt vmcnt(9) lgkmcnt(0)
    s_barrier
    .p2align 3
    v_mfma_f32_16x16x32_bf16 v[0:3], v[152:155], v[112:115], v[0:3]
    ds_read_b64_tr_b16 v[128:129], v177 offset:32768
    v_mfma_f32_16x16x32_bf16 v[4:7], v[152:155], v[116:119], v[4:7]
    ds_read_b64_tr_b16 v[130:131], v177 offset:35840
    v_mfma_f32_16x16x32_bf16 v[8:11], v[152:155], v[120:123], v[8:11]
    ds_read_b128 v[96:99], v176 offset:32768
    v_mfma_f32_16x16x32_bf16 v[12:15], v[152:155], v[124:127], v[12:15]
    ds_read_b128 v[100:103], v176 offset:34816
    v_mfma_f32_16x16x32_bf16 v[60:63], v[164:167], v[124:127], v[60:63]
    ds_read_b128 v[104:107], v176 offset:36864
    v_mfma_f32_16x16x32_bf16 v[56:59], v[164:167], v[120:123], v[56:59]
    ds_read_b128 v[108:111], v176 offset:38912
    v_mfma_f32_16x16x32_bf16 v[52:55], v[164:167], v[116:119], v[52:55]
    ds_read_b64_tr_b16 v[140:141], v177 offset:38912
    v_mfma_f32_16x16x32_bf16 v[48:51], v[164:167], v[112:115], v[48:51]
    ds_read_b64_tr_b16 v[142:143], v177 offset:41984
    v_mfma_f32_16x16x32_bf16 v[16:19], v[156:159], v[112:115], v[16:19]
    v_mfma_f32_16x16x32_bf16 v[20:23], v[156:159], v[116:119], v[20:23]
    ds_read_b64_tr_b16 v[132:133], v178 offset:32768
    v_mfma_f32_16x16x32_bf16 v[24:27], v[156:159], v[120:123], v[24:27]
    ds_read_b64_tr_b16 v[134:135], v178 offset:35840
    v_mfma_f32_16x16x32_bf16 v[28:31], v[156:159], v[124:127], v[28:31]
    ds_read_b64_tr_b16 v[144:145], v178 offset:38912
    v_mfma_f32_16x16x32_bf16 v[76:79], v[168:171], v[124:127], v[76:79]
    ds_read_b64_tr_b16 v[146:147], v178 offset:41984
    v_mfma_f32_16x16x32_bf16 v[72:75], v[168:171], v[120:123], v[72:75]
    ds_read_b64_tr_b16 v[136:137], v179 offset:32768
    v_mfma_f32_16x16x32_bf16 v[68:71], v[168:171], v[116:119], v[68:71]
    ds_read_b64_tr_b16 v[138:139], v179 offset:35840
    v_mfma_f32_16x16x32_bf16 v[64:67], v[168:171], v[112:115], v[64:67]
    ds_read_b64_tr_b16 v[148:149], v179 offset:38912
    v_mfma_f32_16x16x32_bf16 v[32:35], v[160:163], v[112:115], v[32:35]
    ds_read_b64_tr_b16 v[150:151], v179 offset:41984
    v_mfma_f32_16x16x32_bf16 v[36:39], v[160:163], v[116:119], v[36:39]
    v_mfma_f32_16x16x32_bf16 v[40:43], v[160:163], v[120:123], v[40:43]
    v_mfma_f32_16x16x32_bf16 v[44:47], v[160:163], v[124:127], v[44:47]
    v_mfma_f32_16x16x32_bf16 v[92:95], v[172:175], v[124:127], v[92:95]
    v_mfma_f32_16x16x32_bf16 v[88:91], v[172:175], v[120:123], v[88:91]
    v_mfma_f32_16x16x32_bf16 v[84:87], v[172:175], v[116:119], v[84:87]
    v_mfma_f32_16x16x32_bf16 v[80:83], v[172:175], v[112:115], v[80:83]
    s_waitcnt vmcnt(6) lgkmcnt(0)
    s_barrier
    .p2align 3
    v_mfma_f32_16x16x32_bf16 v[0:3], v[128:131], v[96:99], v[0:3]
    ds_read_b64_tr_b16 v[152:153], v180 offset:0
    v_mfma_f32_16x16x32_bf16 v[4:7], v[128:131], v[100:103], v[4:7]
    ds_read_b64_tr_b16 v[154:155], v180 offset:3072
    v_mfma_f32_16x16x32_bf16 v[8:11], v[128:131], v[104:107], v[8:11]
    ds_read_b128 v[112:115], v176 offset:33792
    v_mfma_f32_16x16x32_bf16 v[12:15], v[128:131], v[108:111], v[12:15]
    ds_read_b128 v[116:119], v176 offset:35840
    v_mfma_f32_16x16x32_bf16 v[60:63], v[140:143], v[108:111], v[60:63]
    ds_read_b128 v[120:123], v176 offset:37888
    v_mfma_f32_16x16x32_bf16 v[56:59], v[140:143], v[104:107], v[56:59]
    ds_read_b128 v[124:127], v176 offset:39936
    v_mfma_f32_16x16x32_bf16 v[52:55], v[140:143], v[100:103], v[52:55]
    ds_read_b64_tr_b16 v[164:165], v180 offset:6144
    v_mfma_f32_16x16x32_bf16 v[48:51], v[140:143], v[96:99], v[48:51]
    ds_read_b64_tr_b16 v[166:167], v180 offset:9216
    v_mfma_f32_16x16x32_bf16 v[16:19], v[132:135], v[96:99], v[16:19]
    v_mfma_f32_16x16x32_bf16 v[20:23], v[132:135], v[100:103], v[20:23]
    ds_read_b64_tr_b16 v[156:157], v181 offset:0
    v_mfma_f32_16x16x32_bf16 v[24:27], v[132:135], v[104:107], v[24:27]
    ds_read_b64_tr_b16 v[158:159], v181 offset:3072
    v_mfma_f32_16x16x32_bf16 v[28:31], v[132:135], v[108:111], v[28:31]
    ds_read_b64_tr_b16 v[168:169], v181 offset:6144
    v_mfma_f32_16x16x32_bf16 v[76:79], v[144:147], v[108:111], v[76:79]
    ds_read_b64_tr_b16 v[170:171], v181 offset:9216
    v_mfma_f32_16x16x32_bf16 v[72:75], v[144:147], v[104:107], v[72:75]
    ds_read_b64_tr_b16 v[160:161], v182 offset:0
    v_mfma_f32_16x16x32_bf16 v[68:71], v[144:147], v[100:103], v[68:71]
    ds_read_b64_tr_b16 v[162:163], v182 offset:3072
    v_mfma_f32_16x16x32_bf16 v[64:67], v[144:147], v[96:99], v[64:67]
    ds_read_b64_tr_b16 v[172:173], v182 offset:6144
    v_mfma_f32_16x16x32_bf16 v[32:35], v[136:139], v[96:99], v[32:35]
    ds_read_b64_tr_b16 v[174:175], v182 offset:9216
    v_mfma_f32_16x16x32_bf16 v[36:39], v[136:139], v[100:103], v[36:39]
    v_mfma_f32_16x16x32_bf16 v[40:43], v[136:139], v[104:107], v[40:43]
    v_mfma_f32_16x16x32_bf16 v[44:47], v[136:139], v[108:111], v[44:47]
    v_mfma_f32_16x16x32_bf16 v[92:95], v[148:151], v[108:111], v[92:95]
    v_mfma_f32_16x16x32_bf16 v[88:91], v[148:151], v[104:107], v[88:91]
    v_mfma_f32_16x16x32_bf16 v[84:87], v[148:151], v[100:103], v[84:87]
    v_mfma_f32_16x16x32_bf16 v[80:83], v[148:151], v[96:99], v[80:83]
    s_waitcnt vmcnt(3) lgkmcnt(0)
    s_barrier
    .p2align 3
    v_mfma_f32_16x16x32_bf16 v[0:3], v[152:155], v[112:115], v[0:3]
    ds_read_b64_tr_b16 v[128:129], v180 offset:16384
    v_mfma_f32_16x16x32_bf16 v[4:7], v[152:155], v[116:119], v[4:7]
    ds_read_b64_tr_b16 v[130:131], v180 offset:19456
    v_mfma_f32_16x16x32_bf16 v[8:11], v[152:155], v[120:123], v[8:11]
    ds_read_b128 v[96:99], v176 offset:0
    v_mfma_f32_16x16x32_bf16 v[12:15], v[152:155], v[124:127], v[12:15]
    ds_read_b128 v[100:103], v176 offset:2048
    v_mfma_f32_16x16x32_bf16 v[60:63], v[164:167], v[124:127], v[60:63]
    ds_read_b128 v[104:107], v176 offset:4096
    v_mfma_f32_16x16x32_bf16 v[56:59], v[164:167], v[120:123], v[56:59]
    ds_read_b128 v[108:111], v176 offset:6144
    v_mfma_f32_16x16x32_bf16 v[52:55], v[164:167], v[116:119], v[52:55]
    ds_read_b64_tr_b16 v[140:141], v180 offset:22528
    v_mfma_f32_16x16x32_bf16 v[48:51], v[164:167], v[112:115], v[48:51]
    ds_read_b64_tr_b16 v[142:143], v180 offset:25600
    v_mfma_f32_16x16x32_bf16 v[16:19], v[156:159], v[112:115], v[16:19]
    v_mfma_f32_16x16x32_bf16 v[20:23], v[156:159], v[116:119], v[20:23]
    ds_read_b64_tr_b16 v[132:133], v181 offset:16384
    v_mfma_f32_16x16x32_bf16 v[24:27], v[156:159], v[120:123], v[24:27]
    ds_read_b64_tr_b16 v[134:135], v181 offset:19456
    v_mfma_f32_16x16x32_bf16 v[28:31], v[156:159], v[124:127], v[28:31]
    ds_read_b64_tr_b16 v[144:145], v181 offset:22528
    v_mfma_f32_16x16x32_bf16 v[76:79], v[168:171], v[124:127], v[76:79]
    ds_read_b64_tr_b16 v[146:147], v181 offset:25600
    v_mfma_f32_16x16x32_bf16 v[72:75], v[168:171], v[120:123], v[72:75]
    ds_read_b64_tr_b16 v[136:137], v182 offset:16384
    v_mfma_f32_16x16x32_bf16 v[68:71], v[168:171], v[116:119], v[68:71]
    ds_read_b64_tr_b16 v[138:139], v182 offset:19456
    v_mfma_f32_16x16x32_bf16 v[64:67], v[168:171], v[112:115], v[64:67]
    ds_read_b64_tr_b16 v[148:149], v182 offset:22528
    v_mfma_f32_16x16x32_bf16 v[32:35], v[160:163], v[112:115], v[32:35]
    ds_read_b64_tr_b16 v[150:151], v182 offset:25600
    v_mfma_f32_16x16x32_bf16 v[36:39], v[160:163], v[116:119], v[36:39]
    v_mfma_f32_16x16x32_bf16 v[40:43], v[160:163], v[120:123], v[40:43]
    v_mfma_f32_16x16x32_bf16 v[44:47], v[160:163], v[124:127], v[44:47]
    v_mfma_f32_16x16x32_bf16 v[92:95], v[172:175], v[124:127], v[92:95]
    v_mfma_f32_16x16x32_bf16 v[88:91], v[172:175], v[120:123], v[88:91]
    v_mfma_f32_16x16x32_bf16 v[84:87], v[172:175], v[116:119], v[84:87]
    v_mfma_f32_16x16x32_bf16 v[80:83], v[172:175], v[112:115], v[80:83]
    s_waitcnt vmcnt(0) lgkmcnt(0)
    s_barrier
    .p2align 3
    v_mfma_f32_16x16x32_bf16 v[0:3], v[128:131], v[96:99], v[0:3]
    ds_read_b64_tr_b16 v[152:153], v180 offset:32768
    v_mfma_f32_16x16x32_bf16 v[4:7], v[128:131], v[100:103], v[4:7]
    ds_read_b64_tr_b16 v[154:155], v180 offset:35840
    v_mfma_f32_16x16x32_bf16 v[8:11], v[128:131], v[104:107], v[8:11]
    ds_read_b128 v[112:115], v176 offset:1024
    v_mfma_f32_16x16x32_bf16 v[12:15], v[128:131], v[108:111], v[12:15]
    ds_read_b128 v[116:119], v176 offset:3072
    v_mfma_f32_16x16x32_bf16 v[60:63], v[140:143], v[108:111], v[60:63]
    ds_read_b128 v[120:123], v176 offset:5120
    v_mfma_f32_16x16x32_bf16 v[56:59], v[140:143], v[104:107], v[56:59]
    ds_read_b128 v[124:127], v176 offset:7168
    v_mfma_f32_16x16x32_bf16 v[52:55], v[140:143], v[100:103], v[52:55]
    ds_read_b64_tr_b16 v[164:165], v180 offset:38912
    v_mfma_f32_16x16x32_bf16 v[48:51], v[140:143], v[96:99], v[48:51]
    ds_read_b64_tr_b16 v[166:167], v180 offset:41984
    v_mfma_f32_16x16x32_bf16 v[16:19], v[132:135], v[96:99], v[16:19]
    v_mfma_f32_16x16x32_bf16 v[20:23], v[132:135], v[100:103], v[20:23]
    ds_read_b64_tr_b16 v[156:157], v181 offset:32768
    v_mfma_f32_16x16x32_bf16 v[24:27], v[132:135], v[104:107], v[24:27]
    ds_read_b64_tr_b16 v[158:159], v181 offset:35840
    v_mfma_f32_16x16x32_bf16 v[28:31], v[132:135], v[108:111], v[28:31]
    ds_read_b64_tr_b16 v[168:169], v181 offset:38912
    v_mfma_f32_16x16x32_bf16 v[76:79], v[144:147], v[108:111], v[76:79]
    ds_read_b64_tr_b16 v[170:171], v181 offset:41984
    v_mfma_f32_16x16x32_bf16 v[72:75], v[144:147], v[104:107], v[72:75]
    ds_read_b64_tr_b16 v[160:161], v182 offset:32768
    v_mfma_f32_16x16x32_bf16 v[68:71], v[144:147], v[100:103], v[68:71]
    ds_read_b64_tr_b16 v[162:163], v182 offset:35840
    v_mfma_f32_16x16x32_bf16 v[64:67], v[144:147], v[96:99], v[64:67]
    ds_read_b64_tr_b16 v[172:173], v182 offset:38912
    v_mfma_f32_16x16x32_bf16 v[32:35], v[136:139], v[96:99], v[32:35]
    ds_read_b64_tr_b16 v[174:175], v182 offset:41984
    v_mfma_f32_16x16x32_bf16 v[36:39], v[136:139], v[100:103], v[36:39]
    v_mfma_f32_16x16x32_bf16 v[40:43], v[136:139], v[104:107], v[40:43]
    v_mfma_f32_16x16x32_bf16 v[44:47], v[136:139], v[108:111], v[44:47]
    v_mfma_f32_16x16x32_bf16 v[92:95], v[148:151], v[108:111], v[92:95]
    v_mfma_f32_16x16x32_bf16 v[88:91], v[148:151], v[104:107], v[88:91]
    v_mfma_f32_16x16x32_bf16 v[84:87], v[148:151], v[100:103], v[84:87]
    v_mfma_f32_16x16x32_bf16 v[80:83], v[148:151], v[96:99], v[80:83]
    s_waitcnt lgkmcnt(0)
    s_barrier
    .p2align 3
    v_mfma_f32_16x16x32_bf16 v[0:3], v[152:155], v[112:115], v[0:3]
    ds_read_b64_tr_b16 v[128:129], v177 offset:0
    v_mfma_f32_16x16x32_bf16 v[4:7], v[152:155], v[116:119], v[4:7]
    ds_read_b64_tr_b16 v[130:131], v177 offset:3072
    v_mfma_f32_16x16x32_bf16 v[8:11], v[152:155], v[120:123], v[8:11]
    ds_read_b128 v[96:99], v176 offset:16384
    v_mfma_f32_16x16x32_bf16 v[12:15], v[152:155], v[124:127], v[12:15]
    ds_read_b128 v[100:103], v176 offset:18432
    v_mfma_f32_16x16x32_bf16 v[60:63], v[164:167], v[124:127], v[60:63]
    ds_read_b128 v[104:107], v176 offset:20480
    v_mfma_f32_16x16x32_bf16 v[56:59], v[164:167], v[120:123], v[56:59]
    ds_read_b128 v[108:111], v176 offset:22528
    v_mfma_f32_16x16x32_bf16 v[52:55], v[164:167], v[116:119], v[52:55]
    ds_read_b64_tr_b16 v[140:141], v177 offset:6144
    v_mfma_f32_16x16x32_bf16 v[48:51], v[164:167], v[112:115], v[48:51]
    ds_read_b64_tr_b16 v[142:143], v177 offset:9216
    v_mfma_f32_16x16x32_bf16 v[16:19], v[156:159], v[112:115], v[16:19]
    v_mfma_f32_16x16x32_bf16 v[20:23], v[156:159], v[116:119], v[20:23]
    ds_read_b64_tr_b16 v[132:133], v178 offset:0
    v_mfma_f32_16x16x32_bf16 v[24:27], v[156:159], v[120:123], v[24:27]
    ds_read_b64_tr_b16 v[134:135], v178 offset:3072
    v_mfma_f32_16x16x32_bf16 v[28:31], v[156:159], v[124:127], v[28:31]
    ds_read_b64_tr_b16 v[144:145], v178 offset:6144
    v_mfma_f32_16x16x32_bf16 v[76:79], v[168:171], v[124:127], v[76:79]
    ds_read_b64_tr_b16 v[146:147], v178 offset:9216
    v_mfma_f32_16x16x32_bf16 v[72:75], v[168:171], v[120:123], v[72:75]
    ds_read_b64_tr_b16 v[136:137], v179 offset:0
    v_mfma_f32_16x16x32_bf16 v[68:71], v[168:171], v[116:119], v[68:71]
    ds_read_b64_tr_b16 v[138:139], v179 offset:3072
    v_mfma_f32_16x16x32_bf16 v[64:67], v[168:171], v[112:115], v[64:67]
    ds_read_b64_tr_b16 v[148:149], v179 offset:6144
    v_mfma_f32_16x16x32_bf16 v[32:35], v[160:163], v[112:115], v[32:35]
    ds_read_b64_tr_b16 v[150:151], v179 offset:9216
    v_mfma_f32_16x16x32_bf16 v[36:39], v[160:163], v[116:119], v[36:39]
    v_mfma_f32_16x16x32_bf16 v[40:43], v[160:163], v[120:123], v[40:43]
    v_mfma_f32_16x16x32_bf16 v[44:47], v[160:163], v[124:127], v[44:47]
    v_mfma_f32_16x16x32_bf16 v[92:95], v[172:175], v[124:127], v[92:95]
    v_mfma_f32_16x16x32_bf16 v[88:91], v[172:175], v[120:123], v[88:91]
    v_mfma_f32_16x16x32_bf16 v[84:87], v[172:175], v[116:119], v[84:87]
    v_mfma_f32_16x16x32_bf16 v[80:83], v[172:175], v[112:115], v[80:83]
    s_waitcnt lgkmcnt(0)
    s_barrier
    .p2align 3
    v_mfma_f32_16x16x32_bf16 v[0:3], v[128:131], v[96:99], v[0:3]
    ds_read_b64_tr_b16 v[152:153], v177 offset:16384
    v_mfma_f32_16x16x32_bf16 v[4:7], v[128:131], v[100:103], v[4:7]
    ds_read_b64_tr_b16 v[154:155], v177 offset:19456
    v_mfma_f32_16x16x32_bf16 v[8:11], v[128:131], v[104:107], v[8:11]
    ds_read_b128 v[112:115], v176 offset:17408
    v_mfma_f32_16x16x32_bf16 v[12:15], v[128:131], v[108:111], v[12:15]
    ds_read_b128 v[116:119], v176 offset:19456
    v_mfma_f32_16x16x32_bf16 v[60:63], v[140:143], v[108:111], v[60:63]
    ds_read_b128 v[120:123], v176 offset:21504
    v_mfma_f32_16x16x32_bf16 v[56:59], v[140:143], v[104:107], v[56:59]
    ds_read_b128 v[124:127], v176 offset:23552
    v_mfma_f32_16x16x32_bf16 v[52:55], v[140:143], v[100:103], v[52:55]
    ds_read_b64_tr_b16 v[164:165], v177 offset:22528
    v_mfma_f32_16x16x32_bf16 v[48:51], v[140:143], v[96:99], v[48:51]
    ds_read_b64_tr_b16 v[166:167], v177 offset:25600
    v_mfma_f32_16x16x32_bf16 v[16:19], v[132:135], v[96:99], v[16:19]
    v_mfma_f32_16x16x32_bf16 v[20:23], v[132:135], v[100:103], v[20:23]
    ds_read_b64_tr_b16 v[156:157], v178 offset:16384
    v_mfma_f32_16x16x32_bf16 v[24:27], v[132:135], v[104:107], v[24:27]
    ds_read_b64_tr_b16 v[158:159], v178 offset:19456
    v_mfma_f32_16x16x32_bf16 v[28:31], v[132:135], v[108:111], v[28:31]
    ds_read_b64_tr_b16 v[168:169], v178 offset:22528
    v_mfma_f32_16x16x32_bf16 v[76:79], v[144:147], v[108:111], v[76:79]
    ds_read_b64_tr_b16 v[170:171], v178 offset:25600
    v_mfma_f32_16x16x32_bf16 v[72:75], v[144:147], v[104:107], v[72:75]
    ds_read_b64_tr_b16 v[160:161], v179 offset:16384
    v_mfma_f32_16x16x32_bf16 v[68:71], v[144:147], v[100:103], v[68:71]
    ds_read_b64_tr_b16 v[162:163], v179 offset:19456
    v_mfma_f32_16x16x32_bf16 v[64:67], v[144:147], v[96:99], v[64:67]
    ds_read_b64_tr_b16 v[172:173], v179 offset:22528
    v_mfma_f32_16x16x32_bf16 v[32:35], v[136:139], v[96:99], v[32:35]
    ds_read_b64_tr_b16 v[174:175], v179 offset:25600
    v_mfma_f32_16x16x32_bf16 v[36:39], v[136:139], v[100:103], v[36:39]
    v_mfma_f32_16x16x32_bf16 v[40:43], v[136:139], v[104:107], v[40:43]
    v_mfma_f32_16x16x32_bf16 v[44:47], v[136:139], v[108:111], v[44:47]
    v_mfma_f32_16x16x32_bf16 v[92:95], v[148:151], v[108:111], v[92:95]
    s_sub_u32 s58, s58, 1
    s_cmp_lg_u32 s58, 0
    .p2align 3
    v_mfma_f32_16x16x32_bf16 v[88:91], v[148:151], v[104:107], v[88:91]
    v_mfma_f32_16x16x32_bf16 v[84:87], v[148:151], v[100:103], v[84:87]
    v_mfma_f32_16x16x32_bf16 v[80:83], v[148:151], v[96:99], v[80:83]
    s_cbranch_scc1 loop_87
    s_waitcnt lgkmcnt(0)
    s_barrier
    .p2align 3
    v_mfma_f32_16x16x32_bf16 v[0:3], v[152:155], v[112:115], v[0:3]
    v_mfma_f32_16x16x32_bf16 v[4:7], v[152:155], v[116:119], v[4:7]
    v_mfma_f32_16x16x32_bf16 v[8:11], v[152:155], v[120:123], v[8:11]
    v_mfma_f32_16x16x32_bf16 v[12:15], v[152:155], v[124:127], v[12:15]
    v_mfma_f32_16x16x32_bf16 v[60:63], v[164:167], v[124:127], v[60:63]
    v_mfma_f32_16x16x32_bf16 v[56:59], v[164:167], v[120:123], v[56:59]
    v_mfma_f32_16x16x32_bf16 v[52:55], v[164:167], v[116:119], v[52:55]
    v_mfma_f32_16x16x32_bf16 v[48:51], v[164:167], v[112:115], v[48:51]
    v_mfma_f32_16x16x32_bf16 v[16:19], v[156:159], v[112:115], v[16:19]
    v_mfma_f32_16x16x32_bf16 v[20:23], v[156:159], v[116:119], v[20:23]
    v_mfma_f32_16x16x32_bf16 v[24:27], v[156:159], v[120:123], v[24:27]
    v_mfma_f32_16x16x32_bf16 v[28:31], v[156:159], v[124:127], v[28:31]
    v_mfma_f32_16x16x32_bf16 v[76:79], v[168:171], v[124:127], v[76:79]
    v_mfma_f32_16x16x32_bf16 v[72:75], v[168:171], v[120:123], v[72:75]
    v_mfma_f32_16x16x32_bf16 v[68:71], v[168:171], v[116:119], v[68:71]
    v_mfma_f32_16x16x32_bf16 v[64:67], v[168:171], v[112:115], v[64:67]
    v_mfma_f32_16x16x32_bf16 v[32:35], v[160:163], v[112:115], v[32:35]
    v_mfma_f32_16x16x32_bf16 v[36:39], v[160:163], v[116:119], v[36:39]
    v_mfma_f32_16x16x32_bf16 v[40:43], v[160:163], v[120:123], v[40:43]
    v_mfma_f32_16x16x32_bf16 v[44:47], v[160:163], v[124:127], v[44:47]
    v_mfma_f32_16x16x32_bf16 v[92:95], v[172:175], v[124:127], v[92:95]
    v_mfma_f32_16x16x32_bf16 v[88:91], v[172:175], v[120:123], v[88:91]
    v_mfma_f32_16x16x32_bf16 v[84:87], v[172:175], v[116:119], v[84:87]
    v_mfma_f32_16x16x32_bf16 v[80:83], v[172:175], v[112:115], v[80:83]
    s_setprio 1
    s_barrier
    s_add_u32 m0, s62, 131072
    s_mov_b32 s92, 49152
    buffer_load_dwordx4 v217, s[4:7], s92 offen lds
    s_nop 7
    v_mul_f32 v96, v184, v0
    v_mul_f32 v97, v184, v1
    buffer_load_dwordx4 v217, s[4:7], s92 offen offset:1024 lds
    v_mul_f32 v98, v184, v2
    v_mul_f32 v99, v184, v3
    v_exp_f32 v96, v96
    v_exp_f32 v97, v97
    buffer_load_dwordx4 v217, s[4:7], s92 offen offset:2048 lds
    v_exp_f32 v98, v98
    v_exp_f32 v99, v99
    v_mul_f32 v0, v0, v48
    v_mul_f32 v1, v1, v49
    buffer_load_dwordx4 v217, s[4:7], s92 offen offset:3072 lds
    v_mul_f32 v2, v2, v50
    v_mul_f32 v3, v3, v51
    v_fma_f32 v96, v96, v188, v188
    v_fma_f32 v97, v97, v188, v188
    s_add_u32 m0, s62, 16384
    s_add_u32 s59, s68, 2490368
    buffer_load_dwordx4 v213, s[20:23], s59 offen lds
    v_fma_f32 v98, v98, v188, v188
    v_fma_f32 v99, v99, v188, v188
    v_rcp_f32 v96, v96
    v_rcp_f32 v97, v97
    buffer_load_dwordx4 v214, s[20:23], s59 offen offset:1024 lds
    v_rcp_f32 v98, v98
    v_rcp_f32 v99, v99
    v_mul_f32 v0, v0, v96
    v_mul_f32 v1, v1, v97
    buffer_load_dwordx4 v215, s[20:23], s59 offen offset:2048 lds
    v_mul_f32 v2, v2, v98
    v_mul_f32 v3, v3, v99
    v_cvt_pk_bf16_f32 v100, v0, v1
    v_cvt_pk_bf16_f32 v101, v2, v3
    buffer_load_dwordx4 v216, s[20:23], s59 offen offset:3072 lds
    v_mul_f32 v96, v184, v16
    v_mul_f32 v97, v184, v17
    v_mul_f32 v98, v184, v18
    v_mul_f32 v99, v184, v19
    s_barrier
    s_add_u32 m0, s62, 98304
    s_mov_b32 s92, 65536
    buffer_load_dwordx4 v217, s[4:7], s92 offen lds
    v_exp_f32 v96, v96
    v_exp_f32 v97, v97
    v_exp_f32 v98, v98
    buffer_load_dwordx4 v217, s[4:7], s92 offen offset:1024 lds
    v_exp_f32 v99, v99
    v_mul_f32 v16, v16, v64
    v_mul_f32 v17, v17, v65
    v_mul_f32 v18, v18, v66
    buffer_load_dwordx4 v217, s[4:7], s92 offen offset:2048 lds
    v_mul_f32 v19, v19, v67
    v_fma_f32 v96, v96, v188, v188
    v_fma_f32 v97, v97, v188, v188
    buffer_load_dwordx4 v217, s[4:7], s92 offen offset:3072 lds
    v_fma_f32 v98, v98, v188, v188
    v_fma_f32 v99, v99, v188, v188
    v_rcp_f32 v96, v96
    v_rcp_f32 v97, v97
    s_add_u32 m0, s62, 32768
    s_add_u32 s59, s68, 2752512
    buffer_load_dwordx4 v213, s[20:23], s59 offen lds
    v_rcp_f32 v98, v98
    v_rcp_f32 v99, v99
    v_mul_f32 v16, v16, v96
    buffer_load_dwordx4 v214, s[20:23], s59 offen offset:1024 lds
    v_mul_f32 v17, v17, v97
    v_mul_f32 v18, v18, v98
    v_mul_f32 v19, v19, v99
    v_cvt_pk_bf16_f32 v102, v16, v17
    buffer_load_dwordx4 v215, s[20:23], s59 offen offset:2048 lds
    v_cvt_pk_bf16_f32 v103, v18, v19
    s_add_u32 s55, s89, 262144
    buffer_store_dwordx4 v[100:103], v254, s[4:7], s55 offen sc0 sc1
    v_mul_f32 v96, v185, v4
    buffer_load_dwordx4 v216, s[20:23], s59 offen offset:3072 lds
    v_mul_f32 v97, v185, v5
    v_mul_f32 v98, v185, v6
    v_mul_f32 v99, v185, v7
    v_exp_f32 v96, v96
    s_waitcnt vmcnt(13)
    s_barrier
    s_add_u32 m0, s62, 114688
    s_mov_b32 s92, 81920
    buffer_load_dwordx4 v217, s[4:7], s92 offen lds
    v_exp_f32 v97, v97
    v_exp_f32 v98, v98
    v_exp_f32 v99, v99
    buffer_load_dwordx4 v217, s[4:7], s92 offen offset:1024 lds
    v_mul_f32 v4, v4, v52
    v_mul_f32 v5, v5, v53
    v_mul_f32 v6, v6, v54
    v_mul_f32 v7, v7, v55
    buffer_load_dwordx4 v217, s[4:7], s92 offen offset:2048 lds
    v_fma_f32 v96, v96, v189, v189
    v_fma_f32 v97, v97, v189, v189
    v_fma_f32 v98, v98, v189, v189
    buffer_load_dwordx4 v217, s[4:7], s92 offen offset:3072 lds
    v_fma_f32 v99, v99, v189, v189
    v_rcp_f32 v96, v96
    v_rcp_f32 v97, v97
    v_rcp_f32 v98, v98
    s_add_u32 m0, s62, 49152
    s_add_u32 s59, s68, 3407872
    buffer_load_dwordx4 v213, s[20:23], s59 offen lds
    v_rcp_f32 v99, v99
    v_mul_f32 v4, v4, v96
    v_mul_f32 v5, v5, v97
    v_mul_f32 v6, v6, v98
    buffer_load_dwordx4 v214, s[20:23], s59 offen offset:1024 lds
    v_mul_f32 v7, v7, v99
    v_cvt_pk_bf16_f32 v104, v4, v5
    v_cvt_pk_bf16_f32 v105, v6, v7
    buffer_load_dwordx4 v215, s[20:23], s59 offen offset:2048 lds
    v_mul_f32 v96, v185, v20
    v_mul_f32 v97, v185, v21
    v_mul_f32 v98, v185, v22
    v_mul_f32 v99, v185, v23
    buffer_load_dwordx4 v216, s[20:23], s59 offen offset:3072 lds
    v_exp_f32 v96, v96
    v_exp_f32 v97, v97
    v_exp_f32 v98, v98
    v_exp_f32 v99, v99
    s_waitcnt vmcnt(13)
    s_barrier
    s_add_u32 m0, s62, 131072
    s_mov_b32 s92, 98304
    buffer_load_dwordx4 v217, s[4:7], s92 offen lds
    v_mul_f32 v20, v20, v68
    v_mul_f32 v21, v21, v69
    v_mul_f32 v22, v22, v70
    buffer_load_dwordx4 v217, s[4:7], s92 offen offset:1024 lds
    v_mul_f32 v23, v23, v71
    v_fma_f32 v96, v96, v189, v189
    v_fma_f32 v97, v97, v189, v189
    v_fma_f32 v98, v98, v189, v189
    buffer_load_dwordx4 v217, s[4:7], s92 offen offset:2048 lds
    v_fma_f32 v99, v99, v189, v189
    v_rcp_f32 v96, v96
    v_rcp_f32 v97, v97
    buffer_load_dwordx4 v217, s[4:7], s92 offen offset:3072 lds
    v_rcp_f32 v98, v98
    v_rcp_f32 v99, v99
    v_mul_f32 v20, v20, v96
    v_mul_f32 v21, v21, v97
    s_add_u32 m0, s62, 65536
    s_add_u32 s59, s68, 65536
    buffer_load_dwordx4 v213, s[20:23], s59 offen lds
    v_mul_f32 v22, v22, v98
    v_mul_f32 v23, v23, v99
    v_cvt_pk_bf16_f32 v106, v20, v21
    v_cvt_pk_bf16_f32 v107, v22, v23
    buffer_load_dwordx4 v214, s[20:23], s59 offen offset:1024 lds
    s_add_u32 s55, s89, 264192
    buffer_store_dwordx4 v[104:107], v254, s[4:7], s55 offen sc0 sc1
    v_mul_f32 v96, v186, v8
    v_mul_f32 v97, v186, v9
    buffer_load_dwordx4 v215, s[20:23], s59 offen offset:2048 lds
    v_mul_f32 v98, v186, v10
    v_mul_f32 v99, v186, v11
    v_exp_f32 v96, v96
    v_exp_f32 v97, v97
    buffer_load_dwordx4 v216, s[20:23], s59 offen offset:3072 lds
    v_exp_f32 v98, v98
    v_exp_f32 v99, v99
    v_mul_f32 v8, v8, v56
    v_mul_f32 v9, v9, v57
    s_waitcnt vmcnt(13)
    s_barrier
    v_lshrrev_b32 v252, 2, v254
    v_min_u32 v252, 28, v252
    s_add_u32 s55, s0, 2080
    buffer_load_dword v251, v252, s[4:7], s55 offen sc0 sc1
    s_add_u32 m0, s62, 98304
    s_mov_b32 s92, 114688
    buffer_load_dwordx4 v217, s[4:7], s92 offen lds
    v_mul_f32 v10, v10, v58
    v_mul_f32 v11, v11, v59
    v_fma_f32 v96, v96, v190, v190
    v_fma_f32 v97, v97, v190, v190
    buffer_load_dwordx4 v217, s[4:7], s92 offen offset:1024 lds
    v_fma_f32 v98, v98, v190, v190
    v_fma_f32 v99, v99, v190, v190
    v_rcp_f32 v96, v96
    v_rcp_f32 v97, v97
    buffer_load_dwordx4 v217, s[4:7], s92 offen offset:2048 lds
    v_rcp_f32 v98, v98
    v_rcp_f32 v99, v99
    v_mul_f32 v8, v8, v96
    v_mul_f32 v9, v9, v97
    buffer_load_dwordx4 v217, s[4:7], s92 offen offset:3072 lds
    v_mul_f32 v10, v10, v98
    v_mul_f32 v11, v11, v99
    v_cvt_pk_bf16_f32 v100, v8, v9
    v_cvt_pk_bf16_f32 v101, v10, v11
    s_add_u32 m0, s62, 81920
    s_add_u32 s59, s68, 720896
    buffer_load_dwordx4 v213, s[20:23], s59 offen lds
    v_mul_f32 v96, v186, v24
    v_mul_f32 v97, v186, v25
    v_mul_f32 v98, v186, v26
    v_mul_f32 v99, v186, v27
    buffer_load_dwordx4 v214, s[20:23], s59 offen offset:1024 lds
    v_exp_f32 v96, v96
    v_exp_f32 v97, v97
    v_exp_f32 v98, v98
    v_exp_f32 v99, v99
    buffer_load_dwordx4 v215, s[20:23], s59 offen offset:2048 lds
    v_mul_f32 v24, v24, v72
    v_mul_f32 v25, v25, v73
    v_mul_f32 v26, v26, v74
    v_mul_f32 v27, v27, v75
    buffer_load_dwordx4 v216, s[20:23], s59 offen offset:3072 lds
    v_fma_f32 v96, v96, v190, v190
    v_fma_f32 v97, v97, v190, v190
    v_fma_f32 v98, v98, v190, v190
    v_fma_f32 v99, v99, v190, v190
    s_waitcnt vmcnt(14)
    s_barrier
    s_waitcnt vmcnt(8)
    v_cmp_ne_u32 vcc, 0x01010101, v251
    s_cbranch_vccz ap_88
    v_lshrrev_b32 v252, 2, v254
    v_min_u32 v252, 28, v252
    s_add_u32 s55, s0, 2080
    s_mov_b32 s56, 262144
poll_89:
    buffer_load_dword v253, v252, s[4:7], s55 offen sc0 sc1
    s_waitcnt vmcnt(0)
    v_cmp_ne_u32 vcc, 0x01010101, v253
    s_cbranch_vccz pd_90
    s_sleep 1
    s_sub_u32 s56, s56, 1
    s_cmp_lg_u32 s56, 0
    s_cbranch_scc1 poll_89
pd_90:
ap_88:
    s_add_u32 m0, s62, 114688
    s_mov_b32 s92, 131072
    buffer_load_dwordx4 v217, s[4:7], s92 offen lds
    v_rcp_f32 v96, v96
    v_rcp_f32 v97, v97
    v_rcp_f32 v98, v98
    buffer_load_dwordx4 v217, s[4:7], s92 offen offset:1024 lds
    v_rcp_f32 v99, v99
    v_mul_f32 v24, v24, v96
    v_mul_f32 v25, v25, v97
    v_mul_f32 v26, v26, v98
    buffer_load_dwordx4 v217, s[4:7], s92 offen offset:2048 lds
    v_mul_f32 v27, v27, v99
    v_cvt_pk_bf16_f32 v102, v24, v25
    v_cvt_pk_bf16_f32 v103, v26, v27
    buffer_load_dwordx4 v217, s[4:7], s92 offen offset:3072 lds
    s_add_u32 s55, s89, 266240
    buffer_store_dwordx4 v[100:103], v254, s[4:7], s55 offen sc0 sc1
    v_mul_f32 v96, v187, v12
    v_mul_f32 v97, v187, v13
    v_mul_f32 v98, v187, v14
    s_add_u32 m0, s62, 0
    s_add_u32 s59, s68, 983040
    buffer_load_dwordx4 v213, s[20:23], s59 offen lds
    v_mul_f32 v99, v187, v15
    v_exp_f32 v96, v96
    v_exp_f32 v97, v97
    buffer_load_dwordx4 v214, s[20:23], s59 offen offset:1024 lds
    v_exp_f32 v98, v98
    v_exp_f32 v99, v99
    v_mul_f32 v12, v12, v60
    v_mul_f32 v13, v13, v61
    buffer_load_dwordx4 v215, s[20:23], s59 offen offset:2048 lds
    v_mul_f32 v14, v14, v62
    v_mul_f32 v15, v15, v63
    v_fma_f32 v96, v96, v191, v191
    buffer_load_dwordx4 v216, s[20:23], s59 offen offset:3072 lds
    v_fma_f32 v97, v97, v191, v191
    v_fma_f32 v98, v98, v191, v191
    v_fma_f32 v99, v99, v191, v191
    v_rcp_f32 v96, v96
    s_waitcnt vmcnt(13)
    s_barrier
    s_add_u32 m0, s62, 131072
    s_mov_b32 s92, 147456
    buffer_load_dwordx4 v217, s[4:7], s92 offen lds
    v_rcp_f32 v97, v97
    v_rcp_f32 v98, v98
    v_rcp_f32 v99, v99
    buffer_load_dwordx4 v217, s[4:7], s92 offen offset:1024 lds
    v_mul_f32 v12, v12, v96
    v_mul_f32 v13, v13, v97
    v_mul_f32 v14, v14, v98
    v_mul_f32 v15, v15, v99
    buffer_load_dwordx4 v217, s[4:7], s92 offen offset:2048 lds
    v_cvt_pk_bf16_f32 v104, v12, v13
    v_cvt_pk_bf16_f32 v105, v14, v15
    v_mul_f32 v96, v187, v28
    buffer_load_dwordx4 v217, s[4:7], s92 offen offset:3072 lds
    v_mul_f32 v97, v187, v29
    v_mul_f32 v98, v187, v30
    v_mul_f32 v99, v187, v31
    v_exp_f32 v96, v96
    s_add_u32 m0, s62, 16384
    s_add_u32 s59, s68, 1638400
    buffer_load_dwordx4 v213, s[20:23], s59 offen lds
    v_exp_f32 v97, v97
    v_exp_f32 v98, v98
    v_exp_f32 v99, v99
    v_mul_f32 v28, v28, v76
    buffer_load_dwordx4 v214, s[20:23], s59 offen offset:1024 lds
    v_mul_f32 v29, v29, v77
    v_mul_f32 v30, v30, v78
    v_mul_f32 v31, v31, v79
    buffer_load_dwordx4 v215, s[20:23], s59 offen offset:2048 lds
    v_fma_f32 v96, v96, v191, v191
    v_fma_f32 v97, v97, v191, v191
    v_fma_f32 v98, v98, v191, v191
    v_fma_f32 v99, v99, v191, v191
    buffer_load_dwordx4 v216, s[20:23], s59 offen offset:3072 lds
    v_rcp_f32 v96, v96
    v_rcp_f32 v97, v97
    v_rcp_f32 v98, v98
    v_rcp_f32 v99, v99
    s_waitcnt vmcnt(13)
    s_barrier
    s_add_u32 m0, s62, 98304
    s_mov_b32 s92, 163840
    buffer_load_dwordx4 v217, s[4:7], s92 offen lds
    v_mul_f32 v28, v28, v96
    v_mul_f32 v29, v29, v97
    v_mul_f32 v30, v30, v98
    buffer_load_dwordx4 v217, s[4:7], s92 offen offset:1024 lds
    v_mul_f32 v31, v31, v99
    v_cvt_pk_bf16_f32 v106, v28, v29
    v_cvt_pk_bf16_f32 v107, v30, v31
    s_add_u32 s55, s89, 268288
    buffer_store_dwordx4 v[104:107], v254, s[4:7], s55 offen sc0 sc1
    buffer_load_dwordx4 v217, s[4:7], s92 offen offset:2048 lds
    v_and_b32 v120, 0x100, v254
    v_and_b32 v121, 0x200, v254
    v_lshrrev_b32 v121, 1, v121
    buffer_load_dwordx4 v217, s[4:7], s92 offen offset:3072 lds
    v_lshl_add_u32 v120, v120, 3, v121
    v_and_b32 v121, 0xf0, v254
    v_add_u32 v120, v120, v121
    v_mul_f32 v96, v184, v32
    s_add_u32 m0, s62, 32768
    s_add_u32 s59, s68, 1900544
    buffer_load_dwordx4 v213, s[20:23], s59 offen lds
    v_mul_f32 v97, v184, v33
    v_mul_f32 v98, v184, v34
    v_mul_f32 v99, v184, v35
    v_exp_f32 v96, v96
    buffer_load_dwordx4 v214, s[20:23], s59 offen offset:1024 lds
    v_exp_f32 v97, v97
    v_exp_f32 v98, v98
    v_exp_f32 v99, v99
    buffer_load_dwordx4 v215, s[20:23], s59 offen offset:2048 lds
    v_mul_f32 v32, v32, v80
    v_mul_f32 v33, v33, v81
    v_mul_f32 v34, v34, v82
    v_mul_f32 v35, v35, v83
    buffer_load_dwordx4 v216, s[20:23], s59 offen offset:3072 lds
    v_fma_f32 v96, v96, v188, v188
    v_fma_f32 v97, v97, v188, v188
    v_fma_f32 v98, v98, v188, v188
    v_fma_f32 v99, v99, v188, v188
    s_waitcnt vmcnt(13)
    s_barrier
    s_add_u32 m0, s62, 114688
    s_mov_b32 s92, 180224
    buffer_load_dwordx4 v217, s[4:7], s92 offen lds
    v_rcp_f32 v96, v96
    v_rcp_f32 v97, v97
    v_rcp_f32 v98, v98
    buffer_load_dwordx4 v217, s[4:7], s92 offen offset:1024 lds
    v_rcp_f32 v99, v99
    v_mul_f32 v32, v32, v96
    v_mul_f32 v33, v33, v97
    v_mul_f32 v34, v34, v98
    buffer_load_dwordx4 v217, s[4:7], s92 offen offset:2048 lds
    v_mul_f32 v35, v35, v99
    v_cvt_pk_bf16_f32 v100, v32, v33
    v_cvt_pk_bf16_f32 v101, v34, v35
    buffer_load_dwordx4 v217, s[4:7], s92 offen offset:3072 lds
    v_mul_f32 v96, v185, v36
    v_mul_f32 v97, v185, v37
    v_mul_f32 v98, v185, v38
    v_mul_f32 v99, v185, v39
    s_add_u32 m0, s62, 49152
    s_add_u32 s59, s68, 2555904
    buffer_load_dwordx4 v213, s[20:23], s59 offen lds
    v_exp_f32 v96, v96
    v_exp_f32 v97, v97
    v_exp_f32 v98, v98
    v_exp_f32 v99, v99
    buffer_load_dwordx4 v214, s[20:23], s59 offen offset:1024 lds
    v_mul_f32 v36, v36, v84
    v_mul_f32 v37, v37, v85
    v_mul_f32 v38, v38, v86
    buffer_load_dwordx4 v215, s[20:23], s59 offen offset:2048 lds
    v_mul_f32 v39, v39, v87
    v_fma_f32 v96, v96, v189, v189
    v_fma_f32 v97, v97, v189, v189
    v_fma_f32 v98, v98, v189, v189
    buffer_load_dwordx4 v216, s[20:23], s59 offen offset:3072 lds
    v_fma_f32 v99, v99, v189, v189
    v_rcp_f32 v96, v96
    v_rcp_f32 v97, v97
    v_rcp_f32 v98, v98
    s_waitcnt vmcnt(12)
    s_barrier
    s_cmp_lg_u32 s42, 0
    s_cbranch_scc1 wf_91
    s_lshr_b32 s55, s2, 5
    s_lshl_b32 s55, s55, 2
    s_add_u32 s55, s55, s0
    v_mov_b32 v252, 2112
    v_mov_b32 v253, 0x01010101
    s_mov_b64 exec, 1
    s_cmp_eq_u32 s45, 0
    s_cbranch_scc1 st_92
    buffer_store_dword v253, v252, s[4:7], s55 offen sc0 sc1
    s_branch st_93
st_92:
    buffer_store_dword v253, v252, s[4:7], s55 offen
st_93:
    s_mov_b64 exec, -1
wf_91:
    s_add_u32 m0, s62, 131072
    s_mov_b32 s92, 196608
    buffer_load_dwordx4 v217, s[4:7], s92 offen lds
    v_rcp_f32 v99, v99
    v_mul_f32 v36, v36, v96
    v_mul_f32 v37, v37, v97
    buffer_load_dwordx4 v217, s[4:7], s92 offen offset:1024 lds
    v_mul_f32 v38, v38, v98
    v_mul_f32 v39, v39, v99
    v_cvt_pk_bf16_f32 v102, v36, v37
    buffer_load_dwordx4 v217, s[4:7], s92 offen offset:2048 lds
    v_cvt_pk_bf16_f32 v103, v38, v39
    s_nop 1
    v_permlane16_swap_b32 v100, v102
    v_permlane16_swap_b32 v101, v103
    s_add_u32 s55, s90, 0
    buffer_store_dwordx4 v[100:103], v120, s[4:7], s55 offen sc0 sc1
    v_mul_f32 v96, v186, v40
    buffer_load_dwordx4 v217, s[4:7], s92 offen offset:3072 lds
    v_mul_f32 v97, v186, v41
    v_mul_f32 v98, v186, v42
    v_mul_f32 v99, v186, v43
    s_add_u32 m0, s62, 65536
    s_add_u32 s59, s68, 2818048
    buffer_load_dwordx4 v213, s[20:23], s59 offen lds
    v_exp_f32 v96, v96
    v_exp_f32 v97, v97
    v_exp_f32 v98, v98
    buffer_load_dwordx4 v214, s[20:23], s59 offen offset:1024 lds
    v_exp_f32 v99, v99
    v_mul_f32 v40, v40, v88
    v_mul_f32 v41, v41, v89
    v_mul_f32 v42, v42, v90
    buffer_load_dwordx4 v215, s[20:23], s59 offen offset:2048 lds
    v_mul_f32 v43, v43, v91
    v_fma_f32 v96, v96, v190, v190
    v_fma_f32 v97, v97, v190, v190
    buffer_load_dwordx4 v216, s[20:23], s59 offen offset:3072 lds
    v_fma_f32 v98, v98, v190, v190
    v_fma_f32 v99, v99, v190, v190
    v_rcp_f32 v96, v96
    v_rcp_f32 v97, v97
    s_waitcnt vmcnt(13)
    s_barrier
    s_add_u32 m0, s62, 98304
    s_mov_b32 s92, 212992
    buffer_load_dwordx4 v217, s[4:7], s92 offen lds
    v_rcp_f32 v98, v98
    v_rcp_f32 v99, v99
    v_mul_f32 v40, v40, v96
    buffer_load_dwordx4 v217, s[4:7], s92 offen offset:1024 lds
    v_mul_f32 v41, v41, v97
    v_mul_f32 v42, v42, v98
    v_mul_f32 v43, v43, v99
    v_cvt_pk_bf16_f32 v104, v40, v41
    buffer_load_dwordx4 v217, s[4:7], s92 offen offset:2048 lds
    v_cvt_pk_bf16_f32 v105, v42, v43
    v_mul_f32 v96, v187, v44
    v_mul_f32 v97, v187, v45
    v_mul_f32 v98, v187, v46
    buffer_load_dwordx4 v217, s[4:7], s92 offen offset:3072 lds
    v_mul_f32 v99, v187, v47
    v_exp_f32 v96, v96
    v_exp_f32 v97, v97
    v_exp_f32 v98, v98
    s_add_u32 m0, s62, 81920
    s_add_u32 s59, s68, 3473408
    buffer_load_dwordx4 v213, s[20:23], s59 offen lds
    v_exp_f32 v99, v99
    v_mul_f32 v44, v44, v92
    v_mul_f32 v45, v45, v93
    buffer_load_dwordx4 v214, s[20:23], s59 offen offset:1024 lds
    v_mul_f32 v46, v46, v94
    v_mul_f32 v47, v47, v95
    v_fma_f32 v96, v96, v191, v191
    v_fma_f32 v97, v97, v191, v191
    buffer_load_dwordx4 v215, s[20:23], s59 offen offset:2048 lds
    v_fma_f32 v98, v98, v191, v191
    v_fma_f32 v99, v99, v191, v191
    v_rcp_f32 v96, v96
    v_rcp_f32 v97, v97
    buffer_load_dwordx4 v216, s[20:23], s59 offen offset:3072 lds
    v_rcp_f32 v98, v98
    v_rcp_f32 v99, v99
    v_mul_f32 v44, v44, v96
    v_mul_f32 v45, v45, v97
    s_waitcnt vmcnt(12)
    s_barrier
    s_add_u32 m0, s62, 114688
    s_mov_b32 s92, 229376
    buffer_load_dwordx4 v217, s[4:7], s92 offen lds
    v_mul_f32 v46, v46, v98
    v_mul_f32 v47, v47, v99
    buffer_load_dwordx4 v217, s[4:7], s92 offen offset:1024 lds
    v_cvt_pk_bf16_f32 v106, v44, v45
    v_cvt_pk_bf16_f32 v107, v46, v47
    buffer_load_dwordx4 v217, s[4:7], s92 offen offset:2048 lds
    s_nop 1
    v_permlane16_swap_b32 v104, v106
    v_permlane16_swap_b32 v105, v107
    s_add_u32 s55, s90, 4096
    buffer_store_dwordx4 v[104:107], v120, s[4:7], s55 offen sc0 sc1
    buffer_load_dwordx4 v217, s[4:7], s92 offen offset:3072 lds
    s_cmp_eq_u32 s46, 0
    s_cselect_b32 s63, s63, 2130706432
    v_lshrrev_b32 v224, 7, v254
    s_add_u32 m0, s62, 0
    s_add_u32 s59, s69, 262144
    buffer_load_dwordx4 v213, s[20:23], s59 offen lds
    v_and_b32 v225, 0x70, v254
    v_and_b32 v226, 6, v224
    buffer_load_dwordx4 v214, s[20:23], s59 offen offset:1024 lds
    v_lshlrev_b32 v226, 4, v226
    v_xor_b32 v225, v225, v226
    buffer_load_dwordx4 v215, s[20:23], s59 offen offset:2048 lds
    v_mul_u32_u24 v224, 6144, v224
    v_add3_u32 v224, v224, v225, s63
    buffer_load_dwordx4 v216, s[20:23], s59 offen offset:3072 lds
    s_lshr_b32 s55, s61, 10
    s_add_u32 s55, s55, 0
    s_and_b32 s56, s55, 3
    s_lshl_b32 s56, s56, 3
    s_mul_i32 s56, s56, 6144
    s_lshr_b32 s55, s55, 2
    s_lshl_b32 s55, s55, 11
    s_add_u32 s55, s55, s56
    s_sub_u32 s55, s55, 0
    v_add_u32 v200, s55, v224
    s_lshr_b32 s55, s61, 10
    s_add_u32 s55, s55, 1
    s_and_b32 s56, s55, 3
    s_lshl_b32 s56, s56, 3
    s_mul_i32 s56, s56, 6144
    s_lshr_b32 s55, s55, 2
    s_lshl_b32 s55, s55, 11
    s_add_u32 s55, s55, s56
    s_sub_u32 s55, s55, 1024
    v_add_u32 v201, s55, v224
    s_lshr_b32 s55, s61, 10
    s_add_u32 s55, s55, 2
    s_and_b32 s56, s55, 3
    s_lshl_b32 s56, s56, 3
    s_mul_i32 s56, s56, 6144
    s_lshr_b32 s55, s55, 2
    s_lshl_b32 s55, s55, 11
    s_add_u32 s55, s55, s56
    s_sub_u32 s55, s55, 2048
    v_add_u32 v202, s55, v224
    s_waitcnt vmcnt(13)
    s_barrier
    v_lshrrev_b32 v252, 2, v254
    v_min_u32 v252, 28, v252
    s_add_u32 s55, s0, 2112
    buffer_load_dword v251, v252, s[4:7], s55 offen sc0 sc1
    s_add_u32 m0, s62, 131072
    s_mov_b32 s92, 245760
    buffer_load_dwordx4 v217, s[4:7], s92 offen lds
    buffer_load_dwordx4 v217, s[4:7], s92 offen offset:1024 lds
    buffer_load_dwordx4 v217, s[4:7], s92 offen offset:2048 lds
    buffer_load_dwordx4 v217, s[4:7], s92 offen offset:3072 lds
    s_add_u32 m0, s62, 16384
    s_add_u32 s59, s69, 524288
    buffer_load_dwordx4 v213, s[20:23], s59 offen lds
    buffer_load_dwordx4 v214, s[20:23], s59 offen offset:1024 lds
    buffer_load_dwordx4 v215, s[20:23], s59 offen offset:2048 lds
    buffer_load_dwordx4 v216, s[20:23], s59 offen offset:3072 lds
    s_waitcnt vmcnt(13)
    s_barrier
    s_cmp_lg_u32 s42, 1
    s_cbranch_scc1 wf_94
    s_lshr_b32 s55, s2, 5
    s_lshl_b32 s55, s55, 2
    s_add_u32 s55, s55, s0
    v_mov_b32 v252, 2144
    v_mov_b32 v253, 0x01010101
    s_mov_b64 exec, 1
    s_cmp_eq_u32 s45, 0
    s_cbranch_scc1 st_95
    buffer_store_dword v253, v252, s[4:7], s55 offen sc0 sc1
    s_branch st_96
st_95:
    buffer_store_dword v253, v252, s[4:7], s55 offen
st_96:
    s_mov_b64 exec, -1
wf_94:
    s_waitcnt vmcnt(8)
    v_cmp_ne_u32 vcc, 0x01010101, v251
    s_cbranch_vccz ap_97
    v_lshrrev_b32 v252, 2, v254
    v_min_u32 v252, 28, v252
    s_add_u32 s55, s0, 2112
    s_mov_b32 s56, 262144
poll_98:
    buffer_load_dword v253, v252, s[4:7], s55 offen sc0 sc1
    s_waitcnt vmcnt(0)
    v_cmp_ne_u32 vcc, 0x01010101, v253
    s_cbranch_vccz pd_99
    s_sleep 1
    s_sub_u32 s56, s56, 1
    s_cmp_lg_u32 s56, 0
    s_cbranch_scc1 poll_98
pd_99:
ap_97:
    s_add_u32 m0, s62, 98304
    s_mov_b32 s92, 262144
    buffer_load_dwordx4 v217, s[4:7], s92 offen lds
    buffer_load_dwordx4 v217, s[4:7], s92 offen offset:1024 lds
    buffer_load_dwordx4 v217, s[4:7], s92 offen offset:2048 lds
    buffer_load_dwordx4 v217, s[4:7], s92 offen offset:3072 lds
    s_add_u32 m0, s62, 32768
    s_add_u32 s59, s69, 1179648
    buffer_load_dwordx4 v213, s[20:23], s59 offen lds
    buffer_load_dwordx4 v214, s[20:23], s59 offen offset:1024 lds
    buffer_load_dwordx4 v215, s[20:23], s59 offen offset:2048 lds
    buffer_load_dwordx4 v216, s[20:23], s59 offen offset:3072 lds
    s_waitcnt vmcnt(12)
    s_barrier
    s_add_u32 m0, s62, 114688
    s_mov_b32 s92, 278528
    buffer_load_dwordx4 v217, s[4:7], s92 offen lds
    buffer_load_dwordx4 v217, s[4:7], s92 offen offset:1024 lds
    buffer_load_dwordx4 v217, s[4:7], s92 offen offset:2048 lds
    buffer_load_dwordx4 v217, s[4:7], s92 offen offset:3072 lds
    s_add_u32 m0, s62, 49152
    s_add_u32 s59, s69, 1441792
    buffer_load_dwordx4 v213, s[20:23], s59 offen lds
    buffer_load_dwordx4 v214, s[20:23], s59 offen offset:1024 lds
    buffer_load_dwordx4 v215, s[20:23], s59 offen offset:2048 lds
    buffer_load_dwordx4 v216, s[20:23], s59 offen offset:3072 lds
    s_waitcnt vmcnt(12)
    s_barrier
    s_add_u32 m0, s62, 131072
    s_mov_b32 s92, 294912
    buffer_load_dwordx4 v217, s[4:7], s92 offen lds
    buffer_load_dwordx4 v217, s[4:7], s92 offen offset:1024 lds
    buffer_load_dwordx4 v217, s[4:7], s92 offen offset:2048 lds
    buffer_load_dwordx4 v217, s[4:7], s92 offen offset:3072 lds
    s_add_u32 m0, s62, 65536
    s_add_u32 s59, s69, 2097152
    buffer_load_dwordx4 v213, s[20:23], s59 offen lds
    buffer_load_dwordx4 v214, s[20:23], s59 offen offset:1024 lds
    buffer_load_dwordx4 v215, s[20:23], s59 offen offset:2048 lds
    buffer_load_dwordx4 v216, s[20:23], s59 offen offset:3072 lds
    s_waitcnt vmcnt(12)
    s_barrier
    s_add_u32 m0, s62, 98304
    s_mov_b32 s92, 311296
    buffer_load_dwordx4 v217, s[4:7], s92 offen lds
    buffer_load_dwordx4 v217, s[4:7], s92 offen offset:1024 lds
    buffer_load_dwordx4 v217, s[4:7], s92 offen offset:2048 lds
    buffer_load_dwordx4 v217, s[4:7], s92 offen offset:3072 lds
    s_add_u32 m0, s62, 81920
    s_add_u32 s59, s69, 2359296
    buffer_load_dwordx4 v213, s[20:23], s59 offen lds
    buffer_load_dwordx4 v214, s[20:23], s59 offen offset:1024 lds
    buffer_load_dwordx4 v215, s[20:23], s59 offen offset:2048 lds
    buffer_load_dwordx4 v216, s[20:23], s59 offen offset:3072 lds
    s_waitcnt vmcnt(12)
    s_barrier
    s_add_u32 m0, s62, 114688
    s_mov_b32 s92, 327680
    buffer_load_dwordx4 v217, s[4:7], s92 offen lds
    buffer_load_dwordx4 v217, s[4:7], s92 offen offset:1024 lds
    buffer_load_dwordx4 v217, s[4:7], s92 offen offset:2048 lds
    buffer_load_dwordx4 v217, s[4:7], s92 offen offset:3072 lds
    s_add_u32 m0, s62, 0
    s_add_u32 s59, s69, 3014656
    buffer_load_dwordx4 v213, s[20:23], s59 offen lds
    buffer_load_dwordx4 v214, s[20:23], s59 offen offset:1024 lds
    buffer_load_dwordx4 v215, s[20:23], s59 offen offset:2048 lds
    buffer_load_dwordx4 v216, s[20:23], s59 offen offset:3072 lds
    s_waitcnt vmcnt(12)
    s_barrier
    s_add_u32 m0, s62, 131072
    s_mov_b32 s92, 344064
    buffer_load_dwordx4 v217, s[4:7], s92 offen lds
    buffer_load_dwordx4 v217, s[4:7], s92 offen offset:1024 lds
    buffer_load_dwordx4 v217, s[4:7], s92 offen offset:2048 lds
    buffer_load_dwordx4 v217, s[4:7], s92 offen offset:3072 lds
    s_add_u32 m0, s62, 16384
    s_add_u32 s59, s69, 3276800
    buffer_load_dwordx4 v213, s[20:23], s59 offen lds
    buffer_load_dwordx4 v214, s[20:23], s59 offen offset:1024 lds
    buffer_load_dwordx4 v215, s[20:23], s59 offen offset:2048 lds
    buffer_load_dwordx4 v216, s[20:23], s59 offen offset:3072 lds
    s_waitcnt vmcnt(12)
    s_barrier
    s_add_u32 m0, s62, 98304
    s_mov_b32 s92, 360448
    buffer_load_dwordx4 v217, s[4:7], s92 offen lds
    buffer_load_dwordx4 v217, s[4:7], s92 offen offset:1024 lds
    buffer_load_dwordx4 v217, s[4:7], s92 offen offset:2048 lds
    buffer_load_dwordx4 v217, s[4:7], s92 offen offset:3072 lds
    v_add_u32 v214, 8192, v214
    v_add_u32 v215, 16384, v215
    v_add_u32 v216, 24576, v216
    s_mul_i32 s59, s44, 24576
    s_sub_u32 s69, s69, s59
    s_add_u32 m0, s62, 32768
    s_add_u32 s59, s69, 393216
    buffer_load_dwordx4 v213, s[20:23], s59 offen lds
    buffer_load_dwordx4 v214, s[20:23], s59 offen offset:1024 lds
    buffer_load_dwordx4 v215, s[20:23], s59 offen offset:2048 lds
    buffer_load_dwordx4 v216, s[20:23], s59 offen offset:3072 lds
    s_waitcnt vmcnt(12)
    s_barrier
    v_lshrrev_b32 v252, 2, v254
    v_min_u32 v252, 28, v252
    s_add_u32 s55, s0, 2144
    buffer_load_dword v251, v252, s[4:7], s55 offen sc0 sc1
    s_add_u32 m0, s62, 114688
    s_mov_b32 s92, 376832
    buffer_load_dwordx4 v217, s[4:7], s92 offen lds
    buffer_load_dwordx4 v217, s[4:7], s92 offen offset:1024 lds
    buffer_load_dwordx4 v217, s[4:7], s92 offen offset:2048 lds
    buffer_load_dwordx4 v217, s[4:7], s92 offen offset:3072 lds
    s_add_u32 m0, s62, 49152
    s_add_u32 s59, s69, 1310720
    buffer_load_dwordx4 v213, s[20:23], s59 offen lds
    buffer_load_dwordx4 v214, s[20:23], s59 offen offset:1024 lds
    buffer_load_dwordx4 v215, s[20:23], s59 offen offset:2048 lds
    buffer_load_dwordx4 v216, s[20:23], s59 offen offset:3072 lds
    s_waitcnt vmcnt(13)
    s_barrier
    s_waitcnt vmcnt(8)
    v_cmp_ne_u32 vcc, 0x01010101, v251
    s_cbranch_vccz ap_100
    v_lshrrev_b32 v252, 2, v254
    v_min_u32 v252, 28, v252
    s_add_u32 s55, s0, 2144
    s_mov_b32 s56, 262144
poll_101:
    buffer_load_dword v253, v252, s[4:7], s55 offen sc0 sc1
    s_waitcnt vmcnt(0)
    v_cmp_ne_u32 vcc, 0x01010101, v253
    s_cbranch_vccz pd_102
    s_sleep 1
    s_sub_u32 s56, s56, 1
    s_cmp_lg_u32 s56, 0
    s_cbranch_scc1 poll_101
pd_102:
ap_100:
    s_add_u32 m0, s62, 131072
    s_mov_b32 s92, 393216
    buffer_load_dwordx4 v217, s[4:7], s92 offen lds
    buffer_load_dwordx4 v217, s[4:7], s92 offen offset:1024 lds
    buffer_load_dwordx4 v217, s[4:7], s92 offen offset:2048 lds
    buffer_load_dwordx4 v217, s[4:7], s92 offen offset:3072 lds
    s_add_u32 m0, s62, 65536
    s_add_u32 s59, s69, 2228224
    buffer_load_dwordx4 v213, s[20:23], s59 offen lds
    buffer_load_dwordx4 v214, s[20:23], s59 offen offset:1024 lds
    buffer_load_dwordx4 v215, s[20:23], s59 offen offset:2048 lds
    buffer_load_dwordx4 v216, s[20:23], s59 offen offset:3072 lds
    s_waitcnt vmcnt(12)
    s_barrier
    s_add_u32 m0, s62, 98304
    s_mov_b32 s92, 409600
    buffer_load_dwordx4 v217, s[4:7], s92 offen lds
    buffer_load_dwordx4 v217, s[4:7], s92 offen offset:1024 lds
    buffer_load_dwordx4 v217, s[4:7], s92 offen offset:2048 lds
    buffer_load_dwordx4 v217, s[4:7], s92 offen offset:3072 lds
    s_add_u32 m0, s62, 81920
    s_add_u32 s59, s69, 3145728
    buffer_load_dwordx4 v213, s[20:23], s59 offen lds
    buffer_load_dwordx4 v214, s[20:23], s59 offen offset:1024 lds
    buffer_load_dwordx4 v215, s[20:23], s59 offen offset:2048 lds
    buffer_load_dwordx4 v216, s[20:23], s59 offen offset:3072 lds
    v_subrev_u32 v214, 8192, v214
    v_subrev_u32 v215, 16384, v215
    v_subrev_u32 v216, 24576, v216
    s_mul_i32 s59, s44, 24576
    s_add_u32 s69, s69, s59
    s_waitcnt vmcnt(12)
    s_barrier
    s_add_u32 m0, s62, 114688
    s_mov_b32 s92, 425984
    buffer_load_dwordx4 v217, s[4:7], s92 offen lds
    buffer_load_dwordx4 v217, s[4:7], s92 offen offset:1024 lds
    buffer_load_dwordx4 v217, s[4:7], s92 offen offset:2048 lds
    buffer_load_dwordx4 v217, s[4:7], s92 offen offset:3072 lds
    s_lshl_b32 s93, s51, 12
    s_add_u32 m0, s61, 0
    s_mul_i32 s59, s93, 96
    buffer_load_dwordx4 v200, s[8:11], s59 offen lds
    buffer_load_dwordx4 v201, s[8:11], s59 offen offset:1024 lds
    buffer_load_dwordx4 v202, s[8:11], s59 offen offset:2048 lds
    s_add_u32 s93, s93, 2048
    s_and_b32 s93, s93, 65535
    s_waitcnt vmcnt(11)
    s_barrier
    s_add_u32 m0, s62, 131072
    s_mov_b32 s92, 442368
    buffer_load_dwordx4 v217, s[4:7], s92 offen lds
    buffer_load_dwordx4 v217, s[4:7], s92 offen offset:1024 lds
    buffer_load_dwordx4 v217, s[4:7], s92 offen offset:2048 lds
    buffer_load_dwordx4 v217, s[4:7], s92 offen offset:3072 lds
    s_add_u32 m0, s61, 16384
    s_mul_i32 s59, s93, 96
    buffer_load_dwordx4 v200, s[8:11], s59 offen lds
    buffer_load_dwordx4 v201, s[8:11], s59 offen offset:1024 lds
    buffer_load_dwordx4 v202, s[8:11], s59 offen offset:2048 lds
    s_add_u32 s93, s93, 6144
    s_and_b32 s93, s93, 65535
    s_waitcnt vmcnt(10)
    s_barrier
    s_add_u32 m0, s61, 32768
    s_mul_i32 s59, s93, 96
    buffer_load_dwordx4 v200, s[8:11], s59 offen lds
    buffer_load_dwordx4 v201, s[8:11], s59 offen offset:1024 lds
    buffer_load_dwordx4 v202, s[8:11], s59 offen offset:2048 lds
    s_add_u32 s93, s93, 2048
    s_and_b32 s93, s93, 65535
    s_add_u32 m0, s61, 49152
    s_mul_i32 s59, s93, 96
    buffer_load_dwordx4 v200, s[8:11], s59 offen lds
    buffer_load_dwordx4 v201, s[8:11], s59 offen offset:1024 lds
    buffer_load_dwordx4 v202, s[8:11], s59 offen offset:2048 lds
    s_add_u32 s93, s93, 6144
    s_and_b32 s93, s93, 65535
    s_waitcnt vmcnt(9)
    s_barrier
    s_add_u32 m0, s61, 65536
    s_mul_i32 s59, s93, 96
    buffer_load_dwordx4 v200, s[8:11], s59 offen lds
    buffer_load_dwordx4 v201, s[8:11], s59 offen offset:1024 lds
    buffer_load_dwordx4 v202, s[8:11], s59 offen offset:2048 lds
    s_add_u32 s93, s93, 2048
    s_and_b32 s93, s93, 65535
    s_barrier
    s_add_u32 m0, s61, 81920
    s_mul_i32 s59, s93, 96
    buffer_load_dwordx4 v200, s[8:11], s59 offen lds
    buffer_load_dwordx4 v201, s[8:11], s59 offen offset:1024 lds
    buffer_load_dwordx4 v202, s[8:11], s59 offen offset:2048 lds
    s_add_u32 s93, s93, 6144
    s_and_b32 s93, s93, 65535
    s_setprio 0
    s_cmp_lg_u32 s46, 0
    s_cbranch_scc1 K_end
    s_lshl_b32 s60, s43, 23
    s_add_u32 s60, s60, 83886336
    s_mov_b32 s28, s16
    s_mov_b32 s29, s17
    s_mov_b32 s30, s18
    s_mov_b32 s31, s19
    s_mov_b32 s46, 1
    s_add_u32 s47, s47, 262144
    s_add_u32 s49, s49, 524288
    s_add_u32 s50, s50, 917504
    s_add_u32 s52, s52, 65536
    s_add_u32 s54, s54, 32768
    s_add_u32 s0, s0, 32768
    s_branch Y_layer
K_end:
    s_endpgm

.section .rodata,"a"
.p2align 6
.amdhsa_kernel interleave_layers__sliding_local_dilated__glu_gated_swiglu__prompt_kernel
  .amdhsa_next_free_vgpr 256
  .amdhsa_next_free_sgpr 102
  .amdhsa_accum_offset 256
  .amdhsa_group_segment_fixed_size 0
  .amdhsa_kernarg_size 80
  .amdhsa_user_sgpr_count 2
  .amdhsa_user_sgpr_kernarg_segment_ptr 1
  .amdhsa_system_sgpr_workgroup_id_x 1
.end_amdhsa_kernel
```

```asm
; @launch grid=(256,1,1) block=(512,1,1) lds=163840
.amdgcn_target "amdgcn-amd-amdhsa--gfx950"
.text
.globl interleave_layers__sliding_local_dilated__glu_gated_swiglu__prompt_kernel
.p2align 8
.type interleave_layers__sliding_local_dilated__glu_gated_swiglu__prompt_kernel,@function
interleave_layers__sliding_local_dilated__glu_gated_swiglu__prompt_kernel:
    s_cmp_ge_u32 s2, 256
    s_cbranch_scc0 K_go
    s_endpgm
K_go:
    s_load_dwordx4 s[72:75], s[0:1], 0
    s_load_dwordx2 s[76:77], s[0:1], 16
    s_load_dwordx8 s[80:87], s[0:1], 32
    s_load_dwordx4 s[88:91], s[0:1], 64
    v_lshrrev_b32 v1, 6, v0
    v_and_b32 v254, 63, v0
    v_readfirstlane_b32 s3, v1
    v_lshlrev_b32 v254, 4, v254
    s_and_b32 s55, s2, 6
    s_lshl_b32 s55, s55, 1
    s_lshr_b32 s56, s2, 3
    s_and_b32 s56, s56, 3
    s_add_u32 s40, s55, s56
    s_and_b32 s55, s2, 1
    s_lshr_b32 s56, s2, 5
    s_lshl_b32 s41, s55, 3
    s_add_u32 s41, s41, s56
    s_lshl_b32 s51, s56, 1
    s_add_u32 s51, s51, s55
    s_and_b32 s42, s3, 3
    s_and_b32 s43, s3, 1
    s_lshr_b32 s44, s42, 1
    s_lshl_b32 s55, s43, 1
    s_add_u32 s55, s55, s44
    s_mul_i32 s61, s55, 3072
    s_lshl_b32 s62, s55, 12
    s_mov_b32 s45, 1
    s_mov_b32 s46, 0
    s_lshl_b32 s47, s40, 22
    s_add_u32 s49, s47, 524288
    s_add_u32 s48, s47, 786432
    s_add_u32 s50, s47, 2097152
    s_add_u32 s52, s47, 1835008
    s_add_u32 s53, s52, 32768
    s_lshl_b32 s54, s40, 7
    s_add_u32 s54, s54, 71303168
    s_lshl_b32 s63, s51, 7
    s_lshl_b32 s55, s44, 16
    s_add_u32 s64, s63, s55
    s_mul_i32 s55, s44, 114688
    s_mul_i32 s56, s41, 448
    s_add_u32 s55, s55, s56
    s_and_b32 s56, s41, 1
    s_mul_i32 s56, s56, 192
    s_add_u32 s65, s55, s56
    s_sub_u32 s66, s55, s56
    s_add_u32 s66, s66, 256
    s_lshl_b32 s55, s43, 4
    s_add_u32 s55, s55, s41
    s_lshl_b32 s55, s55, 6
    s_add_u32 s55, s55, s44
    s_lshl_b32 s55, s55, 10
    s_add_u32 s67, s55, 67106816
    s_and_b32 s55, s51, 1
    s_mul_i32 s55, s55, 3670016
    s_lshr_b32 s56, s51, 1
    s_lshl_b32 s56, s56, 8
    s_add_u32 s55, s55, s56
    s_lshl_b32 s56, s44, 15
    s_add_u32 s55, s55, s56
    s_lshl_b32 s56, s43, 16
    s_add_u32 s69, s55, s56
    s_add_u32 s68, s69, s56
    s_waitcnt lgkmcnt(0)
    s_mov_b32 s8, s74
    s_mov_b32 s9, s75
    s_mov_b32 s10, 6291456
    s_mov_b32 s11, 0x00020000
    s_mov_b32 s36, s72
    s_mov_b32 s37, s73
    s_mov_b32 s38, 4194304
    s_mov_b32 s39, 0x00020000
    s_mov_b32 s4, s90
    s_mov_b32 s5, s91
    s_mov_b32 s6, 268435456
    s_mov_b32 s7, 0x00020000
    s_mov_b32 s24, s72
    s_mov_b32 s25, s73
    s_mov_b32 s26, 4194304
    s_mov_b32 s27, 0x00020000
    s_mov_b32 s12, s76
    s_mov_b32 s13, s77
    s_mov_b32 s14, 2097152
    s_mov_b32 s15, 0x00020000
    s_cmp_eq_u32 s43, 0
    s_cselect_b32 s16, s80, s82
    s_cselect_b32 s17, s81, s83
    s_mov_b32 s18, 7340032
    s_mov_b32 s19, 0x00020000
    s_mov_b32 s20, s84
    s_mov_b32 s21, s85
    s_mov_b32 s22, 7340032
    s_mov_b32 s23, 0x00020000
    s_mov_b32 s28, s86
    s_mov_b32 s29, s87
    s_mov_b32 s30, 4194304
    s_mov_b32 s31, 0x00020000
    s_mov_b32 s32, s88
    s_mov_b32 s33, s89
    s_mov_b32 s34, 256
    s_mov_b32 s35, 0x00020000
    s_and_b32 s55, s2, 1
    s_lshl_b32 s55, s55, 13
    s_add_u32 s55, s55, 16384
    s_add_u32 s0, s54, s55
    s_lshl_b32 s55, s51, 14
    s_lshl_b32 s56, s43, 13
    s_add_u32 s55, s55, s56
    s_lshl_b32 s56, s44, 10
    s_add_u32 s1, s55, s56
    s_cmp_lt_u32 s3, 4
    s_cbranch_scc1 X_start
    v_lshrrev_b32 v224, 7, v254
    v_and_b32 v225, 0x70, v254
    v_and_b32 v226, 6, v224
    v_lshlrev_b32 v226, 4, v226
    v_xor_b32 v225, v225, v226
    v_and_b32 v226, 4, v224
    v_add_u32 v224, v224, v226
    v_mul_u32_u24 v224, 6144, v224
    v_add3_u32 v224, v224, v225, s63
    s_lshr_b32 s55, s61, 10
    s_add_u32 s55, s55, 0
    s_and_b32 s56, s55, 3
    s_and_b32 s57, s56, 1
    s_lshl_b32 s57, s57, 4
    s_and_b32 s56, s56, 2
    s_lshl_b32 s56, s56, 1
    s_add_u32 s56, s56, s57
    s_mul_i32 s56, s56, 6144
    s_lshr_b32 s55, s55, 2
    s_lshl_b32 s55, s55, 11
    s_add_u32 s55, s55, s56
    s_sub_u32 s55, s55, 0
    v_add_u32 v200, s55, v224
    s_lshr_b32 s55, s61, 10
    s_add_u32 s55, s55, 1
    s_and_b32 s56, s55, 3
    s_and_b32 s57, s56, 1
    s_lshl_b32 s57, s57, 4
    s_and_b32 s56, s56, 2
    s_lshl_b32 s56, s56, 1
    s_add_u32 s56, s56, s57
    s_mul_i32 s56, s56, 6144
    s_lshr_b32 s55, s55, 2
    s_lshl_b32 s55, s55, 11
    s_add_u32 s55, s55, s56
    s_sub_u32 s55, s55, 1024
    v_add_u32 v201, s55, v224
    s_lshr_b32 s55, s61, 10
    s_add_u32 s55, s55, 2
    s_and_b32 s56, s55, 3
    s_and_b32 s57, s56, 1
    s_lshl_b32 s57, s57, 4
    s_and_b32 s56, s56, 2
    s_lshl_b32 s56, s56, 1
    s_add_u32 s56, s56, s57
    s_mul_i32 s56, s56, 6144
    s_lshr_b32 s55, s55, 2
    s_lshl_b32 s55, s55, 11
    s_add_u32 s55, s55, s56
    s_sub_u32 s55, s55, 2048
    v_add_u32 v202, s55, v224
    s_and_b32 s55, s40, 4
    s_lshl_b32 s55, s55, 1
    s_lshr_b32 s56, s40, 3
    s_add_u32 s55, s55, s56
    s_add_u32 s92, s55, s51
    s_and_b32 s92, s92, 15
    s_lshl_b32 s93, s92, 12
    s_add_u32 m0, s61, 0
    s_mul_i32 s59, s93, 96
    buffer_load_dwordx4 v200, s[8:11], s59 offen lds
    buffer_load_dwordx4 v201, s[8:11], s59 offen offset:1024 lds
    buffer_load_dwordx4 v202, s[8:11], s59 offen offset:2048 lds
    s_add_u32 s93, s93, 2048
    s_and_b32 s93, s93, 65535
    s_lshl_b32 s55, s40, 18
    s_lshl_b32 s56, s62, 4
    s_add_u32 s88, s55, s56
    s_lshl_b32 s56, s43, 14
    s_add_u32 s89, s55, s56
    s_sub_u32 s89, s89, 32768
    v_lshrrev_b32 v224, 7, v254
    v_and_b32 v225, 0x70, v254
    v_and_b32 v226, 6, v224
    v_lshlrev_b32 v226, 4, v226
    v_xor_b32 v225, v225, v226
    v_mul_u32_u24 v224, 2048, v224
    v_add3_u32 v217, v224, v225, s88
    v_add_u32 v218, 15360, v217
    v_add_u32 v219, 30720, v217
    v_add_u32 v220, 46080, v217
    s_lshl_b32 s94, s92, 7
    s_cmp_eq_u32 s40, 0
    s_cselect_b32 s89, 2130706432, s89
    s_sub_u32 s89, s89, s88
    v_add_u32 v221, s89, v217
    s_lshl_b32 s91, s43, 10
    s_cmp_eq_u32 s44, 0
    s_cselect_b32 s84, -1, 0
    s_not_b32 s85, s84
    s_add_u32 m0, s91, 98304
    s_mov_b64 exec, s[84:85]
    buffer_load_dwordx4 v221, s[36:39], s94 offen lds
    s_mov_b64 exec, -1
    s_add_u32 m0, s62, 100352
    s_nop 0
    buffer_load_dwordx4 v217, s[36:39], s94 offen lds
    buffer_load_dwordx4 v218, s[36:39], s94 offen offset:1024 lds
    buffer_load_dwordx4 v219, s[36:39], s94 offen offset:2048 lds
    buffer_load_dwordx4 v220, s[36:39], s94 offen offset:3072 lds
    s_add_u32 s94, s94, 256
    s_and_b32 s94, s94, 2047
    s_add_u32 m0, s61, 16384
    s_mul_i32 s59, s93, 96
    buffer_load_dwordx4 v200, s[8:11], s59 offen lds
    buffer_load_dwordx4 v201, s[8:11], s59 offen offset:1024 lds
    buffer_load_dwordx4 v202, s[8:11], s59 offen offset:2048 lds
    s_add_u32 s93, s93, 6144
    s_and_b32 s93, s93, 65535
    s_add_u32 m0, s91, 116736
    s_mov_b64 exec, s[84:85]
    buffer_load_dwordx4 v221, s[36:39], s94 offen lds
    s_mov_b64 exec, -1
    s_add_u32 m0, s62, 118784
    s_nop 0
    buffer_load_dwordx4 v217, s[36:39], s94 offen lds
    buffer_load_dwordx4 v218, s[36:39], s94 offen offset:1024 lds
    buffer_load_dwordx4 v219, s[36:39], s94 offen offset:2048 lds
    buffer_load_dwordx4 v220, s[36:39], s94 offen offset:3072 lds
    s_add_u32 s94, s94, 256
    s_and_b32 s94, s94, 2047
    s_add_u32 m0, s61, 32768
    s_mul_i32 s59, s93, 96
    buffer_load_dwordx4 v200, s[8:11], s59 offen lds
    buffer_load_dwordx4 v201, s[8:11], s59 offen offset:1024 lds
    buffer_load_dwordx4 v202, s[8:11], s59 offen offset:2048 lds
    s_add_u32 s93, s93, 2048
    s_and_b32 s93, s93, 65535
    s_add_u32 s55, s62, 100352
    v_add_u32 v224, s55, v254
    v_mov_b32 v225, 0x3f803f80
    s_waitcnt vmcnt(11)
    ds_read_b128 v[144:147], v224 offset:0
    ds_read_b128 v[148:151], v224 offset:1024
    ds_read_b128 v[152:155], v224 offset:2048
    ds_read_b128 v[156:159], v224 offset:3072
    s_waitcnt lgkmcnt(0)
    v_dot2_f32_bf16 v160, v144, v225, 0
    v_dot2_f32_bf16 v161, v144, v144, 0
    v_dot2_f32_bf16 v162, v148, v225, 0
    v_dot2_f32_bf16 v163, v148, v148, 0
    v_dot2_f32_bf16 v164, v152, v225, 0
    v_dot2_f32_bf16 v165, v152, v152, 0
    v_dot2_f32_bf16 v166, v156, v225, 0
    v_dot2_f32_bf16 v167, v156, v156, 0
    v_dot2_f32_bf16 v160, v145, v225, v160
    v_dot2_f32_bf16 v161, v145, v145, v161
    v_dot2_f32_bf16 v162, v149, v225, v162
    v_dot2_f32_bf16 v163, v149, v149, v163
    v_dot2_f32_bf16 v164, v153, v225, v164
    v_dot2_f32_bf16 v165, v153, v153, v165
    v_dot2_f32_bf16 v166, v157, v225, v166
    v_dot2_f32_bf16 v167, v157, v157, v167
    v_dot2_f32_bf16 v160, v146, v225, v160
    v_dot2_f32_bf16 v161, v146, v146, v161
    v_dot2_f32_bf16 v162, v150, v225, v162
    v_dot2_f32_bf16 v163, v150, v150, v163
    v_dot2_f32_bf16 v164, v154, v225, v164
    v_dot2_f32_bf16 v165, v154, v154, v165
    v_dot2_f32_bf16 v166, v158, v225, v166
    v_dot2_f32_bf16 v167, v158, v158, v167
    v_dot2_f32_bf16 v160, v147, v225, v160
    v_dot2_f32_bf16 v161, v147, v147, v161
    v_dot2_f32_bf16 v162, v151, v225, v162
    v_dot2_f32_bf16 v163, v151, v151, v163
    v_dot2_f32_bf16 v164, v155, v225, v164
    v_dot2_f32_bf16 v165, v155, v155, v165
    v_dot2_f32_bf16 v166, v159, v225, v166
    v_dot2_f32_bf16 v167, v159, v159, v167
    s_branch Y_first
X_start:
    s_cmp_lg_u32 s42, 0
    s_cbranch_scc1 xz_3
    v_mov_b32 v103, 0
    v_lshrrev_b32 v100, 2, v254
    s_lshl_b32 s55, s2, 8
    s_add_u32 s55, s55, 71303168
    buffer_store_dword v103, v100, s[4:7], s55 offen sc0 sc1
    v_lshlrev_b32 v100, 6, v254
    s_lshl_b32 s55, s2, 2
    s_add_u32 s55, s55, 71565312
    s_mov_b64 exec, 15
    buffer_store_dword v103, v100, s[4:7], s55 offen sc0 sc1
    s_mov_b64 exec, -1
xz_3:
    s_getpc_b64 s[72:73]
K_pc:
    s_mov_b32 s74, K_end-K_pc
    s_mov_b32 s75, 0x00020000
    s_lshr_b32 s55, s2, 3
    s_lshl_b32 s55, s55, 2
    s_add_u32 s55, s55, s42
    s_lshl_b32 s55, s55, 10
    v_lshlrev_b32 v100, 3, v254
    s_mov_b64 exec, 0xff
    buffer_load_dword v235, v100, s[72:75], s55 offen
    s_mov_b64 exec, -1
    s_cmp_lg_u32 s42, 0
    s_cbranch_scc1 xz_4
    s_getreg_b32 s59, hwreg(HW_REG_XCC_ID, 0, 4)
    s_mul_i32 s55, s59, s59
    s_lshl_b32 s55, s55, 15
    s_lshl_b32 s59, s59, 6
    s_add_u32 s59, s59, s55
    s_add_u32 s59, s59, 1
    v_mov_b32 v253, s59
    s_and_b32 s55, s2, 7
    s_lshl_b32 s55, s55, 5
    v_mov_b32 v252, 0
    s_waitcnt vmcnt(1)
    s_mov_b64 exec, 1
    buffer_atomic_add v253, v252, s[32:35], s55 offen sc1
    s_mov_b64 exec, -1
xz_4:
X_layer:
    v_lshrrev_b32 v206, 4, v254
    v_lshrrev_b32 v207, 8, v254
    v_and_b32 v208, 15, v206
    s_lshl_b32 s55, s43, 13
    s_add_u32 s55, s55, 98304
    s_cmp_lg_u32 s46, 0
    s_cbranch_scc1 g1_5
    v_and_b32 v210, 6, v208
    v_xor_b32 v210, v210, v207
    v_lshlrev_b32 v210, 4, v210
    v_lshl_add_u32 v200, v208, 7, v210
    v_xor_b32 v201, 64, v200
    s_branch g1_6
g1_5:
    v_mov_b32 v200, v254
    v_add_u32 v201, 1024, v254
g1_6:
    v_add_u32 v200, s55, v200
    v_add_u32 v201, s55, v201
    v_lshrrev_b32 v209, 6, v254
    v_lshrrev_b32 v210, 1, v209
    v_and_b32 v210, 3, v210
    s_lshl_b32 s55, s44, 1
    v_xor_b32 v210, s55, v210
    v_lshlrev_b32 v209, 7, v209
    v_lshl_add_u32 v209, v210, 5, v209
    v_and_b32 v210, 0x30, v254
    v_lshrrev_b32 v210, 1, v210
    v_add_u32 v202, v209, v210
    v_xor_b32 v203, 32, v202
    v_add_u32 v204, 49152, v202
    v_add_u32 v205, 49152, v203
    s_add_u32 s88, s1, s47
    v_lshlrev_b32 v209, 2, v207
    v_sub_u32 v209, v208, v209
    v_cmp_le_i32 s[72:73], 0, v209
    v_cmp_le_i32 s[74:75], 1, v209
    v_cmp_le_i32 s[76:77], 2, v209
    v_cmp_le_i32 s[78:79], 3, v209
    v_and_b32 v210, 1, v208
    v_cmp_eq_u32 s[80:81], 1, v210
    v_sub_u32 v209, v209, v210
    v_mov_b32 v212, 0x0c0c0c0c
    v_mov_b32 v210, 0xc0c0100
    v_mov_b32 v211, 0x1000c0c
    v_cmp_le_i32 vcc, 0, v209
    v_cndmask_b32 v210, v210, v211, s[80:81]
    s_not_b64 s[82:83], vcc
    v_cndmask_b32 v214, v210, v212, vcc
    v_cndmask_b32 v216, v212, v210, vcc
    v_mov_b32 v210, 0xc0c0302
    v_mov_b32 v211, 0x3020c0c
    v_cmp_le_i32 vcc, 2, v209
    v_cndmask_b32 v210, v210, v211, s[80:81]
    s_not_b64 s[84:85], vcc
    v_cndmask_b32 v215, v210, v212, vcc
    v_cndmask_b32 v217, v212, v210, vcc
    s_or_b32 s55, s40, s43
    s_cmp_eq_u32 s55, 0
    s_cselect_b64 s[82:83], s[82:83], 0
    s_cselect_b64 s[84:85], s[84:85], 0
    s_lshl_b32 s55, s43, 8
    s_add_u32 s55, s55, 159744
    v_lshlrev_b32 v218, 2, v208
    v_add_u32 v218, s55, v218
    v_lshlrev_b32 v219, 4, v207
    v_add_u32 v219, s55, v219
    s_lshl_b32 s55, s44, 7
    s_add_u32 s55, s55, 160896
    v_lshlrev_b32 v220, 4, v207
    v_add_u32 v220, s55, v220
    v_lshlrev_b32 v221, 2, v208
    v_add_u32 v221, s55, v221
    v_mov_b32 v222, 0x3f803f80
    v_mov_b32 v223, 0x3f803f80
    v_mov_b32 v224, 0x3f803f80
    v_mov_b32 v225, 0x3f803f80
    v_mov_b32 v213, 163712
    v_and_b32 v206, 0xf0, v254
    v_lshlrev_b32 v206, 7, v206
    v_and_b32 v210, 0x100, v254
    v_lshrrev_b32 v210, 3, v210
    v_add_u32 v206, v206, v210
    v_and_b32 v210, 0x200, v254
    v_lshrrev_b32 v210, 5, v210
    v_add_u32 v206, v206, v210
    s_lshl_b32 s92, s40, 18
    s_lshl_b32 s56, s43, 17
    s_add_u32 s92, s92, s56
    s_lshl_b32 s56, s51, 7
    s_add_u32 s92, s92, s56
    s_lshl_b32 s56, s44, 6
    s_add_u32 s92, s92, s56
    s_cmp_eq_u32 s46, 0
    s_cbranch_scc1 g1_7
    s_waitcnt vmcnt(0) lgkmcnt(0)
    s_barrier
    s_cmp_lg_u32 s42, 2
    s_cbranch_scc1 wf_8
    s_lshr_b32 s55, s2, 5
    s_lshl_b32 s55, s55, 2
    s_add_u32 s55, s55, s0
    v_mov_b32 v252, 64
    v_mov_b32 v253, 0x01010101
    s_mov_b64 exec, 1
    s_cmp_eq_u32 s45, 0
    s_cbranch_scc1 st_9
    buffer_store_dword v253, v252, s[4:7], s55 offen sc0 sc1
    s_branch st_10
st_9:
    buffer_store_dword v253, v252, s[4:7], s55 offen
st_10:
    s_mov_b64 exec, -1
wf_8:
    s_cmp_lg_u32 s42, 3
    s_cbranch_scc1 wf_11
    s_lshl_b32 s55, s51, 2
    s_add_u32 s55, s55, s54
    v_mov_b32 v252, 8192
    v_mov_b32 v253, 0x01010101
    s_mov_b64 exec, 1
    buffer_store_dword v253, v252, s[4:7], s55 offen sc0 sc1
    s_mov_b64 exec, -1
wf_11:
    s_cmp_lg_u32 s42, 0
    s_cbranch_scc1 so_12
    v_add_u32 v234, 155648, v254
    ds_read_b128 v[226:229], v234
    ds_read_b128 v[230:233], v234 offset:1024
    s_lshl_b32 s55, s51, 10
    s_add_u32 s55, s55, s53
    s_waitcnt lgkmcnt(0)
    v_add_f32 v226, v226, v230
    v_add_f32 v227, v227, v231
    v_add_f32 v228, v228, v232
    v_add_f32 v229, v229, v233
    buffer_store_dwordx4 v[226:229], v254, s[4:7], s55 offen sc0 sc1
so_12:
g1_7:
    s_barrier
    ds_read_b64_tr_b16 v[152:153], v202 offset:0
    ds_read_b64_tr_b16 v[154:155], v202 offset:2048
    ds_read_b128 v[116:119], v200 offset:2048
    ds_read_b128 v[120:123], v200 offset:4096
    ds_read_b128 v[124:127], v200 offset:6144
    ds_read_b128 v[128:131], v200 offset:8192
    ds_read_b64_tr_b16 v[156:157], v203 offset:0
    ds_read_b64_tr_b16 v[158:159], v203 offset:2048
    ds_read_b64_tr_b16 v[160:161], v202 offset:4096
    ds_read_b64_tr_b16 v[162:163], v202 offset:6144
    ds_read_b128 v[112:115], v200 offset:0
    ds_read_b64_tr_b16 v[164:165], v203 offset:4096
    ds_read_b64_tr_b16 v[166:167], v203 offset:6144
    ds_read_b64_tr_b16 v[168:169], v202 offset:8192
    ds_read_b64_tr_b16 v[170:171], v202 offset:10240
    ds_read_b64_tr_b16 v[172:173], v203 offset:8192
    ds_read_b64_tr_b16 v[174:175], v203 offset:10240
    s_mov_b32 s58, 5
    s_waitcnt lgkmcnt(0)
    s_barrier
    .p2align 3
    v_mfma_f32_16x16x32_bf16 v[0:3], v[152:155], v[116:119], 0
    ds_read_b64_tr_b16 v[176:177], v202 offset:16384
    v_mfma_f32_16x16x32_bf16 v[8:11], v[152:155], v[120:123], 0
    ds_read_b64_tr_b16 v[178:179], v202 offset:18432
    v_mfma_f32_16x16x32_bf16 v[16:19], v[152:155], v[124:127], 0
    ds_read_b128 v[136:139], v201 offset:2048
    v_mfma_f32_16x16x32_bf16 v[24:27], v[152:155], v[128:131], 0
    ds_read_b128 v[140:143], v201 offset:4096
    v_mfma_f32_16x16x32_bf16 v[28:31], v[156:159], v[128:131], 0
    ds_read_b128 v[144:147], v201 offset:6144
    v_mfma_f32_16x16x32_bf16 v[20:23], v[156:159], v[124:127], 0
    v_mfma_f32_16x16x32_bf16 v[12:15], v[156:159], v[120:123], 0
    ds_read_b128 v[148:151], v201 offset:8192
    v_mfma_f32_16x16x32_bf16 v[4:7], v[156:159], v[116:119], 0
    ds_read_b64_tr_b16 v[180:181], v203 offset:16384
    v_mfma_f32_16x16x32_bf16 v[40:43], v[160:163], v[116:119], 0
    ds_read_b64_tr_b16 v[182:183], v203 offset:18432
    v_mfma_f32_16x16x32_bf16 v[48:51], v[160:163], v[120:123], 0
    ds_read_b64_tr_b16 v[184:185], v202 offset:20480
    v_mfma_f32_16x16x32_bf16 v[56:59], v[160:163], v[124:127], 0
    v_mfma_f32_16x16x32_bf16 v[64:67], v[160:163], v[128:131], 0
    ds_read_b64_tr_b16 v[186:187], v202 offset:22528
    v_mfma_f32_16x16x32_bf16 v[32:35], v[160:163], v[112:115], 0
    ds_read_b128 v[132:135], v201 offset:0
    v_mfma_f32_16x16x32_bf16 v[36:39], v[164:167], v[112:115], 0
    ds_read_b64_tr_b16 v[188:189], v203 offset:20480
    v_mfma_f32_16x16x32_bf16 v[68:71], v[164:167], v[128:131], 0
    ds_read_b64_tr_b16 v[190:191], v203 offset:22528
    v_mfma_f32_16x16x32_bf16 v[60:63], v[164:167], v[124:127], 0
    v_mfma_f32_16x16x32_bf16 v[52:55], v[164:167], v[120:123], 0
    ds_read_b64_tr_b16 v[192:193], v202 offset:24576
    v_mfma_f32_16x16x32_bf16 v[44:47], v[164:167], v[116:119], 0
    ds_read_b64_tr_b16 v[194:195], v202 offset:26624
    v_mfma_f32_16x16x32_bf16 v[72:75], v[112:115], v[168:171], 0
    ds_read_b64_tr_b16 v[196:197], v203 offset:24576
    v_mfma_f32_16x16x32_bf16 v[80:83], v[116:119], v[168:171], 0
    ds_read_b64_tr_b16 v[198:199], v203 offset:26624
    v_mfma_f32_16x16x32_bf16 v[88:91], v[120:123], v[168:171], 0
    v_mfma_f32_16x16x32_bf16 v[96:99], v[124:127], v[168:171], 0
    v_mfma_f32_16x16x32_bf16 v[104:107], v[128:131], v[168:171], 0
    v_mfma_f32_16x16x32_bf16 v[108:111], v[128:131], v[172:175], 0
    v_mfma_f32_16x16x32_bf16 v[100:103], v[124:127], v[172:175], 0
    v_mfma_f32_16x16x32_bf16 v[92:95], v[120:123], v[172:175], 0
    v_mfma_f32_16x16x32_bf16 v[84:87], v[116:119], v[172:175], 0
    v_mfma_f32_16x16x32_bf16 v[76:79], v[112:115], v[172:175], 0
    .p2align 3
loop_13:
    s_waitcnt lgkmcnt(0)
    s_barrier
    .p2align 3
    v_mfma_f32_16x16x32_bf16 v[0:3], v[176:179], v[136:139], v[0:3]
    ds_read_b64_tr_b16 v[152:153], v202 offset:32768
    v_mfma_f32_16x16x32_bf16 v[8:11], v[176:179], v[140:143], v[8:11]
    ds_read_b64_tr_b16 v[154:155], v202 offset:34816
    v_mfma_f32_16x16x32_bf16 v[16:19], v[176:179], v[144:147], v[16:19]
    ds_read_b128 v[116:119], v200 offset:20480
    v_mfma_f32_16x16x32_bf16 v[24:27], v[176:179], v[148:151], v[24:27]
    ds_read_b128 v[120:123], v200 offset:22528
    v_mfma_f32_16x16x32_bf16 v[28:31], v[180:183], v[148:151], v[28:31]
    ds_read_b128 v[124:127], v200 offset:24576
    v_mfma_f32_16x16x32_bf16 v[20:23], v[180:183], v[144:147], v[20:23]
    v_mfma_f32_16x16x32_bf16 v[12:15], v[180:183], v[140:143], v[12:15]
    ds_read_b128 v[128:131], v200 offset:26624
    v_mfma_f32_16x16x32_bf16 v[4:7], v[180:183], v[136:139], v[4:7]
    ds_read_b64_tr_b16 v[156:157], v203 offset:32768
    v_mfma_f32_16x16x32_bf16 v[40:43], v[184:187], v[136:139], v[40:43]
    ds_read_b64_tr_b16 v[158:159], v203 offset:34816
    v_mfma_f32_16x16x32_bf16 v[48:51], v[184:187], v[140:143], v[48:51]
    ds_read_b64_tr_b16 v[160:161], v202 offset:36864
    v_mfma_f32_16x16x32_bf16 v[56:59], v[184:187], v[144:147], v[56:59]
    v_mfma_f32_16x16x32_bf16 v[64:67], v[184:187], v[148:151], v[64:67]
    ds_read_b64_tr_b16 v[162:163], v202 offset:38912
    v_mfma_f32_16x16x32_bf16 v[32:35], v[184:187], v[132:135], v[32:35]
    ds_read_b128 v[112:115], v200 offset:18432
    v_mfma_f32_16x16x32_bf16 v[36:39], v[188:191], v[132:135], v[36:39]
    ds_read_b64_tr_b16 v[164:165], v203 offset:36864
    v_mfma_f32_16x16x32_bf16 v[68:71], v[188:191], v[148:151], v[68:71]
    ds_read_b64_tr_b16 v[166:167], v203 offset:38912
    v_mfma_f32_16x16x32_bf16 v[60:63], v[188:191], v[144:147], v[60:63]
    v_mfma_f32_16x16x32_bf16 v[52:55], v[188:191], v[140:143], v[52:55]
    ds_read_b64_tr_b16 v[168:169], v202 offset:40960
    v_mfma_f32_16x16x32_bf16 v[44:47], v[188:191], v[136:139], v[44:47]
    ds_read_b64_tr_b16 v[170:171], v202 offset:43008
    v_mfma_f32_16x16x32_bf16 v[72:75], v[132:135], v[192:195], v[72:75]
    ds_read_b64_tr_b16 v[172:173], v203 offset:40960
    v_mfma_f32_16x16x32_bf16 v[80:83], v[136:139], v[192:195], v[80:83]
    ds_read_b64_tr_b16 v[174:175], v203 offset:43008
    v_mfma_f32_16x16x32_bf16 v[88:91], v[140:143], v[192:195], v[88:91]
    v_mfma_f32_16x16x32_bf16 v[96:99], v[144:147], v[192:195], v[96:99]
    v_mfma_f32_16x16x32_bf16 v[104:107], v[148:151], v[192:195], v[104:107]
    v_mfma_f32_16x16x32_bf16 v[108:111], v[148:151], v[196:199], v[108:111]
    v_mfma_f32_16x16x32_bf16 v[100:103], v[144:147], v[196:199], v[100:103]
    v_mfma_f32_16x16x32_bf16 v[92:95], v[140:143], v[196:199], v[92:95]
    v_mfma_f32_16x16x32_bf16 v[84:87], v[136:139], v[196:199], v[84:87]
    v_mfma_f32_16x16x32_bf16 v[76:79], v[132:135], v[196:199], v[76:79]
    s_waitcnt vmcnt(0) lgkmcnt(0)
    s_barrier
    .p2align 3
    v_mfma_f32_16x16x32_bf16 v[0:3], v[152:155], v[116:119], v[0:3]
    ds_read_b64_tr_b16 v[176:177], v204 offset:0
    v_mfma_f32_16x16x32_bf16 v[8:11], v[152:155], v[120:123], v[8:11]
    ds_read_b64_tr_b16 v[178:179], v204 offset:2048
    v_mfma_f32_16x16x32_bf16 v[16:19], v[152:155], v[124:127], v[16:19]
    ds_read_b128 v[136:139], v201 offset:20480
    v_mfma_f32_16x16x32_bf16 v[24:27], v[152:155], v[128:131], v[24:27]
    ds_read_b128 v[140:143], v201 offset:22528
    v_mfma_f32_16x16x32_bf16 v[28:31], v[156:159], v[128:131], v[28:31]
    ds_read_b128 v[144:147], v201 offset:24576
    v_mfma_f32_16x16x32_bf16 v[20:23], v[156:159], v[124:127], v[20:23]
    v_mfma_f32_16x16x32_bf16 v[12:15], v[156:159], v[120:123], v[12:15]
    ds_read_b128 v[148:151], v201 offset:26624
    v_mfma_f32_16x16x32_bf16 v[4:7], v[156:159], v[116:119], v[4:7]
    ds_read_b64_tr_b16 v[180:181], v205 offset:0
    v_mfma_f32_16x16x32_bf16 v[40:43], v[160:163], v[116:119], v[40:43]
    ds_read_b64_tr_b16 v[182:183], v205 offset:2048
    v_mfma_f32_16x16x32_bf16 v[48:51], v[160:163], v[120:123], v[48:51]
    ds_read_b64_tr_b16 v[184:185], v204 offset:4096
    v_mfma_f32_16x16x32_bf16 v[56:59], v[160:163], v[124:127], v[56:59]
    v_mfma_f32_16x16x32_bf16 v[64:67], v[160:163], v[128:131], v[64:67]
    ds_read_b64_tr_b16 v[186:187], v204 offset:6144
    v_mfma_f32_16x16x32_bf16 v[32:35], v[160:163], v[112:115], v[32:35]
    ds_read_b128 v[132:135], v201 offset:18432
    v_mfma_f32_16x16x32_bf16 v[36:39], v[164:167], v[112:115], v[36:39]
    ds_read_b64_tr_b16 v[188:189], v205 offset:4096
    v_mfma_f32_16x16x32_bf16 v[68:71], v[164:167], v[128:131], v[68:71]
    ds_read_b64_tr_b16 v[190:191], v205 offset:6144
    v_mfma_f32_16x16x32_bf16 v[60:63], v[164:167], v[124:127], v[60:63]
    v_mfma_f32_16x16x32_bf16 v[52:55], v[164:167], v[120:123], v[52:55]
    ds_read_b64_tr_b16 v[192:193], v204 offset:8192
    v_mfma_f32_16x16x32_bf16 v[44:47], v[164:167], v[116:119], v[44:47]
    ds_read_b64_tr_b16 v[194:195], v204 offset:10240
    v_mfma_f32_16x16x32_bf16 v[72:75], v[112:115], v[168:171], v[72:75]
    ds_read_b64_tr_b16 v[196:197], v205 offset:8192
    v_mfma_f32_16x16x32_bf16 v[80:83], v[116:119], v[168:171], v[80:83]
    ds_read_b64_tr_b16 v[198:199], v205 offset:10240
    v_mfma_f32_16x16x32_bf16 v[88:91], v[120:123], v[168:171], v[88:91]
    v_mfma_f32_16x16x32_bf16 v[96:99], v[124:127], v[168:171], v[96:99]
    v_mfma_f32_16x16x32_bf16 v[104:107], v[128:131], v[168:171], v[104:107]
    v_mfma_f32_16x16x32_bf16 v[108:111], v[128:131], v[172:175], v[108:111]
    v_mfma_f32_16x16x32_bf16 v[100:103], v[124:127], v[172:175], v[100:103]
    v_mfma_f32_16x16x32_bf16 v[92:95], v[120:123], v[172:175], v[92:95]
    v_mfma_f32_16x16x32_bf16 v[84:87], v[116:119], v[172:175], v[84:87]
    v_mfma_f32_16x16x32_bf16 v[76:79], v[112:115], v[172:175], v[76:79]
    s_waitcnt lgkmcnt(0)
    s_barrier
    .p2align 3
    v_mfma_f32_16x16x32_bf16 v[0:3], v[176:179], v[136:139], v[0:3]
    ds_read_b64_tr_b16 v[152:153], v204 offset:16384
    v_mfma_f32_16x16x32_bf16 v[8:11], v[176:179], v[140:143], v[8:11]
    ds_read_b64_tr_b16 v[154:155], v204 offset:18432
    v_mfma_f32_16x16x32_bf16 v[16:19], v[176:179], v[144:147], v[16:19]
    ds_read_b128 v[116:119], v200 offset:38912
    v_mfma_f32_16x16x32_bf16 v[24:27], v[176:179], v[148:151], v[24:27]
    ds_read_b128 v[120:123], v200 offset:40960
    v_mfma_f32_16x16x32_bf16 v[28:31], v[180:183], v[148:151], v[28:31]
    ds_read_b128 v[124:127], v200 offset:43008
    v_mfma_f32_16x16x32_bf16 v[20:23], v[180:183], v[144:147], v[20:23]
    v_mfma_f32_16x16x32_bf16 v[12:15], v[180:183], v[140:143], v[12:15]
    ds_read_b128 v[128:131], v200 offset:45056
    v_mfma_f32_16x16x32_bf16 v[4:7], v[180:183], v[136:139], v[4:7]
    ds_read_b64_tr_b16 v[156:157], v205 offset:16384
    v_mfma_f32_16x16x32_bf16 v[40:43], v[184:187], v[136:139], v[40:43]
    ds_read_b64_tr_b16 v[158:159], v205 offset:18432
    v_mfma_f32_16x16x32_bf16 v[48:51], v[184:187], v[140:143], v[48:51]
    ds_read_b64_tr_b16 v[160:161], v204 offset:20480
    v_mfma_f32_16x16x32_bf16 v[56:59], v[184:187], v[144:147], v[56:59]
    v_mfma_f32_16x16x32_bf16 v[64:67], v[184:187], v[148:151], v[64:67]
    ds_read_b64_tr_b16 v[162:163], v204 offset:22528
    v_mfma_f32_16x16x32_bf16 v[32:35], v[184:187], v[132:135], v[32:35]
    ds_read_b128 v[112:115], v200 offset:36864
    v_mfma_f32_16x16x32_bf16 v[36:39], v[188:191], v[132:135], v[36:39]
    ds_read_b64_tr_b16 v[164:165], v205 offset:20480
    v_mfma_f32_16x16x32_bf16 v[68:71], v[188:191], v[148:151], v[68:71]
    ds_read_b64_tr_b16 v[166:167], v205 offset:22528
    v_mfma_f32_16x16x32_bf16 v[60:63], v[188:191], v[144:147], v[60:63]
    v_mfma_f32_16x16x32_bf16 v[52:55], v[188:191], v[140:143], v[52:55]
    ds_read_b64_tr_b16 v[168:169], v204 offset:24576
    v_mfma_f32_16x16x32_bf16 v[44:47], v[188:191], v[136:139], v[44:47]
    ds_read_b64_tr_b16 v[170:171], v204 offset:26624
    v_mfma_f32_16x16x32_bf16 v[72:75], v[132:135], v[192:195], v[72:75]
    ds_read_b64_tr_b16 v[172:173], v205 offset:24576
    v_mfma_f32_16x16x32_bf16 v[80:83], v[136:139], v[192:195], v[80:83]
    ds_read_b64_tr_b16 v[174:175], v205 offset:26624
    v_mfma_f32_16x16x32_bf16 v[88:91], v[140:143], v[192:195], v[88:91]
    v_mfma_f32_16x16x32_bf16 v[96:99], v[144:147], v[192:195], v[96:99]
    v_mfma_f32_16x16x32_bf16 v[104:107], v[148:151], v[192:195], v[104:107]
    v_mfma_f32_16x16x32_bf16 v[108:111], v[148:151], v[196:199], v[108:111]
    v_mfma_f32_16x16x32_bf16 v[100:103], v[144:147], v[196:199], v[100:103]
    v_mfma_f32_16x16x32_bf16 v[92:95], v[140:143], v[196:199], v[92:95]
    v_mfma_f32_16x16x32_bf16 v[84:87], v[136:139], v[196:199], v[84:87]
    v_mfma_f32_16x16x32_bf16 v[76:79], v[132:135], v[196:199], v[76:79]
    s_waitcnt lgkmcnt(0)
    s_barrier
    .p2align 3
    v_mfma_f32_16x16x32_bf16 v[0:3], v[152:155], v[116:119], v[0:3]
    ds_read_b64_tr_b16 v[176:177], v204 offset:32768
    v_mfma_f32_16x16x32_bf16 v[8:11], v[152:155], v[120:123], v[8:11]
    ds_read_b64_tr_b16 v[178:179], v204 offset:34816
    v_mfma_f32_16x16x32_bf16 v[16:19], v[152:155], v[124:127], v[16:19]
    ds_read_b128 v[136:139], v201 offset:38912
    v_mfma_f32_16x16x32_bf16 v[24:27], v[152:155], v[128:131], v[24:27]
    ds_read_b128 v[140:143], v201 offset:40960
    v_mfma_f32_16x16x32_bf16 v[28:31], v[156:159], v[128:131], v[28:31]
    ds_read_b128 v[144:147], v201 offset:43008
    v_mfma_f32_16x16x32_bf16 v[20:23], v[156:159], v[124:127], v[20:23]
    v_mfma_f32_16x16x32_bf16 v[12:15], v[156:159], v[120:123], v[12:15]
    ds_read_b128 v[148:151], v201 offset:45056
    v_mfma_f32_16x16x32_bf16 v[4:7], v[156:159], v[116:119], v[4:7]
    ds_read_b64_tr_b16 v[180:181], v205 offset:32768
    v_mfma_f32_16x16x32_bf16 v[40:43], v[160:163], v[116:119], v[40:43]
    ds_read_b64_tr_b16 v[182:183], v205 offset:34816
    v_mfma_f32_16x16x32_bf16 v[48:51], v[160:163], v[120:123], v[48:51]
    ds_read_b64_tr_b16 v[184:185], v204 offset:36864
    v_mfma_f32_16x16x32_bf16 v[56:59], v[160:163], v[124:127], v[56:59]
    v_mfma_f32_16x16x32_bf16 v[64:67], v[160:163], v[128:131], v[64:67]
    ds_read_b64_tr_b16 v[186:187], v204 offset:38912
    v_mfma_f32_16x16x32_bf16 v[32:35], v[160:163], v[112:115], v[32:35]
    ds_read_b128 v[132:135], v201 offset:36864
    v_mfma_f32_16x16x32_bf16 v[36:39], v[164:167], v[112:115], v[36:39]
    ds_read_b64_tr_b16 v[188:189], v205 offset:36864
    v_mfma_f32_16x16x32_bf16 v[68:71], v[164:167], v[128:131], v[68:71]
    ds_read_b64_tr_b16 v[190:191], v205 offset:38912
    v_mfma_f32_16x16x32_bf16 v[60:63], v[164:167], v[124:127], v[60:63]
    v_mfma_f32_16x16x32_bf16 v[52:55], v[164:167], v[120:123], v[52:55]
    ds_read_b64_tr_b16 v[192:193], v204 offset:40960
    v_mfma_f32_16x16x32_bf16 v[44:47], v[164:167], v[116:119], v[44:47]
    ds_read_b64_tr_b16 v[194:195], v204 offset:43008
    v_mfma_f32_16x16x32_bf16 v[72:75], v[112:115], v[168:171], v[72:75]
    ds_read_b64_tr_b16 v[196:197], v205 offset:40960
    v_mfma_f32_16x16x32_bf16 v[80:83], v[116:119], v[168:171], v[80:83]
    ds_read_b64_tr_b16 v[198:199], v205 offset:43008
    v_mfma_f32_16x16x32_bf16 v[88:91], v[120:123], v[168:171], v[88:91]
    v_mfma_f32_16x16x32_bf16 v[96:99], v[124:127], v[168:171], v[96:99]
    v_mfma_f32_16x16x32_bf16 v[104:107], v[128:131], v[168:171], v[104:107]
    v_mfma_f32_16x16x32_bf16 v[108:111], v[128:131], v[172:175], v[108:111]
    v_mfma_f32_16x16x32_bf16 v[100:103], v[124:127], v[172:175], v[100:103]
    v_mfma_f32_16x16x32_bf16 v[92:95], v[120:123], v[172:175], v[92:95]
    v_mfma_f32_16x16x32_bf16 v[84:87], v[116:119], v[172:175], v[84:87]
    v_mfma_f32_16x16x32_bf16 v[76:79], v[112:115], v[172:175], v[76:79]
    s_waitcnt lgkmcnt(0)
    s_barrier
    .p2align 3
    v_mfma_f32_16x16x32_bf16 v[0:3], v[176:179], v[136:139], v[0:3]
    ds_read_b64_tr_b16 v[152:153], v202 offset:0
    v_mfma_f32_16x16x32_bf16 v[8:11], v[176:179], v[140:143], v[8:11]
    ds_read_b64_tr_b16 v[154:155], v202 offset:2048
    v_mfma_f32_16x16x32_bf16 v[16:19], v[176:179], v[144:147], v[16:19]
    ds_read_b128 v[116:119], v200 offset:2048
    v_mfma_f32_16x16x32_bf16 v[24:27], v[176:179], v[148:151], v[24:27]
    ds_read_b128 v[120:123], v200 offset:4096
    v_mfma_f32_16x16x32_bf16 v[28:31], v[180:183], v[148:151], v[28:31]
    ds_read_b128 v[124:127], v200 offset:6144
    v_mfma_f32_16x16x32_bf16 v[20:23], v[180:183], v[144:147], v[20:23]
    v_mfma_f32_16x16x32_bf16 v[12:15], v[180:183], v[140:143], v[12:15]
    ds_read_b128 v[128:131], v200 offset:8192
    v_mfma_f32_16x16x32_bf16 v[4:7], v[180:183], v[136:139], v[4:7]
    ds_read_b64_tr_b16 v[156:157], v203 offset:0
    v_mfma_f32_16x16x32_bf16 v[40:43], v[184:187], v[136:139], v[40:43]
    ds_read_b64_tr_b16 v[158:159], v203 offset:2048
    v_mfma_f32_16x16x32_bf16 v[48:51], v[184:187], v[140:143], v[48:51]
    ds_read_b64_tr_b16 v[160:161], v202 offset:4096
    v_mfma_f32_16x16x32_bf16 v[56:59], v[184:187], v[144:147], v[56:59]
    v_mfma_f32_16x16x32_bf16 v[64:67], v[184:187], v[148:151], v[64:67]
    ds_read_b64_tr_b16 v[162:163], v202 offset:6144
    v_mfma_f32_16x16x32_bf16 v[32:35], v[184:187], v[132:135], v[32:35]
    ds_read_b128 v[112:115], v200 offset:0
    v_mfma_f32_16x16x32_bf16 v[36:39], v[188:191], v[132:135], v[36:39]
    ds_read_b64_tr_b16 v[164:165], v203 offset:4096
    v_mfma_f32_16x16x32_bf16 v[68:71], v[188:191], v[148:151], v[68:71]
    ds_read_b64_tr_b16 v[166:167], v203 offset:6144
    v_mfma_f32_16x16x32_bf16 v[60:63], v[188:191], v[144:147], v[60:63]
    v_mfma_f32_16x16x32_bf16 v[52:55], v[188:191], v[140:143], v[52:55]
    ds_read_b64_tr_b16 v[168:169], v202 offset:8192
    v_mfma_f32_16x16x32_bf16 v[44:47], v[188:191], v[136:139], v[44:47]
    ds_read_b64_tr_b16 v[170:171], v202 offset:10240
    v_mfma_f32_16x16x32_bf16 v[72:75], v[132:135], v[192:195], v[72:75]
    ds_read_b64_tr_b16 v[172:173], v203 offset:8192
    v_mfma_f32_16x16x32_bf16 v[80:83], v[136:139], v[192:195], v[80:83]
    ds_read_b64_tr_b16 v[174:175], v203 offset:10240
    v_mfma_f32_16x16x32_bf16 v[88:91], v[140:143], v[192:195], v[88:91]
    v_mfma_f32_16x16x32_bf16 v[96:99], v[144:147], v[192:195], v[96:99]
    v_mfma_f32_16x16x32_bf16 v[104:107], v[148:151], v[192:195], v[104:107]
    v_mfma_f32_16x16x32_bf16 v[108:111], v[148:151], v[196:199], v[108:111]
    v_mfma_f32_16x16x32_bf16 v[100:103], v[144:147], v[196:199], v[100:103]
    v_mfma_f32_16x16x32_bf16 v[92:95], v[140:143], v[196:199], v[92:95]
    v_mfma_f32_16x16x32_bf16 v[84:87], v[136:139], v[196:199], v[84:87]
    v_mfma_f32_16x16x32_bf16 v[76:79], v[132:135], v[196:199], v[76:79]
    s_waitcnt lgkmcnt(0)
    s_barrier
    .p2align 3
    v_mfma_f32_16x16x32_bf16 v[0:3], v[152:155], v[116:119], v[0:3]
    ds_read_b64_tr_b16 v[176:177], v202 offset:16384
    v_mfma_f32_16x16x32_bf16 v[8:11], v[152:155], v[120:123], v[8:11]
    ds_read_b64_tr_b16 v[178:179], v202 offset:18432
    v_mfma_f32_16x16x32_bf16 v[16:19], v[152:155], v[124:127], v[16:19]
    ds_read_b128 v[136:139], v201 offset:2048
    v_mfma_f32_16x16x32_bf16 v[24:27], v[152:155], v[128:131], v[24:27]
    ds_read_b128 v[140:143], v201 offset:4096
    v_mfma_f32_16x16x32_bf16 v[28:31], v[156:159], v[128:131], v[28:31]
    ds_read_b128 v[144:147], v201 offset:6144
    v_mfma_f32_16x16x32_bf16 v[20:23], v[156:159], v[124:127], v[20:23]
    v_mfma_f32_16x16x32_bf16 v[12:15], v[156:159], v[120:123], v[12:15]
    ds_read_b128 v[148:151], v201 offset:8192
    v_mfma_f32_16x16x32_bf16 v[4:7], v[156:159], v[116:119], v[4:7]
    ds_read_b64_tr_b16 v[180:181], v203 offset:16384
    v_mfma_f32_16x16x32_bf16 v[40:43], v[160:163], v[116:119], v[40:43]
    ds_read_b64_tr_b16 v[182:183], v203 offset:18432
    v_mfma_f32_16x16x32_bf16 v[48:51], v[160:163], v[120:123], v[48:51]
    ds_read_b64_tr_b16 v[184:185], v202 offset:20480
    v_mfma_f32_16x16x32_bf16 v[56:59], v[160:163], v[124:127], v[56:59]
    v_mfma_f32_16x16x32_bf16 v[64:67], v[160:163], v[128:131], v[64:67]
    ds_read_b64_tr_b16 v[186:187], v202 offset:22528
    v_mfma_f32_16x16x32_bf16 v[32:35], v[160:163], v[112:115], v[32:35]
    ds_read_b128 v[132:135], v201 offset:0
    v_mfma_f32_16x16x32_bf16 v[36:39], v[164:167], v[112:115], v[36:39]
    ds_read_b64_tr_b16 v[188:189], v203 offset:20480
    v_mfma_f32_16x16x32_bf16 v[68:71], v[164:167], v[128:131], v[68:71]
    ds_read_b64_tr_b16 v[190:191], v203 offset:22528
    v_mfma_f32_16x16x32_bf16 v[60:63], v[164:167], v[124:127], v[60:63]
    v_mfma_f32_16x16x32_bf16 v[52:55], v[164:167], v[120:123], v[52:55]
    ds_read_b64_tr_b16 v[192:193], v202 offset:24576
    v_mfma_f32_16x16x32_bf16 v[44:47], v[164:167], v[116:119], v[44:47]
    ds_read_b64_tr_b16 v[194:195], v202 offset:26624
    v_mfma_f32_16x16x32_bf16 v[72:75], v[112:115], v[168:171], v[72:75]
    ds_read_b64_tr_b16 v[196:197], v203 offset:24576
    v_mfma_f32_16x16x32_bf16 v[80:83], v[116:119], v[168:171], v[80:83]
    ds_read_b64_tr_b16 v[198:199], v203 offset:26624
    v_mfma_f32_16x16x32_bf16 v[88:91], v[120:123], v[168:171], v[88:91]
    v_mfma_f32_16x16x32_bf16 v[96:99], v[124:127], v[168:171], v[96:99]
    v_mfma_f32_16x16x32_bf16 v[104:107], v[128:131], v[168:171], v[104:107]
    v_mfma_f32_16x16x32_bf16 v[108:111], v[128:131], v[172:175], v[108:111]
    v_mfma_f32_16x16x32_bf16 v[100:103], v[124:127], v[172:175], v[100:103]
    s_sub_u32 s58, s58, 1
    s_cmp_lg_u32 s58, 0
    .p2align 3
    v_mfma_f32_16x16x32_bf16 v[92:95], v[120:123], v[172:175], v[92:95]
    v_mfma_f32_16x16x32_bf16 v[84:87], v[116:119], v[172:175], v[84:87]
    v_mfma_f32_16x16x32_bf16 v[76:79], v[112:115], v[172:175], v[76:79]
    s_cbranch_scc1 loop_13
    s_waitcnt lgkmcnt(0)
    s_barrier
    .p2align 3
    v_mfma_f32_16x16x32_bf16 v[0:3], v[176:179], v[136:139], v[0:3]
    ds_read_b128 v[152:155], v220 offset:0
    v_mfma_f32_16x16x32_bf16 v[8:11], v[176:179], v[140:143], v[8:11]
    ds_read_b128 v[156:159], v220 offset:64
    v_mfma_f32_16x16x32_bf16 v[16:19], v[176:179], v[144:147], v[16:19]
    ds_read_b128 v[160:163], v220 offset:256
    v_mfma_f32_16x16x32_bf16 v[24:27], v[176:179], v[148:151], v[24:27]
    ds_read_b128 v[164:167], v220 offset:320
    v_mfma_f32_16x16x32_bf16 v[28:31], v[180:183], v[148:151], v[28:31]
    ds_read_b32 v112, v218 offset:0
    v_mfma_f32_16x16x32_bf16 v[20:23], v[180:183], v[144:147], v[20:23]
    v_mfma_f32_16x16x32_bf16 v[12:15], v[180:183], v[140:143], v[12:15]
    ds_read_b32 v113, v218 offset:64
    v_mfma_f32_16x16x32_bf16 v[4:7], v[180:183], v[136:139], v[4:7]
    ds_read_b32 v114, v218 offset:128
    v_mfma_f32_16x16x32_bf16 v[40:43], v[184:187], v[136:139], v[40:43]
    ds_read_b32 v115, v218 offset:192
    v_mfma_f32_16x16x32_bf16 v[48:51], v[184:187], v[140:143], v[48:51]
    ds_read_b32 v116, v218 offset:256
    v_mfma_f32_16x16x32_bf16 v[56:59], v[184:187], v[144:147], v[56:59]
    v_mfma_f32_16x16x32_bf16 v[64:67], v[184:187], v[148:151], v[64:67]
    ds_read_b32 v118, v218 offset:576
    v_mfma_f32_16x16x32_bf16 v[32:35], v[184:187], v[132:135], v[32:35]
    ds_read_b32 v119, v218 offset:640
    v_mfma_f32_16x16x32_bf16 v[36:39], v[188:191], v[132:135], v[36:39]
    ds_read_b32 v120, v218 offset:704
    v_mfma_f32_16x16x32_bf16 v[68:71], v[188:191], v[148:151], v[68:71]
    ds_read_b32 v121, v218 offset:768
    v_mfma_f32_16x16x32_bf16 v[60:63], v[188:191], v[144:147], v[60:63]
    v_mfma_f32_16x16x32_bf16 v[52:55], v[188:191], v[140:143], v[52:55]
    ds_read_b32 v122, v218 offset:832
    v_mfma_f32_16x16x32_bf16 v[44:47], v[188:191], v[136:139], v[44:47]
    ds_read_b32 v168, v221 offset:512
    v_mfma_f32_16x16x32_bf16 v[72:75], v[132:135], v[192:195], v[72:75]
    ds_read_b32 v169, v221 offset:576
    v_mfma_f32_16x16x32_bf16 v[80:83], v[136:139], v[192:195], v[80:83]
    ds_read_b32 v170, v213
    v_mfma_f32_16x16x32_bf16 v[88:91], v[140:143], v[192:195], v[88:91]
    v_mfma_f32_16x16x32_bf16 v[96:99], v[144:147], v[192:195], v[96:99]
    v_mfma_f32_16x16x32_bf16 v[104:107], v[148:151], v[192:195], v[104:107]
    v_mfma_f32_16x16x32_bf16 v[108:111], v[148:151], v[196:199], v[108:111]
    v_mfma_f32_16x16x32_bf16 v[100:103], v[144:147], v[196:199], v[100:103]
    v_mfma_f32_16x16x32_bf16 v[92:95], v[140:143], v[196:199], v[92:95]
    s_cmp_lg_u32 s46, 0
    s_cbranch_scc1 g1_14
    buffer_load_dwordx4 v[236:239], v206, s[24:27], s92 offen
    s_add_u32 s92, s92, 32768
    buffer_load_dwordx4 v[240:243], v206, s[24:27], s92 offen
    s_add_u32 s92, s92, 32768
    buffer_load_dwordx4 v[244:247], v206, s[24:27], s92 offen
    s_add_u32 s92, s92, 32768
    buffer_load_dwordx4 v[248:251], v206, s[24:27], s92 offen
    s_add_u32 s92, s92, 32768
g1_14:
    .p2align 3
    v_mfma_f32_16x16x32_bf16 v[84:87], v[136:139], v[196:199], v[84:87]
    v_mfma_f32_16x16x32_bf16 v[76:79], v[132:135], v[196:199], v[76:79]
    s_waitcnt lgkmcnt(0)
    .p2align 3
    ds_read_b128 v[132:135], v219 offset:0
    ds_read_b128 v[176:179], v219 offset:576
    ds_read_b128 v[136:139], v219 offset:64
    ds_read_b128 v[180:183], v219 offset:640
    ds_read_b128 v[140:143], v219 offset:128
    ds_read_b128 v[184:187], v219 offset:704
    ds_read_b128 v[144:147], v219 offset:192
    ds_read_b128 v[188:191], v219 offset:768
    ds_read_b128 v[148:151], v219 offset:256
    ds_read_b128 v[192:195], v219 offset:832
    v_pk_fma_f32 v[0:1], v[112:113], v[152:153], v[0:1] op_sel:[1,0,0] op_sel_hi:[1,1,1]
    v_pk_fma_f32 v[2:3], v[112:113], v[154:155], v[2:3] op_sel:[1,0,0] op_sel_hi:[1,1,1]
    v_pk_fma_f32 v[4:5], v[112:113], v[156:157], v[4:5] op_sel:[1,0,0] op_sel_hi:[1,1,1]
    v_pk_fma_f32 v[6:7], v[112:113], v[158:159], v[6:7] op_sel:[1,0,0] op_sel_hi:[1,1,1]
    v_pk_fma_f32 v[8:9], v[114:115], v[152:153], v[8:9] op_sel:[0,0,0] op_sel_hi:[0,1,1]
    v_pk_fma_f32 v[10:11], v[114:115], v[154:155], v[10:11] op_sel:[0,0,0] op_sel_hi:[0,1,1]
    v_pk_fma_f32 v[12:13], v[114:115], v[156:157], v[12:13] op_sel:[0,0,0] op_sel_hi:[0,1,1]
    v_pk_fma_f32 v[14:15], v[114:115], v[158:159], v[14:15] op_sel:[0,0,0] op_sel_hi:[0,1,1]
    v_pk_fma_f32 v[16:17], v[114:115], v[152:153], v[16:17] op_sel:[1,0,0] op_sel_hi:[1,1,1]
    v_pk_fma_f32 v[18:19], v[114:115], v[154:155], v[18:19] op_sel:[1,0,0] op_sel_hi:[1,1,1]
    v_pk_fma_f32 v[20:21], v[114:115], v[156:157], v[20:21] op_sel:[1,0,0] op_sel_hi:[1,1,1]
    v_pk_fma_f32 v[22:23], v[114:115], v[158:159], v[22:23] op_sel:[1,0,0] op_sel_hi:[1,1,1]
    v_pk_fma_f32 v[24:25], v[116:117], v[152:153], v[24:25] op_sel:[0,0,0] op_sel_hi:[0,1,1]
    v_pk_fma_f32 v[26:27], v[116:117], v[154:155], v[26:27] op_sel:[0,0,0] op_sel_hi:[0,1,1]
    v_pk_fma_f32 v[28:29], v[116:117], v[156:157], v[28:29] op_sel:[0,0,0] op_sel_hi:[0,1,1]
    v_pk_fma_f32 v[30:31], v[116:117], v[158:159], v[30:31] op_sel:[0,0,0] op_sel_hi:[0,1,1]
    v_pk_fma_f32 v[32:33], v[112:113], v[160:161], v[32:33] op_sel:[0,0,0] op_sel_hi:[0,1,1]
    v_pk_fma_f32 v[34:35], v[112:113], v[162:163], v[34:35] op_sel:[0,0,0] op_sel_hi:[0,1,1]
    v_pk_fma_f32 v[36:37], v[112:113], v[164:165], v[36:37] op_sel:[0,0,0] op_sel_hi:[0,1,1]
    v_pk_fma_f32 v[38:39], v[112:113], v[166:167], v[38:39] op_sel:[0,0,0] op_sel_hi:[0,1,1]
    v_pk_fma_f32 v[40:41], v[112:113], v[160:161], v[40:41] op_sel:[1,0,0] op_sel_hi:[1,1,1]
    v_pk_fma_f32 v[42:43], v[112:113], v[162:163], v[42:43] op_sel:[1,0,0] op_sel_hi:[1,1,1]
    v_pk_fma_f32 v[44:45], v[112:113], v[164:165], v[44:45] op_sel:[1,0,0] op_sel_hi:[1,1,1]
    v_pk_fma_f32 v[46:47], v[112:113], v[166:167], v[46:47] op_sel:[1,0,0] op_sel_hi:[1,1,1]
    v_pk_fma_f32 v[48:49], v[114:115], v[160:161], v[48:49] op_sel:[0,0,0] op_sel_hi:[0,1,1]
    v_pk_fma_f32 v[50:51], v[114:115], v[162:163], v[50:51] op_sel:[0,0,0] op_sel_hi:[0,1,1]
    v_pk_fma_f32 v[52:53], v[114:115], v[164:165], v[52:53] op_sel:[0,0,0] op_sel_hi:[0,1,1]
    v_pk_fma_f32 v[54:55], v[114:115], v[166:167], v[54:55] op_sel:[0,0,0] op_sel_hi:[0,1,1]
    v_pk_fma_f32 v[56:57], v[114:115], v[160:161], v[56:57] op_sel:[1,0,0] op_sel_hi:[1,1,1]
    v_pk_fma_f32 v[58:59], v[114:115], v[162:163], v[58:59] op_sel:[1,0,0] op_sel_hi:[1,1,1]
    v_pk_fma_f32 v[60:61], v[114:115], v[164:165], v[60:61] op_sel:[1,0,0] op_sel_hi:[1,1,1]
    v_pk_fma_f32 v[62:63], v[114:115], v[166:167], v[62:63] op_sel:[1,0,0] op_sel_hi:[1,1,1]
    v_pk_fma_f32 v[64:65], v[116:117], v[160:161], v[64:65] op_sel:[0,0,0] op_sel_hi:[0,1,1]
    v_pk_fma_f32 v[66:67], v[116:117], v[162:163], v[66:67] op_sel:[0,0,0] op_sel_hi:[0,1,1]
    v_pk_fma_f32 v[68:69], v[116:117], v[164:165], v[68:69] op_sel:[0,0,0] op_sel_hi:[0,1,1]
    v_pk_fma_f32 v[70:71], v[116:117], v[166:167], v[70:71] op_sel:[0,0,0] op_sel_hi:[0,1,1]
    v_cvt_pk_bf16_f32 v0, v0, v1
    v_cvt_pk_bf16_f32 v1, v2, v3
    v_cvt_pk_bf16_f32 v2, v4, v5
    v_cvt_pk_bf16_f32 v3, v6, v7
    v_cvt_pk_bf16_f32 v8, v8, v9
    v_cvt_pk_bf16_f32 v9, v10, v11
    v_cvt_pk_bf16_f32 v10, v12, v13
    v_cvt_pk_bf16_f32 v11, v14, v15
    v_cvt_pk_bf16_f32 v16, v16, v17
    v_cvt_pk_bf16_f32 v17, v18, v19
    v_cvt_pk_bf16_f32 v18, v20, v21
    v_cvt_pk_bf16_f32 v19, v22, v23
    v_cvt_pk_bf16_f32 v24, v24, v25
    v_cvt_pk_bf16_f32 v25, v26, v27
    v_cvt_pk_bf16_f32 v26, v28, v29
    v_cvt_pk_bf16_f32 v27, v30, v31
    v_pk_mul_f32 v[32:33], v[118:119], v[32:33] op_sel:[0,0] op_sel_hi:[0,1]
    v_pk_mul_f32 v[34:35], v[118:119], v[34:35] op_sel:[0,0] op_sel_hi:[0,1]
    v_pk_mul_f32 v[36:37], v[118:119], v[36:37] op_sel:[0,0] op_sel_hi:[0,1]
    v_pk_mul_f32 v[38:39], v[118:119], v[38:39] op_sel:[0,0] op_sel_hi:[0,1]
    v_pk_mul_f32 v[40:41], v[118:119], v[40:41] op_sel:[1,0] op_sel_hi:[1,1]
    v_pk_mul_f32 v[42:43], v[118:119], v[42:43] op_sel:[1,0] op_sel_hi:[1,1]
    v_pk_mul_f32 v[44:45], v[118:119], v[44:45] op_sel:[1,0] op_sel_hi:[1,1]
    v_pk_mul_f32 v[46:47], v[118:119], v[46:47] op_sel:[1,0] op_sel_hi:[1,1]
    v_pk_mul_f32 v[48:49], v[120:121], v[48:49] op_sel:[0,0] op_sel_hi:[0,1]
    v_pk_mul_f32 v[50:51], v[120:121], v[50:51] op_sel:[0,0] op_sel_hi:[0,1]
    v_pk_mul_f32 v[52:53], v[120:121], v[52:53] op_sel:[0,0] op_sel_hi:[0,1]
    v_pk_mul_f32 v[54:55], v[120:121], v[54:55] op_sel:[0,0] op_sel_hi:[0,1]
    v_pk_mul_f32 v[56:57], v[120:121], v[56:57] op_sel:[1,0] op_sel_hi:[1,1]
    v_pk_mul_f32 v[58:59], v[120:121], v[58:59] op_sel:[1,0] op_sel_hi:[1,1]
    v_pk_mul_f32 v[60:61], v[120:121], v[60:61] op_sel:[1,0] op_sel_hi:[1,1]
    v_pk_mul_f32 v[62:63], v[120:121], v[62:63] op_sel:[1,0] op_sel_hi:[1,1]
    v_pk_mul_f32 v[64:65], v[122:123], v[64:65] op_sel:[0,0] op_sel_hi:[0,1]
    v_pk_mul_f32 v[66:67], v[122:123], v[66:67] op_sel:[0,0] op_sel_hi:[0,1]
    v_pk_mul_f32 v[68:69], v[122:123], v[68:69] op_sel:[0,0] op_sel_hi:[0,1]
    v_pk_mul_f32 v[70:71], v[122:123], v[70:71] op_sel:[0,0] op_sel_hi:[0,1]
    v_cvt_pk_bf16_f32 v32, v32, v33
    v_cvt_pk_bf16_f32 v33, v34, v35
    v_cvt_pk_bf16_f32 v34, v36, v37
    v_cvt_pk_bf16_f32 v35, v38, v39
    v_cvt_pk_bf16_f32 v40, v40, v41
    v_cvt_pk_bf16_f32 v41, v42, v43
    v_cvt_pk_bf16_f32 v42, v44, v45
    v_cvt_pk_bf16_f32 v43, v46, v47
    v_cvt_pk_bf16_f32 v48, v48, v49
    v_cvt_pk_bf16_f32 v49, v50, v51
    v_cvt_pk_bf16_f32 v50, v52, v53
    v_cvt_pk_bf16_f32 v51, v54, v55
    v_cvt_pk_bf16_f32 v56, v56, v57
    v_cvt_pk_bf16_f32 v57, v58, v59
    v_cvt_pk_bf16_f32 v58, v60, v61
    v_cvt_pk_bf16_f32 v59, v62, v63
    v_cvt_pk_bf16_f32 v64, v64, v65
    v_cvt_pk_bf16_f32 v65, v66, v67
    v_cvt_pk_bf16_f32 v66, v68, v69
    v_cvt_pk_bf16_f32 v67, v70, v71
    v_readfirstlane_b32 s45, v170
    s_waitcnt lgkmcnt(0)
    v_mfma_f32_16x16x32_bf16 v[4:7], v[40:43], v[0:3], 0
    v_mfma_f32_16x16x32_bf16 v[44:47], v[32:35], v[0:3], 0
    v_mfma_f32_16x16x32_bf16 v[12:15], v[48:51], v[8:11], 0
    v_mfma_f32_16x16x32_bf16 v[52:55], v[40:43], v[8:11], 0
    v_mfma_f32_16x16x32_bf16 v[20:23], v[56:59], v[16:19], 0
    v_mfma_f32_16x16x32_bf16 v[60:63], v[48:51], v[16:19], 0
    v_mfma_f32_16x16x32_bf16 v[28:31], v[64:67], v[24:27], 0
    v_mfma_f32_16x16x32_bf16 v[68:71], v[56:59], v[24:27], 0
    v_pk_fma_f32 v[72:73], v[132:133], v[168:169], v[72:73] op_sel:[0,0,0] op_sel_hi:[1,0,1]
    v_pk_fma_f32 v[74:75], v[134:135], v[168:169], v[74:75] op_sel:[0,0,0] op_sel_hi:[1,0,1]
    v_pk_fma_f32 v[76:77], v[132:133], v[168:169], v[76:77] op_sel:[0,1,0] op_sel_hi:[1,1,1]
    v_pk_fma_f32 v[78:79], v[134:135], v[168:169], v[78:79] op_sel:[0,1,0] op_sel_hi:[1,1,1]
    v_pk_fma_f32 v[80:81], v[136:137], v[168:169], v[80:81] op_sel:[0,0,0] op_sel_hi:[1,0,1]
    v_pk_fma_f32 v[82:83], v[138:139], v[168:169], v[82:83] op_sel:[0,0,0] op_sel_hi:[1,0,1]
    v_pk_fma_f32 v[84:85], v[136:137], v[168:169], v[84:85] op_sel:[0,1,0] op_sel_hi:[1,1,1]
    v_pk_fma_f32 v[86:87], v[138:139], v[168:169], v[86:87] op_sel:[0,1,0] op_sel_hi:[1,1,1]
    v_pk_fma_f32 v[88:89], v[140:141], v[168:169], v[88:89] op_sel:[0,0,0] op_sel_hi:[1,0,1]
    v_pk_fma_f32 v[90:91], v[142:143], v[168:169], v[90:91] op_sel:[0,0,0] op_sel_hi:[1,0,1]
    v_pk_fma_f32 v[92:93], v[140:141], v[168:169], v[92:93] op_sel:[0,1,0] op_sel_hi:[1,1,1]
    v_pk_fma_f32 v[94:95], v[142:143], v[168:169], v[94:95] op_sel:[0,1,0] op_sel_hi:[1,1,1]
    v_pk_fma_f32 v[96:97], v[144:145], v[168:169], v[96:97] op_sel:[0,0,0] op_sel_hi:[1,0,1]
    v_pk_fma_f32 v[98:99], v[146:147], v[168:169], v[98:99] op_sel:[0,0,0] op_sel_hi:[1,0,1]
    v_pk_fma_f32 v[100:101], v[144:145], v[168:169], v[100:101] op_sel:[0,1,0] op_sel_hi:[1,1,1]
    v_pk_fma_f32 v[102:103], v[146:147], v[168:169], v[102:103] op_sel:[0,1,0] op_sel_hi:[1,1,1]
    v_pk_fma_f32 v[104:105], v[148:149], v[168:169], v[104:105] op_sel:[0,0,0] op_sel_hi:[1,0,1]
    v_pk_fma_f32 v[106:107], v[150:151], v[168:169], v[106:107] op_sel:[0,0,0] op_sel_hi:[1,0,1]
    v_pk_fma_f32 v[108:109], v[148:149], v[168:169], v[108:109] op_sel:[0,1,0] op_sel_hi:[1,1,1]
    v_pk_fma_f32 v[110:111], v[150:151], v[168:169], v[110:111] op_sel:[0,1,0] op_sel_hi:[1,1,1]
    v_cndmask_b32 v44, v44, v4, s[72:73]
    v_cndmask_b32 v45, v45, v5, s[74:75]
    v_cndmask_b32 v46, v46, v6, s[76:77]
    v_cndmask_b32 v47, v47, v7, s[78:79]
    v_cndmask_b32 v52, v52, v12, s[72:73]
    v_cndmask_b32 v53, v53, v13, s[74:75]
    v_cndmask_b32 v54, v54, v14, s[76:77]
    v_cndmask_b32 v55, v55, v15, s[78:79]
    v_cndmask_b32 v60, v60, v20, s[72:73]
    v_cndmask_b32 v61, v61, v21, s[74:75]
    v_cndmask_b32 v62, v62, v22, s[76:77]
    v_cndmask_b32 v63, v63, v23, s[78:79]
    v_cndmask_b32 v68, v68, v28, s[72:73]
    v_cndmask_b32 v69, v69, v29, s[74:75]
    v_cndmask_b32 v70, v70, v30, s[76:77]
    v_cndmask_b32 v71, v71, v31, s[78:79]
    v_cndmask_b32 v44, v44, v45, s[80:81]
    v_cndmask_b32 v45, v46, v47, s[80:81]
    v_cndmask_b32 v52, v52, v53, s[80:81]
    v_cndmask_b32 v53, v54, v55, s[80:81]
    v_cndmask_b32 v60, v60, v61, s[80:81]
    v_cndmask_b32 v61, v62, v63, s[80:81]
    v_cndmask_b32 v68, v68, v69, s[80:81]
    v_cndmask_b32 v69, v70, v71, s[80:81]
    v_mov_b32 v209, 0xf149f2ca
    v_cndmask_b32 v44, v44, v209, s[82:83]
    v_cndmask_b32 v45, v45, v209, s[84:85]
    v_max_f32 v46, v44, v45
    v_max_f32 v54, v52, v53
    v_max_f32 v62, v60, v61
    v_max_f32 v70, v68, v69
    v_pk_mul_f32 v[72:73], v[176:177], v[72:73] op_sel:[0,0] op_sel_hi:[1,1]
    v_pk_mul_f32 v[74:75], v[178:179], v[74:75] op_sel:[0,0] op_sel_hi:[1,1]
    v_permlane32_swap_b32 v46, v62
    v_permlane32_swap_b32 v54, v70
    v_max_f32 v46, v46, v62
    v_max_f32 v54, v54, v70
    v_pk_mul_f32 v[76:77], v[176:177], v[76:77] op_sel:[0,0] op_sel_hi:[1,1]
    v_pk_mul_f32 v[78:79], v[178:179], v[78:79] op_sel:[0,0] op_sel_hi:[1,1]
    v_permlane16_swap_b32 v46, v54
    v_max_f32 v46, v46, v54
    v_mov_b32 v54, v46
    v_pk_mul_f32 v[80:81], v[180:181], v[80:81] op_sel:[0,0] op_sel_hi:[1,1]
    v_pk_mul_f32 v[82:83], v[182:183], v[82:83] op_sel:[0,0] op_sel_hi:[1,1]
    v_permlane16_swap_b32 v46, v54
    v_mov_b32 v62, v46
    v_mov_b32 v70, v54
    v_pk_mul_f32 v[84:85], v[180:181], v[84:85] op_sel:[0,0] op_sel_hi:[1,1]
    v_pk_mul_f32 v[86:87], v[182:183], v[86:87] op_sel:[0,0] op_sel_hi:[1,1]
    v_permlane32_swap_b32 v46, v62
    v_permlane32_swap_b32 v54, v70
    v_mul_f32 v119, 0x3e8293ee, v119
    v_mul_f32 v120, 0x3e8293ee, v120
    v_mul_f32 v121, 0x3e8293ee, v121
    v_mul_f32 v122, 0x3e8293ee, v122
    v_sub_f32 v44, v44, v46
    v_sub_f32 v45, v45, v46
    v_sub_f32 v52, v52, v54
    v_sub_f32 v53, v53, v54
    v_sub_f32 v60, v60, v62
    v_sub_f32 v61, v61, v62
    v_sub_f32 v68, v68, v70
    v_sub_f32 v69, v69, v70
    v_mul_f32 v44, v119, v44
    v_mul_f32 v45, v119, v45
    v_mul_f32 v52, v120, v52
    v_mul_f32 v53, v120, v53
    v_mul_f32 v60, v121, v60
    v_mul_f32 v61, v121, v61
    v_mul_f32 v68, v122, v68
    v_mul_f32 v69, v122, v69
    v_exp_f32 v44, v44
    v_exp_f32 v45, v45
    v_exp_f32 v52, v52
    v_exp_f32 v53, v53
    v_exp_f32 v60, v60
    v_exp_f32 v61, v61
    v_exp_f32 v68, v68
    v_exp_f32 v69, v69
    .p2align 3
    v_pk_mul_f32 v[88:89], v[184:185], v[88:89] op_sel:[0,0] op_sel_hi:[1,1]
    v_pk_mul_f32 v[90:91], v[186:187], v[90:91] op_sel:[0,0] op_sel_hi:[1,1]
    v_pk_mul_f32 v[92:93], v[184:185], v[92:93] op_sel:[0,0] op_sel_hi:[1,1]
    v_pk_mul_f32 v[94:95], v[186:187], v[94:95] op_sel:[0,0] op_sel_hi:[1,1]
    v_pk_mul_f32 v[96:97], v[188:189], v[96:97] op_sel:[0,0] op_sel_hi:[1,1]
    v_pk_mul_f32 v[98:99], v[190:191], v[98:99] op_sel:[0,0] op_sel_hi:[1,1]
    v_pk_mul_f32 v[100:101], v[188:189], v[100:101] op_sel:[0,0] op_sel_hi:[1,1]
    v_pk_mul_f32 v[102:103], v[190:191], v[102:103] op_sel:[0,0] op_sel_hi:[1,1]
    v_pk_mul_f32 v[104:105], v[192:193], v[104:105] op_sel:[0,0] op_sel_hi:[1,1]
    v_pk_mul_f32 v[106:107], v[194:195], v[106:107] op_sel:[0,0] op_sel_hi:[1,1]
    v_pk_mul_f32 v[108:109], v[192:193], v[108:109] op_sel:[0,0] op_sel_hi:[1,1]
    v_pk_mul_f32 v[110:111], v[194:195], v[110:111] op_sel:[0,0] op_sel_hi:[1,1]
    v_cvt_pk_bf16_f32 v44, v44, v45
    v_cvt_pk_bf16_f32 v52, v52, v53
    v_cvt_pk_bf16_f32 v60, v60, v61
    v_cvt_pk_bf16_f32 v68, v68, v69
    v_cvt_pk_bf16_f32 v226, v72, v73
    v_cvt_pk_bf16_f32 v227, v74, v75
    v_cvt_pk_bf16_f32 v152, v76, v77
    v_cvt_pk_bf16_f32 v153, v78, v79
    v_cvt_pk_bf16_f32 v228, v80, v81
    v_cvt_pk_bf16_f32 v229, v82, v83
    v_cvt_pk_bf16_f32 v154, v84, v85
    v_cvt_pk_bf16_f32 v155, v86, v87
    v_cvt_pk_bf16_f32 v230, v88, v89
    v_cvt_pk_bf16_f32 v231, v90, v91
    v_cvt_pk_bf16_f32 v156, v92, v93
    v_cvt_pk_bf16_f32 v157, v94, v95
    v_cvt_pk_bf16_f32 v232, v96, v97
    v_cvt_pk_bf16_f32 v233, v98, v99
    v_cvt_pk_bf16_f32 v158, v100, v101
    v_cvt_pk_bf16_f32 v159, v102, v103
    v_cvt_pk_bf16_f32 v234, v104, v105
    v_cvt_pk_bf16_f32 v235, v106, v107
    v_cvt_pk_bf16_f32 v160, v108, v109
    v_cvt_pk_bf16_f32 v161, v110, v111
    v_perm_b32 v4, v44, v44, v214
    v_perm_b32 v5, v44, v44, v215
    v_perm_b32 v6, v44, v44, v216
    v_perm_b32 v7, v44, v44, v217
    v_perm_b32 v12, v52, v52, v214
    v_perm_b32 v13, v52, v52, v215
    v_perm_b32 v14, v52, v52, v216
    v_perm_b32 v15, v52, v52, v217
    v_perm_b32 v20, v60, v60, v214
    v_perm_b32 v21, v60, v60, v215
    v_perm_b32 v22, v60, v60, v216
    v_perm_b32 v23, v60, v60, v217
    v_perm_b32 v28, v68, v68, v214
    v_perm_b32 v29, v68, v68, v215
    v_perm_b32 v30, v68, v68, v216
    v_perm_b32 v31, v68, v68, v217
    s_add_u32 s55, s88, 4096
    v_mfma_f32_16x16x32_bf16 v[0:3], v[222:225], v[4:7], 0
    v_mfma_f32_16x16x32_bf16 v[8:11], v[222:225], v[12:15], 0
    v_mfma_f32_16x16x32_bf16 v[16:19], v[222:225], v[20:23], 0
    v_mfma_f32_16x16x32_bf16 v[24:27], v[222:225], v[28:31], 0
    v_mfma_f32_16x16x32_bf16 v[72:75], v[226:229], v[4:7], 0
    v_mfma_f32_16x16x32_bf16 v[76:79], v[152:155], v[4:7], 0
    v_mfma_f32_16x16x32_bf16 v[80:83], v[228:231], v[12:15], 0
    v_mfma_f32_16x16x32_bf16 v[84:87], v[154:157], v[12:15], 0
    v_mfma_f32_16x16x32_bf16 v[88:91], v[230:233], v[20:23], 0
    v_mfma_f32_16x16x32_bf16 v[92:95], v[156:159], v[20:23], 0
    v_mfma_f32_16x16x32_bf16 v[96:99], v[232:235], v[28:31], 0
    v_mfma_f32_16x16x32_bf16 v[100:103], v[158:161], v[28:31], 0
    v_rcp_f32 v0, v0
    v_rcp_f32 v8, v8
    v_rcp_f32 v16, v16
    v_rcp_f32 v24, v24
    v_pk_mul_f32 v[72:73], v[0:1], v[72:73] op_sel:[0,0] op_sel_hi:[0,1]
    v_pk_mul_f32 v[74:75], v[0:1], v[74:75] op_sel:[0,0] op_sel_hi:[0,1]
    v_pk_mul_f32 v[76:77], v[0:1], v[76:77] op_sel:[0,0] op_sel_hi:[0,1]
    v_pk_mul_f32 v[78:79], v[0:1], v[78:79] op_sel:[0,0] op_sel_hi:[0,1]
    v_cvt_pk_bf16_f32 v72, v72, v73
    v_cvt_pk_bf16_f32 v73, v74, v75
    v_cvt_pk_bf16_f32 v74, v76, v77
    v_cvt_pk_bf16_f32 v75, v78, v79
    buffer_store_dwordx4 v[72:75], v254, s[4:7], s88 offen offset:0 sc0 sc1
    v_pk_mul_f32 v[80:81], v[8:9], v[80:81] op_sel:[0,0] op_sel_hi:[0,1]
    v_pk_mul_f32 v[82:83], v[8:9], v[82:83] op_sel:[0,0] op_sel_hi:[0,1]
    v_pk_mul_f32 v[84:85], v[8:9], v[84:85] op_sel:[0,0] op_sel_hi:[0,1]
    v_pk_mul_f32 v[86:87], v[8:9], v[86:87] op_sel:[0,0] op_sel_hi:[0,1]
    v_cvt_pk_bf16_f32 v80, v80, v81
    v_cvt_pk_bf16_f32 v81, v82, v83
    v_cvt_pk_bf16_f32 v82, v84, v85
    v_cvt_pk_bf16_f32 v83, v86, v87
    buffer_store_dwordx4 v[80:83], v254, s[4:7], s88 offen offset:2048 sc0 sc1
    v_pk_mul_f32 v[88:89], v[16:17], v[88:89] op_sel:[0,0] op_sel_hi:[0,1]
    v_pk_mul_f32 v[90:91], v[16:17], v[90:91] op_sel:[0,0] op_sel_hi:[0,1]
    v_pk_mul_f32 v[92:93], v[16:17], v[92:93] op_sel:[0,0] op_sel_hi:[0,1]
    v_pk_mul_f32 v[94:95], v[16:17], v[94:95] op_sel:[0,0] op_sel_hi:[0,1]
    v_cvt_pk_bf16_f32 v88, v88, v89
    v_cvt_pk_bf16_f32 v89, v90, v91
    v_cvt_pk_bf16_f32 v90, v92, v93
    v_cvt_pk_bf16_f32 v91, v94, v95
    buffer_store_dwordx4 v[88:91], v254, s[4:7], s55 offen offset:0 sc0 sc1
    s_nop 1
    v_pk_mul_f32 v[96:97], v[24:25], v[96:97] op_sel:[0,0] op_sel_hi:[0,1]
    v_pk_mul_f32 v[98:99], v[24:25], v[98:99] op_sel:[0,0] op_sel_hi:[0,1]
    v_pk_mul_f32 v[100:101], v[24:25], v[100:101] op_sel:[0,0] op_sel_hi:[0,1]
    v_pk_mul_f32 v[102:103], v[24:25], v[102:103] op_sel:[0,0] op_sel_hi:[0,1]
    v_cvt_pk_bf16_f32 v96, v96, v97
    v_cvt_pk_bf16_f32 v97, v98, v99
    v_cvt_pk_bf16_f32 v98, v100, v101
    v_cvt_pk_bf16_f32 v99, v102, v103
    buffer_store_dwordx4 v[96:99], v254, s[4:7], s55 offen offset:2048 sc0 sc1
    s_lshl_b32 s55, s43, 13
    s_add_u32 s55, s55, 98304
    v_add_u32 v136, s55, v254
    v_lshrrev_b32 v152, 6, v254
    v_lshrrev_b32 v153, 1, v152
    v_and_b32 v153, 3, v153
    s_lshl_b32 s55, s44, 1
    v_xor_b32 v153, s55, v153
    v_lshlrev_b32 v152, 7, v152
    v_lshl_add_u32 v152, v153, 5, v152
    v_and_b32 v153, 0x30, v254
    v_lshrrev_b32 v153, 1, v153
    v_add_u32 v137, v152, v153
    v_xor_b32 v138, 32, v137
    v_add_u32 v139, 49152, v137
    v_add_u32 v140, 49152, v138
    s_cmp_lg_u32 s46, 0
    s_cbranch_scc1 g2_15
    s_waitcnt vmcnt(4)
    v_permlane16_swap_b32 v236, v238
    v_permlane16_swap_b32 v237, v239
    v_permlane16_swap_b32 v240, v242
    v_permlane16_swap_b32 v241, v243
    v_permlane16_swap_b32 v244, v246
    v_permlane16_swap_b32 v245, v247
    v_permlane16_swap_b32 v248, v250
    v_permlane16_swap_b32 v249, v251
g2_15:
    v_lshlrev_b32 v0, 16, v236
    v_and_b32 v1, 0xffff0000, v236
    v_lshlrev_b32 v2, 16, v237
    v_and_b32 v3, 0xffff0000, v237
    v_lshlrev_b32 v16, 16, v238
    v_and_b32 v17, 0xffff0000, v238
    v_lshlrev_b32 v18, 16, v239
    v_and_b32 v19, 0xffff0000, v239
    v_lshlrev_b32 v4, 16, v240
    v_and_b32 v5, 0xffff0000, v240
    v_lshlrev_b32 v6, 16, v241
    v_and_b32 v7, 0xffff0000, v241
    v_lshlrev_b32 v20, 16, v242
    v_and_b32 v21, 0xffff0000, v242
    v_lshlrev_b32 v22, 16, v243
    v_and_b32 v23, 0xffff0000, v243
    v_lshlrev_b32 v8, 16, v244
    v_and_b32 v9, 0xffff0000, v244
    v_lshlrev_b32 v10, 16, v245
    v_and_b32 v11, 0xffff0000, v245
    v_lshlrev_b32 v24, 16, v246
    v_and_b32 v25, 0xffff0000, v246
    v_lshlrev_b32 v26, 16, v247
    v_and_b32 v27, 0xffff0000, v247
    v_lshlrev_b32 v12, 16, v248
    v_and_b32 v13, 0xffff0000, v248
    v_lshlrev_b32 v14, 16, v249
    v_and_b32 v15, 0xffff0000, v249
    v_lshlrev_b32 v28, 16, v250
    v_and_b32 v29, 0xffff0000, v250
    v_lshlrev_b32 v30, 16, v251
    v_and_b32 v31, 0xffff0000, v251
    s_waitcnt vmcnt(0)
    s_barrier
    s_cmp_lg_u32 s42, 2
    s_cbranch_scc1 wf_16
    s_lshr_b32 s55, s2, 5
    s_lshl_b32 s55, s55, 2
    s_add_u32 s55, s55, s0
    v_mov_b32 v252, 0
    v_mov_b32 v253, 0x01010101
    s_mov_b64 exec, 1
    s_cmp_eq_u32 s45, 0
    s_cbranch_scc1 st_17
    buffer_store_dword v253, v252, s[4:7], s55 offen sc0 sc1
    s_branch st_18
st_17:
    buffer_store_dword v253, v252, s[4:7], s55 offen
st_18:
    s_mov_b64 exec, -1
wf_16:
    s_cmp_lg_u32 s42, 3
    s_cbranch_scc1 wf_19
    s_lshl_b32 s55, s51, 2
    s_add_u32 s55, s55, s54
    v_mov_b32 v252, 0
    v_mov_b32 v253, 0x01010101
    s_mov_b64 exec, 1
    buffer_store_dword v253, v252, s[4:7], s55 offen sc0 sc1
    s_mov_b64 exec, -1
wf_19:
    s_barrier
    ds_read_b64_tr_b16 v[104:105], v137 offset:32768
    ds_read_b64_tr_b16 v[106:107], v137 offset:34816
    ds_read_b128 v[32:35], v136 offset:0
    ds_read_b128 v[36:39], v136 offset:2048
    ds_read_b128 v[40:43], v136 offset:4096
    ds_read_b128 v[44:47], v136 offset:6144
    ds_read_b64_tr_b16 v[108:109], v138 offset:32768
    ds_read_b64_tr_b16 v[110:111], v138 offset:34816
    ds_read_b64_tr_b16 v[112:113], v137 offset:36864
    ds_read_b64_tr_b16 v[114:115], v137 offset:38912
    ds_read_b128 v[48:51], v136 offset:1024
    ds_read_b128 v[52:55], v136 offset:3072
    ds_read_b128 v[56:59], v136 offset:5120
    ds_read_b128 v[60:63], v136 offset:7168
    ds_read_b64_tr_b16 v[116:117], v138 offset:36864
    ds_read_b64_tr_b16 v[118:119], v138 offset:38912
    s_waitcnt lgkmcnt(0)
    s_barrier
    .p2align 3
    v_mfma_f32_16x16x32_bf16 v[0:3], v[104:107], v[32:35], v[0:3]
    ds_read_b64_tr_b16 v[120:121], v137 offset:40960
    ds_read_b64_tr_b16 v[122:123], v137 offset:43008
    v_mfma_f32_16x16x32_bf16 v[0:3], v[112:115], v[48:51], v[0:3]
    ds_read_b128 v[64:67], v136 offset:16384
    v_mfma_f32_16x16x32_bf16 v[4:7], v[112:115], v[52:55], v[4:7]
    ds_read_b128 v[68:71], v136 offset:18432
    v_mfma_f32_16x16x32_bf16 v[4:7], v[104:107], v[36:39], v[4:7]
    ds_read_b128 v[72:75], v136 offset:20480
    ds_read_b128 v[76:79], v136 offset:22528
    v_mfma_f32_16x16x32_bf16 v[8:11], v[104:107], v[40:43], v[8:11]
    ds_read_b64_tr_b16 v[124:125], v138 offset:40960
    v_mfma_f32_16x16x32_bf16 v[8:11], v[112:115], v[56:59], v[8:11]
    ds_read_b64_tr_b16 v[126:127], v138 offset:43008
    v_mfma_f32_16x16x32_bf16 v[12:15], v[112:115], v[60:63], v[12:15]
    ds_read_b64_tr_b16 v[128:129], v137 offset:45056
    ds_read_b64_tr_b16 v[130:131], v137 offset:47104
    v_mfma_f32_16x16x32_bf16 v[12:15], v[104:107], v[44:47], v[12:15]
    ds_read_b128 v[80:83], v136 offset:17408
    v_mfma_f32_16x16x32_bf16 v[28:31], v[108:111], v[44:47], v[28:31]
    ds_read_b128 v[84:87], v136 offset:19456
    v_mfma_f32_16x16x32_bf16 v[28:31], v[116:119], v[60:63], v[28:31]
    ds_read_b128 v[88:91], v136 offset:21504
    ds_read_b128 v[92:95], v136 offset:23552
    v_mfma_f32_16x16x32_bf16 v[24:27], v[116:119], v[56:59], v[24:27]
    ds_read_b64_tr_b16 v[132:133], v138 offset:45056
    v_mfma_f32_16x16x32_bf16 v[24:27], v[108:111], v[40:43], v[24:27]
    ds_read_b64_tr_b16 v[134:135], v138 offset:47104
    v_mfma_f32_16x16x32_bf16 v[20:23], v[108:111], v[36:39], v[20:23]
    v_mfma_f32_16x16x32_bf16 v[20:23], v[116:119], v[52:55], v[20:23]
    v_mfma_f32_16x16x32_bf16 v[16:19], v[116:119], v[48:51], v[16:19]
    v_mfma_f32_16x16x32_bf16 v[16:19], v[108:111], v[32:35], v[16:19]
    s_waitcnt lgkmcnt(0)
    s_barrier
    .p2align 3
    v_mfma_f32_16x16x32_bf16 v[0:3], v[120:123], v[64:67], v[0:3]
    ds_read_b64_tr_b16 v[104:105], v139 offset:0
    ds_read_b64_tr_b16 v[106:107], v139 offset:2048
    v_mfma_f32_16x16x32_bf16 v[0:3], v[128:131], v[80:83], v[0:3]
    ds_read_b128 v[32:35], v136 offset:32768
    v_mfma_f32_16x16x32_bf16 v[4:7], v[128:131], v[84:87], v[4:7]
    ds_read_b128 v[36:39], v136 offset:34816
    v_mfma_f32_16x16x32_bf16 v[4:7], v[120:123], v[68:71], v[4:7]
    ds_read_b128 v[40:43], v136 offset:36864
    ds_read_b128 v[44:47], v136 offset:38912
    v_mfma_f32_16x16x32_bf16 v[8:11], v[120:123], v[72:75], v[8:11]
    ds_read_b64_tr_b16 v[108:109], v140 offset:0
    v_mfma_f32_16x16x32_bf16 v[8:11], v[128:131], v[88:91], v[8:11]
    ds_read_b64_tr_b16 v[110:111], v140 offset:2048
    v_mfma_f32_16x16x32_bf16 v[12:15], v[128:131], v[92:95], v[12:15]
    ds_read_b64_tr_b16 v[112:113], v139 offset:4096
    ds_read_b64_tr_b16 v[114:115], v139 offset:6144
    v_mfma_f32_16x16x32_bf16 v[12:15], v[120:123], v[76:79], v[12:15]
    ds_read_b128 v[48:51], v136 offset:33792
    v_mfma_f32_16x16x32_bf16 v[28:31], v[124:127], v[76:79], v[28:31]
    ds_read_b128 v[52:55], v136 offset:35840
    v_mfma_f32_16x16x32_bf16 v[28:31], v[132:135], v[92:95], v[28:31]
    ds_read_b128 v[56:59], v136 offset:37888
    ds_read_b128 v[60:63], v136 offset:39936
    v_mfma_f32_16x16x32_bf16 v[24:27], v[132:135], v[88:91], v[24:27]
    ds_read_b64_tr_b16 v[116:117], v140 offset:4096
    v_mfma_f32_16x16x32_bf16 v[24:27], v[124:127], v[72:75], v[24:27]
    ds_read_b64_tr_b16 v[118:119], v140 offset:6144
    v_mfma_f32_16x16x32_bf16 v[20:23], v[124:127], v[68:71], v[20:23]
    v_mfma_f32_16x16x32_bf16 v[20:23], v[132:135], v[84:87], v[20:23]
    v_mfma_f32_16x16x32_bf16 v[16:19], v[132:135], v[80:83], v[16:19]
    v_mfma_f32_16x16x32_bf16 v[16:19], v[124:127], v[64:67], v[16:19]
    s_waitcnt lgkmcnt(0)
    s_barrier
    .p2align 3
    v_mfma_f32_16x16x32_bf16 v[0:3], v[104:107], v[32:35], v[0:3]
    ds_read_b64_tr_b16 v[120:121], v139 offset:8192
    ds_read_b64_tr_b16 v[122:123], v139 offset:10240
    v_mfma_f32_16x16x32_bf16 v[0:3], v[112:115], v[48:51], v[0:3]
    ds_read_b128 v[64:67], v136 offset:0
    v_mfma_f32_16x16x32_bf16 v[4:7], v[112:115], v[52:55], v[4:7]
    ds_read_b128 v[68:71], v136 offset:2048
    v_mfma_f32_16x16x32_bf16 v[4:7], v[104:107], v[36:39], v[4:7]
    ds_read_b128 v[72:75], v136 offset:4096
    ds_read_b128 v[76:79], v136 offset:6144
    v_mfma_f32_16x16x32_bf16 v[8:11], v[104:107], v[40:43], v[8:11]
    ds_read_b64_tr_b16 v[124:125], v140 offset:8192
    v_mfma_f32_16x16x32_bf16 v[8:11], v[112:115], v[56:59], v[8:11]
    ds_read_b64_tr_b16 v[126:127], v140 offset:10240
    v_mfma_f32_16x16x32_bf16 v[12:15], v[112:115], v[60:63], v[12:15]
    ds_read_b64_tr_b16 v[128:129], v139 offset:12288
    ds_read_b64_tr_b16 v[130:131], v139 offset:14336
    v_mfma_f32_16x16x32_bf16 v[12:15], v[104:107], v[44:47], v[12:15]
    ds_read_b128 v[80:83], v136 offset:1024
    v_mfma_f32_16x16x32_bf16 v[28:31], v[108:111], v[44:47], v[28:31]
    ds_read_b128 v[84:87], v136 offset:3072
    v_mfma_f32_16x16x32_bf16 v[28:31], v[116:119], v[60:63], v[28:31]
    ds_read_b128 v[88:91], v136 offset:5120
    ds_read_b128 v[92:95], v136 offset:7168
    v_mfma_f32_16x16x32_bf16 v[24:27], v[116:119], v[56:59], v[24:27]
    ds_read_b64_tr_b16 v[132:133], v140 offset:12288
    v_mfma_f32_16x16x32_bf16 v[24:27], v[108:111], v[40:43], v[24:27]
    ds_read_b64_tr_b16 v[134:135], v140 offset:14336
    v_mfma_f32_16x16x32_bf16 v[20:23], v[108:111], v[36:39], v[20:23]
    v_mfma_f32_16x16x32_bf16 v[20:23], v[116:119], v[52:55], v[20:23]
    v_mfma_f32_16x16x32_bf16 v[16:19], v[116:119], v[48:51], v[16:19]
    v_mfma_f32_16x16x32_bf16 v[16:19], v[108:111], v[32:35], v[16:19]
    s_waitcnt lgkmcnt(0)
    s_barrier
    .p2align 3
    v_mfma_f32_16x16x32_bf16 v[0:3], v[120:123], v[64:67], v[0:3]
    ds_read_b64_tr_b16 v[104:105], v139 offset:16384
    ds_read_b64_tr_b16 v[106:107], v139 offset:18432
    v_mfma_f32_16x16x32_bf16 v[0:3], v[128:131], v[80:83], v[0:3]
    ds_read_b128 v[32:35], v136 offset:16384
    v_mfma_f32_16x16x32_bf16 v[4:7], v[128:131], v[84:87], v[4:7]
    ds_read_b128 v[36:39], v136 offset:18432
    v_mfma_f32_16x16x32_bf16 v[4:7], v[120:123], v[68:71], v[4:7]
    ds_read_b128 v[40:43], v136 offset:20480
    ds_read_b128 v[44:47], v136 offset:22528
    v_mfma_f32_16x16x32_bf16 v[8:11], v[120:123], v[72:75], v[8:11]
    ds_read_b64_tr_b16 v[108:109], v140 offset:16384
    v_mfma_f32_16x16x32_bf16 v[8:11], v[128:131], v[88:91], v[8:11]
    ds_read_b64_tr_b16 v[110:111], v140 offset:18432
    v_mfma_f32_16x16x32_bf16 v[12:15], v[128:131], v[92:95], v[12:15]
    ds_read_b64_tr_b16 v[112:113], v139 offset:20480
    ds_read_b64_tr_b16 v[114:115], v139 offset:22528
    v_mfma_f32_16x16x32_bf16 v[12:15], v[120:123], v[76:79], v[12:15]
    ds_read_b128 v[48:51], v136 offset:17408
    v_mfma_f32_16x16x32_bf16 v[28:31], v[124:127], v[76:79], v[28:31]
    ds_read_b128 v[52:55], v136 offset:19456
    v_mfma_f32_16x16x32_bf16 v[28:31], v[132:135], v[92:95], v[28:31]
    ds_read_b128 v[56:59], v136 offset:21504
    ds_read_b128 v[60:63], v136 offset:23552
    v_mfma_f32_16x16x32_bf16 v[24:27], v[132:135], v[88:91], v[24:27]
    ds_read_b64_tr_b16 v[116:117], v140 offset:20480
    v_mfma_f32_16x16x32_bf16 v[24:27], v[124:127], v[72:75], v[24:27]
    ds_read_b64_tr_b16 v[118:119], v140 offset:22528
    v_mfma_f32_16x16x32_bf16 v[20:23], v[124:127], v[68:71], v[20:23]
    v_mfma_f32_16x16x32_bf16 v[20:23], v[132:135], v[84:87], v[20:23]
    v_mfma_f32_16x16x32_bf16 v[16:19], v[132:135], v[80:83], v[16:19]
    v_mfma_f32_16x16x32_bf16 v[16:19], v[124:127], v[64:67], v[16:19]
    s_waitcnt lgkmcnt(0)
    s_barrier
    .p2align 3
    v_mfma_f32_16x16x32_bf16 v[0:3], v[104:107], v[32:35], v[0:3]
    ds_read_b64_tr_b16 v[120:121], v139 offset:24576
    ds_read_b64_tr_b16 v[122:123], v139 offset:26624
    v_mfma_f32_16x16x32_bf16 v[0:3], v[112:115], v[48:51], v[0:3]
    ds_read_b128 v[64:67], v136 offset:32768
    v_mfma_f32_16x16x32_bf16 v[4:7], v[112:115], v[52:55], v[4:7]
    ds_read_b128 v[68:71], v136 offset:34816
    v_mfma_f32_16x16x32_bf16 v[4:7], v[104:107], v[36:39], v[4:7]
    ds_read_b128 v[72:75], v136 offset:36864
    ds_read_b128 v[76:79], v136 offset:38912
    v_mfma_f32_16x16x32_bf16 v[8:11], v[104:107], v[40:43], v[8:11]
    ds_read_b64_tr_b16 v[124:125], v140 offset:24576
    v_mfma_f32_16x16x32_bf16 v[8:11], v[112:115], v[56:59], v[8:11]
    ds_read_b64_tr_b16 v[126:127], v140 offset:26624
    v_mfma_f32_16x16x32_bf16 v[12:15], v[112:115], v[60:63], v[12:15]
    ds_read_b64_tr_b16 v[128:129], v139 offset:28672
    ds_read_b64_tr_b16 v[130:131], v139 offset:30720
    v_mfma_f32_16x16x32_bf16 v[12:15], v[104:107], v[44:47], v[12:15]
    ds_read_b128 v[80:83], v136 offset:33792
    v_mfma_f32_16x16x32_bf16 v[28:31], v[108:111], v[44:47], v[28:31]
    ds_read_b128 v[84:87], v136 offset:35840
    v_mfma_f32_16x16x32_bf16 v[28:31], v[116:119], v[60:63], v[28:31]
    ds_read_b128 v[88:91], v136 offset:37888
    ds_read_b128 v[92:95], v136 offset:39936
    v_mfma_f32_16x16x32_bf16 v[24:27], v[116:119], v[56:59], v[24:27]
    ds_read_b64_tr_b16 v[132:133], v140 offset:28672
    v_mfma_f32_16x16x32_bf16 v[24:27], v[108:111], v[40:43], v[24:27]
    ds_read_b64_tr_b16 v[134:135], v140 offset:30720
    v_mfma_f32_16x16x32_bf16 v[20:23], v[108:111], v[36:39], v[20:23]
    v_mfma_f32_16x16x32_bf16 v[20:23], v[116:119], v[52:55], v[20:23]
    v_mfma_f32_16x16x32_bf16 v[16:19], v[116:119], v[48:51], v[16:19]
    v_mfma_f32_16x16x32_bf16 v[16:19], v[108:111], v[32:35], v[16:19]
    s_waitcnt lgkmcnt(0)
    s_barrier
    .p2align 3
    v_mfma_f32_16x16x32_bf16 v[0:3], v[120:123], v[64:67], v[0:3]
    ds_read_b64_tr_b16 v[104:105], v139 offset:32768
    ds_read_b64_tr_b16 v[106:107], v139 offset:34816
    v_mfma_f32_16x16x32_bf16 v[0:3], v[128:131], v[80:83], v[0:3]
    ds_read_b128 v[32:35], v136 offset:0
    v_mfma_f32_16x16x32_bf16 v[4:7], v[128:131], v[84:87], v[4:7]
    ds_read_b128 v[36:39], v136 offset:2048
    v_mfma_f32_16x16x32_bf16 v[4:7], v[120:123], v[68:71], v[4:7]
    ds_read_b128 v[40:43], v136 offset:4096
    ds_read_b128 v[44:47], v136 offset:6144
    v_mfma_f32_16x16x32_bf16 v[8:11], v[120:123], v[72:75], v[8:11]
    ds_read_b64_tr_b16 v[108:109], v140 offset:32768
    v_mfma_f32_16x16x32_bf16 v[8:11], v[128:131], v[88:91], v[8:11]
    ds_read_b64_tr_b16 v[110:111], v140 offset:34816
    v_mfma_f32_16x16x32_bf16 v[12:15], v[128:131], v[92:95], v[12:15]
    ds_read_b64_tr_b16 v[112:113], v139 offset:36864
    ds_read_b64_tr_b16 v[114:115], v139 offset:38912
    v_mfma_f32_16x16x32_bf16 v[12:15], v[120:123], v[76:79], v[12:15]
    ds_read_b128 v[48:51], v136 offset:1024
    v_mfma_f32_16x16x32_bf16 v[28:31], v[124:127], v[76:79], v[28:31]
    ds_read_b128 v[52:55], v136 offset:3072
    v_mfma_f32_16x16x32_bf16 v[28:31], v[132:135], v[92:95], v[28:31]
    ds_read_b128 v[56:59], v136 offset:5120
    ds_read_b128 v[60:63], v136 offset:7168
    v_mfma_f32_16x16x32_bf16 v[24:27], v[132:135], v[88:91], v[24:27]
    ds_read_b64_tr_b16 v[116:117], v140 offset:36864
    v_mfma_f32_16x16x32_bf16 v[24:27], v[124:127], v[72:75], v[24:27]
    ds_read_b64_tr_b16 v[118:119], v140 offset:38912
    v_mfma_f32_16x16x32_bf16 v[20:23], v[124:127], v[68:71], v[20:23]
    v_mfma_f32_16x16x32_bf16 v[20:23], v[132:135], v[84:87], v[20:23]
    v_mfma_f32_16x16x32_bf16 v[16:19], v[132:135], v[80:83], v[16:19]
    v_mfma_f32_16x16x32_bf16 v[16:19], v[124:127], v[64:67], v[16:19]
    s_waitcnt lgkmcnt(0)
    s_barrier
    .p2align 3
    v_mfma_f32_16x16x32_bf16 v[0:3], v[104:107], v[32:35], v[0:3]
    ds_read_b64_tr_b16 v[120:121], v139 offset:40960
    ds_read_b64_tr_b16 v[122:123], v139 offset:43008
    v_mfma_f32_16x16x32_bf16 v[0:3], v[112:115], v[48:51], v[0:3]
    ds_read_b128 v[64:67], v136 offset:16384
    v_mfma_f32_16x16x32_bf16 v[4:7], v[112:115], v[52:55], v[4:7]
    ds_read_b128 v[68:71], v136 offset:18432
    v_mfma_f32_16x16x32_bf16 v[4:7], v[104:107], v[36:39], v[4:7]
    ds_read_b128 v[72:75], v136 offset:20480
    ds_read_b128 v[76:79], v136 offset:22528
    v_mfma_f32_16x16x32_bf16 v[8:11], v[104:107], v[40:43], v[8:11]
    ds_read_b64_tr_b16 v[124:125], v140 offset:40960
    v_mfma_f32_16x16x32_bf16 v[8:11], v[112:115], v[56:59], v[8:11]
    ds_read_b64_tr_b16 v[126:127], v140 offset:43008
    v_mfma_f32_16x16x32_bf16 v[12:15], v[112:115], v[60:63], v[12:15]
    ds_read_b64_tr_b16 v[128:129], v139 offset:45056
    ds_read_b64_tr_b16 v[130:131], v139 offset:47104
    v_mfma_f32_16x16x32_bf16 v[12:15], v[104:107], v[44:47], v[12:15]
    ds_read_b128 v[80:83], v136 offset:17408
    v_mfma_f32_16x16x32_bf16 v[28:31], v[108:111], v[44:47], v[28:31]
    ds_read_b128 v[84:87], v136 offset:19456
    v_mfma_f32_16x16x32_bf16 v[28:31], v[116:119], v[60:63], v[28:31]
    ds_read_b128 v[88:91], v136 offset:21504
    ds_read_b128 v[92:95], v136 offset:23552
    v_mfma_f32_16x16x32_bf16 v[24:27], v[116:119], v[56:59], v[24:27]
    ds_read_b64_tr_b16 v[132:133], v140 offset:45056
    v_mfma_f32_16x16x32_bf16 v[24:27], v[108:111], v[40:43], v[24:27]
    ds_read_b64_tr_b16 v[134:135], v140 offset:47104
    v_mfma_f32_16x16x32_bf16 v[20:23], v[108:111], v[36:39], v[20:23]
    v_mfma_f32_16x16x32_bf16 v[20:23], v[116:119], v[52:55], v[20:23]
    v_mfma_f32_16x16x32_bf16 v[16:19], v[116:119], v[48:51], v[16:19]
    v_mfma_f32_16x16x32_bf16 v[16:19], v[108:111], v[32:35], v[16:19]
    s_waitcnt lgkmcnt(0)
    s_barrier
    .p2align 3
    v_mfma_f32_16x16x32_bf16 v[0:3], v[120:123], v[64:67], v[0:3]
    ds_read_b64_tr_b16 v[104:105], v137 offset:0
    ds_read_b64_tr_b16 v[106:107], v137 offset:2048
    v_mfma_f32_16x16x32_bf16 v[0:3], v[128:131], v[80:83], v[0:3]
    ds_read_b128 v[32:35], v136 offset:32768
    v_mfma_f32_16x16x32_bf16 v[4:7], v[128:131], v[84:87], v[4:7]
    ds_read_b128 v[36:39], v136 offset:34816
    v_mfma_f32_16x16x32_bf16 v[4:7], v[120:123], v[68:71], v[4:7]
    ds_read_b128 v[40:43], v136 offset:36864
    ds_read_b128 v[44:47], v136 offset:38912
    v_mfma_f32_16x16x32_bf16 v[8:11], v[120:123], v[72:75], v[8:11]
    ds_read_b64_tr_b16 v[108:109], v138 offset:0
    v_mfma_f32_16x16x32_bf16 v[8:11], v[128:131], v[88:91], v[8:11]
    ds_read_b64_tr_b16 v[110:111], v138 offset:2048
    v_mfma_f32_16x16x32_bf16 v[12:15], v[128:131], v[92:95], v[12:15]
    ds_read_b64_tr_b16 v[112:113], v137 offset:4096
    ds_read_b64_tr_b16 v[114:115], v137 offset:6144
    v_mfma_f32_16x16x32_bf16 v[12:15], v[120:123], v[76:79], v[12:15]
    ds_read_b128 v[48:51], v136 offset:33792
    v_mfma_f32_16x16x32_bf16 v[28:31], v[124:127], v[76:79], v[28:31]
    ds_read_b128 v[52:55], v136 offset:35840
    v_mfma_f32_16x16x32_bf16 v[28:31], v[132:135], v[92:95], v[28:31]
    ds_read_b128 v[56:59], v136 offset:37888
    ds_read_b128 v[60:63], v136 offset:39936
    v_mfma_f32_16x16x32_bf16 v[24:27], v[132:135], v[88:91], v[24:27]
    ds_read_b64_tr_b16 v[116:117], v138 offset:4096
    v_mfma_f32_16x16x32_bf16 v[24:27], v[124:127], v[72:75], v[24:27]
    ds_read_b64_tr_b16 v[118:119], v138 offset:6144
    v_mfma_f32_16x16x32_bf16 v[20:23], v[124:127], v[68:71], v[20:23]
    v_mfma_f32_16x16x32_bf16 v[20:23], v[132:135], v[84:87], v[20:23]
    v_mfma_f32_16x16x32_bf16 v[16:19], v[132:135], v[80:83], v[16:19]
    v_mfma_f32_16x16x32_bf16 v[16:19], v[124:127], v[64:67], v[16:19]
    s_waitcnt lgkmcnt(0)
    s_barrier
    .p2align 3
    v_mfma_f32_16x16x32_bf16 v[0:3], v[104:107], v[32:35], v[0:3]
    ds_read_b64_tr_b16 v[120:121], v137 offset:8192
    ds_read_b64_tr_b16 v[122:123], v137 offset:10240
    v_mfma_f32_16x16x32_bf16 v[0:3], v[112:115], v[48:51], v[0:3]
    ds_read_b128 v[64:67], v136 offset:0
    v_mfma_f32_16x16x32_bf16 v[4:7], v[112:115], v[52:55], v[4:7]
    ds_read_b128 v[68:71], v136 offset:2048
    v_mfma_f32_16x16x32_bf16 v[4:7], v[104:107], v[36:39], v[4:7]
    ds_read_b128 v[72:75], v136 offset:4096
    ds_read_b128 v[76:79], v136 offset:6144
    v_mfma_f32_16x16x32_bf16 v[8:11], v[104:107], v[40:43], v[8:11]
    ds_read_b64_tr_b16 v[124:125], v138 offset:8192
    v_mfma_f32_16x16x32_bf16 v[8:11], v[112:115], v[56:59], v[8:11]
    ds_read_b64_tr_b16 v[126:127], v138 offset:10240
    v_mfma_f32_16x16x32_bf16 v[12:15], v[112:115], v[60:63], v[12:15]
    ds_read_b64_tr_b16 v[128:129], v137 offset:12288
    ds_read_b64_tr_b16 v[130:131], v137 offset:14336
    v_mfma_f32_16x16x32_bf16 v[12:15], v[104:107], v[44:47], v[12:15]
    ds_read_b128 v[80:83], v136 offset:1024
    v_mfma_f32_16x16x32_bf16 v[28:31], v[108:111], v[44:47], v[28:31]
    ds_read_b128 v[84:87], v136 offset:3072
    v_mfma_f32_16x16x32_bf16 v[28:31], v[116:119], v[60:63], v[28:31]
    ds_read_b128 v[88:91], v136 offset:5120
    ds_read_b128 v[92:95], v136 offset:7168
    v_mfma_f32_16x16x32_bf16 v[24:27], v[116:119], v[56:59], v[24:27]
    ds_read_b64_tr_b16 v[132:133], v138 offset:12288
    v_mfma_f32_16x16x32_bf16 v[24:27], v[108:111], v[40:43], v[24:27]
    ds_read_b64_tr_b16 v[134:135], v138 offset:14336
    v_mfma_f32_16x16x32_bf16 v[20:23], v[108:111], v[36:39], v[20:23]
    v_mfma_f32_16x16x32_bf16 v[20:23], v[116:119], v[52:55], v[20:23]
    v_mfma_f32_16x16x32_bf16 v[16:19], v[116:119], v[48:51], v[16:19]
    v_mfma_f32_16x16x32_bf16 v[16:19], v[108:111], v[32:35], v[16:19]
    s_waitcnt lgkmcnt(0)
    s_barrier
    .p2align 3
    v_mfma_f32_16x16x32_bf16 v[0:3], v[120:123], v[64:67], v[0:3]
    ds_read_b64_tr_b16 v[104:105], v137 offset:16384
    ds_read_b64_tr_b16 v[106:107], v137 offset:18432
    v_mfma_f32_16x16x32_bf16 v[0:3], v[128:131], v[80:83], v[0:3]
    ds_read_b128 v[32:35], v136 offset:16384
    v_mfma_f32_16x16x32_bf16 v[4:7], v[128:131], v[84:87], v[4:7]
    ds_read_b128 v[36:39], v136 offset:18432
    v_mfma_f32_16x16x32_bf16 v[4:7], v[120:123], v[68:71], v[4:7]
    ds_read_b128 v[40:43], v136 offset:20480
    ds_read_b128 v[44:47], v136 offset:22528
    v_mfma_f32_16x16x32_bf16 v[8:11], v[120:123], v[72:75], v[8:11]
    ds_read_b64_tr_b16 v[108:109], v138 offset:16384
    v_mfma_f32_16x16x32_bf16 v[8:11], v[128:131], v[88:91], v[8:11]
    ds_read_b64_tr_b16 v[110:111], v138 offset:18432
    v_mfma_f32_16x16x32_bf16 v[12:15], v[128:131], v[92:95], v[12:15]
    ds_read_b64_tr_b16 v[112:113], v137 offset:20480
    ds_read_b64_tr_b16 v[114:115], v137 offset:22528
    v_mfma_f32_16x16x32_bf16 v[12:15], v[120:123], v[76:79], v[12:15]
    ds_read_b128 v[48:51], v136 offset:17408
    v_mfma_f32_16x16x32_bf16 v[28:31], v[124:127], v[76:79], v[28:31]
    ds_read_b128 v[52:55], v136 offset:19456
    v_mfma_f32_16x16x32_bf16 v[28:31], v[132:135], v[92:95], v[28:31]
    ds_read_b128 v[56:59], v136 offset:21504
    ds_read_b128 v[60:63], v136 offset:23552
    v_mfma_f32_16x16x32_bf16 v[24:27], v[132:135], v[88:91], v[24:27]
    ds_read_b64_tr_b16 v[116:117], v138 offset:20480
    v_mfma_f32_16x16x32_bf16 v[24:27], v[124:127], v[72:75], v[24:27]
    ds_read_b64_tr_b16 v[118:119], v138 offset:22528
    v_mfma_f32_16x16x32_bf16 v[20:23], v[124:127], v[68:71], v[20:23]
    v_mfma_f32_16x16x32_bf16 v[20:23], v[132:135], v[84:87], v[20:23]
    v_mfma_f32_16x16x32_bf16 v[16:19], v[132:135], v[80:83], v[16:19]
    v_mfma_f32_16x16x32_bf16 v[16:19], v[124:127], v[64:67], v[16:19]
    s_waitcnt lgkmcnt(0)
    s_barrier
    .p2align 3
    v_mfma_f32_16x16x32_bf16 v[0:3], v[104:107], v[32:35], v[0:3]
    ds_read_b64_tr_b16 v[120:121], v137 offset:24576
    ds_read_b64_tr_b16 v[122:123], v137 offset:26624
    v_mfma_f32_16x16x32_bf16 v[0:3], v[112:115], v[48:51], v[0:3]
    ds_read_b128 v[64:67], v136 offset:32768
    v_mfma_f32_16x16x32_bf16 v[4:7], v[112:115], v[52:55], v[4:7]
    ds_read_b128 v[68:71], v136 offset:34816
    v_mfma_f32_16x16x32_bf16 v[4:7], v[104:107], v[36:39], v[4:7]
    ds_read_b128 v[72:75], v136 offset:36864
    ds_read_b128 v[76:79], v136 offset:38912
    v_mfma_f32_16x16x32_bf16 v[8:11], v[104:107], v[40:43], v[8:11]
    ds_read_b64_tr_b16 v[124:125], v138 offset:24576
    v_mfma_f32_16x16x32_bf16 v[8:11], v[112:115], v[56:59], v[8:11]
    ds_read_b64_tr_b16 v[126:127], v138 offset:26624
    v_mfma_f32_16x16x32_bf16 v[12:15], v[112:115], v[60:63], v[12:15]
    ds_read_b64_tr_b16 v[128:129], v137 offset:28672
    ds_read_b64_tr_b16 v[130:131], v137 offset:30720
    v_mfma_f32_16x16x32_bf16 v[12:15], v[104:107], v[44:47], v[12:15]
    ds_read_b128 v[80:83], v136 offset:33792
    v_mfma_f32_16x16x32_bf16 v[28:31], v[108:111], v[44:47], v[28:31]
    ds_read_b128 v[84:87], v136 offset:35840
    v_mfma_f32_16x16x32_bf16 v[28:31], v[116:119], v[60:63], v[28:31]
    ds_read_b128 v[88:91], v136 offset:37888
    ds_read_b128 v[92:95], v136 offset:39936
    v_mfma_f32_16x16x32_bf16 v[24:27], v[116:119], v[56:59], v[24:27]
    ds_read_b64_tr_b16 v[132:133], v138 offset:28672
    v_mfma_f32_16x16x32_bf16 v[24:27], v[108:111], v[40:43], v[24:27]
    ds_read_b64_tr_b16 v[134:135], v138 offset:30720
    v_mfma_f32_16x16x32_bf16 v[20:23], v[108:111], v[36:39], v[20:23]
    v_mfma_f32_16x16x32_bf16 v[20:23], v[116:119], v[52:55], v[20:23]
    v_mfma_f32_16x16x32_bf16 v[16:19], v[116:119], v[48:51], v[16:19]
    v_mfma_f32_16x16x32_bf16 v[16:19], v[108:111], v[32:35], v[16:19]
    s_waitcnt lgkmcnt(0)
    s_barrier
    .p2align 3
    v_mfma_f32_16x16x32_bf16 v[0:3], v[120:123], v[64:67], v[0:3]
    ds_read_b64_tr_b16 v[104:105], v137 offset:32768
    ds_read_b64_tr_b16 v[106:107], v137 offset:34816
    v_mfma_f32_16x16x32_bf16 v[0:3], v[128:131], v[80:83], v[0:3]
    ds_read_b128 v[32:35], v136 offset:0
    v_mfma_f32_16x16x32_bf16 v[4:7], v[128:131], v[84:87], v[4:7]
    ds_read_b128 v[36:39], v136 offset:2048
    v_mfma_f32_16x16x32_bf16 v[4:7], v[120:123], v[68:71], v[4:7]
    ds_read_b128 v[40:43], v136 offset:4096
    ds_read_b128 v[44:47], v136 offset:6144
    v_mfma_f32_16x16x32_bf16 v[8:11], v[120:123], v[72:75], v[8:11]
    ds_read_b64_tr_b16 v[108:109], v138 offset:32768
    v_mfma_f32_16x16x32_bf16 v[8:11], v[128:131], v[88:91], v[8:11]
    ds_read_b64_tr_b16 v[110:111], v138 offset:34816
    v_mfma_f32_16x16x32_bf16 v[12:15], v[128:131], v[92:95], v[12:15]
    ds_read_b64_tr_b16 v[112:113], v137 offset:36864
    ds_read_b64_tr_b16 v[114:115], v137 offset:38912
    v_mfma_f32_16x16x32_bf16 v[12:15], v[120:123], v[76:79], v[12:15]
    ds_read_b128 v[48:51], v136 offset:1024
    v_mfma_f32_16x16x32_bf16 v[28:31], v[124:127], v[76:79], v[28:31]
    ds_read_b128 v[52:55], v136 offset:3072
    v_mfma_f32_16x16x32_bf16 v[28:31], v[132:135], v[92:95], v[28:31]
    ds_read_b128 v[56:59], v136 offset:5120
    ds_read_b128 v[60:63], v136 offset:7168
    v_mfma_f32_16x16x32_bf16 v[24:27], v[132:135], v[88:91], v[24:27]
    ds_read_b64_tr_b16 v[116:117], v138 offset:36864
    v_mfma_f32_16x16x32_bf16 v[24:27], v[124:127], v[72:75], v[24:27]
    ds_read_b64_tr_b16 v[118:119], v138 offset:38912
    v_mfma_f32_16x16x32_bf16 v[20:23], v[124:127], v[68:71], v[20:23]
    v_mfma_f32_16x16x32_bf16 v[20:23], v[132:135], v[84:87], v[20:23]
    v_mfma_f32_16x16x32_bf16 v[16:19], v[132:135], v[80:83], v[16:19]
    v_mfma_f32_16x16x32_bf16 v[16:19], v[124:127], v[64:67], v[16:19]
    s_waitcnt lgkmcnt(0)
    s_barrier
    .p2align 3
    v_mfma_f32_16x16x32_bf16 v[0:3], v[104:107], v[32:35], v[0:3]
    ds_read_b64_tr_b16 v[120:121], v137 offset:40960
    ds_read_b64_tr_b16 v[122:123], v137 offset:43008
    v_mfma_f32_16x16x32_bf16 v[0:3], v[112:115], v[48:51], v[0:3]
    ds_read_b128 v[64:67], v136 offset:16384
    v_mfma_f32_16x16x32_bf16 v[4:7], v[112:115], v[52:55], v[4:7]
    ds_read_b128 v[68:71], v136 offset:18432
    v_mfma_f32_16x16x32_bf16 v[4:7], v[104:107], v[36:39], v[4:7]
    ds_read_b128 v[72:75], v136 offset:20480
    ds_read_b128 v[76:79], v136 offset:22528
    v_mfma_f32_16x16x32_bf16 v[8:11], v[104:107], v[40:43], v[8:11]
    ds_read_b64_tr_b16 v[124:125], v138 offset:40960
    v_mfma_f32_16x16x32_bf16 v[8:11], v[112:115], v[56:59], v[8:11]
    ds_read_b64_tr_b16 v[126:127], v138 offset:43008
    v_mfma_f32_16x16x32_bf16 v[12:15], v[112:115], v[60:63], v[12:15]
    ds_read_b64_tr_b16 v[128:129], v137 offset:45056
    ds_read_b64_tr_b16 v[130:131], v137 offset:47104
    v_mfma_f32_16x16x32_bf16 v[12:15], v[104:107], v[44:47], v[12:15]
    ds_read_b128 v[80:83], v136 offset:17408
    v_mfma_f32_16x16x32_bf16 v[28:31], v[108:111], v[44:47], v[28:31]
    ds_read_b128 v[84:87], v136 offset:19456
    v_mfma_f32_16x16x32_bf16 v[28:31], v[116:119], v[60:63], v[28:31]
    ds_read_b128 v[88:91], v136 offset:21504
    ds_read_b128 v[92:95], v136 offset:23552
    v_mfma_f32_16x16x32_bf16 v[24:27], v[116:119], v[56:59], v[24:27]
    ds_read_b64_tr_b16 v[132:133], v138 offset:45056
    v_mfma_f32_16x16x32_bf16 v[24:27], v[108:111], v[40:43], v[24:27]
    ds_read_b64_tr_b16 v[134:135], v138 offset:47104
    v_mfma_f32_16x16x32_bf16 v[20:23], v[108:111], v[36:39], v[20:23]
    v_mfma_f32_16x16x32_bf16 v[20:23], v[116:119], v[52:55], v[20:23]
    v_mfma_f32_16x16x32_bf16 v[16:19], v[116:119], v[48:51], v[16:19]
    v_mfma_f32_16x16x32_bf16 v[16:19], v[108:111], v[32:35], v[16:19]
    s_waitcnt lgkmcnt(0)
    s_barrier
    .p2align 3
    v_mfma_f32_16x16x32_bf16 v[0:3], v[120:123], v[64:67], v[0:3]
    ds_read_b64_tr_b16 v[104:105], v139 offset:0
    ds_read_b64_tr_b16 v[106:107], v139 offset:2048
    v_mfma_f32_16x16x32_bf16 v[0:3], v[128:131], v[80:83], v[0:3]
    ds_read_b128 v[32:35], v136 offset:32768
    v_mfma_f32_16x16x32_bf16 v[4:7], v[128:131], v[84:87], v[4:7]
    ds_read_b128 v[36:39], v136 offset:34816
    v_mfma_f32_16x16x32_bf16 v[4:7], v[120:123], v[68:71], v[4:7]
    ds_read_b128 v[40:43], v136 offset:36864
    ds_read_b128 v[44:47], v136 offset:38912
    v_mfma_f32_16x16x32_bf16 v[8:11], v[120:123], v[72:75], v[8:11]
    ds_read_b64_tr_b16 v[108:109], v140 offset:0
    v_mfma_f32_16x16x32_bf16 v[8:11], v[128:131], v[88:91], v[8:11]
    ds_read_b64_tr_b16 v[110:111], v140 offset:2048
    v_mfma_f32_16x16x32_bf16 v[12:15], v[128:131], v[92:95], v[12:15]
    ds_read_b64_tr_b16 v[112:113], v139 offset:4096
    ds_read_b64_tr_b16 v[114:115], v139 offset:6144
    v_mfma_f32_16x16x32_bf16 v[12:15], v[120:123], v[76:79], v[12:15]
    ds_read_b128 v[48:51], v136 offset:33792
    v_mfma_f32_16x16x32_bf16 v[28:31], v[124:127], v[76:79], v[28:31]
    ds_read_b128 v[52:55], v136 offset:35840
    v_mfma_f32_16x16x32_bf16 v[28:31], v[132:135], v[92:95], v[28:31]
    ds_read_b128 v[56:59], v136 offset:37888
    ds_read_b128 v[60:63], v136 offset:39936
    v_mfma_f32_16x16x32_bf16 v[24:27], v[132:135], v[88:91], v[24:27]
    ds_read_b64_tr_b16 v[116:117], v140 offset:4096
    v_mfma_f32_16x16x32_bf16 v[24:27], v[124:127], v[72:75], v[24:27]
    ds_read_b64_tr_b16 v[118:119], v140 offset:6144
    v_mfma_f32_16x16x32_bf16 v[20:23], v[124:127], v[68:71], v[20:23]
    v_mfma_f32_16x16x32_bf16 v[20:23], v[132:135], v[84:87], v[20:23]
    v_mfma_f32_16x16x32_bf16 v[16:19], v[132:135], v[80:83], v[16:19]
    v_mfma_f32_16x16x32_bf16 v[16:19], v[124:127], v[64:67], v[16:19]
    s_waitcnt lgkmcnt(0)
    s_barrier
    .p2align 3
    v_mfma_f32_16x16x32_bf16 v[0:3], v[104:107], v[32:35], v[0:3]
    ds_read_b64_tr_b16 v[120:121], v139 offset:8192
    ds_read_b64_tr_b16 v[122:123], v139 offset:10240
    v_mfma_f32_16x16x32_bf16 v[0:3], v[112:115], v[48:51], v[0:3]
    ds_read_b128 v[64:67], v136 offset:0
    v_mfma_f32_16x16x32_bf16 v[4:7], v[112:115], v[52:55], v[4:7]
    ds_read_b128 v[68:71], v136 offset:2048
    v_mfma_f32_16x16x32_bf16 v[4:7], v[104:107], v[36:39], v[4:7]
    ds_read_b128 v[72:75], v136 offset:4096
    ds_read_b128 v[76:79], v136 offset:6144
    v_mfma_f32_16x16x32_bf16 v[8:11], v[104:107], v[40:43], v[8:11]
    ds_read_b64_tr_b16 v[124:125], v140 offset:8192
    v_mfma_f32_16x16x32_bf16 v[8:11], v[112:115], v[56:59], v[8:11]
    ds_read_b64_tr_b16 v[126:127], v140 offset:10240
    v_mfma_f32_16x16x32_bf16 v[12:15], v[112:115], v[60:63], v[12:15]
    ds_read_b64_tr_b16 v[128:129], v139 offset:12288
    ds_read_b64_tr_b16 v[130:131], v139 offset:14336
    v_mfma_f32_16x16x32_bf16 v[12:15], v[104:107], v[44:47], v[12:15]
    ds_read_b128 v[80:83], v136 offset:1024
    v_mfma_f32_16x16x32_bf16 v[28:31], v[108:111], v[44:47], v[28:31]
    ds_read_b128 v[84:87], v136 offset:3072
    v_mfma_f32_16x16x32_bf16 v[28:31], v[116:119], v[60:63], v[28:31]
    ds_read_b128 v[88:91], v136 offset:5120
    ds_read_b128 v[92:95], v136 offset:7168
    v_mfma_f32_16x16x32_bf16 v[24:27], v[116:119], v[56:59], v[24:27]
    ds_read_b64_tr_b16 v[132:133], v140 offset:12288
    v_mfma_f32_16x16x32_bf16 v[24:27], v[108:111], v[40:43], v[24:27]
    ds_read_b64_tr_b16 v[134:135], v140 offset:14336
    v_mfma_f32_16x16x32_bf16 v[20:23], v[108:111], v[36:39], v[20:23]
    v_mfma_f32_16x16x32_bf16 v[20:23], v[116:119], v[52:55], v[20:23]
    v_mfma_f32_16x16x32_bf16 v[16:19], v[116:119], v[48:51], v[16:19]
    v_mfma_f32_16x16x32_bf16 v[16:19], v[108:111], v[32:35], v[16:19]
    s_waitcnt lgkmcnt(0)
    s_barrier
    .p2align 3
    v_mfma_f32_16x16x32_bf16 v[0:3], v[120:123], v[64:67], v[0:3]
    v_mfma_f32_16x16x32_bf16 v[0:3], v[128:131], v[80:83], v[0:3]
    v_mfma_f32_16x16x32_bf16 v[4:7], v[128:131], v[84:87], v[4:7]
    v_mfma_f32_16x16x32_bf16 v[4:7], v[120:123], v[68:71], v[4:7]
    v_mfma_f32_16x16x32_bf16 v[8:11], v[120:123], v[72:75], v[8:11]
    v_mfma_f32_16x16x32_bf16 v[8:11], v[128:131], v[88:91], v[8:11]
    v_mfma_f32_16x16x32_bf16 v[12:15], v[128:131], v[92:95], v[12:15]
    v_mfma_f32_16x16x32_bf16 v[12:15], v[120:123], v[76:79], v[12:15]
    v_mfma_f32_16x16x32_bf16 v[28:31], v[124:127], v[76:79], v[28:31]
    v_mfma_f32_16x16x32_bf16 v[28:31], v[132:135], v[92:95], v[28:31]
    v_mfma_f32_16x16x32_bf16 v[24:27], v[132:135], v[88:91], v[24:27]
    v_mfma_f32_16x16x32_bf16 v[24:27], v[124:127], v[72:75], v[24:27]
    v_mfma_f32_16x16x32_bf16 v[20:23], v[124:127], v[68:71], v[20:23]
    v_mfma_f32_16x16x32_bf16 v[20:23], v[132:135], v[84:87], v[20:23]
    v_mfma_f32_16x16x32_bf16 v[16:19], v[132:135], v[80:83], v[16:19]
    v_mfma_f32_16x16x32_bf16 v[16:19], v[124:127], v[64:67], v[16:19]
    s_nop 7
    s_add_u32 s59, s1, s49
    s_add_u32 s60, s59, 4096
    v_cvt_pk_bf16_f32 v192, v0, v1
    v_cvt_pk_bf16_f32 v193, v2, v3
    v_cvt_pk_bf16_f32 v194, v16, v17
    v_cvt_pk_bf16_f32 v195, v18, v19
    buffer_store_dwordx4 v[192:195], v254, s[4:7], s59 offen offset:0 sc0 sc1
    v_cvt_pk_bf16_f32 v196, v4, v5
    v_cvt_pk_bf16_f32 v197, v6, v7
    v_cvt_pk_bf16_f32 v198, v20, v21
    v_cvt_pk_bf16_f32 v199, v22, v23
    buffer_store_dwordx4 v[196:199], v254, s[4:7], s59 offen offset:2048 sc0 sc1
    v_cvt_pk_bf16_f32 v200, v8, v9
    v_cvt_pk_bf16_f32 v201, v10, v11
    v_cvt_pk_bf16_f32 v202, v24, v25
    v_cvt_pk_bf16_f32 v203, v26, v27
    buffer_store_dwordx4 v[200:203], v254, s[4:7], s60 offen offset:0 sc0 sc1
    v_cvt_pk_bf16_f32 v204, v12, v13
    v_cvt_pk_bf16_f32 v205, v14, v15
    v_cvt_pk_bf16_f32 v206, v28, v29
    v_cvt_pk_bf16_f32 v207, v30, v31
    buffer_store_dwordx4 v[204:207], v254, s[4:7], s60 offen offset:2048 sc0 sc1
    v_mov_b32 v216, 0x3f803f80
    v_dot2_f32_bf16 v208, v192, v216, 0
    v_dot2_f32_bf16 v212, v192, v192, 0
    v_dot2_f32_bf16 v209, v196, v216, 0
    v_dot2_f32_bf16 v213, v196, v196, 0
    v_dot2_f32_bf16 v210, v200, v216, 0
    v_dot2_f32_bf16 v214, v200, v200, 0
    v_dot2_f32_bf16 v211, v204, v216, 0
    v_dot2_f32_bf16 v215, v204, v204, 0
    v_dot2_f32_bf16 v208, v193, v216, v208
    v_dot2_f32_bf16 v212, v193, v193, v212
    v_dot2_f32_bf16 v209, v197, v216, v209
    v_dot2_f32_bf16 v213, v197, v197, v213
    v_dot2_f32_bf16 v210, v201, v216, v210
    v_dot2_f32_bf16 v214, v201, v201, v214
    v_dot2_f32_bf16 v211, v205, v216, v211
    v_dot2_f32_bf16 v215, v205, v205, v215
    v_dot2_f32_bf16 v208, v194, v216, v208
    v_dot2_f32_bf16 v212, v194, v194, v212
    v_dot2_f32_bf16 v209, v198, v216, v209
    v_dot2_f32_bf16 v213, v198, v198, v213
    v_dot2_f32_bf16 v210, v202, v216, v210
    v_dot2_f32_bf16 v214, v202, v202, v214
    v_dot2_f32_bf16 v211, v206, v216, v211
    v_dot2_f32_bf16 v215, v206, v206, v215
    v_dot2_f32_bf16 v208, v195, v216, v208
    v_dot2_f32_bf16 v212, v195, v195, v212
    v_dot2_f32_bf16 v209, v199, v216, v209
    v_dot2_f32_bf16 v213, v199, v199, v213
    v_dot2_f32_bf16 v210, v203, v216, v210
    v_dot2_f32_bf16 v214, v203, v203, v214
    v_dot2_f32_bf16 v211, v207, v216, v211
    v_dot2_f32_bf16 v215, v207, v207, v215
    s_lshl_b32 s55, s42, 9
    s_add_u32 s55, s55, 155648
    s_nop 1
    v_permlane32_swap_b32 v208, v210
    v_permlane32_swap_b32 v209, v211
    v_permlane32_swap_b32 v212, v214
    v_permlane32_swap_b32 v213, v215
    v_add_f32 v208, v208, v210
    v_add_f32 v209, v209, v211
    v_add_f32 v212, v212, v214
    v_add_f32 v213, v213, v215
    v_lshrrev_b32 v216, 1, v254
    v_add_u32 v216, s55, v216
    v_permlane16_swap_b32 v208, v209
    v_permlane16_swap_b32 v212, v213
    v_add_f32 v208, v208, v209
    v_add_f32 v209, v212, v213
    ds_write_b64 v216, v[208:209]
    s_lshl_b32 s55, s43, 13
    s_add_u32 s55, s55, 98304
    v_add_u32 v224, s55, v254
    s_lshl_b32 s56, s44, 2
    v_lshrrev_b32 v233, 6, v254
    v_and_b32 v234, 7, v233
    v_xor_b32 v234, s56, v234
    v_lshlrev_b32 v233, 8, v233
    v_lshl_add_u32 v233, v234, 5, v233
    v_and_b32 v234, 0x30, v254
    v_lshrrev_b32 v234, 1, v234
    v_add_u32 v233, v233, v234
    v_xor_b32 v225, 0, v233
    v_xor_b32 v226, 32, v233
    v_xor_b32 v227, 64, v233
    v_xor_b32 v228, 96, v233
    v_add_u32 v229, 49152, v225
    v_add_u32 v230, 49152, v226
    v_add_u32 v231, 49152, v227
    v_add_u32 v232, 49152, v228
    v_lshrrev_b32 v233, 7, v254
    v_and_b32 v234, 0x70, v254
    v_and_b32 v235, 6, v233
    v_lshlrev_b32 v235, 4, v235
    v_xor_b32 v234, v234, v235
    v_mul_u32_u24 v233, 7168, v233
    v_add3_u32 v236, v233, v234, s66
    v_add_u32 v237, 56320, v236
    v_add_u32 v242, s67, v254
    v_and_b32 v234, 0xf0, v254
    v_lshrrev_b32 v233, 8, v254
    v_lshlrev_b32 v235, 5, v233
    v_xor_b32 v234, v234, v235
    v_mul_u32_u24 v233, 2048, v233
    v_add_u32 v238, v233, v234
    v_xor_b32 v234, 0x80, v234
    v_add_u32 v233, v233, v234
    v_add_u32 v239, 7168, v233
    v_add_u32 v240, 14336, v238
    v_add_u32 v241, 14336, v239
    v_mov_b32 v243, v224
    s_and_b32 s56, s51, 1
    s_lshl_b32 s56, s56, 2
    s_lshl_b32 s55, s44, 1
    s_add_u32 s56, s56, s55
    v_lshrrev_b32 v233, 6, v254
    v_and_b32 v234, 7, v233
    v_xor_b32 v234, s56, v234
    v_lshlrev_b32 v233, 8, v233
    v_lshl_add_u32 v233, v234, 5, v233
    v_and_b32 v234, 0x30, v254
    v_lshrrev_b32 v234, 1, v234
    v_add_u32 v233, v233, v234
    v_xor_b32 v244, 0, v233
    v_xor_b32 v245, 32, v233
    v_xor_b32 v246, 128, v233
    v_xor_b32 v247, 160, v233
    v_add_u32 v248, 49152, v244
    v_add_u32 v249, 49152, v245
    v_add_u32 v250, 49152, v246
    v_add_u32 v251, 49152, v247
    s_and_b32 s55, s51, 1
    s_mul_i32 s55, s55, 458752
    s_add_u32 s95, s50, s55
    s_and_b32 s55, s41, 7
    s_lshl_b32 s55, s55, 14
    s_and_b32 s56, s1, 0x3fff
    s_add_u32 s55, s55, s56
    s_add_u32 s89, s55, s95
    s_and_b32 s55, s41, 6
    s_add_u32 s55, s55, 48
    s_lshl_b32 s55, s55, 13
    s_and_b32 s56, s41, 1
    s_lshl_b32 s56, s56, 10
    s_add_u32 s55, s55, s56
    s_lshl_b32 s56, s43, 13
    s_add_u32 s55, s55, s56
    s_lshl_b32 s56, s44, 9
    s_add_u32 s55, s55, s56
    s_add_u32 s90, s55, s95
    s_lshl_b32 s60, s43, 23
    s_add_u32 s60, s60, 83886336
    s_mov_b32 s24, s16
    s_mov_b32 s25, s17
    s_mov_b32 s26, s18
    s_mov_b32 s27, s19
    s_add_u32 s88, s49, s62
    s_lshl_b32 s94, s51, 14
    s_waitcnt vmcnt(0) lgkmcnt(0)
    s_barrier
    s_cmp_lg_u32 s42, 2
    s_cbranch_scc1 wf_20
    s_lshr_b32 s55, s2, 5
    s_lshl_b32 s55, s55, 2
    s_add_u32 s55, s55, s0
    v_mov_b32 v252, 32
    v_mov_b32 v253, 0x01010101
    s_mov_b64 exec, 1
    s_cmp_eq_u32 s45, 0
    s_cbranch_scc1 st_21
    buffer_store_dword v253, v252, s[4:7], s55 offen sc0 sc1
    s_branch st_22
st_21:
    buffer_store_dword v253, v252, s[4:7], s55 offen
st_22:
    s_mov_b64 exec, -1
wf_20:
    s_cmp_lg_u32 s42, 0
    s_cbranch_scc1 so_23
    v_add_u32 v216, 155648, v254
    ds_read_b128 v[208:211], v216
    ds_read_b128 v[212:215], v216 offset:1024
    s_lshl_b32 s55, s51, 10
    s_add_u32 s55, s55, s52
    s_waitcnt lgkmcnt(0)
    v_add_f32 v208, v208, v212
    v_add_f32 v209, v209, v213
    v_add_f32 v210, v210, v214
    v_add_f32 v211, v211, v215
    buffer_store_dwordx4 v[208:211], v254, s[4:7], s55 offen sc0 sc1
so_23:
    s_barrier
    ds_read_b64_tr_b16 v[160:161], v229 offset:16384
    ds_read_b64_tr_b16 v[162:163], v229 offset:20480
    ds_read_b128 v[128:131], v224 offset:0
    ds_read_b128 v[132:135], v224 offset:2048
    ds_read_b128 v[136:139], v224 offset:4096
    ds_read_b128 v[140:143], v224 offset:6144
    ds_read_b64_tr_b16 v[176:177], v229 offset:24576
    ds_read_b64_tr_b16 v[178:179], v229 offset:28672
    ds_read_b64_tr_b16 v[164:165], v230 offset:16384
    ds_read_b64_tr_b16 v[166:167], v230 offset:20480
    ds_read_b64_tr_b16 v[180:181], v230 offset:24576
    ds_read_b64_tr_b16 v[182:183], v230 offset:28672
    ds_read_b64_tr_b16 v[168:169], v231 offset:16384
    ds_read_b64_tr_b16 v[170:171], v231 offset:20480
    ds_read_b64_tr_b16 v[184:185], v231 offset:24576
    ds_read_b64_tr_b16 v[186:187], v231 offset:28672
    ds_read_b64_tr_b16 v[172:173], v232 offset:16384
    ds_read_b64_tr_b16 v[174:175], v232 offset:20480
    ds_read_b64_tr_b16 v[188:189], v232 offset:24576
    ds_read_b64_tr_b16 v[190:191], v232 offset:28672
    s_mov_b32 s58, 5
    s_waitcnt lgkmcnt(0)
    s_barrier
    .p2align 3
    v_mfma_f32_16x16x32_bf16 v[0:3], v[160:163], v[128:131], 0
    ds_read_b64_tr_b16 v[192:193], v229 offset:32768
    v_mfma_f32_16x16x32_bf16 v[4:7], v[160:163], v[132:135], 0
    ds_read_b64_tr_b16 v[194:195], v229 offset:36864
    v_mfma_f32_16x16x32_bf16 v[8:11], v[160:163], v[136:139], 0
    ds_read_b128 v[144:147], v224 offset:1024
    v_mfma_f32_16x16x32_bf16 v[12:15], v[160:163], v[140:143], 0
    ds_read_b128 v[148:151], v224 offset:3072
    v_mfma_f32_16x16x32_bf16 v[76:79], v[176:179], v[140:143], 0
    ds_read_b128 v[152:155], v224 offset:5120
    v_mfma_f32_16x16x32_bf16 v[72:75], v[176:179], v[136:139], 0
    v_mfma_f32_16x16x32_bf16 v[68:71], v[176:179], v[132:135], 0
    ds_read_b128 v[156:159], v224 offset:7168
    v_mfma_f32_16x16x32_bf16 v[64:67], v[176:179], v[128:131], 0
    ds_read_b64_tr_b16 v[208:209], v229 offset:40960
    v_mfma_f32_16x16x32_bf16 v[16:19], v[164:167], v[128:131], 0
    ds_read_b64_tr_b16 v[210:211], v229 offset:45056
    v_mfma_f32_16x16x32_bf16 v[20:23], v[164:167], v[132:135], 0
    ds_read_b64_tr_b16 v[196:197], v230 offset:32768
    v_mfma_f32_16x16x32_bf16 v[24:27], v[164:167], v[136:139], 0
    ds_read_b64_tr_b16 v[198:199], v230 offset:36864
    v_mfma_f32_16x16x32_bf16 v[28:31], v[164:167], v[140:143], 0
    v_mfma_f32_16x16x32_bf16 v[92:95], v[180:183], v[140:143], 0
    ds_read_b64_tr_b16 v[212:213], v230 offset:40960
    v_mfma_f32_16x16x32_bf16 v[88:91], v[180:183], v[136:139], 0
    ds_read_b64_tr_b16 v[214:215], v230 offset:45056
    v_mfma_f32_16x16x32_bf16 v[84:87], v[180:183], v[132:135], 0
    ds_read_b64_tr_b16 v[200:201], v231 offset:32768
    v_mfma_f32_16x16x32_bf16 v[80:83], v[180:183], v[128:131], 0
    ds_read_b64_tr_b16 v[202:203], v231 offset:36864
    v_mfma_f32_16x16x32_bf16 v[32:35], v[168:171], v[128:131], 0
    ds_read_b64_tr_b16 v[216:217], v231 offset:40960
    v_mfma_f32_16x16x32_bf16 v[36:39], v[168:171], v[132:135], 0
    v_mfma_f32_16x16x32_bf16 v[40:43], v[168:171], v[136:139], 0
    ds_read_b64_tr_b16 v[218:219], v231 offset:45056
    v_mfma_f32_16x16x32_bf16 v[44:47], v[168:171], v[140:143], 0
    ds_read_b64_tr_b16 v[204:205], v232 offset:32768
    v_mfma_f32_16x16x32_bf16 v[108:111], v[184:187], v[140:143], 0
    ds_read_b64_tr_b16 v[206:207], v232 offset:36864
    v_mfma_f32_16x16x32_bf16 v[104:107], v[184:187], v[136:139], 0
    ds_read_b64_tr_b16 v[220:221], v232 offset:40960
    v_mfma_f32_16x16x32_bf16 v[100:103], v[184:187], v[132:135], 0
    ds_read_b64_tr_b16 v[222:223], v232 offset:45056
    v_mfma_f32_16x16x32_bf16 v[96:99], v[184:187], v[128:131], 0
    v_mfma_f32_16x16x32_bf16 v[48:51], v[172:175], v[128:131], 0
    v_mfma_f32_16x16x32_bf16 v[52:55], v[172:175], v[132:135], 0
    v_mfma_f32_16x16x32_bf16 v[56:59], v[172:175], v[136:139], 0
    v_mfma_f32_16x16x32_bf16 v[60:63], v[172:175], v[140:143], 0
    v_mfma_f32_16x16x32_bf16 v[124:127], v[188:191], v[140:143], 0
    v_mfma_f32_16x16x32_bf16 v[120:123], v[188:191], v[136:139], 0
    v_mfma_f32_16x16x32_bf16 v[116:119], v[188:191], v[132:135], 0
    v_mfma_f32_16x16x32_bf16 v[112:115], v[188:191], v[128:131], 0
    .p2align 3
loop_24:
    s_waitcnt lgkmcnt(0)
    s_barrier
    .p2align 3
    v_mfma_f32_16x16x32_bf16 v[0:3], v[192:195], v[144:147], v[0:3]
    ds_read_b64_tr_b16 v[160:161], v225 offset:0
    v_mfma_f32_16x16x32_bf16 v[4:7], v[192:195], v[148:151], v[4:7]
    ds_read_b64_tr_b16 v[162:163], v225 offset:4096
    v_mfma_f32_16x16x32_bf16 v[8:11], v[192:195], v[152:155], v[8:11]
    ds_read_b128 v[128:131], v224 offset:16384
    v_mfma_f32_16x16x32_bf16 v[12:15], v[192:195], v[156:159], v[12:15]
    ds_read_b128 v[132:135], v224 offset:18432
    v_mfma_f32_16x16x32_bf16 v[76:79], v[208:211], v[156:159], v[76:79]
    ds_read_b128 v[136:139], v224 offset:20480
    v_mfma_f32_16x16x32_bf16 v[72:75], v[208:211], v[152:155], v[72:75]
    v_mfma_f32_16x16x32_bf16 v[68:71], v[208:211], v[148:151], v[68:71]
    ds_read_b128 v[140:143], v224 offset:22528
    v_mfma_f32_16x16x32_bf16 v[64:67], v[208:211], v[144:147], v[64:67]
    ds_read_b64_tr_b16 v[176:177], v225 offset:8192
    v_mfma_f32_16x16x32_bf16 v[16:19], v[196:199], v[144:147], v[16:19]
    ds_read_b64_tr_b16 v[178:179], v225 offset:12288
    v_mfma_f32_16x16x32_bf16 v[20:23], v[196:199], v[148:151], v[20:23]
    ds_read_b64_tr_b16 v[164:165], v226 offset:0
    v_mfma_f32_16x16x32_bf16 v[24:27], v[196:199], v[152:155], v[24:27]
    ds_read_b64_tr_b16 v[166:167], v226 offset:4096
    v_mfma_f32_16x16x32_bf16 v[28:31], v[196:199], v[156:159], v[28:31]
    v_mfma_f32_16x16x32_bf16 v[92:95], v[212:215], v[156:159], v[92:95]
    ds_read_b64_tr_b16 v[180:181], v226 offset:8192
    v_mfma_f32_16x16x32_bf16 v[88:91], v[212:215], v[152:155], v[88:91]
    ds_read_b64_tr_b16 v[182:183], v226 offset:12288
    v_mfma_f32_16x16x32_bf16 v[84:87], v[212:215], v[148:151], v[84:87]
    ds_read_b64_tr_b16 v[168:169], v227 offset:0
    v_mfma_f32_16x16x32_bf16 v[80:83], v[212:215], v[144:147], v[80:83]
    ds_read_b64_tr_b16 v[170:171], v227 offset:4096
    v_mfma_f32_16x16x32_bf16 v[32:35], v[200:203], v[144:147], v[32:35]
    ds_read_b64_tr_b16 v[184:185], v227 offset:8192
    v_mfma_f32_16x16x32_bf16 v[36:39], v[200:203], v[148:151], v[36:39]
    v_mfma_f32_16x16x32_bf16 v[40:43], v[200:203], v[152:155], v[40:43]
    ds_read_b64_tr_b16 v[186:187], v227 offset:12288
    v_mfma_f32_16x16x32_bf16 v[44:47], v[200:203], v[156:159], v[44:47]
    ds_read_b64_tr_b16 v[172:173], v228 offset:0
    v_mfma_f32_16x16x32_bf16 v[108:111], v[216:219], v[156:159], v[108:111]
    ds_read_b64_tr_b16 v[174:175], v228 offset:4096
    v_mfma_f32_16x16x32_bf16 v[104:107], v[216:219], v[152:155], v[104:107]
    ds_read_b64_tr_b16 v[188:189], v228 offset:8192
    v_mfma_f32_16x16x32_bf16 v[100:103], v[216:219], v[148:151], v[100:103]
    ds_read_b64_tr_b16 v[190:191], v228 offset:12288
    v_mfma_f32_16x16x32_bf16 v[96:99], v[216:219], v[144:147], v[96:99]
    v_mfma_f32_16x16x32_bf16 v[48:51], v[204:207], v[144:147], v[48:51]
    v_mfma_f32_16x16x32_bf16 v[52:55], v[204:207], v[148:151], v[52:55]
    v_mfma_f32_16x16x32_bf16 v[56:59], v[204:207], v[152:155], v[56:59]
    v_mfma_f32_16x16x32_bf16 v[60:63], v[204:207], v[156:159], v[60:63]
    v_mfma_f32_16x16x32_bf16 v[124:127], v[220:223], v[156:159], v[124:127]
    v_mfma_f32_16x16x32_bf16 v[120:123], v[220:223], v[152:155], v[120:123]
    v_mfma_f32_16x16x32_bf16 v[116:119], v[220:223], v[148:151], v[116:119]
    v_mfma_f32_16x16x32_bf16 v[112:115], v[220:223], v[144:147], v[112:115]
    s_waitcnt vmcnt(0) lgkmcnt(0)
    s_barrier
    .p2align 3
    v_mfma_f32_16x16x32_bf16 v[0:3], v[160:163], v[128:131], v[0:3]
    ds_read_b64_tr_b16 v[192:193], v225 offset:16384
    v_mfma_f32_16x16x32_bf16 v[4:7], v[160:163], v[132:135], v[4:7]
    ds_read_b64_tr_b16 v[194:195], v225 offset:20480
    v_mfma_f32_16x16x32_bf16 v[8:11], v[160:163], v[136:139], v[8:11]
    ds_read_b128 v[144:147], v224 offset:17408
    v_mfma_f32_16x16x32_bf16 v[12:15], v[160:163], v[140:143], v[12:15]
    ds_read_b128 v[148:151], v224 offset:19456
    v_mfma_f32_16x16x32_bf16 v[76:79], v[176:179], v[140:143], v[76:79]
    ds_read_b128 v[152:155], v224 offset:21504
    v_mfma_f32_16x16x32_bf16 v[72:75], v[176:179], v[136:139], v[72:75]
    v_mfma_f32_16x16x32_bf16 v[68:71], v[176:179], v[132:135], v[68:71]
    ds_read_b128 v[156:159], v224 offset:23552
    v_mfma_f32_16x16x32_bf16 v[64:67], v[176:179], v[128:131], v[64:67]
    ds_read_b64_tr_b16 v[208:209], v225 offset:24576
    v_mfma_f32_16x16x32_bf16 v[16:19], v[164:167], v[128:131], v[16:19]
    ds_read_b64_tr_b16 v[210:211], v225 offset:28672
    v_mfma_f32_16x16x32_bf16 v[20:23], v[164:167], v[132:135], v[20:23]
    ds_read_b64_tr_b16 v[196:197], v226 offset:16384
    v_mfma_f32_16x16x32_bf16 v[24:27], v[164:167], v[136:139], v[24:27]
    ds_read_b64_tr_b16 v[198:199], v226 offset:20480
    v_mfma_f32_16x16x32_bf16 v[28:31], v[164:167], v[140:143], v[28:31]
    v_mfma_f32_16x16x32_bf16 v[92:95], v[180:183], v[140:143], v[92:95]
    ds_read_b64_tr_b16 v[212:213], v226 offset:24576
    v_mfma_f32_16x16x32_bf16 v[88:91], v[180:183], v[136:139], v[88:91]
    ds_read_b64_tr_b16 v[214:215], v226 offset:28672
    v_mfma_f32_16x16x32_bf16 v[84:87], v[180:183], v[132:135], v[84:87]
    ds_read_b64_tr_b16 v[200:201], v227 offset:16384
    v_mfma_f32_16x16x32_bf16 v[80:83], v[180:183], v[128:131], v[80:83]
    ds_read_b64_tr_b16 v[202:203], v227 offset:20480
    v_mfma_f32_16x16x32_bf16 v[32:35], v[168:171], v[128:131], v[32:35]
    ds_read_b64_tr_b16 v[216:217], v227 offset:24576
    v_mfma_f32_16x16x32_bf16 v[36:39], v[168:171], v[132:135], v[36:39]
    v_mfma_f32_16x16x32_bf16 v[40:43], v[168:171], v[136:139], v[40:43]
    ds_read_b64_tr_b16 v[218:219], v227 offset:28672
    v_mfma_f32_16x16x32_bf16 v[44:47], v[168:171], v[140:143], v[44:47]
    ds_read_b64_tr_b16 v[204:205], v228 offset:16384
    v_mfma_f32_16x16x32_bf16 v[108:111], v[184:187], v[140:143], v[108:111]
    ds_read_b64_tr_b16 v[206:207], v228 offset:20480
    v_mfma_f32_16x16x32_bf16 v[104:107], v[184:187], v[136:139], v[104:107]
    ds_read_b64_tr_b16 v[220:221], v228 offset:24576
    v_mfma_f32_16x16x32_bf16 v[100:103], v[184:187], v[132:135], v[100:103]
    ds_read_b64_tr_b16 v[222:223], v228 offset:28672
    v_mfma_f32_16x16x32_bf16 v[96:99], v[184:187], v[128:131], v[96:99]
    v_mfma_f32_16x16x32_bf16 v[48:51], v[172:175], v[128:131], v[48:51]
    v_mfma_f32_16x16x32_bf16 v[52:55], v[172:175], v[132:135], v[52:55]
    v_mfma_f32_16x16x32_bf16 v[56:59], v[172:175], v[136:139], v[56:59]
    v_mfma_f32_16x16x32_bf16 v[60:63], v[172:175], v[140:143], v[60:63]
    v_mfma_f32_16x16x32_bf16 v[124:127], v[188:191], v[140:143], v[124:127]
    v_mfma_f32_16x16x32_bf16 v[120:123], v[188:191], v[136:139], v[120:123]
    v_mfma_f32_16x16x32_bf16 v[116:119], v[188:191], v[132:135], v[116:119]
    v_mfma_f32_16x16x32_bf16 v[112:115], v[188:191], v[128:131], v[112:115]
    s_waitcnt lgkmcnt(0)
    s_barrier
    .p2align 3
    v_mfma_f32_16x16x32_bf16 v[0:3], v[192:195], v[144:147], v[0:3]
    ds_read_b64_tr_b16 v[160:161], v225 offset:32768
    v_mfma_f32_16x16x32_bf16 v[4:7], v[192:195], v[148:151], v[4:7]
    ds_read_b64_tr_b16 v[162:163], v225 offset:36864
    v_mfma_f32_16x16x32_bf16 v[8:11], v[192:195], v[152:155], v[8:11]
    ds_read_b128 v[128:131], v224 offset:32768
    v_mfma_f32_16x16x32_bf16 v[12:15], v[192:195], v[156:159], v[12:15]
    ds_read_b128 v[132:135], v224 offset:34816
    v_mfma_f32_16x16x32_bf16 v[76:79], v[208:211], v[156:159], v[76:79]
    ds_read_b128 v[136:139], v224 offset:36864
    v_mfma_f32_16x16x32_bf16 v[72:75], v[208:211], v[152:155], v[72:75]
    v_mfma_f32_16x16x32_bf16 v[68:71], v[208:211], v[148:151], v[68:71]
    ds_read_b128 v[140:143], v224 offset:38912
    v_mfma_f32_16x16x32_bf16 v[64:67], v[208:211], v[144:147], v[64:67]
    ds_read_b64_tr_b16 v[176:177], v225 offset:40960
    v_mfma_f32_16x16x32_bf16 v[16:19], v[196:199], v[144:147], v[16:19]
    ds_read_b64_tr_b16 v[178:179], v225 offset:45056
    v_mfma_f32_16x16x32_bf16 v[20:23], v[196:199], v[148:151], v[20:23]
    ds_read_b64_tr_b16 v[164:165], v226 offset:32768
    v_mfma_f32_16x16x32_bf16 v[24:27], v[196:199], v[152:155], v[24:27]
    ds_read_b64_tr_b16 v[166:167], v226 offset:36864
    v_mfma_f32_16x16x32_bf16 v[28:31], v[196:199], v[156:159], v[28:31]
    v_mfma_f32_16x16x32_bf16 v[92:95], v[212:215], v[156:159], v[92:95]
    ds_read_b64_tr_b16 v[180:181], v226 offset:40960
    v_mfma_f32_16x16x32_bf16 v[88:91], v[212:215], v[152:155], v[88:91]
    ds_read_b64_tr_b16 v[182:183], v226 offset:45056
    v_mfma_f32_16x16x32_bf16 v[84:87], v[212:215], v[148:151], v[84:87]
    ds_read_b64_tr_b16 v[168:169], v227 offset:32768
    v_mfma_f32_16x16x32_bf16 v[80:83], v[212:215], v[144:147], v[80:83]
    ds_read_b64_tr_b16 v[170:171], v227 offset:36864
    v_mfma_f32_16x16x32_bf16 v[32:35], v[200:203], v[144:147], v[32:35]
    ds_read_b64_tr_b16 v[184:185], v227 offset:40960
    v_mfma_f32_16x16x32_bf16 v[36:39], v[200:203], v[148:151], v[36:39]
    v_mfma_f32_16x16x32_bf16 v[40:43], v[200:203], v[152:155], v[40:43]
    ds_read_b64_tr_b16 v[186:187], v227 offset:45056
    v_mfma_f32_16x16x32_bf16 v[44:47], v[200:203], v[156:159], v[44:47]
    ds_read_b64_tr_b16 v[172:173], v228 offset:32768
    v_mfma_f32_16x16x32_bf16 v[108:111], v[216:219], v[156:159], v[108:111]
    ds_read_b64_tr_b16 v[174:175], v228 offset:36864
    v_mfma_f32_16x16x32_bf16 v[104:107], v[216:219], v[152:155], v[104:107]
    ds_read_b64_tr_b16 v[188:189], v228 offset:40960
    v_mfma_f32_16x16x32_bf16 v[100:103], v[216:219], v[148:151], v[100:103]
    ds_read_b64_tr_b16 v[190:191], v228 offset:45056
    v_mfma_f32_16x16x32_bf16 v[96:99], v[216:219], v[144:147], v[96:99]
    v_mfma_f32_16x16x32_bf16 v[48:51], v[204:207], v[144:147], v[48:51]
    v_mfma_f32_16x16x32_bf16 v[52:55], v[204:207], v[148:151], v[52:55]
    v_mfma_f32_16x16x32_bf16 v[56:59], v[204:207], v[152:155], v[56:59]
    v_mfma_f32_16x16x32_bf16 v[60:63], v[204:207], v[156:159], v[60:63]
    v_mfma_f32_16x16x32_bf16 v[124:127], v[220:223], v[156:159], v[124:127]
    v_mfma_f32_16x16x32_bf16 v[120:123], v[220:223], v[152:155], v[120:123]
    v_mfma_f32_16x16x32_bf16 v[116:119], v[220:223], v[148:151], v[116:119]
    v_mfma_f32_16x16x32_bf16 v[112:115], v[220:223], v[144:147], v[112:115]
    s_waitcnt lgkmcnt(0)
    s_barrier
    .p2align 3
    v_mfma_f32_16x16x32_bf16 v[0:3], v[160:163], v[128:131], v[0:3]
    ds_read_b64_tr_b16 v[192:193], v229 offset:0
    v_mfma_f32_16x16x32_bf16 v[4:7], v[160:163], v[132:135], v[4:7]
    ds_read_b64_tr_b16 v[194:195], v229 offset:4096
    v_mfma_f32_16x16x32_bf16 v[8:11], v[160:163], v[136:139], v[8:11]
    ds_read_b128 v[144:147], v224 offset:33792
    v_mfma_f32_16x16x32_bf16 v[12:15], v[160:163], v[140:143], v[12:15]
    ds_read_b128 v[148:151], v224 offset:35840
    v_mfma_f32_16x16x32_bf16 v[76:79], v[176:179], v[140:143], v[76:79]
    ds_read_b128 v[152:155], v224 offset:37888
    v_mfma_f32_16x16x32_bf16 v[72:75], v[176:179], v[136:139], v[72:75]
    v_mfma_f32_16x16x32_bf16 v[68:71], v[176:179], v[132:135], v[68:71]
    ds_read_b128 v[156:159], v224 offset:39936
    v_mfma_f32_16x16x32_bf16 v[64:67], v[176:179], v[128:131], v[64:67]
    ds_read_b64_tr_b16 v[208:209], v229 offset:8192
    v_mfma_f32_16x16x32_bf16 v[16:19], v[164:167], v[128:131], v[16:19]
    ds_read_b64_tr_b16 v[210:211], v229 offset:12288
    v_mfma_f32_16x16x32_bf16 v[20:23], v[164:167], v[132:135], v[20:23]
    ds_read_b64_tr_b16 v[196:197], v230 offset:0
    v_mfma_f32_16x16x32_bf16 v[24:27], v[164:167], v[136:139], v[24:27]
    ds_read_b64_tr_b16 v[198:199], v230 offset:4096
    v_mfma_f32_16x16x32_bf16 v[28:31], v[164:167], v[140:143], v[28:31]
    v_mfma_f32_16x16x32_bf16 v[92:95], v[180:183], v[140:143], v[92:95]
    ds_read_b64_tr_b16 v[212:213], v230 offset:8192
    v_mfma_f32_16x16x32_bf16 v[88:91], v[180:183], v[136:139], v[88:91]
    ds_read_b64_tr_b16 v[214:215], v230 offset:12288
    v_mfma_f32_16x16x32_bf16 v[84:87], v[180:183], v[132:135], v[84:87]
    ds_read_b64_tr_b16 v[200:201], v231 offset:0
    v_mfma_f32_16x16x32_bf16 v[80:83], v[180:183], v[128:131], v[80:83]
    ds_read_b64_tr_b16 v[202:203], v231 offset:4096
    v_mfma_f32_16x16x32_bf16 v[32:35], v[168:171], v[128:131], v[32:35]
    ds_read_b64_tr_b16 v[216:217], v231 offset:8192
    v_mfma_f32_16x16x32_bf16 v[36:39], v[168:171], v[132:135], v[36:39]
    v_mfma_f32_16x16x32_bf16 v[40:43], v[168:171], v[136:139], v[40:43]
    ds_read_b64_tr_b16 v[218:219], v231 offset:12288
    v_mfma_f32_16x16x32_bf16 v[44:47], v[168:171], v[140:143], v[44:47]
    ds_read_b64_tr_b16 v[204:205], v232 offset:0
    v_mfma_f32_16x16x32_bf16 v[108:111], v[184:187], v[140:143], v[108:111]
    ds_read_b64_tr_b16 v[206:207], v232 offset:4096
    v_mfma_f32_16x16x32_bf16 v[104:107], v[184:187], v[136:139], v[104:107]
    ds_read_b64_tr_b16 v[220:221], v232 offset:8192
    v_mfma_f32_16x16x32_bf16 v[100:103], v[184:187], v[132:135], v[100:103]
    ds_read_b64_tr_b16 v[222:223], v232 offset:12288
    v_mfma_f32_16x16x32_bf16 v[96:99], v[184:187], v[128:131], v[96:99]
    v_mfma_f32_16x16x32_bf16 v[48:51], v[172:175], v[128:131], v[48:51]
    v_mfma_f32_16x16x32_bf16 v[52:55], v[172:175], v[132:135], v[52:55]
    v_mfma_f32_16x16x32_bf16 v[56:59], v[172:175], v[136:139], v[56:59]
    v_mfma_f32_16x16x32_bf16 v[60:63], v[172:175], v[140:143], v[60:63]
    v_mfma_f32_16x16x32_bf16 v[124:127], v[188:191], v[140:143], v[124:127]
    v_mfma_f32_16x16x32_bf16 v[120:123], v[188:191], v[136:139], v[120:123]
    v_mfma_f32_16x16x32_bf16 v[116:119], v[188:191], v[132:135], v[116:119]
    v_mfma_f32_16x16x32_bf16 v[112:115], v[188:191], v[128:131], v[112:115]
    s_waitcnt lgkmcnt(0)
    s_barrier
    .p2align 3
    v_mfma_f32_16x16x32_bf16 v[0:3], v[192:195], v[144:147], v[0:3]
    ds_read_b64_tr_b16 v[160:161], v229 offset:16384
    v_mfma_f32_16x16x32_bf16 v[4:7], v[192:195], v[148:151], v[4:7]
    ds_read_b64_tr_b16 v[162:163], v229 offset:20480
    v_mfma_f32_16x16x32_bf16 v[8:11], v[192:195], v[152:155], v[8:11]
    ds_read_b128 v[128:131], v224 offset:0
    v_mfma_f32_16x16x32_bf16 v[12:15], v[192:195], v[156:159], v[12:15]
    ds_read_b128 v[132:135], v224 offset:2048
    v_mfma_f32_16x16x32_bf16 v[76:79], v[208:211], v[156:159], v[76:79]
    ds_read_b128 v[136:139], v224 offset:4096
    v_mfma_f32_16x16x32_bf16 v[72:75], v[208:211], v[152:155], v[72:75]
    v_mfma_f32_16x16x32_bf16 v[68:71], v[208:211], v[148:151], v[68:71]
    ds_read_b128 v[140:143], v224 offset:6144
    v_mfma_f32_16x16x32_bf16 v[64:67], v[208:211], v[144:147], v[64:67]
    ds_read_b64_tr_b16 v[176:177], v229 offset:24576
    v_mfma_f32_16x16x32_bf16 v[16:19], v[196:199], v[144:147], v[16:19]
    ds_read_b64_tr_b16 v[178:179], v229 offset:28672
    v_mfma_f32_16x16x32_bf16 v[20:23], v[196:199], v[148:151], v[20:23]
    ds_read_b64_tr_b16 v[164:165], v230 offset:16384
    v_mfma_f32_16x16x32_bf16 v[24:27], v[196:199], v[152:155], v[24:27]
    ds_read_b64_tr_b16 v[166:167], v230 offset:20480
    v_mfma_f32_16x16x32_bf16 v[28:31], v[196:199], v[156:159], v[28:31]
    v_mfma_f32_16x16x32_bf16 v[92:95], v[212:215], v[156:159], v[92:95]
    ds_read_b64_tr_b16 v[180:181], v230 offset:24576
    v_mfma_f32_16x16x32_bf16 v[88:91], v[212:215], v[152:155], v[88:91]
    ds_read_b64_tr_b16 v[182:183], v230 offset:28672
    v_mfma_f32_16x16x32_bf16 v[84:87], v[212:215], v[148:151], v[84:87]
    ds_read_b64_tr_b16 v[168:169], v231 offset:16384
    v_mfma_f32_16x16x32_bf16 v[80:83], v[212:215], v[144:147], v[80:83]
    ds_read_b64_tr_b16 v[170:171], v231 offset:20480
    v_mfma_f32_16x16x32_bf16 v[32:35], v[200:203], v[144:147], v[32:35]
    ds_read_b64_tr_b16 v[184:185], v231 offset:24576
    v_mfma_f32_16x16x32_bf16 v[36:39], v[200:203], v[148:151], v[36:39]
    v_mfma_f32_16x16x32_bf16 v[40:43], v[200:203], v[152:155], v[40:43]
    ds_read_b64_tr_b16 v[186:187], v231 offset:28672
    v_mfma_f32_16x16x32_bf16 v[44:47], v[200:203], v[156:159], v[44:47]
    ds_read_b64_tr_b16 v[172:173], v232 offset:16384
    v_mfma_f32_16x16x32_bf16 v[108:111], v[216:219], v[156:159], v[108:111]
    ds_read_b64_tr_b16 v[174:175], v232 offset:20480
    v_mfma_f32_16x16x32_bf16 v[104:107], v[216:219], v[152:155], v[104:107]
    ds_read_b64_tr_b16 v[188:189], v232 offset:24576
    v_mfma_f32_16x16x32_bf16 v[100:103], v[216:219], v[148:151], v[100:103]
    ds_read_b64_tr_b16 v[190:191], v232 offset:28672
    v_mfma_f32_16x16x32_bf16 v[96:99], v[216:219], v[144:147], v[96:99]
    v_mfma_f32_16x16x32_bf16 v[48:51], v[204:207], v[144:147], v[48:51]
    v_mfma_f32_16x16x32_bf16 v[52:55], v[204:207], v[148:151], v[52:55]
    v_mfma_f32_16x16x32_bf16 v[56:59], v[204:207], v[152:155], v[56:59]
    v_mfma_f32_16x16x32_bf16 v[60:63], v[204:207], v[156:159], v[60:63]
    v_mfma_f32_16x16x32_bf16 v[124:127], v[220:223], v[156:159], v[124:127]
    v_mfma_f32_16x16x32_bf16 v[120:123], v[220:223], v[152:155], v[120:123]
    v_mfma_f32_16x16x32_bf16 v[116:119], v[220:223], v[148:151], v[116:119]
    v_mfma_f32_16x16x32_bf16 v[112:115], v[220:223], v[144:147], v[112:115]
    s_waitcnt lgkmcnt(0)
    s_barrier
    .p2align 3
    v_mfma_f32_16x16x32_bf16 v[0:3], v[160:163], v[128:131], v[0:3]
    ds_read_b64_tr_b16 v[192:193], v229 offset:32768
    v_mfma_f32_16x16x32_bf16 v[4:7], v[160:163], v[132:135], v[4:7]
    ds_read_b64_tr_b16 v[194:195], v229 offset:36864
    v_mfma_f32_16x16x32_bf16 v[8:11], v[160:163], v[136:139], v[8:11]
    ds_read_b128 v[144:147], v224 offset:1024
    v_mfma_f32_16x16x32_bf16 v[12:15], v[160:163], v[140:143], v[12:15]
    ds_read_b128 v[148:151], v224 offset:3072
    v_mfma_f32_16x16x32_bf16 v[76:79], v[176:179], v[140:143], v[76:79]
    ds_read_b128 v[152:155], v224 offset:5120
    v_mfma_f32_16x16x32_bf16 v[72:75], v[176:179], v[136:139], v[72:75]
    v_mfma_f32_16x16x32_bf16 v[68:71], v[176:179], v[132:135], v[68:71]
    ds_read_b128 v[156:159], v224 offset:7168
    v_mfma_f32_16x16x32_bf16 v[64:67], v[176:179], v[128:131], v[64:67]
    ds_read_b64_tr_b16 v[208:209], v229 offset:40960
    v_mfma_f32_16x16x32_bf16 v[16:19], v[164:167], v[128:131], v[16:19]
    ds_read_b64_tr_b16 v[210:211], v229 offset:45056
    v_mfma_f32_16x16x32_bf16 v[20:23], v[164:167], v[132:135], v[20:23]
    ds_read_b64_tr_b16 v[196:197], v230 offset:32768
    v_mfma_f32_16x16x32_bf16 v[24:27], v[164:167], v[136:139], v[24:27]
    ds_read_b64_tr_b16 v[198:199], v230 offset:36864
    v_mfma_f32_16x16x32_bf16 v[28:31], v[164:167], v[140:143], v[28:31]
    v_mfma_f32_16x16x32_bf16 v[92:95], v[180:183], v[140:143], v[92:95]
    ds_read_b64_tr_b16 v[212:213], v230 offset:40960
    v_mfma_f32_16x16x32_bf16 v[88:91], v[180:183], v[136:139], v[88:91]
    ds_read_b64_tr_b16 v[214:215], v230 offset:45056
    v_mfma_f32_16x16x32_bf16 v[84:87], v[180:183], v[132:135], v[84:87]
    ds_read_b64_tr_b16 v[200:201], v231 offset:32768
    v_mfma_f32_16x16x32_bf16 v[80:83], v[180:183], v[128:131], v[80:83]
    ds_read_b64_tr_b16 v[202:203], v231 offset:36864
    v_mfma_f32_16x16x32_bf16 v[32:35], v[168:171], v[128:131], v[32:35]
    ds_read_b64_tr_b16 v[216:217], v231 offset:40960
    v_mfma_f32_16x16x32_bf16 v[36:39], v[168:171], v[132:135], v[36:39]
    v_mfma_f32_16x16x32_bf16 v[40:43], v[168:171], v[136:139], v[40:43]
    ds_read_b64_tr_b16 v[218:219], v231 offset:45056
    v_mfma_f32_16x16x32_bf16 v[44:47], v[168:171], v[140:143], v[44:47]
    ds_read_b64_tr_b16 v[204:205], v232 offset:32768
    v_mfma_f32_16x16x32_bf16 v[108:111], v[184:187], v[140:143], v[108:111]
    ds_read_b64_tr_b16 v[206:207], v232 offset:36864
    v_mfma_f32_16x16x32_bf16 v[104:107], v[184:187], v[136:139], v[104:107]
    ds_read_b64_tr_b16 v[220:221], v232 offset:40960
    v_mfma_f32_16x16x32_bf16 v[100:103], v[184:187], v[132:135], v[100:103]
    ds_read_b64_tr_b16 v[222:223], v232 offset:45056
    v_mfma_f32_16x16x32_bf16 v[96:99], v[184:187], v[128:131], v[96:99]
    v_mfma_f32_16x16x32_bf16 v[48:51], v[172:175], v[128:131], v[48:51]
    v_mfma_f32_16x16x32_bf16 v[52:55], v[172:175], v[132:135], v[52:55]
    v_mfma_f32_16x16x32_bf16 v[56:59], v[172:175], v[136:139], v[56:59]
    v_mfma_f32_16x16x32_bf16 v[60:63], v[172:175], v[140:143], v[60:63]
    v_mfma_f32_16x16x32_bf16 v[124:127], v[188:191], v[140:143], v[124:127]
    s_sub_u32 s58, s58, 1
    s_cmp_lg_u32 s58, 0
    .p2align 3
    v_mfma_f32_16x16x32_bf16 v[120:123], v[188:191], v[136:139], v[120:123]
    v_mfma_f32_16x16x32_bf16 v[116:119], v[188:191], v[132:135], v[116:119]
    v_mfma_f32_16x16x32_bf16 v[112:115], v[188:191], v[128:131], v[112:115]
    s_cbranch_scc1 loop_24
    s_waitcnt lgkmcnt(0)
    s_barrier
    .p2align 3
    v_mfma_f32_16x16x32_bf16 v[0:3], v[192:195], v[144:147], v[0:3]
    v_mfma_f32_16x16x32_bf16 v[4:7], v[192:195], v[148:151], v[4:7]
    v_mfma_f32_16x16x32_bf16 v[8:11], v[192:195], v[152:155], v[8:11]
    v_mfma_f32_16x16x32_bf16 v[12:15], v[192:195], v[156:159], v[12:15]
    v_mfma_f32_16x16x32_bf16 v[76:79], v[208:211], v[156:159], v[76:79]
    v_mfma_f32_16x16x32_bf16 v[72:75], v[208:211], v[152:155], v[72:75]
    v_mfma_f32_16x16x32_bf16 v[68:71], v[208:211], v[148:151], v[68:71]
    v_mfma_f32_16x16x32_bf16 v[64:67], v[208:211], v[144:147], v[64:67]
    v_mfma_f32_16x16x32_bf16 v[16:19], v[196:199], v[144:147], v[16:19]
    v_mfma_f32_16x16x32_bf16 v[20:23], v[196:199], v[148:151], v[20:23]
    v_mfma_f32_16x16x32_bf16 v[24:27], v[196:199], v[152:155], v[24:27]
    v_mfma_f32_16x16x32_bf16 v[28:31], v[196:199], v[156:159], v[28:31]
    v_mfma_f32_16x16x32_bf16 v[92:95], v[212:215], v[156:159], v[92:95]
    v_mfma_f32_16x16x32_bf16 v[88:91], v[212:215], v[152:155], v[88:91]
    v_mfma_f32_16x16x32_bf16 v[84:87], v[212:215], v[148:151], v[84:87]
    v_mfma_f32_16x16x32_bf16 v[80:83], v[212:215], v[144:147], v[80:83]
    v_mfma_f32_16x16x32_bf16 v[32:35], v[200:203], v[144:147], v[32:35]
    v_mfma_f32_16x16x32_bf16 v[36:39], v[200:203], v[148:151], v[36:39]
    v_mfma_f32_16x16x32_bf16 v[40:43], v[200:203], v[152:155], v[40:43]
    v_mfma_f32_16x16x32_bf16 v[44:47], v[200:203], v[156:159], v[44:47]
    v_mfma_f32_16x16x32_bf16 v[108:111], v[216:219], v[156:159], v[108:111]
    v_mfma_f32_16x16x32_bf16 v[104:107], v[216:219], v[152:155], v[104:107]
    v_mfma_f32_16x16x32_bf16 v[100:103], v[216:219], v[148:151], v[100:103]
    v_mfma_f32_16x16x32_bf16 v[96:99], v[216:219], v[144:147], v[96:99]
    v_mfma_f32_16x16x32_bf16 v[48:51], v[204:207], v[144:147], v[48:51]
    v_mfma_f32_16x16x32_bf16 v[52:55], v[204:207], v[148:151], v[52:55]
    v_mfma_f32_16x16x32_bf16 v[56:59], v[204:207], v[152:155], v[56:59]
    v_mfma_f32_16x16x32_bf16 v[60:63], v[204:207], v[156:159], v[60:63]
    v_mfma_f32_16x16x32_bf16 v[124:127], v[220:223], v[156:159], v[124:127]
    v_mfma_f32_16x16x32_bf16 v[120:123], v[220:223], v[152:155], v[120:123]
    v_mfma_f32_16x16x32_bf16 v[116:119], v[220:223], v[148:151], v[116:119]
    v_mfma_f32_16x16x32_bf16 v[112:115], v[220:223], v[144:147], v[112:115]
    s_setprio 1
    v_add_u32 v191, s88, v254
    s_barrier
    s_add_u32 s93, s51, 0
    s_and_b32 s93, s93, 15
    s_lshl_b32 s93, s93, 12
    s_add_u32 m0, s61, 0
    s_mul_i32 s59, s93, 112
    buffer_load_dwordx4 v236, s[24:27], s59 offen lds
    s_nop 7
    s_lshl_b32 s55, s43, 9
    s_add_u32 s55, s55, 159744
    v_and_b32 v232, 0xf0, v254
    v_lshrrev_b32 v232, 1, v232
    v_add_u32 v232, s55, v232
    ds_read_b64 v[220:221], v232 offset:0
    ds_read_b64 v[222:223], v232 offset:128
    ds_read_b64 v[224:225], v232 offset:256
    ds_read_b64 v[226:227], v232 offset:384
    s_waitcnt lgkmcnt(0)
    v_sub_f32 v192, 0, v220
    buffer_load_dwordx4 v237, s[24:27], s59 offen offset:1024 lds
    v_mul_f32 v196, 0xbfb8aa3b, v221
    v_mul_f32 v200, v221, v221
    v_sub_f32 v193, 0, v222
    v_mul_f32 v197, 0xbfb8aa3b, v223
    v_mul_f32 v201, v223, v223
    v_sub_f32 v194, 0, v224
    v_mul_f32 v198, 0xbfb8aa3b, v225
    v_mul_f32 v202, v225, v225
    buffer_load_dwordx4 v242, s[4:7], s93 offen offset:2048 lds
    s_add_u32 s93, s93, 2048
    s_and_b32 s93, s93, 65535
    v_sub_f32 v195, 0, v226
    v_mul_f32 v199, 0xbfb8aa3b, v227
    v_mul_f32 v203, v227, v227
    v_rcp_f32 v200, v200
    v_rcp_f32 v201, v201
    v_rcp_f32 v202, v202
    v_rcp_f32 v203, v203
    s_nop 0
    s_barrier
    s_add_u32 m0, s62, 114688
    s_nop 0
    buffer_load_dwordx4 v191, s[4:7], s94 offen lds
    s_lshl_b32 s55, s44, 8
    s_add_u32 s55, s55, 161664
    v_lshrrev_b32 v235, 8, v254
    v_lshlrev_b32 v235, 4, v235
    v_add_u32 v235, s55, v235
    ds_read_b128 v[204:207], v235 offset:0
    ds_read_b128 v[208:211], v235 offset:512
    ds_read_b128 v[212:215], v235 offset:64
    buffer_load_dwordx4 v191, s[4:7], s94 offen offset:1024 lds
    ds_read_b128 v[216:219], v235 offset:576
    s_waitcnt lgkmcnt(0)
    v_fmac_f32 v0, v192, v204
    v_fmac_f32 v1, v192, v205
    v_fmac_f32 v2, v192, v206
    s_add_u32 m0, s61, 16384
    s_mul_i32 s59, s93, 112
    buffer_load_dwordx4 v236, s[24:27], s59 offen lds
    v_fmac_f32 v3, v192, v207
    v_mul_f32 v220, v196, v0
    v_mul_f32 v221, v196, v1
    v_mul_f32 v222, v196, v2
    buffer_load_dwordx4 v237, s[24:27], s59 offen offset:1024 lds
    v_mul_f32 v223, v196, v3
    v_fmac_f32 v64, v192, v208
    v_fmac_f32 v65, v192, v209
    v_fmac_f32 v66, v192, v210
    v_fmac_f32 v67, v192, v211
    buffer_load_dwordx4 v242, s[4:7], s93 offen offset:2048 lds
    s_add_u32 s93, s93, 6144
    s_and_b32 s93, s93, 65535
    v_exp_f32 v220, v220
    v_exp_f32 v221, v221
    v_exp_f32 v222, v222
    v_exp_f32 v223, v223
    v_mul_f32 v0, v0, v64
    s_barrier
    s_add_u32 m0, s62, 114688
    s_nop 0
    buffer_load_dwordx4 v191, s[4:7], s94 offen offset:2048 lds
    v_mul_f32 v1, v1, v65
    v_mul_f32 v2, v2, v66
    v_mul_f32 v3, v3, v67
    v_fma_f32 v220, v220, v200, v200
    buffer_load_dwordx4 v191, s[4:7], s94 offen offset:3072 lds
    s_add_u32 s94, s94, 32768
    s_and_b32 s94, s94, 262143
    v_fma_f32 v221, v221, v200, v200
    v_fma_f32 v222, v222, v200, v200
    v_fma_f32 v223, v223, v200, v200
    v_rcp_f32 v220, v220
    v_rcp_f32 v221, v221
    s_add_u32 m0, s61, 32768
    s_mul_i32 s59, s93, 112
    buffer_load_dwordx4 v236, s[24:27], s59 offen lds
    v_rcp_f32 v222, v222
    v_rcp_f32 v223, v223
    v_mul_f32 v0, v0, v220
    v_mul_f32 v1, v1, v221
    v_mul_f32 v2, v2, v222
    buffer_load_dwordx4 v237, s[24:27], s59 offen offset:1024 lds
    v_mul_f32 v3, v3, v223
    v_cvt_pk_bf16_f32 v224, v0, v1
    v_cvt_pk_bf16_f32 v225, v2, v3
    v_fmac_f32 v16, v192, v212
    v_fmac_f32 v17, v192, v213
    buffer_load_dwordx4 v242, s[4:7], s93 offen offset:2048 lds
    s_add_u32 s93, s93, 2048
    s_and_b32 s93, s93, 65535
    v_fmac_f32 v18, v192, v214
    v_fmac_f32 v19, v192, v215
    v_mul_f32 v220, v196, v16
    v_mul_f32 v221, v196, v17
    v_mul_f32 v222, v196, v18
    s_barrier
    s_add_u32 m0, s62, 131072
    s_nop 0
    buffer_load_dwordx4 v191, s[4:7], s94 offen lds
    v_mul_f32 v223, v196, v19
    v_fmac_f32 v80, v192, v216
    v_fmac_f32 v81, v192, v217
    v_fmac_f32 v82, v192, v218
    buffer_load_dwordx4 v191, s[4:7], s94 offen offset:1024 lds
    v_fmac_f32 v83, v192, v219
    v_exp_f32 v220, v220
    v_exp_f32 v221, v221
    v_exp_f32 v222, v222
    s_add_u32 m0, s61, 49152
    s_mul_i32 s59, s93, 112
    buffer_load_dwordx4 v236, s[24:27], s59 offen lds
    v_exp_f32 v223, v223
    v_mul_f32 v16, v16, v80
    v_mul_f32 v17, v17, v81
    v_mul_f32 v18, v18, v82
    buffer_load_dwordx4 v237, s[24:27], s59 offen offset:1024 lds
    v_mul_f32 v19, v19, v83
    v_fma_f32 v220, v220, v200, v200
    v_fma_f32 v221, v221, v200, v200
    v_fma_f32 v222, v222, v200, v200
    buffer_load_dwordx4 v242, s[4:7], s93 offen offset:2048 lds
    s_add_u32 s93, s93, 6144
    s_and_b32 s93, s93, 65535
    v_fma_f32 v223, v223, v200, v200
    v_rcp_f32 v220, v220
    v_rcp_f32 v221, v221
    v_rcp_f32 v222, v222
    s_barrier
    s_add_u32 m0, s62, 131072
    s_nop 0
    buffer_load_dwordx4 v191, s[4:7], s94 offen offset:2048 lds
    v_rcp_f32 v223, v223
    v_mul_f32 v16, v16, v220
    v_mul_f32 v17, v17, v221
    v_mul_f32 v18, v18, v222
    buffer_load_dwordx4 v191, s[4:7], s94 offen offset:3072 lds
    s_add_u32 s94, s94, 32768
    s_and_b32 s94, s94, 262143
    v_mul_f32 v19, v19, v223
    v_cvt_pk_bf16_f32 v226, v16, v17
    v_cvt_pk_bf16_f32 v227, v18, v19
    s_add_u32 s55, s89, 0
    buffer_store_dwordx4 v[224:227], v254, s[4:7], s55 offen sc0 sc1
    s_add_u32 m0, s61, 65536
    s_mul_i32 s59, s93, 112
    buffer_load_dwordx4 v236, s[24:27], s59 offen lds
    v_fmac_f32 v4, v193, v204
    v_fmac_f32 v5, v193, v205
    v_fmac_f32 v6, v193, v206
    v_fmac_f32 v7, v193, v207
    v_mul_f32 v220, v197, v4
    buffer_load_dwordx4 v237, s[24:27], s59 offen offset:1024 lds
    v_mul_f32 v221, v197, v5
    v_mul_f32 v222, v197, v6
    v_mul_f32 v223, v197, v7
    v_fmac_f32 v68, v193, v208
    buffer_load_dwordx4 v242, s[4:7], s93 offen offset:2048 lds
    s_add_u32 s93, s93, 2048
    s_and_b32 s93, s93, 65535
    v_fmac_f32 v69, v193, v209
    v_fmac_f32 v70, v193, v210
    v_fmac_f32 v71, v193, v211
    v_exp_f32 v220, v220
    v_exp_f32 v221, v221
    s_waitcnt vmcnt(14)
    s_barrier
    s_add_u32 m0, s62, 98304
    s_nop 0
    buffer_load_dwordx4 v191, s[4:7], s94 offen lds
    v_exp_f32 v222, v222
    v_exp_f32 v223, v223
    v_mul_f32 v4, v4, v68
    v_mul_f32 v5, v5, v69
    buffer_load_dwordx4 v191, s[4:7], s94 offen offset:1024 lds
    v_mul_f32 v6, v6, v70
    v_mul_f32 v7, v7, v71
    v_fma_f32 v220, v220, v201, v201
    v_fma_f32 v221, v221, v201, v201
    s_add_u32 m0, s61, 81920
    s_mul_i32 s59, s93, 112
    buffer_load_dwordx4 v236, s[24:27], s59 offen lds
    v_fma_f32 v222, v222, v201, v201
    v_fma_f32 v223, v223, v201, v201
    v_rcp_f32 v220, v220
    v_rcp_f32 v221, v221
    v_rcp_f32 v222, v222
    buffer_load_dwordx4 v237, s[24:27], s59 offen offset:1024 lds
    v_rcp_f32 v223, v223
    v_mul_f32 v4, v4, v220
    v_mul_f32 v5, v5, v221
    v_mul_f32 v6, v6, v222
    buffer_load_dwordx4 v242, s[4:7], s93 offen offset:2048 lds
    s_add_u32 s93, s93, 6144
    s_and_b32 s93, s93, 65535
    v_mul_f32 v7, v7, v223
    v_cvt_pk_bf16_f32 v228, v4, v5
    v_cvt_pk_bf16_f32 v229, v6, v7
    v_fmac_f32 v20, v193, v212
    v_fmac_f32 v21, v193, v213
    s_barrier
    s_add_u32 m0, s62, 98304
    s_nop 0
    buffer_load_dwordx4 v191, s[4:7], s94 offen offset:2048 lds
    v_fmac_f32 v22, v193, v214
    v_fmac_f32 v23, v193, v215
    v_mul_f32 v220, v197, v20
    v_mul_f32 v221, v197, v21
    buffer_load_dwordx4 v191, s[4:7], s94 offen offset:3072 lds
    s_add_u32 s94, s94, 32768
    s_and_b32 s94, s94, 262143
    v_mul_f32 v222, v197, v22
    v_mul_f32 v223, v197, v23
    v_fmac_f32 v84, v193, v216
    v_fmac_f32 v85, v193, v217
    v_fmac_f32 v86, v193, v218
    s_add_u32 m0, s61, 0
    s_mul_i32 s59, s93, 112
    buffer_load_dwordx4 v236, s[24:27], s59 offen lds
    v_fmac_f32 v87, v193, v219
    v_exp_f32 v220, v220
    v_exp_f32 v221, v221
    v_exp_f32 v222, v222
    buffer_load_dwordx4 v237, s[24:27], s59 offen offset:1024 lds
    v_exp_f32 v223, v223
    v_mul_f32 v20, v20, v84
    v_mul_f32 v21, v21, v85
    v_mul_f32 v22, v22, v86
    v_mul_f32 v23, v23, v87
    buffer_load_dwordx4 v242, s[4:7], s93 offen offset:2048 lds
    s_add_u32 s93, s93, 2048
    s_and_b32 s93, s93, 65535
    v_fma_f32 v220, v220, v201, v201
    v_fma_f32 v221, v221, v201, v201
    v_fma_f32 v222, v222, v201, v201
    v_fma_f32 v223, v223, v201, v201
    v_rcp_f32 v220, v220
    s_waitcnt vmcnt(14)
    s_barrier
    s_add_u32 m0, s62, 114688
    s_nop 0
    buffer_load_dwordx4 v191, s[4:7], s94 offen lds
    v_rcp_f32 v221, v221
    v_rcp_f32 v222, v222
    v_rcp_f32 v223, v223
    v_mul_f32 v20, v20, v220
    buffer_load_dwordx4 v191, s[4:7], s94 offen offset:1024 lds
    v_mul_f32 v21, v21, v221
    v_mul_f32 v22, v22, v222
    v_mul_f32 v23, v23, v223
    v_cvt_pk_bf16_f32 v230, v20, v21
    s_add_u32 m0, s61, 16384
    s_mul_i32 s59, s93, 112
    buffer_load_dwordx4 v236, s[24:27], s59 offen lds
    v_cvt_pk_bf16_f32 v231, v22, v23
    s_add_u32 s55, s89, 2048
    buffer_store_dwordx4 v[228:231], v254, s[4:7], s55 offen sc0 sc1
    v_fmac_f32 v8, v194, v204
    v_fmac_f32 v9, v194, v205
    v_fmac_f32 v10, v194, v206
    buffer_load_dwordx4 v237, s[24:27], s59 offen offset:1024 lds
    v_fmac_f32 v11, v194, v207
    v_mul_f32 v220, v198, v8
    v_mul_f32 v221, v198, v9
    v_mul_f32 v222, v198, v10
    buffer_load_dwordx4 v242, s[4:7], s93 offen offset:2048 lds
    s_add_u32 s93, s93, 6144
    s_and_b32 s93, s93, 65535
    v_mul_f32 v223, v198, v11
    v_fmac_f32 v72, v194, v208
    v_fmac_f32 v73, v194, v209
    v_fmac_f32 v74, v194, v210
    v_fmac_f32 v75, v194, v211
    s_barrier
    s_add_u32 m0, s62, 114688
    s_nop 0
    buffer_load_dwordx4 v191, s[4:7], s94 offen offset:2048 lds
    v_exp_f32 v220, v220
    v_exp_f32 v221, v221
    v_exp_f32 v222, v222
    v_exp_f32 v223, v223
    buffer_load_dwordx4 v191, s[4:7], s94 offen offset:3072 lds
    s_add_u32 s94, s94, 32768
    s_and_b32 s94, s94, 262143
    v_mul_f32 v8, v8, v72
    v_mul_f32 v9, v9, v73
    v_mul_f32 v10, v10, v74
    v_mul_f32 v11, v11, v75
    s_add_u32 m0, s61, 32768
    s_mul_i32 s59, s93, 112
    buffer_load_dwordx4 v236, s[24:27], s59 offen lds
    v_fma_f32 v220, v220, v202, v202
    v_fma_f32 v221, v221, v202, v202
    v_fma_f32 v222, v222, v202, v202
    v_fma_f32 v223, v223, v202, v202
    buffer_load_dwordx4 v237, s[24:27], s59 offen offset:1024 lds
    v_rcp_f32 v220, v220
    v_rcp_f32 v221, v221
    v_rcp_f32 v222, v222
    v_rcp_f32 v223, v223
    buffer_load_dwordx4 v242, s[4:7], s93 offen offset:2048 lds
    s_add_u32 s93, s93, 2048
    s_and_b32 s93, s93, 65535
    v_mul_f32 v8, v8, v220
    v_mul_f32 v9, v9, v221
    v_mul_f32 v10, v10, v222
    v_mul_f32 v11, v11, v223
    s_waitcnt vmcnt(14)
    s_barrier
    s_add_u32 m0, s62, 131072
    s_nop 0
    buffer_load_dwordx4 v191, s[4:7], s94 offen lds
    v_cvt_pk_bf16_f32 v224, v8, v9
    v_cvt_pk_bf16_f32 v225, v10, v11
    v_fmac_f32 v24, v194, v212
    v_fmac_f32 v25, v194, v213
    buffer_load_dwordx4 v191, s[4:7], s94 offen offset:1024 lds
    v_fmac_f32 v26, v194, v214
    v_fmac_f32 v27, v194, v215
    v_mul_f32 v220, v198, v24
    v_mul_f32 v221, v198, v25
    v_mul_f32 v222, v198, v26
    s_add_u32 m0, s61, 49152
    s_mul_i32 s59, s93, 112
    buffer_load_dwordx4 v236, s[24:27], s59 offen lds
    v_mul_f32 v223, v198, v27
    v_fmac_f32 v88, v194, v216
    v_fmac_f32 v89, v194, v217
    v_fmac_f32 v90, v194, v218
    v_fmac_f32 v91, v194, v219
    buffer_load_dwordx4 v237, s[24:27], s59 offen offset:1024 lds
    v_exp_f32 v220, v220
    v_exp_f32 v221, v221
    v_exp_f32 v222, v222
    v_exp_f32 v223, v223
    v_mul_f32 v24, v24, v88
    buffer_load_dwordx4 v242, s[4:7], s93 offen offset:2048 lds
    s_add_u32 s93, s93, 6144
    s_and_b32 s93, s93, 65535
    v_mul_f32 v25, v25, v89
    v_mul_f32 v26, v26, v90
    v_mul_f32 v27, v27, v91
    v_fma_f32 v220, v220, v202, v202
    v_fma_f32 v221, v221, v202, v202
    s_barrier
    s_add_u32 m0, s62, 131072
    s_nop 0
    buffer_load_dwordx4 v191, s[4:7], s94 offen offset:2048 lds
    v_fma_f32 v222, v222, v202, v202
    v_fma_f32 v223, v223, v202, v202
    v_rcp_f32 v220, v220
    v_rcp_f32 v221, v221
    buffer_load_dwordx4 v191, s[4:7], s94 offen offset:3072 lds
    s_add_u32 s94, s94, 32768
    s_and_b32 s94, s94, 262143
    v_rcp_f32 v222, v222
    v_rcp_f32 v223, v223
    v_mul_f32 v24, v24, v220
    v_mul_f32 v25, v25, v221
    s_add_u32 m0, s61, 65536
    s_mul_i32 s59, s93, 112
    buffer_load_dwordx4 v236, s[24:27], s59 offen lds
    v_mul_f32 v26, v26, v222
    v_mul_f32 v27, v27, v223
    v_cvt_pk_bf16_f32 v226, v24, v25
    v_cvt_pk_bf16_f32 v227, v26, v27
    buffer_load_dwordx4 v237, s[24:27], s59 offen offset:1024 lds
    s_add_u32 s55, s89, 4096
    buffer_store_dwordx4 v[224:227], v254, s[4:7], s55 offen sc0 sc1
    v_fmac_f32 v12, v195, v204
    v_fmac_f32 v13, v195, v205
    v_fmac_f32 v14, v195, v206
    buffer_load_dwordx4 v242, s[4:7], s93 offen offset:2048 lds
    s_add_u32 s93, s93, 2048
    s_and_b32 s93, s93, 65535
    v_fmac_f32 v15, v195, v207
    v_mul_f32 v220, v199, v12
    v_mul_f32 v221, v199, v13
    v_mul_f32 v222, v199, v14
    v_mul_f32 v223, v199, v15
    s_waitcnt vmcnt(14)
    s_barrier
    s_add_u32 m0, s62, 98304
    s_nop 0
    buffer_load_dwordx4 v191, s[4:7], s94 offen lds
    v_fmac_f32 v76, v195, v208
    v_fmac_f32 v77, v195, v209
    v_fmac_f32 v78, v195, v210
    v_fmac_f32 v79, v195, v211
    buffer_load_dwordx4 v191, s[4:7], s94 offen offset:1024 lds
    v_exp_f32 v220, v220
    v_exp_f32 v221, v221
    v_exp_f32 v222, v222
    v_exp_f32 v223, v223
    s_add_u32 m0, s61, 81920
    s_mul_i32 s59, s93, 112
    buffer_load_dwordx4 v236, s[24:27], s59 offen lds
    v_mul_f32 v12, v12, v76
    v_mul_f32 v13, v13, v77
    v_mul_f32 v14, v14, v78
    v_mul_f32 v15, v15, v79
    buffer_load_dwordx4 v237, s[24:27], s59 offen offset:1024 lds
    v_fma_f32 v220, v220, v203, v203
    v_fma_f32 v221, v221, v203, v203
    v_fma_f32 v222, v222, v203, v203
    v_fma_f32 v223, v223, v203, v203
    buffer_load_dwordx4 v242, s[4:7], s93 offen offset:2048 lds
    s_add_u32 s93, s93, 6144
    s_and_b32 s93, s93, 65535
    v_rcp_f32 v220, v220
    v_rcp_f32 v221, v221
    v_rcp_f32 v222, v222
    v_rcp_f32 v223, v223
    s_barrier
    s_add_u32 m0, s62, 98304
    s_nop 0
    buffer_load_dwordx4 v191, s[4:7], s94 offen offset:2048 lds
    v_mul_f32 v12, v12, v220
    v_mul_f32 v13, v13, v221
    v_mul_f32 v14, v14, v222
    v_mul_f32 v15, v15, v223
    buffer_load_dwordx4 v191, s[4:7], s94 offen offset:3072 lds
    s_add_u32 s94, s94, 32768
    s_and_b32 s94, s94, 262143
    v_cvt_pk_bf16_f32 v228, v12, v13
    v_cvt_pk_bf16_f32 v229, v14, v15
    v_fmac_f32 v28, v195, v212
    v_fmac_f32 v29, v195, v213
    v_fmac_f32 v30, v195, v214
    s_add_u32 m0, s61, 0
    s_mul_i32 s59, s93, 112
    buffer_load_dwordx4 v236, s[24:27], s59 offen lds
    v_fmac_f32 v31, v195, v215
    v_mul_f32 v220, v199, v28
    v_mul_f32 v221, v199, v29
    v_mul_f32 v222, v199, v30
    v_mul_f32 v223, v199, v31
    buffer_load_dwordx4 v237, s[24:27], s59 offen offset:1024 lds
    v_fmac_f32 v92, v195, v216
    v_fmac_f32 v93, v195, v217
    v_fmac_f32 v94, v195, v218
    v_fmac_f32 v95, v195, v219
    v_exp_f32 v220, v220
    buffer_load_dwordx4 v242, s[4:7], s93 offen offset:2048 lds
    s_add_u32 s93, s93, 2048
    s_and_b32 s93, s93, 65535
    v_exp_f32 v221, v221
    v_exp_f32 v222, v222
    v_exp_f32 v223, v223
    v_mul_f32 v28, v28, v92
    v_mul_f32 v29, v29, v93
    s_waitcnt vmcnt(14)
    s_barrier
    s_add_u32 m0, s62, 114688
    s_nop 0
    buffer_load_dwordx4 v191, s[4:7], s94 offen lds
    v_mul_f32 v30, v30, v94
    v_mul_f32 v31, v31, v95
    v_fma_f32 v220, v220, v203, v203
    buffer_load_dwordx4 v191, s[4:7], s94 offen offset:1024 lds
    v_fma_f32 v221, v221, v203, v203
    v_fma_f32 v222, v222, v203, v203
    v_fma_f32 v223, v223, v203, v203
    s_add_u32 m0, s61, 16384
    s_mul_i32 s59, s93, 112
    buffer_load_dwordx4 v236, s[24:27], s59 offen lds
    v_rcp_f32 v220, v220
    v_rcp_f32 v221, v221
    v_rcp_f32 v222, v222
    v_rcp_f32 v223, v223
    buffer_load_dwordx4 v237, s[24:27], s59 offen offset:1024 lds
    v_mul_f32 v28, v28, v220
    v_mul_f32 v29, v29, v221
    v_mul_f32 v30, v30, v222
    buffer_load_dwordx4 v242, s[4:7], s93 offen offset:2048 lds
    s_add_u32 s93, s93, 6144
    s_and_b32 s93, s93, 65535
    v_mul_f32 v31, v31, v223
    v_cvt_pk_bf16_f32 v230, v28, v29
    v_cvt_pk_bf16_f32 v231, v30, v31
    s_add_u32 s55, s89, 6144
    buffer_store_dwordx4 v[228:231], v254, s[4:7], s55 offen sc0 sc1
    s_barrier
    s_add_u32 m0, s62, 114688
    s_nop 0
    buffer_load_dwordx4 v191, s[4:7], s94 offen offset:2048 lds
    ds_read_b128 v[204:207], v235 offset:128
    ds_read_b128 v[208:211], v235 offset:640
    ds_read_b128 v[212:215], v235 offset:192
    ds_read_b128 v[216:219], v235 offset:704
    s_waitcnt lgkmcnt(0)
    buffer_load_dwordx4 v191, s[4:7], s94 offen offset:3072 lds
    s_add_u32 s94, s94, 32768
    s_and_b32 s94, s94, 262143
    v_fmac_f32 v32, v192, v204
    v_fmac_f32 v33, v192, v205
    v_fmac_f32 v34, v192, v206
    v_fmac_f32 v35, v192, v207
    v_mul_f32 v220, v196, v32
    s_add_u32 m0, s61, 32768
    s_mul_i32 s59, s93, 112
    buffer_load_dwordx4 v236, s[24:27], s59 offen lds
    v_mul_f32 v221, v196, v33
    v_mul_f32 v222, v196, v34
    v_mul_f32 v223, v196, v35
    v_fmac_f32 v96, v192, v208
    v_fmac_f32 v97, v192, v209
    buffer_load_dwordx4 v237, s[24:27], s59 offen offset:1024 lds
    v_fmac_f32 v98, v192, v210
    v_fmac_f32 v99, v192, v211
    v_exp_f32 v220, v220
    v_exp_f32 v221, v221
    v_exp_f32 v222, v222
    buffer_load_dwordx4 v242, s[4:7], s93 offen offset:2048 lds
    s_add_u32 s93, s93, 2048
    s_and_b32 s93, s93, 65535
    v_exp_f32 v223, v223
    v_mul_f32 v32, v32, v96
    v_mul_f32 v33, v33, v97
    v_mul_f32 v34, v34, v98
    v_mul_f32 v35, v35, v99
    v_fma_f32 v220, v220, v200, v200
    s_waitcnt vmcnt(14)
    s_barrier
    s_add_u32 m0, s62, 131072
    s_nop 0
    buffer_load_dwordx4 v191, s[4:7], s94 offen lds
    v_fma_f32 v221, v221, v200, v200
    v_fma_f32 v222, v222, v200, v200
    v_fma_f32 v223, v223, v200, v200
    v_rcp_f32 v220, v220
    buffer_load_dwordx4 v191, s[4:7], s94 offen offset:1024 lds
    v_rcp_f32 v221, v221
    v_rcp_f32 v222, v222
    v_rcp_f32 v223, v223
    v_mul_f32 v32, v32, v220
    v_mul_f32 v33, v33, v221
    s_add_u32 m0, s61, 49152
    s_mul_i32 s59, s93, 112
    buffer_load_dwordx4 v236, s[24:27], s59 offen lds
    v_mul_f32 v34, v34, v222
    v_mul_f32 v35, v35, v223
    v_cvt_pk_bf16_f32 v224, v32, v33
    v_cvt_pk_bf16_f32 v225, v34, v35
    v_fmac_f32 v48, v192, v212
    buffer_load_dwordx4 v237, s[24:27], s59 offen offset:1024 lds
    v_fmac_f32 v49, v192, v213
    v_fmac_f32 v50, v192, v214
    v_fmac_f32 v51, v192, v215
    v_mul_f32 v220, v196, v48
    v_mul_f32 v221, v196, v49
    buffer_load_dwordx4 v242, s[4:7], s93 offen offset:2048 lds
    s_add_u32 s93, s93, 10240
    s_and_b32 s93, s93, 65535
    v_mul_f32 v222, v196, v50
    v_mul_f32 v223, v196, v51
    v_fmac_f32 v112, v192, v216
    v_fmac_f32 v113, v192, v217
    v_fmac_f32 v114, v192, v218
    s_barrier
    s_add_u32 m0, s62, 131072
    s_nop 0
    buffer_load_dwordx4 v191, s[4:7], s94 offen offset:2048 lds
    v_fmac_f32 v115, v192, v219
    v_exp_f32 v220, v220
    v_exp_f32 v221, v221
    v_exp_f32 v222, v222
    buffer_load_dwordx4 v191, s[4:7], s94 offen offset:3072 lds
    s_add_u32 s94, s94, 49152
    s_and_b32 s94, s94, 262143
    v_exp_f32 v223, v223
    v_mul_f32 v48, v48, v112
    v_mul_f32 v49, v49, v113
    v_mul_f32 v50, v50, v114
    s_add_u32 m0, s61, 65536
    s_mul_i32 s59, s93, 112
    buffer_load_dwordx4 v236, s[24:27], s59 offen lds
    v_mul_f32 v51, v51, v115
    v_fma_f32 v220, v220, v200, v200
    v_fma_f32 v221, v221, v200, v200
    v_fma_f32 v222, v222, v200, v200
    buffer_load_dwordx4 v237, s[24:27], s59 offen offset:1024 lds
    v_fma_f32 v223, v223, v200, v200
    v_rcp_f32 v220, v220
    v_rcp_f32 v221, v221
    v_rcp_f32 v222, v222
    buffer_load_dwordx4 v242, s[4:7], s93 offen offset:2048 lds
    s_add_u32 s93, s93, 2048
    s_and_b32 s93, s93, 65535
    v_rcp_f32 v223, v223
    v_mul_f32 v48, v48, v220
    v_mul_f32 v49, v49, v221
    v_mul_f32 v50, v50, v222
    s_waitcnt vmcnt(13)
    s_barrier
    s_cmp_lg_u32 s42, 0
    s_cbranch_scc1 wf_25
    s_lshr_b32 s55, s2, 5
    s_lshl_b32 s55, s55, 2
    s_add_u32 s55, s55, s0
    v_mov_b32 v252, 2048
    v_mov_b32 v253, 0x01010101
    s_mov_b64 exec, 1
    s_cmp_eq_u32 s45, 0
    s_cbranch_scc1 st_26
    buffer_store_dword v253, v252, s[4:7], s55 offen sc0 sc1
    s_branch st_27
st_26:
    buffer_store_dword v253, v252, s[4:7], s55 offen
st_27:
    s_mov_b64 exec, -1
wf_25:
    s_add_u32 m0, s62, 98304
    s_nop 0
    buffer_load_dwordx4 v191, s[4:7], s94 offen lds
    v_mul_f32 v51, v51, v223
    v_cvt_pk_bf16_f32 v226, v48, v49
    v_cvt_pk_bf16_f32 v227, v50, v51
    s_add_u32 s55, s89, 131072
    buffer_store_dwordx4 v[224:227], v254, s[4:7], s55 offen sc0 sc1
    buffer_load_dwordx4 v191, s[4:7], s94 offen offset:1024 lds
    v_fmac_f32 v36, v193, v204
    v_fmac_f32 v37, v193, v205
    v_fmac_f32 v38, v193, v206
    v_fmac_f32 v39, v193, v207
    s_add_u32 m0, s61, 81920
    s_mul_i32 s59, s93, 112
    buffer_load_dwordx4 v236, s[24:27], s59 offen lds
    v_mul_f32 v220, v197, v36
    v_mul_f32 v221, v197, v37
    v_mul_f32 v222, v197, v38
    v_mul_f32 v223, v197, v39
    buffer_load_dwordx4 v237, s[24:27], s59 offen offset:1024 lds
    v_fmac_f32 v100, v193, v208
    v_fmac_f32 v101, v193, v209
    v_fmac_f32 v102, v193, v210
    v_fmac_f32 v103, v193, v211
    buffer_load_dwordx4 v242, s[4:7], s93 offen offset:2048 lds
    s_add_u32 s93, s93, 6144
    s_and_b32 s93, s93, 65535
    v_exp_f32 v220, v220
    v_exp_f32 v221, v221
    v_exp_f32 v222, v222
    v_exp_f32 v223, v223
    v_mul_f32 v36, v36, v100
    s_barrier
    s_add_u32 m0, s62, 98304
    s_nop 0
    buffer_load_dwordx4 v191, s[4:7], s94 offen offset:2048 lds
    v_mul_f32 v37, v37, v101
    v_mul_f32 v38, v38, v102
    v_mul_f32 v39, v39, v103
    v_fma_f32 v220, v220, v201, v201
    buffer_load_dwordx4 v191, s[4:7], s94 offen offset:3072 lds
    s_add_u32 s94, s94, 32768
    s_and_b32 s94, s94, 262143
    v_fma_f32 v221, v221, v201, v201
    v_fma_f32 v222, v222, v201, v201
    v_fma_f32 v223, v223, v201, v201
    v_rcp_f32 v220, v220
    v_rcp_f32 v221, v221
    s_add_u32 m0, s61, 0
    s_mul_i32 s59, s93, 112
    buffer_load_dwordx4 v236, s[24:27], s59 offen lds
    v_rcp_f32 v222, v222
    v_rcp_f32 v223, v223
    v_mul_f32 v36, v36, v220
    v_mul_f32 v37, v37, v221
    v_mul_f32 v38, v38, v222
    buffer_load_dwordx4 v237, s[24:27], s59 offen offset:1024 lds
    v_mul_f32 v39, v39, v223
    v_cvt_pk_bf16_f32 v228, v36, v37
    v_cvt_pk_bf16_f32 v229, v38, v39
    v_fmac_f32 v52, v193, v212
    v_fmac_f32 v53, v193, v213
    buffer_load_dwordx4 v242, s[4:7], s93 offen offset:2048 lds
    s_add_u32 s93, s93, 2048
    s_and_b32 s93, s93, 65535
    v_fmac_f32 v54, v193, v214
    v_fmac_f32 v55, v193, v215
    v_mul_f32 v220, v197, v52
    v_mul_f32 v221, v197, v53
    v_mul_f32 v222, v197, v54
    s_waitcnt vmcnt(14)
    s_barrier
    s_add_u32 m0, s62, 114688
    s_nop 0
    buffer_load_dwordx4 v191, s[4:7], s94 offen lds
    v_mul_f32 v223, v197, v55
    v_fmac_f32 v116, v193, v216
    v_fmac_f32 v117, v193, v217
    v_fmac_f32 v118, v193, v218
    buffer_load_dwordx4 v191, s[4:7], s94 offen offset:1024 lds
    v_fmac_f32 v119, v193, v219
    v_exp_f32 v220, v220
    v_exp_f32 v221, v221
    v_exp_f32 v222, v222
    s_add_u32 m0, s61, 16384
    s_mul_i32 s59, s93, 112
    buffer_load_dwordx4 v236, s[24:27], s59 offen lds
    v_exp_f32 v223, v223
    v_mul_f32 v52, v52, v116
    v_mul_f32 v53, v53, v117
    v_mul_f32 v54, v54, v118
    buffer_load_dwordx4 v237, s[24:27], s59 offen offset:1024 lds
    v_mul_f32 v55, v55, v119
    v_fma_f32 v220, v220, v201, v201
    v_fma_f32 v221, v221, v201, v201
    v_fma_f32 v222, v222, v201, v201
    buffer_load_dwordx4 v242, s[4:7], s93 offen offset:2048 lds
    s_add_u32 s93, s93, 6144
    s_and_b32 s93, s93, 65535
    v_fma_f32 v223, v223, v201, v201
    v_rcp_f32 v220, v220
    v_rcp_f32 v221, v221
    v_rcp_f32 v222, v222
    s_barrier
    s_add_u32 m0, s62, 114688
    s_nop 0
    buffer_load_dwordx4 v191, s[4:7], s94 offen offset:2048 lds
    v_rcp_f32 v223, v223
    v_mul_f32 v52, v52, v220
    v_mul_f32 v53, v53, v221
    v_mul_f32 v54, v54, v222
    buffer_load_dwordx4 v191, s[4:7], s94 offen offset:3072 lds
    s_add_u32 s94, s94, 32768
    s_and_b32 s94, s94, 262143
    v_mul_f32 v55, v55, v223
    v_cvt_pk_bf16_f32 v230, v52, v53
    v_cvt_pk_bf16_f32 v231, v54, v55
    s_add_u32 s55, s89, 133120
    buffer_store_dwordx4 v[228:231], v254, s[4:7], s55 offen sc0 sc1
    s_add_u32 m0, s61, 32768
    s_mul_i32 s59, s93, 112
    buffer_load_dwordx4 v236, s[24:27], s59 offen lds
    v_fmac_f32 v40, v194, v204
    v_fmac_f32 v41, v194, v205
    v_fmac_f32 v42, v194, v206
    v_fmac_f32 v43, v194, v207
    v_mul_f32 v220, v198, v40
    buffer_load_dwordx4 v237, s[24:27], s59 offen offset:1024 lds
    v_mul_f32 v221, v198, v41
    v_mul_f32 v222, v198, v42
    v_mul_f32 v223, v198, v43
    v_fmac_f32 v104, v194, v208
    buffer_load_dwordx4 v242, s[4:7], s93 offen offset:2048 lds
    s_add_u32 s93, s93, 2048
    s_and_b32 s93, s93, 65535
    v_fmac_f32 v105, v194, v209
    v_fmac_f32 v106, v194, v210
    v_fmac_f32 v107, v194, v211
    v_exp_f32 v220, v220
    v_exp_f32 v221, v221
    s_waitcnt vmcnt(14)
    s_barrier
    s_add_u32 m0, s62, 131072
    s_nop 0
    buffer_load_dwordx4 v191, s[4:7], s94 offen lds
    v_exp_f32 v222, v222
    v_exp_f32 v223, v223
    v_mul_f32 v40, v40, v104
    v_mul_f32 v41, v41, v105
    buffer_load_dwordx4 v191, s[4:7], s94 offen offset:1024 lds
    v_mul_f32 v42, v42, v106
    v_mul_f32 v43, v43, v107
    v_fma_f32 v220, v220, v202, v202
    v_fma_f32 v221, v221, v202, v202
    s_add_u32 m0, s61, 49152
    s_mul_i32 s59, s93, 112
    buffer_load_dwordx4 v236, s[24:27], s59 offen lds
    v_fma_f32 v222, v222, v202, v202
    v_fma_f32 v223, v223, v202, v202
    v_rcp_f32 v220, v220
    v_rcp_f32 v221, v221
    v_rcp_f32 v222, v222
    buffer_load_dwordx4 v237, s[24:27], s59 offen offset:1024 lds
    v_rcp_f32 v223, v223
    v_mul_f32 v40, v40, v220
    v_mul_f32 v41, v41, v221
    v_mul_f32 v42, v42, v222
    buffer_load_dwordx4 v242, s[4:7], s93 offen offset:2048 lds
    s_add_u32 s93, s93, 6144
    s_and_b32 s93, s93, 65535
    v_mul_f32 v43, v43, v223
    v_cvt_pk_bf16_f32 v224, v40, v41
    v_cvt_pk_bf16_f32 v225, v42, v43
    v_fmac_f32 v56, v194, v212
    v_fmac_f32 v57, v194, v213
    s_barrier
    s_add_u32 m0, s62, 131072
    s_nop 0
    buffer_load_dwordx4 v191, s[4:7], s94 offen offset:2048 lds
    v_fmac_f32 v58, v194, v214
    v_fmac_f32 v59, v194, v215
    v_mul_f32 v220, v198, v56
    v_mul_f32 v221, v198, v57
    buffer_load_dwordx4 v191, s[4:7], s94 offen offset:3072 lds
    s_add_u32 s94, s94, 32768
    s_and_b32 s94, s94, 262143
    v_mul_f32 v222, v198, v58
    v_mul_f32 v223, v198, v59
    v_fmac_f32 v120, v194, v216
    v_fmac_f32 v121, v194, v217
    v_fmac_f32 v122, v194, v218
    s_add_u32 m0, s61, 65536
    s_mul_i32 s59, s93, 112
    buffer_load_dwordx4 v236, s[24:27], s59 offen lds
    v_fmac_f32 v123, v194, v219
    v_exp_f32 v220, v220
    v_exp_f32 v221, v221
    v_exp_f32 v222, v222
    buffer_load_dwordx4 v237, s[24:27], s59 offen offset:1024 lds
    v_exp_f32 v223, v223
    v_mul_f32 v56, v56, v120
    v_mul_f32 v57, v57, v121
    v_mul_f32 v58, v58, v122
    v_mul_f32 v59, v59, v123
    buffer_load_dwordx4 v242, s[4:7], s93 offen offset:2048 lds
    s_add_u32 s93, s93, 2048
    s_and_b32 s93, s93, 65535
    v_fma_f32 v220, v220, v202, v202
    v_fma_f32 v221, v221, v202, v202
    v_fma_f32 v222, v222, v202, v202
    v_fma_f32 v223, v223, v202, v202
    v_rcp_f32 v220, v220
    s_waitcnt vmcnt(14)
    s_barrier
    s_add_u32 m0, s62, 98304
    s_nop 0
    buffer_load_dwordx4 v191, s[4:7], s94 offen lds
    v_rcp_f32 v221, v221
    v_rcp_f32 v222, v222
    v_rcp_f32 v223, v223
    v_mul_f32 v56, v56, v220
    buffer_load_dwordx4 v191, s[4:7], s94 offen offset:1024 lds
    v_mul_f32 v57, v57, v221
    v_mul_f32 v58, v58, v222
    v_mul_f32 v59, v59, v223
    v_cvt_pk_bf16_f32 v226, v56, v57
    s_add_u32 m0, s61, 81920
    s_mul_i32 s59, s93, 112
    buffer_load_dwordx4 v236, s[24:27], s59 offen lds
    v_cvt_pk_bf16_f32 v227, v58, v59
    s_add_u32 s55, s89, 135168
    buffer_store_dwordx4 v[224:227], v254, s[4:7], s55 offen sc0 sc1
    v_fmac_f32 v44, v195, v204
    v_fmac_f32 v45, v195, v205
    v_fmac_f32 v46, v195, v206
    buffer_load_dwordx4 v237, s[24:27], s59 offen offset:1024 lds
    v_fmac_f32 v47, v195, v207
    v_mul_f32 v220, v199, v44
    v_mul_f32 v221, v199, v45
    v_mul_f32 v222, v199, v46
    buffer_load_dwordx4 v242, s[4:7], s93 offen offset:2048 lds
    s_add_u32 s93, s93, 6144
    s_and_b32 s93, s93, 65535
    v_mul_f32 v223, v199, v47
    v_fmac_f32 v108, v195, v208
    v_fmac_f32 v109, v195, v209
    v_fmac_f32 v110, v195, v210
    v_fmac_f32 v111, v195, v211
    s_barrier
    s_add_u32 m0, s62, 98304
    s_nop 0
    buffer_load_dwordx4 v191, s[4:7], s94 offen offset:2048 lds
    v_exp_f32 v220, v220
    v_exp_f32 v221, v221
    v_exp_f32 v222, v222
    v_exp_f32 v223, v223
    buffer_load_dwordx4 v191, s[4:7], s94 offen offset:3072 lds
    s_add_u32 s94, s94, 32768
    s_and_b32 s94, s94, 262143
    v_mul_f32 v44, v44, v108
    v_mul_f32 v45, v45, v109
    v_mul_f32 v46, v46, v110
    v_mul_f32 v47, v47, v111
    s_add_u32 m0, s61, 0
    s_mul_i32 s59, s93, 112
    buffer_load_dwordx4 v236, s[24:27], s59 offen lds
    v_fma_f32 v220, v220, v203, v203
    v_fma_f32 v221, v221, v203, v203
    v_fma_f32 v222, v222, v203, v203
    v_fma_f32 v223, v223, v203, v203
    buffer_load_dwordx4 v237, s[24:27], s59 offen offset:1024 lds
    v_rcp_f32 v220, v220
    v_rcp_f32 v221, v221
    v_rcp_f32 v222, v222
    v_rcp_f32 v223, v223
    buffer_load_dwordx4 v242, s[4:7], s93 offen offset:2048 lds
    s_add_u32 s93, s93, 2048
    s_and_b32 s93, s93, 65535
    v_mul_f32 v44, v44, v220
    v_mul_f32 v45, v45, v221
    v_mul_f32 v46, v46, v222
    v_mul_f32 v47, v47, v223
    s_waitcnt vmcnt(14)
    s_barrier
    v_lshrrev_b32 v252, 2, v254
    v_min_u32 v252, 28, v252
    s_add_u32 s55, s0, 2048
    buffer_load_dword v232, v252, s[4:7], s55 offen sc0 sc1
    s_add_u32 m0, s62, 114688
    s_nop 0
    buffer_load_dwordx4 v191, s[4:7], s94 offen lds
    v_cvt_pk_bf16_f32 v228, v44, v45
    v_cvt_pk_bf16_f32 v229, v46, v47
    v_fmac_f32 v60, v195, v212
    v_fmac_f32 v61, v195, v213
    buffer_load_dwordx4 v191, s[4:7], s94 offen offset:1024 lds
    v_fmac_f32 v62, v195, v214
    v_fmac_f32 v63, v195, v215
    v_mul_f32 v220, v199, v60
    v_mul_f32 v221, v199, v61
    v_mul_f32 v222, v199, v62
    s_add_u32 m0, s61, 16384
    s_mul_i32 s59, s93, 112
    buffer_load_dwordx4 v236, s[24:27], s59 offen lds
    v_mul_f32 v223, v199, v63
    v_fmac_f32 v124, v195, v216
    v_fmac_f32 v125, v195, v217
    v_fmac_f32 v126, v195, v218
    v_fmac_f32 v127, v195, v219
    buffer_load_dwordx4 v237, s[24:27], s59 offen offset:1024 lds
    v_exp_f32 v220, v220
    v_exp_f32 v221, v221
    v_exp_f32 v222, v222
    v_exp_f32 v223, v223
    v_mul_f32 v60, v60, v124
    buffer_load_dwordx4 v242, s[4:7], s93 offen offset:2048 lds
    v_mul_f32 v61, v61, v125
    v_mul_f32 v62, v62, v126
    v_mul_f32 v63, v63, v127
    v_fma_f32 v220, v220, v203, v203
    v_fma_f32 v221, v221, v203, v203
    s_barrier
    s_add_u32 m0, s62, 114688
    s_nop 0
    buffer_load_dwordx4 v191, s[4:7], s94 offen offset:2048 lds
    v_fma_f32 v222, v222, v203, v203
    v_fma_f32 v223, v223, v203, v203
    buffer_load_dwordx4 v191, s[4:7], s94 offen offset:3072 lds
    v_rcp_f32 v220, v220
    v_rcp_f32 v221, v221
    s_add_u32 m0, s62, 32768
    s_add_u32 s59, s68, 0
    buffer_load_dwordx4 v238, s[20:23], s59 offen lds
    v_rcp_f32 v222, v222
    v_rcp_f32 v223, v223
    buffer_load_dwordx4 v239, s[20:23], s59 offen offset:1024 lds
    v_mul_f32 v60, v60, v220
    v_mul_f32 v61, v61, v221
    buffer_load_dwordx4 v240, s[20:23], s59 offen offset:2048 lds
    v_mul_f32 v62, v62, v222
    v_mul_f32 v63, v63, v223
    buffer_load_dwordx4 v241, s[20:23], s59 offen offset:3072 lds
    v_cvt_pk_bf16_f32 v230, v60, v61
    v_cvt_pk_bf16_f32 v231, v62, v63
    s_add_u32 s55, s89, 137216
    buffer_store_dwordx4 v[228:231], v254, s[4:7], s55 offen sc0 sc1
    s_waitcnt vmcnt(16)
    s_barrier
    s_waitcnt vmcnt(12)
    v_cmp_ne_u32 vcc, 0x01010101, v232
    s_cbranch_vccz ap_28
    v_lshrrev_b32 v252, 2, v254
    v_min_u32 v252, 28, v252
    s_add_u32 s55, s0, 2048
    s_mov_b32 s56, 262144
poll_29:
    buffer_load_dword v253, v252, s[4:7], s55 offen sc0 sc1
    s_waitcnt vmcnt(0)
    v_cmp_ne_u32 vcc, 0x01010101, v253
    s_cbranch_vccz pd_30
    s_sleep 1
    s_sub_u32 s56, s56, 1
    s_cmp_lg_u32 s56, 0
    s_cbranch_scc1 poll_29
pd_30:
ap_28:
    s_add_u32 s88, s95, s62
    v_add_u32 v191, s88, v254
    s_add_u32 m0, s62, 131072
    s_mov_b32 s92, 0
    buffer_load_dwordx4 v191, s[4:7], s92 offen lds
    buffer_load_dwordx4 v191, s[4:7], s92 offen offset:1024 lds
    s_add_u32 m0, s62, 49152
    s_add_u32 s59, s68, 655360
    buffer_load_dwordx4 v238, s[20:23], s59 offen lds
    buffer_load_dwordx4 v239, s[20:23], s59 offen offset:1024 lds
    buffer_load_dwordx4 v240, s[20:23], s59 offen offset:2048 lds
    buffer_load_dwordx4 v241, s[20:23], s59 offen offset:3072 lds
    s_barrier
    s_add_u32 m0, s62, 131072
    s_mov_b32 s92, 0
    buffer_load_dwordx4 v191, s[4:7], s92 offen offset:2048 lds
    buffer_load_dwordx4 v191, s[4:7], s92 offen offset:3072 lds
    s_add_u32 m0, s62, 65536
    s_add_u32 s59, s68, 917504
    buffer_load_dwordx4 v238, s[20:23], s59 offen lds
    buffer_load_dwordx4 v239, s[20:23], s59 offen offset:1024 lds
    buffer_load_dwordx4 v240, s[20:23], s59 offen offset:2048 lds
    buffer_load_dwordx4 v241, s[20:23], s59 offen offset:3072 lds
    s_waitcnt vmcnt(17)
    s_barrier
    s_add_u32 m0, s62, 98304
    s_mov_b32 s92, 16384
    buffer_load_dwordx4 v191, s[4:7], s92 offen lds
    buffer_load_dwordx4 v191, s[4:7], s92 offen offset:1024 lds
    s_add_u32 m0, s62, 81920
    s_add_u32 s59, s68, 1572864
    buffer_load_dwordx4 v238, s[20:23], s59 offen lds
    buffer_load_dwordx4 v239, s[20:23], s59 offen offset:1024 lds
    buffer_load_dwordx4 v240, s[20:23], s59 offen offset:2048 lds
    buffer_load_dwordx4 v241, s[20:23], s59 offen offset:3072 lds
    s_waitcnt vmcnt(18)
    s_barrier
    s_cmp_lg_u32 s42, 1
    s_cbranch_scc1 wf_31
    s_lshr_b32 s55, s2, 5
    s_lshl_b32 s55, s55, 2
    s_add_u32 s55, s55, s0
    v_mov_b32 v252, 2080
    v_mov_b32 v253, 0x01010101
    s_mov_b64 exec, 1
    s_cmp_eq_u32 s45, 0
    s_cbranch_scc1 st_32
    buffer_store_dword v253, v252, s[4:7], s55 offen sc0 sc1
    s_branch st_33
st_32:
    buffer_store_dword v253, v252, s[4:7], s55 offen
st_33:
    s_mov_b64 exec, -1
wf_31:
    s_add_u32 m0, s62, 98304
    s_mov_b32 s92, 16384
    buffer_load_dwordx4 v191, s[4:7], s92 offen offset:2048 lds
    buffer_load_dwordx4 v191, s[4:7], s92 offen offset:3072 lds
    s_add_u32 m0, s62, 0
    s_add_u32 s59, s68, 1835008
    buffer_load_dwordx4 v238, s[20:23], s59 offen lds
    buffer_load_dwordx4 v239, s[20:23], s59 offen offset:1024 lds
    buffer_load_dwordx4 v240, s[20:23], s59 offen offset:2048 lds
    buffer_load_dwordx4 v241, s[20:23], s59 offen offset:3072 lds
    s_waitcnt vmcnt(16)
    s_barrier
    ds_read_b64_tr_b16 v[32:33], v244 offset:32768
    ds_read_b64_tr_b16 v[34:35], v244 offset:36864
    ds_read_b128 v[0:3], v243 offset:32768
    ds_read_b128 v[4:7], v243 offset:34816
    ds_read_b128 v[8:11], v243 offset:36864
    ds_read_b128 v[12:15], v243 offset:38912
    ds_read_b64_tr_b16 v[36:37], v245 offset:32768
    ds_read_b64_tr_b16 v[38:39], v245 offset:36864
    ds_read_b64_tr_b16 v[40:41], v246 offset:32768
    ds_read_b64_tr_b16 v[42:43], v246 offset:36864
    ds_read_b64_tr_b16 v[44:45], v247 offset:32768
    ds_read_b64_tr_b16 v[46:47], v247 offset:36864
    ds_read_b64_tr_b16 v[48:49], v244 offset:40960
    ds_read_b64_tr_b16 v[50:51], v244 offset:45056
    ds_read_b128 v[16:19], v243 offset:33792
    ds_read_b128 v[20:23], v243 offset:35840
    ds_read_b128 v[24:27], v243 offset:37888
    ds_read_b128 v[28:31], v243 offset:39936
    ds_read_b64_tr_b16 v[52:53], v245 offset:40960
    ds_read_b64_tr_b16 v[54:55], v245 offset:45056
    ds_read_b64_tr_b16 v[56:57], v246 offset:40960
    ds_read_b64_tr_b16 v[58:59], v246 offset:45056
    ds_read_b64_tr_b16 v[60:61], v247 offset:40960
    ds_read_b64_tr_b16 v[62:63], v247 offset:45056
    s_add_u32 m0, s62, 114688
    s_mov_b32 s92, 32768
    buffer_load_dwordx4 v191, s[4:7], s92 offen lds
    buffer_load_dwordx4 v191, s[4:7], s92 offen offset:1024 lds
    buffer_load_dwordx4 v191, s[4:7], s92 offen offset:2048 lds
    buffer_load_dwordx4 v191, s[4:7], s92 offen offset:3072 lds
    s_setprio 0
    s_lshl_b32 s55, s51, 14
    s_add_u32 s55, s55, s62
    s_add_u32 s55, s55, s47
    s_add_u32 s88, s55, 1310720
    s_xor_b32 s89, s88, 16384
    s_add_u32 s59, s1, s49
    s_add_u32 s60, s59, 4096
    s_mov_b32 s58, 4
    s_waitcnt vmcnt(8) lgkmcnt(0)
    s_barrier
    .p2align 3
    v_mfma_f32_16x16x32_bf16 v[128:131], v[32:35], v[0:3], 0
    ds_read_b64_tr_b16 v[96:97], v248 offset:0
    v_mfma_f32_16x16x32_bf16 v[128:131], v[48:51], v[16:19], v[128:131]
    ds_read_b64_tr_b16 v[98:99], v248 offset:4096
    v_mfma_f32_16x16x32_bf16 v[132:135], v[48:51], v[20:23], 0
    ds_read_b128 v[64:67], v243 offset:0
    v_mfma_f32_16x16x32_bf16 v[132:135], v[32:35], v[4:7], v[132:135]
    ds_read_b128 v[68:71], v243 offset:2048
    v_mfma_f32_16x16x32_bf16 v[136:139], v[32:35], v[8:11], 0
    ds_read_b128 v[72:75], v243 offset:4096
    v_mfma_f32_16x16x32_bf16 v[136:139], v[48:51], v[24:27], v[136:139]
    ds_read_b128 v[76:79], v243 offset:6144
    v_mfma_f32_16x16x32_bf16 v[140:143], v[48:51], v[28:31], 0
    ds_read_b64_tr_b16 v[100:101], v249 offset:0
    v_mfma_f32_16x16x32_bf16 v[140:143], v[32:35], v[12:15], v[140:143]
    ds_read_b64_tr_b16 v[102:103], v249 offset:4096
    v_mfma_f32_16x16x32_bf16 v[156:159], v[36:39], v[12:15], 0
    v_mfma_f32_16x16x32_bf16 v[156:159], v[52:55], v[28:31], v[156:159]
    ds_read_b64_tr_b16 v[104:105], v250 offset:0
    v_mfma_f32_16x16x32_bf16 v[152:155], v[52:55], v[24:27], 0
    ds_read_b64_tr_b16 v[106:107], v250 offset:4096
    v_mfma_f32_16x16x32_bf16 v[152:155], v[36:39], v[8:11], v[152:155]
    ds_read_b64_tr_b16 v[108:109], v251 offset:0
    v_mfma_f32_16x16x32_bf16 v[148:151], v[36:39], v[4:7], 0
    ds_read_b64_tr_b16 v[110:111], v251 offset:4096
    v_mfma_f32_16x16x32_bf16 v[148:151], v[52:55], v[20:23], v[148:151]
    ds_read_b64_tr_b16 v[112:113], v248 offset:8192
    v_mfma_f32_16x16x32_bf16 v[144:147], v[52:55], v[16:19], 0
    ds_read_b64_tr_b16 v[114:115], v248 offset:12288
    v_mfma_f32_16x16x32_bf16 v[144:147], v[36:39], v[0:3], v[144:147]
    ds_read_b128 v[80:83], v243 offset:1024
    v_mfma_f32_16x16x32_bf16 v[160:163], v[40:43], v[0:3], 0
    ds_read_b128 v[84:87], v243 offset:3072
    v_mfma_f32_16x16x32_bf16 v[160:163], v[56:59], v[16:19], v[160:163]
    v_mfma_f32_16x16x32_bf16 v[164:167], v[56:59], v[20:23], 0
    ds_read_b128 v[88:91], v243 offset:5120
    v_mfma_f32_16x16x32_bf16 v[164:167], v[40:43], v[4:7], v[164:167]
    ds_read_b128 v[92:95], v243 offset:7168
    v_mfma_f32_16x16x32_bf16 v[168:171], v[40:43], v[8:11], 0
    ds_read_b64_tr_b16 v[116:117], v249 offset:8192
    v_mfma_f32_16x16x32_bf16 v[168:171], v[56:59], v[24:27], v[168:171]
    ds_read_b64_tr_b16 v[118:119], v249 offset:12288
    v_mfma_f32_16x16x32_bf16 v[172:175], v[56:59], v[28:31], 0
    ds_read_b64_tr_b16 v[120:121], v250 offset:8192
    v_mfma_f32_16x16x32_bf16 v[172:175], v[40:43], v[12:15], v[172:175]
    ds_read_b64_tr_b16 v[122:123], v250 offset:12288
    v_mfma_f32_16x16x32_bf16 v[188:191], v[44:47], v[12:15], 0
    ds_read_b64_tr_b16 v[124:125], v251 offset:8192
    v_mfma_f32_16x16x32_bf16 v[188:191], v[60:63], v[28:31], v[188:191]
    ds_read_b64_tr_b16 v[126:127], v251 offset:12288
    v_mfma_f32_16x16x32_bf16 v[184:187], v[60:63], v[24:27], 0
    v_mfma_f32_16x16x32_bf16 v[184:187], v[44:47], v[8:11], v[184:187]
    v_mfma_f32_16x16x32_bf16 v[180:183], v[44:47], v[4:7], 0
    v_mfma_f32_16x16x32_bf16 v[180:183], v[60:63], v[20:23], v[180:183]
    v_mfma_f32_16x16x32_bf16 v[176:179], v[60:63], v[16:19], 0
    v_mfma_f32_16x16x32_bf16 v[176:179], v[44:47], v[0:3], v[176:179]
    .p2align 3
loop_34:
    s_waitcnt vmcnt(0) lgkmcnt(0)
    s_barrier
    .p2align 3
    v_mfma_f32_16x16x32_bf16 v[128:131], v[96:99], v[64:67], v[128:131]
    ds_read_b64_tr_b16 v[32:33], v248 offset:16384
    v_mfma_f32_16x16x32_bf16 v[128:131], v[112:115], v[80:83], v[128:131]
    ds_read_b64_tr_b16 v[34:35], v248 offset:20480
    v_mfma_f32_16x16x32_bf16 v[132:135], v[112:115], v[84:87], v[132:135]
    ds_read_b128 v[0:3], v243 offset:16384
    v_mfma_f32_16x16x32_bf16 v[132:135], v[96:99], v[68:71], v[132:135]
    ds_read_b128 v[4:7], v243 offset:18432
    v_mfma_f32_16x16x32_bf16 v[136:139], v[96:99], v[72:75], v[136:139]
    ds_read_b128 v[8:11], v243 offset:20480
    v_mfma_f32_16x16x32_bf16 v[136:139], v[112:115], v[88:91], v[136:139]
    ds_read_b128 v[12:15], v243 offset:22528
    v_mfma_f32_16x16x32_bf16 v[140:143], v[112:115], v[92:95], v[140:143]
    ds_read_b64_tr_b16 v[36:37], v249 offset:16384
    v_mfma_f32_16x16x32_bf16 v[140:143], v[96:99], v[76:79], v[140:143]
    ds_read_b64_tr_b16 v[38:39], v249 offset:20480
    v_mfma_f32_16x16x32_bf16 v[156:159], v[100:103], v[76:79], v[156:159]
    v_mfma_f32_16x16x32_bf16 v[156:159], v[116:119], v[92:95], v[156:159]
    ds_read_b64_tr_b16 v[40:41], v250 offset:16384
    v_mfma_f32_16x16x32_bf16 v[152:155], v[116:119], v[88:91], v[152:155]
    ds_read_b64_tr_b16 v[42:43], v250 offset:20480
    v_mfma_f32_16x16x32_bf16 v[152:155], v[100:103], v[72:75], v[152:155]
    ds_read_b64_tr_b16 v[44:45], v251 offset:16384
    v_mfma_f32_16x16x32_bf16 v[148:151], v[100:103], v[68:71], v[148:151]
    ds_read_b64_tr_b16 v[46:47], v251 offset:20480
    v_mfma_f32_16x16x32_bf16 v[148:151], v[116:119], v[84:87], v[148:151]
    ds_read_b64_tr_b16 v[48:49], v248 offset:24576
    v_mfma_f32_16x16x32_bf16 v[144:147], v[116:119], v[80:83], v[144:147]
    ds_read_b64_tr_b16 v[50:51], v248 offset:28672
    v_mfma_f32_16x16x32_bf16 v[144:147], v[100:103], v[64:67], v[144:147]
    ds_read_b128 v[16:19], v243 offset:17408
    v_mfma_f32_16x16x32_bf16 v[160:163], v[104:107], v[64:67], v[160:163]
    ds_read_b128 v[20:23], v243 offset:19456
    v_mfma_f32_16x16x32_bf16 v[160:163], v[120:123], v[80:83], v[160:163]
    v_mfma_f32_16x16x32_bf16 v[164:167], v[120:123], v[84:87], v[164:167]
    ds_read_b128 v[24:27], v243 offset:21504
    v_mfma_f32_16x16x32_bf16 v[164:167], v[104:107], v[68:71], v[164:167]
    ds_read_b128 v[28:31], v243 offset:23552
    v_mfma_f32_16x16x32_bf16 v[168:171], v[104:107], v[72:75], v[168:171]
    ds_read_b64_tr_b16 v[52:53], v249 offset:24576
    v_mfma_f32_16x16x32_bf16 v[168:171], v[120:123], v[88:91], v[168:171]
    ds_read_b64_tr_b16 v[54:55], v249 offset:28672
    v_mfma_f32_16x16x32_bf16 v[172:175], v[120:123], v[92:95], v[172:175]
    ds_read_b64_tr_b16 v[56:57], v250 offset:24576
    v_mfma_f32_16x16x32_bf16 v[172:175], v[104:107], v[76:79], v[172:175]
    ds_read_b64_tr_b16 v[58:59], v250 offset:28672
    v_mfma_f32_16x16x32_bf16 v[188:191], v[108:111], v[76:79], v[188:191]
    ds_read_b64_tr_b16 v[60:61], v251 offset:24576
    v_mfma_f32_16x16x32_bf16 v[188:191], v[124:127], v[92:95], v[188:191]
    ds_read_b64_tr_b16 v[62:63], v251 offset:28672
    v_mfma_f32_16x16x32_bf16 v[184:187], v[124:127], v[88:91], v[184:187]
    v_mfma_f32_16x16x32_bf16 v[184:187], v[108:111], v[72:75], v[184:187]
    v_mfma_f32_16x16x32_bf16 v[180:183], v[108:111], v[68:71], v[180:183]
    v_mfma_f32_16x16x32_bf16 v[180:183], v[124:127], v[84:87], v[180:183]
    v_mfma_f32_16x16x32_bf16 v[176:179], v[124:127], v[80:83], v[176:179]
    v_mfma_f32_16x16x32_bf16 v[176:179], v[108:111], v[64:67], v[176:179]
    s_waitcnt lgkmcnt(0)
    s_barrier
    .p2align 3
    v_mfma_f32_16x16x32_bf16 v[128:131], v[32:35], v[0:3], v[128:131]
    ds_read_b64_tr_b16 v[96:97], v248 offset:32768
    v_mfma_f32_16x16x32_bf16 v[128:131], v[48:51], v[16:19], v[128:131]
    ds_read_b64_tr_b16 v[98:99], v248 offset:36864
    v_mfma_f32_16x16x32_bf16 v[132:135], v[48:51], v[20:23], v[132:135]
    ds_read_b128 v[64:67], v243 offset:32768
    v_mfma_f32_16x16x32_bf16 v[132:135], v[32:35], v[4:7], v[132:135]
    ds_read_b128 v[68:71], v243 offset:34816
    v_mfma_f32_16x16x32_bf16 v[136:139], v[32:35], v[8:11], v[136:139]
    ds_read_b128 v[72:75], v243 offset:36864
    v_mfma_f32_16x16x32_bf16 v[136:139], v[48:51], v[24:27], v[136:139]
    ds_read_b128 v[76:79], v243 offset:38912
    v_mfma_f32_16x16x32_bf16 v[140:143], v[48:51], v[28:31], v[140:143]
    ds_read_b64_tr_b16 v[100:101], v249 offset:32768
    v_mfma_f32_16x16x32_bf16 v[140:143], v[32:35], v[12:15], v[140:143]
    ds_read_b64_tr_b16 v[102:103], v249 offset:36864
    v_mfma_f32_16x16x32_bf16 v[156:159], v[36:39], v[12:15], v[156:159]
    v_mfma_f32_16x16x32_bf16 v[156:159], v[52:55], v[28:31], v[156:159]
    ds_read_b64_tr_b16 v[104:105], v250 offset:32768
    v_mfma_f32_16x16x32_bf16 v[152:155], v[52:55], v[24:27], v[152:155]
    ds_read_b64_tr_b16 v[106:107], v250 offset:36864
    v_mfma_f32_16x16x32_bf16 v[152:155], v[36:39], v[8:11], v[152:155]
    ds_read_b64_tr_b16 v[108:109], v251 offset:32768
    v_mfma_f32_16x16x32_bf16 v[148:151], v[36:39], v[4:7], v[148:151]
    ds_read_b64_tr_b16 v[110:111], v251 offset:36864
    v_mfma_f32_16x16x32_bf16 v[148:151], v[52:55], v[20:23], v[148:151]
    ds_read_b64_tr_b16 v[112:113], v248 offset:40960
    v_mfma_f32_16x16x32_bf16 v[144:147], v[52:55], v[16:19], v[144:147]
    ds_read_b64_tr_b16 v[114:115], v248 offset:45056
    v_mfma_f32_16x16x32_bf16 v[144:147], v[36:39], v[0:3], v[144:147]
    ds_read_b128 v[80:83], v243 offset:33792
    v_mfma_f32_16x16x32_bf16 v[160:163], v[40:43], v[0:3], v[160:163]
    ds_read_b128 v[84:87], v243 offset:35840
    v_mfma_f32_16x16x32_bf16 v[160:163], v[56:59], v[16:19], v[160:163]
    v_mfma_f32_16x16x32_bf16 v[164:167], v[56:59], v[20:23], v[164:167]
    ds_read_b128 v[88:91], v243 offset:37888
    v_mfma_f32_16x16x32_bf16 v[164:167], v[40:43], v[4:7], v[164:167]
    ds_read_b128 v[92:95], v243 offset:39936
    v_mfma_f32_16x16x32_bf16 v[168:171], v[40:43], v[8:11], v[168:171]
    ds_read_b64_tr_b16 v[116:117], v249 offset:40960
    v_mfma_f32_16x16x32_bf16 v[168:171], v[56:59], v[24:27], v[168:171]
    ds_read_b64_tr_b16 v[118:119], v249 offset:45056
    v_mfma_f32_16x16x32_bf16 v[172:175], v[56:59], v[28:31], v[172:175]
    ds_read_b64_tr_b16 v[120:121], v250 offset:40960
    v_mfma_f32_16x16x32_bf16 v[172:175], v[40:43], v[12:15], v[172:175]
    ds_read_b64_tr_b16 v[122:123], v250 offset:45056
    v_mfma_f32_16x16x32_bf16 v[188:191], v[44:47], v[12:15], v[188:191]
    ds_read_b64_tr_b16 v[124:125], v251 offset:40960
    v_mfma_f32_16x16x32_bf16 v[188:191], v[60:63], v[28:31], v[188:191]
    ds_read_b64_tr_b16 v[126:127], v251 offset:45056
    v_mfma_f32_16x16x32_bf16 v[184:187], v[60:63], v[24:27], v[184:187]
    v_mfma_f32_16x16x32_bf16 v[184:187], v[44:47], v[8:11], v[184:187]
    v_mfma_f32_16x16x32_bf16 v[180:183], v[44:47], v[4:7], v[180:183]
    v_mfma_f32_16x16x32_bf16 v[180:183], v[60:63], v[20:23], v[180:183]
    v_mfma_f32_16x16x32_bf16 v[176:179], v[60:63], v[16:19], v[176:179]
    v_mfma_f32_16x16x32_bf16 v[176:179], v[44:47], v[0:3], v[176:179]
    s_waitcnt lgkmcnt(0)
    s_barrier
    .p2align 3
    v_mfma_f32_16x16x32_bf16 v[128:131], v[96:99], v[64:67], v[128:131]
    ds_read_b64_tr_b16 v[32:33], v244 offset:0
    v_mfma_f32_16x16x32_bf16 v[128:131], v[112:115], v[80:83], v[128:131]
    ds_read_b64_tr_b16 v[34:35], v244 offset:4096
    v_mfma_f32_16x16x32_bf16 v[132:135], v[112:115], v[84:87], v[132:135]
    ds_read_b128 v[0:3], v243 offset:0
    v_mfma_f32_16x16x32_bf16 v[132:135], v[96:99], v[68:71], v[132:135]
    ds_read_b128 v[4:7], v243 offset:2048
    v_mfma_f32_16x16x32_bf16 v[136:139], v[96:99], v[72:75], v[136:139]
    ds_read_b128 v[8:11], v243 offset:4096
    v_mfma_f32_16x16x32_bf16 v[136:139], v[112:115], v[88:91], v[136:139]
    ds_read_b128 v[12:15], v243 offset:6144
    v_mfma_f32_16x16x32_bf16 v[140:143], v[112:115], v[92:95], v[140:143]
    ds_read_b64_tr_b16 v[36:37], v245 offset:0
    v_mfma_f32_16x16x32_bf16 v[140:143], v[96:99], v[76:79], v[140:143]
    ds_read_b64_tr_b16 v[38:39], v245 offset:4096
    v_mfma_f32_16x16x32_bf16 v[156:159], v[100:103], v[76:79], v[156:159]
    v_mfma_f32_16x16x32_bf16 v[156:159], v[116:119], v[92:95], v[156:159]
    ds_read_b64_tr_b16 v[40:41], v246 offset:0
    v_mfma_f32_16x16x32_bf16 v[152:155], v[116:119], v[88:91], v[152:155]
    ds_read_b64_tr_b16 v[42:43], v246 offset:4096
    v_mfma_f32_16x16x32_bf16 v[152:155], v[100:103], v[72:75], v[152:155]
    ds_read_b64_tr_b16 v[44:45], v247 offset:0
    v_mfma_f32_16x16x32_bf16 v[148:151], v[100:103], v[68:71], v[148:151]
    ds_read_b64_tr_b16 v[46:47], v247 offset:4096
    v_mfma_f32_16x16x32_bf16 v[148:151], v[116:119], v[84:87], v[148:151]
    ds_read_b64_tr_b16 v[48:49], v244 offset:8192
    v_mfma_f32_16x16x32_bf16 v[144:147], v[116:119], v[80:83], v[144:147]
    ds_read_b64_tr_b16 v[50:51], v244 offset:12288
    v_mfma_f32_16x16x32_bf16 v[144:147], v[100:103], v[64:67], v[144:147]
    ds_read_b128 v[16:19], v243 offset:1024
    v_mfma_f32_16x16x32_bf16 v[160:163], v[104:107], v[64:67], v[160:163]
    ds_read_b128 v[20:23], v243 offset:3072
    v_mfma_f32_16x16x32_bf16 v[160:163], v[120:123], v[80:83], v[160:163]
    v_mfma_f32_16x16x32_bf16 v[164:167], v[120:123], v[84:87], v[164:167]
    ds_read_b128 v[24:27], v243 offset:5120
    v_mfma_f32_16x16x32_bf16 v[164:167], v[104:107], v[68:71], v[164:167]
    ds_read_b128 v[28:31], v243 offset:7168
    v_mfma_f32_16x16x32_bf16 v[168:171], v[104:107], v[72:75], v[168:171]
    ds_read_b64_tr_b16 v[52:53], v245 offset:8192
    v_mfma_f32_16x16x32_bf16 v[168:171], v[120:123], v[88:91], v[168:171]
    ds_read_b64_tr_b16 v[54:55], v245 offset:12288
    v_mfma_f32_16x16x32_bf16 v[172:175], v[120:123], v[92:95], v[172:175]
    ds_read_b64_tr_b16 v[56:57], v246 offset:8192
    v_mfma_f32_16x16x32_bf16 v[172:175], v[104:107], v[76:79], v[172:175]
    ds_read_b64_tr_b16 v[58:59], v246 offset:12288
    v_mfma_f32_16x16x32_bf16 v[188:191], v[108:111], v[76:79], v[188:191]
    ds_read_b64_tr_b16 v[60:61], v247 offset:8192
    v_mfma_f32_16x16x32_bf16 v[188:191], v[124:127], v[92:95], v[188:191]
    ds_read_b64_tr_b16 v[62:63], v247 offset:12288
    v_mfma_f32_16x16x32_bf16 v[184:187], v[124:127], v[88:91], v[184:187]
    v_mfma_f32_16x16x32_bf16 v[184:187], v[108:111], v[72:75], v[184:187]
    v_mfma_f32_16x16x32_bf16 v[180:183], v[108:111], v[68:71], v[180:183]
    v_mfma_f32_16x16x32_bf16 v[180:183], v[124:127], v[84:87], v[180:183]
    v_mfma_f32_16x16x32_bf16 v[176:179], v[124:127], v[80:83], v[176:179]
    v_mfma_f32_16x16x32_bf16 v[176:179], v[108:111], v[64:67], v[176:179]
    s_waitcnt lgkmcnt(0)
    s_barrier
    .p2align 3
    v_mfma_f32_16x16x32_bf16 v[128:131], v[32:35], v[0:3], v[128:131]
    ds_read_b64_tr_b16 v[96:97], v244 offset:16384
    v_mfma_f32_16x16x32_bf16 v[128:131], v[48:51], v[16:19], v[128:131]
    ds_read_b64_tr_b16 v[98:99], v244 offset:20480
    v_mfma_f32_16x16x32_bf16 v[132:135], v[48:51], v[20:23], v[132:135]
    ds_read_b128 v[64:67], v243 offset:16384
    v_mfma_f32_16x16x32_bf16 v[132:135], v[32:35], v[4:7], v[132:135]
    ds_read_b128 v[68:71], v243 offset:18432
    v_mfma_f32_16x16x32_bf16 v[136:139], v[32:35], v[8:11], v[136:139]
    ds_read_b128 v[72:75], v243 offset:20480
    v_mfma_f32_16x16x32_bf16 v[136:139], v[48:51], v[24:27], v[136:139]
    ds_read_b128 v[76:79], v243 offset:22528
    v_mfma_f32_16x16x32_bf16 v[140:143], v[48:51], v[28:31], v[140:143]
    ds_read_b64_tr_b16 v[100:101], v245 offset:16384
    v_mfma_f32_16x16x32_bf16 v[140:143], v[32:35], v[12:15], v[140:143]
    ds_read_b64_tr_b16 v[102:103], v245 offset:20480
    v_mfma_f32_16x16x32_bf16 v[156:159], v[36:39], v[12:15], v[156:159]
    v_mfma_f32_16x16x32_bf16 v[156:159], v[52:55], v[28:31], v[156:159]
    ds_read_b64_tr_b16 v[104:105], v246 offset:16384
    v_mfma_f32_16x16x32_bf16 v[152:155], v[52:55], v[24:27], v[152:155]
    ds_read_b64_tr_b16 v[106:107], v246 offset:20480
    v_mfma_f32_16x16x32_bf16 v[152:155], v[36:39], v[8:11], v[152:155]
    ds_read_b64_tr_b16 v[108:109], v247 offset:16384
    v_mfma_f32_16x16x32_bf16 v[148:151], v[36:39], v[4:7], v[148:151]
    ds_read_b64_tr_b16 v[110:111], v247 offset:20480
    v_mfma_f32_16x16x32_bf16 v[148:151], v[52:55], v[20:23], v[148:151]
    ds_read_b64_tr_b16 v[112:113], v244 offset:24576
    v_mfma_f32_16x16x32_bf16 v[144:147], v[52:55], v[16:19], v[144:147]
    ds_read_b64_tr_b16 v[114:115], v244 offset:28672
    v_mfma_f32_16x16x32_bf16 v[144:147], v[36:39], v[0:3], v[144:147]
    ds_read_b128 v[80:83], v243 offset:17408
    v_mfma_f32_16x16x32_bf16 v[160:163], v[40:43], v[0:3], v[160:163]
    ds_read_b128 v[84:87], v243 offset:19456
    v_mfma_f32_16x16x32_bf16 v[160:163], v[56:59], v[16:19], v[160:163]
    v_mfma_f32_16x16x32_bf16 v[164:167], v[56:59], v[20:23], v[164:167]
    ds_read_b128 v[88:91], v243 offset:21504
    v_mfma_f32_16x16x32_bf16 v[164:167], v[40:43], v[4:7], v[164:167]
    ds_read_b128 v[92:95], v243 offset:23552
    v_mfma_f32_16x16x32_bf16 v[168:171], v[40:43], v[8:11], v[168:171]
    ds_read_b64_tr_b16 v[116:117], v245 offset:24576
    v_mfma_f32_16x16x32_bf16 v[168:171], v[56:59], v[24:27], v[168:171]
    ds_read_b64_tr_b16 v[118:119], v245 offset:28672
    v_mfma_f32_16x16x32_bf16 v[172:175], v[56:59], v[28:31], v[172:175]
    ds_read_b64_tr_b16 v[120:121], v246 offset:24576
    v_mfma_f32_16x16x32_bf16 v[172:175], v[40:43], v[12:15], v[172:175]
    ds_read_b64_tr_b16 v[122:123], v246 offset:28672
    v_mfma_f32_16x16x32_bf16 v[188:191], v[44:47], v[12:15], v[188:191]
    ds_read_b64_tr_b16 v[124:125], v247 offset:24576
    v_mfma_f32_16x16x32_bf16 v[188:191], v[60:63], v[28:31], v[188:191]
    ds_read_b64_tr_b16 v[126:127], v247 offset:28672
    v_mfma_f32_16x16x32_bf16 v[184:187], v[60:63], v[24:27], v[184:187]
    v_mfma_f32_16x16x32_bf16 v[184:187], v[44:47], v[8:11], v[184:187]
    v_mfma_f32_16x16x32_bf16 v[180:183], v[44:47], v[4:7], v[180:183]
    v_mfma_f32_16x16x32_bf16 v[180:183], v[60:63], v[20:23], v[180:183]
    v_mfma_f32_16x16x32_bf16 v[176:179], v[60:63], v[16:19], v[176:179]
    v_mfma_f32_16x16x32_bf16 v[176:179], v[44:47], v[0:3], v[176:179]
    s_waitcnt lgkmcnt(0)
    s_barrier
    .p2align 3
    v_mfma_f32_16x16x32_bf16 v[128:131], v[96:99], v[64:67], v[128:131]
    ds_read_b64_tr_b16 v[32:33], v244 offset:32768
    v_mfma_f32_16x16x32_bf16 v[128:131], v[112:115], v[80:83], v[128:131]
    ds_read_b64_tr_b16 v[34:35], v244 offset:36864
    v_mfma_f32_16x16x32_bf16 v[132:135], v[112:115], v[84:87], v[132:135]
    ds_read_b128 v[0:3], v243 offset:32768
    v_mfma_f32_16x16x32_bf16 v[132:135], v[96:99], v[68:71], v[132:135]
    ds_read_b128 v[4:7], v243 offset:34816
    v_mfma_f32_16x16x32_bf16 v[136:139], v[96:99], v[72:75], v[136:139]
    ds_read_b128 v[8:11], v243 offset:36864
    v_mfma_f32_16x16x32_bf16 v[136:139], v[112:115], v[88:91], v[136:139]
    ds_read_b128 v[12:15], v243 offset:38912
    v_mfma_f32_16x16x32_bf16 v[140:143], v[112:115], v[92:95], v[140:143]
    ds_read_b64_tr_b16 v[36:37], v245 offset:32768
    v_mfma_f32_16x16x32_bf16 v[140:143], v[96:99], v[76:79], v[140:143]
    ds_read_b64_tr_b16 v[38:39], v245 offset:36864
    v_mfma_f32_16x16x32_bf16 v[156:159], v[100:103], v[76:79], v[156:159]
    v_mfma_f32_16x16x32_bf16 v[156:159], v[116:119], v[92:95], v[156:159]
    ds_read_b64_tr_b16 v[40:41], v246 offset:32768
    v_mfma_f32_16x16x32_bf16 v[152:155], v[116:119], v[88:91], v[152:155]
    ds_read_b64_tr_b16 v[42:43], v246 offset:36864
    v_mfma_f32_16x16x32_bf16 v[152:155], v[100:103], v[72:75], v[152:155]
    ds_read_b64_tr_b16 v[44:45], v247 offset:32768
    v_mfma_f32_16x16x32_bf16 v[148:151], v[100:103], v[68:71], v[148:151]
    ds_read_b64_tr_b16 v[46:47], v247 offset:36864
    v_mfma_f32_16x16x32_bf16 v[148:151], v[116:119], v[84:87], v[148:151]
    ds_read_b64_tr_b16 v[48:49], v244 offset:40960
    v_mfma_f32_16x16x32_bf16 v[144:147], v[116:119], v[80:83], v[144:147]
    ds_read_b64_tr_b16 v[50:51], v244 offset:45056
    v_mfma_f32_16x16x32_bf16 v[144:147], v[100:103], v[64:67], v[144:147]
    ds_read_b128 v[16:19], v243 offset:33792
    v_mfma_f32_16x16x32_bf16 v[160:163], v[104:107], v[64:67], v[160:163]
    ds_read_b128 v[20:23], v243 offset:35840
    v_mfma_f32_16x16x32_bf16 v[160:163], v[120:123], v[80:83], v[160:163]
    v_mfma_f32_16x16x32_bf16 v[164:167], v[120:123], v[84:87], v[164:167]
    ds_read_b128 v[24:27], v243 offset:37888
    v_mfma_f32_16x16x32_bf16 v[164:167], v[104:107], v[68:71], v[164:167]
    ds_read_b128 v[28:31], v243 offset:39936
    v_mfma_f32_16x16x32_bf16 v[168:171], v[104:107], v[72:75], v[168:171]
    ds_read_b64_tr_b16 v[52:53], v245 offset:40960
    v_mfma_f32_16x16x32_bf16 v[168:171], v[120:123], v[88:91], v[168:171]
    ds_read_b64_tr_b16 v[54:55], v245 offset:45056
    v_mfma_f32_16x16x32_bf16 v[172:175], v[120:123], v[92:95], v[172:175]
    ds_read_b64_tr_b16 v[56:57], v246 offset:40960
    v_mfma_f32_16x16x32_bf16 v[172:175], v[104:107], v[76:79], v[172:175]
    ds_read_b64_tr_b16 v[58:59], v246 offset:45056
    v_mfma_f32_16x16x32_bf16 v[188:191], v[108:111], v[76:79], v[188:191]
    ds_read_b64_tr_b16 v[60:61], v247 offset:40960
    v_mfma_f32_16x16x32_bf16 v[188:191], v[124:127], v[92:95], v[188:191]
    ds_read_b64_tr_b16 v[62:63], v247 offset:45056
    v_mfma_f32_16x16x32_bf16 v[184:187], v[124:127], v[88:91], v[184:187]
    v_mfma_f32_16x16x32_bf16 v[184:187], v[108:111], v[72:75], v[184:187]
    v_mfma_f32_16x16x32_bf16 v[180:183], v[108:111], v[68:71], v[180:183]
    v_mfma_f32_16x16x32_bf16 v[180:183], v[124:127], v[84:87], v[180:183]
    v_mfma_f32_16x16x32_bf16 v[176:179], v[124:127], v[80:83], v[176:179]
    v_mfma_f32_16x16x32_bf16 v[176:179], v[108:111], v[64:67], v[176:179]
    s_waitcnt lgkmcnt(0)
    s_barrier
    .p2align 3
    v_mfma_f32_16x16x32_bf16 v[128:131], v[32:35], v[0:3], v[128:131]
    ds_read_b64_tr_b16 v[96:97], v248 offset:0
    v_mfma_f32_16x16x32_bf16 v[128:131], v[48:51], v[16:19], v[128:131]
    ds_read_b64_tr_b16 v[98:99], v248 offset:4096
    v_mfma_f32_16x16x32_bf16 v[132:135], v[48:51], v[20:23], v[132:135]
    ds_read_b128 v[64:67], v243 offset:0
    v_mfma_f32_16x16x32_bf16 v[132:135], v[32:35], v[4:7], v[132:135]
    ds_read_b128 v[68:71], v243 offset:2048
    v_mfma_f32_16x16x32_bf16 v[136:139], v[32:35], v[8:11], v[136:139]
    ds_read_b128 v[72:75], v243 offset:4096
    v_mfma_f32_16x16x32_bf16 v[136:139], v[48:51], v[24:27], v[136:139]
    ds_read_b128 v[76:79], v243 offset:6144
    v_mfma_f32_16x16x32_bf16 v[140:143], v[48:51], v[28:31], v[140:143]
    ds_read_b64_tr_b16 v[100:101], v249 offset:0
    v_mfma_f32_16x16x32_bf16 v[140:143], v[32:35], v[12:15], v[140:143]
    ds_read_b64_tr_b16 v[102:103], v249 offset:4096
    v_mfma_f32_16x16x32_bf16 v[156:159], v[36:39], v[12:15], v[156:159]
    v_mfma_f32_16x16x32_bf16 v[156:159], v[52:55], v[28:31], v[156:159]
    ds_read_b64_tr_b16 v[104:105], v250 offset:0
    v_mfma_f32_16x16x32_bf16 v[152:155], v[52:55], v[24:27], v[152:155]
    ds_read_b64_tr_b16 v[106:107], v250 offset:4096
    v_mfma_f32_16x16x32_bf16 v[152:155], v[36:39], v[8:11], v[152:155]
    ds_read_b64_tr_b16 v[108:109], v251 offset:0
    v_mfma_f32_16x16x32_bf16 v[148:151], v[36:39], v[4:7], v[148:151]
    ds_read_b64_tr_b16 v[110:111], v251 offset:4096
    v_mfma_f32_16x16x32_bf16 v[148:151], v[52:55], v[20:23], v[148:151]
    ds_read_b64_tr_b16 v[112:113], v248 offset:8192
    v_mfma_f32_16x16x32_bf16 v[144:147], v[52:55], v[16:19], v[144:147]
    ds_read_b64_tr_b16 v[114:115], v248 offset:12288
    v_mfma_f32_16x16x32_bf16 v[144:147], v[36:39], v[0:3], v[144:147]
    ds_read_b128 v[80:83], v243 offset:1024
    v_mfma_f32_16x16x32_bf16 v[160:163], v[40:43], v[0:3], v[160:163]
    ds_read_b128 v[84:87], v243 offset:3072
    v_mfma_f32_16x16x32_bf16 v[160:163], v[56:59], v[16:19], v[160:163]
    v_mfma_f32_16x16x32_bf16 v[164:167], v[56:59], v[20:23], v[164:167]
    ds_read_b128 v[88:91], v243 offset:5120
    v_mfma_f32_16x16x32_bf16 v[164:167], v[40:43], v[4:7], v[164:167]
    ds_read_b128 v[92:95], v243 offset:7168
    v_mfma_f32_16x16x32_bf16 v[168:171], v[40:43], v[8:11], v[168:171]
    ds_read_b64_tr_b16 v[116:117], v249 offset:8192
    v_mfma_f32_16x16x32_bf16 v[168:171], v[56:59], v[24:27], v[168:171]
    ds_read_b64_tr_b16 v[118:119], v249 offset:12288
    v_mfma_f32_16x16x32_bf16 v[172:175], v[56:59], v[28:31], v[172:175]
    ds_read_b64_tr_b16 v[120:121], v250 offset:8192
    v_mfma_f32_16x16x32_bf16 v[172:175], v[40:43], v[12:15], v[172:175]
    ds_read_b64_tr_b16 v[122:123], v250 offset:12288
    v_mfma_f32_16x16x32_bf16 v[188:191], v[44:47], v[12:15], v[188:191]
    ds_read_b64_tr_b16 v[124:125], v251 offset:8192
    v_mfma_f32_16x16x32_bf16 v[188:191], v[60:63], v[28:31], v[188:191]
    ds_read_b64_tr_b16 v[126:127], v251 offset:12288
    v_mfma_f32_16x16x32_bf16 v[184:187], v[60:63], v[24:27], v[184:187]
    v_mfma_f32_16x16x32_bf16 v[184:187], v[44:47], v[8:11], v[184:187]
    v_mfma_f32_16x16x32_bf16 v[180:183], v[44:47], v[4:7], v[180:183]
    v_mfma_f32_16x16x32_bf16 v[180:183], v[60:63], v[20:23], v[180:183]
    s_sub_u32 s58, s58, 1
    s_cmp_lg_u32 s58, 0
    .p2align 3
    v_mfma_f32_16x16x32_bf16 v[176:179], v[60:63], v[16:19], v[176:179]
    v_mfma_f32_16x16x32_bf16 v[176:179], v[44:47], v[0:3], v[176:179]
    s_cbranch_scc1 loop_34
    s_waitcnt lgkmcnt(0)
    s_barrier
    .p2align 3
    v_mfma_f32_16x16x32_bf16 v[128:131], v[96:99], v[64:67], v[128:131]
    ds_read_b64_tr_b16 v[32:33], v248 offset:16384
    v_mfma_f32_16x16x32_bf16 v[128:131], v[112:115], v[80:83], v[128:131]
    ds_read_b64_tr_b16 v[34:35], v248 offset:20480
    v_mfma_f32_16x16x32_bf16 v[132:135], v[112:115], v[84:87], v[132:135]
    ds_read_b128 v[0:3], v243 offset:16384
    v_mfma_f32_16x16x32_bf16 v[132:135], v[96:99], v[68:71], v[132:135]
    ds_read_b128 v[4:7], v243 offset:18432
    v_mfma_f32_16x16x32_bf16 v[136:139], v[96:99], v[72:75], v[136:139]
    ds_read_b128 v[8:11], v243 offset:20480
    v_mfma_f32_16x16x32_bf16 v[136:139], v[112:115], v[88:91], v[136:139]
    ds_read_b128 v[12:15], v243 offset:22528
    v_mfma_f32_16x16x32_bf16 v[140:143], v[112:115], v[92:95], v[140:143]
    ds_read_b64_tr_b16 v[36:37], v249 offset:16384
    v_mfma_f32_16x16x32_bf16 v[140:143], v[96:99], v[76:79], v[140:143]
    ds_read_b64_tr_b16 v[38:39], v249 offset:20480
    v_mfma_f32_16x16x32_bf16 v[156:159], v[100:103], v[76:79], v[156:159]
    v_mfma_f32_16x16x32_bf16 v[156:159], v[116:119], v[92:95], v[156:159]
    ds_read_b64_tr_b16 v[40:41], v250 offset:16384
    v_mfma_f32_16x16x32_bf16 v[152:155], v[116:119], v[88:91], v[152:155]
    ds_read_b64_tr_b16 v[42:43], v250 offset:20480
    v_mfma_f32_16x16x32_bf16 v[152:155], v[100:103], v[72:75], v[152:155]
    ds_read_b64_tr_b16 v[44:45], v251 offset:16384
    v_mfma_f32_16x16x32_bf16 v[148:151], v[100:103], v[68:71], v[148:151]
    ds_read_b64_tr_b16 v[46:47], v251 offset:20480
    v_mfma_f32_16x16x32_bf16 v[148:151], v[116:119], v[84:87], v[148:151]
    ds_read_b64_tr_b16 v[48:49], v248 offset:24576
    v_mfma_f32_16x16x32_bf16 v[144:147], v[116:119], v[80:83], v[144:147]
    ds_read_b64_tr_b16 v[50:51], v248 offset:28672
    v_mfma_f32_16x16x32_bf16 v[144:147], v[100:103], v[64:67], v[144:147]
    ds_read_b128 v[16:19], v243 offset:17408
    v_mfma_f32_16x16x32_bf16 v[160:163], v[104:107], v[64:67], v[160:163]
    ds_read_b128 v[20:23], v243 offset:19456
    v_mfma_f32_16x16x32_bf16 v[160:163], v[120:123], v[80:83], v[160:163]
    v_mfma_f32_16x16x32_bf16 v[164:167], v[120:123], v[84:87], v[164:167]
    ds_read_b128 v[24:27], v243 offset:21504
    v_mfma_f32_16x16x32_bf16 v[164:167], v[104:107], v[68:71], v[164:167]
    ds_read_b128 v[28:31], v243 offset:23552
    v_mfma_f32_16x16x32_bf16 v[168:171], v[104:107], v[72:75], v[168:171]
    ds_read_b64_tr_b16 v[52:53], v249 offset:24576
    v_mfma_f32_16x16x32_bf16 v[168:171], v[120:123], v[88:91], v[168:171]
    ds_read_b64_tr_b16 v[54:55], v249 offset:28672
    v_mfma_f32_16x16x32_bf16 v[172:175], v[120:123], v[92:95], v[172:175]
    ds_read_b64_tr_b16 v[56:57], v250 offset:24576
    v_mfma_f32_16x16x32_bf16 v[172:175], v[104:107], v[76:79], v[172:175]
    ds_read_b64_tr_b16 v[58:59], v250 offset:28672
    v_mfma_f32_16x16x32_bf16 v[188:191], v[108:111], v[76:79], v[188:191]
    ds_read_b64_tr_b16 v[60:61], v251 offset:24576
    v_mfma_f32_16x16x32_bf16 v[188:191], v[124:127], v[92:95], v[188:191]
    ds_read_b64_tr_b16 v[62:63], v251 offset:28672
    v_mfma_f32_16x16x32_bf16 v[184:187], v[124:127], v[88:91], v[184:187]
    v_mfma_f32_16x16x32_bf16 v[184:187], v[108:111], v[72:75], v[184:187]
    v_mfma_f32_16x16x32_bf16 v[180:183], v[108:111], v[68:71], v[180:183]
    v_mfma_f32_16x16x32_bf16 v[180:183], v[124:127], v[84:87], v[180:183]
    v_mfma_f32_16x16x32_bf16 v[176:179], v[124:127], v[80:83], v[176:179]
    v_mfma_f32_16x16x32_bf16 v[176:179], v[108:111], v[64:67], v[176:179]
    s_waitcnt lgkmcnt(0)
    s_barrier
    .p2align 3
    v_mfma_f32_16x16x32_bf16 v[128:131], v[32:35], v[0:3], v[128:131]
    ds_read_b64_tr_b16 v[96:97], v248 offset:32768
    v_mfma_f32_16x16x32_bf16 v[128:131], v[48:51], v[16:19], v[128:131]
    ds_read_b64_tr_b16 v[98:99], v248 offset:36864
    v_mfma_f32_16x16x32_bf16 v[132:135], v[48:51], v[20:23], v[132:135]
    ds_read_b128 v[64:67], v243 offset:32768
    v_mfma_f32_16x16x32_bf16 v[132:135], v[32:35], v[4:7], v[132:135]
    ds_read_b128 v[68:71], v243 offset:34816
    v_mfma_f32_16x16x32_bf16 v[136:139], v[32:35], v[8:11], v[136:139]
    ds_read_b128 v[72:75], v243 offset:36864
    v_mfma_f32_16x16x32_bf16 v[136:139], v[48:51], v[24:27], v[136:139]
    ds_read_b128 v[76:79], v243 offset:38912
    v_mfma_f32_16x16x32_bf16 v[140:143], v[48:51], v[28:31], v[140:143]
    ds_read_b64_tr_b16 v[100:101], v249 offset:32768
    v_mfma_f32_16x16x32_bf16 v[140:143], v[32:35], v[12:15], v[140:143]
    ds_read_b64_tr_b16 v[102:103], v249 offset:36864
    v_mfma_f32_16x16x32_bf16 v[156:159], v[36:39], v[12:15], v[156:159]
    v_mfma_f32_16x16x32_bf16 v[156:159], v[52:55], v[28:31], v[156:159]
    ds_read_b64_tr_b16 v[104:105], v250 offset:32768
    v_mfma_f32_16x16x32_bf16 v[152:155], v[52:55], v[24:27], v[152:155]
    ds_read_b64_tr_b16 v[106:107], v250 offset:36864
    v_mfma_f32_16x16x32_bf16 v[152:155], v[36:39], v[8:11], v[152:155]
    ds_read_b64_tr_b16 v[108:109], v251 offset:32768
    v_mfma_f32_16x16x32_bf16 v[148:151], v[36:39], v[4:7], v[148:151]
    ds_read_b64_tr_b16 v[110:111], v251 offset:36864
    v_mfma_f32_16x16x32_bf16 v[148:151], v[52:55], v[20:23], v[148:151]
    ds_read_b64_tr_b16 v[112:113], v248 offset:40960
    v_mfma_f32_16x16x32_bf16 v[144:147], v[52:55], v[16:19], v[144:147]
    ds_read_b64_tr_b16 v[114:115], v248 offset:45056
    v_mfma_f32_16x16x32_bf16 v[144:147], v[36:39], v[0:3], v[144:147]
    ds_read_b128 v[80:83], v243 offset:33792
    v_mfma_f32_16x16x32_bf16 v[160:163], v[40:43], v[0:3], v[160:163]
    ds_read_b128 v[84:87], v243 offset:35840
    v_mfma_f32_16x16x32_bf16 v[160:163], v[56:59], v[16:19], v[160:163]
    v_mfma_f32_16x16x32_bf16 v[164:167], v[56:59], v[20:23], v[164:167]
    ds_read_b128 v[88:91], v243 offset:37888
    v_mfma_f32_16x16x32_bf16 v[164:167], v[40:43], v[4:7], v[164:167]
    ds_read_b128 v[92:95], v243 offset:39936
    v_mfma_f32_16x16x32_bf16 v[168:171], v[40:43], v[8:11], v[168:171]
    ds_read_b64_tr_b16 v[116:117], v249 offset:40960
    v_mfma_f32_16x16x32_bf16 v[168:171], v[56:59], v[24:27], v[168:171]
    ds_read_b64_tr_b16 v[118:119], v249 offset:45056
    v_mfma_f32_16x16x32_bf16 v[172:175], v[56:59], v[28:31], v[172:175]
    ds_read_b64_tr_b16 v[120:121], v250 offset:40960
    v_mfma_f32_16x16x32_bf16 v[172:175], v[40:43], v[12:15], v[172:175]
    ds_read_b64_tr_b16 v[122:123], v250 offset:45056
    v_mfma_f32_16x16x32_bf16 v[188:191], v[44:47], v[12:15], v[188:191]
    ds_read_b64_tr_b16 v[124:125], v251 offset:40960
    v_mfma_f32_16x16x32_bf16 v[188:191], v[60:63], v[28:31], v[188:191]
    ds_read_b64_tr_b16 v[126:127], v251 offset:45056
    v_mfma_f32_16x16x32_bf16 v[184:187], v[60:63], v[24:27], v[184:187]
    v_mfma_f32_16x16x32_bf16 v[184:187], v[44:47], v[8:11], v[184:187]
    v_mfma_f32_16x16x32_bf16 v[180:183], v[44:47], v[4:7], v[180:183]
    v_mfma_f32_16x16x32_bf16 v[180:183], v[60:63], v[20:23], v[180:183]
    v_mfma_f32_16x16x32_bf16 v[176:179], v[60:63], v[16:19], v[176:179]
    v_mfma_f32_16x16x32_bf16 v[176:179], v[44:47], v[0:3], v[176:179]
    s_waitcnt lgkmcnt(0)
    s_barrier
    .p2align 3
    v_mfma_f32_16x16x32_bf16 v[128:131], v[96:99], v[64:67], v[128:131]
    v_mfma_f32_16x16x32_bf16 v[128:131], v[112:115], v[80:83], v[128:131]
    buffer_load_dwordx4 v[196:199], v254, s[4:7], s59 offen offset:0
    .p2align 3
    v_mfma_f32_16x16x32_bf16 v[132:135], v[112:115], v[84:87], v[132:135]
    v_mfma_f32_16x16x32_bf16 v[132:135], v[96:99], v[68:71], v[132:135]
    v_mfma_f32_16x16x32_bf16 v[136:139], v[96:99], v[72:75], v[136:139]
    buffer_load_dwordx4 v[200:203], v254, s[4:7], s59 offen offset:2048
    .p2align 3
    v_mfma_f32_16x16x32_bf16 v[136:139], v[112:115], v[88:91], v[136:139]
    v_mfma_f32_16x16x32_bf16 v[140:143], v[112:115], v[92:95], v[140:143]
    v_mfma_f32_16x16x32_bf16 v[140:143], v[96:99], v[76:79], v[140:143]
    buffer_load_dwordx4 v[204:207], v254, s[4:7], s60 offen offset:0
    .p2align 3
    v_mfma_f32_16x16x32_bf16 v[156:159], v[100:103], v[76:79], v[156:159]
    v_mfma_f32_16x16x32_bf16 v[156:159], v[116:119], v[92:95], v[156:159]
    v_mfma_f32_16x16x32_bf16 v[152:155], v[116:119], v[88:91], v[152:155]
    buffer_load_dwordx4 v[208:211], v254, s[4:7], s60 offen offset:2048
    .p2align 3
    v_mfma_f32_16x16x32_bf16 v[152:155], v[100:103], v[72:75], v[152:155]
    v_mfma_f32_16x16x32_bf16 v[148:151], v[100:103], v[68:71], v[148:151]
    v_mfma_f32_16x16x32_bf16 v[148:151], v[116:119], v[84:87], v[148:151]
    v_mfma_f32_16x16x32_bf16 v[144:147], v[116:119], v[80:83], v[144:147]
    v_mfma_f32_16x16x32_bf16 v[144:147], v[100:103], v[64:67], v[144:147]
    v_mfma_f32_16x16x32_bf16 v[160:163], v[104:107], v[64:67], v[160:163]
    v_mfma_f32_16x16x32_bf16 v[160:163], v[120:123], v[80:83], v[160:163]
    v_mfma_f32_16x16x32_bf16 v[164:167], v[120:123], v[84:87], v[164:167]
    v_mfma_f32_16x16x32_bf16 v[164:167], v[104:107], v[68:71], v[164:167]
    v_mfma_f32_16x16x32_bf16 v[168:171], v[104:107], v[72:75], v[168:171]
    v_mfma_f32_16x16x32_bf16 v[168:171], v[120:123], v[88:91], v[168:171]
    v_mfma_f32_16x16x32_bf16 v[172:175], v[120:123], v[92:95], v[172:175]
    v_mfma_f32_16x16x32_bf16 v[172:175], v[104:107], v[76:79], v[172:175]
    v_mfma_f32_16x16x32_bf16 v[188:191], v[108:111], v[76:79], v[188:191]
    v_mfma_f32_16x16x32_bf16 v[188:191], v[124:127], v[92:95], v[188:191]
    v_mfma_f32_16x16x32_bf16 v[184:187], v[124:127], v[88:91], v[184:187]
    v_mfma_f32_16x16x32_bf16 v[184:187], v[108:111], v[72:75], v[184:187]
    v_mfma_f32_16x16x32_bf16 v[180:183], v[108:111], v[68:71], v[180:183]
    v_mfma_f32_16x16x32_bf16 v[180:183], v[124:127], v[84:87], v[180:183]
    v_mfma_f32_16x16x32_bf16 v[176:179], v[124:127], v[80:83], v[176:179]
    v_mfma_f32_16x16x32_bf16 v[176:179], v[108:111], v[64:67], v[176:179]
    s_nop 7
    v_cvt_pk_bf16_f32 v0, v160, v161
    v_cvt_pk_bf16_f32 v1, v162, v163
    v_cvt_pk_bf16_f32 v2, v176, v177
    v_cvt_pk_bf16_f32 v3, v178, v179
    v_min_u32 v0, -2, v0
    v_min_u32 v1, -2, v1
    v_min_u32 v2, -2, v2
    v_min_u32 v3, -2, v3
    buffer_store_dwordx4 v[0:3], v254, s[4:7], s88 offen offset:0 sc0 sc1
    v_cvt_pk_bf16_f32 v4, v164, v165
    v_cvt_pk_bf16_f32 v5, v166, v167
    v_cvt_pk_bf16_f32 v6, v180, v181
    v_cvt_pk_bf16_f32 v7, v182, v183
    v_min_u32 v4, -2, v4
    v_min_u32 v5, -2, v5
    v_min_u32 v6, -2, v6
    v_min_u32 v7, -2, v7
    buffer_store_dwordx4 v[4:7], v254, s[4:7], s88 offen offset:1024 sc0 sc1
    v_cvt_pk_bf16_f32 v8, v168, v169
    v_cvt_pk_bf16_f32 v9, v170, v171
    v_cvt_pk_bf16_f32 v10, v184, v185
    v_cvt_pk_bf16_f32 v11, v186, v187
    v_min_u32 v8, -2, v8
    v_min_u32 v9, -2, v9
    v_min_u32 v10, -2, v10
    v_min_u32 v11, -2, v11
    buffer_store_dwordx4 v[8:11], v254, s[4:7], s88 offen offset:2048 sc0 sc1
    v_cvt_pk_bf16_f32 v12, v172, v173
    v_cvt_pk_bf16_f32 v13, v174, v175
    v_cvt_pk_bf16_f32 v14, v188, v189
    v_cvt_pk_bf16_f32 v15, v190, v191
    v_min_u32 v12, -2, v12
    v_min_u32 v13, -2, v13
    v_min_u32 v14, -2, v14
    v_min_u32 v15, -2, v15
    buffer_store_dwordx4 v[12:15], v254, s[4:7], s88 offen offset:3072 sc0 sc1
    s_waitcnt vmcnt(4)
    v_lshlrev_b32 v160, 16, v196
    v_and_b32 v161, 0xffff0000, v196
    v_lshlrev_b32 v162, 16, v197
    v_and_b32 v163, 0xffff0000, v197
    v_pk_add_f32 v[128:129], v[128:129], v[160:161]
    v_pk_add_f32 v[130:131], v[130:131], v[162:163]
    v_lshlrev_b32 v164, 16, v198
    v_and_b32 v165, 0xffff0000, v198
    v_lshlrev_b32 v166, 16, v199
    v_and_b32 v167, 0xffff0000, v199
    v_pk_add_f32 v[144:145], v[144:145], v[164:165]
    v_pk_add_f32 v[146:147], v[146:147], v[166:167]
    v_lshlrev_b32 v168, 16, v200
    v_and_b32 v169, 0xffff0000, v200
    v_lshlrev_b32 v170, 16, v201
    v_and_b32 v171, 0xffff0000, v201
    v_pk_add_f32 v[132:133], v[132:133], v[168:169]
    v_pk_add_f32 v[134:135], v[134:135], v[170:171]
    v_lshlrev_b32 v172, 16, v202
    v_and_b32 v173, 0xffff0000, v202
    v_lshlrev_b32 v174, 16, v203
    v_and_b32 v175, 0xffff0000, v203
    v_pk_add_f32 v[148:149], v[148:149], v[172:173]
    v_pk_add_f32 v[150:151], v[150:151], v[174:175]
    v_lshlrev_b32 v160, 16, v204
    v_and_b32 v161, 0xffff0000, v204
    v_lshlrev_b32 v162, 16, v205
    v_and_b32 v163, 0xffff0000, v205
    v_pk_add_f32 v[136:137], v[136:137], v[160:161]
    v_pk_add_f32 v[138:139], v[138:139], v[162:163]
    v_lshlrev_b32 v164, 16, v206
    v_and_b32 v165, 0xffff0000, v206
    v_lshlrev_b32 v166, 16, v207
    v_and_b32 v167, 0xffff0000, v207
    v_pk_add_f32 v[152:153], v[152:153], v[164:165]
    v_pk_add_f32 v[154:155], v[154:155], v[166:167]
    v_lshlrev_b32 v168, 16, v208
    v_and_b32 v169, 0xffff0000, v208
    v_lshlrev_b32 v170, 16, v209
    v_and_b32 v171, 0xffff0000, v209
    v_pk_add_f32 v[140:141], v[140:141], v[168:169]
    v_pk_add_f32 v[142:143], v[142:143], v[170:171]
    v_lshlrev_b32 v172, 16, v210
    v_and_b32 v173, 0xffff0000, v210
    v_lshlrev_b32 v174, 16, v211
    v_and_b32 v175, 0xffff0000, v211
    v_pk_add_f32 v[156:157], v[156:157], v[172:173]
    v_pk_add_f32 v[158:159], v[158:159], v[174:175]
    s_mov_b32 s56, 262144
poll_35:
    buffer_load_dwordx4 v[16:19], v254, s[4:7], s89 offen offset:0 sc0 sc1
    buffer_load_dwordx4 v[20:23], v254, s[4:7], s89 offen offset:1024 sc0 sc1
    buffer_load_dwordx4 v[24:27], v254, s[4:7], s89 offen offset:2048 sc0 sc1
    buffer_load_dwordx4 v[28:31], v254, s[4:7], s89 offen offset:3072 sc0 sc1
    s_waitcnt vmcnt(0)
pc_37:
    v_max3_u32 v192, v16, v17, v18
    v_max3_u32 v193, v19, v20, v21
    v_max3_u32 v192, v192, v22, v23
    v_max3_u32 v193, v193, v24, v25
    v_max3_u32 v192, v192, v26, v27
    v_max3_u32 v193, v193, v28, v29
    v_max3_u32 v192, v192, v30, v31
    v_max_u32 v192, v192, v193
    v_cmp_eq_u32 vcc, -1, v192
    s_cbranch_vccz pd_36
    s_sub_u32 s56, s56, 1
    s_cmp_lg_u32 s56, 0
    s_cbranch_scc1 poll_35
pd_36:
    v_lshlrev_b32 v160, 16, v16
    v_and_b32 v161, 0xffff0000, v16
    v_lshlrev_b32 v162, 16, v17
    v_and_b32 v163, 0xffff0000, v17
    v_pk_add_f32 v[128:129], v[128:129], v[160:161]
    v_pk_add_f32 v[130:131], v[130:131], v[162:163]
    v_lshlrev_b32 v164, 16, v18
    v_and_b32 v165, 0xffff0000, v18
    v_lshlrev_b32 v166, 16, v19
    v_and_b32 v167, 0xffff0000, v19
    v_pk_add_f32 v[144:145], v[144:145], v[164:165]
    v_pk_add_f32 v[146:147], v[146:147], v[166:167]
    v_lshlrev_b32 v168, 16, v20
    v_and_b32 v169, 0xffff0000, v20
    v_lshlrev_b32 v170, 16, v21
    v_and_b32 v171, 0xffff0000, v21
    v_pk_add_f32 v[132:133], v[132:133], v[168:169]
    v_pk_add_f32 v[134:135], v[134:135], v[170:171]
    v_lshlrev_b32 v172, 16, v22
    v_and_b32 v173, 0xffff0000, v22
    v_lshlrev_b32 v174, 16, v23
    v_and_b32 v175, 0xffff0000, v23
    v_pk_add_f32 v[148:149], v[148:149], v[172:173]
    v_pk_add_f32 v[150:151], v[150:151], v[174:175]
    v_lshlrev_b32 v160, 16, v24
    v_and_b32 v161, 0xffff0000, v24
    v_lshlrev_b32 v162, 16, v25
    v_and_b32 v163, 0xffff0000, v25
    v_pk_add_f32 v[136:137], v[136:137], v[160:161]
    v_pk_add_f32 v[138:139], v[138:139], v[162:163]
    v_lshlrev_b32 v164, 16, v26
    v_and_b32 v165, 0xffff0000, v26
    v_lshlrev_b32 v166, 16, v27
    v_and_b32 v167, 0xffff0000, v27
    v_pk_add_f32 v[152:153], v[152:153], v[164:165]
    v_pk_add_f32 v[154:155], v[154:155], v[166:167]
    v_lshlrev_b32 v168, 16, v28
    v_and_b32 v169, 0xffff0000, v28
    v_lshlrev_b32 v170, 16, v29
    v_and_b32 v171, 0xffff0000, v29
    v_pk_add_f32 v[140:141], v[140:141], v[168:169]
    v_pk_add_f32 v[142:143], v[142:143], v[170:171]
    v_lshlrev_b32 v172, 16, v30
    v_and_b32 v173, 0xffff0000, v30
    v_lshlrev_b32 v174, 16, v31
    v_and_b32 v175, 0xffff0000, v31
    v_pk_add_f32 v[156:157], v[156:157], v[172:173]
    v_pk_add_f32 v[158:159], v[158:159], v[174:175]
    s_cmp_lg_u32 s46, 0
    s_cbranch_scc1 X_fin
    s_add_u32 s59, s1, s48
    s_add_u32 s60, s59, 4096
    v_cvt_pk_bf16_f32 v236, v128, v129
    v_cvt_pk_bf16_f32 v237, v130, v131
    v_cvt_pk_bf16_f32 v238, v144, v145
    v_cvt_pk_bf16_f32 v239, v146, v147
    buffer_store_dwordx4 v[236:239], v254, s[4:7], s59 offen offset:0 sc0 sc1
    v_cvt_pk_bf16_f32 v240, v132, v133
    v_cvt_pk_bf16_f32 v241, v134, v135
    v_cvt_pk_bf16_f32 v242, v148, v149
    v_cvt_pk_bf16_f32 v243, v150, v151
    buffer_store_dwordx4 v[240:243], v254, s[4:7], s59 offen offset:2048 sc0 sc1
    v_cvt_pk_bf16_f32 v244, v136, v137
    v_cvt_pk_bf16_f32 v245, v138, v139
    v_cvt_pk_bf16_f32 v246, v152, v153
    v_cvt_pk_bf16_f32 v247, v154, v155
    buffer_store_dwordx4 v[244:247], v254, s[4:7], s60 offen offset:0 sc0 sc1
    v_cvt_pk_bf16_f32 v248, v140, v141
    v_cvt_pk_bf16_f32 v249, v142, v143
    v_cvt_pk_bf16_f32 v250, v156, v157
    v_cvt_pk_bf16_f32 v251, v158, v159
    buffer_store_dwordx4 v[248:251], v254, s[4:7], s60 offen offset:2048 sc0 sc1
    v_mov_b32 v234, 0x3f803f80
    v_dot2_f32_bf16 v226, v236, v234, 0
    v_dot2_f32_bf16 v230, v236, v236, 0
    v_dot2_f32_bf16 v227, v240, v234, 0
    v_dot2_f32_bf16 v231, v240, v240, 0
    v_dot2_f32_bf16 v228, v244, v234, 0
    v_dot2_f32_bf16 v232, v244, v244, 0
    v_dot2_f32_bf16 v229, v248, v234, 0
    v_dot2_f32_bf16 v233, v248, v248, 0
    v_dot2_f32_bf16 v226, v237, v234, v226
    v_dot2_f32_bf16 v230, v237, v237, v230
    v_dot2_f32_bf16 v227, v241, v234, v227
    v_dot2_f32_bf16 v231, v241, v241, v231
    v_dot2_f32_bf16 v228, v245, v234, v228
    v_dot2_f32_bf16 v232, v245, v245, v232
    v_dot2_f32_bf16 v229, v249, v234, v229
    v_dot2_f32_bf16 v233, v249, v249, v233
    v_dot2_f32_bf16 v226, v238, v234, v226
    v_dot2_f32_bf16 v230, v238, v238, v230
    v_dot2_f32_bf16 v227, v242, v234, v227
    v_dot2_f32_bf16 v231, v242, v242, v231
    v_dot2_f32_bf16 v228, v246, v234, v228
    v_dot2_f32_bf16 v232, v246, v246, v232
    v_dot2_f32_bf16 v229, v250, v234, v229
    v_dot2_f32_bf16 v233, v250, v250, v233
    v_dot2_f32_bf16 v226, v239, v234, v226
    v_dot2_f32_bf16 v230, v239, v239, v230
    v_dot2_f32_bf16 v227, v243, v234, v227
    v_dot2_f32_bf16 v231, v243, v243, v231
    v_dot2_f32_bf16 v228, v247, v234, v228
    v_dot2_f32_bf16 v232, v247, v247, v232
    v_dot2_f32_bf16 v229, v251, v234, v229
    v_dot2_f32_bf16 v233, v251, v251, v233
    s_lshl_b32 s55, s42, 9
    s_add_u32 s55, s55, 155648
    s_nop 1
    v_permlane32_swap_b32 v226, v228
    v_permlane32_swap_b32 v227, v229
    v_permlane32_swap_b32 v230, v232
    v_permlane32_swap_b32 v231, v233
    v_add_f32 v226, v226, v228
    v_add_f32 v227, v227, v229
    v_add_f32 v230, v230, v232
    v_add_f32 v231, v231, v233
    v_lshrrev_b32 v234, 1, v254
    v_add_u32 v234, s55, v234
    v_permlane16_swap_b32 v226, v227
    v_permlane16_swap_b32 v230, v231
    v_add_f32 v226, v226, v227
    v_add_f32 v227, v230, v231
    ds_write_b64 v234, v[226:227]
    s_mov_b32 s46, 1
    s_add_u32 s47, s47, 262144
    s_add_u32 s49, s49, 524288
    s_add_u32 s50, s50, 917504
    s_add_u32 s52, s52, 65536
    s_add_u32 s54, s54, 32768
    s_add_u32 s0, s0, 32768
    s_branch X_layer
X_fin:
    v_and_b32 v192, 0xf0, v254
    v_lshlrev_b32 v192, 7, v192
    v_and_b32 v193, 0x100, v254
    v_lshrrev_b32 v193, 3, v193
    v_add_u32 v192, v192, v193
    v_and_b32 v193, 0x200, v254
    v_lshrrev_b32 v193, 5, v193
    v_add_u32 v192, v192, v193
    s_lshl_b32 s55, s40, 18
    s_lshl_b32 s56, s43, 17
    s_add_u32 s55, s55, s56
    s_lshl_b32 s56, s51, 7
    s_add_u32 s55, s55, s56
    s_lshl_b32 s56, s44, 6
    s_add_u32 s55, s55, s56
    v_cvt_pk_bf16_f32 v0, v128, v129
    v_cvt_pk_bf16_f32 v1, v130, v131
    v_cvt_pk_bf16_f32 v2, v144, v145
    v_cvt_pk_bf16_f32 v3, v146, v147
    s_nop 1
    v_permlane16_swap_b32 v0, v2
    v_permlane16_swap_b32 v1, v3
    buffer_store_dwordx4 v[0:3], v192, s[28:31], s55 offen sc0 sc1
    s_add_u32 s55, s55, 32768
    v_cvt_pk_bf16_f32 v4, v132, v133
    v_cvt_pk_bf16_f32 v5, v134, v135
    v_cvt_pk_bf16_f32 v6, v148, v149
    v_cvt_pk_bf16_f32 v7, v150, v151
    s_nop 1
    v_permlane16_swap_b32 v4, v6
    v_permlane16_swap_b32 v5, v7
    buffer_store_dwordx4 v[4:7], v192, s[28:31], s55 offen sc0 sc1
    s_add_u32 s55, s55, 32768
    v_cvt_pk_bf16_f32 v8, v136, v137
    v_cvt_pk_bf16_f32 v9, v138, v139
    v_cvt_pk_bf16_f32 v10, v152, v153
    v_cvt_pk_bf16_f32 v11, v154, v155
    s_nop 1
    v_permlane16_swap_b32 v8, v10
    v_permlane16_swap_b32 v9, v11
    buffer_store_dwordx4 v[8:11], v192, s[28:31], s55 offen sc0 sc1
    s_add_u32 s55, s55, 32768
    v_cvt_pk_bf16_f32 v12, v140, v141
    v_cvt_pk_bf16_f32 v13, v142, v143
    v_cvt_pk_bf16_f32 v14, v156, v157
    v_cvt_pk_bf16_f32 v15, v158, v159
    s_nop 1
    v_permlane16_swap_b32 v12, v14
    v_permlane16_swap_b32 v13, v15
    buffer_store_dwordx4 v[12:15], v192, s[28:31], s55 offen sc0 sc1
    s_add_u32 s55, s55, 32768
    s_endpgm
Y_first:
    v_mov_b32 v120, 0x3f80
    v_lshrrev_b32 v224, 4, v254
    v_and_b32 v225, 1, v224
    v_lshlrev_b32 v225, 4, v225
    v_lshlrev_b32 v225, v225, v120
    v_bfe_u32 v224, v224, 1, 3
    v_cmp_eq_u32 vcc, 0, v224
    s_nop 1
    v_cndmask_b32 v120, 0, v225, vcc
    v_cmp_eq_u32 vcc, 1, v224
    s_nop 1
    v_cndmask_b32 v121, 0, v225, vcc
    v_cmp_eq_u32 vcc, 2, v224
    s_nop 1
    v_cndmask_b32 v122, 0, v225, vcc
    v_cmp_eq_u32 vcc, 3, v224
    s_nop 1
    v_cndmask_b32 v123, 0, v225, vcc
    v_lshrrev_b32 v224, 7, v254
    v_and_b32 v225, 0x70, v254
    v_and_b32 v226, 6, v224
    v_lshlrev_b32 v226, 4, v226
    v_xor_b32 v225, v225, v226
    v_lshl_add_u32 v172, v224, 7, v225
    s_min_u32 s55, s42, 2
    s_lshl_b32 s55, s55, 12
    v_add_u32 v172, s55, v172
    s_setprio 1
    s_barrier
    s_add_u32 m0, s91, 135168
    s_mov_b64 exec, s[84:85]
    buffer_load_dwordx4 v221, s[36:39], s94 offen lds
    s_mov_b64 exec, -1
    s_add_u32 m0, s62, 137216
    s_nop 0
    buffer_load_dwordx4 v217, s[36:39], s94 offen lds
    buffer_load_dwordx4 v218, s[36:39], s94 offen offset:1024 lds
    buffer_load_dwordx4 v219, s[36:39], s94 offen offset:2048 lds
    buffer_load_dwordx4 v220, s[36:39], s94 offen offset:3072 lds
    s_add_u32 s94, s94, 256
    s_and_b32 s94, s94, 2047
    s_lshl_b32 s55, s2, 2
    s_add_u32 s55, s55, s42
    s_lshl_b32 s55, s55, 11
    v_lshlrev_b32 v176, 3, v254
    s_mov_b64 exec, 0xffff
    buffer_load_dword v251, v176, s[12:15], s55 offen
    s_mov_b64 exec, -1
    s_mov_b32 s74, 7340032
    s_mov_b32 s75, 0x00020000
    s_lshl_b32 s55, s2, 1
    s_add_u32 s55, s55, s44
    s_mul_i32 s95, s55, 14336
    s_and_b32 s55, s40, 3
    s_cmp_lg_u32 s55, 0
    s_cbranch_scc1 qc_38
    ds_read_b128 v[128:131], v172 offset:0
    ds_read_b128 v[132:135], v172 offset:1024
    ds_read_b128 v[136:139], v172 offset:2048
    ds_read_b128 v[140:143], v172 offset:3072
    s_waitcnt lgkmcnt(0)
    v_mfma_f32_16x16x32_bf16 v[124:127], v[120:123], v[128:131], 0
    v_mfma_f32_16x16x32_bf16 v[124:127], v[120:123], v[132:135], v[124:127]
    v_mfma_f32_16x16x32_bf16 v[124:127], v[120:123], v[136:139], v[124:127]
    v_mfma_f32_16x16x32_bf16 v[124:127], v[120:123], v[140:143], v[124:127]
    s_nop 7
qc_38:
    s_waitcnt vmcnt(14)
    s_barrier
    s_add_u32 m0, s61, 49152
    s_mul_i32 s59, s93, 96
    buffer_load_dwordx4 v200, s[8:11], s59 offen lds
    v_add_f32_dpp v160, v160, v160 quad_perm:[1,0,3,2] row_mask:0xf bank_mask:0xf
    v_add_f32_dpp v161, v161, v161 quad_perm:[1,0,3,2] row_mask:0xf bank_mask:0xf
    v_add_f32_dpp v162, v162, v162 quad_perm:[1,0,3,2] row_mask:0xf bank_mask:0xf
    v_add_f32_dpp v163, v163, v163 quad_perm:[1,0,3,2] row_mask:0xf bank_mask:0xf
    v_add_f32_dpp v164, v164, v164 quad_perm:[1,0,3,2] row_mask:0xf bank_mask:0xf
    v_add_f32_dpp v165, v165, v165 quad_perm:[1,0,3,2] row_mask:0xf bank_mask:0xf
    v_add_f32_dpp v166, v166, v166 quad_perm:[1,0,3,2] row_mask:0xf bank_mask:0xf
    v_add_f32_dpp v167, v167, v167 quad_perm:[1,0,3,2] row_mask:0xf bank_mask:0xf
    buffer_load_dwordx4 v201, s[8:11], s59 offen offset:1024 lds
    v_add_f32_dpp v160, v160, v160 quad_perm:[2,3,0,1] row_mask:0xf bank_mask:0xf
    v_add_f32_dpp v161, v161, v161 quad_perm:[2,3,0,1] row_mask:0xf bank_mask:0xf
    v_add_f32_dpp v162, v162, v162 quad_perm:[2,3,0,1] row_mask:0xf bank_mask:0xf
    v_add_f32_dpp v163, v163, v163 quad_perm:[2,3,0,1] row_mask:0xf bank_mask:0xf
    v_add_f32_dpp v164, v164, v164 quad_perm:[2,3,0,1] row_mask:0xf bank_mask:0xf
    v_add_f32_dpp v165, v165, v165 quad_perm:[2,3,0,1] row_mask:0xf bank_mask:0xf
    v_add_f32_dpp v166, v166, v166 quad_perm:[2,3,0,1] row_mask:0xf bank_mask:0xf
    v_add_f32_dpp v167, v167, v167 quad_perm:[2,3,0,1] row_mask:0xf bank_mask:0xf
    buffer_load_dwordx4 v202, s[8:11], s59 offen offset:2048 lds
    s_add_u32 s93, s93, 6144
    s_and_b32 s93, s93, 65535
    v_add_f32_dpp v160, v160, v160 row_half_mirror row_mask:0xf bank_mask:0xf
    v_add_f32_dpp v161, v161, v161 row_half_mirror row_mask:0xf bank_mask:0xf
    v_add_f32_dpp v162, v162, v162 row_half_mirror row_mask:0xf bank_mask:0xf
    v_add_f32_dpp v163, v163, v163 row_half_mirror row_mask:0xf bank_mask:0xf
    v_add_f32_dpp v164, v164, v164 row_half_mirror row_mask:0xf bank_mask:0xf
    v_add_f32_dpp v165, v165, v165 row_half_mirror row_mask:0xf bank_mask:0xf
    v_add_f32_dpp v166, v166, v166 row_half_mirror row_mask:0xf bank_mask:0xf
    v_add_f32_dpp v167, v167, v167 row_half_mirror row_mask:0xf bank_mask:0xf
    s_and_b32 s55, s40, 3
    s_cmp_lg_u32 s55, 0
    s_cbranch_scc1 qc_39
    ds_read_b128 v[128:131], v172 offset:16384
    ds_read_b128 v[132:135], v172 offset:17408
    ds_read_b128 v[136:139], v172 offset:18432
    ds_read_b128 v[140:143], v172 offset:19456
    s_waitcnt lgkmcnt(0)
    v_mfma_f32_16x16x32_bf16 v[124:127], v[120:123], v[128:131], v[124:127]
    v_mfma_f32_16x16x32_bf16 v[124:127], v[120:123], v[132:135], v[124:127]
    v_mfma_f32_16x16x32_bf16 v[124:127], v[120:123], v[136:139], v[124:127]
    v_mfma_f32_16x16x32_bf16 v[124:127], v[120:123], v[140:143], v[124:127]
    s_nop 7
qc_39:
    s_waitcnt vmcnt(9)
    s_barrier
    s_add_u32 m0, s91, 98304
    s_mov_b64 exec, s[84:85]
    buffer_load_dwordx4 v221, s[36:39], s94 offen lds
    s_mov_b64 exec, -1
    v_and_b32 v224, 0x70, v254
    s_add_u32 m0, s62, 100352
    s_nop 0
    buffer_load_dwordx4 v217, s[36:39], s94 offen lds
    v_cmp_eq_u32 vcc, 16, v224
    s_nop 1
    v_cndmask_b32 v160, v160, v162, vcc
    v_cndmask_b32 v161, v161, v163, vcc
    buffer_load_dwordx4 v218, s[36:39], s94 offen offset:1024 lds
    v_cmp_eq_u32 vcc, 32, v224
    s_nop 1
    v_cndmask_b32 v160, v160, v164, vcc
    v_cndmask_b32 v161, v161, v165, vcc
    s_add_u32 m0, s61, 65536
    s_mul_i32 s59, s93, 96
    buffer_load_dwordx4 v200, s[8:11], s59 offen lds
    v_cmp_eq_u32 vcc, 48, v224
    s_nop 1
    v_cndmask_b32 v160, v160, v166, vcc
    v_cndmask_b32 v161, v161, v167, vcc
    buffer_load_dwordx4 v201, s[8:11], s59 offen offset:1024 lds
    v_lshrrev_b32 v225, 7, v254
    buffer_load_dwordx4 v202, s[8:11], s59 offen offset:2048 lds
    s_add_u32 s93, s93, 2048
    s_and_b32 s93, s93, 65535
    v_lshlrev_b32 v225, 3, v225
    v_lshl_add_u32 v224, v224, 2, v225
    s_and_b32 s55, s40, 3
    s_cmp_lg_u32 s55, 1
    s_cbranch_scc1 qc_40
    ds_read_b128 v[128:131], v172 offset:32768
    ds_read_b128 v[132:135], v172 offset:33792
    ds_read_b128 v[136:139], v172 offset:34816
    ds_read_b128 v[140:143], v172 offset:35840
    s_waitcnt lgkmcnt(0)
    v_mfma_f32_16x16x32_bf16 v[124:127], v[120:123], v[128:131], 0
    v_mfma_f32_16x16x32_bf16 v[124:127], v[120:123], v[132:135], v[124:127]
    v_mfma_f32_16x16x32_bf16 v[124:127], v[120:123], v[136:139], v[124:127]
    v_mfma_f32_16x16x32_bf16 v[124:127], v[120:123], v[140:143], v[124:127]
    s_nop 7
qc_40:
    s_lshl_b32 s55, s51, 10
    s_lshr_b32 s56, s62, 4
    s_add_u32 s55, s55, s56
    s_add_u32 s55, s55, s53
    s_add_u32 s55, s55, 65536
    s_mov_b32 s70, 0x0f0f0f0f
    s_mov_b32 s71, 0x0f0f0f0f
    s_mov_b64 exec, s[70:71]
    buffer_store_dwordx2 v[160:161], v224, s[4:7], s55 offen sc0 sc1
    s_mov_b64 exec, -1
    s_waitcnt vmcnt(7)
    s_barrier
    s_add_u32 m0, s62, 100352
    s_nop 0
    buffer_load_dwordx4 v219, s[36:39], s94 offen offset:2048 lds
    s_add_u32 s55, s51, 4
    s_and_b32 s56, s55, 7
    s_lshr_b32 s55, s55, 3
    s_and_b32 s55, s55, 1
    s_lshl_b32 s56, s56, 1
    s_add_u32 s55, s55, s56
    s_lshr_b32 s56, s40, 1
    s_mul_i32 s56, s56, 14
    s_add_u32 s56, s56, s55
    s_lshl_b32 s56, s56, 1
    s_and_b32 s79, s40, 1
    s_add_u32 s79, s79, s56
    s_cmp_lt_u32 s55, 14
    s_cselect_b32 s79, s79, 255
    s_lshr_b32 s55, s79, 1
    s_cmp_lt_u32 s55, 56
    s_cselect_b32 s72, s80, s82
    s_cselect_b32 s73, s81, s83
    s_cselect_b32 s56, 0, 56
    s_sub_u32 s55, s55, s56
    s_lshl_b32 s76, s55, 7
    s_and_b32 s55, s79, 1
    s_lshl_b32 s55, s55, 2
    s_add_u32 s55, s55, s42
    s_mul_i32 s55, s55, 917504
    s_add_u32 s76, s76, s55
    s_cmp_lt_u32 s79, 224
    s_cselect_b32 s76, s76, 2130706432
    v_lshrrev_b32 v96, 7, v254
    buffer_load_dwordx4 v220, s[36:39], s94 offen offset:3072 lds
    s_add_u32 s94, s94, 256
    s_and_b32 s94, s94, 2047
    v_mul_u32_u24 v96, 7168, v96
    v_and_b32 v224, 0x70, v254
    s_add_u32 m0, s61, 81920
    s_mul_i32 s59, s93, 96
    buffer_load_dwordx4 v200, s[8:11], s59 offen lds
    v_add_u32 v96, v96, v224
    v_lshrrev_b32 v97, 6, v254
    v_mul_u32_u24 v97, 7168, v97
    buffer_load_dwordx4 v201, s[8:11], s59 offen offset:1024 lds
    v_lshrrev_b32 v224, 3, v254
    v_and_b32 v224, 0x20, v224
    buffer_load_dwordx4 v202, s[8:11], s59 offen offset:2048 lds
    s_add_u32 s93, s93, 6144
    s_and_b32 s93, s93, 65535
    v_and_b32 v225, 0x30, v254
    v_xor_b32 v224, v224, v225
    v_add_u32 v97, v97, v224
    s_and_b32 s55, s40, 3
    s_cmp_lg_u32 s55, 1
    s_cbranch_scc1 qc_41
    v_add_u32 v252, 49152, v172
    ds_read_b128 v[128:131], v252 offset:0
    ds_read_b128 v[132:135], v252 offset:1024
    ds_read_b128 v[136:139], v252 offset:2048
    ds_read_b128 v[140:143], v252 offset:3072
    s_waitcnt lgkmcnt(0)
    v_mfma_f32_16x16x32_bf16 v[124:127], v[120:123], v[128:131], v[124:127]
    v_mfma_f32_16x16x32_bf16 v[124:127], v[120:123], v[132:135], v[124:127]
    v_mfma_f32_16x16x32_bf16 v[124:127], v[120:123], v[136:139], v[124:127]
    v_mfma_f32_16x16x32_bf16 v[124:127], v[120:123], v[140:143], v[124:127]
    s_nop 7
qc_41:
    s_waitcnt vmcnt(6)
    s_barrier
    s_add_u32 m0, s91, 116736
    s_mov_b64 exec, s[84:85]
    buffer_load_dwordx4 v221, s[36:39], s94 offen lds
    s_mov_b64 exec, -1
    s_add_u32 m0, s62, 118784
    s_nop 0
    buffer_load_dwordx4 v217, s[36:39], s94 offen lds
    buffer_load_dwordx4 v218, s[36:39], s94 offen offset:1024 lds
    s_add_u32 m0, s61, 0
    s_mul_i32 s59, s93, 96
    buffer_load_dwordx4 v200, s[8:11], s59 offen lds
    buffer_load_dwordx4 v201, s[8:11], s59 offen offset:1024 lds
    buffer_load_dwordx4 v202, s[8:11], s59 offen offset:2048 lds
    s_add_u32 s93, s93, 2048
    s_and_b32 s93, s93, 65535
    s_getreg_b32 s77, hwreg(HW_REG_XCC_ID, 0, 4)
    s_mul_i32 s55, s77, s77
    s_lshl_b32 s55, s55, 15
    s_lshl_b32 s77, s77, 6
    s_add_u32 s77, s77, s55
    s_add_u32 s77, s77, 1
    s_and_b32 s55, s40, 3
    s_cmp_lg_u32 s55, 2
    s_cbranch_scc1 qc_42
    v_add_u32 v252, 49152, v172
    ds_read_b128 v[128:131], v252 offset:16384
    ds_read_b128 v[132:135], v252 offset:17408
    ds_read_b128 v[136:139], v252 offset:18432
    ds_read_b128 v[140:143], v252 offset:19456
    s_waitcnt lgkmcnt(0)
    v_mfma_f32_16x16x32_bf16 v[124:127], v[120:123], v[128:131], 0
    v_mfma_f32_16x16x32_bf16 v[124:127], v[120:123], v[132:135], v[124:127]
    v_mfma_f32_16x16x32_bf16 v[124:127], v[120:123], v[136:139], v[124:127]
    v_mfma_f32_16x16x32_bf16 v[124:127], v[120:123], v[140:143], v[124:127]
    s_nop 7
qc_42:
    s_waitcnt vmcnt(6)
    s_barrier
    s_add_u32 m0, s62, 118784
    s_nop 0
    buffer_load_dwordx4 v219, s[36:39], s94 offen offset:2048 lds
    buffer_load_dwordx4 v220, s[36:39], s94 offen offset:3072 lds
    s_add_u32 s94, s94, 256
    s_and_b32 s94, s94, 2047
    s_add_u32 m0, s61, 16384
    s_mul_i32 s59, s93, 96
    buffer_load_dwordx4 v200, s[8:11], s59 offen lds
    buffer_load_dwordx4 v201, s[8:11], s59 offen offset:1024 lds
    buffer_load_dwordx4 v202, s[8:11], s59 offen offset:2048 lds
    s_add_u32 s93, s93, 6144
    s_and_b32 s93, s93, 65535
    s_and_b32 s55, s40, 3
    s_cmp_lg_u32 s55, 2
    s_cbranch_scc1 qc_43
    v_add_u32 v252, 49152, v172
    ds_read_b128 v[128:131], v252 offset:32768
    ds_read_b128 v[132:135], v252 offset:33792
    ds_read_b128 v[136:139], v252 offset:34816
    ds_read_b128 v[140:143], v252 offset:35840
    s_waitcnt lgkmcnt(0)
    v_mfma_f32_16x16x32_bf16 v[124:127], v[120:123], v[128:131], v[124:127]
    v_mfma_f32_16x16x32_bf16 v[124:127], v[120:123], v[132:135], v[124:127]
    v_mfma_f32_16x16x32_bf16 v[124:127], v[120:123], v[136:139], v[124:127]
    v_mfma_f32_16x16x32_bf16 v[124:127], v[120:123], v[140:143], v[124:127]
    s_nop 7
qc_43:
    s_waitcnt vmcnt(5)
    s_barrier
    s_add_u32 m0, s91, 135168
    s_mov_b64 exec, s[84:85]
    buffer_load_dwordx4 v221, s[36:39], s94 offen lds
    s_mov_b64 exec, -1
    s_add_u32 m0, s62, 137216
    s_nop 0
    buffer_load_dwordx4 v217, s[36:39], s94 offen lds
    buffer_load_dwordx4 v218, s[36:39], s94 offen offset:1024 lds
    s_add_u32 m0, s61, 32768
    s_mul_i32 s59, s93, 96
    buffer_load_dwordx4 v200, s[8:11], s59 offen lds
    buffer_load_dwordx4 v201, s[8:11], s59 offen offset:1024 lds
    buffer_load_dwordx4 v202, s[8:11], s59 offen offset:2048 lds
    s_add_u32 s93, s93, 2048
    s_and_b32 s93, s93, 65535
    s_and_b32 s55, s40, 3
    s_cmp_lg_u32 s55, 3
    s_cbranch_scc1 qc_44
    ds_read_b128 v[128:131], v172 offset:0
    ds_read_b128 v[132:135], v172 offset:1024
    ds_read_b128 v[136:139], v172 offset:2048
    ds_read_b128 v[140:143], v172 offset:3072
    s_waitcnt lgkmcnt(0)
    v_mfma_f32_16x16x32_bf16 v[124:127], v[120:123], v[128:131], 0
    v_mfma_f32_16x16x32_bf16 v[124:127], v[120:123], v[132:135], v[124:127]
    v_mfma_f32_16x16x32_bf16 v[124:127], v[120:123], v[136:139], v[124:127]
    v_mfma_f32_16x16x32_bf16 v[124:127], v[120:123], v[140:143], v[124:127]
    s_nop 7
qc_44:
    s_waitcnt vmcnt(6)
    s_barrier
    s_add_u32 m0, s62, 137216
    s_nop 0
    buffer_load_dwordx4 v219, s[36:39], s94 offen offset:2048 lds
    buffer_load_dwordx4 v220, s[36:39], s94 offen offset:3072 lds
    s_add_u32 s94, s94, 256
    s_and_b32 s94, s94, 2047
    s_add_u32 m0, s61, 49152
    s_mul_i32 s59, s93, 96
    buffer_load_dwordx4 v200, s[8:11], s59 offen lds
    buffer_load_dwordx4 v201, s[8:11], s59 offen offset:1024 lds
    buffer_load_dwordx4 v202, s[8:11], s59 offen offset:2048 lds
    s_add_u32 s93, s93, 6144
    s_and_b32 s93, s93, 65535
    s_and_b32 s55, s40, 3
    s_cmp_lg_u32 s55, 3
    s_cbranch_scc1 qc_45
    ds_read_b128 v[128:131], v172 offset:16384
    ds_read_b128 v[132:135], v172 offset:17408
    ds_read_b128 v[136:139], v172 offset:18432
    ds_read_b128 v[140:143], v172 offset:19456
    s_waitcnt lgkmcnt(0)
    v_mfma_f32_16x16x32_bf16 v[124:127], v[120:123], v[128:131], v[124:127]
    v_mfma_f32_16x16x32_bf16 v[124:127], v[120:123], v[132:135], v[124:127]
    v_mfma_f32_16x16x32_bf16 v[124:127], v[120:123], v[136:139], v[124:127]
    v_mfma_f32_16x16x32_bf16 v[124:127], v[120:123], v[140:143], v[124:127]
    s_nop 7
qc_45:
    s_waitcnt vmcnt(5)
    s_barrier
    s_add_u32 m0, s91, 98304
    s_mov_b64 exec, s[84:85]
    buffer_load_dwordx4 v221, s[36:39], s94 offen lds
    s_mov_b64 exec, -1
    v_add_f32_dpp v124, v124, v124 row_ror:8 row_mask:0xf bank_mask:0xf
    s_add_u32 m0, s62, 100352
    s_nop 0
    buffer_load_dwordx4 v217, s[36:39], s94 offen lds
    v_add_f32_dpp v125, v125, v125 row_ror:8 row_mask:0xf bank_mask:0xf
    buffer_load_dwordx4 v218, s[36:39], s94 offen offset:1024 lds
    v_add_f32_dpp v126, v126, v126 row_ror:8 row_mask:0xf bank_mask:0xf
    v_add_f32_dpp v127, v127, v127 row_ror:8 row_mask:0xf bank_mask:0xf
    s_add_u32 m0, s61, 65536
    s_mul_i32 s59, s93, 96
    buffer_load_dwordx4 v200, s[8:11], s59 offen lds
    v_and_b32 v224, 0x70, v254
    buffer_load_dwordx4 v201, s[8:11], s59 offen offset:1024 lds
    v_lshrrev_b32 v225, 4, v254
    buffer_load_dwordx4 v202, s[8:11], s59 offen offset:2048 lds
    s_add_u32 s93, s93, 2048
    s_and_b32 s93, s93, 65535
    v_and_b32 v225, 16, v225
    v_lshl_add_u32 v224, v224, 1, v225
    s_mul_i32 s55, s40, 12288
    s_lshl_b32 s56, s42, 12
    s_add_u32 s55, s55, s56
    s_lshl_b32 s56, s51, 8
    s_add_u32 s55, s55, s56
    s_add_u32 s55, s55, 70516736
    s_cmp_lt_u32 s42, 3
    s_cselect_b32 s55, s55, 2130706432
    s_mov_b64 exec, 0x00ff00ff
    buffer_store_dwordx4 v[124:127], v224, s[4:7], s55 offen sc0 sc1
    s_mov_b64 exec, -1
    s_waitcnt vmcnt(7)
    s_barrier
    s_add_u32 m0, s62, 100352
    s_nop 0
    buffer_load_dwordx4 v219, s[36:39], s94 offen offset:2048 lds
    v_lshrrev_b32 v224, 7, v254
    v_and_b32 v225, 0x70, v254
    buffer_load_dwordx4 v220, s[36:39], s94 offen offset:3072 lds
    s_add_u32 s94, s94, 256
    s_and_b32 s94, s94, 2047
    v_and_b32 v226, 6, v224
    v_lshlrev_b32 v226, 4, v226
    s_add_u32 m0, s61, 81920
    s_mul_i32 s59, s93, 96
    buffer_load_dwordx4 v200, s[8:11], s59 offen lds
    v_xor_b32 v225, v225, v226
    v_mul_u32_u24 v224, 2048, v224
    buffer_load_dwordx4 v201, s[8:11], s59 offen offset:1024 lds
    v_add3_u32 v203, v224, v225, s64
    v_add_u32 v204, 15360, v203
    buffer_load_dwordx4 v202, s[8:11], s59 offen offset:2048 lds
    s_add_u32 s93, s93, 6144
    s_and_b32 s93, s93, 65535
    v_add_u32 v205, 30720, v203
    v_add_u32 v206, 46080, v203
    s_waitcnt vmcnt(6)
    s_barrier
    s_add_u32 m0, s91, 116736
    s_mov_b64 exec, s[84:85]
    buffer_load_dwordx4 v221, s[36:39], s94 offen lds
    s_mov_b64 exec, -1
    s_add_u32 m0, s62, 118784
    s_nop 0
    buffer_load_dwordx4 v217, s[36:39], s94 offen lds
    buffer_load_dwordx4 v218, s[36:39], s94 offen offset:1024 lds
    s_add_u32 m0, s61, 0
    s_mul_i32 s59, s93, 96
    buffer_load_dwordx4 v200, s[8:11], s59 offen lds
    buffer_load_dwordx4 v201, s[8:11], s59 offen offset:1024 lds
    buffer_load_dwordx4 v202, s[8:11], s59 offen offset:2048 lds
    s_add_u32 s93, s93, 2048
    s_and_b32 s93, s93, 65535
    s_waitcnt vmcnt(6)
    s_barrier
    s_add_u32 m0, s62, 118784
    s_nop 0
    buffer_load_dwordx4 v219, s[36:39], s94 offen offset:2048 lds
    buffer_load_dwordx4 v220, s[36:39], s94 offen offset:3072 lds
    s_add_u32 s94, s94, 384
    s_and_b32 s94, s94, 2047
    s_add_u32 m0, s61, 16384
    s_mul_i32 s59, s93, 96
    buffer_load_dwordx4 v200, s[8:11], s59 offen lds
    buffer_load_dwordx4 v201, s[8:11], s59 offen offset:1024 lds
    buffer_load_dwordx4 v202, s[8:11], s59 offen offset:2048 lds
    s_add_u32 s93, s93, 6144
    s_and_b32 s93, s93, 65535
    s_cmp_lg_u32 s42, 1
    s_cbranch_scc1 hs_46
    v_mov_b32 v252, 0
    v_mov_b32 v253, 1
    s_lshl_b32 s55, s2, 2
    s_add_u32 s55, s55, 71565312
    s_mov_b64 exec, 1
    buffer_store_dword v253, v252, s[4:7], s55 offen sc0 sc1
    s_mov_b64 exec, -1
hs_46:
    s_waitcnt vmcnt(5)
    s_barrier
    s_add_u32 m0, s91, 135168
    s_mov_b64 exec, s[84:85]
    buffer_load_dwordx4 v221, s[36:39], s94 offen lds
    s_mov_b64 exec, -1
    s_add_u32 m0, s62, 137216
    s_nop 0
    buffer_load_dwordx4 v217, s[36:39], s94 offen lds
    buffer_load_dwordx4 v218, s[36:39], s94 offen offset:1024 lds
    s_add_u32 m0, s61, 32768
    s_mul_i32 s59, s93, 96
    buffer_load_dwordx4 v200, s[8:11], s59 offen lds
    buffer_load_dwordx4 v201, s[8:11], s59 offen offset:1024 lds
    buffer_load_dwordx4 v202, s[8:11], s59 offen offset:2048 lds
    s_add_u32 s93, s93, 2048
    s_and_b32 s93, s93, 65535
    s_and_b32 s55, s40, 3
    s_lshl_b32 s55, s55, 2
    s_lshr_b32 s56, s40, 2
    s_add_u32 s55, s55, s56
    s_mul_i32 s55, s55, 10
    s_lshr_b32 s95, s55, 4
    s_cmp_lg_u32 s95, 0
    s_cbranch_scc1 jb_47
    s_call_b64 s[70:71], Y_burst
jb_47:
    s_waitcnt vmcnt(6)
    s_barrier
    s_add_u32 m0, s62, 137216
    s_nop 0
    buffer_load_dwordx4 v219, s[36:39], s94 offen offset:2048 lds
    buffer_load_dwordx4 v220, s[36:39], s94 offen offset:3072 lds
    s_add_u32 s94, s94, 256
    s_and_b32 s94, s94, 2047
    s_add_u32 m0, s61, 49152
    s_mul_i32 s59, s93, 96
    buffer_load_dwordx4 v200, s[8:11], s59 offen lds
    buffer_load_dwordx4 v201, s[8:11], s59 offen offset:1024 lds
    buffer_load_dwordx4 v202, s[8:11], s59 offen offset:2048 lds
    s_add_u32 s93, s93, 10240
    s_and_b32 s93, s93, 65535
    s_cmp_lg_u32 s95, 1
    s_cbranch_scc1 jb_48
    s_call_b64 s[70:71], Y_burst
jb_48:
    s_waitcnt vmcnt(5)
    s_barrier
    s_add_u32 m0, s91, 98304
    s_mov_b64 exec, s[84:85]
    buffer_load_dwordx4 v221, s[36:39], s94 offen lds
    s_mov_b64 exec, -1
    s_add_u32 m0, s62, 100352
    s_nop 0
    buffer_load_dwordx4 v217, s[36:39], s94 offen lds
    buffer_load_dwordx4 v218, s[36:39], s94 offen offset:1024 lds
    s_add_u32 m0, s61, 65536
    s_mul_i32 s59, s93, 96
    buffer_load_dwordx4 v200, s[8:11], s59 offen lds
    buffer_load_dwordx4 v201, s[8:11], s59 offen offset:1024 lds
    buffer_load_dwordx4 v202, s[8:11], s59 offen offset:2048 lds
    s_add_u32 s93, s93, 2048
    s_and_b32 s93, s93, 65535
    s_cmp_lg_u32 s95, 2
    s_cbranch_scc1 jb_49
    s_call_b64 s[70:71], Y_burst
jb_49:
    s_waitcnt vmcnt(6)
    s_barrier
    v_lshlrev_b32 v227, 1, v254
    v_and_b32 v227, 0xff, v227
    buffer_load_dword v98, v227, s[32:35], 0 offen sc0 sc1
    s_add_u32 m0, s62, 100352
    s_nop 0
    buffer_load_dwordx4 v219, s[36:39], s94 offen offset:2048 lds
    buffer_load_dwordx4 v220, s[36:39], s94 offen offset:3072 lds
    s_add_u32 s94, s94, 256
    s_and_b32 s94, s94, 2047
    s_add_u32 m0, s61, 81920
    s_mul_i32 s59, s93, 96
    buffer_load_dwordx4 v200, s[8:11], s59 offen lds
    buffer_load_dwordx4 v201, s[8:11], s59 offen offset:1024 lds
    buffer_load_dwordx4 v202, s[8:11], s59 offen offset:2048 lds
    s_add_u32 s93, s93, 6144
    s_and_b32 s93, s93, 65535
    s_cmp_lg_u32 s95, 3
    s_cbranch_scc1 jb_50
    s_call_b64 s[70:71], Y_burst
jb_50:
    s_waitcnt vmcnt(6)
    s_barrier
    s_add_u32 m0, s91, 116736
    s_mov_b64 exec, s[84:85]
    buffer_load_dwordx4 v221, s[36:39], s94 offen lds
    s_mov_b64 exec, -1
    s_add_u32 m0, s62, 118784
    s_nop 0
    buffer_load_dwordx4 v217, s[36:39], s94 offen lds
    buffer_load_dwordx4 v218, s[36:39], s94 offen offset:1024 lds
    s_add_u32 m0, s61, 0
    s_mul_i32 s59, s93, 96
    buffer_load_dwordx4 v200, s[8:11], s59 offen lds
    buffer_load_dwordx4 v201, s[8:11], s59 offen offset:1024 lds
    buffer_load_dwordx4 v202, s[8:11], s59 offen offset:2048 lds
    s_add_u32 s93, s93, 2048
    s_and_b32 s93, s93, 65535
    s_cmp_lg_u32 s95, 4
    s_cbranch_scc1 jb_51
    s_call_b64 s[70:71], Y_burst
jb_51:
    s_waitcnt vmcnt(6)
    s_barrier
    s_add_u32 m0, s62, 118784
    s_nop 0
    buffer_load_dwordx4 v219, s[36:39], s94 offen offset:2048 lds
    buffer_load_dwordx4 v220, s[36:39], s94 offen offset:3072 lds
    s_add_u32 s94, s94, 256
    s_and_b32 s94, s94, 2047
    s_add_u32 m0, s61, 16384
    s_mul_i32 s59, s93, 96
    buffer_load_dwordx4 v200, s[8:11], s59 offen lds
    buffer_load_dwordx4 v201, s[8:11], s59 offen offset:1024 lds
    buffer_load_dwordx4 v202, s[8:11], s59 offen offset:2048 lds
    s_add_u32 s93, s93, 6144
    s_and_b32 s93, s93, 65535
    s_cmp_lg_u32 s95, 5
    s_cbranch_scc1 jb_52
    s_call_b64 s[70:71], Y_burst
jb_52:
    s_waitcnt vmcnt(5)
    s_barrier
    s_mov_b32 s56, 262144
hs_54:
    v_and_b32 v225, 63, v98
    v_cmp_ne_u32 vcc, 32, v225
    s_cbranch_vccz hs_55
    buffer_load_dword v98, v227, s[32:35], 0 offen sc0 sc1
    s_waitcnt vmcnt(0)
    s_sub_u32 s56, s56, 1
    s_cmp_lg_u32 s56, 0
    s_cbranch_scc1 hs_54
hs_55:
    s_mov_b32 s55, 71565312
    buffer_load_dwordx4 v[72:75], v254, s[4:7], s55 offen sc0 sc1
    s_add_u32 m0, s91, 135168
    s_mov_b64 exec, s[84:85]
    buffer_load_dwordx4 v221, s[36:39], s94 offen lds
    s_mov_b64 exec, -1
    s_add_u32 m0, s62, 137216
    s_nop 0
    buffer_load_dwordx4 v217, s[36:39], s94 offen lds
    buffer_load_dwordx4 v218, s[36:39], s94 offen offset:1024 lds
    s_add_u32 m0, s61, 32768
    s_mul_i32 s59, s93, 96
    buffer_load_dwordx4 v200, s[8:11], s59 offen lds
    buffer_load_dwordx4 v201, s[8:11], s59 offen offset:1024 lds
    buffer_load_dwordx4 v202, s[8:11], s59 offen offset:2048 lds
    s_add_u32 s93, s93, 2048
    s_and_b32 s93, s93, 65535
    s_and_b32 s55, s2, 7
    s_lshl_b32 s56, s77, 5
    v_readlane_b32 s55, v98, s55
    s_nop 3
    s_cmp_lg_u32 s55, s56
    s_cselect_b32 s45, 1, 0
    v_mov_b32 v224, 163712
    v_mov_b32 v225, s45
    s_mov_b64 exec, 1
    ds_write_b32 v224, v225
    s_mov_b64 exec, -1
    s_cmp_lg_u32 s95, 6
    s_cbranch_scc1 jb_53
    s_call_b64 s[70:71], Y_burst
jb_53:
    s_waitcnt vmcnt(7)
    s_barrier
    s_add_u32 m0, s62, 137216
    s_nop 0
    buffer_load_dwordx4 v219, s[36:39], s94 offen offset:2048 lds
    v_and_b32 v173, 0xf0, v254
    buffer_load_dwordx4 v220, s[36:39], s94 offen offset:3072 lds
    s_add_u32 s94, s94, 256
    s_and_b32 s94, s94, 2047
    v_min_u32 v173, 0xb0, v173
    s_mul_i32 s55, s42, 192
    v_add_u32 v173, s55, v173
    s_add_u32 m0, s61, 49152
    s_mul_i32 s59, s93, 96
    buffer_load_dwordx4 v200, s[8:11], s59 offen lds
    v_lshrrev_b32 v224, 8, v173
    v_and_b32 v225, 0xff, v173
    buffer_load_dwordx4 v201, s[8:11], s59 offen offset:1024 lds
    v_lshl_add_u32 v224, v224, 12, v225
    v_lshrrev_b32 v225, 8, v254
    buffer_load_dwordx4 v202, s[8:11], s59 offen offset:2048 lds
    s_add_u32 s93, s93, 6144
    s_and_b32 s93, s93, 65535
    v_mul_u32_u24 v225, 12288, v225
    s_lshl_b32 s55, s51, 8
    v_add3_u32 v174, v224, v225, s55
    s_cmp_lg_u32 s95, 7
    s_cbranch_scc1 jb_56
    s_call_b64 s[70:71], Y_burst
jb_56:
    s_waitcnt vmcnt(5)
    s_barrier
    s_add_u32 m0, s91, 98304
    s_mov_b64 exec, s[84:85]
    buffer_load_dwordx4 v221, s[36:39], s94 offen lds
    s_mov_b64 exec, -1
    s_add_u32 m0, s62, 100352
    s_nop 0
    buffer_load_dwordx4 v217, s[36:39], s94 offen lds
    buffer_load_dwordx4 v218, s[36:39], s94 offen offset:1024 lds
    s_add_u32 m0, s61, 65536
    s_mul_i32 s59, s93, 96
    buffer_load_dwordx4 v200, s[8:11], s59 offen lds
    buffer_load_dwordx4 v201, s[8:11], s59 offen offset:1024 lds
    buffer_load_dwordx4 v202, s[8:11], s59 offen offset:2048 lds
    s_add_u32 s93, s93, 2048
    s_and_b32 s93, s93, 65535
    s_cmp_lg_u32 s95, 8
    s_cbranch_scc1 jb_57
    s_call_b64 s[70:71], Y_burst
jb_57:
    s_waitcnt vmcnt(6)
    s_barrier
    v_and_b32 v72, v72, v73
    v_and_b32 v74, v74, v75
    v_and_b32 v72, v72, v74
    v_cmp_ne_u32 vcc, 1, v72
    s_cbranch_vccz a4_59
    s_mov_b32 s55, 71565312
    s_mov_b32 s56, 262144
p4_60:
    buffer_load_dwordx4 v[72:75], v254, s[4:7], s55 offen sc0 sc1
    s_waitcnt vmcnt(0)
    v_and_b32 v72, v72, v73
    v_and_b32 v74, v74, v75
    v_and_b32 v72, v72, v74
    v_cmp_ne_u32 vcc, 1, v72
    s_cbranch_vccz p4_61
    s_sleep 1
    s_sub_u32 s56, s56, 1
    s_cmp_lg_u32 s56, 0
    s_cbranch_scc1 p4_60
p4_61:
a4_59:
    s_add_u32 m0, s62, 100352
    s_nop 0
    buffer_load_dwordx4 v219, s[36:39], s94 offen offset:2048 lds
    buffer_load_dwordx4 v220, s[36:39], s94 offen offset:3072 lds
    s_add_u32 s94, s94, 256
    s_and_b32 s94, s94, 2047
    v_and_b32 v226, 0xf0, v254
    v_and_b32 v227, 0x300, v254
    v_lshl_add_u32 v227, v227, 2, v226
    s_lshl_b32 s78, s42, 8
    s_add_u32 s78, s78, s53
    s_add_u32 s78, s78, 65536
    s_add_u32 m0, s61, 81920
    s_mul_i32 s59, s93, 96
    buffer_load_dwordx4 v200, s[8:11], s59 offen lds
    buffer_load_dwordx4 v[144:147], v227, s[4:7], s78 offen
    s_add_u32 s78, s78, 4096
    buffer_load_dwordx4 v201, s[8:11], s59 offen offset:1024 lds
    buffer_load_dwordx4 v[148:151], v227, s[4:7], s78 offen
    s_add_u32 s78, s78, 4096
    buffer_load_dwordx4 v202, s[8:11], s59 offen offset:2048 lds
    s_add_u32 s93, s93, 6144
    s_and_b32 s93, s93, 65535
    buffer_load_dwordx4 v[152:155], v227, s[4:7], s78 offen
    s_add_u32 s78, s78, 4096
    s_cmp_lg_u32 s95, 9
    s_cbranch_scc1 jb_58
    s_call_b64 s[70:71], Y_burst
jb_58:
    s_waitcnt vmcnt(8)
    s_barrier
    s_add_u32 m0, s91, 116736
    s_mov_b64 exec, s[84:85]
    buffer_load_dwordx4 v221, s[36:39], s94 offen lds
    s_mov_b64 exec, -1
    s_add_u32 m0, s62, 118784
    s_nop 0
    buffer_load_dwordx4 v217, s[36:39], s94 offen lds
    buffer_load_dwordx4 v[156:159], v227, s[4:7], s78 offen
    s_add_u32 s78, s78, 4096
    buffer_load_dwordx4 v218, s[36:39], s94 offen offset:1024 lds
    v_lshrrev_b32 v224, 7, v254
    v_and_b32 v175, 0x70, v254
    v_lshl_add_u32 v224, v224, 10, v175
    s_sub_u32 s70, s53, 4127872
    s_cmp_eq_u32 s40, 0
    s_cselect_b32 s70, 2130706432, s70
    s_add_u32 m0, s61, 0
    s_mul_i32 s59, s93, 96
    buffer_load_dwordx4 v200, s[8:11], s59 offen lds
    buffer_load_dwordx4 v201, s[8:11], s59 offen offset:1024 lds
    buffer_load_dwordx4 v[164:167], v224, s[4:7], s70 offen
    s_add_u32 s70, s70, 8192
    buffer_load_dwordx4 v202, s[8:11], s59 offen offset:2048 lds
    s_add_u32 s93, s93, 2048
    s_and_b32 s93, s93, 65535
    buffer_load_dwordx4 v[168:171], v224, s[4:7], s70 offen
    s_add_u32 s70, s70, 8192
    s_waitcnt vmcnt(10)
    s_barrier
    s_add_u32 m0, s62, 118784
    s_nop 0
    buffer_load_dwordx4 v219, s[36:39], s94 offen offset:2048 lds
    buffer_load_dwordx4 v220, s[36:39], s94 offen offset:3072 lds
    s_add_u32 s94, s94, 256
    s_and_b32 s94, s94, 2047
    s_add_u32 m0, s61, 16384
    s_mul_i32 s59, s93, 96
    buffer_load_dwordx4 v200, s[8:11], s59 offen lds
    s_mov_b32 s55, 70516736
    buffer_load_dwordx4 v[76:79], v174, s[4:7], s55 offen sc1
    buffer_load_dwordx4 v201, s[8:11], s59 offen offset:1024 lds
    buffer_load_dwordx4 v202, s[8:11], s59 offen offset:2048 lds
    s_add_u32 s93, s93, 6144
    s_and_b32 s93, s93, 65535
    s_mov_b32 s55, 70565888
    buffer_load_dwordx4 v[80:83], v174, s[4:7], s55 offen sc1
    s_waitcnt vmcnt(8)
    s_barrier
    s_add_u32 m0, s91, 135168
    s_mov_b64 exec, s[84:85]
    buffer_load_dwordx4 v221, s[36:39], s94 offen lds
    s_mov_b64 exec, -1
    s_mov_b32 s55, 70615040
    buffer_load_dwordx4 v[84:87], v174, s[4:7], s55 offen sc1
    s_mov_b32 s55, 70664192
    buffer_load_dwordx4 v[88:91], v174, s[4:7], s55 offen sc1
    v_add_f32 v144, v144, v148
    v_add_f32 v145, v145, v149
    s_add_u32 m0, s62, 137216
    s_nop 0
    buffer_load_dwordx4 v217, s[36:39], s94 offen lds
    v_add_f32 v146, v146, v150
    v_add_f32 v147, v147, v151
    v_add_f32 v152, v152, v156
    v_add_f32 v153, v153, v157
    v_add_f32 v154, v154, v158
    buffer_load_dwordx4 v218, s[36:39], s94 offen offset:1024 lds
    v_add_f32 v155, v155, v159
    v_add_f32 v160, v144, v152
    v_add_f32 v161, v145, v153
    v_add_f32 v162, v146, v154
    s_add_u32 m0, s61, 32768
    s_mul_i32 s59, s93, 96
    buffer_load_dwordx4 v200, s[8:11], s59 offen lds
    v_add_f32 v163, v147, v155
    v_mov_b32 v144, v160
    v_mov_b32 v145, v161
    v_mov_b32 v146, v162
    v_mov_b32 v147, v163
    buffer_load_dwordx4 v201, s[8:11], s59 offen offset:1024 lds
    s_nop 1
    v_permlane16_swap_b32 v160, v144
    v_permlane16_swap_b32 v161, v145
    v_permlane16_swap_b32 v162, v146
    buffer_load_dwordx4 v202, s[8:11], s59 offen offset:2048 lds
    s_add_u32 s93, s93, 2048
    s_and_b32 s93, s93, 65535
    v_permlane16_swap_b32 v163, v147
    v_add_f32 v160, v160, v144
    v_add_f32 v161, v161, v145
    v_add_f32 v162, v162, v146
    v_add_f32 v163, v163, v147
    s_waitcnt vmcnt(9)
    s_barrier
    s_add_u32 m0, s62, 137216
    s_nop 0
    buffer_load_dwordx4 v219, s[36:39], s94 offen offset:2048 lds
    s_lshr_b32 s55, s2, 3
    s_lshl_b32 s55, s55, 1
    s_add_u32 s55, s55, s44
    s_and_b32 s56, s2, 7
    s_lshl_b32 s90, s43, 3
    s_add_u32 s90, s90, s56
    s_lshl_b32 s90, s90, 7
    s_add_u32 s90, s90, s55
    s_lshl_b32 s90, s90, 10
    s_add_u32 s90, s90, 67108864
    s_mul_i32 s55, s55, 114688
    s_mul_i32 s56, s56, 896
    s_add_u32 s70, s55, s56
    buffer_load_dwordx4 v[64:67], v97, s[16:19], s70 offen offset:384
    buffer_load_dwordx4 v[68:71], v97, s[16:19], s70 offen offset:448
    buffer_load_dwordx4 v220, s[36:39], s94 offen offset:3072 lds
    s_add_u32 s94, s94, 256
    s_and_b32 s94, s94, 2047
    v_mov_b32 v144, v160
    v_mov_b32 v145, v161
    v_mov_b32 v146, v162
    s_add_u32 m0, s61, 49152
    s_mul_i32 s59, s93, 96
    buffer_load_dwordx4 v200, s[8:11], s59 offen lds
    v_mov_b32 v147, v163
    s_nop 1
    v_permlane32_swap_b32 v160, v144
    buffer_load_dwordx4 v201, s[8:11], s59 offen offset:1024 lds
    v_permlane32_swap_b32 v161, v145
    v_permlane32_swap_b32 v162, v146
    v_permlane32_swap_b32 v163, v147
    buffer_load_dwordx4 v202, s[8:11], s59 offen offset:2048 lds
    s_add_u32 s93, s93, 6144
    s_and_b32 s93, s93, 65535
    v_add_f32 v160, v160, v144
    v_add_f32 v161, v161, v145
    v_add_f32 v162, v162, v146
    v_add_f32 v163, v163, v147
    s_waitcnt vmcnt(7)
    s_barrier
    s_add_u32 m0, s91, 98304
    s_mov_b64 exec, s[84:85]
    buffer_load_dwordx4 v221, s[36:39], s94 offen lds
    s_mov_b64 exec, -1
    v_mul_f32 v160, 0x3a800000, v160
    v_mul_f32 v161, 0x3a800000, v161
    s_add_u32 m0, s62, 100352
    s_nop 0
    buffer_load_dwordx4 v217, s[36:39], s94 offen lds
    v_fma_f32 v161, -v160, v160, v161
    v_max_f32 v161, 0, v161
    v_cvt_pk_bf16_f32 v160, v160, v160
    buffer_load_dwordx4 v218, s[36:39], s94 offen offset:1024 lds
    v_lshlrev_b32 v160, 16, v160
    v_cvt_pk_bf16_f32 v161, v161, v161
    v_lshlrev_b32 v161, 16, v161
    s_add_u32 m0, s61, 65536
    s_mul_i32 s59, s93, 96
    buffer_load_dwordx4 v200, s[8:11], s59 offen lds
    v_add_f32 v161, 0x3727c5ac, v161
    v_cvt_pk_bf16_f32 v161, v161, v161
    v_lshlrev_b32 v161, 16, v161
    buffer_load_dwordx4 v201, s[8:11], s59 offen offset:1024 lds
    v_sqrt_f32 v161, v161
    s_nop 0
    v_cvt_pk_bf16_f32 v161, v161, v161
    buffer_load_dwordx4 v202, s[8:11], s59 offen offset:2048 lds
    s_add_u32 s93, s93, 2048
    s_and_b32 s93, s93, 65535
    v_lshlrev_b32 v161, 16, v161
    v_rcp_f32 v161, v161
    s_nop 0
    s_waitcnt vmcnt(6)
    s_barrier
    s_add_u32 m0, s62, 100352
    s_nop 0
    buffer_load_dwordx4 v219, s[36:39], s94 offen offset:2048 lds
    v_mul_f32 v162, 0x3a800000, v162
    v_mul_f32 v163, 0x3a800000, v163
    v_fma_f32 v163, -v162, v162, v163
    v_max_f32 v163, 0, v163
    v_cvt_pk_bf16_f32 v162, v162, v162
    buffer_load_dwordx4 v220, s[36:39], s94 offen offset:3072 lds
    v_lshlrev_b32 v162, 16, v162
    v_cvt_pk_bf16_f32 v163, v163, v163
    v_lshlrev_b32 v163, 16, v163
    v_add_f32 v163, 0x3727c5ac, v163
    v_cvt_pk_bf16_f32 v163, v163, v163
    s_add_u32 m0, s61, 81920
    s_mul_i32 s59, s93, 96
    buffer_load_dwordx4 v200, s[8:11], s59 offen lds
    v_lshlrev_b32 v163, 16, v163
    v_sqrt_f32 v163, v163
    s_nop 0
    v_cvt_pk_bf16_f32 v163, v163, v163
    v_lshlrev_b32 v163, 16, v163
    v_rcp_f32 v163, v163
    buffer_load_dwordx4 v201, s[8:11], s59 offen offset:1024 lds
    s_nop 0
    v_lshrrev_b32 v226, 1, v226
    s_lshl_b32 s55, s42, 7
    s_add_u32 s55, s55, 159808
    v_add_u32 v226, s55, v226
    v_sub_f32 v160, 0, v160
    v_sub_f32 v162, 0, v162
    s_mov_b64 exec, 0xffff
    ds_write2_b32 v226, v160, v162 offset0:0 offset1:1
    ds_write2_b32 v226, v161, v163 offset0:144 offset1:145
    s_mov_b64 exec, -1
    v_add_f32 v164, v164, v168
    v_add_f32 v165, v165, v169
    v_add_f32 v166, v166, v170
    buffer_load_dwordx4 v202, s[8:11], s59 offen offset:2048 lds
    s_add_u32 s93, s93, 6144
    s_and_b32 s93, s93, 65535
    v_add_f32 v167, v167, v171
    s_nop 1
    v_add_f32_dpp v164, v164, v164 row_ror:8 row_mask:0xf bank_mask:0xf
    v_add_f32_dpp v165, v165, v165 row_ror:8 row_mask:0xf bank_mask:0xf
    v_add_f32_dpp v166, v166, v166 row_ror:8 row_mask:0xf bank_mask:0xf
    v_add_f32_dpp v167, v167, v167 row_ror:8 row_mask:0xf bank_mask:0xf
    s_waitcnt vmcnt(5)
    s_barrier
    s_add_u32 m0, s61, 0
    s_mul_i32 s59, s93, 96
    buffer_load_dwordx4 v200, s[8:11], s59 offen lds
    v_mov_b32 v168, v164
    v_mov_b32 v169, v165
    v_mov_b32 v170, v166
    v_mov_b32 v171, v167
    buffer_load_dwordx4 v201, s[8:11], s59 offen offset:1024 lds
    s_nop 1
    v_permlane16_swap_b32 v164, v168
    v_permlane16_swap_b32 v165, v169
    v_permlane16_swap_b32 v166, v170
    buffer_load_dwordx4 v202, s[8:11], s59 offen offset:2048 lds
    s_add_u32 s93, s93, 2048
    s_and_b32 s93, s93, 65535
    v_permlane16_swap_b32 v167, v171
    v_add_f32 v164, v164, v168
    v_add_f32 v165, v165, v169
    v_add_f32 v166, v166, v170
    v_add_f32 v167, v167, v171
    s_add_u32 m0, s61, 16384
    s_mul_i32 s59, s93, 96
    buffer_load_dwordx4 v200, s[8:11], s59 offen lds
    v_mov_b32 v168, v164
    v_mov_b32 v169, v165
    v_mov_b32 v170, v166
    v_mov_b32 v171, v167
    buffer_load_dwordx4 v201, s[8:11], s59 offen offset:1024 lds
    s_nop 1
    v_permlane32_swap_b32 v164, v168
    v_permlane32_swap_b32 v165, v169
    v_permlane32_swap_b32 v166, v170
    buffer_load_dwordx4 v202, s[8:11], s59 offen offset:2048 lds
    v_permlane32_swap_b32 v167, v171
    v_add_f32 v164, v164, v168
    v_add_f32 v165, v165, v169
    v_add_f32 v166, v166, v170
    v_add_f32 v167, v167, v171
    s_waitcnt vmcnt(6)
    s_barrier
    s_lshl_b32 s93, s43, 1
    s_add_u32 s93, s51, s93
    s_and_b32 s93, s93, 15
    s_add_u32 m0, s62, 32768
    s_lshl_b32 s93, s93, 17
    buffer_load_dwordx4 v203, s[12:15], s93 offen lds
    v_mul_f32 v164, 0x3a800000, v164
    v_mul_f32 v165, 0x3a800000, v165
    v_fma_f32 v165, -v164, v164, v165
    v_max_f32 v165, 0, v165
    buffer_load_dwordx4 v204, s[12:15], s93 offen offset:1024 lds
    v_cvt_pk_bf16_f32 v164, v164, v164
    v_lshlrev_b32 v164, 16, v164
    v_cvt_pk_bf16_f32 v165, v165, v165
    v_lshlrev_b32 v165, 16, v165
    v_add_f32 v165, 0x3727c5ac, v165
    buffer_load_dwordx4 v205, s[12:15], s93 offen offset:2048 lds
    v_cvt_pk_bf16_f32 v165, v165, v165
    v_lshlrev_b32 v165, 16, v165
    v_sqrt_f32 v165, v165
    s_nop 0
    v_cvt_pk_bf16_f32 v165, v165, v165
    buffer_load_dwordx4 v206, s[12:15], s93 offen offset:3072 lds
    s_add_u32 s93, s93, 524288
    s_and_b32 s93, s93, 2097151
    v_lshlrev_b32 v165, 16, v165
    v_rcp_f32 v165, v165
    s_nop 0
    v_mul_f32 v166, 0x3a800000, v166
    v_mul_f32 v167, 0x3a800000, v167
    s_add_u32 m0, s62, 49152
    s_nop 0
    buffer_load_dwordx4 v203, s[12:15], s93 offen lds
    v_fma_f32 v167, -v166, v166, v167
    v_max_f32 v167, 0, v167
    v_cvt_pk_bf16_f32 v166, v166, v166
    v_lshlrev_b32 v166, 16, v166
    v_cvt_pk_bf16_f32 v167, v167, v167
    buffer_load_dwordx4 v204, s[12:15], s93 offen offset:1024 lds
    v_lshlrev_b32 v167, 16, v167
    v_add_f32 v167, 0x3727c5ac, v167
    v_cvt_pk_bf16_f32 v167, v167, v167
    v_lshlrev_b32 v167, 16, v167
    v_sqrt_f32 v167, v167
    buffer_load_dwordx4 v205, s[12:15], s93 offen offset:2048 lds
    s_nop 0
    v_cvt_pk_bf16_f32 v167, v167, v167
    v_lshlrev_b32 v167, 16, v167
    v_rcp_f32 v167, v167
    s_nop 0
    buffer_load_dwordx4 v206, s[12:15], s93 offen offset:3072 lds
    s_add_u32 s93, s93, 524288
    s_and_b32 s93, s93, 2097151
    v_lshrrev_b32 v175, 1, v175
    v_add_u32 v175, 159744, v175
    v_sub_f32 v164, 0, v164
    v_sub_f32 v166, 0, v166
    s_lshl_b32 s55, s42, 1
    s_lshl_b64 exec, 3, s55
    ds_write2_b32 v175, v164, v166 offset0:0 offset1:1
    ds_write2_b32 v175, v165, v167 offset0:144 offset1:145
    s_mov_b64 exec, -1
    s_waitcnt vmcnt(11)
    s_barrier
    s_add_u32 m0, s62, 65536
    s_nop 0
    buffer_load_dwordx4 v203, s[12:15], s93 offen lds
    v_add_f32 v76, v76, v80
    v_add_f32 v77, v77, v81
    v_add_f32 v78, v78, v82
    buffer_load_dwordx4 v204, s[12:15], s93 offen offset:1024 lds
    v_add_f32 v79, v79, v83
    v_add_f32 v84, v84, v88
    v_add_f32 v85, v85, v89
    buffer_load_dwordx4 v205, s[12:15], s93 offen offset:2048 lds
    v_add_f32 v86, v86, v90
    v_add_f32 v87, v87, v91
    v_add_f32 v76, v76, v84
    buffer_load_dwordx4 v206, s[12:15], s93 offen offset:3072 lds
    s_add_u32 s93, s93, 524288
    s_and_b32 s93, s93, 2097151
    v_add_f32 v77, v77, v85
    v_add_f32 v78, v78, v86
    v_add_f32 v79, v79, v87
    s_add_u32 m0, s62, 81920
    s_nop 0
    buffer_load_dwordx4 v203, s[12:15], s93 offen lds
    v_mov_b32 v80, v76
    v_mov_b32 v81, v77
    v_mov_b32 v82, v78
    buffer_load_dwordx4 v204, s[12:15], s93 offen offset:1024 lds
    v_mov_b32 v83, v79
    s_nop 1
    v_permlane16_swap_b32 v76, v80
    buffer_load_dwordx4 v205, s[12:15], s93 offen offset:2048 lds
    v_permlane16_swap_b32 v77, v81
    v_permlane16_swap_b32 v78, v82
    v_permlane16_swap_b32 v79, v83
    buffer_load_dwordx4 v206, s[12:15], s93 offen offset:3072 lds
    s_add_u32 s93, s93, 655360
    s_and_b32 s93, s93, 2097151
    v_add_f32 v76, v76, v80
    v_add_f32 v77, v77, v81
    v_add_f32 v78, v78, v82
    v_add_f32 v79, v79, v83
    s_waitcnt vmcnt(16)
    s_barrier
    s_add_u32 m0, s62, 0
    s_nop 0
    buffer_load_dwordx4 v203, s[12:15], s93 offen lds
    v_mov_b32 v80, v76
    v_mov_b32 v81, v77
    v_mov_b32 v82, v78
    buffer_load_dwordx4 v204, s[12:15], s93 offen offset:1024 lds
    v_mov_b32 v83, v79
    s_nop 1
    v_permlane32_swap_b32 v76, v80
    v_permlane32_swap_b32 v77, v81
    buffer_load_dwordx4 v205, s[12:15], s93 offen offset:2048 lds
    v_permlane32_swap_b32 v78, v82
    v_permlane32_swap_b32 v79, v83
    v_add_f32 v76, v76, v80
    v_add_f32 v77, v77, v81
    buffer_load_dwordx4 v206, s[12:15], s93 offen offset:3072 lds
    s_add_u32 s93, s93, 524288
    s_and_b32 s93, s93, 2097151
    v_add_f32 v78, v78, v82
    v_add_f32 v79, v79, v83
    v_add_u32 v173, 160896, v173
    s_mov_b64 exec, 0xfff
    ds_write_b128 v173, v[76:79]
    s_mov_b64 exec, -1
    s_waitcnt lgkmcnt(0)
    s_barrier
    s_add_u32 m0, s62, 16384
    s_nop 0
    buffer_load_dwordx4 v203, s[12:15], s93 offen lds
    buffer_load_dwordx4 v204, s[12:15], s93 offen offset:1024 lds
    buffer_load_dwordx4 v205, s[12:15], s93 offen offset:2048 lds
    buffer_load_dwordx4 v206, s[12:15], s93 offen offset:3072 lds
    s_add_u32 s93, s93, 524288
    s_and_b32 s93, s93, 2097151
    buffer_store_dwordx4 v[64:67], v254, s[4:7], s90 offen sc0 sc1
    s_add_u32 s90, s90, 65536
    buffer_store_dwordx4 v[68:71], v254, s[4:7], s90 offen sc0 sc1
    s_add_u32 s90, s90, 65536
    s_setprio 0
    s_branch Y_g2
Y_burst:
    buffer_load_dwordx4 v[0:3], v96, s[72:75], s76 offen
    s_add_u32 s76, s76, 57344
    buffer_load_dwordx4 v[4:7], v96, s[72:75], s76 offen
    s_add_u32 s76, s76, 57344
    buffer_load_dwordx4 v[8:11], v96, s[72:75], s76 offen
    s_add_u32 s76, s76, 57344
    buffer_load_dwordx4 v[12:15], v96, s[72:75], s76 offen
    s_add_u32 s76, s76, 57344
    buffer_load_dwordx4 v[16:19], v96, s[72:75], s76 offen
    s_add_u32 s76, s76, 57344
    buffer_load_dwordx4 v[20:23], v96, s[72:75], s76 offen
    s_add_u32 s76, s76, 57344
    buffer_load_dwordx4 v[24:27], v96, s[72:75], s76 offen
    s_add_u32 s76, s76, 57344
    buffer_load_dwordx4 v[28:31], v96, s[72:75], s76 offen
    s_add_u32 s76, s76, 57344
    buffer_load_dwordx4 v[32:35], v96, s[72:75], s76 offen
    s_add_u32 s76, s76, 57344
    buffer_load_dwordx4 v[36:39], v96, s[72:75], s76 offen
    s_add_u32 s76, s76, 57344
    buffer_load_dwordx4 v[40:43], v96, s[72:75], s76 offen
    s_add_u32 s76, s76, 57344
    buffer_load_dwordx4 v[44:47], v96, s[72:75], s76 offen
    s_add_u32 s76, s76, 57344
    buffer_load_dwordx4 v[48:51], v96, s[72:75], s76 offen
    s_add_u32 s76, s76, 57344
    buffer_load_dwordx4 v[52:55], v96, s[72:75], s76 offen
    s_add_u32 s76, s76, 57344
    buffer_load_dwordx4 v[56:59], v96, s[72:75], s76 offen
    s_add_u32 s76, s76, 57344
    buffer_load_dwordx4 v[60:63], v96, s[72:75], s76 offen
    s_add_u32 s76, s76, 57344
    s_setpc_b64 s[70:71]
Y_w2:
    v_lshlrev_b32 v252, 3, v254
    s_lshl_b32 s55, s40, 4
    s_add_u32 s55, s55, s51
    s_lshl_b32 s55, s55, 2
    s_add_u32 s55, s55, s42
    s_mul_i32 s55, s55, 7168
    s_mov_b32 exec_hi, 0xffffff
    buffer_load_dword v250, v252, s[20:23], s55 offen
    s_mov_b64 exec, -1
    s_setpc_b64 s[70:71]
Y_layer:
    s_mov_b32 s36, s4
    s_mov_b32 s37, s5
    s_mov_b32 s38, s6
    s_mov_b32 s39, s7
    s_add_u32 s88, s48, s62
    s_lshl_b32 s56, s43, 10
    s_add_u32 s89, s48, s56
    s_sub_u32 s89, s89, 4179968
    v_add_u32 v217, s88, v254
    s_lshl_b32 s94, s51, 14
    s_cmp_eq_u32 s40, 0
    s_cselect_b32 s89, 2130706432, s89
    s_sub_u32 s89, s89, s88
    v_add_u32 v221, s89, v217
    s_lshl_b32 s91, s43, 10
    s_cmp_eq_u32 s44, 0
    s_cselect_b32 s84, -1, 0
    s_not_b32 s85, s84
    s_add_u32 s59, s0, 4294967232
    s_add_u32 s60, s54, 8064
    s_and_b32 s55, s40, 3
    s_cselect_b32 s59, s59, s60
    s_cselect_b32 s60, 28, 60
    s_add_u32 s55, s0, 64
    s_cmp_eq_u32 s40, 0
    s_cselect_b32 s59, s55, s59
    s_cselect_b32 s60, 28, s60
    v_lshrrev_b32 v224, 2, v254
    v_and_b32 v224, 60, v224
    v_min_u32 v225, s60, v224
    v_add_u32 v225, s59, v225
    v_min_u32 v224, 28, v224
    v_add_u32 v224, s55, v224
    v_cmp_gt_u32 vcc, 256, v254
    v_lshlrev_b32 v226, 3, v254
    v_and_b32 v226, 0xfff, v226
    v_cndmask_b32 v224, v225, v224, vcc
    s_add_u32 s92, s88, s94
    s_barrier
    buffer_load_dword v251, v226, s[4:7], s92 offen sc0 sc1
    s_mov_b32 s56, 262144
poll_62:
    buffer_load_dword v225, v224, s[4:7], 0 offen sc0 sc1
    s_waitcnt vmcnt(0)
    v_cmp_ne_u32 vcc, 0x01010101, v225
    s_cbranch_vccz pd_63
    s_sleep 1
    s_sub_u32 s56, s56, 1
    s_cmp_lg_u32 s56, 0
    s_cbranch_scc1 poll_62
pd_63:
    s_add_u32 m0, s91, 98304
    s_mov_b64 exec, s[84:85]
    buffer_load_dwordx4 v221, s[36:39], s94 offen lds
    s_mov_b64 exec, -1
    s_add_u32 m0, s62, 100352
    s_nop 0
    buffer_load_dwordx4 v217, s[36:39], s94 offen lds
    buffer_load_dwordx4 v217, s[36:39], s94 offen offset:1024 lds
    buffer_load_dwordx4 v217, s[36:39], s94 offen offset:2048 lds
    buffer_load_dwordx4 v217, s[36:39], s94 offen offset:3072 lds
    s_add_u32 s94, s94, 32768
    s_and_b32 s94, s94, 262143
    s_add_u32 m0, s91, 116736
    s_mov_b64 exec, s[84:85]
    buffer_load_dwordx4 v221, s[36:39], s94 offen lds
    s_mov_b64 exec, -1
    s_add_u32 m0, s62, 118784
    s_nop 0
    buffer_load_dwordx4 v217, s[36:39], s94 offen lds
    buffer_load_dwordx4 v217, s[36:39], s94 offen offset:1024 lds
    buffer_load_dwordx4 v217, s[36:39], s94 offen offset:2048 lds
    buffer_load_dwordx4 v217, s[36:39], s94 offen offset:3072 lds
    s_add_u32 s94, s94, 32768
    s_and_b32 s94, s94, 262143
    s_add_u32 m0, s91, 135168
    s_mov_b64 exec, s[84:85]
    buffer_load_dwordx4 v221, s[36:39], s94 offen lds
    s_mov_b64 exec, -1
    s_add_u32 m0, s62, 137216
    s_nop 0
    buffer_load_dwordx4 v217, s[36:39], s94 offen lds
    buffer_load_dwordx4 v217, s[36:39], s94 offen offset:1024 lds
    buffer_load_dwordx4 v217, s[36:39], s94 offen offset:2048 lds
    buffer_load_dwordx4 v217, s[36:39], s94 offen offset:3072 lds
    s_add_u32 s94, s94, 32768
    s_and_b32 s94, s94, 262143
    s_setprio 1
    s_waitcnt vmcnt(10)
    s_barrier
    s_barrier
    s_add_u32 m0, s61, 0
    s_mul_i32 s59, s93, 96
    buffer_load_dwordx4 v200, s[8:11], s59 offen lds
    buffer_load_dwordx4 v201, s[8:11], s59 offen offset:1024 lds
    buffer_load_dwordx4 v202, s[8:11], s59 offen offset:2048 lds
    s_add_u32 s93, s93, 2048
    s_and_b32 s93, s93, 65535
    s_waitcnt vmcnt(8)
    s_barrier
    s_add_u32 m0, s91, 98304
    s_mov_b64 exec, s[84:85]
    buffer_load_dwordx4 v221, s[36:39], s94 offen lds
    s_mov_b64 exec, -1
    s_add_u32 m0, s62, 100352
    s_nop 0
    buffer_load_dwordx4 v217, s[36:39], s94 offen lds
    buffer_load_dwordx4 v217, s[36:39], s94 offen offset:1024 lds
    s_add_u32 m0, s61, 16384
    s_mul_i32 s59, s93, 96
    buffer_load_dwordx4 v200, s[8:11], s59 offen lds
    buffer_load_dwordx4 v201, s[8:11], s59 offen offset:1024 lds
    buffer_load_dwordx4 v202, s[8:11], s59 offen offset:2048 lds
    s_add_u32 s93, s93, 6144
    s_and_b32 s93, s93, 65535
    s_barrier
    s_add_u32 m0, s62, 100352
    s_nop 0
    buffer_load_dwordx4 v217, s[36:39], s94 offen offset:2048 lds
    buffer_load_dwordx4 v217, s[36:39], s94 offen offset:3072 lds
    s_add_u32 s94, s94, 32768
    s_and_b32 s94, s94, 262143
    s_add_u32 m0, s61, 32768
    s_mul_i32 s59, s93, 96
    buffer_load_dwordx4 v200, s[8:11], s59 offen lds
    buffer_load_dwordx4 v201, s[8:11], s59 offen offset:1024 lds
    buffer_load_dwordx4 v202, s[8:11], s59 offen offset:2048 lds
    s_add_u32 s93, s93, 2048
    s_and_b32 s93, s93, 65535
    s_cmp_lg_u32 s42, 0
    s_cbranch_scc1 wf_64
    s_lshl_b32 s55, s51, 2
    s_add_u32 s55, s55, s54
    v_mov_b32 v252, 14336
    v_mov_b32 v253, 0x01010101
    s_mov_b64 exec, 1
    buffer_store_dword v253, v252, s[4:7], s55 offen sc0 sc1
    s_mov_b64 exec, -1
wf_64:
    s_waitcnt vmcnt(14)
    s_barrier
    s_add_u32 m0, s91, 116736
    s_mov_b64 exec, s[84:85]
    buffer_load_dwordx4 v221, s[36:39], s94 offen lds
    s_mov_b64 exec, -1
    s_add_u32 m0, s62, 118784
    s_nop 0
    buffer_load_dwordx4 v217, s[36:39], s94 offen lds
    buffer_load_dwordx4 v217, s[36:39], s94 offen offset:1024 lds
    s_add_u32 m0, s61, 49152
    s_mul_i32 s59, s93, 96
    buffer_load_dwordx4 v200, s[8:11], s59 offen lds
    buffer_load_dwordx4 v201, s[8:11], s59 offen offset:1024 lds
    buffer_load_dwordx4 v202, s[8:11], s59 offen offset:2048 lds
    s_add_u32 s93, s93, 6144
    s_and_b32 s93, s93, 65535
    s_barrier
    s_add_u32 m0, s62, 118784
    s_nop 0
    buffer_load_dwordx4 v217, s[36:39], s94 offen offset:2048 lds
    buffer_load_dwordx4 v217, s[36:39], s94 offen offset:3072 lds
    s_add_u32 s94, s94, 32768
    s_and_b32 s94, s94, 262143
    s_add_u32 m0, s61, 65536
    s_mul_i32 s59, s93, 96
    buffer_load_dwordx4 v200, s[8:11], s59 offen lds
    buffer_load_dwordx4 v201, s[8:11], s59 offen offset:1024 lds
    buffer_load_dwordx4 v202, s[8:11], s59 offen offset:2048 lds
    s_add_u32 s93, s93, 2048
    s_and_b32 s93, s93, 65535
    s_waitcnt vmcnt(14)
    s_barrier
    s_add_u32 m0, s91, 135168
    s_mov_b64 exec, s[84:85]
    buffer_load_dwordx4 v221, s[36:39], s94 offen lds
    s_mov_b64 exec, -1
    s_add_u32 m0, s62, 137216
    s_nop 0
    buffer_load_dwordx4 v217, s[36:39], s94 offen lds
    buffer_load_dwordx4 v217, s[36:39], s94 offen offset:1024 lds
    s_add_u32 m0, s61, 81920
    s_mul_i32 s59, s93, 96
    buffer_load_dwordx4 v200, s[8:11], s59 offen lds
    buffer_load_dwordx4 v201, s[8:11], s59 offen offset:1024 lds
    buffer_load_dwordx4 v202, s[8:11], s59 offen offset:2048 lds
    s_add_u32 s93, s93, 6144
    s_and_b32 s93, s93, 65535
    s_barrier
    s_add_u32 m0, s62, 137216
    s_nop 0
    buffer_load_dwordx4 v217, s[36:39], s94 offen offset:2048 lds
    buffer_load_dwordx4 v217, s[36:39], s94 offen offset:3072 lds
    s_add_u32 s94, s94, 32768
    s_and_b32 s94, s94, 262143
    s_add_u32 m0, s61, 0
    s_mul_i32 s59, s93, 96
    buffer_load_dwordx4 v200, s[8:11], s59 offen lds
    buffer_load_dwordx4 v201, s[8:11], s59 offen offset:1024 lds
    buffer_load_dwordx4 v202, s[8:11], s59 offen offset:2048 lds
    s_add_u32 s93, s93, 2048
    s_and_b32 s93, s93, 65535
    s_waitcnt vmcnt(14)
    s_barrier
    v_lshrrev_b32 v224, 2, v254
    v_and_b32 v225, 64, v224
    v_and_b32 v224, 60, v224
    s_cmp_eq_u32 s40, 0
    s_cselect_b32 s55, 0, 2
    v_mul_lo_u32 v225, v225, s55
    v_sub_u32 v98, v224, v225
    v_add_u32 v98, 14336, v98
    buffer_load_dword v251, v98, s[4:7], s54 offen sc0 sc1
    s_add_u32 m0, s91, 98304
    s_mov_b64 exec, s[84:85]
    buffer_load_dwordx4 v221, s[36:39], s94 offen lds
    s_mov_b64 exec, -1
    s_add_u32 m0, s62, 100352
    s_nop 0
    buffer_load_dwordx4 v217, s[36:39], s94 offen lds
    buffer_load_dwordx4 v217, s[36:39], s94 offen offset:1024 lds
    s_add_u32 m0, s61, 16384
    s_mul_i32 s59, s93, 96
    buffer_load_dwordx4 v200, s[8:11], s59 offen lds
    buffer_load_dwordx4 v201, s[8:11], s59 offen offset:1024 lds
    buffer_load_dwordx4 v202, s[8:11], s59 offen offset:2048 lds
    s_add_u32 s93, s93, 6144
    s_and_b32 s93, s93, 65535
    s_barrier
    s_add_u32 m0, s62, 100352
    s_nop 0
    buffer_load_dwordx4 v217, s[36:39], s94 offen offset:2048 lds
    buffer_load_dwordx4 v217, s[36:39], s94 offen offset:3072 lds
    s_add_u32 s94, s94, 32768
    s_and_b32 s94, s94, 262143
    s_add_u32 m0, s61, 32768
    s_mul_i32 s59, s93, 96
    buffer_load_dwordx4 v200, s[8:11], s59 offen lds
    buffer_load_dwordx4 v201, s[8:11], s59 offen offset:1024 lds
    buffer_load_dwordx4 v202, s[8:11], s59 offen offset:2048 lds
    s_add_u32 s93, s93, 2048
    s_and_b32 s93, s93, 65535
    s_waitcnt vmcnt(15)
    s_barrier
    s_add_u32 m0, s91, 116736
    s_mov_b64 exec, s[84:85]
    buffer_load_dwordx4 v221, s[36:39], s94 offen lds
    s_mov_b64 exec, -1
    s_add_u32 m0, s62, 118784
    s_nop 0
    buffer_load_dwordx4 v217, s[36:39], s94 offen lds
    buffer_load_dwordx4 v217, s[36:39], s94 offen offset:1024 lds
    s_add_u32 m0, s61, 49152
    s_mul_i32 s59, s93, 96
    buffer_load_dwordx4 v200, s[8:11], s59 offen lds
    buffer_load_dwordx4 v201, s[8:11], s59 offen offset:1024 lds
    buffer_load_dwordx4 v202, s[8:11], s59 offen offset:2048 lds
    s_add_u32 s93, s93, 10240
    s_and_b32 s93, s93, 65535
    s_barrier
    s_waitcnt vmcnt(17)
    s_mov_b32 s56, 262144
poll_65:
    v_cmp_ne_u32 vcc, 0x01010101, v251
    s_cbranch_vccz pd_66
    buffer_load_dword v251, v98, s[4:7], s54 offen sc0 sc1
    s_waitcnt vmcnt(0)
    s_sub_u32 s56, s56, 1
    s_cmp_lg_u32 s56, 0
    s_cbranch_scc1 poll_65
pd_66:
    s_add_u32 m0, s62, 118784
    s_nop 0
    buffer_load_dwordx4 v217, s[36:39], s94 offen offset:2048 lds
    buffer_load_dwordx4 v217, s[36:39], s94 offen offset:3072 lds
    s_add_u32 s94, s94, 49152
    s_and_b32 s94, s94, 262143
    s_add_u32 m0, s61, 65536
    s_mul_i32 s59, s93, 96
    buffer_load_dwordx4 v200, s[8:11], s59 offen lds
    buffer_load_dwordx4 v201, s[8:11], s59 offen offset:1024 lds
    buffer_load_dwordx4 v202, s[8:11], s59 offen offset:2048 lds
    s_add_u32 s93, s93, 2048
    s_and_b32 s93, s93, 65535
    s_waitcnt vmcnt(14)
    s_barrier
    s_add_u32 m0, s91, 135168
    s_mov_b64 exec, s[84:85]
    buffer_load_dwordx4 v221, s[36:39], s94 offen lds
    s_mov_b64 exec, -1
    s_add_u32 m0, s62, 137216
    s_nop 0
    buffer_load_dwordx4 v217, s[36:39], s94 offen lds
    buffer_load_dwordx4 v217, s[36:39], s94 offen offset:1024 lds
    v_and_b32 v226, 0xf0, v254
    v_and_b32 v227, 0x300, v254
    v_lshl_add_u32 v227, v227, 2, v226
    s_lshl_b32 s78, s42, 8
    s_add_u32 s78, s78, s53
    s_add_u32 m0, s61, 81920
    s_mul_i32 s59, s93, 96
    buffer_load_dwordx4 v200, s[8:11], s59 offen lds
    buffer_load_dwordx4 v201, s[8:11], s59 offen offset:1024 lds
    buffer_load_dwordx4 v202, s[8:11], s59 offen offset:2048 lds
    s_add_u32 s93, s93, 6144
    s_and_b32 s93, s93, 65535
    buffer_load_dwordx4 v[144:147], v227, s[4:7], s78 offen
    s_add_u32 s78, s78, 4096
    s_barrier
    s_add_u32 m0, s62, 137216
    s_nop 0
    buffer_load_dwordx4 v217, s[36:39], s94 offen offset:2048 lds
    buffer_load_dwordx4 v217, s[36:39], s94 offen offset:3072 lds
    s_add_u32 s94, s94, 32768
    s_and_b32 s94, s94, 262143
    s_add_u32 m0, s61, 0
    s_mul_i32 s59, s93, 96
    buffer_load_dwordx4 v200, s[8:11], s59 offen lds
    buffer_load_dwordx4 v201, s[8:11], s59 offen offset:1024 lds
    buffer_load_dwordx4 v202, s[8:11], s59 offen offset:2048 lds
    s_add_u32 s93, s93, 2048
    s_and_b32 s93, s93, 65535
    buffer_load_dwordx4 v[148:151], v227, s[4:7], s78 offen
    s_add_u32 s78, s78, 4096
    s_waitcnt vmcnt(16)
    s_barrier
    s_add_u32 m0, s91, 98304
    s_mov_b64 exec, s[84:85]
    buffer_load_dwordx4 v221, s[36:39], s94 offen lds
    s_mov_b64 exec, -1
    s_add_u32 m0, s62, 100352
    s_nop 0
    buffer_load_dwordx4 v217, s[36:39], s94 offen lds
    buffer_load_dwordx4 v217, s[36:39], s94 offen offset:1024 lds
    s_add_u32 m0, s61, 16384
    s_mul_i32 s59, s93, 96
    buffer_load_dwordx4 v200, s[8:11], s59 offen lds
    buffer_load_dwordx4 v201, s[8:11], s59 offen offset:1024 lds
    buffer_load_dwordx4 v202, s[8:11], s59 offen offset:2048 lds
    s_add_u32 s93, s93, 6144
    s_and_b32 s93, s93, 65535
    buffer_load_dwordx4 v[152:155], v227, s[4:7], s78 offen
    s_add_u32 s78, s78, 4096
    s_barrier
    s_add_u32 m0, s62, 100352
    s_nop 0
    buffer_load_dwordx4 v217, s[36:39], s94 offen offset:2048 lds
    buffer_load_dwordx4 v217, s[36:39], s94 offen offset:3072 lds
    s_add_u32 s94, s94, 32768
    s_and_b32 s94, s94, 262143
    s_add_u32 m0, s61, 32768
    s_mul_i32 s59, s93, 96
    buffer_load_dwordx4 v200, s[8:11], s59 offen lds
    buffer_load_dwordx4 v201, s[8:11], s59 offen offset:1024 lds
    buffer_load_dwordx4 v202, s[8:11], s59 offen offset:2048 lds
    s_add_u32 s93, s93, 2048
    s_and_b32 s93, s93, 65535
    buffer_load_dwordx4 v[156:159], v227, s[4:7], s78 offen
    s_add_u32 s78, s78, 4096
    s_waitcnt vmcnt(17)
    s_barrier
    s_add_u32 m0, s91, 116736
    s_mov_b64 exec, s[84:85]
    buffer_load_dwordx4 v221, s[36:39], s94 offen lds
    s_mov_b64 exec, -1
    s_add_u32 m0, s62, 118784
    s_nop 0
    buffer_load_dwordx4 v217, s[36:39], s94 offen lds
    buffer_load_dwordx4 v217, s[36:39], s94 offen offset:1024 lds
    s_add_u32 m0, s61, 49152
    s_mul_i32 s59, s93, 96
    buffer_load_dwordx4 v200, s[8:11], s59 offen lds
    buffer_load_dwordx4 v201, s[8:11], s59 offen offset:1024 lds
    buffer_load_dwordx4 v202, s[8:11], s59 offen offset:2048 lds
    s_add_u32 s93, s93, 6144
    s_and_b32 s93, s93, 65535
    s_barrier
    s_add_u32 m0, s62, 118784
    s_nop 0
    buffer_load_dwordx4 v217, s[36:39], s94 offen offset:2048 lds
    buffer_load_dwordx4 v217, s[36:39], s94 offen offset:3072 lds
    s_add_u32 s94, s94, 32768
    s_and_b32 s94, s94, 262143
    v_lshrrev_b32 v224, 7, v254
    v_and_b32 v175, 0x70, v254
    v_lshl_add_u32 v224, v224, 10, v175
    s_sub_u32 s70, s53, 4193408
    s_cmp_eq_u32 s40, 0
    s_cselect_b32 s70, 2130706432, s70
    s_add_u32 m0, s61, 65536
    s_mul_i32 s59, s93, 96
    buffer_load_dwordx4 v200, s[8:11], s59 offen lds
    buffer_load_dwordx4 v201, s[8:11], s59 offen offset:1024 lds
    buffer_load_dwordx4 v[164:167], v224, s[4:7], s70 offen
    s_add_u32 s70, s70, 8192
    buffer_load_dwordx4 v202, s[8:11], s59 offen offset:2048 lds
    s_add_u32 s93, s93, 2048
    s_and_b32 s93, s93, 65535
    buffer_load_dwordx4 v[168:171], v224, s[4:7], s70 offen
    s_add_u32 s70, s70, 8192
    s_waitcnt vmcnt(17)
    s_barrier
    s_waitcnt vmcnt(13)
    s_add_u32 m0, s91, 135168
    s_mov_b64 exec, s[84:85]
    buffer_load_dwordx4 v221, s[36:39], s94 offen lds
    s_mov_b64 exec, -1
    v_add_f32 v144, v144, v148
    v_add_f32 v145, v145, v149
    v_add_f32 v146, v146, v150
    v_add_f32 v147, v147, v151
    s_add_u32 m0, s62, 137216
    s_nop 0
    buffer_load_dwordx4 v217, s[36:39], s94 offen lds
    v_add_f32 v152, v152, v156
    v_add_f32 v153, v153, v157
    v_add_f32 v154, v154, v158
    v_add_f32 v155, v155, v159
    buffer_load_dwordx4 v217, s[36:39], s94 offen offset:1024 lds
    v_add_f32 v160, v144, v152
    v_add_f32 v161, v145, v153
    v_add_f32 v162, v146, v154
    v_add_f32 v163, v147, v155
    s_add_u32 m0, s61, 81920
    s_mul_i32 s59, s93, 96
    buffer_load_dwordx4 v200, s[8:11], s59 offen lds
    v_mov_b32 v144, v160
    v_mov_b32 v145, v161
    v_mov_b32 v146, v162
    v_mov_b32 v147, v163
    buffer_load_dwordx4 v201, s[8:11], s59 offen offset:1024 lds
    s_nop 1
    v_permlane16_swap_b32 v160, v144
    v_permlane16_swap_b32 v161, v145
    v_permlane16_swap_b32 v162, v146
    buffer_load_dwordx4 v202, s[8:11], s59 offen offset:2048 lds
    s_add_u32 s93, s93, 6144
    s_and_b32 s93, s93, 65535
    v_permlane16_swap_b32 v163, v147
    v_add_f32 v160, v160, v144
    v_add_f32 v161, v161, v145
    v_add_f32 v162, v162, v146
    v_add_f32 v163, v163, v147
    s_barrier
    s_add_u32 m0, s62, 137216
    s_nop 0
    buffer_load_dwordx4 v217, s[36:39], s94 offen offset:2048 lds
    v_mov_b32 v144, v160
    v_mov_b32 v145, v161
    buffer_load_dwordx4 v217, s[36:39], s94 offen offset:3072 lds
    s_add_u32 s94, s94, 32768
    s_and_b32 s94, s94, 262143
    v_mov_b32 v146, v162
    v_mov_b32 v147, v163
    s_nop 1
    s_add_u32 m0, s61, 0
    s_mul_i32 s59, s93, 96
    buffer_load_dwordx4 v200, s[8:11], s59 offen lds
    v_permlane32_swap_b32 v160, v144
    v_permlane32_swap_b32 v161, v145
    buffer_load_dwordx4 v201, s[8:11], s59 offen offset:1024 lds
    v_permlane32_swap_b32 v162, v146
    v_permlane32_swap_b32 v163, v147
    v_add_f32 v160, v160, v144
    buffer_load_dwordx4 v202, s[8:11], s59 offen offset:2048 lds
    s_add_u32 s93, s93, 2048
    s_and_b32 s93, s93, 65535
    v_add_f32 v161, v161, v145
    v_add_f32 v162, v162, v146
    v_add_f32 v163, v163, v147
    s_waitcnt vmcnt(16)
    s_barrier
    s_add_u32 m0, s91, 98304
    s_mov_b64 exec, s[84:85]
    buffer_load_dwordx4 v221, s[36:39], s94 offen lds
    s_mov_b64 exec, -1
    v_mul_f32 v160, 0x3a800000, v160
    v_mul_f32 v161, 0x3a800000, v161
    s_add_u32 m0, s62, 100352
    s_nop 0
    buffer_load_dwordx4 v217, s[36:39], s94 offen lds
    v_fma_f32 v161, -v160, v160, v161
    v_max_f32 v161, 0, v161
    v_cvt_pk_bf16_f32 v160, v160, v160
    buffer_load_dwordx4 v217, s[36:39], s94 offen offset:1024 lds
    v_lshlrev_b32 v160, 16, v160
    v_cvt_pk_bf16_f32 v161, v161, v161
    v_lshlrev_b32 v161, 16, v161
    s_add_u32 m0, s61, 16384
    s_mul_i32 s59, s93, 96
    buffer_load_dwordx4 v200, s[8:11], s59 offen lds
    v_add_f32 v161, 0x3727c5ac, v161
    v_cvt_pk_bf16_f32 v161, v161, v161
    v_lshlrev_b32 v161, 16, v161
    buffer_load_dwordx4 v201, s[8:11], s59 offen offset:1024 lds
    v_sqrt_f32 v161, v161
    s_nop 0
    v_cvt_pk_bf16_f32 v161, v161, v161
    buffer_load_dwordx4 v202, s[8:11], s59 offen offset:2048 lds
    s_add_u32 s93, s93, 6144
    s_and_b32 s93, s93, 65535
    v_lshlrev_b32 v161, 16, v161
    v_rcp_f32 v161, v161
    s_nop 0
    s_barrier
    s_add_u32 m0, s62, 100352
    s_nop 0
    buffer_load_dwordx4 v217, s[36:39], s94 offen offset:2048 lds
    v_mul_f32 v162, 0x3a800000, v162
    v_mul_f32 v163, 0x3a800000, v163
    v_fma_f32 v163, -v162, v162, v163
    buffer_load_dwordx4 v217, s[36:39], s94 offen offset:3072 lds
    s_add_u32 s94, s94, 32768
    s_and_b32 s94, s94, 262143
    v_max_f32 v163, 0, v163
    v_cvt_pk_bf16_f32 v162, v162, v162
    v_lshlrev_b32 v162, 16, v162
    v_cvt_pk_bf16_f32 v163, v163, v163
    s_add_u32 m0, s61, 32768
    s_mul_i32 s59, s93, 96
    buffer_load_dwordx4 v200, s[8:11], s59 offen lds
    v_lshlrev_b32 v163, 16, v163
    v_add_f32 v163, 0x3727c5ac, v163
    v_cvt_pk_bf16_f32 v163, v163, v163
    buffer_load_dwordx4 v201, s[8:11], s59 offen offset:1024 lds
    v_lshlrev_b32 v163, 16, v163
    v_sqrt_f32 v163, v163
    s_nop 0
    v_cvt_pk_bf16_f32 v163, v163, v163
    buffer_load_dwordx4 v202, s[8:11], s59 offen offset:2048 lds
    s_add_u32 s93, s93, 2048
    s_and_b32 s93, s93, 65535
    v_lshlrev_b32 v163, 16, v163
    v_rcp_f32 v163, v163
    s_nop 0
    v_lshrrev_b32 v226, 1, v226
    s_lshl_b32 s55, s42, 7
    s_add_u32 s55, s55, 159808
    v_add_u32 v226, s55, v226
    v_sub_f32 v160, 0, v160
    v_sub_f32 v162, 0, v162
    s_mov_b64 exec, 0xffff
    ds_write2_b32 v226, v160, v162 offset0:0 offset1:1
    ds_write2_b32 v226, v161, v163 offset0:144 offset1:145
    s_mov_b64 exec, -1
    s_waitcnt vmcnt(14)
    s_barrier
    s_add_u32 m0, s91, 116736
    s_mov_b64 exec, s[84:85]
    buffer_load_dwordx4 v221, s[36:39], s94 offen lds
    s_mov_b64 exec, -1
    v_add_f32 v164, v164, v168
    v_add_f32 v165, v165, v169
    v_add_f32 v166, v166, v170
    s_add_u32 m0, s62, 118784
    s_nop 0
    buffer_load_dwordx4 v217, s[36:39], s94 offen lds
    v_add_f32 v167, v167, v171
    s_nop 1
    v_add_f32_dpp v164, v164, v164 row_ror:8 row_mask:0xf bank_mask:0xf
    v_add_f32_dpp v165, v165, v165 row_ror:8 row_mask:0xf bank_mask:0xf
    buffer_load_dwordx4 v217, s[36:39], s94 offen offset:1024 lds
    v_add_f32_dpp v166, v166, v166 row_ror:8 row_mask:0xf bank_mask:0xf
    v_add_f32_dpp v167, v167, v167 row_ror:8 row_mask:0xf bank_mask:0xf
    v_mov_b32 v168, v164
    v_mov_b32 v169, v165
    s_add_u32 m0, s61, 49152
    s_mul_i32 s59, s93, 96
    buffer_load_dwordx4 v200, s[8:11], s59 offen lds
    v_mov_b32 v170, v166
    v_mov_b32 v171, v167
    s_nop 1
    buffer_load_dwordx4 v201, s[8:11], s59 offen offset:1024 lds
    v_permlane16_swap_b32 v164, v168
    v_permlane16_swap_b32 v165, v169
    v_permlane16_swap_b32 v166, v170
    v_permlane16_swap_b32 v167, v171
    buffer_load_dwordx4 v202, s[8:11], s59 offen offset:2048 lds
    s_add_u32 s93, s93, 6144
    s_and_b32 s93, s93, 65535
    v_add_f32 v164, v164, v168
    v_add_f32 v165, v165, v169
    v_add_f32 v166, v166, v170
    v_add_f32 v167, v167, v171
    s_barrier
    s_add_u32 m0, s62, 118784
    s_nop 0
    buffer_load_dwordx4 v217, s[36:39], s94 offen offset:2048 lds
    v_mov_b32 v168, v164
    v_mov_b32 v169, v165
    buffer_load_dwordx4 v217, s[36:39], s94 offen offset:3072 lds
    s_add_u32 s94, s94, 32768
    s_and_b32 s94, s94, 262143
    v_mov_b32 v170, v166
    v_mov_b32 v171, v167
    s_nop 1
    s_add_u32 m0, s61, 65536
    s_mul_i32 s59, s93, 96
    buffer_load_dwordx4 v200, s[8:11], s59 offen lds
    v_permlane32_swap_b32 v164, v168
    v_permlane32_swap_b32 v165, v169
    buffer_load_dwordx4 v201, s[8:11], s59 offen offset:1024 lds
    v_permlane32_swap_b32 v166, v170
    v_permlane32_swap_b32 v167, v171
    v_add_f32 v164, v164, v168
    buffer_load_dwordx4 v202, s[8:11], s59 offen offset:2048 lds
    s_add_u32 s93, s93, 2048
    s_and_b32 s93, s93, 65535
    v_add_f32 v165, v165, v169
    v_add_f32 v166, v166, v170
    v_add_f32 v167, v167, v171
    s_waitcnt vmcnt(14)
    s_barrier
    s_add_u32 m0, s91, 135168
    s_mov_b64 exec, s[84:85]
    buffer_load_dwordx4 v221, s[36:39], s94 offen lds
    s_mov_b64 exec, -1
    v_mul_f32 v164, 0x3a800000, v164
    v_mul_f32 v165, 0x3a800000, v165
    s_add_u32 m0, s62, 137216
    s_nop 0
    buffer_load_dwordx4 v217, s[36:39], s94 offen lds
    v_fma_f32 v165, -v164, v164, v165
    v_max_f32 v165, 0, v165
    v_cvt_pk_bf16_f32 v164, v164, v164
    buffer_load_dwordx4 v217, s[36:39], s94 offen offset:1024 lds
    v_lshlrev_b32 v164, 16, v164
    v_cvt_pk_bf16_f32 v165, v165, v165
    v_lshlrev_b32 v165, 16, v165
    s_add_u32 m0, s61, 81920
    s_mul_i32 s59, s93, 96
    buffer_load_dwordx4 v200, s[8:11], s59 offen lds
    v_add_f32 v165, 0x3727c5ac, v165
    v_cvt_pk_bf16_f32 v165, v165, v165
    v_lshlrev_b32 v165, 16, v165
    buffer_load_dwordx4 v201, s[8:11], s59 offen offset:1024 lds
    v_sqrt_f32 v165, v165
    s_nop 0
    v_cvt_pk_bf16_f32 v165, v165, v165
    buffer_load_dwordx4 v202, s[8:11], s59 offen offset:2048 lds
    s_add_u32 s93, s93, 6144
    s_and_b32 s93, s93, 65535
    v_lshlrev_b32 v165, 16, v165
    v_rcp_f32 v165, v165
    s_nop 0
    s_barrier
    s_add_u32 m0, s62, 137216
    s_nop 0
    buffer_load_dwordx4 v217, s[36:39], s94 offen offset:2048 lds
    v_mul_f32 v166, 0x3a800000, v166
    v_mul_f32 v167, 0x3a800000, v167
    v_fma_f32 v167, -v166, v166, v167
    v_max_f32 v167, 0, v167
    buffer_load_dwordx4 v217, s[36:39], s94 offen offset:3072 lds
    s_add_u32 s94, s94, 32768
    s_and_b32 s94, s94, 262143
    v_cvt_pk_bf16_f32 v166, v166, v166
    v_lshlrev_b32 v166, 16, v166
    v_cvt_pk_bf16_f32 v167, v167, v167
    v_lshlrev_b32 v167, 16, v167
    s_add_u32 m0, s61, 0
    s_mul_i32 s59, s93, 96
    buffer_load_dwordx4 v200, s[8:11], s59 offen lds
    v_add_f32 v167, 0x3727c5ac, v167
    v_cvt_pk_bf16_f32 v167, v167, v167
    v_lshlrev_b32 v167, 16, v167
    v_sqrt_f32 v167, v167
    s_nop 0
    buffer_load_dwordx4 v201, s[8:11], s59 offen offset:1024 lds
    v_cvt_pk_bf16_f32 v167, v167, v167
    v_lshlrev_b32 v167, 16, v167
    v_rcp_f32 v167, v167
    s_nop 0
    buffer_load_dwordx4 v202, s[8:11], s59 offen offset:2048 lds
    s_add_u32 s93, s93, 2048
    s_and_b32 s93, s93, 65535
    v_lshrrev_b32 v175, 1, v175
    v_add_u32 v175, 159744, v175
    v_sub_f32 v164, 0, v164
    v_sub_f32 v166, 0, v166
    s_lshl_b32 s55, s42, 1
    s_lshl_b64 exec, 3, s55
    ds_write2_b32 v175, v164, v166 offset0:0 offset1:1
    ds_write2_b32 v175, v165, v167 offset0:144 offset1:145
    s_mov_b64 exec, -1
    s_waitcnt vmcnt(14)
    s_barrier
    s_add_u32 m0, s91, 98304
    s_mov_b64 exec, s[84:85]
    buffer_load_dwordx4 v221, s[36:39], s94 offen lds
    s_mov_b64 exec, -1
    s_add_u32 m0, s62, 100352
    s_nop 0
    buffer_load_dwordx4 v217, s[36:39], s94 offen lds
    buffer_load_dwordx4 v217, s[36:39], s94 offen offset:1024 lds
    s_add_u32 m0, s61, 16384
    s_mul_i32 s59, s93, 96
    buffer_load_dwordx4 v200, s[8:11], s59 offen lds
    buffer_load_dwordx4 v201, s[8:11], s59 offen offset:1024 lds
    buffer_load_dwordx4 v202, s[8:11], s59 offen offset:2048 lds
    s_barrier
    s_add_u32 m0, s62, 100352
    s_nop 0
    buffer_load_dwordx4 v217, s[36:39], s94 offen offset:2048 lds
    buffer_load_dwordx4 v217, s[36:39], s94 offen offset:3072 lds
    s_lshl_b32 s93, s43, 1
    s_add_u32 s93, s51, s93
    s_and_b32 s93, s93, 15
    s_add_u32 m0, s62, 32768
    s_lshl_b32 s93, s93, 17
    buffer_load_dwordx4 v203, s[12:15], s93 offen lds
    buffer_load_dwordx4 v204, s[12:15], s93 offen offset:1024 lds
    buffer_load_dwordx4 v205, s[12:15], s93 offen offset:2048 lds
    buffer_load_dwordx4 v206, s[12:15], s93 offen offset:3072 lds
    s_add_u32 s93, s93, 524288
    s_and_b32 s93, s93, 2097151
    s_waitcnt vmcnt(15)
    s_barrier
    s_add_u32 m0, s62, 49152
    s_nop 0
    buffer_load_dwordx4 v203, s[12:15], s93 offen lds
    buffer_load_dwordx4 v204, s[12:15], s93 offen offset:1024 lds
    buffer_load_dwordx4 v205, s[12:15], s93 offen offset:2048 lds
    buffer_load_dwordx4 v206, s[12:15], s93 offen offset:3072 lds
    s_add_u32 s93, s93, 524288
    s_and_b32 s93, s93, 2097151
    s_barrier
    s_add_u32 m0, s62, 65536
    s_nop 0
    buffer_load_dwordx4 v203, s[12:15], s93 offen lds
    buffer_load_dwordx4 v204, s[12:15], s93 offen offset:1024 lds
    buffer_load_dwordx4 v205, s[12:15], s93 offen offset:2048 lds
    buffer_load_dwordx4 v206, s[12:15], s93 offen offset:3072 lds
    s_add_u32 s93, s93, 524288
    s_and_b32 s93, s93, 2097151
    s_waitcnt vmcnt(12)
    s_barrier
    s_add_u32 m0, s62, 81920
    s_nop 0
    buffer_load_dwordx4 v203, s[12:15], s93 offen lds
    buffer_load_dwordx4 v204, s[12:15], s93 offen offset:1024 lds
    buffer_load_dwordx4 v205, s[12:15], s93 offen offset:2048 lds
    buffer_load_dwordx4 v206, s[12:15], s93 offen offset:3072 lds
    s_add_u32 s93, s93, 655360
    s_and_b32 s93, s93, 2097151
    s_barrier
    s_add_u32 m0, s62, 0
    s_nop 0
    buffer_load_dwordx4 v203, s[12:15], s93 offen lds
    buffer_load_dwordx4 v204, s[12:15], s93 offen offset:1024 lds
    buffer_load_dwordx4 v205, s[12:15], s93 offen offset:2048 lds
    buffer_load_dwordx4 v206, s[12:15], s93 offen offset:3072 lds
    s_add_u32 s93, s93, 524288
    s_and_b32 s93, s93, 2097151
    s_waitcnt lgkmcnt(0)
    s_barrier
    s_add_u32 m0, s62, 16384
    s_nop 0
    buffer_load_dwordx4 v203, s[12:15], s93 offen lds
    buffer_load_dwordx4 v204, s[12:15], s93 offen offset:1024 lds
    buffer_load_dwordx4 v205, s[12:15], s93 offen offset:2048 lds
    buffer_load_dwordx4 v206, s[12:15], s93 offen offset:3072 lds
    s_add_u32 s93, s93, 524288
    s_and_b32 s93, s93, 2097151
    s_setprio 0
Y_g2:
    v_lshlrev_b32 v224, 7, v254
    s_lshl_b32 s55, s44, 19
    s_add_u32 s55, s55, s93
    s_and_b32 s55, s55, 2097151
    s_add_u32 s55, s55, s63
    buffer_load_dword v251, v224, s[12:15], s55 offen
    v_mov_b32 v112, -1
    v_mov_b32 v113, -1
    v_mov_b32 v114, -1
    v_mov_b32 v115, -1
    s_lshl_b32 s94, s51, 14
    s_add_u32 s88, s47, s62
    v_add_u32 v217, s88, v254
    s_add_u32 s55, s88, s94
    s_add_u32 s55, s55, 1310720
    buffer_store_dwordx4 v[112:115], v254, s[4:7], s55 offen offset:0 sc0 sc1
    buffer_store_dwordx4 v[112:115], v254, s[4:7], s55 offen offset:1024 sc0 sc1
    buffer_store_dwordx4 v[112:115], v254, s[4:7], s55 offen offset:2048 sc0 sc1
    buffer_store_dwordx4 v[112:115], v254, s[4:7], s55 offen offset:3072 sc0 sc1
    s_cmp_lg_u32 s46, 0
    s_cbranch_scc1 cp_67
    v_and_b32 v225, 0xf0, v254
    v_lshrrev_b32 v224, 8, v254
    v_lshlrev_b32 v226, 5, v224
    v_xor_b32 v225, v225, v226
    v_mul_u32_u24 v224, 7168, v224
    v_add_u32 v224, s65, v224
    v_add_u32 v207, v224, v225
    v_xor_b32 v225, 0x80, v225
    v_add_u32 v224, v224, v225
    v_add_u32 v208, 27648, v224
    v_add_u32 v209, 55296, v207
    v_add_u32 v210, 55296, v208
    v_lshrrev_b32 v224, 7, v254
    v_and_b32 v225, 0x70, v254
    v_and_b32 v226, 6, v224
    v_lshlrev_b32 v226, 4, v226
    v_xor_b32 v225, v225, v226
    v_mul_u32_u24 v224, 7168, v224
    v_add3_u32 v211, v224, v225, s66
    v_add_u32 v212, 56320, v211
    v_add_u32 v222, s67, v254
    v_and_b32 v225, 0xf0, v254
    v_lshrrev_b32 v224, 8, v254
    v_lshlrev_b32 v226, 5, v224
    v_xor_b32 v225, v225, v226
    v_mul_u32_u24 v224, 2048, v224
    v_add_u32 v213, v224, v225
    v_xor_b32 v225, 0x80, v225
    v_add_u32 v224, v224, v225
    v_add_u32 v214, 7168, v224
    v_add_u32 v215, 14336, v213
    v_add_u32 v216, 14336, v214
    s_lshl_b32 s60, s43, 23
    s_add_u32 s60, s60, 83886336
    s_mov_b32 s28, s16
    s_mov_b32 s29, s17
    s_mov_b32 s30, s18
    s_mov_b32 s31, s19
    s_lshl_b32 s60, s43, 23
    s_add_u32 s60, s60, 83886336
    s_mov_b32 s24, s16
    s_mov_b32 s25, s17
    s_mov_b32 s26, s18
    s_mov_b32 s27, s19
cp_67:
    s_barrier
    s_add_u32 m0, s62, 98304
    s_nop 0
    buffer_load_dwordx4 v217, s[4:7], s94 offen lds
    buffer_load_dwordx4 v217, s[4:7], s94 offen offset:1024 lds
    buffer_load_dwordx4 v217, s[4:7], s94 offen offset:2048 lds
    buffer_load_dwordx4 v217, s[4:7], s94 offen offset:3072 lds
    s_add_u32 s94, s94, 32768
    s_and_b32 s94, s94, 262143
    s_waitcnt vmcnt(0)
    s_barrier
    v_lshrrev_b32 v252, 2, v254
    v_min_u32 v252, 28, v252
    s_add_u32 s55, s0, 0
    s_mov_b32 s56, 262144
poll_68:
    buffer_load_dword v253, v252, s[4:7], s55 offen sc0 sc1
    s_waitcnt vmcnt(0)
    v_cmp_ne_u32 vcc, 0x01010101, v253
    s_cbranch_vccz pd_69
    s_sleep 1
    s_sub_u32 s56, s56, 1
    s_cmp_lg_u32 s56, 0
    s_cbranch_scc1 poll_68
pd_69:
    s_add_u32 m0, s62, 114688
    s_nop 0
    buffer_load_dwordx4 v217, s[4:7], s94 offen lds
    buffer_load_dwordx4 v217, s[4:7], s94 offen offset:1024 lds
    buffer_load_dwordx4 v217, s[4:7], s94 offen offset:2048 lds
    buffer_load_dwordx4 v217, s[4:7], s94 offen offset:3072 lds
    s_add_u32 s94, s94, 32768
    s_and_b32 s94, s94, 262143
    s_add_u32 m0, s62, 131072
    s_nop 0
    buffer_load_dwordx4 v217, s[4:7], s94 offen lds
    buffer_load_dwordx4 v217, s[4:7], s94 offen offset:1024 lds
    buffer_load_dwordx4 v217, s[4:7], s94 offen offset:2048 lds
    buffer_load_dwordx4 v217, s[4:7], s94 offen offset:3072 lds
    s_add_u32 s94, s94, 32768
    s_and_b32 s94, s94, 262143
    s_waitcnt vmcnt(4)
    s_barrier
    s_add_u32 m0, s62, 98304
    s_nop 0
    buffer_load_dwordx4 v217, s[4:7], s94 offen lds
    buffer_load_dwordx4 v217, s[4:7], s94 offen offset:1024 lds
    buffer_load_dwordx4 v217, s[4:7], s94 offen offset:2048 lds
    buffer_load_dwordx4 v217, s[4:7], s94 offen offset:3072 lds
    s_add_u32 s94, s94, 32768
    s_and_b32 s94, s94, 262143
    s_waitcnt vmcnt(4)
    s_barrier
    s_add_u32 m0, s62, 114688
    s_nop 0
    buffer_load_dwordx4 v217, s[4:7], s94 offen lds
    buffer_load_dwordx4 v217, s[4:7], s94 offen offset:1024 lds
    buffer_load_dwordx4 v217, s[4:7], s94 offen offset:2048 lds
    buffer_load_dwordx4 v217, s[4:7], s94 offen offset:3072 lds
    s_add_u32 s94, s94, 32768
    s_and_b32 s94, s94, 262143
    s_add_u32 m0, s62, 32768
    s_nop 0
    buffer_load_dwordx4 v203, s[12:15], s93 offen lds
    buffer_load_dwordx4 v204, s[12:15], s93 offen offset:1024 lds
    buffer_load_dwordx4 v205, s[12:15], s93 offen offset:2048 lds
    buffer_load_dwordx4 v206, s[12:15], s93 offen offset:3072 lds
    s_add_u32 s93, s93, 524288
    s_and_b32 s93, s93, 2097151
    s_waitcnt vmcnt(8)
    s_barrier
    s_add_u32 m0, s62, 131072
    s_nop 0
    buffer_load_dwordx4 v217, s[4:7], s94 offen lds
    buffer_load_dwordx4 v217, s[4:7], s94 offen offset:1024 lds
    buffer_load_dwordx4 v217, s[4:7], s94 offen offset:2048 lds
    buffer_load_dwordx4 v217, s[4:7], s94 offen offset:3072 lds
    s_add_u32 s94, s94, 32768
    s_and_b32 s94, s94, 262143
    s_waitcnt vmcnt(8)
    s_barrier
    v_lshrrev_b32 v252, 2, v254
    v_min_u32 v252, 60, v252
    s_add_u32 s55, s54, 0
    buffer_load_dword v251, v252, s[4:7], s55 offen sc0 sc1
    s_add_u32 m0, s62, 98304
    s_nop 0
    buffer_load_dwordx4 v217, s[4:7], s94 offen lds
    buffer_load_dwordx4 v217, s[4:7], s94 offen offset:1024 lds
    buffer_load_dwordx4 v217, s[4:7], s94 offen offset:2048 lds
    buffer_load_dwordx4 v217, s[4:7], s94 offen offset:3072 lds
    s_add_u32 s94, s94, 32768
    s_and_b32 s94, s94, 262143
    s_add_u32 m0, s62, 49152
    s_nop 0
    buffer_load_dwordx4 v203, s[12:15], s93 offen lds
    buffer_load_dwordx4 v204, s[12:15], s93 offen offset:1024 lds
    buffer_load_dwordx4 v205, s[12:15], s93 offen offset:2048 lds
    buffer_load_dwordx4 v206, s[12:15], s93 offen offset:3072 lds
    s_add_u32 s93, s93, 524288
    s_and_b32 s93, s93, 2097151
    s_waitcnt vmcnt(9)
    s_barrier
    s_add_u32 m0, s62, 114688
    s_nop 0
    buffer_load_dwordx4 v217, s[4:7], s94 offen lds
    buffer_load_dwordx4 v217, s[4:7], s94 offen offset:1024 lds
    buffer_load_dwordx4 v217, s[4:7], s94 offen offset:2048 lds
    buffer_load_dwordx4 v217, s[4:7], s94 offen offset:3072 lds
    s_add_u32 s94, s94, 49152
    s_and_b32 s94, s94, 262143
    s_waitcnt vmcnt(8)
    s_barrier
    v_cmp_ne_u32 vcc, 0x01010101, v251
    s_cbranch_vccz ap_70
    v_lshrrev_b32 v252, 2, v254
    v_min_u32 v252, 60, v252
    s_add_u32 s55, s54, 0
    s_mov_b32 s56, 262144
poll_71:
    buffer_load_dword v253, v252, s[4:7], s55 offen sc0 sc1
    s_waitcnt vmcnt(0)
    v_cmp_ne_u32 vcc, 0x01010101, v253
    s_cbranch_vccz pd_72
    s_sleep 1
    s_sub_u32 s56, s56, 1
    s_cmp_lg_u32 s56, 0
    s_cbranch_scc1 poll_71
pd_72:
ap_70:
    s_add_u32 m0, s62, 131072
    s_nop 0
    buffer_load_dwordx4 v217, s[4:7], s94 offen lds
    buffer_load_dwordx4 v217, s[4:7], s94 offen offset:1024 lds
    buffer_load_dwordx4 v217, s[4:7], s94 offen offset:2048 lds
    buffer_load_dwordx4 v217, s[4:7], s94 offen offset:3072 lds
    s_add_u32 s94, s94, 32768
    s_and_b32 s94, s94, 262143
    s_waitcnt vmcnt(4)
    s_barrier
    s_add_u32 m0, s62, 98304
    s_nop 0
    buffer_load_dwordx4 v217, s[4:7], s94 offen lds
    buffer_load_dwordx4 v217, s[4:7], s94 offen offset:1024 lds
    buffer_load_dwordx4 v217, s[4:7], s94 offen offset:2048 lds
    buffer_load_dwordx4 v217, s[4:7], s94 offen offset:3072 lds
    s_add_u32 s94, s94, 32768
    s_and_b32 s94, s94, 262143
    s_waitcnt vmcnt(4)
    s_barrier
    s_add_u32 m0, s62, 114688
    s_nop 0
    buffer_load_dwordx4 v217, s[4:7], s94 offen lds
    buffer_load_dwordx4 v217, s[4:7], s94 offen offset:1024 lds
    buffer_load_dwordx4 v217, s[4:7], s94 offen offset:2048 lds
    buffer_load_dwordx4 v217, s[4:7], s94 offen offset:3072 lds
    s_add_u32 s94, s94, 32768
    s_and_b32 s94, s94, 262143
    s_waitcnt vmcnt(4)
    s_barrier
    s_add_u32 m0, s62, 131072
    s_nop 0
    buffer_load_dwordx4 v217, s[4:7], s94 offen lds
    buffer_load_dwordx4 v217, s[4:7], s94 offen offset:1024 lds
    buffer_load_dwordx4 v217, s[4:7], s94 offen offset:2048 lds
    buffer_load_dwordx4 v217, s[4:7], s94 offen offset:3072 lds
    s_add_u32 s94, s94, 32768
    s_and_b32 s94, s94, 262143
    s_waitcnt vmcnt(4)
    s_barrier
    s_add_u32 m0, s62, 98304
    s_nop 0
    buffer_load_dwordx4 v217, s[4:7], s94 offen lds
    buffer_load_dwordx4 v217, s[4:7], s94 offen offset:1024 lds
    buffer_load_dwordx4 v217, s[4:7], s94 offen offset:2048 lds
    buffer_load_dwordx4 v217, s[4:7], s94 offen offset:3072 lds
    s_add_u32 s94, s94, 32768
    s_and_b32 s94, s94, 262143
    s_waitcnt vmcnt(4)
    s_barrier
    s_add_u32 m0, s62, 114688
    s_nop 0
    buffer_load_dwordx4 v217, s[4:7], s94 offen lds
    buffer_load_dwordx4 v217, s[4:7], s94 offen offset:1024 lds
    buffer_load_dwordx4 v217, s[4:7], s94 offen offset:2048 lds
    buffer_load_dwordx4 v217, s[4:7], s94 offen offset:3072 lds
    s_add_u32 s94, s94, 32768
    s_and_b32 s94, s94, 262143
    s_waitcnt vmcnt(4)
    s_barrier
    s_add_u32 m0, s62, 131072
    s_nop 0
    buffer_load_dwordx4 v217, s[4:7], s94 offen lds
    buffer_load_dwordx4 v217, s[4:7], s94 offen offset:1024 lds
    buffer_load_dwordx4 v217, s[4:7], s94 offen offset:2048 lds
    buffer_load_dwordx4 v217, s[4:7], s94 offen offset:3072 lds
    s_add_u32 s94, s94, 32768
    s_and_b32 s94, s94, 262143
    s_waitcnt vmcnt(4)
    s_barrier
    s_add_u32 m0, s62, 98304
    s_nop 0
    buffer_load_dwordx4 v217, s[4:7], s94 offen lds
    buffer_load_dwordx4 v217, s[4:7], s94 offen offset:1024 lds
    buffer_load_dwordx4 v217, s[4:7], s94 offen offset:2048 lds
    buffer_load_dwordx4 v217, s[4:7], s94 offen offset:3072 lds
    s_waitcnt vmcnt(4)
    s_barrier
    s_lshl_b32 s93, s51, 12
    s_add_u32 m0, s62, 65536
    s_mul_i32 s59, s93, 112
    buffer_load_dwordx4 v207, s[28:31], s59 offen lds
    buffer_load_dwordx4 v208, s[28:31], s59 offen offset:1024 lds
    buffer_load_dwordx4 v209, s[28:31], s59 offen offset:2048 lds
    buffer_load_dwordx4 v210, s[28:31], s59 offen offset:3072 lds
    s_add_u32 s93, s93, 2048
    s_and_b32 s93, s93, 65535
    s_waitcnt vmcnt(4)
    s_barrier
    s_add_u32 m0, s62, 81920
    s_mul_i32 s59, s93, 112
    buffer_load_dwordx4 v207, s[28:31], s59 offen lds
    buffer_load_dwordx4 v208, s[28:31], s59 offen offset:1024 lds
    buffer_load_dwordx4 v209, s[28:31], s59 offen offset:2048 lds
    buffer_load_dwordx4 v210, s[28:31], s59 offen offset:3072 lds
    s_add_u32 s93, s93, 6144
    s_and_b32 s93, s93, 65535
    s_barrier
    s_add_u32 m0, s62, 0
    s_mul_i32 s59, s93, 112
    buffer_load_dwordx4 v207, s[28:31], s59 offen lds
    buffer_load_dwordx4 v208, s[28:31], s59 offen offset:1024 lds
    buffer_load_dwordx4 v209, s[28:31], s59 offen offset:2048 lds
    buffer_load_dwordx4 v210, s[28:31], s59 offen offset:3072 lds
    s_add_u32 s93, s93, 2048
    s_and_b32 s93, s93, 65535
    s_add_u32 m0, s62, 16384
    s_mul_i32 s59, s93, 112
    buffer_load_dwordx4 v207, s[28:31], s59 offen lds
    buffer_load_dwordx4 v208, s[28:31], s59 offen offset:1024 lds
    buffer_load_dwordx4 v209, s[28:31], s59 offen offset:2048 lds
    buffer_load_dwordx4 v210, s[28:31], s59 offen offset:3072 lds
    s_add_u32 s93, s93, 6144
    s_and_b32 s93, s93, 65535
    s_cmp_lg_u32 s46, 0
    s_cbranch_scc1 jf_73
    v_mov_b32 v104, 0x3f80
    v_lshrrev_b32 v224, 4, v254
    v_and_b32 v225, 1, v224
    v_lshlrev_b32 v225, 4, v225
    v_lshlrev_b32 v225, v225, v104
    v_bfe_u32 v224, v224, 1, 3
    v_cmp_eq_u32 vcc, 0, v224
    s_nop 1
    v_cndmask_b32 v104, 0, v225, vcc
    v_cmp_eq_u32 vcc, 1, v224
    s_nop 1
    v_cndmask_b32 v105, 0, v225, vcc
    v_cmp_eq_u32 vcc, 2, v224
    s_nop 1
    v_cndmask_b32 v106, 0, v225, vcc
    v_cmp_eq_u32 vcc, 3, v224
    s_nop 1
    v_cndmask_b32 v107, 0, v225, vcc
    s_nop 1
    v_mfma_f32_16x16x32_bf16 v[100:103], v[104:107], v[0:3], 0
    v_mfma_f32_16x16x32_bf16 v[100:103], v[104:107], v[4:7], v[100:103]
    v_mfma_f32_16x16x32_bf16 v[100:103], v[104:107], v[8:11], v[100:103]
    v_mfma_f32_16x16x32_bf16 v[100:103], v[104:107], v[12:15], v[100:103]
    v_mfma_f32_16x16x32_bf16 v[100:103], v[104:107], v[16:19], v[100:103]
    v_mfma_f32_16x16x32_bf16 v[100:103], v[104:107], v[20:23], v[100:103]
    v_mfma_f32_16x16x32_bf16 v[100:103], v[104:107], v[24:27], v[100:103]
    v_mfma_f32_16x16x32_bf16 v[100:103], v[104:107], v[28:31], v[100:103]
    v_mfma_f32_16x16x32_bf16 v[100:103], v[104:107], v[32:35], v[100:103]
    v_mfma_f32_16x16x32_bf16 v[100:103], v[104:107], v[36:39], v[100:103]
    v_mfma_f32_16x16x32_bf16 v[100:103], v[104:107], v[40:43], v[100:103]
    v_mfma_f32_16x16x32_bf16 v[100:103], v[104:107], v[44:47], v[100:103]
    v_mfma_f32_16x16x32_bf16 v[100:103], v[104:107], v[48:51], v[100:103]
    v_mfma_f32_16x16x32_bf16 v[100:103], v[104:107], v[52:55], v[100:103]
    v_mfma_f32_16x16x32_bf16 v[100:103], v[104:107], v[56:59], v[100:103]
    v_mfma_f32_16x16x32_bf16 v[100:103], v[104:107], v[60:63], v[100:103]
    s_and_b32 s56, s79, 1
    s_lshl_b32 s56, s56, 2
    s_add_u32 s56, s56, s42
    s_mul_i32 s56, s56, 28672
    s_lshr_b32 s55, s79, 1
    s_lshl_b32 s55, s55, 8
    s_add_u32 s55, s55, s56
    s_add_u32 s55, s55, 70778880
    s_cmp_lt_u32 s79, 224
    s_cselect_b32 s55, s55, 2130706432
    v_and_b32 v224, 0x70, v254
    v_lshrrev_b32 v225, 4, v254
    v_and_b32 v225, 16, v225
    v_lshl_add_u32 v224, v224, 1, v225
    s_nop 2
    v_add_f32_dpp v100, v100, v100 row_ror:8 row_mask:0xf bank_mask:0xf
    v_add_f32_dpp v101, v101, v101 row_ror:8 row_mask:0xf bank_mask:0xf
    v_add_f32_dpp v102, v102, v102 row_ror:8 row_mask:0xf bank_mask:0xf
    v_add_f32_dpp v103, v103, v103 row_ror:8 row_mask:0xf bank_mask:0xf
    s_mov_b64 exec, 0x00ff00ff
    buffer_store_dwordx4 v[100:103], v224, s[4:7], s55 offen sc0 sc1
    s_mov_b64 exec, -1
jf_73:
    s_add_u32 s88, s49, s62
    s_lshl_b32 s94, s51, 14
    v_add_u32 v217, s88, v254
    s_and_b32 s55, s51, 1
    s_mul_i32 s55, s55, 458752
    s_add_u32 s95, s50, s55
    s_and_b32 s55, s41, 7
    s_lshl_b32 s55, s55, 14
    s_and_b32 s56, s1, 0x3fff
    s_add_u32 s55, s55, s56
    s_add_u32 s89, s55, s95
    s_and_b32 s55, s41, 6
    s_add_u32 s55, s55, 48
    s_lshl_b32 s55, s55, 13
    s_and_b32 s56, s41, 1
    s_lshl_b32 s56, s56, 10
    s_add_u32 s55, s55, s56
    s_lshl_b32 s56, s43, 13
    s_add_u32 s55, s55, s56
    s_lshl_b32 s56, s44, 9
    s_add_u32 s55, s55, s56
    s_add_u32 s90, s55, s95
    s_barrier
    s_add_u32 m0, s62, 98304
    s_nop 0
    buffer_load_dwordx4 v217, s[4:7], s94 offen lds
    buffer_load_dwordx4 v217, s[4:7], s94 offen offset:1024 lds
    buffer_load_dwordx4 v217, s[4:7], s94 offen offset:2048 lds
    buffer_load_dwordx4 v217, s[4:7], s94 offen offset:3072 lds
    s_add_u32 s94, s94, 32768
    s_and_b32 s94, s94, 262143
    s_waitcnt vmcnt(0)
    s_barrier
    v_lshrrev_b32 v252, 2, v254
    v_min_u32 v252, 28, v252
    s_add_u32 s55, s0, 32
    buffer_load_dword v251, v252, s[4:7], s55 offen sc0 sc1
    s_setprio 1
    s_barrier
    s_waitcnt vmcnt(0)
    v_cmp_ne_u32 vcc, 0x01010101, v251
    s_cbranch_vccz ap_74
    v_lshrrev_b32 v252, 2, v254
    v_min_u32 v252, 28, v252
    s_add_u32 s55, s0, 32
    s_mov_b32 s56, 262144
poll_75:
    buffer_load_dword v253, v252, s[4:7], s55 offen sc0 sc1
    s_waitcnt vmcnt(0)
    v_cmp_ne_u32 vcc, 0x01010101, v253
    s_cbranch_vccz pd_76
    s_sleep 1
    s_sub_u32 s56, s56, 1
    s_cmp_lg_u32 s56, 0
    s_cbranch_scc1 poll_75
pd_76:
ap_74:
    s_add_u32 m0, s62, 114688
    s_nop 0
    buffer_load_dwordx4 v217, s[4:7], s94 offen lds
    buffer_load_dwordx4 v217, s[4:7], s94 offen offset:1024 lds
    buffer_load_dwordx4 v217, s[4:7], s94 offen offset:2048 lds
    buffer_load_dwordx4 v217, s[4:7], s94 offen offset:3072 lds
    s_add_u32 s94, s94, 32768
    s_and_b32 s94, s94, 262143
    s_add_u32 m0, s62, 131072
    s_nop 0
    buffer_load_dwordx4 v217, s[4:7], s94 offen lds
    buffer_load_dwordx4 v217, s[4:7], s94 offen offset:1024 lds
    buffer_load_dwordx4 v217, s[4:7], s94 offen offset:2048 lds
    buffer_load_dwordx4 v217, s[4:7], s94 offen offset:3072 lds
    s_add_u32 s94, s94, 32768
    s_and_b32 s94, s94, 262143
    s_add_u32 m0, s62, 32768
    s_mul_i32 s59, s93, 112
    buffer_load_dwordx4 v207, s[28:31], s59 offen lds
    buffer_load_dwordx4 v208, s[28:31], s59 offen offset:1024 lds
    buffer_load_dwordx4 v209, s[28:31], s59 offen offset:2048 lds
    buffer_load_dwordx4 v210, s[28:31], s59 offen offset:3072 lds
    s_add_u32 s93, s93, 2048
    s_and_b32 s93, s93, 65535
    s_waitcnt vmcnt(8)
    s_barrier
    s_add_u32 m0, s62, 98304
    s_nop 0
    buffer_load_dwordx4 v217, s[4:7], s94 offen lds
    buffer_load_dwordx4 v217, s[4:7], s94 offen offset:1024 lds
    s_add_u32 m0, s62, 49152
    s_mul_i32 s59, s93, 112
    buffer_load_dwordx4 v207, s[28:31], s59 offen lds
    buffer_load_dwordx4 v208, s[28:31], s59 offen offset:1024 lds
    buffer_load_dwordx4 v209, s[28:31], s59 offen offset:2048 lds
    buffer_load_dwordx4 v210, s[28:31], s59 offen offset:3072 lds
    s_add_u32 s93, s93, 6144
    s_and_b32 s93, s93, 65535
    s_barrier
    s_add_u32 m0, s62, 98304
    s_nop 0
    buffer_load_dwordx4 v217, s[4:7], s94 offen offset:2048 lds
    buffer_load_dwordx4 v217, s[4:7], s94 offen offset:3072 lds
    s_add_u32 s94, s94, 32768
    s_and_b32 s94, s94, 262143
    s_add_u32 m0, s62, 65536
    s_mul_i32 s59, s93, 112
    buffer_load_dwordx4 v207, s[28:31], s59 offen lds
    buffer_load_dwordx4 v208, s[28:31], s59 offen offset:1024 lds
    buffer_load_dwordx4 v209, s[28:31], s59 offen offset:2048 lds
    buffer_load_dwordx4 v210, s[28:31], s59 offen offset:3072 lds
    s_add_u32 s93, s93, 2048
    s_and_b32 s93, s93, 65535
    s_cmp_lg_u32 s42, 0
    s_cbranch_scc1 wf_77
    s_lshl_b32 s55, s51, 2
    s_add_u32 s55, s55, s54
    v_mov_b32 v252, 12288
    v_mov_b32 v253, 0x01010101
    s_mov_b64 exec, 1
    buffer_store_dword v253, v252, s[4:7], s55 offen sc0 sc1
    s_mov_b64 exec, -1
wf_77:
    s_xor_b32 s55, s42, 1
    s_or_b32 s55, s46, s55
    s_cbranch_scc1 cf_78
    v_mov_b32 v252, 0
    v_mov_b32 v253, 1
    s_lshl_b32 s55, s2, 2
    s_add_u32 s55, s55, 71566336
    s_mov_b64 exec, 1
    buffer_store_dword v253, v252, s[4:7], s55 offen sc0 sc1
    s_mov_b64 exec, -1
cf_78:
    s_waitcnt vmcnt(12)
    s_barrier
    s_add_u32 m0, s62, 114688
    s_nop 0
    buffer_load_dwordx4 v217, s[4:7], s94 offen lds
    buffer_load_dwordx4 v217, s[4:7], s94 offen offset:1024 lds
    s_add_u32 m0, s62, 81920
    s_mul_i32 s59, s93, 112
    buffer_load_dwordx4 v207, s[28:31], s59 offen lds
    buffer_load_dwordx4 v208, s[28:31], s59 offen offset:1024 lds
    buffer_load_dwordx4 v209, s[28:31], s59 offen offset:2048 lds
    buffer_load_dwordx4 v210, s[28:31], s59 offen offset:3072 lds
    s_add_u32 s93, s93, 6144
    s_and_b32 s93, s93, 65535
    s_waitcnt vmcnt(12)
    s_barrier
    s_add_u32 m0, s62, 114688
    s_nop 0
    buffer_load_dwordx4 v217, s[4:7], s94 offen offset:2048 lds
    buffer_load_dwordx4 v217, s[4:7], s94 offen offset:3072 lds
    s_add_u32 s94, s94, 32768
    s_and_b32 s94, s94, 262143
    s_add_u32 m0, s62, 0
    s_mul_i32 s59, s93, 112
    buffer_load_dwordx4 v207, s[28:31], s59 offen lds
    buffer_load_dwordx4 v208, s[28:31], s59 offen offset:1024 lds
    buffer_load_dwordx4 v209, s[28:31], s59 offen offset:2048 lds
    buffer_load_dwordx4 v210, s[28:31], s59 offen offset:3072 lds
    s_add_u32 s93, s93, 2048
    s_and_b32 s93, s93, 65535
    s_waitcnt vmcnt(12)
    s_barrier
    s_add_u32 m0, s62, 131072
    s_nop 0
    buffer_load_dwordx4 v217, s[4:7], s94 offen lds
    buffer_load_dwordx4 v217, s[4:7], s94 offen offset:1024 lds
    s_add_u32 m0, s62, 16384
    s_mul_i32 s59, s93, 112
    buffer_load_dwordx4 v207, s[28:31], s59 offen lds
    buffer_load_dwordx4 v208, s[28:31], s59 offen offset:1024 lds
    buffer_load_dwordx4 v209, s[28:31], s59 offen offset:2048 lds
    buffer_load_dwordx4 v210, s[28:31], s59 offen offset:3072 lds
    s_add_u32 s93, s93, 6144
    s_and_b32 s93, s93, 65535
    s_waitcnt vmcnt(12)
    s_barrier
    v_lshrrev_b32 v252, 2, v254
    v_min_u32 v252, 60, v252
    s_add_u32 s55, s54, 12288
    buffer_load_dword v251, v252, s[4:7], s55 offen sc0 sc1
    s_add_u32 m0, s62, 131072
    s_nop 0
    buffer_load_dwordx4 v217, s[4:7], s94 offen offset:2048 lds
    buffer_load_dwordx4 v217, s[4:7], s94 offen offset:3072 lds
    s_add_u32 s94, s94, 32768
    s_and_b32 s94, s94, 262143
    s_add_u32 m0, s62, 32768
    s_mul_i32 s59, s93, 112
    buffer_load_dwordx4 v207, s[28:31], s59 offen lds
    buffer_load_dwordx4 v208, s[28:31], s59 offen offset:1024 lds
    buffer_load_dwordx4 v209, s[28:31], s59 offen offset:2048 lds
    buffer_load_dwordx4 v210, s[28:31], s59 offen offset:3072 lds
    s_add_u32 s93, s93, 2048
    s_and_b32 s93, s93, 65535
    s_waitcnt vmcnt(13)
    s_barrier
    s_add_u32 m0, s62, 98304
    s_nop 0
    buffer_load_dwordx4 v217, s[4:7], s94 offen lds
    buffer_load_dwordx4 v217, s[4:7], s94 offen offset:1024 lds
    s_add_u32 m0, s62, 49152
    s_mul_i32 s59, s93, 112
    buffer_load_dwordx4 v207, s[28:31], s59 offen lds
    buffer_load_dwordx4 v208, s[28:31], s59 offen offset:1024 lds
    buffer_load_dwordx4 v209, s[28:31], s59 offen offset:2048 lds
    buffer_load_dwordx4 v210, s[28:31], s59 offen offset:3072 lds
    s_add_u32 s93, s93, 6144
    s_and_b32 s93, s93, 65535
    s_waitcnt vmcnt(13)
    s_barrier
    s_add_u32 m0, s62, 98304
    s_nop 0
    buffer_load_dwordx4 v217, s[4:7], s94 offen offset:2048 lds
    buffer_load_dwordx4 v217, s[4:7], s94 offen offset:3072 lds
    s_add_u32 s94, s94, 32768
    s_and_b32 s94, s94, 262143
    s_add_u32 m0, s62, 65536
    s_mul_i32 s59, s93, 112
    buffer_load_dwordx4 v207, s[28:31], s59 offen lds
    buffer_load_dwordx4 v208, s[28:31], s59 offen offset:1024 lds
    buffer_load_dwordx4 v209, s[28:31], s59 offen offset:2048 lds
    buffer_load_dwordx4 v210, s[28:31], s59 offen offset:3072 lds
    s_add_u32 s93, s93, 2048
    s_and_b32 s93, s93, 65535
    s_waitcnt vmcnt(12)
    s_barrier
    v_cmp_ne_u32 vcc, 0x01010101, v251
    s_cbranch_vccz ap_79
    v_lshrrev_b32 v252, 2, v254
    v_min_u32 v252, 60, v252
    s_add_u32 s55, s54, 12288
    s_mov_b32 s56, 262144
poll_80:
    buffer_load_dword v253, v252, s[4:7], s55 offen sc0 sc1
    s_waitcnt vmcnt(0)
    v_cmp_ne_u32 vcc, 0x01010101, v253
    s_cbranch_vccz pd_81
    s_sleep 1
    s_sub_u32 s56, s56, 1
    s_cmp_lg_u32 s56, 0
    s_cbranch_scc1 poll_80
pd_81:
ap_79:
    s_add_u32 m0, s62, 114688
    s_nop 0
    buffer_load_dwordx4 v217, s[4:7], s94 offen lds
    buffer_load_dwordx4 v217, s[4:7], s94 offen offset:1024 lds
    s_add_u32 m0, s62, 81920
    s_mul_i32 s59, s93, 112
    buffer_load_dwordx4 v207, s[28:31], s59 offen lds
    v_and_b32 v226, 0xf0, v254
    v_and_b32 v227, 0x300, v254
    v_lshl_add_u32 v227, v227, 2, v226
    s_lshl_b32 s78, s42, 8
    s_add_u32 s78, s78, s52
    buffer_load_dwordx4 v208, s[28:31], s59 offen offset:1024 lds
    buffer_load_dwordx4 v209, s[28:31], s59 offen offset:2048 lds
    buffer_load_dwordx4 v210, s[28:31], s59 offen offset:3072 lds
    s_add_u32 s93, s93, 6144
    s_and_b32 s93, s93, 65535
    buffer_load_dwordx4 v[96:99], v227, s[4:7], s78 offen
    s_add_u32 s78, s78, 4096
    s_waitcnt vmcnt(13)
    s_barrier
    s_mov_b32 s55, 71566336
    buffer_load_dwordx4 v[128:131], v254, s[4:7], s55 offen sc0 sc1
    s_add_u32 m0, s62, 114688
    s_nop 0
    buffer_load_dwordx4 v217, s[4:7], s94 offen offset:2048 lds
    buffer_load_dwordx4 v217, s[4:7], s94 offen offset:3072 lds
    s_add_u32 s94, s94, 49152
    s_and_b32 s94, s94, 262143
    s_add_u32 m0, s62, 0
    s_mul_i32 s59, s93, 112
    buffer_load_dwordx4 v207, s[28:31], s59 offen lds
    buffer_load_dwordx4 v208, s[28:31], s59 offen offset:1024 lds
    buffer_load_dwordx4 v209, s[28:31], s59 offen offset:2048 lds
    buffer_load_dwordx4 v210, s[28:31], s59 offen offset:3072 lds
    s_add_u32 s93, s93, 2048
    s_and_b32 s93, s93, 65535
    buffer_load_dwordx4 v[100:103], v227, s[4:7], s78 offen
    s_add_u32 s78, s78, 4096
    s_waitcnt vmcnt(15)
    s_barrier
    s_add_u32 m0, s62, 131072
    s_nop 0
    buffer_load_dwordx4 v217, s[4:7], s94 offen lds
    buffer_load_dwordx4 v217, s[4:7], s94 offen offset:1024 lds
    s_add_u32 m0, s62, 16384
    s_mul_i32 s59, s93, 112
    buffer_load_dwordx4 v207, s[28:31], s59 offen lds
    buffer_load_dwordx4 v208, s[28:31], s59 offen offset:1024 lds
    buffer_load_dwordx4 v209, s[28:31], s59 offen offset:2048 lds
    buffer_load_dwordx4 v210, s[28:31], s59 offen offset:3072 lds
    s_add_u32 s93, s93, 10240
    s_and_b32 s93, s93, 65535
    buffer_load_dwordx4 v[104:107], v227, s[4:7], s78 offen
    s_add_u32 s78, s78, 4096
    s_waitcnt vmcnt(16)
    s_barrier
    s_add_u32 m0, s62, 131072
    s_nop 0
    buffer_load_dwordx4 v217, s[4:7], s94 offen offset:2048 lds
    buffer_load_dwordx4 v217, s[4:7], s94 offen offset:3072 lds
    s_add_u32 s94, s94, 32768
    s_and_b32 s94, s94, 262143
    s_add_u32 m0, s62, 32768
    s_mul_i32 s59, s93, 112
    buffer_load_dwordx4 v207, s[28:31], s59 offen lds
    buffer_load_dwordx4 v208, s[28:31], s59 offen offset:1024 lds
    buffer_load_dwordx4 v209, s[28:31], s59 offen offset:2048 lds
    buffer_load_dwordx4 v210, s[28:31], s59 offen offset:3072 lds
    s_add_u32 s93, s93, 2048
    s_and_b32 s93, s93, 65535
    buffer_load_dwordx4 v[108:111], v227, s[4:7], s78 offen
    s_add_u32 s78, s78, 4096
    s_waitcnt vmcnt(15)
    s_barrier
    s_cmp_eq_u32 s46, 1
    s_cbranch_scc1 a4_82
    v_and_b32 v128, v128, v129
    v_and_b32 v130, v130, v131
    v_and_b32 v128, v128, v130
    v_cmp_ne_u32 vcc, 1, v128
    s_cbranch_vccz a4_82
    s_mov_b32 s55, 71566336
    s_mov_b32 s56, 262144
p4_83:
    buffer_load_dwordx4 v[128:131], v254, s[4:7], s55 offen sc0 sc1
    s_waitcnt vmcnt(0)
    v_and_b32 v128, v128, v129
    v_and_b32 v130, v130, v131
    v_and_b32 v128, v128, v130
    v_cmp_ne_u32 vcc, 1, v128
    s_cbranch_vccz p4_84
    s_sleep 1
    s_sub_u32 s56, s56, 1
    s_cmp_lg_u32 s56, 0
    s_cbranch_scc1 p4_83
p4_84:
a4_82:
    s_cmp_lg_u32 s46, 0
    s_cbranch_scc1 cs_85
    s_and_b32 s55, s41, 1
    s_mul_i32 s56, s55, 384
    s_xor_b32 s55, s55, 1
    s_lshl_b32 s55, s55, 9
    s_cmp_eq_u32 s44, 0
    s_cselect_b32 s55, s56, s55
    s_mul_i32 s56, s41, 896
    s_add_u32 s55, s55, s56
    s_mul_i32 s56, s43, 14336
    s_add_u32 s55, s55, s56
    s_add_u32 s55, s55, 70778880
    v_lshrrev_b32 v224, 9, v254
    v_mul_u32_u24 v224, 28672, v224
    v_and_b32 v225, 0x1f0, v254
    v_add_u32 v224, v224, v225
    buffer_load_dwordx4 v[128:131], v224, s[4:7], s55 offen sc1
    s_add_u32 s55, s55, 57344
    buffer_load_dwordx4 v[132:135], v224, s[4:7], s55 offen sc1
    s_add_u32 s55, s55, 57344
    buffer_load_dwordx4 v[136:139], v224, s[4:7], s55 offen sc1
    s_add_u32 s55, s55, 57344
    buffer_load_dwordx4 v[140:143], v224, s[4:7], s55 offen sc1
    s_add_u32 s55, s55, 57344
cs_85:
    s_add_u32 m0, s62, 98304
    s_nop 0
    buffer_load_dwordx4 v217, s[4:7], s94 offen lds
    buffer_load_dwordx4 v217, s[4:7], s94 offen offset:1024 lds
    s_add_u32 m0, s62, 49152
    s_mul_i32 s59, s93, 112
    buffer_load_dwordx4 v207, s[28:31], s59 offen lds
    buffer_load_dwordx4 v208, s[28:31], s59 offen offset:1024 lds
    buffer_load_dwordx4 v209, s[28:31], s59 offen offset:2048 lds
    buffer_load_dwordx4 v210, s[28:31], s59 offen offset:3072 lds
    s_add_u32 s93, s93, 6144
    s_and_b32 s93, s93, 65535
    s_waitcnt vmcnt(14)
    s_barrier
    s_add_u32 m0, s62, 98304
    s_nop 0
    buffer_load_dwordx4 v217, s[4:7], s94 offen offset:2048 lds
    buffer_load_dwordx4 v217, s[4:7], s94 offen offset:3072 lds
    s_add_u32 s94, s94, 32768
    s_and_b32 s94, s94, 262143
    s_add_u32 m0, s62, 65536
    s_mul_i32 s59, s93, 112
    buffer_load_dwordx4 v207, s[28:31], s59 offen lds
    buffer_load_dwordx4 v208, s[28:31], s59 offen offset:1024 lds
    buffer_load_dwordx4 v209, s[28:31], s59 offen offset:2048 lds
    buffer_load_dwordx4 v210, s[28:31], s59 offen offset:3072 lds
    s_add_u32 s93, s93, 2048
    s_and_b32 s93, s93, 65535
    s_lshl_b32 s55, s46, 4
    s_add_u32 s55, s55, s40
    s_cmp_lg_u32 s55, 0
    s_cbranch_scc1 w2_86
    s_call_b64 s[70:71], Y_w2
w2_86:
    s_waitcnt vmcnt(13)
    s_barrier
    s_waitcnt vmcnt(12)
    s_add_u32 m0, s62, 114688
    s_nop 0
    buffer_load_dwordx4 v217, s[4:7], s94 offen lds
    v_add_f32 v96, v96, v100
    v_add_f32 v97, v97, v101
    v_add_f32 v98, v98, v102
    v_add_f32 v99, v99, v103
    buffer_load_dwordx4 v217, s[4:7], s94 offen offset:1024 lds
    v_add_f32 v104, v104, v108
    v_add_f32 v105, v105, v109
    v_add_f32 v106, v106, v110
    v_add_f32 v107, v107, v111
    s_add_u32 m0, s62, 81920
    s_mul_i32 s59, s93, 112
    buffer_load_dwordx4 v207, s[28:31], s59 offen lds
    v_add_f32 v192, v96, v104
    v_add_f32 v193, v97, v105
    v_add_f32 v194, v98, v106
    v_add_f32 v195, v99, v107
    buffer_load_dwordx4 v208, s[28:31], s59 offen offset:1024 lds
    v_mov_b32 v96, v192
    v_mov_b32 v97, v193
    v_mov_b32 v98, v194
    v_mov_b32 v99, v195
    buffer_load_dwordx4 v209, s[28:31], s59 offen offset:2048 lds
    s_nop 1
    v_permlane16_swap_b32 v192, v96
    v_permlane16_swap_b32 v193, v97
    v_permlane16_swap_b32 v194, v98
    buffer_load_dwordx4 v210, s[28:31], s59 offen offset:3072 lds
    s_add_u32 s93, s93, 6144
    s_and_b32 s93, s93, 65535
    v_permlane16_swap_b32 v195, v99
    v_add_f32 v192, v192, v96
    v_add_f32 v193, v193, v97
    v_add_f32 v194, v194, v98
    v_add_f32 v195, v195, v99
    s_lshl_b32 s55, s46, 4
    s_add_u32 s55, s55, s40
    s_cmp_lg_u32 s55, 4
    s_cbranch_scc1 w2_87
    s_call_b64 s[70:71], Y_w2
w2_87:
    s_waitcnt vmcnt(12)
    s_barrier
    s_add_u32 m0, s62, 114688
    s_nop 0
    buffer_load_dwordx4 v217, s[4:7], s94 offen offset:2048 lds
    v_mov_b32 v96, v192
    v_mov_b32 v97, v193
    buffer_load_dwordx4 v217, s[4:7], s94 offen offset:3072 lds
    s_add_u32 s94, s94, 32768
    s_and_b32 s94, s94, 262143
    v_mov_b32 v98, v194
    v_mov_b32 v99, v195
    s_add_u32 m0, s62, 0
    s_mul_i32 s59, s93, 112
    buffer_load_dwordx4 v207, s[28:31], s59 offen lds
    s_nop 1
    v_permlane32_swap_b32 v192, v96
    buffer_load_dwordx4 v208, s[28:31], s59 offen offset:1024 lds
    v_permlane32_swap_b32 v193, v97
    v_permlane32_swap_b32 v194, v98
    buffer_load_dwordx4 v209, s[28:31], s59 offen offset:2048 lds
    v_permlane32_swap_b32 v195, v99
    v_add_f32 v192, v192, v96
    buffer_load_dwordx4 v210, s[28:31], s59 offen offset:3072 lds
    s_add_u32 s93, s93, 2048
    s_and_b32 s93, s93, 65535
    v_add_f32 v193, v193, v97
    v_add_f32 v194, v194, v98
    v_add_f32 v195, v195, v99
    s_lshl_b32 s55, s46, 4
    s_add_u32 s55, s55, s40
    s_cmp_lg_u32 s55, 8
    s_cbranch_scc1 w2_88
    s_call_b64 s[70:71], Y_w2
w2_88:
    s_waitcnt vmcnt(12)
    s_barrier
    s_cmp_lg_u32 s46, 0
    s_cbranch_scc1 cs_89
    v_add_f32 v128, v128, v132
    v_add_f32 v136, v136, v140
    v_add_f32 v129, v129, v133
    v_add_f32 v137, v137, v141
    v_add_f32 v130, v130, v134
    v_add_f32 v138, v138, v142
    v_add_f32 v131, v131, v135
    v_add_f32 v139, v139, v143
    v_add_f32 v128, v128, v136
    v_add_f32 v129, v129, v137
    v_add_f32 v130, v130, v138
    v_add_f32 v131, v131, v139
    v_mov_b32 v132, v128
    v_mov_b32 v133, v129
    v_mov_b32 v134, v130
    v_mov_b32 v135, v131
    s_nop 1
    v_permlane32_swap_b32 v128, v132
    v_permlane32_swap_b32 v129, v133
    v_permlane32_swap_b32 v130, v134
    v_permlane32_swap_b32 v131, v135
    v_add_f32 v128, v128, v132
    v_add_f32 v129, v129, v133
    v_add_f32 v130, v130, v134
    v_add_f32 v131, v131, v135
    s_lshl_b32 s55, s42, 9
    s_add_u32 s55, s55, 161664
    v_and_b32 v225, 0x1f0, v254
    v_add_u32 v224, s55, v225
    s_mov_b64 exec, 0xffffffff
    ds_write_b128 v224, v[128:131]
    s_mov_b64 exec, -1
cs_89:
    s_add_u32 m0, s62, 131072
    s_nop 0
    buffer_load_dwordx4 v217, s[4:7], s94 offen lds
    v_mul_f32 v192, 0x3a800000, v192
    v_mul_f32 v193, 0x3a800000, v193
    buffer_load_dwordx4 v217, s[4:7], s94 offen offset:1024 lds
    v_fma_f32 v193, -v192, v192, v193
    v_max_f32 v193, 0, v193
    v_cvt_pk_bf16_f32 v192, v192, v192
    s_add_u32 m0, s62, 16384
    s_mul_i32 s59, s93, 112
    buffer_load_dwordx4 v207, s[28:31], s59 offen lds
    v_lshlrev_b32 v192, 16, v192
    v_cvt_pk_bf16_f32 v193, v193, v193
    v_lshlrev_b32 v193, 16, v193
    buffer_load_dwordx4 v208, s[28:31], s59 offen offset:1024 lds
    v_add_f32 v193, 0x3727c5ac, v193
    v_cvt_pk_bf16_f32 v193, v193, v193
    v_lshlrev_b32 v193, 16, v193
    buffer_load_dwordx4 v209, s[28:31], s59 offen offset:2048 lds
    v_sqrt_f32 v193, v193
    s_nop 0
    v_cvt_pk_bf16_f32 v193, v193, v193
    buffer_load_dwordx4 v210, s[28:31], s59 offen offset:3072 lds
    s_add_u32 s93, s93, 6144
    s_and_b32 s93, s93, 65535
    v_lshlrev_b32 v193, 16, v193
    v_rcp_f32 v193, v193
    s_nop 0
    s_lshl_b32 s55, s46, 4
    s_add_u32 s55, s55, s40
    s_cmp_lg_u32 s55, 12
    s_cbranch_scc1 w2_90
    s_call_b64 s[70:71], Y_w2
w2_90:
    s_waitcnt vmcnt(12)
    s_barrier
    s_add_u32 m0, s62, 131072
    s_nop 0
    buffer_load_dwordx4 v217, s[4:7], s94 offen offset:2048 lds
    v_mul_f32 v194, 0x3a800000, v194
    v_mul_f32 v195, 0x3a800000, v195
    v_fma_f32 v195, -v194, v194, v195
    buffer_load_dwordx4 v217, s[4:7], s94 offen offset:3072 lds
    s_add_u32 s94, s94, 32768
    s_and_b32 s94, s94, 262143
    v_max_f32 v195, 0, v195
    v_cvt_pk_bf16_f32 v194, v194, v194
    v_lshlrev_b32 v194, 16, v194
    s_add_u32 m0, s62, 32768
    s_mul_i32 s59, s93, 112
    buffer_load_dwordx4 v207, s[28:31], s59 offen lds
    v_cvt_pk_bf16_f32 v195, v195, v195
    v_lshlrev_b32 v195, 16, v195
    v_add_f32 v195, 0x3727c5ac, v195
    buffer_load_dwordx4 v208, s[28:31], s59 offen offset:1024 lds
    v_cvt_pk_bf16_f32 v195, v195, v195
    v_lshlrev_b32 v195, 16, v195
    v_sqrt_f32 v195, v195
    buffer_load_dwordx4 v209, s[28:31], s59 offen offset:2048 lds
    s_nop 0
    v_cvt_pk_bf16_f32 v195, v195, v195
    v_lshlrev_b32 v195, 16, v195
    buffer_load_dwordx4 v210, s[28:31], s59 offen offset:3072 lds
    s_add_u32 s93, s93, 2048
    s_and_b32 s93, s93, 65535
    v_rcp_f32 v195, v195
    s_nop 0
    s_lshl_b32 s55, s42, 8
    s_add_u32 s55, s55, 159744
    v_add_u32 v226, s55, v226
    s_mov_b64 exec, 0xffff
    ds_write_b128 v226, v[192:195]
    s_mov_b64 exec, -1
    s_lshl_b32 s55, s46, 4
    s_add_u32 s55, s55, s40
    s_cmp_lg_u32 s55, 1
    s_cbranch_scc1 w2_91
    s_call_b64 s[70:71], Y_w2
w2_91:
    s_waitcnt vmcnt(12)
    s_barrier
    s_add_u32 m0, s62, 98304
    s_nop 0
    buffer_load_dwordx4 v217, s[4:7], s94 offen lds
    buffer_load_dwordx4 v217, s[4:7], s94 offen offset:1024 lds
    s_add_u32 m0, s62, 49152
    s_mul_i32 s59, s93, 112
    buffer_load_dwordx4 v207, s[28:31], s59 offen lds
    buffer_load_dwordx4 v208, s[28:31], s59 offen offset:1024 lds
    buffer_load_dwordx4 v209, s[28:31], s59 offen offset:2048 lds
    buffer_load_dwordx4 v210, s[28:31], s59 offen offset:3072 lds
    s_add_u32 s93, s93, 6144
    s_and_b32 s93, s93, 65535
    s_lshl_b32 s55, s46, 4
    s_add_u32 s55, s55, s40
    s_cmp_lg_u32 s55, 5
    s_cbranch_scc1 w2_92
    s_call_b64 s[70:71], Y_w2
w2_92:
    s_waitcnt vmcnt(12)
    s_barrier
    s_add_u32 m0, s62, 98304
    s_nop 0
    buffer_load_dwordx4 v217, s[4:7], s94 offen offset:2048 lds
    s_lshl_b32 s55, s43, 13
    s_add_u32 s55, s55, 98304
    v_add_u32 v176, s55, v254
    v_lshrrev_b32 v224, 6, v254
    v_lshrrev_b32 v225, 1, v224
    buffer_load_dwordx4 v217, s[4:7], s94 offen offset:3072 lds
    s_add_u32 s94, s94, 32768
    s_and_b32 s94, s94, 262143
    v_and_b32 v225, 3, v225
    s_lshl_b32 s55, s44, 1
    v_xor_b32 v225, s55, v225
    v_lshlrev_b32 v225, 5, v225
    v_lshl_add_u32 v225, v224, 7, v225
    s_add_u32 m0, s62, 65536
    s_mul_i32 s59, s93, 112
    buffer_load_dwordx4 v207, s[28:31], s59 offen lds
    v_and_b32 v180, 0x30, v254
    v_lshrrev_b32 v180, 1, v180
    v_add_u32 v177, v225, v180
    buffer_load_dwordx4 v208, s[28:31], s59 offen offset:1024 lds
    v_xor_b32 v178, 32, v177
    v_lshrrev_b32 v225, 2, v224
    v_and_b32 v225, 1, v225
    v_xor_b32 v225, s44, v225
    buffer_load_dwordx4 v209, s[28:31], s59 offen offset:2048 lds
    v_lshlrev_b32 v225, 5, v225
    v_lshl_add_u32 v225, v224, 6, v225
    v_add_u32 v225, v225, v180
    buffer_load_dwordx4 v210, s[28:31], s59 offen offset:3072 lds
    s_add_u32 s93, s93, 2048
    s_and_b32 s93, s93, 65535
    v_add_u32 v179, 2048, v225
    v_add_u32 v180, 49152, v177
    v_add_u32 v181, 49152, v178
    v_add_u32 v182, 49152, v179
    s_lshl_b32 s55, s46, 4
    s_add_u32 s55, s55, s40
    s_cmp_lg_u32 s55, 9
    s_cbranch_scc1 w2_93
    s_call_b64 s[70:71], Y_w2
w2_93:
    s_waitcnt vmcnt(12)
    s_barrier
    s_add_u32 m0, s62, 114688
    s_nop 0
    buffer_load_dwordx4 v217, s[4:7], s94 offen lds
    buffer_load_dwordx4 v217, s[4:7], s94 offen offset:1024 lds
    s_add_u32 m0, s62, 81920
    s_mul_i32 s59, s93, 112
    buffer_load_dwordx4 v207, s[28:31], s59 offen lds
    buffer_load_dwordx4 v208, s[28:31], s59 offen offset:1024 lds
    buffer_load_dwordx4 v209, s[28:31], s59 offen offset:2048 lds
    buffer_load_dwordx4 v210, s[28:31], s59 offen offset:3072 lds
    s_add_u32 s93, s93, 6144
    s_and_b32 s93, s93, 65535
    s_lshl_b32 s55, s46, 4
    s_add_u32 s55, s55, s40
    s_cmp_lg_u32 s55, 13
    s_cbranch_scc1 w2_94
    s_call_b64 s[70:71], Y_w2
w2_94:
    s_waitcnt vmcnt(12) lgkmcnt(0)
    s_barrier
    s_add_u32 m0, s62, 114688
    s_nop 0
    buffer_load_dwordx4 v217, s[4:7], s94 offen offset:2048 lds
    s_lshl_b32 s55, s43, 9
    s_add_u32 s55, s55, 159744
    v_and_b32 v224, 0xf0, v254
    v_lshrrev_b32 v224, 1, v224
    v_add_u32 v224, s55, v224
    ds_read_b64 v[96:97], v224 offset:0
    ds_read_b64 v[98:99], v224 offset:128
    buffer_load_dwordx4 v217, s[4:7], s94 offen offset:3072 lds
    s_add_u32 s94, s94, 32768
    s_and_b32 s94, s94, 262143
    ds_read_b64 v[100:101], v224 offset:256
    ds_read_b64 v[102:103], v224 offset:384
    s_waitcnt lgkmcnt(0)
    s_add_u32 m0, s62, 0
    s_mul_i32 s59, s93, 112
    buffer_load_dwordx4 v207, s[28:31], s59 offen lds
    v_sub_f32 v196, 0, v96
    v_mul_f32 v184, 0xbfb8aa3b, v97
    v_mul_f32 v188, v97, v97
    v_sub_f32 v197, 0, v98
    buffer_load_dwordx4 v208, s[28:31], s59 offen offset:1024 lds
    v_mul_f32 v185, 0xbfb8aa3b, v99
    v_mul_f32 v189, v99, v99
    v_sub_f32 v198, 0, v100
    buffer_load_dwordx4 v209, s[28:31], s59 offen offset:2048 lds
    v_mul_f32 v186, 0xbfb8aa3b, v101
    v_mul_f32 v190, v101, v101
    v_sub_f32 v199, 0, v102
    buffer_load_dwordx4 v210, s[28:31], s59 offen offset:3072 lds
    s_add_u32 s93, s93, 2048
    s_and_b32 s93, s93, 65535
    v_mul_f32 v187, 0xbfb8aa3b, v103
    v_mul_f32 v191, v103, v103
    v_rcp_f32 v188, v188
    v_rcp_f32 v189, v189
    s_lshl_b32 s55, s46, 4
    s_add_u32 s55, s55, s40
    s_cmp_lg_u32 s55, 2
    s_cbranch_scc1 w2_95
    s_call_b64 s[70:71], Y_w2
w2_95:
    s_waitcnt vmcnt(12)
    s_barrier
    s_add_u32 m0, s62, 131072
    s_nop 0
    buffer_load_dwordx4 v217, s[4:7], s94 offen lds
    v_rcp_f32 v190, v190
    v_rcp_f32 v191, v191
    s_nop 0
    buffer_load_dwordx4 v217, s[4:7], s94 offen offset:1024 lds
    v_lshrrev_b32 v224, 8, v254
    v_lshlrev_b32 v224, 4, v224
    v_add_u32 v224, 162688, v224
    s_and_b32 s56, s41, 1
    s_add_u32 s55, s56, s44
    s_lshl_b32 s55, s55, 7
    v_add_u32 v225, s55, v224
    s_xor_b32 s56, s56, 1
    s_lshl_b32 s56, s56, 2
    s_add_u32 s56, s56, s44
    s_lshl_b32 s56, s56, 6
    v_add_u32 v224, s56, v224
    s_add_u32 m0, s62, 16384
    s_mul_i32 s59, s93, 112
    buffer_load_dwordx4 v207, s[28:31], s59 offen lds
    ds_read_b128 v[96:99], v225 offset:0
    ds_read_b128 v[100:103], v225 offset:64
    ds_read_b128 v[104:107], v224 offset:0
    buffer_load_dwordx4 v208, s[28:31], s59 offen offset:1024 lds
    ds_read_b128 v[108:111], v225 offset:512
    ds_read_b128 v[112:115], v225 offset:576
    ds_read_b128 v[116:119], v224 offset:512
    s_waitcnt lgkmcnt(0)
    buffer_load_dwordx4 v209, s[28:31], s59 offen offset:2048 lds
    v_mul_f32 v0, v196, v96
    v_mul_f32 v1, v196, v97
    v_mul_f32 v2, v196, v98
    buffer_load_dwordx4 v210, s[28:31], s59 offen offset:3072 lds
    s_add_u32 s93, s93, 6144
    s_and_b32 s93, s93, 65535
    v_mul_f32 v3, v196, v99
    v_mul_f32 v4, v197, v96
    v_mul_f32 v5, v197, v97
    v_mul_f32 v6, v197, v98
    s_lshl_b32 s55, s46, 4
    s_add_u32 s55, s55, s40
    s_cmp_lg_u32 s55, 6
    s_cbranch_scc1 w2_96
    s_call_b64 s[70:71], Y_w2
w2_96:
    s_waitcnt vmcnt(12)
    s_barrier
    s_add_u32 m0, s62, 131072
    s_nop 0
    buffer_load_dwordx4 v217, s[4:7], s94 offen offset:2048 lds
    v_mul_f32 v7, v197, v99
    v_mul_f32 v8, v198, v96
    v_mul_f32 v9, v198, v97
    v_mul_f32 v10, v198, v98
    buffer_load_dwordx4 v217, s[4:7], s94 offen offset:3072 lds
    s_add_u32 s94, s94, 32768
    s_and_b32 s94, s94, 262143
    v_mul_f32 v11, v198, v99
    v_mul_f32 v12, v199, v96
    v_mul_f32 v13, v199, v97
    v_mul_f32 v14, v199, v98
    s_add_u32 m0, s62, 32768
    s_mul_i32 s59, s93, 112
    buffer_load_dwordx4 v207, s[28:31], s59 offen lds
    v_mul_f32 v15, v199, v99
    v_mul_f32 v16, v196, v100
    v_mul_f32 v17, v196, v101
    v_mul_f32 v18, v196, v102
    buffer_load_dwordx4 v208, s[28:31], s59 offen offset:1024 lds
    v_mul_f32 v19, v196, v103
    v_mul_f32 v20, v197, v100
    v_mul_f32 v21, v197, v101
    v_mul_f32 v22, v197, v102
    buffer_load_dwordx4 v209, s[28:31], s59 offen offset:2048 lds
    v_mul_f32 v23, v197, v103
    v_mul_f32 v24, v198, v100
    v_mul_f32 v25, v198, v101
    v_mul_f32 v26, v198, v102
    buffer_load_dwordx4 v210, s[28:31], s59 offen offset:3072 lds
    s_add_u32 s93, s93, 2048
    s_and_b32 s93, s93, 65535
    v_mul_f32 v27, v198, v103
    v_mul_f32 v28, v199, v100
    v_mul_f32 v29, v199, v101
    v_mul_f32 v30, v199, v102
    s_lshl_b32 s55, s46, 4
    s_add_u32 s55, s55, s40
    s_cmp_lg_u32 s55, 10
    s_cbranch_scc1 w2_97
    s_call_b64 s[70:71], Y_w2
w2_97:
    s_waitcnt vmcnt(12)
    s_barrier
    s_add_u32 m0, s62, 98304
    s_nop 0
    buffer_load_dwordx4 v217, s[4:7], s94 offen lds
    v_mul_f32 v31, v199, v103
    v_mul_f32 v32, v196, v104
    v_mul_f32 v33, v196, v105
    v_mul_f32 v34, v196, v106
    buffer_load_dwordx4 v217, s[4:7], s94 offen offset:1024 lds
    v_mul_f32 v35, v196, v107
    v_mul_f32 v36, v197, v104
    v_mul_f32 v37, v197, v105
    v_mul_f32 v38, v197, v106
    s_add_u32 m0, s62, 49152
    s_mul_i32 s59, s93, 112
    buffer_load_dwordx4 v207, s[28:31], s59 offen lds
    v_mul_f32 v39, v197, v107
    v_mul_f32 v40, v198, v104
    v_mul_f32 v41, v198, v105
    v_mul_f32 v42, v198, v106
    buffer_load_dwordx4 v208, s[28:31], s59 offen offset:1024 lds
    v_mul_f32 v43, v198, v107
    v_mul_f32 v44, v199, v104
    v_mul_f32 v45, v199, v105
    v_mul_f32 v46, v199, v106
    buffer_load_dwordx4 v209, s[28:31], s59 offen offset:2048 lds
    v_mul_f32 v47, v199, v107
    v_mul_f32 v48, v196, v108
    v_mul_f32 v49, v196, v109
    v_mul_f32 v50, v196, v110
    buffer_load_dwordx4 v210, s[28:31], s59 offen offset:3072 lds
    s_add_u32 s93, s93, 6144
    s_and_b32 s93, s93, 65535
    v_mul_f32 v51, v196, v111
    v_mul_f32 v52, v197, v108
    v_mul_f32 v53, v197, v109
    v_mul_f32 v54, v197, v110
    s_lshl_b32 s55, s46, 4
    s_add_u32 s55, s55, s40
    s_cmp_lg_u32 s55, 14
    s_cbranch_scc1 w2_98
    s_call_b64 s[70:71], Y_w2
w2_98:
    s_waitcnt vmcnt(12)
    s_barrier
    s_add_u32 m0, s62, 98304
    s_nop 0
    buffer_load_dwordx4 v217, s[4:7], s94 offen offset:2048 lds
    v_mul_f32 v55, v197, v111
    v_mul_f32 v56, v198, v108
    v_mul_f32 v57, v198, v109
    v_mul_f32 v58, v198, v110
    buffer_load_dwordx4 v217, s[4:7], s94 offen offset:3072 lds
    v_mul_f32 v59, v198, v111
    v_mul_f32 v60, v199, v108
    v_mul_f32 v61, v199, v109
    v_mul_f32 v62, v199, v110
    s_add_u32 m0, s62, 65536
    s_mul_i32 s59, s93, 112
    buffer_load_dwordx4 v207, s[28:31], s59 offen lds
    v_mul_f32 v63, v199, v111
    v_mul_f32 v64, v196, v112
    v_mul_f32 v65, v196, v113
    v_mul_f32 v66, v196, v114
    buffer_load_dwordx4 v208, s[28:31], s59 offen offset:1024 lds
    v_mul_f32 v67, v196, v115
    v_mul_f32 v68, v197, v112
    v_mul_f32 v69, v197, v113
    v_mul_f32 v70, v197, v114
    buffer_load_dwordx4 v209, s[28:31], s59 offen offset:2048 lds
    v_mul_f32 v71, v197, v115
    v_mul_f32 v72, v198, v112
    v_mul_f32 v73, v198, v113
    v_mul_f32 v74, v198, v114
    buffer_load_dwordx4 v210, s[28:31], s59 offen offset:3072 lds
    s_add_u32 s93, s93, 2048
    s_and_b32 s93, s93, 65535
    v_mul_f32 v75, v198, v115
    v_mul_f32 v76, v199, v112
    v_mul_f32 v77, v199, v113
    v_mul_f32 v78, v199, v114
    s_lshl_b32 s55, s46, 4
    s_add_u32 s55, s55, s40
    s_cmp_lg_u32 s55, 3
    s_cbranch_scc1 w2_99
    s_call_b64 s[70:71], Y_w2
w2_99:
    s_waitcnt vmcnt(12)
    s_barrier
    s_add_u32 m0, s62, 81920
    s_mul_i32 s59, s93, 112
    buffer_load_dwordx4 v207, s[28:31], s59 offen lds
    v_mul_f32 v79, v199, v115
    v_mul_f32 v80, v196, v116
    buffer_load_dwordx4 v208, s[28:31], s59 offen offset:1024 lds
    v_mul_f32 v81, v196, v117
    v_mul_f32 v82, v196, v118
    buffer_load_dwordx4 v209, s[28:31], s59 offen offset:2048 lds
    v_mul_f32 v83, v196, v119
    v_mul_f32 v84, v197, v116
    buffer_load_dwordx4 v210, s[28:31], s59 offen offset:3072 lds
    v_mul_f32 v85, v197, v117
    v_mul_f32 v86, v197, v118
    s_add_u32 s93, s51, 11
    s_and_b32 s93, s93, 15
    s_lshl_b32 s93, s93, 12
    s_add_u32 m0, s61, 0
    s_mul_i32 s59, s93, 112
    buffer_load_dwordx4 v211, s[24:27], s59 offen lds
    v_mul_f32 v87, v197, v119
    v_mul_f32 v88, v198, v116
    buffer_load_dwordx4 v212, s[24:27], s59 offen offset:1024 lds
    v_mul_f32 v89, v198, v117
    v_mul_f32 v90, v198, v118
    buffer_load_dwordx4 v222, s[4:7], s93 offen offset:2048 lds
    s_add_u32 s93, s93, 2048
    s_and_b32 s93, s93, 65535
    v_mul_f32 v91, v198, v119
    v_mul_f32 v92, v199, v116
    s_add_u32 m0, s61, 16384
    s_mul_i32 s59, s93, 112
    buffer_load_dwordx4 v211, s[24:27], s59 offen lds
    v_mul_f32 v93, v199, v117
    v_mul_f32 v94, v199, v118
    v_mul_f32 v95, v199, v119
    s_lshl_b32 s55, s46, 4
    s_add_u32 s55, s55, s40
    s_cmp_lg_u32 s55, 7
    s_cbranch_scc1 w2_100
    s_call_b64 s[70:71], Y_w2
w2_100:
    s_waitcnt vmcnt(14)
    s_barrier
    s_add_u32 m0, s61, 16384
    s_nop 0
    buffer_load_dwordx4 v212, s[24:27], s59 offen offset:1024 lds
    buffer_load_dwordx4 v222, s[4:7], s93 offen offset:2048 lds
    s_add_u32 s93, s93, 6144
    s_and_b32 s93, s93, 65535
    s_add_u32 m0, s61, 32768
    s_mul_i32 s59, s93, 112
    buffer_load_dwordx4 v211, s[24:27], s59 offen lds
    buffer_load_dwordx4 v212, s[24:27], s59 offen offset:1024 lds
    buffer_load_dwordx4 v222, s[4:7], s93 offen offset:2048 lds
    s_add_u32 s93, s93, 2048
    s_and_b32 s93, s93, 65535
    s_lshl_b32 s55, s46, 4
    s_add_u32 s55, s55, s40
    s_cmp_lg_u32 s55, 11
    s_cbranch_scc1 w2_101
    s_call_b64 s[70:71], Y_w2
w2_101:
    s_waitcnt vmcnt(13)
    s_barrier
    s_add_u32 m0, s61, 49152
    s_mul_i32 s59, s93, 112
    buffer_load_dwordx4 v211, s[24:27], s59 offen lds
    buffer_load_dwordx4 v212, s[24:27], s59 offen offset:1024 lds
    buffer_load_dwordx4 v222, s[4:7], s93 offen offset:2048 lds
    s_add_u32 s93, s93, 6144
    s_and_b32 s93, s93, 65535
    s_lshl_b32 s55, s46, 4
    s_add_u32 s55, s55, s40
    s_cmp_lg_u32 s55, 15
    s_cbranch_scc1 w2_102
    s_call_b64 s[70:71], Y_w2
w2_102:
    s_waitcnt vmcnt(12)
    s_barrier
    s_add_u32 m0, s61, 65536
    s_mul_i32 s59, s93, 112
    buffer_load_dwordx4 v211, s[24:27], s59 offen lds
    buffer_load_dwordx4 v212, s[24:27], s59 offen offset:1024 lds
    buffer_load_dwordx4 v222, s[4:7], s93 offen offset:2048 lds
    s_add_u32 s93, s93, 2048
    s_and_b32 s93, s93, 65535
    s_waitcnt vmcnt(12)
    s_barrier
    s_add_u32 m0, s61, 81920
    s_mul_i32 s59, s93, 112
    buffer_load_dwordx4 v211, s[24:27], s59 offen lds
    buffer_load_dwordx4 v212, s[24:27], s59 offen offset:1024 lds
    buffer_load_dwordx4 v222, s[4:7], s93 offen offset:2048 lds
    s_add_u32 s93, s93, 2048
    s_and_b32 s93, s93, 65535
    s_setprio 0
    ds_read_b64_tr_b16 v[128:129], v177 offset:0
    ds_read_b64_tr_b16 v[130:131], v177 offset:3072
    ds_read_b128 v[96:99], v176 offset:16384
    ds_read_b128 v[100:103], v176 offset:18432
    ds_read_b128 v[104:107], v176 offset:20480
    ds_read_b128 v[108:111], v176 offset:22528
    ds_read_b64_tr_b16 v[140:141], v177 offset:6144
    ds_read_b64_tr_b16 v[142:143], v177 offset:9216
    ds_read_b64_tr_b16 v[132:133], v178 offset:0
    ds_read_b64_tr_b16 v[134:135], v178 offset:3072
    ds_read_b64_tr_b16 v[144:145], v178 offset:6144
    ds_read_b64_tr_b16 v[146:147], v178 offset:9216
    ds_read_b64_tr_b16 v[136:137], v179 offset:0
    ds_read_b64_tr_b16 v[138:139], v179 offset:3072
    ds_read_b64_tr_b16 v[148:149], v179 offset:6144
    ds_read_b64_tr_b16 v[150:151], v179 offset:9216
    s_add_u32 s88, s95, s62
    v_add_u32 v217, s88, v254
    s_mov_b32 s58, 5
    s_waitcnt vmcnt(12) lgkmcnt(0)
    s_barrier
    .p2align 3
    v_mfma_f32_16x16x32_bf16 v[0:3], v[128:131], v[96:99], v[0:3]
    ds_read_b64_tr_b16 v[152:153], v177 offset:16384
    v_mfma_f32_16x16x32_bf16 v[4:7], v[128:131], v[100:103], v[4:7]
    ds_read_b64_tr_b16 v[154:155], v177 offset:19456
    v_mfma_f32_16x16x32_bf16 v[8:11], v[128:131], v[104:107], v[8:11]
    ds_read_b128 v[112:115], v176 offset:17408
    v_mfma_f32_16x16x32_bf16 v[12:15], v[128:131], v[108:111], v[12:15]
    ds_read_b128 v[116:119], v176 offset:19456
    v_mfma_f32_16x16x32_bf16 v[60:63], v[140:143], v[108:111], v[60:63]
    ds_read_b128 v[120:123], v176 offset:21504
    v_mfma_f32_16x16x32_bf16 v[56:59], v[140:143], v[104:107], v[56:59]
    ds_read_b128 v[124:127], v176 offset:23552
    v_mfma_f32_16x16x32_bf16 v[52:55], v[140:143], v[100:103], v[52:55]
    ds_read_b64_tr_b16 v[164:165], v177 offset:22528
    v_mfma_f32_16x16x32_bf16 v[48:51], v[140:143], v[96:99], v[48:51]
    ds_read_b64_tr_b16 v[166:167], v177 offset:25600
    v_mfma_f32_16x16x32_bf16 v[16:19], v[132:135], v[96:99], v[16:19]
    v_mfma_f32_16x16x32_bf16 v[20:23], v[132:135], v[100:103], v[20:23]
    ds_read_b64_tr_b16 v[156:157], v178 offset:16384
    v_mfma_f32_16x16x32_bf16 v[24:27], v[132:135], v[104:107], v[24:27]
    ds_read_b64_tr_b16 v[158:159], v178 offset:19456
    v_mfma_f32_16x16x32_bf16 v[28:31], v[132:135], v[108:111], v[28:31]
    ds_read_b64_tr_b16 v[168:169], v178 offset:22528
    v_mfma_f32_16x16x32_bf16 v[76:79], v[144:147], v[108:111], v[76:79]
    ds_read_b64_tr_b16 v[170:171], v178 offset:25600
    v_mfma_f32_16x16x32_bf16 v[72:75], v[144:147], v[104:107], v[72:75]
    ds_read_b64_tr_b16 v[160:161], v179 offset:16384
    v_mfma_f32_16x16x32_bf16 v[68:71], v[144:147], v[100:103], v[68:71]
    ds_read_b64_tr_b16 v[162:163], v179 offset:19456
    v_mfma_f32_16x16x32_bf16 v[64:67], v[144:147], v[96:99], v[64:67]
    ds_read_b64_tr_b16 v[172:173], v179 offset:22528
    v_mfma_f32_16x16x32_bf16 v[32:35], v[136:139], v[96:99], v[32:35]
    ds_read_b64_tr_b16 v[174:175], v179 offset:25600
    v_mfma_f32_16x16x32_bf16 v[36:39], v[136:139], v[100:103], v[36:39]
    v_mfma_f32_16x16x32_bf16 v[40:43], v[136:139], v[104:107], v[40:43]
    v_mfma_f32_16x16x32_bf16 v[44:47], v[136:139], v[108:111], v[44:47]
    v_mfma_f32_16x16x32_bf16 v[92:95], v[148:151], v[108:111], v[92:95]
    v_mfma_f32_16x16x32_bf16 v[88:91], v[148:151], v[104:107], v[88:91]
    v_mfma_f32_16x16x32_bf16 v[84:87], v[148:151], v[100:103], v[84:87]
    v_mfma_f32_16x16x32_bf16 v[80:83], v[148:151], v[96:99], v[80:83]
    .p2align 3
loop_103:
    s_waitcnt vmcnt(9) lgkmcnt(0)
    s_barrier
    .p2align 3
    v_mfma_f32_16x16x32_bf16 v[0:3], v[152:155], v[112:115], v[0:3]
    ds_read_b64_tr_b16 v[128:129], v177 offset:32768
    v_mfma_f32_16x16x32_bf16 v[4:7], v[152:155], v[116:119], v[4:7]
    ds_read_b64_tr_b16 v[130:131], v177 offset:35840
    v_mfma_f32_16x16x32_bf16 v[8:11], v[152:155], v[120:123], v[8:11]
    ds_read_b128 v[96:99], v176 offset:32768
    v_mfma_f32_16x16x32_bf16 v[12:15], v[152:155], v[124:127], v[12:15]
    ds_read_b128 v[100:103], v176 offset:34816
    v_mfma_f32_16x16x32_bf16 v[60:63], v[164:167], v[124:127], v[60:63]
    ds_read_b128 v[104:107], v176 offset:36864
    v_mfma_f32_16x16x32_bf16 v[56:59], v[164:167], v[120:123], v[56:59]
    ds_read_b128 v[108:111], v176 offset:38912
    v_mfma_f32_16x16x32_bf16 v[52:55], v[164:167], v[116:119], v[52:55]
    ds_read_b64_tr_b16 v[140:141], v177 offset:38912
    v_mfma_f32_16x16x32_bf16 v[48:51], v[164:167], v[112:115], v[48:51]
    ds_read_b64_tr_b16 v[142:143], v177 offset:41984
    v_mfma_f32_16x16x32_bf16 v[16:19], v[156:159], v[112:115], v[16:19]
    v_mfma_f32_16x16x32_bf16 v[20:23], v[156:159], v[116:119], v[20:23]
    ds_read_b64_tr_b16 v[132:133], v178 offset:32768
    v_mfma_f32_16x16x32_bf16 v[24:27], v[156:159], v[120:123], v[24:27]
    ds_read_b64_tr_b16 v[134:135], v178 offset:35840
    v_mfma_f32_16x16x32_bf16 v[28:31], v[156:159], v[124:127], v[28:31]
    ds_read_b64_tr_b16 v[144:145], v178 offset:38912
    v_mfma_f32_16x16x32_bf16 v[76:79], v[168:171], v[124:127], v[76:79]
    ds_read_b64_tr_b16 v[146:147], v178 offset:41984
    v_mfma_f32_16x16x32_bf16 v[72:75], v[168:171], v[120:123], v[72:75]
    ds_read_b64_tr_b16 v[136:137], v179 offset:32768
    v_mfma_f32_16x16x32_bf16 v[68:71], v[168:171], v[116:119], v[68:71]
    ds_read_b64_tr_b16 v[138:139], v179 offset:35840
    v_mfma_f32_16x16x32_bf16 v[64:67], v[168:171], v[112:115], v[64:67]
    ds_read_b64_tr_b16 v[148:149], v179 offset:38912
    v_mfma_f32_16x16x32_bf16 v[32:35], v[160:163], v[112:115], v[32:35]
    ds_read_b64_tr_b16 v[150:151], v179 offset:41984
    v_mfma_f32_16x16x32_bf16 v[36:39], v[160:163], v[116:119], v[36:39]
    v_mfma_f32_16x16x32_bf16 v[40:43], v[160:163], v[120:123], v[40:43]
    v_mfma_f32_16x16x32_bf16 v[44:47], v[160:163], v[124:127], v[44:47]
    v_mfma_f32_16x16x32_bf16 v[92:95], v[172:175], v[124:127], v[92:95]
    v_mfma_f32_16x16x32_bf16 v[88:91], v[172:175], v[120:123], v[88:91]
    v_mfma_f32_16x16x32_bf16 v[84:87], v[172:175], v[116:119], v[84:87]
    v_mfma_f32_16x16x32_bf16 v[80:83], v[172:175], v[112:115], v[80:83]
    s_waitcnt vmcnt(6) lgkmcnt(0)
    s_barrier
    .p2align 3
    v_mfma_f32_16x16x32_bf16 v[0:3], v[128:131], v[96:99], v[0:3]
    ds_read_b64_tr_b16 v[152:153], v180 offset:0
    v_mfma_f32_16x16x32_bf16 v[4:7], v[128:131], v[100:103], v[4:7]
    ds_read_b64_tr_b16 v[154:155], v180 offset:3072
    v_mfma_f32_16x16x32_bf16 v[8:11], v[128:131], v[104:107], v[8:11]
    ds_read_b128 v[112:115], v176 offset:33792
    v_mfma_f32_16x16x32_bf16 v[12:15], v[128:131], v[108:111], v[12:15]
    ds_read_b128 v[116:119], v176 offset:35840
    v_mfma_f32_16x16x32_bf16 v[60:63], v[140:143], v[108:111], v[60:63]
    ds_read_b128 v[120:123], v176 offset:37888
    v_mfma_f32_16x16x32_bf16 v[56:59], v[140:143], v[104:107], v[56:59]
    ds_read_b128 v[124:127], v176 offset:39936
    v_mfma_f32_16x16x32_bf16 v[52:55], v[140:143], v[100:103], v[52:55]
    ds_read_b64_tr_b16 v[164:165], v180 offset:6144
    v_mfma_f32_16x16x32_bf16 v[48:51], v[140:143], v[96:99], v[48:51]
    ds_read_b64_tr_b16 v[166:167], v180 offset:9216
    v_mfma_f32_16x16x32_bf16 v[16:19], v[132:135], v[96:99], v[16:19]
    v_mfma_f32_16x16x32_bf16 v[20:23], v[132:135], v[100:103], v[20:23]
    ds_read_b64_tr_b16 v[156:157], v181 offset:0
    v_mfma_f32_16x16x32_bf16 v[24:27], v[132:135], v[104:107], v[24:27]
    ds_read_b64_tr_b16 v[158:159], v181 offset:3072
    v_mfma_f32_16x16x32_bf16 v[28:31], v[132:135], v[108:111], v[28:31]
    ds_read_b64_tr_b16 v[168:169], v181 offset:6144
    v_mfma_f32_16x16x32_bf16 v[76:79], v[144:147], v[108:111], v[76:79]
    ds_read_b64_tr_b16 v[170:171], v181 offset:9216
    v_mfma_f32_16x16x32_bf16 v[72:75], v[144:147], v[104:107], v[72:75]
    ds_read_b64_tr_b16 v[160:161], v182 offset:0
    v_mfma_f32_16x16x32_bf16 v[68:71], v[144:147], v[100:103], v[68:71]
    ds_read_b64_tr_b16 v[162:163], v182 offset:3072
    v_mfma_f32_16x16x32_bf16 v[64:67], v[144:147], v[96:99], v[64:67]
    ds_read_b64_tr_b16 v[172:173], v182 offset:6144
    v_mfma_f32_16x16x32_bf16 v[32:35], v[136:139], v[96:99], v[32:35]
    ds_read_b64_tr_b16 v[174:175], v182 offset:9216
    v_mfma_f32_16x16x32_bf16 v[36:39], v[136:139], v[100:103], v[36:39]
    v_mfma_f32_16x16x32_bf16 v[40:43], v[136:139], v[104:107], v[40:43]
    v_mfma_f32_16x16x32_bf16 v[44:47], v[136:139], v[108:111], v[44:47]
    v_mfma_f32_16x16x32_bf16 v[92:95], v[148:151], v[108:111], v[92:95]
    v_mfma_f32_16x16x32_bf16 v[88:91], v[148:151], v[104:107], v[88:91]
    v_mfma_f32_16x16x32_bf16 v[84:87], v[148:151], v[100:103], v[84:87]
    v_mfma_f32_16x16x32_bf16 v[80:83], v[148:151], v[96:99], v[80:83]
    s_waitcnt vmcnt(3) lgkmcnt(0)
    s_barrier
    .p2align 3
    v_mfma_f32_16x16x32_bf16 v[0:3], v[152:155], v[112:115], v[0:3]
    ds_read_b64_tr_b16 v[128:129], v180 offset:16384
    v_mfma_f32_16x16x32_bf16 v[4:7], v[152:155], v[116:119], v[4:7]
    ds_read_b64_tr_b16 v[130:131], v180 offset:19456
    v_mfma_f32_16x16x32_bf16 v[8:11], v[152:155], v[120:123], v[8:11]
    ds_read_b128 v[96:99], v176 offset:0
    v_mfma_f32_16x16x32_bf16 v[12:15], v[152:155], v[124:127], v[12:15]
    ds_read_b128 v[100:103], v176 offset:2048
    v_mfma_f32_16x16x32_bf16 v[60:63], v[164:167], v[124:127], v[60:63]
    ds_read_b128 v[104:107], v176 offset:4096
    v_mfma_f32_16x16x32_bf16 v[56:59], v[164:167], v[120:123], v[56:59]
    ds_read_b128 v[108:111], v176 offset:6144
    v_mfma_f32_16x16x32_bf16 v[52:55], v[164:167], v[116:119], v[52:55]
    ds_read_b64_tr_b16 v[140:141], v180 offset:22528
    v_mfma_f32_16x16x32_bf16 v[48:51], v[164:167], v[112:115], v[48:51]
    ds_read_b64_tr_b16 v[142:143], v180 offset:25600
    v_mfma_f32_16x16x32_bf16 v[16:19], v[156:159], v[112:115], v[16:19]
    v_mfma_f32_16x16x32_bf16 v[20:23], v[156:159], v[116:119], v[20:23]
    ds_read_b64_tr_b16 v[132:133], v181 offset:16384
    v_mfma_f32_16x16x32_bf16 v[24:27], v[156:159], v[120:123], v[24:27]
    ds_read_b64_tr_b16 v[134:135], v181 offset:19456
    v_mfma_f32_16x16x32_bf16 v[28:31], v[156:159], v[124:127], v[28:31]
    ds_read_b64_tr_b16 v[144:145], v181 offset:22528
    v_mfma_f32_16x16x32_bf16 v[76:79], v[168:171], v[124:127], v[76:79]
    ds_read_b64_tr_b16 v[146:147], v181 offset:25600
    v_mfma_f32_16x16x32_bf16 v[72:75], v[168:171], v[120:123], v[72:75]
    ds_read_b64_tr_b16 v[136:137], v182 offset:16384
    v_mfma_f32_16x16x32_bf16 v[68:71], v[168:171], v[116:119], v[68:71]
    ds_read_b64_tr_b16 v[138:139], v182 offset:19456
    v_mfma_f32_16x16x32_bf16 v[64:67], v[168:171], v[112:115], v[64:67]
    ds_read_b64_tr_b16 v[148:149], v182 offset:22528
    v_mfma_f32_16x16x32_bf16 v[32:35], v[160:163], v[112:115], v[32:35]
    ds_read_b64_tr_b16 v[150:151], v182 offset:25600
    v_mfma_f32_16x16x32_bf16 v[36:39], v[160:163], v[116:119], v[36:39]
    v_mfma_f32_16x16x32_bf16 v[40:43], v[160:163], v[120:123], v[40:43]
    v_mfma_f32_16x16x32_bf16 v[44:47], v[160:163], v[124:127], v[44:47]
    v_mfma_f32_16x16x32_bf16 v[92:95], v[172:175], v[124:127], v[92:95]
    v_mfma_f32_16x16x32_bf16 v[88:91], v[172:175], v[120:123], v[88:91]
    v_mfma_f32_16x16x32_bf16 v[84:87], v[172:175], v[116:119], v[84:87]
    v_mfma_f32_16x16x32_bf16 v[80:83], v[172:175], v[112:115], v[80:83]
    s_waitcnt vmcnt(0) lgkmcnt(0)
    s_barrier
    .p2align 3
    v_mfma_f32_16x16x32_bf16 v[0:3], v[128:131], v[96:99], v[0:3]
    ds_read_b64_tr_b16 v[152:153], v180 offset:32768
    v_mfma_f32_16x16x32_bf16 v[4:7], v[128:131], v[100:103], v[4:7]
    ds_read_b64_tr_b16 v[154:155], v180 offset:35840
    v_mfma_f32_16x16x32_bf16 v[8:11], v[128:131], v[104:107], v[8:11]
    ds_read_b128 v[112:115], v176 offset:1024
    v_mfma_f32_16x16x32_bf16 v[12:15], v[128:131], v[108:111], v[12:15]
    ds_read_b128 v[116:119], v176 offset:3072
    v_mfma_f32_16x16x32_bf16 v[60:63], v[140:143], v[108:111], v[60:63]
    ds_read_b128 v[120:123], v176 offset:5120
    v_mfma_f32_16x16x32_bf16 v[56:59], v[140:143], v[104:107], v[56:59]
    ds_read_b128 v[124:127], v176 offset:7168
    v_mfma_f32_16x16x32_bf16 v[52:55], v[140:143], v[100:103], v[52:55]
    ds_read_b64_tr_b16 v[164:165], v180 offset:38912
    v_mfma_f32_16x16x32_bf16 v[48:51], v[140:143], v[96:99], v[48:51]
    ds_read_b64_tr_b16 v[166:167], v180 offset:41984
    v_mfma_f32_16x16x32_bf16 v[16:19], v[132:135], v[96:99], v[16:19]
    v_mfma_f32_16x16x32_bf16 v[20:23], v[132:135], v[100:103], v[20:23]
    ds_read_b64_tr_b16 v[156:157], v181 offset:32768
    v_mfma_f32_16x16x32_bf16 v[24:27], v[132:135], v[104:107], v[24:27]
    ds_read_b64_tr_b16 v[158:159], v181 offset:35840
    v_mfma_f32_16x16x32_bf16 v[28:31], v[132:135], v[108:111], v[28:31]
    ds_read_b64_tr_b16 v[168:169], v181 offset:38912
    v_mfma_f32_16x16x32_bf16 v[76:79], v[144:147], v[108:111], v[76:79]
    ds_read_b64_tr_b16 v[170:171], v181 offset:41984
    v_mfma_f32_16x16x32_bf16 v[72:75], v[144:147], v[104:107], v[72:75]
    ds_read_b64_tr_b16 v[160:161], v182 offset:32768
    v_mfma_f32_16x16x32_bf16 v[68:71], v[144:147], v[100:103], v[68:71]
    ds_read_b64_tr_b16 v[162:163], v182 offset:35840
    v_mfma_f32_16x16x32_bf16 v[64:67], v[144:147], v[96:99], v[64:67]
    ds_read_b64_tr_b16 v[172:173], v182 offset:38912
    v_mfma_f32_16x16x32_bf16 v[32:35], v[136:139], v[96:99], v[32:35]
    ds_read_b64_tr_b16 v[174:175], v182 offset:41984
    v_mfma_f32_16x16x32_bf16 v[36:39], v[136:139], v[100:103], v[36:39]
    v_mfma_f32_16x16x32_bf16 v[40:43], v[136:139], v[104:107], v[40:43]
    v_mfma_f32_16x16x32_bf16 v[44:47], v[136:139], v[108:111], v[44:47]
    v_mfma_f32_16x16x32_bf16 v[92:95], v[148:151], v[108:111], v[92:95]
    v_mfma_f32_16x16x32_bf16 v[88:91], v[148:151], v[104:107], v[88:91]
    v_mfma_f32_16x16x32_bf16 v[84:87], v[148:151], v[100:103], v[84:87]
    v_mfma_f32_16x16x32_bf16 v[80:83], v[148:151], v[96:99], v[80:83]
    s_waitcnt lgkmcnt(0)
    s_barrier
    .p2align 3
    v_mfma_f32_16x16x32_bf16 v[0:3], v[152:155], v[112:115], v[0:3]
    ds_read_b64_tr_b16 v[128:129], v177 offset:0
    v_mfma_f32_16x16x32_bf16 v[4:7], v[152:155], v[116:119], v[4:7]
    ds_read_b64_tr_b16 v[130:131], v177 offset:3072
    v_mfma_f32_16x16x32_bf16 v[8:11], v[152:155], v[120:123], v[8:11]
    ds_read_b128 v[96:99], v176 offset:16384
    v_mfma_f32_16x16x32_bf16 v[12:15], v[152:155], v[124:127], v[12:15]
    ds_read_b128 v[100:103], v176 offset:18432
    v_mfma_f32_16x16x32_bf16 v[60:63], v[164:167], v[124:127], v[60:63]
    ds_read_b128 v[104:107], v176 offset:20480
    v_mfma_f32_16x16x32_bf16 v[56:59], v[164:167], v[120:123], v[56:59]
    ds_read_b128 v[108:111], v176 offset:22528
    v_mfma_f32_16x16x32_bf16 v[52:55], v[164:167], v[116:119], v[52:55]
    ds_read_b64_tr_b16 v[140:141], v177 offset:6144
    v_mfma_f32_16x16x32_bf16 v[48:51], v[164:167], v[112:115], v[48:51]
    ds_read_b64_tr_b16 v[142:143], v177 offset:9216
    v_mfma_f32_16x16x32_bf16 v[16:19], v[156:159], v[112:115], v[16:19]
    v_mfma_f32_16x16x32_bf16 v[20:23], v[156:159], v[116:119], v[20:23]
    ds_read_b64_tr_b16 v[132:133], v178 offset:0
    v_mfma_f32_16x16x32_bf16 v[24:27], v[156:159], v[120:123], v[24:27]
    ds_read_b64_tr_b16 v[134:135], v178 offset:3072
    v_mfma_f32_16x16x32_bf16 v[28:31], v[156:159], v[124:127], v[28:31]
    ds_read_b64_tr_b16 v[144:145], v178 offset:6144
    v_mfma_f32_16x16x32_bf16 v[76:79], v[168:171], v[124:127], v[76:79]
    ds_read_b64_tr_b16 v[146:147], v178 offset:9216
    v_mfma_f32_16x16x32_bf16 v[72:75], v[168:171], v[120:123], v[72:75]
    ds_read_b64_tr_b16 v[136:137], v179 offset:0
    v_mfma_f32_16x16x32_bf16 v[68:71], v[168:171], v[116:119], v[68:71]
    ds_read_b64_tr_b16 v[138:139], v179 offset:3072
    v_mfma_f32_16x16x32_bf16 v[64:67], v[168:171], v[112:115], v[64:67]
    ds_read_b64_tr_b16 v[148:149], v179 offset:6144
    v_mfma_f32_16x16x32_bf16 v[32:35], v[160:163], v[112:115], v[32:35]
    ds_read_b64_tr_b16 v[150:151], v179 offset:9216
    v_mfma_f32_16x16x32_bf16 v[36:39], v[160:163], v[116:119], v[36:39]
    v_mfma_f32_16x16x32_bf16 v[40:43], v[160:163], v[120:123], v[40:43]
    v_mfma_f32_16x16x32_bf16 v[44:47], v[160:163], v[124:127], v[44:47]
    v_mfma_f32_16x16x32_bf16 v[92:95], v[172:175], v[124:127], v[92:95]
    v_mfma_f32_16x16x32_bf16 v[88:91], v[172:175], v[120:123], v[88:91]
    v_mfma_f32_16x16x32_bf16 v[84:87], v[172:175], v[116:119], v[84:87]
    v_mfma_f32_16x16x32_bf16 v[80:83], v[172:175], v[112:115], v[80:83]
    s_waitcnt lgkmcnt(0)
    s_barrier
    .p2align 3
    v_mfma_f32_16x16x32_bf16 v[0:3], v[128:131], v[96:99], v[0:3]
    ds_read_b64_tr_b16 v[152:153], v177 offset:16384
    v_mfma_f32_16x16x32_bf16 v[4:7], v[128:131], v[100:103], v[4:7]
    ds_read_b64_tr_b16 v[154:155], v177 offset:19456
    v_mfma_f32_16x16x32_bf16 v[8:11], v[128:131], v[104:107], v[8:11]
    ds_read_b128 v[112:115], v176 offset:17408
    v_mfma_f32_16x16x32_bf16 v[12:15], v[128:131], v[108:111], v[12:15]
    ds_read_b128 v[116:119], v176 offset:19456
    v_mfma_f32_16x16x32_bf16 v[60:63], v[140:143], v[108:111], v[60:63]
    ds_read_b128 v[120:123], v176 offset:21504
    v_mfma_f32_16x16x32_bf16 v[56:59], v[140:143], v[104:107], v[56:59]
    ds_read_b128 v[124:127], v176 offset:23552
    v_mfma_f32_16x16x32_bf16 v[52:55], v[140:143], v[100:103], v[52:55]
    ds_read_b64_tr_b16 v[164:165], v177 offset:22528
    v_mfma_f32_16x16x32_bf16 v[48:51], v[140:143], v[96:99], v[48:51]
    ds_read_b64_tr_b16 v[166:167], v177 offset:25600
    v_mfma_f32_16x16x32_bf16 v[16:19], v[132:135], v[96:99], v[16:19]
    v_mfma_f32_16x16x32_bf16 v[20:23], v[132:135], v[100:103], v[20:23]
    ds_read_b64_tr_b16 v[156:157], v178 offset:16384
    v_mfma_f32_16x16x32_bf16 v[24:27], v[132:135], v[104:107], v[24:27]
    ds_read_b64_tr_b16 v[158:159], v178 offset:19456
    v_mfma_f32_16x16x32_bf16 v[28:31], v[132:135], v[108:111], v[28:31]
    ds_read_b64_tr_b16 v[168:169], v178 offset:22528
    v_mfma_f32_16x16x32_bf16 v[76:79], v[144:147], v[108:111], v[76:79]
    ds_read_b64_tr_b16 v[170:171], v178 offset:25600
    v_mfma_f32_16x16x32_bf16 v[72:75], v[144:147], v[104:107], v[72:75]
    ds_read_b64_tr_b16 v[160:161], v179 offset:16384
    v_mfma_f32_16x16x32_bf16 v[68:71], v[144:147], v[100:103], v[68:71]
    ds_read_b64_tr_b16 v[162:163], v179 offset:19456
    v_mfma_f32_16x16x32_bf16 v[64:67], v[144:147], v[96:99], v[64:67]
    ds_read_b64_tr_b16 v[172:173], v179 offset:22528
    v_mfma_f32_16x16x32_bf16 v[32:35], v[136:139], v[96:99], v[32:35]
    ds_read_b64_tr_b16 v[174:175], v179 offset:25600
    v_mfma_f32_16x16x32_bf16 v[36:39], v[136:139], v[100:103], v[36:39]
    v_mfma_f32_16x16x32_bf16 v[40:43], v[136:139], v[104:107], v[40:43]
    v_mfma_f32_16x16x32_bf16 v[44:47], v[136:139], v[108:111], v[44:47]
    v_mfma_f32_16x16x32_bf16 v[92:95], v[148:151], v[108:111], v[92:95]
    s_sub_u32 s58, s58, 1
    s_cmp_lg_u32 s58, 0
    .p2align 3
    v_mfma_f32_16x16x32_bf16 v[88:91], v[148:151], v[104:107], v[88:91]
    v_mfma_f32_16x16x32_bf16 v[84:87], v[148:151], v[100:103], v[84:87]
    v_mfma_f32_16x16x32_bf16 v[80:83], v[148:151], v[96:99], v[80:83]
    s_cbranch_scc1 loop_103
    s_waitcnt lgkmcnt(0)
    s_barrier
    .p2align 3
    v_mfma_f32_16x16x32_bf16 v[0:3], v[152:155], v[112:115], v[0:3]
    v_mfma_f32_16x16x32_bf16 v[4:7], v[152:155], v[116:119], v[4:7]
    v_mfma_f32_16x16x32_bf16 v[8:11], v[152:155], v[120:123], v[8:11]
    v_mfma_f32_16x16x32_bf16 v[12:15], v[152:155], v[124:127], v[12:15]
    v_mfma_f32_16x16x32_bf16 v[60:63], v[164:167], v[124:127], v[60:63]
    v_mfma_f32_16x16x32_bf16 v[56:59], v[164:167], v[120:123], v[56:59]
    v_mfma_f32_16x16x32_bf16 v[52:55], v[164:167], v[116:119], v[52:55]
    v_mfma_f32_16x16x32_bf16 v[48:51], v[164:167], v[112:115], v[48:51]
    v_mfma_f32_16x16x32_bf16 v[16:19], v[156:159], v[112:115], v[16:19]
    v_mfma_f32_16x16x32_bf16 v[20:23], v[156:159], v[116:119], v[20:23]
    v_mfma_f32_16x16x32_bf16 v[24:27], v[156:159], v[120:123], v[24:27]
    v_mfma_f32_16x16x32_bf16 v[28:31], v[156:159], v[124:127], v[28:31]
    v_mfma_f32_16x16x32_bf16 v[76:79], v[168:171], v[124:127], v[76:79]
    v_mfma_f32_16x16x32_bf16 v[72:75], v[168:171], v[120:123], v[72:75]
    v_mfma_f32_16x16x32_bf16 v[68:71], v[168:171], v[116:119], v[68:71]
    v_mfma_f32_16x16x32_bf16 v[64:67], v[168:171], v[112:115], v[64:67]
    v_mfma_f32_16x16x32_bf16 v[32:35], v[160:163], v[112:115], v[32:35]
    v_mfma_f32_16x16x32_bf16 v[36:39], v[160:163], v[116:119], v[36:39]
    v_mfma_f32_16x16x32_bf16 v[40:43], v[160:163], v[120:123], v[40:43]
    v_mfma_f32_16x16x32_bf16 v[44:47], v[160:163], v[124:127], v[44:47]
    v_mfma_f32_16x16x32_bf16 v[92:95], v[172:175], v[124:127], v[92:95]
    v_mfma_f32_16x16x32_bf16 v[88:91], v[172:175], v[120:123], v[88:91]
    v_mfma_f32_16x16x32_bf16 v[84:87], v[172:175], v[116:119], v[84:87]
    v_mfma_f32_16x16x32_bf16 v[80:83], v[172:175], v[112:115], v[80:83]
    s_setprio 1
    s_barrier
    s_add_u32 m0, s62, 131072
    s_mov_b32 s92, 49152
    buffer_load_dwordx4 v217, s[4:7], s92 offen lds
    s_nop 7
    v_mul_f32 v96, v184, v0
    v_mul_f32 v97, v184, v1
    buffer_load_dwordx4 v217, s[4:7], s92 offen offset:1024 lds
    v_mul_f32 v98, v184, v2
    v_mul_f32 v99, v184, v3
    v_exp_f32 v96, v96
    v_exp_f32 v97, v97
    buffer_load_dwordx4 v217, s[4:7], s92 offen offset:2048 lds
    v_exp_f32 v98, v98
    v_exp_f32 v99, v99
    v_mul_f32 v0, v0, v48
    v_mul_f32 v1, v1, v49
    buffer_load_dwordx4 v217, s[4:7], s92 offen offset:3072 lds
    v_mul_f32 v2, v2, v50
    v_mul_f32 v3, v3, v51
    v_fma_f32 v96, v96, v188, v188
    v_fma_f32 v97, v97, v188, v188
    s_add_u32 m0, s62, 16384
    s_add_u32 s59, s68, 2490368
    buffer_load_dwordx4 v213, s[20:23], s59 offen lds
    v_fma_f32 v98, v98, v188, v188
    v_fma_f32 v99, v99, v188, v188
    v_rcp_f32 v96, v96
    v_rcp_f32 v97, v97
    buffer_load_dwordx4 v214, s[20:23], s59 offen offset:1024 lds
    v_rcp_f32 v98, v98
    v_rcp_f32 v99, v99
    v_mul_f32 v0, v0, v96
    v_mul_f32 v1, v1, v97
    buffer_load_dwordx4 v215, s[20:23], s59 offen offset:2048 lds
    v_mul_f32 v2, v2, v98
    v_mul_f32 v3, v3, v99
    v_cvt_pk_bf16_f32 v100, v0, v1
    v_cvt_pk_bf16_f32 v101, v2, v3
    buffer_load_dwordx4 v216, s[20:23], s59 offen offset:3072 lds
    v_mul_f32 v96, v184, v16
    v_mul_f32 v97, v184, v17
    v_mul_f32 v98, v184, v18
    v_mul_f32 v99, v184, v19
    s_barrier
    s_add_u32 m0, s62, 98304
    s_mov_b32 s92, 65536
    buffer_load_dwordx4 v217, s[4:7], s92 offen lds
    v_exp_f32 v96, v96
    v_exp_f32 v97, v97
    v_exp_f32 v98, v98
    buffer_load_dwordx4 v217, s[4:7], s92 offen offset:1024 lds
    v_exp_f32 v99, v99
    v_mul_f32 v16, v16, v64
    v_mul_f32 v17, v17, v65
    v_mul_f32 v18, v18, v66
    buffer_load_dwordx4 v217, s[4:7], s92 offen offset:2048 lds
    v_mul_f32 v19, v19, v67
    v_fma_f32 v96, v96, v188, v188
    v_fma_f32 v97, v97, v188, v188
    buffer_load_dwordx4 v217, s[4:7], s92 offen offset:3072 lds
    v_fma_f32 v98, v98, v188, v188
    v_fma_f32 v99, v99, v188, v188
    v_rcp_f32 v96, v96
    v_rcp_f32 v97, v97
    s_add_u32 m0, s62, 32768
    s_add_u32 s59, s68, 2752512
    buffer_load_dwordx4 v213, s[20:23], s59 offen lds
    v_rcp_f32 v98, v98
    v_rcp_f32 v99, v99
    v_mul_f32 v16, v16, v96
    buffer_load_dwordx4 v214, s[20:23], s59 offen offset:1024 lds
    v_mul_f32 v17, v17, v97
    v_mul_f32 v18, v18, v98
    v_mul_f32 v19, v19, v99
    v_cvt_pk_bf16_f32 v102, v16, v17
    buffer_load_dwordx4 v215, s[20:23], s59 offen offset:2048 lds
    v_cvt_pk_bf16_f32 v103, v18, v19
    s_add_u32 s55, s89, 262144
    buffer_store_dwordx4 v[100:103], v254, s[4:7], s55 offen sc0 sc1
    v_mul_f32 v96, v185, v4
    buffer_load_dwordx4 v216, s[20:23], s59 offen offset:3072 lds
    v_mul_f32 v97, v185, v5
    v_mul_f32 v98, v185, v6
    v_mul_f32 v99, v185, v7
    v_exp_f32 v96, v96
    s_waitcnt vmcnt(13)
    s_barrier
    s_add_u32 m0, s62, 114688
    s_mov_b32 s92, 81920
    buffer_load_dwordx4 v217, s[4:7], s92 offen lds
    v_exp_f32 v97, v97
    v_exp_f32 v98, v98
    v_exp_f32 v99, v99
    buffer_load_dwordx4 v217, s[4:7], s92 offen offset:1024 lds
    v_mul_f32 v4, v4, v52
    v_mul_f32 v5, v5, v53
    v_mul_f32 v6, v6, v54
    v_mul_f32 v7, v7, v55
    buffer_load_dwordx4 v217, s[4:7], s92 offen offset:2048 lds
    v_fma_f32 v96, v96, v189, v189
    v_fma_f32 v97, v97, v189, v189
    v_fma_f32 v98, v98, v189, v189
    buffer_load_dwordx4 v217, s[4:7], s92 offen offset:3072 lds
    v_fma_f32 v99, v99, v189, v189
    v_rcp_f32 v96, v96
    v_rcp_f32 v97, v97
    v_rcp_f32 v98, v98
    s_add_u32 m0, s62, 49152
    s_add_u32 s59, s68, 3407872
    buffer_load_dwordx4 v213, s[20:23], s59 offen lds
    v_rcp_f32 v99, v99
    v_mul_f32 v4, v4, v96
    v_mul_f32 v5, v5, v97
    v_mul_f32 v6, v6, v98
    buffer_load_dwordx4 v214, s[20:23], s59 offen offset:1024 lds
    v_mul_f32 v7, v7, v99
    v_cvt_pk_bf16_f32 v104, v4, v5
    v_cvt_pk_bf16_f32 v105, v6, v7
    buffer_load_dwordx4 v215, s[20:23], s59 offen offset:2048 lds
    v_mul_f32 v96, v185, v20
    v_mul_f32 v97, v185, v21
    v_mul_f32 v98, v185, v22
    v_mul_f32 v99, v185, v23
    buffer_load_dwordx4 v216, s[20:23], s59 offen offset:3072 lds
    v_exp_f32 v96, v96
    v_exp_f32 v97, v97
    v_exp_f32 v98, v98
    v_exp_f32 v99, v99
    s_waitcnt vmcnt(13)
    s_barrier
    s_add_u32 m0, s62, 131072
    s_mov_b32 s92, 98304
    buffer_load_dwordx4 v217, s[4:7], s92 offen lds
    v_mul_f32 v20, v20, v68
    v_mul_f32 v21, v21, v69
    v_mul_f32 v22, v22, v70
    buffer_load_dwordx4 v217, s[4:7], s92 offen offset:1024 lds
    v_mul_f32 v23, v23, v71
    v_fma_f32 v96, v96, v189, v189
    v_fma_f32 v97, v97, v189, v189
    v_fma_f32 v98, v98, v189, v189
    buffer_load_dwordx4 v217, s[4:7], s92 offen offset:2048 lds
    v_fma_f32 v99, v99, v189, v189
    v_rcp_f32 v96, v96
    v_rcp_f32 v97, v97
    buffer_load_dwordx4 v217, s[4:7], s92 offen offset:3072 lds
    v_rcp_f32 v98, v98
    v_rcp_f32 v99, v99
    v_mul_f32 v20, v20, v96
    v_mul_f32 v21, v21, v97
    s_add_u32 m0, s62, 65536
    s_add_u32 s59, s68, 65536
    buffer_load_dwordx4 v213, s[20:23], s59 offen lds
    v_mul_f32 v22, v22, v98
    v_mul_f32 v23, v23, v99
    v_cvt_pk_bf16_f32 v106, v20, v21
    v_cvt_pk_bf16_f32 v107, v22, v23
    buffer_load_dwordx4 v214, s[20:23], s59 offen offset:1024 lds
    s_add_u32 s55, s89, 264192
    buffer_store_dwordx4 v[104:107], v254, s[4:7], s55 offen sc0 sc1
    v_mul_f32 v96, v186, v8
    v_mul_f32 v97, v186, v9
    buffer_load_dwordx4 v215, s[20:23], s59 offen offset:2048 lds
    v_mul_f32 v98, v186, v10
    v_mul_f32 v99, v186, v11
    v_exp_f32 v96, v96
    v_exp_f32 v97, v97
    buffer_load_dwordx4 v216, s[20:23], s59 offen offset:3072 lds
    v_exp_f32 v98, v98
    v_exp_f32 v99, v99
    v_mul_f32 v8, v8, v56
    v_mul_f32 v9, v9, v57
    s_waitcnt vmcnt(13)
    s_barrier
    v_lshrrev_b32 v252, 2, v254
    v_min_u32 v252, 28, v252
    s_add_u32 s55, s0, 2080
    buffer_load_dword v251, v252, s[4:7], s55 offen sc0 sc1
    s_add_u32 m0, s62, 98304
    s_mov_b32 s92, 114688
    buffer_load_dwordx4 v217, s[4:7], s92 offen lds
    v_mul_f32 v10, v10, v58
    v_mul_f32 v11, v11, v59
    v_fma_f32 v96, v96, v190, v190
    v_fma_f32 v97, v97, v190, v190
    buffer_load_dwordx4 v217, s[4:7], s92 offen offset:1024 lds
    v_fma_f32 v98, v98, v190, v190
    v_fma_f32 v99, v99, v190, v190
    v_rcp_f32 v96, v96
    v_rcp_f32 v97, v97
    buffer_load_dwordx4 v217, s[4:7], s92 offen offset:2048 lds
    v_rcp_f32 v98, v98
    v_rcp_f32 v99, v99
    v_mul_f32 v8, v8, v96
    v_mul_f32 v9, v9, v97
    buffer_load_dwordx4 v217, s[4:7], s92 offen offset:3072 lds
    v_mul_f32 v10, v10, v98
    v_mul_f32 v11, v11, v99
    v_cvt_pk_bf16_f32 v100, v8, v9
    v_cvt_pk_bf16_f32 v101, v10, v11
    s_add_u32 m0, s62, 81920
    s_add_u32 s59, s68, 720896
    buffer_load_dwordx4 v213, s[20:23], s59 offen lds
    v_mul_f32 v96, v186, v24
    v_mul_f32 v97, v186, v25
    v_mul_f32 v98, v186, v26
    v_mul_f32 v99, v186, v27
    buffer_load_dwordx4 v214, s[20:23], s59 offen offset:1024 lds
    v_exp_f32 v96, v96
    v_exp_f32 v97, v97
    v_exp_f32 v98, v98
    v_exp_f32 v99, v99
    buffer_load_dwordx4 v215, s[20:23], s59 offen offset:2048 lds
    v_mul_f32 v24, v24, v72
    v_mul_f32 v25, v25, v73
    v_mul_f32 v26, v26, v74
    v_mul_f32 v27, v27, v75
    buffer_load_dwordx4 v216, s[20:23], s59 offen offset:3072 lds
    v_fma_f32 v96, v96, v190, v190
    v_fma_f32 v97, v97, v190, v190
    v_fma_f32 v98, v98, v190, v190
    v_fma_f32 v99, v99, v190, v190
    s_waitcnt vmcnt(14)
    s_barrier
    s_waitcnt vmcnt(8)
    v_cmp_ne_u32 vcc, 0x01010101, v251
    s_cbranch_vccz ap_104
    v_lshrrev_b32 v252, 2, v254
    v_min_u32 v252, 28, v252
    s_add_u32 s55, s0, 2080
    s_mov_b32 s56, 262144
poll_105:
    buffer_load_dword v253, v252, s[4:7], s55 offen sc0 sc1
    s_waitcnt vmcnt(0)
    v_cmp_ne_u32 vcc, 0x01010101, v253
    s_cbranch_vccz pd_106
    s_sleep 1
    s_sub_u32 s56, s56, 1
    s_cmp_lg_u32 s56, 0
    s_cbranch_scc1 poll_105
pd_106:
ap_104:
    s_add_u32 m0, s62, 114688
    s_mov_b32 s92, 131072
    buffer_load_dwordx4 v217, s[4:7], s92 offen lds
    v_rcp_f32 v96, v96
    v_rcp_f32 v97, v97
    v_rcp_f32 v98, v98
    buffer_load_dwordx4 v217, s[4:7], s92 offen offset:1024 lds
    v_rcp_f32 v99, v99
    v_mul_f32 v24, v24, v96
    v_mul_f32 v25, v25, v97
    v_mul_f32 v26, v26, v98
    buffer_load_dwordx4 v217, s[4:7], s92 offen offset:2048 lds
    v_mul_f32 v27, v27, v99
    v_cvt_pk_bf16_f32 v102, v24, v25
    v_cvt_pk_bf16_f32 v103, v26, v27
    buffer_load_dwordx4 v217, s[4:7], s92 offen offset:3072 lds
    s_add_u32 s55, s89, 266240
    buffer_store_dwordx4 v[100:103], v254, s[4:7], s55 offen sc0 sc1
    v_mul_f32 v96, v187, v12
    v_mul_f32 v97, v187, v13
    v_mul_f32 v98, v187, v14
    s_add_u32 m0, s62, 0
    s_add_u32 s59, s68, 983040
    buffer_load_dwordx4 v213, s[20:23], s59 offen lds
    v_mul_f32 v99, v187, v15
    v_exp_f32 v96, v96
    v_exp_f32 v97, v97
    buffer_load_dwordx4 v214, s[20:23], s59 offen offset:1024 lds
    v_exp_f32 v98, v98
    v_exp_f32 v99, v99
    v_mul_f32 v12, v12, v60
    v_mul_f32 v13, v13, v61
    buffer_load_dwordx4 v215, s[20:23], s59 offen offset:2048 lds
    v_mul_f32 v14, v14, v62
    v_mul_f32 v15, v15, v63
    v_fma_f32 v96, v96, v191, v191
    buffer_load_dwordx4 v216, s[20:23], s59 offen offset:3072 lds
    v_fma_f32 v97, v97, v191, v191
    v_fma_f32 v98, v98, v191, v191
    v_fma_f32 v99, v99, v191, v191
    v_rcp_f32 v96, v96
    s_waitcnt vmcnt(13)
    s_barrier
    s_add_u32 m0, s62, 131072
    s_mov_b32 s92, 147456
    buffer_load_dwordx4 v217, s[4:7], s92 offen lds
    v_rcp_f32 v97, v97
    v_rcp_f32 v98, v98
    v_rcp_f32 v99, v99
    buffer_load_dwordx4 v217, s[4:7], s92 offen offset:1024 lds
    v_mul_f32 v12, v12, v96
    v_mul_f32 v13, v13, v97
    v_mul_f32 v14, v14, v98
    v_mul_f32 v15, v15, v99
    buffer_load_dwordx4 v217, s[4:7], s92 offen offset:2048 lds
    v_cvt_pk_bf16_f32 v104, v12, v13
    v_cvt_pk_bf16_f32 v105, v14, v15
    v_mul_f32 v96, v187, v28
    buffer_load_dwordx4 v217, s[4:7], s92 offen offset:3072 lds
    v_mul_f32 v97, v187, v29
    v_mul_f32 v98, v187, v30
    v_mul_f32 v99, v187, v31
    v_exp_f32 v96, v96
    s_add_u32 m0, s62, 16384
    s_add_u32 s59, s68, 1638400
    buffer_load_dwordx4 v213, s[20:23], s59 offen lds
    v_exp_f32 v97, v97
    v_exp_f32 v98, v98
    v_exp_f32 v99, v99
    v_mul_f32 v28, v28, v76
    buffer_load_dwordx4 v214, s[20:23], s59 offen offset:1024 lds
    v_mul_f32 v29, v29, v77
    v_mul_f32 v30, v30, v78
    v_mul_f32 v31, v31, v79
    buffer_load_dwordx4 v215, s[20:23], s59 offen offset:2048 lds
    v_fma_f32 v96, v96, v191, v191
    v_fma_f32 v97, v97, v191, v191
    v_fma_f32 v98, v98, v191, v191
    v_fma_f32 v99, v99, v191, v191
    buffer_load_dwordx4 v216, s[20:23], s59 offen offset:3072 lds
    v_rcp_f32 v96, v96
    v_rcp_f32 v97, v97
    v_rcp_f32 v98, v98
    v_rcp_f32 v99, v99
    s_waitcnt vmcnt(13)
    s_barrier
    s_add_u32 m0, s62, 98304
    s_mov_b32 s92, 163840
    buffer_load_dwordx4 v217, s[4:7], s92 offen lds
    v_mul_f32 v28, v28, v96
    v_mul_f32 v29, v29, v97
    v_mul_f32 v30, v30, v98
    buffer_load_dwordx4 v217, s[4:7], s92 offen offset:1024 lds
    v_mul_f32 v31, v31, v99
    v_cvt_pk_bf16_f32 v106, v28, v29
    v_cvt_pk_bf16_f32 v107, v30, v31
    s_add_u32 s55, s89, 268288
    buffer_store_dwordx4 v[104:107], v254, s[4:7], s55 offen sc0 sc1
    buffer_load_dwordx4 v217, s[4:7], s92 offen offset:2048 lds
    v_and_b32 v120, 0x100, v254
    v_and_b32 v121, 0x200, v254
    v_lshrrev_b32 v121, 1, v121
    buffer_load_dwordx4 v217, s[4:7], s92 offen offset:3072 lds
    v_lshl_add_u32 v120, v120, 3, v121
    v_and_b32 v121, 0xf0, v254
    v_add_u32 v120, v120, v121
    v_mul_f32 v96, v184, v32
    s_add_u32 m0, s62, 32768
    s_add_u32 s59, s68, 1900544
    buffer_load_dwordx4 v213, s[20:23], s59 offen lds
    v_mul_f32 v97, v184, v33
    v_mul_f32 v98, v184, v34
    v_mul_f32 v99, v184, v35
    v_exp_f32 v96, v96
    buffer_load_dwordx4 v214, s[20:23], s59 offen offset:1024 lds
    v_exp_f32 v97, v97
    v_exp_f32 v98, v98
    v_exp_f32 v99, v99
    buffer_load_dwordx4 v215, s[20:23], s59 offen offset:2048 lds
    v_mul_f32 v32, v32, v80
    v_mul_f32 v33, v33, v81
    v_mul_f32 v34, v34, v82
    v_mul_f32 v35, v35, v83
    buffer_load_dwordx4 v216, s[20:23], s59 offen offset:3072 lds
    v_fma_f32 v96, v96, v188, v188
    v_fma_f32 v97, v97, v188, v188
    v_fma_f32 v98, v98, v188, v188
    v_fma_f32 v99, v99, v188, v188
    s_waitcnt vmcnt(13)
    s_barrier
    s_add_u32 m0, s62, 114688
    s_mov_b32 s92, 180224
    buffer_load_dwordx4 v217, s[4:7], s92 offen lds
    v_rcp_f32 v96, v96
    v_rcp_f32 v97, v97
    v_rcp_f32 v98, v98
    buffer_load_dwordx4 v217, s[4:7], s92 offen offset:1024 lds
    v_rcp_f32 v99, v99
    v_mul_f32 v32, v32, v96
    v_mul_f32 v33, v33, v97
    v_mul_f32 v34, v34, v98
    buffer_load_dwordx4 v217, s[4:7], s92 offen offset:2048 lds
    v_mul_f32 v35, v35, v99
    v_cvt_pk_bf16_f32 v100, v32, v33
    v_cvt_pk_bf16_f32 v101, v34, v35
    buffer_load_dwordx4 v217, s[4:7], s92 offen offset:3072 lds
    v_mul_f32 v96, v185, v36
    v_mul_f32 v97, v185, v37
    v_mul_f32 v98, v185, v38
    v_mul_f32 v99, v185, v39
    s_add_u32 m0, s62, 49152
    s_add_u32 s59, s68, 2555904
    buffer_load_dwordx4 v213, s[20:23], s59 offen lds
    v_exp_f32 v96, v96
    v_exp_f32 v97, v97
    v_exp_f32 v98, v98
    v_exp_f32 v99, v99
    buffer_load_dwordx4 v214, s[20:23], s59 offen offset:1024 lds
    v_mul_f32 v36, v36, v84
    v_mul_f32 v37, v37, v85
    v_mul_f32 v38, v38, v86
    buffer_load_dwordx4 v215, s[20:23], s59 offen offset:2048 lds
    v_mul_f32 v39, v39, v87
    v_fma_f32 v96, v96, v189, v189
    v_fma_f32 v97, v97, v189, v189
    v_fma_f32 v98, v98, v189, v189
    buffer_load_dwordx4 v216, s[20:23], s59 offen offset:3072 lds
    v_fma_f32 v99, v99, v189, v189
    v_rcp_f32 v96, v96
    v_rcp_f32 v97, v97
    v_rcp_f32 v98, v98
    s_waitcnt vmcnt(12)
    s_barrier
    s_cmp_lg_u32 s42, 0
    s_cbranch_scc1 wf_107
    s_lshr_b32 s55, s2, 5
    s_lshl_b32 s55, s55, 2
    s_add_u32 s55, s55, s0
    v_mov_b32 v252, 2112
    v_mov_b32 v253, 0x01010101
    s_mov_b64 exec, 1
    s_cmp_eq_u32 s45, 0
    s_cbranch_scc1 st_108
    buffer_store_dword v253, v252, s[4:7], s55 offen sc0 sc1
    s_branch st_109
st_108:
    buffer_store_dword v253, v252, s[4:7], s55 offen
st_109:
    s_mov_b64 exec, -1
wf_107:
    s_add_u32 m0, s62, 131072
    s_mov_b32 s92, 196608
    buffer_load_dwordx4 v217, s[4:7], s92 offen lds
    v_rcp_f32 v99, v99
    v_mul_f32 v36, v36, v96
    v_mul_f32 v37, v37, v97
    buffer_load_dwordx4 v217, s[4:7], s92 offen offset:1024 lds
    v_mul_f32 v38, v38, v98
    v_mul_f32 v39, v39, v99
    v_cvt_pk_bf16_f32 v102, v36, v37
    buffer_load_dwordx4 v217, s[4:7], s92 offen offset:2048 lds
    v_cvt_pk_bf16_f32 v103, v38, v39
    s_nop 1
    v_permlane16_swap_b32 v100, v102
    v_permlane16_swap_b32 v101, v103
    s_add_u32 s55, s90, 0
    buffer_store_dwordx4 v[100:103], v120, s[4:7], s55 offen sc0 sc1
    v_mul_f32 v96, v186, v40
    buffer_load_dwordx4 v217, s[4:7], s92 offen offset:3072 lds
    v_mul_f32 v97, v186, v41
    v_mul_f32 v98, v186, v42
    v_mul_f32 v99, v186, v43
    s_add_u32 m0, s62, 65536
    s_add_u32 s59, s68, 2818048
    buffer_load_dwordx4 v213, s[20:23], s59 offen lds
    v_exp_f32 v96, v96
    v_exp_f32 v97, v97
    v_exp_f32 v98, v98
    buffer_load_dwordx4 v214, s[20:23], s59 offen offset:1024 lds
    v_exp_f32 v99, v99
    v_mul_f32 v40, v40, v88
    v_mul_f32 v41, v41, v89
    v_mul_f32 v42, v42, v90
    buffer_load_dwordx4 v215, s[20:23], s59 offen offset:2048 lds
    v_mul_f32 v43, v43, v91
    v_fma_f32 v96, v96, v190, v190
    v_fma_f32 v97, v97, v190, v190
    buffer_load_dwordx4 v216, s[20:23], s59 offen offset:3072 lds
    v_fma_f32 v98, v98, v190, v190
    v_fma_f32 v99, v99, v190, v190
    v_rcp_f32 v96, v96
    v_rcp_f32 v97, v97
    s_waitcnt vmcnt(13)
    s_barrier
    s_add_u32 m0, s62, 98304
    s_mov_b32 s92, 212992
    buffer_load_dwordx4 v217, s[4:7], s92 offen lds
    v_rcp_f32 v98, v98
    v_rcp_f32 v99, v99
    v_mul_f32 v40, v40, v96
    buffer_load_dwordx4 v217, s[4:7], s92 offen offset:1024 lds
    v_mul_f32 v41, v41, v97
    v_mul_f32 v42, v42, v98
    v_mul_f32 v43, v43, v99
    v_cvt_pk_bf16_f32 v104, v40, v41
    buffer_load_dwordx4 v217, s[4:7], s92 offen offset:2048 lds
    v_cvt_pk_bf16_f32 v105, v42, v43
    v_mul_f32 v96, v187, v44
    v_mul_f32 v97, v187, v45
    v_mul_f32 v98, v187, v46
    buffer_load_dwordx4 v217, s[4:7], s92 offen offset:3072 lds
    v_mul_f32 v99, v187, v47
    v_exp_f32 v96, v96
    v_exp_f32 v97, v97
    v_exp_f32 v98, v98
    s_add_u32 m0, s62, 81920
    s_add_u32 s59, s68, 3473408
    buffer_load_dwordx4 v213, s[20:23], s59 offen lds
    v_exp_f32 v99, v99
    v_mul_f32 v44, v44, v92
    v_mul_f32 v45, v45, v93
    buffer_load_dwordx4 v214, s[20:23], s59 offen offset:1024 lds
    v_mul_f32 v46, v46, v94
    v_mul_f32 v47, v47, v95
    v_fma_f32 v96, v96, v191, v191
    v_fma_f32 v97, v97, v191, v191
    buffer_load_dwordx4 v215, s[20:23], s59 offen offset:2048 lds
    v_fma_f32 v98, v98, v191, v191
    v_fma_f32 v99, v99, v191, v191
    v_rcp_f32 v96, v96
    v_rcp_f32 v97, v97
    buffer_load_dwordx4 v216, s[20:23], s59 offen offset:3072 lds
    v_rcp_f32 v98, v98
    v_rcp_f32 v99, v99
    v_mul_f32 v44, v44, v96
    v_mul_f32 v45, v45, v97
    s_waitcnt vmcnt(12)
    s_barrier
    s_add_u32 m0, s62, 114688
    s_mov_b32 s92, 229376
    buffer_load_dwordx4 v217, s[4:7], s92 offen lds
    v_mul_f32 v46, v46, v98
    v_mul_f32 v47, v47, v99
    buffer_load_dwordx4 v217, s[4:7], s92 offen offset:1024 lds
    v_cvt_pk_bf16_f32 v106, v44, v45
    v_cvt_pk_bf16_f32 v107, v46, v47
    buffer_load_dwordx4 v217, s[4:7], s92 offen offset:2048 lds
    s_nop 1
    v_permlane16_swap_b32 v104, v106
    v_permlane16_swap_b32 v105, v107
    s_add_u32 s55, s90, 4096
    buffer_store_dwordx4 v[104:107], v120, s[4:7], s55 offen sc0 sc1
    buffer_load_dwordx4 v217, s[4:7], s92 offen offset:3072 lds
    s_cmp_eq_u32 s46, 0
    s_cselect_b32 s63, s63, 2130706432
    v_lshrrev_b32 v224, 7, v254
    s_add_u32 m0, s62, 0
    s_add_u32 s59, s69, 262144
    buffer_load_dwordx4 v213, s[20:23], s59 offen lds
    v_and_b32 v225, 0x70, v254
    v_and_b32 v226, 6, v224
    buffer_load_dwordx4 v214, s[20:23], s59 offen offset:1024 lds
    v_lshlrev_b32 v226, 4, v226
    v_xor_b32 v225, v225, v226
    buffer_load_dwordx4 v215, s[20:23], s59 offen offset:2048 lds
    v_mul_u32_u24 v224, 6144, v224
    v_add3_u32 v224, v224, v225, s63
    buffer_load_dwordx4 v216, s[20:23], s59 offen offset:3072 lds
    s_lshr_b32 s55, s61, 10
    s_add_u32 s55, s55, 0
    s_and_b32 s56, s55, 3
    s_lshl_b32 s56, s56, 3
    s_mul_i32 s56, s56, 6144
    s_lshr_b32 s55, s55, 2
    s_lshl_b32 s55, s55, 11
    s_add_u32 s55, s55, s56
    s_sub_u32 s55, s55, 0
    v_add_u32 v200, s55, v224
    s_lshr_b32 s55, s61, 10
    s_add_u32 s55, s55, 1
    s_and_b32 s56, s55, 3
    s_lshl_b32 s56, s56, 3
    s_mul_i32 s56, s56, 6144
    s_lshr_b32 s55, s55, 2
    s_lshl_b32 s55, s55, 11
    s_add_u32 s55, s55, s56
    s_sub_u32 s55, s55, 1024
    v_add_u32 v201, s55, v224
    s_lshr_b32 s55, s61, 10
    s_add_u32 s55, s55, 2
    s_and_b32 s56, s55, 3
    s_lshl_b32 s56, s56, 3
    s_mul_i32 s56, s56, 6144
    s_lshr_b32 s55, s55, 2
    s_lshl_b32 s55, s55, 11
    s_add_u32 s55, s55, s56
    s_sub_u32 s55, s55, 2048
    v_add_u32 v202, s55, v224
    s_waitcnt vmcnt(13)
    s_barrier
    v_lshrrev_b32 v252, 2, v254
    v_min_u32 v252, 28, v252
    s_add_u32 s55, s0, 2112
    buffer_load_dword v251, v252, s[4:7], s55 offen sc0 sc1
    s_add_u32 m0, s62, 131072
    s_mov_b32 s92, 245760
    buffer_load_dwordx4 v217, s[4:7], s92 offen lds
    buffer_load_dwordx4 v217, s[4:7], s92 offen offset:1024 lds
    buffer_load_dwordx4 v217, s[4:7], s92 offen offset:2048 lds
    buffer_load_dwordx4 v217, s[4:7], s92 offen offset:3072 lds
    s_add_u32 m0, s62, 16384
    s_add_u32 s59, s69, 524288
    buffer_load_dwordx4 v213, s[20:23], s59 offen lds
    buffer_load_dwordx4 v214, s[20:23], s59 offen offset:1024 lds
    buffer_load_dwordx4 v215, s[20:23], s59 offen offset:2048 lds
    buffer_load_dwordx4 v216, s[20:23], s59 offen offset:3072 lds
    s_waitcnt vmcnt(13)
    s_barrier
    s_cmp_lg_u32 s42, 1
    s_cbranch_scc1 wf_110
    s_lshr_b32 s55, s2, 5
    s_lshl_b32 s55, s55, 2
    s_add_u32 s55, s55, s0
    v_mov_b32 v252, 2144
    v_mov_b32 v253, 0x01010101
    s_mov_b64 exec, 1
    s_cmp_eq_u32 s45, 0
    s_cbranch_scc1 st_111
    buffer_store_dword v253, v252, s[4:7], s55 offen sc0 sc1
    s_branch st_112
st_111:
    buffer_store_dword v253, v252, s[4:7], s55 offen
st_112:
    s_mov_b64 exec, -1
wf_110:
    s_waitcnt vmcnt(8)
    v_cmp_ne_u32 vcc, 0x01010101, v251
    s_cbranch_vccz ap_113
    v_lshrrev_b32 v252, 2, v254
    v_min_u32 v252, 28, v252
    s_add_u32 s55, s0, 2112
    s_mov_b32 s56, 262144
poll_114:
    buffer_load_dword v253, v252, s[4:7], s55 offen sc0 sc1
    s_waitcnt vmcnt(0)
    v_cmp_ne_u32 vcc, 0x01010101, v253
    s_cbranch_vccz pd_115
    s_sleep 1
    s_sub_u32 s56, s56, 1
    s_cmp_lg_u32 s56, 0
    s_cbranch_scc1 poll_114
pd_115:
ap_113:
    s_add_u32 m0, s62, 98304
    s_mov_b32 s92, 262144
    buffer_load_dwordx4 v217, s[4:7], s92 offen lds
    buffer_load_dwordx4 v217, s[4:7], s92 offen offset:1024 lds
    buffer_load_dwordx4 v217, s[4:7], s92 offen offset:2048 lds
    buffer_load_dwordx4 v217, s[4:7], s92 offen offset:3072 lds
    s_add_u32 m0, s62, 32768
    s_add_u32 s59, s69, 1179648
    buffer_load_dwordx4 v213, s[20:23], s59 offen lds
    buffer_load_dwordx4 v214, s[20:23], s59 offen offset:1024 lds
    buffer_load_dwordx4 v215, s[20:23], s59 offen offset:2048 lds
    buffer_load_dwordx4 v216, s[20:23], s59 offen offset:3072 lds
    s_waitcnt vmcnt(12)
    s_barrier
    s_add_u32 m0, s62, 114688
    s_mov_b32 s92, 278528
    buffer_load_dwordx4 v217, s[4:7], s92 offen lds
    buffer_load_dwordx4 v217, s[4:7], s92 offen offset:1024 lds
    buffer_load_dwordx4 v217, s[4:7], s92 offen offset:2048 lds
    buffer_load_dwordx4 v217, s[4:7], s92 offen offset:3072 lds
    s_add_u32 m0, s62, 49152
    s_add_u32 s59, s69, 1441792
    buffer_load_dwordx4 v213, s[20:23], s59 offen lds
    buffer_load_dwordx4 v214, s[20:23], s59 offen offset:1024 lds
    buffer_load_dwordx4 v215, s[20:23], s59 offen offset:2048 lds
    buffer_load_dwordx4 v216, s[20:23], s59 offen offset:3072 lds
    s_waitcnt vmcnt(12)
    s_barrier
    s_add_u32 m0, s62, 131072
    s_mov_b32 s92, 294912
    buffer_load_dwordx4 v217, s[4:7], s92 offen lds
    buffer_load_dwordx4 v217, s[4:7], s92 offen offset:1024 lds
    buffer_load_dwordx4 v217, s[4:7], s92 offen offset:2048 lds
    buffer_load_dwordx4 v217, s[4:7], s92 offen offset:3072 lds
    s_add_u32 m0, s62, 65536
    s_add_u32 s59, s69, 2097152
    buffer_load_dwordx4 v213, s[20:23], s59 offen lds
    buffer_load_dwordx4 v214, s[20:23], s59 offen offset:1024 lds
    buffer_load_dwordx4 v215, s[20:23], s59 offen offset:2048 lds
    buffer_load_dwordx4 v216, s[20:23], s59 offen offset:3072 lds
    s_waitcnt vmcnt(12)
    s_barrier
    s_add_u32 m0, s62, 98304
    s_mov_b32 s92, 311296
    buffer_load_dwordx4 v217, s[4:7], s92 offen lds
    buffer_load_dwordx4 v217, s[4:7], s92 offen offset:1024 lds
    buffer_load_dwordx4 v217, s[4:7], s92 offen offset:2048 lds
    buffer_load_dwordx4 v217, s[4:7], s92 offen offset:3072 lds
    s_add_u32 m0, s62, 81920
    s_add_u32 s59, s69, 2359296
    buffer_load_dwordx4 v213, s[20:23], s59 offen lds
    buffer_load_dwordx4 v214, s[20:23], s59 offen offset:1024 lds
    buffer_load_dwordx4 v215, s[20:23], s59 offen offset:2048 lds
    buffer_load_dwordx4 v216, s[20:23], s59 offen offset:3072 lds
    s_waitcnt vmcnt(12)
    s_barrier
    s_add_u32 m0, s62, 114688
    s_mov_b32 s92, 327680
    buffer_load_dwordx4 v217, s[4:7], s92 offen lds
    buffer_load_dwordx4 v217, s[4:7], s92 offen offset:1024 lds
    buffer_load_dwordx4 v217, s[4:7], s92 offen offset:2048 lds
    buffer_load_dwordx4 v217, s[4:7], s92 offen offset:3072 lds
    s_add_u32 m0, s62, 0
    s_add_u32 s59, s69, 3014656
    buffer_load_dwordx4 v213, s[20:23], s59 offen lds
    buffer_load_dwordx4 v214, s[20:23], s59 offen offset:1024 lds
    buffer_load_dwordx4 v215, s[20:23], s59 offen offset:2048 lds
    buffer_load_dwordx4 v216, s[20:23], s59 offen offset:3072 lds
    s_waitcnt vmcnt(12)
    s_barrier
    s_add_u32 m0, s62, 131072
    s_mov_b32 s92, 344064
    buffer_load_dwordx4 v217, s[4:7], s92 offen lds
    buffer_load_dwordx4 v217, s[4:7], s92 offen offset:1024 lds
    buffer_load_dwordx4 v217, s[4:7], s92 offen offset:2048 lds
    buffer_load_dwordx4 v217, s[4:7], s92 offen offset:3072 lds
    s_add_u32 m0, s62, 16384
    s_add_u32 s59, s69, 3276800
    buffer_load_dwordx4 v213, s[20:23], s59 offen lds
    buffer_load_dwordx4 v214, s[20:23], s59 offen offset:1024 lds
    buffer_load_dwordx4 v215, s[20:23], s59 offen offset:2048 lds
    buffer_load_dwordx4 v216, s[20:23], s59 offen offset:3072 lds
    s_waitcnt vmcnt(12)
    s_barrier
    s_add_u32 m0, s62, 98304
    s_mov_b32 s92, 360448
    buffer_load_dwordx4 v217, s[4:7], s92 offen lds
    buffer_load_dwordx4 v217, s[4:7], s92 offen offset:1024 lds
    buffer_load_dwordx4 v217, s[4:7], s92 offen offset:2048 lds
    buffer_load_dwordx4 v217, s[4:7], s92 offen offset:3072 lds
    v_add_u32 v214, 8192, v214
    v_add_u32 v215, 16384, v215
    v_add_u32 v216, 24576, v216
    s_mul_i32 s59, s44, 24576
    s_sub_u32 s69, s69, s59
    s_add_u32 m0, s62, 32768
    s_add_u32 s59, s69, 393216
    buffer_load_dwordx4 v213, s[20:23], s59 offen lds
    buffer_load_dwordx4 v214, s[20:23], s59 offen offset:1024 lds
    buffer_load_dwordx4 v215, s[20:23], s59 offen offset:2048 lds
    buffer_load_dwordx4 v216, s[20:23], s59 offen offset:3072 lds
    s_waitcnt vmcnt(12)
    s_barrier
    v_lshrrev_b32 v252, 2, v254
    v_min_u32 v252, 28, v252
    s_add_u32 s55, s0, 2144
    buffer_load_dword v251, v252, s[4:7], s55 offen sc0 sc1
    s_add_u32 m0, s62, 114688
    s_mov_b32 s92, 376832
    buffer_load_dwordx4 v217, s[4:7], s92 offen lds
    buffer_load_dwordx4 v217, s[4:7], s92 offen offset:1024 lds
    buffer_load_dwordx4 v217, s[4:7], s92 offen offset:2048 lds
    buffer_load_dwordx4 v217, s[4:7], s92 offen offset:3072 lds
    s_add_u32 m0, s62, 49152
    s_add_u32 s59, s69, 1310720
    buffer_load_dwordx4 v213, s[20:23], s59 offen lds
    buffer_load_dwordx4 v214, s[20:23], s59 offen offset:1024 lds
    buffer_load_dwordx4 v215, s[20:23], s59 offen offset:2048 lds
    buffer_load_dwordx4 v216, s[20:23], s59 offen offset:3072 lds
    s_waitcnt vmcnt(13)
    s_barrier
    s_waitcnt vmcnt(8)
    v_cmp_ne_u32 vcc, 0x01010101, v251
    s_cbranch_vccz ap_116
    v_lshrrev_b32 v252, 2, v254
    v_min_u32 v252, 28, v252
    s_add_u32 s55, s0, 2144
    s_mov_b32 s56, 262144
poll_117:
    buffer_load_dword v253, v252, s[4:7], s55 offen sc0 sc1
    s_waitcnt vmcnt(0)
    v_cmp_ne_u32 vcc, 0x01010101, v253
    s_cbranch_vccz pd_118
    s_sleep 1
    s_sub_u32 s56, s56, 1
    s_cmp_lg_u32 s56, 0
    s_cbranch_scc1 poll_117
pd_118:
ap_116:
    s_add_u32 m0, s62, 131072
    s_mov_b32 s92, 393216
    buffer_load_dwordx4 v217, s[4:7], s92 offen lds
    buffer_load_dwordx4 v217, s[4:7], s92 offen offset:1024 lds
    buffer_load_dwordx4 v217, s[4:7], s92 offen offset:2048 lds
    buffer_load_dwordx4 v217, s[4:7], s92 offen offset:3072 lds
    s_add_u32 m0, s62, 65536
    s_add_u32 s59, s69, 2228224
    buffer_load_dwordx4 v213, s[20:23], s59 offen lds
    buffer_load_dwordx4 v214, s[20:23], s59 offen offset:1024 lds
    buffer_load_dwordx4 v215, s[20:23], s59 offen offset:2048 lds
    buffer_load_dwordx4 v216, s[20:23], s59 offen offset:3072 lds
    s_waitcnt vmcnt(12)
    s_barrier
    s_add_u32 m0, s62, 98304
    s_mov_b32 s92, 409600
    buffer_load_dwordx4 v217, s[4:7], s92 offen lds
    buffer_load_dwordx4 v217, s[4:7], s92 offen offset:1024 lds
    buffer_load_dwordx4 v217, s[4:7], s92 offen offset:2048 lds
    buffer_load_dwordx4 v217, s[4:7], s92 offen offset:3072 lds
    s_add_u32 m0, s62, 81920
    s_add_u32 s59, s69, 3145728
    buffer_load_dwordx4 v213, s[20:23], s59 offen lds
    buffer_load_dwordx4 v214, s[20:23], s59 offen offset:1024 lds
    buffer_load_dwordx4 v215, s[20:23], s59 offen offset:2048 lds
    buffer_load_dwordx4 v216, s[20:23], s59 offen offset:3072 lds
    v_subrev_u32 v214, 8192, v214
    v_subrev_u32 v215, 16384, v215
    v_subrev_u32 v216, 24576, v216
    s_mul_i32 s59, s44, 24576
    s_add_u32 s69, s69, s59
    s_waitcnt vmcnt(12)
    s_barrier
    s_add_u32 m0, s62, 114688
    s_mov_b32 s92, 425984
    buffer_load_dwordx4 v217, s[4:7], s92 offen lds
    buffer_load_dwordx4 v217, s[4:7], s92 offen offset:1024 lds
    buffer_load_dwordx4 v217, s[4:7], s92 offen offset:2048 lds
    buffer_load_dwordx4 v217, s[4:7], s92 offen offset:3072 lds
    s_lshl_b32 s93, s51, 12
    s_add_u32 m0, s61, 0
    s_mul_i32 s59, s93, 96
    buffer_load_dwordx4 v200, s[8:11], s59 offen lds
    buffer_load_dwordx4 v201, s[8:11], s59 offen offset:1024 lds
    buffer_load_dwordx4 v202, s[8:11], s59 offen offset:2048 lds
    s_add_u32 s93, s93, 2048
    s_and_b32 s93, s93, 65535
    s_waitcnt vmcnt(11)
    s_barrier
    s_add_u32 m0, s62, 131072
    s_mov_b32 s92, 442368
    buffer_load_dwordx4 v217, s[4:7], s92 offen lds
    buffer_load_dwordx4 v217, s[4:7], s92 offen offset:1024 lds
    buffer_load_dwordx4 v217, s[4:7], s92 offen offset:2048 lds
    buffer_load_dwordx4 v217, s[4:7], s92 offen offset:3072 lds
    s_add_u32 m0, s61, 16384
    s_mul_i32 s59, s93, 96
    buffer_load_dwordx4 v200, s[8:11], s59 offen lds
    buffer_load_dwordx4 v201, s[8:11], s59 offen offset:1024 lds
    buffer_load_dwordx4 v202, s[8:11], s59 offen offset:2048 lds
    s_add_u32 s93, s93, 6144
    s_and_b32 s93, s93, 65535
    s_waitcnt vmcnt(10)
    s_barrier
    s_add_u32 m0, s61, 32768
    s_mul_i32 s59, s93, 96
    buffer_load_dwordx4 v200, s[8:11], s59 offen lds
    buffer_load_dwordx4 v201, s[8:11], s59 offen offset:1024 lds
    buffer_load_dwordx4 v202, s[8:11], s59 offen offset:2048 lds
    s_add_u32 s93, s93, 2048
    s_and_b32 s93, s93, 65535
    s_add_u32 m0, s61, 49152
    s_mul_i32 s59, s93, 96
    buffer_load_dwordx4 v200, s[8:11], s59 offen lds
    buffer_load_dwordx4 v201, s[8:11], s59 offen offset:1024 lds
    buffer_load_dwordx4 v202, s[8:11], s59 offen offset:2048 lds
    s_add_u32 s93, s93, 6144
    s_and_b32 s93, s93, 65535
    s_waitcnt vmcnt(9)
    s_barrier
    s_add_u32 m0, s61, 65536
    s_mul_i32 s59, s93, 96
    buffer_load_dwordx4 v200, s[8:11], s59 offen lds
    buffer_load_dwordx4 v201, s[8:11], s59 offen offset:1024 lds
    buffer_load_dwordx4 v202, s[8:11], s59 offen offset:2048 lds
    s_add_u32 s93, s93, 2048
    s_and_b32 s93, s93, 65535
    s_barrier
    s_add_u32 m0, s61, 81920
    s_mul_i32 s59, s93, 96
    buffer_load_dwordx4 v200, s[8:11], s59 offen lds
    buffer_load_dwordx4 v201, s[8:11], s59 offen offset:1024 lds
    buffer_load_dwordx4 v202, s[8:11], s59 offen offset:2048 lds
    s_add_u32 s93, s93, 6144
    s_and_b32 s93, s93, 65535
    s_setprio 0
    s_cmp_lg_u32 s46, 0
    s_cbranch_scc1 K_end
    s_lshl_b32 s60, s43, 23
    s_add_u32 s60, s60, 83886336
    s_mov_b32 s28, s16
    s_mov_b32 s29, s17
    s_mov_b32 s30, s18
    s_mov_b32 s31, s19
    s_mov_b32 s46, 1
    s_add_u32 s47, s47, 262144
    s_add_u32 s49, s49, 524288
    s_add_u32 s50, s50, 917504
    s_add_u32 s52, s52, 65536
    s_add_u32 s54, s54, 32768
    s_add_u32 s0, s0, 32768
    s_branch Y_layer
K_end:
    s_endpgm

.section .rodata,"a"
.p2align 6
.amdhsa_kernel interleave_layers__sliding_local_dilated__glu_gated_swiglu__prompt_kernel
  .amdhsa_next_free_vgpr 256
  .amdhsa_next_free_sgpr 102
  .amdhsa_accum_offset 256
  .amdhsa_group_segment_fixed_size 0
  .amdhsa_kernarg_size 80
  .amdhsa_user_sgpr_count 2
  .amdhsa_user_sgpr_kernarg_segment_ptr 1
  .amdhsa_system_sgpr_workgroup_id_x 1
.end_amdhsa_kernel
```
